```python
import torch

def _softmax(x, axis=-1):
    return torch.softmax(x, dim=axis)
def _gelu(x):
    return torch.nn.functional.gelu(x, approximate="tanh")
def _silu(x):
    return torch.nn.functional.silu(x)
def _sigmoid(x):
    return torch.sigmoid(x)
def _layernorm(x, axis=-1, eps=1e-5):
    m = x.mean(dim=axis, keepdim=True)
    v = x.var(dim=axis, keepdim=True, unbiased=False)
    return (x - m) / torch.sqrt(v + eps)
def _scatter_add(tgt, idx, src, axis=0):
    return tgt.clone().index_add_(axis, idx, src)
def _segment_sum(src, seg, n):
    out = torch.zeros((n,) + src.shape[1:], dtype=src.dtype)
    return out.index_add_(0, seg, src)
def _pad(x, pw):
    flat = tuple(v for pair in reversed(pw) for v in pair)
    return torch.nn.functional.pad(x, flat)

kernel_name = 'recurrent_scan__sliding_local_dilated__moe_arch_mod__prompt'

def setup_inputs():

    _w = (lambda a: (lambda t: t.to(torch.bfloat16) if t.is_floating_point() else t)(torch.as_tensor(a)))
    def _A_setup():
        B, S, D = 1, 2048, 640
        return {
            "x": _w((lambda *s: torch.randn(*s, dtype=torch.bfloat16) * 0.05)(B, S, D)),
            "wqkv": _w((lambda *s: torch.randn(*s, dtype=torch.bfloat16) * 0.05)(D, 3 * D)),
            "wo": _w((lambda *s: torch.randn(*s, dtype=torch.bfloat16) * 0.05)(D, D)),
        }
    _A_in = _A_setup()

    def _B_setup():
        B, S, D, F, C = 1, 2048, 640, 1728, 2
        return {
            "x": _w((lambda *s: torch.randn(*s, dtype=torch.bfloat16) * 0.05)(B, S, D)),
            "w_r": _w((lambda *s: torch.randn(*s, dtype=torch.bfloat16) * 0.05)(D)),
            "w_gate": _w((lambda *s: torch.randn(*s, dtype=torch.bfloat16) * 0.05)(D, F)),
            "w_up": _w((lambda *s: torch.randn(*s, dtype=torch.bfloat16) * 0.05)(D, F)),
            "w_down": _w((lambda *s: torch.randn(*s, dtype=torch.bfloat16) * 0.05)(F, D)),
        }
    _B_in = _B_setup()

    return {
        "A_x": _A_in["x"],
        "A_wqkv": _A_in["wqkv"],
        "A_wo": _A_in["wo"],
        "B_x": _B_in["x"],
        "B_w_r": _B_in["w_r"],
        "B_w_gate": _B_in["w_gate"],
        "B_w_up": _B_in["w_up"],
        "B_w_down": _B_in["w_down"],
    }

def reference(A_x, A_wqkv, A_wo, B_x, B_w_r, B_w_gate, B_w_up, B_w_down):
    def _A_ref(x, wqkv, wo):
        B, S, D = x.shape
        H = 32; Dh = D // H
        W, dil = 8, 2
        qkv = (lambda x, *d: x.permute(*d))((x @ wqkv).reshape(B, S, 3, H, Dh), 2, 0, 3, 1, 4)
        q, k, v = qkv[0], qkv[1], qkv[2]
        scale = Dh ** -0.5
        pos = torch.arange(S)
        off = torch.arange(W) * dil
        idx = pos[:, None] - off[None, :]
        mask = idx >= 0
        idx_c = torch.where(mask, idx, 0).reshape(-1)
        kg = k[:, :, idx_c, :].reshape(B, H, S, W, Dh)
        vg = v[:, :, idx_c, :].reshape(B, H, S, W, Dh)
        logits = torch.einsum("bhsd,bhswd->bhsw", q, kg) * scale
        logits = torch.where(mask[None, None, :, :], logits, -1e9)
        attn = _softmax(logits, axis=-1)
        o = torch.einsum("bhsw,bhswd->bhsd", attn, vg)
        return (lambda x, *d: x.permute(*d))(o, 0, 2, 1, 3).reshape(B, S, D) @ wo

    def _B_ref(x, w_r, w_gate, w_up, w_down):
        B, S, D = x.shape
        C = 2
        r = x @ w_r
        idx = torch.argsort(-r, axis=-1)[:, :C]
        idx_e = (lambda x, n, axis: torch.repeat_interleave(x, n, dim=axis))(idx.reshape(B, C, 1), D, axis=2)
        x_sel = (lambda x, i, axis: torch.take_along_dim(x, i, dim=axis))(x, idx_e, axis=1)
        g = _silu(x_sel @ w_gate)
        u = x_sel @ w_up
        y = (g * u) @ w_down
        r_sel = _sigmoid((lambda x, i, axis: torch.take_along_dim(x, i, dim=axis))(r, idx, axis=1))
        y = y * r_sel.reshape(B, C, 1)
        b_off = (torch.arange(B) * S).reshape(B, 1)
        flat_idx = (idx + b_off).reshape(B * C)
        zero = (x * 0.0).reshape(B * S, D)
        upd = _scatter_add(zero, flat_idx, y.reshape(B * C, D), axis=0)
        return x + upd.reshape(B, S, D)

    x = A_x
    xn = _layernorm(x, axis=-1)
    s = _A_ref(xn, A_wqkv, A_wo)
    g = _silu(_B_ref(xn, B_w_r, B_w_gate, B_w_up, B_w_down))
    return x + s * g
```

```asm
; @launch grid=(256,1,1) block=(512,1,1) lds=163840
.amdgcn_target "amdgcn-amd-amdhsa--gfx950"
.text
.globl recurrent_scan__sliding_local_dilated__moe_arch_mod__prompt_kernel
.p2align 8
.type recurrent_scan__sliding_local_dilated__moe_arch_mod__prompt_kernel,@function
recurrent_scan__sliding_local_dilated__moe_arch_mod__prompt_kernel:
    s_load_dwordx2 s[24:25], s[0:1], 0
    s_load_dwordx2 s[32:33], s[0:1], 8
    s_load_dwordx2 s[28:29], s[0:1], 80
    s_cmpk_ge_u32 s2, 256
    s_cbranch_scc1 K_EXIT
    v_readfirstlane_b32 s3, v0
    s_getpc_b64 s[20:21]
K_PC:
    s_lshr_b32 s54, s2, 3
    s_lshl_b32 s60, s54, 10
    v_lshl_add_u32 v2, v0, 1, s60
    global_load_ushort v255, v2, s[20:21]
    s_mul_i32 s60, s54, 52
    s_lshr_b32 s60, s60, 8
    s_mul_i32 s53, s60, 5
    s_sub_u32 s53, s54, s53
    s_add_u32 s67, s60, s53
    s_bitcmp1_b32 s2, 1
    s_cselect_b32 s61, 5, 0
    s_add_u32 s56, s60, s61
    s_mulk_i32 s56, 104
    s_sub_u32 s56, s56, 8
    s_and_b32 s57, s2, 4
    s_mulk_i32 s57, 320
    s_bitcmp1_b32 s2, 0
    s_cselect_b32 s61, 5, 0
    s_add_u32 s58, s53, s61
    s_lshl_b32 s58, s58, 7
    s_mov_b32 s26, 2621440
    s_mov_b32 s27, 0x20000
    s_lshr_b32 s60, s3, 3
    s_max_u32 s60, s60, s54
    s_cmp_ge_u32 s60, 25
    s_cbranch_scc1 K_NL
    v_lshrrev_b32 v2, 3, v0
    v_add_u32 v3, s56, v2
    v_mul_i32_i24 v3, 2560, v3
    v_bitop3_b32 v1, v0, v2, 7 bitop3:0x28
    v_lshl_add_u32 v196, v1, 4, v3
    v_and_b32 v3, 2, v2
    v_lshrrev_b32 v1, 1, v2
    v_and_or_b32 v3, v1, 4, v3
    v_bitop3_b32 v3, v0, v3, 7 bitop3:0x28
    v_mul_u32_u24 v200, 3840, v2
    v_lshl_add_u32 v200, v3, 4, v200
    s_cmp_ge_u32 s67, 5
    s_cselect_b32 s61, 5, 0
    s_sub_u32 s67, s67, s61
    s_lshl_b32 s67, s67, 2
    s_and_b32 s68, s2, 6
    s_mul_i32 s68, s68, 5
    s_lshr_b32 s68, s68, 2
    s_lshl_b32 s69, s3, 4
    s_mov_b32 s34, 2457600
    s_mov_b32 s35, s27
    s_cmp_eq_u32 s3, 0
    s_cselect_b32 s70, 0xffffff00, -1
    s_cmpk_lt_u32 s69, 2048
    s_cselect_b64 vcc, -1, 0
    s_lshr_b32 s64, 66064, s67
    s_and_b32 s64, s64, 15
    s_add_u32 s64, s64, s68
    s_cmp_ge_u32 s64, 10
    s_cselect_b32 s65, 10, 0
    s_sub_u32 s64, s64, s65
    s_mul_i32 s65, s64, 245760
    s_lshl_b32 s64, s64, 7
    s_add_u32 s64, s64, s57
    s_add_u32 m0, s69, 77824
    s_mov_b32 exec_lo, s70
    s_waitcnt lgkmcnt(0)
    buffer_load_dwordx4 v196, s[24:27], s64 offen lds
    s_add_u32 m0, s69, 81920
    s_mov_b32 exec_lo, -1
    v_add_u32 v197, 81920, v196
    buffer_load_dwordx4 v197, s[24:27], s64 offen lds
    s_add_u32 m0, s69, 86016
    s_add_u32 s65, s65, s58
    v_add_u32 v198, 163840, v196
    buffer_load_dwordx4 v198, s[24:27], s64 offen lds
    v_add_u32 v199, 245760, v196
    s_cbranch_vccz L_SK0
    s_add_u32 m0, s69, 90112
    s_nop 0
    buffer_load_dwordx4 v199, s[24:27], s64 offen lds
L_SK0:
    s_add_u32 m0, s69, 92160
    s_add_u32 s66, s65, 122880
    buffer_load_dwordx4 v200, s[32:35], s65 offen offset:0 lds
    s_add_u32 m0, s69, 99072
    s_nop 0
    buffer_load_dwordx4 v200, s[32:35], s65 offen offset:1280 lds
    s_add_u32 m0, s69, 105984
    s_nop 0
    buffer_load_dwordx4 v200, s[32:35], s65 offen offset:2560 lds
    s_add_u32 m0, s69, 96256
    s_nop 0
    buffer_load_dwordx4 v200, s[32:35], s66 offen offset:0 lds
    s_add_u32 m0, s69, 103168
    s_nop 0
    buffer_load_dwordx4 v200, s[32:35], s66 offen offset:1280 lds
    s_add_u32 m0, s69, 110080
    s_nop 0
    buffer_load_dwordx4 v200, s[32:35], s66 offen offset:2560 lds
    s_branch L_CONT
K_NL:
    s_cmpk_ge_u32 s3, 256
    s_cbranch_scc1 K_ER
    s_sub_u32 s56, s2, 200
    s_mov_b32 s101, 1
    s_cmp_ge_u32 s56, 27
    s_cbranch_scc1 K_AUX
    s_load_dwordx2 s[48:49], s[0:1], 40
    s_load_dwordx2 s[36:37], s[0:1], 48
    v_lshrrev_b32 v2, 3, v0
    v_and_b32 v3, 2, v2
    v_lshrrev_b32 v1, 1, v2
    v_and_or_b32 v3, v1, 4, v3
    v_bitop3_b32 v3, v0, v3, 7 bitop3:0x28
    v_mul_u32_u24 v30, 3456, v2
    v_lshl_add_u32 v30, v3, 4, v30
    s_lshl_b32 s68, s56, 7
    s_lshl_b32 s69, s3, 4
    s_mov_b32 s70, 12
    s_mov_b32 s50, 2211840
    s_mov_b32 s51, 0x20000
    s_mov_b32 s38, 2211840
    s_mov_b32 s39, 0x20000
    s_waitcnt lgkmcnt(0)
FL_GU1:
    s_mov_b32 m0, s69
    s_sub_u32 s70, s70, 1
    buffer_load_dwordx4 v30, s[48:51], s68 offen nt lds
    s_add_u32 m0, s69, 16384
    s_add_u32 s69, s69, 4096
    buffer_load_dwordx4 v30, s[36:39], s68 offen nt lds
    s_add_u32 s68, s68, 110592
    s_and_b32 s60, s70, 3
    s_cselect_b32 s60, 0, 16384
    s_add_u32 s69, s69, s60
    s_cmp_lg_u32 s70, 0
    s_cbranch_scc1 FL_GU1
    s_mov_b32 s101, 5
    s_branch K_AUX
K_ER:
    s_setprio 3
    s_load_dwordx2 s[22:23], s[0:1], 32
    v_bfe_u32 v232, v0, 5, 3
    v_and_b32 v4, 31, v0
    v_mul_u32_u24 v7, 2560, v232
    v_lshlrev_b32 v5, 4, v4
    v_lshlrev_b32 v6, 3, v4
    v_add_u32 v8, v7, v6
    v_add_u32 v7, v7, v5
    s_and_b32 s68, s2, 3
    s_lshl_b32 s68, s68, 5
    s_add_u32 s68, s68, s54
    s_mul_i32 s69, s68, 20480
    s_add_u32 s69, s69, s57
    s_waitcnt lgkmcnt(0)
    buffer_load_dwordx4 v[212:215], v7, s[24:27], s69 offen
    buffer_load_dwordx4 v[216:219], v7, s[24:27], s69 offen offset:512
    buffer_load_dwordx2 v[220:221], v8, s[24:27], s69 offen offset:1024
    global_load_dwordx4 v[222:225], v5, s[22:23]
    global_load_dwordx4 v[226:229], v5, s[22:23] offset:512
    global_load_dwordx2 v[230:231], v6, s[22:23] offset:1024
    s_load_dword s52, s[28:29], 0
    s_mov_b32 s30, 7077888
    s_mov_b32 s31, 0x20000
    s_and_b32 s70, s2, 4
    s_lshl_b32 s70, s70, 5
    s_add_u32 s70, s70, s68
    s_lshl_b32 s71, s70, 6
    s_lshl_b32 s70, s70, 7
    s_add_u32 s70, s70, 16384
    s_add_u32 s71, s71, 49152
    s_setprio 0
    s_mov_b32 s101, 1
    s_cmp_ge_u32 s54, 25
    s_cbranch_scc1 K_AUX0
    s_mul_i32 s60, s3, 5
    s_lshl_b32 s61, s53, 6
    s_add_u32 s60, s60, s61
    s_add_u32 s60, s60, K_TAB-K_PC
    s_load_dwordx16 s[4:19], s[20:21], s60
    s_load_dwordx2 s[44:45], s[0:1], 64
    s_load_dwordx2 s[40:41], s[0:1], 16
    s_mov_b32 s46, 2621440
    s_mov_b32 s47, 0x20000
    s_mov_b32 s30, 7077888
    s_mov_b32 s31, 0x20000
    s_mov_b32 s42, 819200
    s_mov_b32 s43, 0x20000
    s_lshr_b32 s3, s3, 6
    s_and_b32 s59, s3, 3
    s_mov_b32 s55, 0xffff0000
    s_mov_b32 s100, 0
    v_and_b32 v1, 63, v0
    v_and_b32 v4, 15, v1
    v_lshrrev_b32 v5, 4, v1
    v_mov_b32 v19, 163584
    v_add_u32 v18, s3, v19
    v_mov_b32 v2, 0
    v_mov_b32 v3, 0
    v_mov_b32 v46, 0x00010100
    v_mov_b32 v47, 0x01000001
    ds_write2_b64 v19, v[2:3], v[46:47] offset1:1
    ds_write_b64 v19, v[46:47] offset:16
    v_bfe_u32 v46, v0, 1, 7
    v_min_u32 v46, 111, v46
    v_mul_u32_u24 v46, 392, v46
    v_add_u32 v46, 116864, v46
    ds_write_b64 v46, v[2:3]
    s_min_u32 s60, s59, 2
    s_mul_i32 s60, s60, 38912
    v_and_b32 v46, 31, v0
    v_lshl_add_u32 v46, v46, 2, s60
    v_mov_b32 v47, 0x3f803f80
    ds_write_b32 v46, v47
    v_lshlrev_b32 v6, 4, v1
    v_mov_b32 v28, 0x3f803f80
    v_mov_b32 v29, 0x3f803f80
    v_mov_b32 v30, 0x3f803f80
    v_mov_b32 v31, 0x3f803f80
    v_lshlrev_b32 v2, 2, v5
    v_sub_u32 v3, v4, v2
    v_add_u32 v3, 12, v3
    s_mov_b32 s60, 267390975
    v_bfe_i32 v32, s60, v3, 1
    v_and_b32 v32, 0xff800000, v32
    s_mov_b32 s60, 268435440
    v_bfe_i32 v36, s60, v3, 1
    v_and_b32 v36, 0xff800000, v36
    s_mov_b32 s60, 266346495
    v_bfe_i32 v33, s60, v3, 1
    v_and_b32 v33, 0xff800000, v33
    s_mov_b32 s60, 268435424
    v_bfe_i32 v37, s60, v3, 1
    v_and_b32 v37, 0xff800000, v37
    s_mov_b32 s60, 264257535
    v_bfe_i32 v34, s60, v3, 1
    v_and_b32 v34, 0xff800000, v34
    s_mov_b32 s60, 268435392
    v_bfe_i32 v38, s60, v3, 1
    v_and_b32 v38, 0xff800000, v38
    s_mov_b32 s60, 260079615
    v_bfe_i32 v35, s60, v3, 1
    v_and_b32 v35, 0xff800000, v35
    s_mov_b32 s60, 268435328
    v_bfe_i32 v39, s60, v3, 1
    v_and_b32 v39, 0xff800000, v39
    v_sub_u32 v2, 13, v3
    v_med3_i32 v2, v2, 0, 2
    v_lshlrev_b32 v2, 3, v2
    v_mov_b32 v40, -1
    v_lshrrev_b32 v40, v2, v40
    v_lshrrev_b32 v40, v2, v40
    v_sub_u32 v2, 15, v3
    v_med3_i32 v2, v2, 0, 2
    v_lshlrev_b32 v2, 3, v2
    v_mov_b32 v41, -1
    v_lshrrev_b32 v41, v2, v41
    v_lshrrev_b32 v41, v2, v41
    v_mul_u32_u24 v25, 20224, v5
    v_add_u32 v25, v25, v6
    v_lshrrev_b32 v24, 5, v1
    v_mul_u32_u24 v24, 19968, v24
    v_add_u32 v24, v24, v6
    v_lshlrev_b32 v26, 4, v4
    v_add_u32 v26, 162568, v26
    v_bfe_u32 v2, v1, 2, 2
    v_lshlrev_b32 v2, 7, v2
    v_and_b32 v3, 8, v1
    v_lshl_add_u32 v2, v3, 2, v2
    v_and_b32 v3, 3, v1
    v_lshl_add_u32 v2, v3, 3, v2
    v_and_b32 v3, 48, v1
    s_mov_b32 s62, 0xffff
    s_mov_b32 s60, 1140867648
    s_mov_b32 s61, 1312836608
    v_lshrrev_b64 v[46:47], v3, s[60:61]
    v_and_or_b32 v9, v46, s62, v2
    s_mov_b32 s60, 977287168
    s_mov_b32 s61, 3489713728
    v_lshrrev_b64 v[46:47], v3, s[60:61]
    v_and_or_b32 v10, v46, s62, v2
    s_mov_b32 s60, 1409305152
    s_mov_b32 s61, 1916823552
    v_lshrrev_b64 v[46:47], v3, s[60:61]
    v_and_or_b32 v11, v46, s62, v2
    s_mov_b32 s60, 3422601792
    s_mov_b32 s61, 3594534912
    v_lshrrev_b64 v[46:47], v3, s[60:61]
    v_and_or_b32 v12, v46, s62, v2
    s_mov_b32 s60, 1514166272
    s_mov_b32 s61, 2990583808
    v_lshrrev_b64 v[46:47], v3, s[60:61]
    v_and_or_b32 v13, v46, s62, v2
    s_mov_b32 s60, 2013295616
    s_mov_b32 s61, 2550174272
    v_lshrrev_b64 v[46:47], v3, s[60:61]
    v_and_or_b32 v14, v46, s62, v2
    s_mov_b32 s60, 2080396864
    s_mov_b32 s61, 3087046208
    v_lshrrev_b64 v[46:47], v3, s[60:61]
    v_and_or_b32 v15, v46, s62, v2
    v_lshrrev_b32 v2, 3, v1
    v_bitop3_b32 v3, v1, v2, 7 bitop3:0x28
    v_mul_u32_u24 v7, 2560, v2
    v_lshl_add_u32 v7, v3, 4, v7
    v_lshrrev_b32 v2, 5, v1
    v_bitop3_b32 v2, v2, v4, 7 bitop3:0x28
    v_lshlrev_b32 v8, 7, v4
    v_lshl_add_u32 v8, v2, 4, v8
    v_and_b32 v2, 1, v5
    v_lshl_add_u32 v8, v2, 3, v8
    v_bfe_u32 v2, v0, 3, 5
    v_and_b32 v3, 6, v2
    v_bitop3_b32 v3, v0, v3, 7 bitop3:0x28
    v_mul_u32_u24 v16, 1280, v2
    v_lshl_add_u32 v16, v3, 4, v16
    s_lshl_b32 s98, s56, 4
    s_mul_i32 s60, s57, 13
    s_add_u32 s98, s98, s60
    s_add_u32 s98, s98, 458880
    s_add_u32 s98, s98, s58
    s_cmp_eq_u32 s59, 0
    s_cselect_b32 s98, s98, 2146435072
    s_add_u32 s96, s56, 8
    s_mulk_i32 s96, 1408
    s_mul_i32 s60, s57, 1144
    s_add_u32 s96, s96, s60
    s_add_u32 s96, s96, 1048576
    s_and_b32 s62, s2, 1
    s_mulk_i32 s62, 10240
    s_add_u32 s62, s62, s96
    s_sub_u32 s63, s54, s53
    s_and_b32 s60, s2, 7
    s_mul_i32 s60, s60, 25
    s_add_u32 s63, s63, s60
    s_mulk_i32 s63, 11520
    s_add_u32 s63, s63, 4194304
    v_mul_u32_u24 v2, 392, v4
    v_add_u32 v2, 135552, v2
    v_lshlrev_b32 v3, 3, v5
    s_waitcnt lgkmcnt(0)
    s_mul_i32 s52, s52, 0x9E3779B1
    s_add_u32 s52, s52, 0x7F4A7C15
    s_or_b32 s52, s52, 1
    v_mov_b32 v46, s52
    ds_write_b32 v19, v46 offset:32
    v_bfe_u32 v20, s4, v3, 8
    v_bfe_u32 v21, s5, v3, 8
    v_add_u32 v20, v20, v2
    v_add_u32 v21, v21, v2
    v_lshrrev_b32 v2, 2, v1
    v_mul_u32_u24 v2, 392, v2
    v_add_u32 v2, 135552, v2
    v_add_u32 v23, s7, v2
    v_lshlrev_b32 v3, 3, v1
    v_bfe_u32 v22, s6, v3, 8
    v_add_u32 v22, v22, v2
    s_add_u32 s9, s9, s62
    s_add_u32 s10, s10, s62
    s_add_u32 s11, s11, s63
    s_add_u32 s12, s12, s63
    s_add_u32 s5, s9, 40960
    s_mul_i32 s60, s8, 20480
    s_add_u32 s96, s96, s60
    s_lshl4_add_u32 s95, s8, s56
    s_cmp_eq_u32 s8, 6
    s_cselect_b32 s101, 1, 2
    s_cmpk_ge_i32 s95, 1024
    s_cselect_b32 s101, 0, s101
    s_mul_i32 s97, s95, 2560
    s_add_u32 s97, s97, s57
    s_add_u32 s97, s97, s58
    s_add_u32 s94, s97, 20480
    s_cmp_eq_u32 s8, 0
    s_cselect_b32 s97, 2146435072, s97
    s_cselect_b32 s61, 2146435072, 0
    s_and_b32 s60, s53, 2
    s_mul_i32 s22, s60, 204800
    s_sub_u32 s23, 409600, s22
    s_add_u32 s22, s22, s58
    s_add_u32 s23, s23, s58
    s_mulk_i32 s60, 5120
    s_sub_u32 s4, s96, s60
    s_add_u32 s4, s4, 10240
    s_add_u32 s96, s96, s60
    s_add_u32 s92, s96, 4096
    s_add_u32 s93, s92, 4096
    s_add_u32 s6, s4, 4096
    s_add_u32 s7, s6, 4096
    v_bfe_i32 v2, v1, 3, 1
    v_bfi_b32 v2, v2, 0, s61
    v_or_b32 v27, v2, v6
    s_and_b32 s60, s2, 4
    s_lshl_b32 s60, s60, 8
    s_add_u32 s95, s95, s60
    s_lshl_b32 s60, s8, 11
    s_add_u32 s60, s60, 0
    v_add_u32 v8, s60, v8
    s_lshl_b32 s60, s8, 8
    s_add_u32 s60, s60, 161536
    v_lshl_add_u32 v17, v4, 4, s60
    v_bitop3_b32 v2, v5, v4, 7 bitop3:0x28
    v_lshlrev_b32 v2, 4, v2
    v_lshl_add_u32 v42, v4, 7, v2
    v_add_u32 v42, 77824, v42
    v_xor_b32 v43, 64, v42
    v_bfe_u32 v2, v1, 3, 2
    v_xor_b32 v2, s59, v2
    v_lshlrev_b32 v2, 5, v2
    v_lshl_add_u32 v2, v5, 10, v2
    v_bfe_u32 v3, v1, 2, 2
    v_lshl_add_u32 v2, v3, 7, v2
    v_and_b32 v3, 3, v1
    v_lshl_add_u32 v2, v3, 3, v2
    v_add_u32 v44, 92160, v2
    s_lshl_b32 s60, s59, 5
    s_add_u32 s60, s60, 116736
    v_mul_u32_u24 v46, 392, v4
    v_lshl_add_u32 v2, v5, 3, s60
    v_add_u32 v46, v46, v2
    v_lshlrev_b32 v45, 4, v4
    v_add_u32 v45, 161536, v45
    v_mov_b32 v48, 0
    v_mov_b32 v49, 0
    v_mov_b32 v50, 0
    v_mov_b32 v51, 0
    v_mov_b32 v52, 0
    v_mov_b32 v53, 0
    v_mov_b32 v54, 0
    v_mov_b32 v55, 0
    v_mov_b32 v56, 0
    v_mov_b32 v57, 0
    v_mov_b32 v58, 0
    v_mov_b32 v59, 0
    v_mov_b32 v60, 0
    v_mov_b32 v61, 0
    v_mov_b32 v62, 0
    v_mov_b32 v63, 0
    v_mov_b32 v64, 0
    v_mov_b32 v65, 0
    v_mov_b32 v66, 0
    v_mov_b32 v67, 0
    v_mov_b32 v68, 0
    v_mov_b32 v69, 0
    v_mov_b32 v70, 0
    v_mov_b32 v71, 0
    v_mov_b32 v72, 0
    v_mov_b32 v73, 0
    v_mov_b32 v74, 0
    v_mov_b32 v75, 0
    v_mov_b32 v76, 0
    v_mov_b32 v77, 0
    v_mov_b32 v78, 0
    v_mov_b32 v79, 0
    v_mov_b32 v80, 0
    v_mov_b32 v81, 0
    v_mov_b32 v82, 0
    v_mov_b32 v83, 0
    v_mov_b32 v84, 0
    v_mov_b32 v85, 0
    v_mov_b32 v86, 0
    v_mov_b32 v87, 0
    v_mov_b32 v88, 0
    v_mov_b32 v89, 0
    v_mov_b32 v90, 0
    v_mov_b32 v91, 0
    v_mov_b32 v92, 0
    v_mov_b32 v93, 0
    v_mov_b32 v94, 0
    v_mov_b32 v95, 0
    v_mov_b32 v96, 0
    v_mov_b32 v97, 0
    v_mov_b32 v98, 0
    v_mov_b32 v99, 0
    v_mov_b32 v100, 0
    v_mov_b32 v101, 0
    v_mov_b32 v102, 0
    v_mov_b32 v103, 0
    v_mov_b32 v104, 0
    v_mov_b32 v105, 0
    v_mov_b32 v106, 0
    v_mov_b32 v107, 0
    v_mov_b32 v108, 0
    v_mov_b32 v109, 0
    v_mov_b32 v110, 0
    v_mov_b32 v111, 0
    v_mov_b32 v112, 0
    v_mov_b32 v113, 0
    v_mov_b32 v114, 0
    v_mov_b32 v115, 0
    v_mov_b32 v116, 0
    v_mov_b32 v117, 0
    v_mov_b32 v118, 0
    v_mov_b32 v119, 0
    v_mov_b32 v120, 0
    v_mov_b32 v121, 0
    v_mov_b32 v122, 0
    v_mov_b32 v123, 0
    v_mov_b32 v124, 0
    v_mov_b32 v125, 0
    v_mov_b32 v126, 0
    v_mov_b32 v127, 0
    v_mov_b32 v128, 0
    v_mov_b32 v129, 0
    v_mov_b32 v130, 0
    v_mov_b32 v131, 0
    v_mov_b32 v241, 0x3f803f80
    v_mov_b32 v245, s52
    v_mov_b32 v247, s52
    s_bfe_u32 s60, s2, 0x10002
    s_lshl4_add_u32 s60, s68, s60
    s_sub_u32 s60, 0xffff, s60
    v_lshlrev_b32 v239, 1, v232
    v_sub_u32 v239, s60, v239
    v_lshlrev_b32 v243, 3, v232
    v_lshlrev_b32 v232, 4, v232
    v_mov_b32 v249, s52
    s_setprio 3
    s_waitcnt vmcnt(3)
    v_dot2_f32_bf16 v233, v212, v241, 0
    v_dot2_f32_bf16 v234, v212, v212, 0
    v_dot2_f32_bf16 v233, v213, v241, v233
    v_dot2_f32_bf16 v234, v213, v213, v234
    v_dot2_f32_bf16 v233, v214, v241, v233
    v_dot2_f32_bf16 v234, v214, v214, v234
    v_dot2_f32_bf16 v233, v215, v241, v233
    v_dot2_f32_bf16 v234, v215, v215, v234
    v_dot2_f32_bf16 v233, v216, v241, v233
    v_dot2_f32_bf16 v234, v216, v216, v234
    v_dot2_f32_bf16 v233, v217, v241, v233
    v_dot2_f32_bf16 v234, v217, v217, v234
    v_dot2_f32_bf16 v233, v218, v241, v233
    v_dot2_f32_bf16 v234, v218, v218, v234
    v_dot2_f32_bf16 v233, v219, v241, v233
    v_dot2_f32_bf16 v234, v219, v219, v234
    v_dot2_f32_bf16 v233, v220, v241, v233
    v_dot2_f32_bf16 v234, v220, v220, v234
    v_dot2_f32_bf16 v233, v221, v241, v233
    v_dot2_f32_bf16 v234, v221, v221, v234
    s_waitcnt vmcnt(0)
    v_dot2_f32_bf16 v235, v212, v222, 0
    v_dot2_f32_bf16 v236, v222, v241, 0
    v_dot2_f32_bf16 v235, v213, v223, v235
    v_dot2_f32_bf16 v236, v223, v241, v236
    v_dot2_f32_bf16 v235, v214, v224, v235
    v_dot2_f32_bf16 v236, v224, v241, v236
    v_dot2_f32_bf16 v235, v215, v225, v235
    v_dot2_f32_bf16 v236, v225, v241, v236
    v_dot2_f32_bf16 v235, v216, v226, v235
    v_dot2_f32_bf16 v236, v226, v241, v236
    v_dot2_f32_bf16 v235, v217, v227, v235
    v_dot2_f32_bf16 v236, v227, v241, v236
    v_dot2_f32_bf16 v235, v218, v228, v235
    v_dot2_f32_bf16 v236, v228, v241, v236
    v_dot2_f32_bf16 v235, v219, v229, v235
    v_dot2_f32_bf16 v236, v229, v241, v236
    v_dot2_f32_bf16 v235, v220, v230, v235
    v_dot2_f32_bf16 v236, v230, v241, v236
    v_dot2_f32_bf16 v235, v221, v231, v235
    v_dot2_f32_bf16 v236, v231, v241, v236
    v_permlane16_swap_b32 v233, v234
    v_add_f32 v233, v233, v234
    s_nop 0
    v_permlane16_swap_b32 v235, v236
    v_add_f32 v235, v235, v236
    v_add_f32_dpp v233, v233, v233 row_ror:8 row_mask:0xf bank_mask:0xf
    s_nop 0
    v_add_f32_dpp v235, v235, v235 row_ror:8 row_mask:0xf bank_mask:0xf
    v_add_f32_dpp v233, v233, v233 row_ror:4 row_mask:0xf bank_mask:0xf
    s_nop 0
    v_add_f32_dpp v235, v235, v235 row_ror:4 row_mask:0xf bank_mask:0xf
    v_add_f32_dpp v233, v233, v233 row_ror:2 row_mask:0xf bank_mask:0xf
    s_nop 0
    v_add_f32_dpp v235, v235, v235 row_ror:2 row_mask:0xf bank_mask:0xf
    v_add_f32_dpp v233, v233, v233 row_ror:1 row_mask:0xf bank_mask:0xf
    s_nop 0
    v_add_f32_dpp v235, v235, v235 row_ror:1 row_mask:0xf bank_mask:0xf
    v_mul_f32 v233, 0x3acccccd, v233
    v_mov_b32 v236, v235
    v_mov_b32 v234, v233
    s_nop 0
    v_permlane16_swap_b32 v235, v236
    v_permlane16_swap_b32 v233, v234
    v_fma_f32 v234, -v233, v233, v234
    v_max_f32 v234, 0, v234
    v_cvt_pk_bf16_f32 v237, v233, v234
    v_lshlrev_b32 v233, 16, v237
    v_and_b32 v234, 0xffff0000, v237
    v_add_f32 v234, 0x3727c5ac, v234
    v_cvt_pk_bf16_f32 v234, v234, v234
    v_lshlrev_b32 v234, 16, v234
    v_sqrt_f32 v234, v234
    v_fma_f32 v235, -v233, v236, v235
    v_cvt_pk_bf16_f32 v234, v234, v234
    v_lshlrev_b32 v234, 16, v234
    v_rcp_f32 v246, v234
    s_mov_b32 exec_lo, 1
    s_mov_b32 exec_hi, 1
    v_mul_f32 v235, v235, v246
    v_xor_b32 v244, 0x80000000, v233
    v_cvt_pk_bf16_f32 v235, v235, v235
    buffer_store_dwordx4 v[244:247], v232, s[28:31], s70 offen sc1
    v_ashrrev_i32 v237, 31, v235
    v_or_b32 v237, 0x80000000, v237
    v_xor_b32 v235, v235, v237
    v_bfi_b32 v248, s55, v235, v239
    buffer_store_dwordx2 v[248:249], v243, s[28:31], s71 offen sc1
    s_mov_b64 exec, -1
    s_setprio 0
    v_mov_b32 v252, s52
    v_mov_b32 v253, s52
    v_mov_b32 v254, s52
    v_mov_b32 v255, s52
    s_mov_b32 s63, 0
    s_mov_b32 s64, 77824
    s_mov_b32 s67, 38912
    s_waitcnt lgkmcnt(0)
    s_barrier
    ds_read_b64_tr_b16 v[132:133], v44 offset:0
    ds_read_b64_tr_b16 v[134:135], v44 offset:512
    ds_read_b128 v[156:159], v42 offset:0
    ds_read_b64_tr_b16 v[136:137], v44 offset:8192
    ds_read_b64_tr_b16 v[138:139], v44 offset:8704
    ds_read_b128 v[160:163], v42 offset:2048
    ds_read_b64_tr_b16 v[140:141], v44 offset:16384
    ds_read_b64_tr_b16 v[142:143], v44 offset:16896
    ds_read_b128 v[164:167], v42 offset:4096
    ds_read_b128 v[168:171], v42 offset:6144
    ds_read_b128 v[172:175], v42 offset:8192
    ds_read_b128 v[176:179], v42 offset:10240
    ds_read_b128 v[180:183], v42 offset:12288
C_LOOP:
    s_waitcnt lgkmcnt(10)
    v_mfma_f32_16x16x32_bf16 v[48:51], v[132:135], v[156:159], v[48:51]
    ds_read_b64_tr_b16 v[144:145], v44 offset:4096
    s_waitcnt lgkmcnt(9)
    v_mfma_f32_16x16x32_bf16 v[76:79], v[136:139], v[156:159], v[76:79]
    ds_read_b64_tr_b16 v[146:147], v44 offset:4608
    s_waitcnt lgkmcnt(9)
    v_mfma_f32_16x16x32_bf16 v[52:55], v[132:135], v[160:163], v[52:55]
    ds_read_b128 v[184:187], v43 offset:0
    v_mfma_f32_16x16x32_bf16 v[80:83], v[136:139], v[160:163], v[80:83]
    ds_read_b64_tr_b16 v[148:149], v44 offset:12288
    s_waitcnt lgkmcnt(9)
    v_mfma_f32_16x16x32_bf16 v[104:107], v[140:143], v[156:159], v[104:107]
    ds_read_b64_tr_b16 v[150:151], v44 offset:12800
    v_mfma_f32_16x16x32_bf16 v[108:111], v[140:143], v[160:163], v[108:111]
    ds_read_b128 v[188:191], v43 offset:2048
    s_waitcnt lgkmcnt(10)
    v_mfma_f32_16x16x32_bf16 v[56:59], v[132:135], v[164:167], v[56:59]
    ds_read_b64_tr_b16 v[152:153], v44 offset:20480
    v_mfma_f32_16x16x32_bf16 v[84:87], v[136:139], v[164:167], v[84:87]
    ds_read_b64_tr_b16 v[154:155], v44 offset:20992
    v_mfma_f32_16x16x32_bf16 v[112:115], v[140:143], v[164:167], v[112:115]
    ds_read_b128 v[192:195], v43 offset:4096
    s_waitcnt lgkmcnt(12)
    v_mfma_f32_16x16x32_bf16 v[60:63], v[132:135], v[168:171], v[60:63]
    ds_read_b128 v[196:199], v43 offset:6144
    v_mfma_f32_16x16x32_bf16 v[88:91], v[136:139], v[168:171], v[88:91]
    ds_read_b128 v[200:203], v43 offset:8192
    v_mfma_f32_16x16x32_bf16 v[116:119], v[140:143], v[168:171], v[116:119]
    ds_read_b128 v[204:207], v43 offset:10240
    s_waitcnt lgkmcnt(14)
    v_mfma_f32_16x16x32_bf16 v[64:67], v[132:135], v[172:175], v[64:67]
    ds_read_b128 v[208:211], v43 offset:12288
    v_mfma_f32_16x16x32_bf16 v[92:95], v[136:139], v[172:175], v[92:95]
    v_mfma_f32_16x16x32_bf16 v[120:123], v[140:143], v[172:175], v[120:123]
    s_cmp_eq_u32 s64, 77824
    s_cselect_b32 s66, 4294889472, s67
    s_waitcnt lgkmcnt(14)
    v_mfma_f32_16x16x32_bf16 v[68:71], v[132:135], v[176:179], v[68:71]
    s_add_u32 s64, s64, s66
    s_add_u32 s63, s63, 1
    v_mfma_f32_16x16x32_bf16 v[96:99], v[136:139], v[176:179], v[96:99]
    v_add_u32 v44, s66, v44
    v_mfma_f32_16x16x32_bf16 v[124:127], v[140:143], v[176:179], v[124:127]
    v_add_u32 v42, s66, v42
    s_waitcnt lgkmcnt(13)
    v_mfma_f32_16x16x32_bf16 v[72:75], v[132:135], v[180:183], v[72:75]
    v_add_u32 v43, s66, v43
    v_mfma_f32_16x16x32_bf16 v[100:103], v[136:139], v[180:183], v[100:103]
    s_cmp_lt_u32 s63, 9
    v_mfma_f32_16x16x32_bf16 v[128:131], v[140:143], v[180:183], v[128:131]
    s_waitcnt lgkmcnt(0)
    v_mfma_f32_16x16x32_bf16 v[48:51], v[144:147], v[184:187], v[48:51]
    v_mfma_f32_16x16x32_bf16 v[76:79], v[148:151], v[184:187], v[76:79]
    v_mfma_f32_16x16x32_bf16 v[104:107], v[152:155], v[184:187], v[104:107]
    v_mfma_f32_16x16x32_bf16 v[52:55], v[144:147], v[188:191], v[52:55]
    v_mfma_f32_16x16x32_bf16 v[80:83], v[148:151], v[188:191], v[80:83]
    v_mfma_f32_16x16x32_bf16 v[108:111], v[152:155], v[188:191], v[108:111]
    s_barrier
    ds_read_b64_tr_b16 v[132:133], v44 offset:0
    v_mfma_f32_16x16x32_bf16 v[56:59], v[144:147], v[192:195], v[56:59]
    ds_read_b64_tr_b16 v[134:135], v44 offset:512
    v_mfma_f32_16x16x32_bf16 v[84:87], v[148:151], v[192:195], v[84:87]
    ds_read_b128 v[156:159], v42 offset:0
    v_mfma_f32_16x16x32_bf16 v[112:115], v[152:155], v[192:195], v[112:115]
    ds_read_b64_tr_b16 v[136:137], v44 offset:8192
    v_mfma_f32_16x16x32_bf16 v[60:63], v[144:147], v[196:199], v[60:63]
    ds_read_b64_tr_b16 v[138:139], v44 offset:8704
    v_mfma_f32_16x16x32_bf16 v[88:91], v[148:151], v[196:199], v[88:91]
    ds_read_b128 v[160:163], v42 offset:2048
    v_mfma_f32_16x16x32_bf16 v[116:119], v[152:155], v[196:199], v[116:119]
    ds_read_b64_tr_b16 v[140:141], v44 offset:16384
    v_mfma_f32_16x16x32_bf16 v[64:67], v[144:147], v[200:203], v[64:67]
    ds_read_b64_tr_b16 v[142:143], v44 offset:16896
    v_mfma_f32_16x16x32_bf16 v[92:95], v[148:151], v[200:203], v[92:95]
    ds_read_b128 v[164:167], v42 offset:4096
    v_mfma_f32_16x16x32_bf16 v[120:123], v[152:155], v[200:203], v[120:123]
    ds_read_b128 v[168:171], v42 offset:6144
    v_mfma_f32_16x16x32_bf16 v[68:71], v[144:147], v[204:207], v[68:71]
    ds_read_b128 v[172:175], v42 offset:8192
    v_mfma_f32_16x16x32_bf16 v[96:99], v[148:151], v[204:207], v[96:99]
    ds_read_b128 v[176:179], v42 offset:10240
    v_mfma_f32_16x16x32_bf16 v[124:127], v[152:155], v[204:207], v[124:127]
    ds_read_b128 v[180:183], v42 offset:12288
    v_mfma_f32_16x16x32_bf16 v[72:75], v[144:147], v[208:211], v[72:75]
    v_mfma_f32_16x16x32_bf16 v[100:103], v[148:151], v[208:211], v[100:103]
    v_mfma_f32_16x16x32_bf16 v[128:131], v[152:155], v[208:211], v[128:131]
    s_cbranch_scc1 C_LOOP
    s_setprio 2
    s_waitcnt lgkmcnt(10)
    v_mfma_f32_16x16x32_bf16 v[48:51], v[132:135], v[156:159], v[48:51]
    ds_read_b64_tr_b16 v[144:145], v44 offset:4096
    s_waitcnt lgkmcnt(9)
    v_mfma_f32_16x16x32_bf16 v[76:79], v[136:139], v[156:159], v[76:79]
    ds_read_b64_tr_b16 v[146:147], v44 offset:4608
    s_waitcnt lgkmcnt(9)
    v_mfma_f32_16x16x32_bf16 v[52:55], v[132:135], v[160:163], v[52:55]
    ds_read_b64_tr_b16 v[148:149], v44 offset:12288
    v_mfma_f32_16x16x32_bf16 v[80:83], v[136:139], v[160:163], v[80:83]
    ds_read_b64_tr_b16 v[150:151], v44 offset:12800
    ds_read_b64_tr_b16 v[152:153], v44 offset:20480
    s_waitcnt lgkmcnt(10)
    v_mfma_f32_16x16x32_bf16 v[104:107], v[140:143], v[156:159], v[104:107]
    ds_read_b64_tr_b16 v[154:155], v44 offset:20992
    ds_read_b128 v[184:187], v43 offset:0
    v_mfma_f32_16x16x32_bf16 v[108:111], v[140:143], v[160:163], v[108:111]
    ds_read_b128 v[188:191], v43 offset:2048
    ds_read_b128 v[192:195], v43 offset:4096
    s_waitcnt lgkmcnt(13)
    v_mfma_f32_16x16x32_bf16 v[56:59], v[132:135], v[164:167], v[56:59]
    ds_read_b96 v[212:214], v45 offset:0
    ds_read_b96 v[216:218], v45 offset:256
    v_mfma_f32_16x16x32_bf16 v[84:87], v[136:139], v[164:167], v[84:87]
    ds_read_b96 v[220:222], v45 offset:512
    ds_read_b128 v[196:199], v43 offset:6144
    v_mfma_f32_16x16x32_bf16 v[112:115], v[140:143], v[164:167], v[112:115]
    ds_read_b128 v[200:203], v43 offset:8192
    ds_read_b128 v[204:207], v43 offset:10240
    s_waitcnt lgkmcnt(15)
    v_mfma_f32_16x16x32_bf16 v[60:63], v[132:135], v[168:171], v[60:63]
    ds_read_b128 v[208:211], v43 offset:12288
    ds_read_b96 v[224:226], v45 offset:768
    v_mfma_f32_16x16x32_bf16 v[88:91], v[136:139], v[168:171], v[88:91]
    ds_read_b96 v[228:230], v45 offset:1024
    ds_read_b96 v[232:234], v45 offset:1280
    v_mfma_f32_16x16x32_bf16 v[116:119], v[140:143], v[168:171], v[116:119]
    ds_read_b96 v[236:238], v45 offset:1536
    s_waitcnt lgkmcnt(13)
    v_mfma_f32_16x16x32_bf16 v[48:51], v[144:147], v[184:187], v[48:51]
    v_mfma_f32_16x16x32_bf16 v[76:79], v[148:151], v[184:187], v[76:79]
    v_mfma_f32_16x16x32_bf16 v[104:107], v[152:155], v[184:187], v[104:107]
    s_waitcnt lgkmcnt(0)
    v_mfma_f32_16x16x32_bf16 v[52:55], v[144:147], v[188:191], v[52:55]
    v_mfma_f32_16x16x32_bf16 v[80:83], v[148:151], v[188:191], v[80:83]
    s_nop 2
    v_mov_b32_dpp v240, v48 row_newbcast:0 row_mask:0xf bank_mask:0xf
    v_mov_b32_dpp v241, v49 row_newbcast:0 row_mask:0xf bank_mask:0xf
    v_mov_b32_dpp v242, v50 row_newbcast:0 row_mask:0xf bank_mask:0xf
    v_mfma_f32_16x16x32_bf16 v[108:111], v[152:155], v[188:191], v[108:111]
    v_mov_b32_dpp v243, v51 row_newbcast:0 row_mask:0xf bank_mask:0xf
    v_mov_b32_dpp v244, v76 row_newbcast:0 row_mask:0xf bank_mask:0xf
    v_mov_b32_dpp v245, v77 row_newbcast:0 row_mask:0xf bank_mask:0xf
    v_mfma_f32_16x16x32_bf16 v[56:59], v[144:147], v[192:195], v[56:59]
    v_mov_b32_dpp v246, v78 row_newbcast:0 row_mask:0xf bank_mask:0xf
    v_mov_b32_dpp v247, v79 row_newbcast:0 row_mask:0xf bank_mask:0xf
    v_mov_b32_dpp v248, v104 row_newbcast:0 row_mask:0xf bank_mask:0xf
    v_mfma_f32_16x16x32_bf16 v[84:87], v[148:151], v[192:195], v[84:87]
    v_mov_b32_dpp v249, v105 row_newbcast:0 row_mask:0xf bank_mask:0xf
    v_mov_b32_dpp v250, v106 row_newbcast:0 row_mask:0xf bank_mask:0xf
    v_mov_b32_dpp v251, v107 row_newbcast:0 row_mask:0xf bank_mask:0xf
    v_mfma_f32_16x16x32_bf16 v[112:115], v[152:155], v[192:195], v[112:115]
    v_fmac_f32 v48, v212, v240
    v_fmac_f32 v49, v212, v241
    v_fmac_f32 v50, v212, v242
    v_mfma_f32_16x16x32_bf16 v[60:63], v[144:147], v[196:199], v[60:63]
    v_fmac_f32 v51, v212, v243
    v_cvt_pk_bf16_f32 v48, v48, v49
    v_cvt_pk_bf16_f32 v49, v50, v51
    v_mfma_f32_16x16x32_bf16 v[88:91], v[148:151], v[196:199], v[88:91]
    v_fmac_f32 v76, v212, v244
    v_fmac_f32 v77, v212, v245
    v_fmac_f32 v78, v212, v246
    v_mfma_f32_16x16x32_bf16 v[116:119], v[152:155], v[196:199], v[116:119]
    v_fmac_f32 v79, v212, v247
    v_mul_f32 v76, v76, v214
    v_mul_f32 v77, v77, v214
    v_mfma_f32_16x16x32_bf16 v[64:67], v[132:135], v[172:175], v[64:67]
    v_mul_f32 v78, v78, v214
    v_mul_f32 v79, v79, v214
    v_cvt_pk_bf16_f32 v76, v76, v77
    v_mfma_f32_16x16x32_bf16 v[92:95], v[136:139], v[172:175], v[92:95]
    v_cvt_pk_bf16_f32 v77, v78, v79
    v_fmac_f32 v104, v212, v248
    v_fmac_f32 v105, v212, v249
    v_mfma_f32_16x16x32_bf16 v[120:123], v[140:143], v[172:175], v[120:123]
    v_fmac_f32 v106, v212, v250
    v_fmac_f32 v107, v212, v251
    v_mul_f32 v104, v104, v214
    v_mfma_f32_16x16x32_bf16 v[64:67], v[144:147], v[200:203], v[64:67]
    v_mul_f32 v105, v105, v214
    v_mul_f32 v106, v106, v214
    v_mul_f32 v107, v107, v214
    v_mfma_f32_16x16x32_bf16 v[92:95], v[148:151], v[200:203], v[92:95]
    v_cvt_pk_bf16_f32 v104, v104, v105
    v_cvt_pk_bf16_f32 v105, v106, v107
    v_fmac_f32 v52, v216, v240
    v_mfma_f32_16x16x32_bf16 v[120:123], v[152:155], v[200:203], v[120:123]
    v_fmac_f32 v53, v216, v241
    v_fmac_f32 v54, v216, v242
    v_fmac_f32 v55, v216, v243
    v_mfma_f32_16x16x32_bf16 v[68:71], v[132:135], v[176:179], v[68:71]
    s_mov_b64 exec, 0xff
    buffer_store_dwordx4 v[252:255], v6, s[28:31], s98 offen sc1
    s_mov_b64 exec, -1
    v_cvt_pk_bf16_f32 v52, v52, v53
    v_cvt_pk_bf16_f32 v53, v54, v55
    v_fmac_f32 v80, v216, v244
    v_mfma_f32_16x16x32_bf16 v[96:99], v[136:139], v[176:179], v[96:99]
    v_fmac_f32 v81, v216, v245
    v_fmac_f32 v82, v216, v246
    v_fmac_f32 v83, v216, v247
    v_mfma_f32_16x16x32_bf16 v[124:127], v[140:143], v[176:179], v[124:127]
    v_mul_f32 v80, v80, v218
    v_mul_f32 v81, v81, v218
    v_mul_f32 v82, v82, v218
    v_mfma_f32_16x16x32_bf16 v[68:71], v[144:147], v[204:207], v[68:71]
    v_mul_f32 v83, v83, v218
    v_cvt_pk_bf16_f32 v80, v80, v81
    v_cvt_pk_bf16_f32 v81, v82, v83
    v_mfma_f32_16x16x32_bf16 v[96:99], v[148:151], v[204:207], v[96:99]
    v_fmac_f32 v108, v216, v248
    v_fmac_f32 v109, v216, v249
    v_fmac_f32 v110, v216, v250
    v_mfma_f32_16x16x32_bf16 v[124:127], v[152:155], v[204:207], v[124:127]
    v_fmac_f32 v111, v216, v251
    v_mul_f32 v108, v108, v218
    v_mul_f32 v109, v109, v218
    v_mfma_f32_16x16x32_bf16 v[72:75], v[132:135], v[180:183], v[72:75]
    v_mul_f32 v110, v110, v218
    v_mul_f32 v111, v111, v218
    v_cvt_pk_bf16_f32 v108, v108, v109
    v_mfma_f32_16x16x32_bf16 v[100:103], v[136:139], v[180:183], v[100:103]
    v_cvt_pk_bf16_f32 v109, v110, v111
    v_mfma_f32_16x16x32_bf16 v[128:131], v[140:143], v[180:183], v[128:131]
    ds_write_b64 v46, v[48:49] offset:0
    v_mfma_f32_16x16x32_bf16 v[72:75], v[144:147], v[208:211], v[72:75]
    ds_write_b64 v46, v[76:77] offset:136
    v_mfma_f32_16x16x32_bf16 v[100:103], v[148:151], v[208:211], v[100:103]
    ds_write_b64 v46, v[104:105] offset:264
    v_mfma_f32_16x16x32_bf16 v[128:131], v[152:155], v[208:211], v[128:131]
    ds_write_b64 v46, v[52:53] offset:6272
    ds_write_b64 v46, v[80:81] offset:6408
    ds_write_b64 v46, v[108:109] offset:6536
    v_pk_fma_f32 v[84:85], v[220:221], v[244:245], v[84:85] op_sel_hi:[0,1,1]
    v_pk_fma_f32 v[86:87], v[220:221], v[246:247], v[86:87] op_sel_hi:[0,1,1]
    v_pk_fma_f32 v[112:113], v[220:221], v[248:249], v[112:113] op_sel_hi:[0,1,1]
    v_pk_fma_f32 v[114:115], v[220:221], v[250:251], v[114:115] op_sel_hi:[0,1,1]
    v_pk_fma_f32 v[56:57], v[220:221], v[240:241], v[56:57] op_sel_hi:[0,1,1]
    v_pk_fma_f32 v[58:59], v[220:221], v[242:243], v[58:59] op_sel_hi:[0,1,1]
    v_pk_mul_f32 v[84:85], v[84:85], v[222:223] op_sel_hi:[1,0]
    v_pk_mul_f32 v[86:87], v[86:87], v[222:223] op_sel_hi:[1,0]
    v_pk_mul_f32 v[112:113], v[112:113], v[222:223] op_sel_hi:[1,0]
    v_pk_mul_f32 v[114:115], v[114:115], v[222:223] op_sel_hi:[1,0]
    v_cvt_pk_bf16_f32 v56, v56, v57
    v_cvt_pk_bf16_f32 v57, v58, v59
    v_cvt_pk_bf16_f32 v84, v84, v85
    v_cvt_pk_bf16_f32 v85, v86, v87
    ds_write_b64 v46, v[56:57] offset:12544
    v_cvt_pk_bf16_f32 v112, v112, v113
    v_cvt_pk_bf16_f32 v113, v114, v115
    ds_write_b64 v46, v[84:85] offset:12680
    ds_write_b64 v46, v[112:113] offset:12808
    v_pk_fma_f32 v[88:89], v[224:225], v[244:245], v[88:89] op_sel_hi:[0,1,1]
    v_pk_fma_f32 v[90:91], v[224:225], v[246:247], v[90:91] op_sel_hi:[0,1,1]
    v_pk_fma_f32 v[116:117], v[224:225], v[248:249], v[116:117] op_sel_hi:[0,1,1]
    v_pk_fma_f32 v[118:119], v[224:225], v[250:251], v[118:119] op_sel_hi:[0,1,1]
    v_pk_fma_f32 v[60:61], v[224:225], v[240:241], v[60:61] op_sel_hi:[0,1,1]
    v_pk_fma_f32 v[62:63], v[224:225], v[242:243], v[62:63] op_sel_hi:[0,1,1]
    v_pk_mul_f32 v[88:89], v[88:89], v[226:227] op_sel_hi:[1,0]
    v_pk_mul_f32 v[90:91], v[90:91], v[226:227] op_sel_hi:[1,0]
    v_pk_mul_f32 v[116:117], v[116:117], v[226:227] op_sel_hi:[1,0]
    v_pk_mul_f32 v[118:119], v[118:119], v[226:227] op_sel_hi:[1,0]
    v_cvt_pk_bf16_f32 v60, v60, v61
    v_cvt_pk_bf16_f32 v61, v62, v63
    v_cvt_pk_bf16_f32 v88, v88, v89
    v_cvt_pk_bf16_f32 v89, v90, v91
    ds_write_b64 v46, v[60:61] offset:18816
    v_cvt_pk_bf16_f32 v116, v116, v117
    v_cvt_pk_bf16_f32 v117, v118, v119
    ds_write_b64 v46, v[88:89] offset:18952
    ds_write_b64 v46, v[116:117] offset:19080
    s_waitcnt lgkmcnt(0)
    s_barrier
    v_pk_fma_f32 v[92:93], v[228:229], v[244:245], v[92:93] op_sel_hi:[0,1,1]
    v_pk_fma_f32 v[94:95], v[228:229], v[246:247], v[94:95] op_sel_hi:[0,1,1]
    v_pk_fma_f32 v[120:121], v[228:229], v[248:249], v[120:121] op_sel_hi:[0,1,1]
    v_pk_fma_f32 v[122:123], v[228:229], v[250:251], v[122:123] op_sel_hi:[0,1,1]
    v_pk_fma_f32 v[64:65], v[228:229], v[240:241], v[64:65] op_sel_hi:[0,1,1]
    v_pk_fma_f32 v[66:67], v[228:229], v[242:243], v[66:67] op_sel_hi:[0,1,1]
    v_pk_mul_f32 v[92:93], v[92:93], v[230:231] op_sel_hi:[1,0]
    v_pk_mul_f32 v[94:95], v[94:95], v[230:231] op_sel_hi:[1,0]
    v_pk_mul_f32 v[120:121], v[120:121], v[230:231] op_sel_hi:[1,0]
    v_pk_mul_f32 v[122:123], v[122:123], v[230:231] op_sel_hi:[1,0]
    v_cvt_pk_bf16_f32 v64, v64, v65
    v_cvt_pk_bf16_f32 v65, v66, v67
    v_cvt_pk_bf16_f32 v92, v92, v93
    v_cvt_pk_bf16_f32 v93, v94, v95
    ds_write_b64 v46, v[64:65] offset:25088
    v_cvt_pk_bf16_f32 v120, v120, v121
    v_cvt_pk_bf16_f32 v121, v122, v123
    ds_write_b64 v46, v[92:93] offset:25224
    ds_write_b64 v46, v[120:121] offset:25352
    v_pk_fma_f32 v[96:97], v[232:233], v[244:245], v[96:97] op_sel_hi:[0,1,1]
    v_pk_fma_f32 v[98:99], v[232:233], v[246:247], v[98:99] op_sel_hi:[0,1,1]
    v_pk_fma_f32 v[124:125], v[232:233], v[248:249], v[124:125] op_sel_hi:[0,1,1]
    v_pk_fma_f32 v[126:127], v[232:233], v[250:251], v[126:127] op_sel_hi:[0,1,1]
    v_pk_fma_f32 v[68:69], v[232:233], v[240:241], v[68:69] op_sel_hi:[0,1,1]
    v_pk_fma_f32 v[70:71], v[232:233], v[242:243], v[70:71] op_sel_hi:[0,1,1]
    v_pk_mul_f32 v[96:97], v[96:97], v[234:235] op_sel_hi:[1,0]
    v_pk_mul_f32 v[98:99], v[98:99], v[234:235] op_sel_hi:[1,0]
    v_pk_mul_f32 v[124:125], v[124:125], v[234:235] op_sel_hi:[1,0]
    v_pk_mul_f32 v[126:127], v[126:127], v[234:235] op_sel_hi:[1,0]
    v_cvt_pk_bf16_f32 v68, v68, v69
    v_cvt_pk_bf16_f32 v69, v70, v71
    v_cvt_pk_bf16_f32 v96, v96, v97
    v_cvt_pk_bf16_f32 v97, v98, v99
    ds_write_b64 v46, v[68:69] offset:31360
    v_cvt_pk_bf16_f32 v124, v124, v125
    v_cvt_pk_bf16_f32 v125, v126, v127
    ds_write_b64 v46, v[96:97] offset:31496
    ds_write_b64 v46, v[124:125] offset:31624
    v_pk_fma_f32 v[100:101], v[236:237], v[244:245], v[100:101] op_sel_hi:[0,1,1]
    v_pk_fma_f32 v[102:103], v[236:237], v[246:247], v[102:103] op_sel_hi:[0,1,1]
    v_pk_fma_f32 v[128:129], v[236:237], v[248:249], v[128:129] op_sel_hi:[0,1,1]
    v_pk_fma_f32 v[130:131], v[236:237], v[250:251], v[130:131] op_sel_hi:[0,1,1]
    v_pk_fma_f32 v[72:73], v[236:237], v[240:241], v[72:73] op_sel_hi:[0,1,1]
    v_pk_fma_f32 v[74:75], v[236:237], v[242:243], v[74:75] op_sel_hi:[0,1,1]
    v_pk_mul_f32 v[100:101], v[100:101], v[238:239] op_sel_hi:[1,0]
    v_pk_mul_f32 v[102:103], v[102:103], v[238:239] op_sel_hi:[1,0]
    v_pk_mul_f32 v[128:129], v[128:129], v[238:239] op_sel_hi:[1,0]
    v_pk_mul_f32 v[130:131], v[130:131], v[238:239] op_sel_hi:[1,0]
    v_cvt_pk_bf16_f32 v72, v72, v73
    v_cvt_pk_bf16_f32 v73, v74, v75
    v_cvt_pk_bf16_f32 v100, v100, v101
    v_cvt_pk_bf16_f32 v101, v102, v103
    ds_write_b64 v46, v[72:73] offset:37632
    v_cvt_pk_bf16_f32 v128, v128, v129
    v_cvt_pk_bf16_f32 v129, v130, v131
    ds_write_b64 v46, v[100:101] offset:37768
    ds_write_b64 v46, v[128:129] offset:37896
    s_waitcnt lgkmcnt(0)
    s_barrier
    ds_read_b64 v[80:81], v20 offset:136
    ds_read_b64 v[82:83], v21 offset:136
    ds_read_b64 v[64:65], v20 offset:6272
    ds_read_b64 v[66:67], v21 offset:6272
    ds_read_b64 v[84:85], v20 offset:6408
    ds_read_b64 v[86:87], v21 offset:6408
    ds_read_b64 v[68:69], v20 offset:12544
    ds_read_b64 v[70:71], v21 offset:12544
    ds_read_b64 v[88:89], v20 offset:12680
    ds_read_b64 v[90:91], v21 offset:12680
    ds_read_b64 v[72:73], v20 offset:18816
    ds_read_b64 v[74:75], v21 offset:18816
    ds_read_b64 v[92:93], v20 offset:18952
    ds_read_b64 v[94:95], v21 offset:18952
    v_lshl_add_u32 v3, v5, 8, v26
    v_mov_b32 v0, v27
    s_waitcnt lgkmcnt(8)
    v_mfma_f32_16x16x32_bf16 v[120:123], v[84:87], v[64:67], v[32:35]
    v_mfma_f32_16x16x32_bf16 v[100:103], v[80:83], v[64:67], v[36:39]
    s_waitcnt lgkmcnt(4)
    v_mfma_f32_16x16x32_bf16 v[124:127], v[88:91], v[68:71], v[32:35]
    v_mfma_f32_16x16x32_bf16 v[104:107], v[84:87], v[68:71], v[36:39]
    s_waitcnt lgkmcnt(0)
    v_mfma_f32_16x16x32_bf16 v[128:131], v[92:95], v[72:75], v[32:35]
    v_mfma_f32_16x16x32_bf16 v[108:111], v[88:91], v[72:75], v[36:39]
    ds_read_b32 v27, v3
    ds_read2st64_b32 v[36:37], v26 offset1:1
    ds_read2st64_b32 v[38:39], v26 offset0:2 offset1:3
    ds_read_b64_tr_b16 v[168:169], v22 offset:264
    ds_read_b64_tr_b16 v[178:179], v23 offset:0
    ds_read_b64_tr_b16 v[170:171], v22 offset:6536
    ds_read_b64_tr_b16 v[180:181], v23 offset:6272
    ds_read_b64_tr_b16 v[172:173], v22 offset:12808
    ds_read_b64_tr_b16 v[182:183], v23 offset:12544
    ds_read_b64_tr_b16 v[174:175], v22 offset:19080
    ds_read_b64_tr_b16 v[184:185], v23 offset:18816
    v_max_f32 v120, v120, v100
    v_max_f32 v121, v121, v101
    v_max_f32 v122, v122, v102
    v_max_f32 v123, v123, v103
    v_max_f32 v124, v124, v104
    v_max_f32 v125, v125, v105
    v_max_f32 v126, v126, v106
    v_max_f32 v127, v127, v107
    v_max_f32 v128, v128, v108
    v_max_f32 v129, v129, v109
    v_max_f32 v130, v130, v110
    v_max_f32 v131, v131, v111
    s_cmp_lg_u32 s13, 1
    s_cbranch_scc1 AC_SM
    v_cvt_pk_bf16_f32 v64, v120, v121
    v_mov_b32 v65, s52
    v_cvt_pk_bf16_f32 v66, v122, v123
    v_mov_b32 v67, s52
    buffer_store_dwordx4 v[64:67], v6, s[28:31], s11 offen offset:0 sc1
    v_cvt_pk_bf16_f32 v68, v124, v125
    v_mov_b32 v69, s52
    v_cvt_pk_bf16_f32 v70, v126, v127
    v_mov_b32 v71, s52
    buffer_store_dwordx4 v[68:71], v6, s[28:31], s11 offen offset:1024 sc1
    v_cvt_pk_bf16_f32 v72, v128, v129
    v_mov_b32 v73, s52
    v_cvt_pk_bf16_f32 v74, v130, v131
    v_mov_b32 v75, s52
    buffer_store_dwordx4 v[72:75], v6, s[28:31], s11 offen offset:2048 sc1
    s_setprio 0
    s_branch AC_X
AC_SM:
    v_max3_f32 v136, v120, v121, v122
    v_max3_f32 v138, v124, v125, v126
    v_max3_f32 v140, v128, v129, v130
    v_max_f32 v136, v136, v123
    v_max_f32 v138, v138, v127
    v_max_f32 v140, v140, v131
    s_nop 1
    v_permlane32_swap_b32 v136, v140
    v_permlane32_swap_b32 v138, v142
    v_max_f32 v136, v136, v140
    v_max_f32 v138, v138, v142
    s_waitcnt lgkmcnt(8)
    v_mul_f32 v27, 0x3ea52b5c, v27
    v_permlane16_swap_b32 v136, v138
    v_max_f32 v136, v136, v138
    v_mul_f32 v138, v136, v27
    v_mul_f32 v136, v136, v27
    v_mul_f32 v32, 0x3ea52b5c, v36
    v_mul_f32 v34, 0x3ea52b5c, v37
    v_permlane16_swap_b32 v136, v138
    v_mov_b32 v140, v136
    v_mov_b32 v142, v138
    v_mul_f32 v36, 0x3ea52b5c, v38
    v_permlane32_swap_b32 v136, v140
    v_permlane32_swap_b32 v138, v142
    v_pk_fma_f32 v[120:121], v[120:121], v[32:33], v[136:137] op_sel_hi:[1,0,0] neg_lo:[0,0,1] neg_hi:[0,0,1]
    v_pk_fma_f32 v[122:123], v[122:123], v[32:33], v[136:137] op_sel_hi:[1,0,0] neg_lo:[0,0,1] neg_hi:[0,0,1]
    v_pk_fma_f32 v[124:125], v[124:125], v[34:35], v[138:139] op_sel_hi:[1,0,0] neg_lo:[0,0,1] neg_hi:[0,0,1]
    v_pk_fma_f32 v[126:127], v[126:127], v[34:35], v[138:139] op_sel_hi:[1,0,0] neg_lo:[0,0,1] neg_hi:[0,0,1]
    v_pk_fma_f32 v[128:129], v[128:129], v[36:37], v[140:141] op_sel_hi:[1,0,0] neg_lo:[0,0,1] neg_hi:[0,0,1]
    v_pk_fma_f32 v[130:131], v[130:131], v[36:37], v[140:141] op_sel_hi:[1,0,0] neg_lo:[0,0,1] neg_hi:[0,0,1]
    v_exp_f32 v120, v120
    v_exp_f32 v121, v121
    v_exp_f32 v122, v122
    v_exp_f32 v123, v123
    v_cvt_pk_bf16_f32 v2, v120, v121
    v_cvt_pk_bf16_f32 v3, v122, v123
    v_bfi_b32 v120, v40, 0, v2
    v_bfi_b32 v121, v41, 0, v3
    v_and_b32 v122, v40, v2
    v_and_b32 v123, v41, v3
    s_waitcnt lgkmcnt(0)
    v_exp_f32 v124, v124
    v_mfma_f32_16x16x32_bf16 v[188:191], v[28:31], v[120:123], 0
    v_exp_f32 v125, v125
    v_mfma_f32_16x16x32_bf16 v[136:139], v[168:171], v[120:123], 0
    v_exp_f32 v126, v126
    v_mfma_f32_16x16x32_bf16 v[152:155], v[178:181], v[120:123], 0
    v_exp_f32 v127, v127
    v_cvt_pk_bf16_f32 v2, v124, v125
    v_cvt_pk_bf16_f32 v3, v126, v127
    v_bfi_b32 v124, v40, 0, v2
    v_bfi_b32 v125, v41, 0, v3
    v_and_b32 v126, v40, v2
    v_and_b32 v127, v41, v3
    v_rcp_f32 v32, v188
    v_exp_f32 v128, v128
    v_mfma_f32_16x16x32_bf16 v[192:195], v[28:31], v[124:127], 0
    v_exp_f32 v129, v129
    v_mfma_f32_16x16x32_bf16 v[140:143], v[170:173], v[124:127], 0
    v_exp_f32 v130, v130
    v_mfma_f32_16x16x32_bf16 v[156:159], v[180:183], v[124:127], 0
    v_exp_f32 v131, v131
    v_cvt_pk_bf16_f32 v2, v128, v129
    v_cvt_pk_bf16_f32 v3, v130, v131
    v_bfi_b32 v128, v40, 0, v2
    v_bfi_b32 v129, v41, 0, v3
    v_and_b32 v130, v40, v2
    v_and_b32 v131, v41, v3
    v_rcp_f32 v34, v192
    v_mul_f32 v136, v136, v32
    v_mfma_f32_16x16x32_bf16 v[188:191], v[28:31], v[128:131], 0
    v_mul_f32 v137, v137, v32
    v_mfma_f32_16x16x32_bf16 v[144:147], v[172:175], v[128:131], 0
    v_mul_f32 v138, v138, v32
    v_mfma_f32_16x16x32_bf16 v[160:163], v[182:185], v[128:131], 0
    v_mul_f32 v139, v139, v32
    v_cvt_pk_bf16_f32 v136, v136, v137
    v_cvt_pk_bf16_f32 v137, v138, v139
    v_mul_f32 v140, v140, v34
    v_mul_f32 v141, v141, v34
    v_mul_f32 v142, v142, v34
    v_mul_f32 v143, v143, v34
    v_cvt_pk_bf16_f32 v138, v140, v141
    v_cvt_pk_bf16_f32 v139, v142, v143
    v_rcp_f32 v36, v188
    v_permlane32_swap_b32 v136, v138
    v_permlane32_swap_b32 v137, v139
    v_pk_mul_f32 v[144:145], v[144:145], v[36:37] op_sel_hi:[1,0]
    v_pk_mul_f32 v[146:147], v[146:147], v[36:37] op_sel_hi:[1,0]
    v_cvt_pk_bf16_f32 v144, v144, v145
    v_cvt_pk_bf16_f32 v145, v146, v147
    s_mov_b64 exec, s[14:15]
    buffer_store_dwordx4 v[136:139], v24, s[28:31], s9 offen sc1
    s_mov_b64 exec, -1
    v_permlane32_swap_b32 v144, v146
    v_permlane32_swap_b32 v145, v147
    v_pk_mul_f32 v[152:153], v[152:153], v[32:33] op_sel_hi:[1,0]
    v_pk_mul_f32 v[154:155], v[154:155], v[32:33] op_sel_hi:[1,0]
    s_mov_b64 exec, s[16:17]
    buffer_store_dwordx4 v[144:147], v24, s[28:31], s5 offen sc1
    s_lshl_b64 exec, -1, 16
    v_pk_mul_f32 v[152:153], v[156:157], v[34:35] op_sel_hi:[1,0]
    v_pk_mul_f32 v[154:155], v[158:159], v[34:35] op_sel_hi:[1,0]
    s_lshl_b64 exec, -1, 32
    v_pk_mul_f32 v[152:153], v[160:161], v[36:37] op_sel_hi:[1,0]
    v_pk_mul_f32 v[154:155], v[162:163], v[36:37] op_sel_hi:[1,0]
    s_mov_b64 exec, s[18:19]
    v_cvt_pk_bf16_f32 v152, v152, v153
    v_cvt_pk_bf16_f32 v153, v154, v155
    buffer_store_dwordx2 v[152:153], v25, s[28:31], s10 offen sc1
    s_mov_b64 exec, -1
A_DONE:
    s_cmp_lg_u32 s13, 0
    s_cbranch_scc1 P_TAIL
    s_setprio 1
    v_mov_b32 v2, 1
    ds_write_b8 v18, v2 offset:0
    s_cmp_eq_u32 s101, 0
    s_cbranch_scc1 K_END
    v_xor_b32 v28, 32, v8
    v_xor_b32 v29, 64, v8
    v_xor_b32 v30, 96, v8
    ds_read_b64 v[48:49], v8 offset:0
    ds_read_b64 v[50:51], v28 offset:0
    ds_read_b64 v[52:53], v29 offset:0
    ds_read_b64 v[54:55], v30 offset:0
    ds_read_b64 v[56:57], v8 offset:2048
    ds_read_b64 v[58:59], v28 offset:2048
    ds_read_b64 v[60:61], v29 offset:2048
    ds_read_b64 v[62:63], v30 offset:2048
    s_cmp_eq_u32 s101, 2
    s_cselect_b32 s60, 0, 2146435072
    s_add_u32 s60, s60, 20480
    v_add_u32 v31, s60, v6
    s_mov_b32 s100, 0
    v_xor_b32 v28, 32, v9
    v_xor_b32 v29, 64, v9
    v_xor_b32 v30, 96, v9
    ds_read_b64_tr_b16 v[160:161], v9 offset:0
    ds_read_b64_tr_b16 v[164:165], v28 offset:0
    ds_read_b64_tr_b16 v[168:169], v29 offset:0
    ds_read_b64_tr_b16 v[172:173], v30 offset:0
    ds_read_b64_tr_b16 v[162:163], v9 offset:1024
    ds_read_b64_tr_b16 v[166:167], v28 offset:1024
    ds_read_b64_tr_b16 v[170:171], v29 offset:1024
    ds_read_b64_tr_b16 v[174:175], v30 offset:1024
    s_waitcnt lgkmcnt(8)
    v_lshlrev_b32 v64, 16, v48
    ds_read_b64_tr_b16 v[176:177], v29 offset:7680
    v_and_b32 v65, 0xffff0000, v48
    ds_read_b64_tr_b16 v[180:181], v30 offset:7680
    v_lshlrev_b32 v66, 16, v49
    ds_read_b64_tr_b16 v[184:185], v9 offset:7680
    v_and_b32 v67, 0xffff0000, v49
    ds_read_b64_tr_b16 v[188:189], v28 offset:7680
    v_lshlrev_b32 v68, 16, v50
    ds_read_b64_tr_b16 v[178:179], v29 offset:8704
    v_and_b32 v69, 0xffff0000, v50
    ds_read_b64_tr_b16 v[182:183], v30 offset:8704
    v_lshlrev_b32 v70, 16, v51
    ds_read_b64_tr_b16 v[186:187], v9 offset:8704
    v_and_b32 v71, 0xffff0000, v51
    ds_read_b64_tr_b16 v[190:191], v28 offset:8704
    v_lshlrev_b32 v72, 16, v52
    ds_read_b64_tr_b16 v[192:193], v9 offset:15360
    v_and_b32 v73, 0xffff0000, v52
    ds_read_b64_tr_b16 v[196:197], v28 offset:15360
    v_lshlrev_b32 v74, 16, v53
    ds_read_b64_tr_b16 v[200:201], v29 offset:15360
    v_and_b32 v75, 0xffff0000, v53
    ds_read_b64_tr_b16 v[204:205], v30 offset:15360
    v_lshlrev_b32 v76, 16, v54
    ds_read_b64_tr_b16 v[194:195], v9 offset:16384
    v_and_b32 v77, 0xffff0000, v54
    ds_read_b64_tr_b16 v[198:199], v28 offset:16384
    v_lshlrev_b32 v78, 16, v55
    ds_read_b64_tr_b16 v[202:203], v29 offset:16384
    v_and_b32 v79, 0xffff0000, v55
    ds_read_b64_tr_b16 v[206:207], v30 offset:16384
    v_lshlrev_b32 v80, 16, v56
    ds_read_b64_tr_b16 v[208:209], v29 offset:23040
    v_and_b32 v81, 0xffff0000, v56
    ds_read_b64_tr_b16 v[212:213], v30 offset:23040
    v_lshlrev_b32 v82, 16, v57
    ds_read_b64_tr_b16 v[216:217], v9 offset:23040
    v_and_b32 v83, 0xffff0000, v57
    ds_read_b64_tr_b16 v[220:221], v28 offset:23040
    v_lshlrev_b32 v84, 16, v58
    ds_read_b64_tr_b16 v[210:211], v29 offset:24064
    v_and_b32 v85, 0xffff0000, v58
    ds_read_b64_tr_b16 v[214:215], v30 offset:24064
    v_lshlrev_b32 v86, 16, v59
    ds_read_b64_tr_b16 v[218:219], v9 offset:24064
    v_and_b32 v87, 0xffff0000, v59
    ds_read_b64_tr_b16 v[222:223], v28 offset:24064
    v_lshlrev_b32 v88, 16, v60
    ds_read_b64_tr_b16 v[224:225], v9 offset:30720
    v_and_b32 v89, 0xffff0000, v60
    ds_read_b64_tr_b16 v[228:229], v28 offset:30720
    v_lshlrev_b32 v90, 16, v61
    ds_read_b64_tr_b16 v[232:233], v29 offset:30720
    v_and_b32 v91, 0xffff0000, v61
    ds_read_b64_tr_b16 v[236:237], v30 offset:30720
    v_lshlrev_b32 v92, 16, v62
    ds_read_b64_tr_b16 v[226:227], v9 offset:31744
    v_and_b32 v93, 0xffff0000, v62
    ds_read_b64_tr_b16 v[230:231], v28 offset:31744
    s_sleep 8
    buffer_load_dwordx4 v[96:99], v0, s[28:31], s96 offen offset:0 sc1
    buffer_load_dwordx4 v[100:103], v31, s[28:31], s96 offen offset:0 sc1
    buffer_load_dwordx4 v[104:107], v0, s[28:31], s96 offen offset:1024 sc1
    buffer_load_dwordx4 v[108:111], v31, s[28:31], s96 offen offset:1024 sc1
    buffer_load_dwordx4 v[112:115], v0, s[28:31], s96 offen offset:2048 sc1
    buffer_load_dwordx4 v[116:119], v31, s[28:31], s96 offen offset:2048 sc1
    buffer_load_dwordx4 v[120:123], v0, s[28:31], s96 offen offset:3072 sc1
    buffer_load_dwordx4 v[124:127], v31, s[28:31], s96 offen offset:3072 sc1
    buffer_load_dwordx4 v[128:131], v0, s[28:31], s92 offen offset:0 sc1
    buffer_load_dwordx4 v[132:135], v31, s[28:31], s92 offen offset:0 sc1
    v_lshlrev_b32 v94, 16, v63
    ds_read_b64_tr_b16 v[234:235], v29 offset:31744
    v_and_b32 v95, 0xffff0000, v63
    ds_read_b64_tr_b16 v[238:239], v30 offset:31744
    v_xor_b32 v28, 32, v10
    v_xor_b32 v29, 64, v10
    v_xor_b32 v30, 96, v10
    ds_read_b64_tr_b16 v[240:241], v10 offset:0
    ds_read_b64_tr_b16 v[244:245], v28 offset:0
    ds_read_b64_tr_b16 v[248:249], v29 offset:0
    ds_read_b64_tr_b16 v[252:253], v30 offset:0
    ds_read_b64_tr_b16 v[242:243], v10 offset:1024
    ds_read_b64_tr_b16 v[246:247], v28 offset:1024
    ds_read_b64_tr_b16 v[250:251], v29 offset:1024
    ds_read_b64_tr_b16 v[254:255], v30 offset:1024
    s_waitcnt vmcnt(8)
    v_max3_u32 v2, v96, v97, v98
    v_max3_u32 v3, v99, v100, v101
    v_max3_u32 v2, v2, v102, v103
    v_max_u32 v2, v2, v3
    v_cmp_eq_u32 vcc, -1, v2
    s_cbranch_vccnz G2_R0
G2_OK0:
    s_waitcnt lgkmcnt(15)
    v_mfma_f32_16x16x32_bf16 v[32:35], v[160:163], v[96:99], 0
    buffer_load_dwordx4 v[136:139], v0, s[28:31], s92 offen offset:1024 sc1
    v_mfma_f32_16x16x32_bf16 v[48:51], v[160:163], v[100:103], 0
    v_mfma_f32_16x16x32_bf16 v[36:39], v[164:167], v[96:99], 0
    buffer_load_dwordx4 v[140:143], v31, s[28:31], s92 offen offset:1024 sc1
    v_mfma_f32_16x16x32_bf16 v[52:55], v[164:167], v[100:103], 0
    v_mfma_f32_16x16x32_bf16 v[40:43], v[168:171], v[96:99], 0
    v_mfma_f32_16x16x32_bf16 v[56:59], v[168:171], v[100:103], 0
    s_waitcnt vmcnt(8)
    v_max3_u32 v2, v104, v105, v106
    v_max3_u32 v3, v107, v108, v109
    v_mfma_f32_16x16x32_bf16 v[44:47], v[172:175], v[96:99], 0
    v_max3_u32 v2, v2, v110, v111
    v_max_u32 v2, v2, v3
    v_cmp_eq_u32 vcc, -1, v2
    v_mfma_f32_16x16x32_bf16 v[60:63], v[172:175], v[100:103], 0
    s_cbranch_vccnz G2_R1
G2_OK1:
    s_waitcnt lgkmcnt(15)
    v_mfma_f32_16x16x32_bf16 v[32:35], v[176:179], v[104:107], v[32:35]
    buffer_load_dwordx4 v[144:147], v0, s[28:31], s92 offen offset:2048 sc1
    buffer_load_dwordx4 v[148:151], v31, s[28:31], s92 offen offset:2048 sc1
    v_xor_b32 v28, 32, v11
    v_mfma_f32_16x16x32_bf16 v[48:51], v[176:179], v[108:111], v[48:51]
    v_xor_b32 v29, 64, v11
    v_xor_b32 v30, 96, v11
    ds_read_b64_tr_b16 v[160:161], v11 offset:0
    v_mfma_f32_16x16x32_bf16 v[36:39], v[180:183], v[104:107], v[36:39]
    ds_read_b64_tr_b16 v[164:165], v28 offset:0
    ds_read_b64_tr_b16 v[168:169], v29 offset:0
    v_mfma_f32_16x16x32_bf16 v[52:55], v[180:183], v[108:111], v[52:55]
    ds_read_b64_tr_b16 v[172:173], v30 offset:0
    ds_read_b64_tr_b16 v[162:163], v11 offset:15360
    ds_read_b64_tr_b16 v[166:167], v28 offset:15360
    v_mfma_f32_16x16x32_bf16 v[40:43], v[184:187], v[104:107], v[40:43]
    ds_read_b64_tr_b16 v[170:171], v29 offset:15360
    ds_read_b64_tr_b16 v[174:175], v30 offset:15360
    v_mfma_f32_16x16x32_bf16 v[56:59], v[184:187], v[108:111], v[56:59]
    s_waitcnt vmcnt(8)
    v_max3_u32 v2, v112, v113, v114
    v_max3_u32 v3, v115, v116, v117
    v_mfma_f32_16x16x32_bf16 v[44:47], v[188:191], v[104:107], v[44:47]
    v_max3_u32 v2, v2, v118, v119
    v_max_u32 v2, v2, v3
    v_cmp_eq_u32 vcc, -1, v2
    v_mfma_f32_16x16x32_bf16 v[60:63], v[188:191], v[108:111], v[60:63]
    s_cbranch_vccnz G2_R2
G2_OK2:
    s_waitcnt lgkmcnt(15)
    v_mfma_f32_16x16x32_bf16 v[32:35], v[192:195], v[112:115], v[32:35]
    buffer_load_dwordx4 v[152:155], v0, s[28:31], s4 offen offset:0 sc1
    v_mfma_f32_16x16x32_bf16 v[48:51], v[192:195], v[116:119], v[48:51]
    v_mfma_f32_16x16x32_bf16 v[36:39], v[196:199], v[112:115], v[36:39]
    buffer_load_dwordx4 v[156:159], v31, s[28:31], s4 offen offset:0 sc1
    v_mfma_f32_16x16x32_bf16 v[52:55], v[196:199], v[116:119], v[52:55]
    v_mfma_f32_16x16x32_bf16 v[40:43], v[200:203], v[112:115], v[40:43]
    v_mfma_f32_16x16x32_bf16 v[56:59], v[200:203], v[116:119], v[56:59]
    s_waitcnt vmcnt(8)
    v_max3_u32 v2, v120, v121, v122
    v_max3_u32 v3, v123, v124, v125
    v_mfma_f32_16x16x32_bf16 v[44:47], v[204:207], v[112:115], v[44:47]
    v_max3_u32 v2, v2, v126, v127
    v_max_u32 v2, v2, v3
    v_cmp_eq_u32 vcc, -1, v2
    v_mfma_f32_16x16x32_bf16 v[60:63], v[204:207], v[116:119], v[60:63]
    s_cbranch_vccnz G2_R3
G2_OK3:
    s_waitcnt lgkmcnt(15)
    v_mfma_f32_16x16x32_bf16 v[32:35], v[208:211], v[120:123], v[32:35]
    ds_read_b64 v[24:25], v19 offset:16
    v_mfma_f32_16x16x32_bf16 v[48:51], v[208:211], v[124:127], v[48:51]
    buffer_load_dwordx4 v[96:99], v0, s[28:31], s4 offen offset:1024 sc1
    v_mfma_f32_16x16x32_bf16 v[36:39], v[212:215], v[120:123], v[36:39]
    v_mfma_f32_16x16x32_bf16 v[52:55], v[212:215], v[124:127], v[52:55]
    buffer_load_dwordx4 v[100:103], v31, s[28:31], s4 offen offset:1024 sc1
    v_mfma_f32_16x16x32_bf16 v[40:43], v[216:219], v[120:123], v[40:43]
    v_mfma_f32_16x16x32_bf16 v[56:59], v[216:219], v[124:127], v[56:59]
    s_waitcnt vmcnt(8)
    v_max3_u32 v2, v128, v129, v130
    v_max3_u32 v3, v131, v132, v133
    v_mfma_f32_16x16x32_bf16 v[44:47], v[220:223], v[120:123], v[44:47]
    v_max3_u32 v2, v2, v134, v135
    v_max_u32 v2, v2, v3
    v_cmp_eq_u32 vcc, -1, v2
    v_mfma_f32_16x16x32_bf16 v[60:63], v[220:223], v[124:127], v[60:63]
    s_cbranch_vccnz G2_R4
G2_OK4:
    s_waitcnt lgkmcnt(0)
    v_and_b32 v2, v24, v25
    v_cmp_ne_u32 vcc, 0x01010101, v2
    s_cbranch_vccnz G2_ZAR
G2_ZAOK:
    v_mfma_f32_16x16x32_bf16 v[32:35], v[224:227], v[128:131], v[32:35]
    buffer_load_dwordx4 v[104:107], v0, s[28:31], s4 offen offset:2048 sc1
    buffer_load_dwordx4 v[108:111], v31, s[28:31], s4 offen offset:2048 sc1
    v_add_u32 v9, 40960, v9
    v_mfma_f32_16x16x32_bf16 v[48:51], v[224:227], v[132:135], v[48:51]
    v_xor_b32 v28, 32, v9
    v_xor_b32 v29, 64, v9
    v_xor_b32 v30, 96, v9
    v_mfma_f32_16x16x32_bf16 v[36:39], v[228:231], v[128:131], v[36:39]
    ds_read_b64_tr_b16 v[176:177], v9 offset:0
    ds_read_b64_tr_b16 v[180:181], v28 offset:0
    ds_read_b64_tr_b16 v[184:185], v29 offset:0
    v_mfma_f32_16x16x32_bf16 v[52:55], v[228:231], v[132:135], v[52:55]
    ds_read_b64_tr_b16 v[188:189], v30 offset:0
    ds_read_b64_tr_b16 v[178:179], v9 offset:1024
    ds_read_b64_tr_b16 v[182:183], v28 offset:1024
    v_mfma_f32_16x16x32_bf16 v[40:43], v[232:235], v[128:131], v[40:43]
    ds_read_b64_tr_b16 v[186:187], v29 offset:1024
    ds_read_b64_tr_b16 v[190:191], v30 offset:1024
    v_mfma_f32_16x16x32_bf16 v[56:59], v[232:235], v[132:135], v[56:59]
    s_waitcnt vmcnt(8)
    v_max3_u32 v2, v136, v137, v138
    v_max3_u32 v3, v139, v140, v141
    v_mfma_f32_16x16x32_bf16 v[44:47], v[236:239], v[128:131], v[44:47]
    v_max3_u32 v2, v2, v142, v143
    v_max_u32 v2, v2, v3
    v_cmp_eq_u32 vcc, -1, v2
    v_mfma_f32_16x16x32_bf16 v[60:63], v[236:239], v[132:135], v[60:63]
    s_cbranch_vccnz G2_R5
G2_OK5:
    v_mfma_f32_16x16x32_bf16 v[32:35], v[240:243], v[136:139], v[32:35]
    buffer_load_dwordx4 v[112:115], v0, s[28:31], s4 offen offset:3072 sc1
    buffer_load_dwordx4 v[116:119], v31, s[28:31], s4 offen offset:3072 sc1
    v_mfma_f32_16x16x32_bf16 v[48:51], v[240:243], v[140:143], v[48:51]
    ds_read_b64_tr_b16 v[192:193], v29 offset:7680
    ds_read_b64_tr_b16 v[196:197], v30 offset:7680
    v_mfma_f32_16x16x32_bf16 v[36:39], v[244:247], v[136:139], v[36:39]
    ds_read_b64_tr_b16 v[200:201], v9 offset:7680
    ds_read_b64_tr_b16 v[204:205], v28 offset:7680
    v_mfma_f32_16x16x32_bf16 v[52:55], v[244:247], v[140:143], v[52:55]
    ds_read_b64_tr_b16 v[194:195], v29 offset:8704
    ds_read_b64_tr_b16 v[198:199], v30 offset:8704
    v_mfma_f32_16x16x32_bf16 v[40:43], v[248:251], v[136:139], v[40:43]
    ds_read_b64_tr_b16 v[202:203], v9 offset:8704
    ds_read_b64_tr_b16 v[206:207], v28 offset:8704
    v_mfma_f32_16x16x32_bf16 v[56:59], v[248:251], v[140:143], v[56:59]
    s_waitcnt vmcnt(8)
    v_max3_u32 v2, v144, v145, v146
    v_max3_u32 v3, v147, v148, v149
    v_mfma_f32_16x16x32_bf16 v[44:47], v[252:255], v[136:139], v[44:47]
    v_max3_u32 v2, v2, v150, v151
    v_max_u32 v2, v2, v3
    v_cmp_eq_u32 vcc, -1, v2
    v_mfma_f32_16x16x32_bf16 v[60:63], v[252:255], v[140:143], v[60:63]
    s_cbranch_vccnz G2_R6
G2_OK6:
    v_mfma_f32_16x16x32_bf16 v[32:35], v[160:163], v[144:147], v[32:35]
    ds_read_b64 v[24:25], v19 offset:0
    buffer_load_dwordx4 v[120:123], v0, s[28:31], s6 offen offset:0 sc1
    buffer_load_dwordx4 v[124:127], v31, s[28:31], s6 offen offset:0 sc1
    v_mfma_f32_16x16x32_bf16 v[48:51], v[160:163], v[148:151], v[48:51]
    ds_read_b64_tr_b16 v[208:209], v9 offset:15360
    ds_read_b64_tr_b16 v[212:213], v28 offset:15360
    v_mfma_f32_16x16x32_bf16 v[36:39], v[164:167], v[144:147], v[36:39]
    ds_read_b64_tr_b16 v[216:217], v29 offset:15360
    ds_read_b64_tr_b16 v[220:221], v30 offset:15360
    v_mfma_f32_16x16x32_bf16 v[52:55], v[164:167], v[148:151], v[52:55]
    ds_read_b64_tr_b16 v[210:211], v9 offset:16384
    ds_read_b64_tr_b16 v[214:215], v28 offset:16384
    v_mfma_f32_16x16x32_bf16 v[40:43], v[168:171], v[144:147], v[40:43]
    ds_read_b64_tr_b16 v[218:219], v29 offset:16384
    ds_read_b64_tr_b16 v[222:223], v30 offset:16384
    v_mfma_f32_16x16x32_bf16 v[56:59], v[168:171], v[148:151], v[56:59]
    s_waitcnt vmcnt(8)
    v_max3_u32 v2, v152, v153, v154
    v_max3_u32 v3, v155, v156, v157
    v_mfma_f32_16x16x32_bf16 v[44:47], v[172:175], v[144:147], v[44:47]
    v_max3_u32 v2, v2, v158, v159
    v_max_u32 v2, v2, v3
    v_cmp_eq_u32 vcc, -1, v2
    v_mfma_f32_16x16x32_bf16 v[60:63], v[172:175], v[148:151], v[60:63]
    s_cbranch_vccnz G2_R7
G2_OK7:
    s_waitcnt lgkmcnt(8)
    v_and_b32 v2, v24, v25
    v_cmp_ne_u32 vcc, 0x01010101, v2
    s_cbranch_vccnz G2_ZLR
G2_ZLOK:
    v_mfma_f32_16x16x32_bf16 v[32:35], v[176:179], v[152:155], v[32:35]
    buffer_load_dwordx4 v[128:131], v0, s[28:31], s6 offen offset:1024 sc1
    buffer_load_dwordx4 v[132:135], v31, s[28:31], s6 offen offset:1024 sc1
    v_mfma_f32_16x16x32_bf16 v[48:51], v[176:179], v[156:159], v[48:51]
    ds_read_b64_tr_b16 v[224:225], v29 offset:23040
    ds_read_b64_tr_b16 v[228:229], v30 offset:23040
    v_mfma_f32_16x16x32_bf16 v[36:39], v[180:183], v[152:155], v[36:39]
    ds_read_b64_tr_b16 v[232:233], v9 offset:23040
    ds_read_b64_tr_b16 v[236:237], v28 offset:23040
    v_mfma_f32_16x16x32_bf16 v[52:55], v[180:183], v[156:159], v[52:55]
    ds_read_b64_tr_b16 v[226:227], v29 offset:24064
    ds_read_b64_tr_b16 v[230:231], v30 offset:24064
    v_mfma_f32_16x16x32_bf16 v[40:43], v[184:187], v[152:155], v[40:43]
    ds_read_b64_tr_b16 v[234:235], v9 offset:24064
    ds_read_b64_tr_b16 v[238:239], v28 offset:24064
    v_mfma_f32_16x16x32_bf16 v[56:59], v[184:187], v[156:159], v[56:59]
    s_waitcnt vmcnt(8)
    v_max3_u32 v2, v96, v97, v98
    v_max3_u32 v3, v99, v100, v101
    v_mfma_f32_16x16x32_bf16 v[44:47], v[188:191], v[152:155], v[44:47]
    v_max3_u32 v2, v2, v102, v103
    v_max_u32 v2, v2, v3
    v_cmp_eq_u32 vcc, -1, v2
    v_mfma_f32_16x16x32_bf16 v[60:63], v[188:191], v[156:159], v[60:63]
    s_cbranch_vccnz G2_R8
G2_OK8:
    v_mfma_f32_16x16x32_bf16 v[32:35], v[192:195], v[96:99], v[32:35]
    buffer_load_dwordx4 v[136:139], v0, s[28:31], s6 offen offset:2048 sc1
    buffer_load_dwordx4 v[140:143], v31, s[28:31], s6 offen offset:2048 sc1
    v_mfma_f32_16x16x32_bf16 v[48:51], v[192:195], v[100:103], v[48:51]
    ds_read_b64_tr_b16 v[240:241], v9 offset:30720
    ds_read_b64_tr_b16 v[244:245], v28 offset:30720
    v_mfma_f32_16x16x32_bf16 v[36:39], v[196:199], v[96:99], v[36:39]
    ds_read_b64_tr_b16 v[248:249], v29 offset:30720
    ds_read_b64_tr_b16 v[252:253], v30 offset:30720
    v_mfma_f32_16x16x32_bf16 v[52:55], v[196:199], v[100:103], v[52:55]
    ds_read_b64_tr_b16 v[242:243], v9 offset:31744
    ds_read_b64_tr_b16 v[246:247], v28 offset:31744
    v_mfma_f32_16x16x32_bf16 v[40:43], v[200:203], v[96:99], v[40:43]
    ds_read_b64_tr_b16 v[250:251], v29 offset:31744
    ds_read_b64_tr_b16 v[254:255], v30 offset:31744
    v_mfma_f32_16x16x32_bf16 v[56:59], v[200:203], v[100:103], v[56:59]
    s_waitcnt vmcnt(8)
    v_max3_u32 v2, v104, v105, v106
    v_max3_u32 v3, v107, v108, v109
    v_mfma_f32_16x16x32_bf16 v[44:47], v[204:207], v[96:99], v[44:47]
    v_max3_u32 v2, v2, v110, v111
    v_max_u32 v2, v2, v3
    v_cmp_eq_u32 vcc, -1, v2
    v_mfma_f32_16x16x32_bf16 v[60:63], v[204:207], v[100:103], v[60:63]
    s_cbranch_vccnz G2_R9
G2_OK9:
    s_waitcnt lgkmcnt(15)
    v_mfma_f32_16x16x32_bf16 v[32:35], v[208:211], v[104:107], v[32:35]
    v_xor_b32 v28, 32, v10
    v_xor_b32 v29, 64, v10
    v_xor_b32 v30, 96, v10
    v_mfma_f32_16x16x32_bf16 v[48:51], v[208:211], v[108:111], v[48:51]
    ds_read_b64_tr_b16 v[160:161], v10 offset:40960
    ds_read_b64_tr_b16 v[164:165], v28 offset:40960
    v_mfma_f32_16x16x32_bf16 v[36:39], v[212:215], v[104:107], v[36:39]
    ds_read_b64_tr_b16 v[168:169], v29 offset:40960
    ds_read_b64_tr_b16 v[172:173], v30 offset:40960
    v_mfma_f32_16x16x32_bf16 v[52:55], v[212:215], v[108:111], v[52:55]
    ds_read_b64_tr_b16 v[162:163], v10 offset:41984
    ds_read_b64_tr_b16 v[166:167], v28 offset:41984
    v_mfma_f32_16x16x32_bf16 v[40:43], v[216:219], v[104:107], v[40:43]
    ds_read_b64_tr_b16 v[170:171], v29 offset:41984
    ds_read_b64_tr_b16 v[174:175], v30 offset:41984
    v_mfma_f32_16x16x32_bf16 v[56:59], v[216:219], v[108:111], v[56:59]
    s_waitcnt vmcnt(6)
    v_max3_u32 v2, v112, v113, v114
    v_max3_u32 v3, v115, v116, v117
    v_mfma_f32_16x16x32_bf16 v[44:47], v[220:223], v[104:107], v[44:47]
    v_max3_u32 v2, v2, v118, v119
    v_max_u32 v2, v2, v3
    v_cmp_eq_u32 vcc, -1, v2
    v_mfma_f32_16x16x32_bf16 v[60:63], v[220:223], v[108:111], v[60:63]
    s_cbranch_vccnz G2_R10
G2_OK10:
    s_waitcnt lgkmcnt(15)
    v_mfma_f32_16x16x32_bf16 v[32:35], v[224:227], v[112:115], v[32:35]
    buffer_load_dwordx4 v[144:147], v0, s[28:31], s93 offen offset:0 sc1
    buffer_load_dwordx4 v[148:151], v31, s[28:31], s93 offen offset:0 sc1
    buffer_load_dwordx4 v[152:155], v0, s[28:31], s7 offen offset:0 sc1
    v_mfma_f32_16x16x32_bf16 v[48:51], v[224:227], v[116:119], v[48:51]
    buffer_load_dwordx4 v[156:159], v31, s[28:31], s7 offen offset:0 sc1
    v_xor_b32 v28, 32, v11
    v_xor_b32 v29, 64, v11
    v_mfma_f32_16x16x32_bf16 v[36:39], v[228:231], v[112:115], v[36:39]
    v_xor_b32 v30, 96, v11
    ds_read_b64_tr_b16 v[176:177], v11 offset:40960
    ds_read_b64_tr_b16 v[180:181], v28 offset:40960
    v_mfma_f32_16x16x32_bf16 v[52:55], v[228:231], v[116:119], v[52:55]
    ds_read_b64_tr_b16 v[184:185], v29 offset:40960
    ds_read_b64_tr_b16 v[188:189], v30 offset:40960
    ds_read_b64_tr_b16 v[178:179], v11 offset:56320
    v_mfma_f32_16x16x32_bf16 v[40:43], v[232:235], v[112:115], v[40:43]
    ds_read_b64_tr_b16 v[182:183], v28 offset:56320
    ds_read_b64_tr_b16 v[186:187], v29 offset:56320
    ds_read_b64_tr_b16 v[190:191], v30 offset:56320
    v_mfma_f32_16x16x32_bf16 v[56:59], v[232:235], v[116:119], v[56:59]
    s_waitcnt vmcnt(8)
    v_max3_u32 v2, v120, v121, v122
    v_max3_u32 v3, v123, v124, v125
    v_mfma_f32_16x16x32_bf16 v[44:47], v[236:239], v[112:115], v[44:47]
    v_max3_u32 v2, v2, v126, v127
    v_max_u32 v2, v2, v3
    v_cmp_eq_u32 vcc, -1, v2
    v_mfma_f32_16x16x32_bf16 v[60:63], v[236:239], v[116:119], v[60:63]
    s_cbranch_vccnz G2_R11
G2_OK11:
    s_waitcnt lgkmcnt(15)
    v_mfma_f32_16x16x32_bf16 v[32:35], v[240:243], v[120:123], v[32:35]
    buffer_load_dwordx4 v[96:99], v0, s[28:31], s93 offen offset:1024 sc1
    buffer_load_dwordx4 v[100:103], v31, s[28:31], s93 offen offset:1024 sc1
    v_xor_b32 v28, 32, v13
    v_mfma_f32_16x16x32_bf16 v[48:51], v[240:243], v[124:127], v[48:51]
    v_xor_b32 v29, 64, v13
    v_xor_b32 v30, 96, v13
    ds_read_b64_tr_b16 v[192:193], v13 offset:0
    v_mfma_f32_16x16x32_bf16 v[36:39], v[244:247], v[120:123], v[36:39]
    ds_read_b64_tr_b16 v[196:197], v28 offset:0
    ds_read_b64_tr_b16 v[200:201], v29 offset:0
    v_mfma_f32_16x16x32_bf16 v[52:55], v[244:247], v[124:127], v[52:55]
    ds_read_b64_tr_b16 v[204:205], v30 offset:0
    ds_read_b64_tr_b16 v[194:195], v13 offset:1024
    ds_read_b64_tr_b16 v[198:199], v28 offset:1024
    v_mfma_f32_16x16x32_bf16 v[40:43], v[248:251], v[120:123], v[40:43]
    ds_read_b64_tr_b16 v[202:203], v29 offset:1024
    ds_read_b64_tr_b16 v[206:207], v30 offset:1024
    v_mfma_f32_16x16x32_bf16 v[56:59], v[248:251], v[124:127], v[56:59]
    s_waitcnt vmcnt(8)
    v_max3_u32 v2, v128, v129, v130
    v_max3_u32 v3, v131, v132, v133
    v_mfma_f32_16x16x32_bf16 v[44:47], v[252:255], v[120:123], v[44:47]
    v_max3_u32 v2, v2, v134, v135
    v_max_u32 v2, v2, v3
    v_cmp_eq_u32 vcc, -1, v2
    v_mfma_f32_16x16x32_bf16 v[60:63], v[252:255], v[124:127], v[60:63]
    s_cbranch_vccnz G2_R12
G2_OK12:
    s_waitcnt lgkmcnt(15)
    v_mfma_f32_16x16x32_bf16 v[32:35], v[160:163], v[128:131], v[32:35]
    buffer_load_dwordx4 v[104:107], v0, s[28:31], s7 offen offset:1024 sc1
    buffer_load_dwordx4 v[108:111], v31, s[28:31], s7 offen offset:1024 sc1
    v_mfma_f32_16x16x32_bf16 v[48:51], v[160:163], v[132:135], v[48:51]
    ds_read_b64_tr_b16 v[208:209], v13 offset:40960
    ds_read_b64_tr_b16 v[212:213], v28 offset:40960
    v_mfma_f32_16x16x32_bf16 v[36:39], v[164:167], v[128:131], v[36:39]
    ds_read_b64_tr_b16 v[216:217], v29 offset:40960
    ds_read_b64_tr_b16 v[220:221], v30 offset:40960
    v_mfma_f32_16x16x32_bf16 v[52:55], v[164:167], v[132:135], v[52:55]
    ds_read_b64_tr_b16 v[210:211], v13 offset:41984
    ds_read_b64_tr_b16 v[214:215], v28 offset:41984
    v_mfma_f32_16x16x32_bf16 v[40:43], v[168:171], v[128:131], v[40:43]
    ds_read_b64_tr_b16 v[218:219], v29 offset:41984
    ds_read_b64_tr_b16 v[222:223], v30 offset:41984
    v_mfma_f32_16x16x32_bf16 v[56:59], v[168:171], v[132:135], v[56:59]
    s_waitcnt vmcnt(8)
    v_max3_u32 v2, v136, v137, v138
    v_max3_u32 v3, v139, v140, v141
    v_mfma_f32_16x16x32_bf16 v[44:47], v[172:175], v[128:131], v[44:47]
    v_max3_u32 v2, v2, v142, v143
    v_max_u32 v2, v2, v3
    v_cmp_eq_u32 vcc, -1, v2
    v_mfma_f32_16x16x32_bf16 v[60:63], v[172:175], v[132:135], v[60:63]
    s_cbranch_vccnz G2_R13
G2_OK13:
    s_waitcnt lgkmcnt(15)
    v_mfma_f32_16x16x32_bf16 v[32:35], v[176:179], v[136:139], v[32:35]
    buffer_load_dwordx4 v[112:115], v0, s[28:31], s92 offen offset:3072 sc1
    buffer_load_dwordx4 v[116:119], v31, s[28:31], s92 offen offset:3072 sc1
    v_xor_b32 v28, 32, v14
    v_mfma_f32_16x16x32_bf16 v[48:51], v[176:179], v[140:143], v[48:51]
    v_xor_b32 v29, 64, v14
    v_xor_b32 v30, 96, v14
    ds_read_b64_tr_b16 v[224:225], v14 offset:0
    v_mfma_f32_16x16x32_bf16 v[36:39], v[180:183], v[136:139], v[36:39]
    ds_read_b64_tr_b16 v[228:229], v28 offset:0
    ds_read_b64_tr_b16 v[232:233], v29 offset:0
    v_mfma_f32_16x16x32_bf16 v[52:55], v[180:183], v[140:143], v[52:55]
    ds_read_b64_tr_b16 v[236:237], v30 offset:0
    ds_read_b64_tr_b16 v[226:227], v29 offset:512
    ds_read_b64_tr_b16 v[230:231], v30 offset:512
    v_mfma_f32_16x16x32_bf16 v[40:43], v[184:187], v[136:139], v[40:43]
    ds_read_b64_tr_b16 v[234:235], v14 offset:512
    ds_read_b64_tr_b16 v[238:239], v28 offset:512
    v_mfma_f32_16x16x32_bf16 v[56:59], v[184:187], v[140:143], v[56:59]
    s_waitcnt vmcnt(8)
    v_max3_u32 v2, v144, v145, v146
    v_max3_u32 v3, v147, v148, v149
    v_mfma_f32_16x16x32_bf16 v[44:47], v[188:191], v[136:139], v[44:47]
    v_max3_u32 v2, v2, v150, v151
    v_max_u32 v2, v2, v3
    v_cmp_eq_u32 vcc, -1, v2
    v_mfma_f32_16x16x32_bf16 v[60:63], v[188:191], v[140:143], v[60:63]
    s_cbranch_vccnz G2_R14
G2_OK14:
    s_waitcnt lgkmcnt(15)
    v_mfma_f32_16x16x32_bf16 v[32:35], v[192:195], v[144:147], v[32:35]
    buffer_load_dwordx4 v[120:123], v0, s[28:31], s6 offen offset:3072 sc1
    buffer_load_dwordx4 v[124:127], v31, s[28:31], s6 offen offset:3072 sc1
    v_mfma_f32_16x16x32_bf16 v[48:51], v[192:195], v[148:151], v[48:51]
    ds_read_b64_tr_b16 v[240:241], v14 offset:40960
    ds_read_b64_tr_b16 v[244:245], v28 offset:40960
    v_mfma_f32_16x16x32_bf16 v[36:39], v[196:199], v[144:147], v[36:39]
    ds_read_b64_tr_b16 v[248:249], v29 offset:40960
    ds_read_b64_tr_b16 v[252:253], v30 offset:40960
    v_mfma_f32_16x16x32_bf16 v[52:55], v[196:199], v[148:151], v[52:55]
    ds_read_b64_tr_b16 v[242:243], v29 offset:41472
    ds_read_b64_tr_b16 v[246:247], v30 offset:41472
    v_mfma_f32_16x16x32_bf16 v[40:43], v[200:203], v[144:147], v[40:43]
    ds_read_b64_tr_b16 v[250:251], v14 offset:41472
    ds_read_b64_tr_b16 v[254:255], v28 offset:41472
    v_mfma_f32_16x16x32_bf16 v[56:59], v[200:203], v[148:151], v[56:59]
    s_waitcnt vmcnt(8)
    v_max3_u32 v2, v152, v153, v154
    v_max3_u32 v3, v155, v156, v157
    v_mfma_f32_16x16x32_bf16 v[44:47], v[204:207], v[144:147], v[44:47]
    v_max3_u32 v2, v2, v158, v159
    v_max_u32 v2, v2, v3
    v_cmp_eq_u32 vcc, -1, v2
    v_mfma_f32_16x16x32_bf16 v[60:63], v[204:207], v[148:151], v[60:63]
    s_cbranch_vccnz G2_R15
G2_OK15:
    s_waitcnt lgkmcnt(15)
    v_mfma_f32_16x16x32_bf16 v[32:35], v[208:211], v[152:155], v[32:35]
    v_xor_b32 v28, 32, v12
    v_xor_b32 v29, 64, v12
    v_xor_b32 v30, 96, v12
    v_mfma_f32_16x16x32_bf16 v[48:51], v[208:211], v[156:159], v[48:51]
    ds_read_b64_tr_b16 v[160:161], v12 offset:0
    ds_read_b64_tr_b16 v[164:165], v28 offset:0
    ds_read_b64_tr_b16 v[168:169], v29 offset:0
    v_mfma_f32_16x16x32_bf16 v[36:39], v[212:215], v[152:155], v[36:39]
    ds_read_b64_tr_b16 v[172:173], v30 offset:0
    v_xor_b32 v28, 32, v15
    v_xor_b32 v29, 64, v15
    v_mfma_f32_16x16x32_bf16 v[52:55], v[212:215], v[156:159], v[52:55]
    v_xor_b32 v30, 96, v15
    ds_read_b64_tr_b16 v[162:163], v15 offset:0
    ds_read_b64_tr_b16 v[166:167], v28 offset:0
    v_mfma_f32_16x16x32_bf16 v[40:43], v[216:219], v[152:155], v[40:43]
    ds_read_b64_tr_b16 v[170:171], v29 offset:0
    ds_read_b64_tr_b16 v[174:175], v30 offset:0
    v_mfma_f32_16x16x32_bf16 v[56:59], v[216:219], v[156:159], v[56:59]
    s_waitcnt vmcnt(6)
    v_max3_u32 v2, v96, v97, v98
    v_max3_u32 v3, v99, v100, v101
    v_mfma_f32_16x16x32_bf16 v[44:47], v[220:223], v[152:155], v[44:47]
    v_max3_u32 v2, v2, v102, v103
    v_max_u32 v2, v2, v3
    v_cmp_eq_u32 vcc, -1, v2
    v_mfma_f32_16x16x32_bf16 v[60:63], v[220:223], v[156:159], v[60:63]
    s_cbranch_vccnz G2_R16
G2_OK16:
    s_waitcnt lgkmcnt(15)
    v_mfma_f32_16x16x32_bf16 v[32:35], v[224:227], v[96:99], v[32:35]
    v_xor_b32 v28, 32, v12
    v_xor_b32 v29, 64, v12
    v_xor_b32 v30, 96, v12
    v_mfma_f32_16x16x32_bf16 v[48:51], v[224:227], v[100:103], v[48:51]
    ds_read_b64_tr_b16 v[176:177], v12 offset:40960
    ds_read_b64_tr_b16 v[180:181], v28 offset:40960
    ds_read_b64_tr_b16 v[184:185], v29 offset:40960
    v_mfma_f32_16x16x32_bf16 v[36:39], v[228:231], v[96:99], v[36:39]
    ds_read_b64_tr_b16 v[188:189], v30 offset:40960
    v_xor_b32 v28, 32, v15
    v_xor_b32 v29, 64, v15
    v_mfma_f32_16x16x32_bf16 v[52:55], v[228:231], v[100:103], v[52:55]
    v_xor_b32 v30, 96, v15
    ds_read_b64_tr_b16 v[178:179], v15 offset:40960
    ds_read_b64_tr_b16 v[182:183], v28 offset:40960
    v_mfma_f32_16x16x32_bf16 v[40:43], v[232:235], v[96:99], v[40:43]
    ds_read_b64_tr_b16 v[186:187], v29 offset:40960
    ds_read_b64_tr_b16 v[190:191], v30 offset:40960
    v_mfma_f32_16x16x32_bf16 v[56:59], v[232:235], v[100:103], v[56:59]
    s_waitcnt vmcnt(4)
    v_max3_u32 v2, v104, v105, v106
    v_max3_u32 v3, v107, v108, v109
    v_mfma_f32_16x16x32_bf16 v[44:47], v[236:239], v[96:99], v[44:47]
    v_max3_u32 v2, v2, v110, v111
    v_max_u32 v2, v2, v3
    v_cmp_eq_u32 vcc, -1, v2
    v_mfma_f32_16x16x32_bf16 v[60:63], v[236:239], v[100:103], v[60:63]
    s_cbranch_vccnz G2_R17
G2_OK17:
    s_waitcnt lgkmcnt(15)
    v_mfma_f32_16x16x32_bf16 v[32:35], v[240:243], v[104:107], v[32:35]
    v_mfma_f32_16x16x32_bf16 v[48:51], v[240:243], v[108:111], v[48:51]
    v_mfma_f32_16x16x32_bf16 v[36:39], v[244:247], v[104:107], v[36:39]
    v_mfma_f32_16x16x32_bf16 v[52:55], v[244:247], v[108:111], v[52:55]
    v_mfma_f32_16x16x32_bf16 v[40:43], v[248:251], v[104:107], v[40:43]
    v_mfma_f32_16x16x32_bf16 v[56:59], v[248:251], v[108:111], v[56:59]
    s_waitcnt vmcnt(2)
    v_max3_u32 v2, v112, v113, v114
    v_max3_u32 v3, v115, v116, v117
    v_mfma_f32_16x16x32_bf16 v[44:47], v[252:255], v[104:107], v[44:47]
    v_max3_u32 v2, v2, v118, v119
    v_max_u32 v2, v2, v3
    v_cmp_eq_u32 vcc, -1, v2
    v_mfma_f32_16x16x32_bf16 v[60:63], v[252:255], v[108:111], v[60:63]
    s_cbranch_vccnz G2_R18
G2_OK18:
    s_waitcnt lgkmcnt(8)
    v_mfma_f32_16x16x32_bf16 v[32:35], v[160:163], v[112:115], v[32:35]
    ds_read_b64 v[24:25], v19 offset:8
    v_xor_b32 v28, 32, v8
    v_mfma_f32_16x16x32_bf16 v[48:51], v[160:163], v[116:119], v[48:51]
    v_xor_b32 v29, 64, v8
    v_xor_b32 v30, 96, v8
    v_mfma_f32_16x16x32_bf16 v[36:39], v[164:167], v[112:115], v[36:39]
    s_lshl_b32 s60, s8, 11
    v_mfma_f32_16x16x32_bf16 v[52:55], v[164:167], v[116:119], v[52:55]
    v_add_u32 v17, s60, v6
    s_add_u32 s60, s60, 116736
    v_mfma_f32_16x16x32_bf16 v[40:43], v[168:171], v[112:115], v[40:43]
    v_add_u32 v20, s60, v17
    v_mfma_f32_16x16x32_bf16 v[56:59], v[168:171], v[116:119], v[56:59]
    s_waitcnt vmcnt(0)
    v_max3_u32 v2, v120, v121, v122
    v_max3_u32 v3, v123, v124, v125
    v_mfma_f32_16x16x32_bf16 v[44:47], v[172:175], v[112:115], v[44:47]
    v_max3_u32 v2, v2, v126, v127
    v_max_u32 v2, v2, v3
    v_cmp_eq_u32 vcc, -1, v2
    v_mfma_f32_16x16x32_bf16 v[60:63], v[172:175], v[116:119], v[60:63]
    s_cbranch_vccnz G2_R19
G2_OK19:
    s_waitcnt lgkmcnt(0)
    v_and_b32 v2, v24, v25
    v_cmp_ne_u32 vcc, 0x01010101, v2
    s_cbranch_vccnz G2_ZGR
G2_ZGOK:
    v_mfma_f32_16x16x32_bf16 v[32:35], v[176:179], v[120:123], v[32:35]
    ds_read_b128 v[192:195], v20 offset:0
    ds_read_b128 v[196:199], v20 offset:1024
    v_mfma_f32_16x16x32_bf16 v[36:39], v[180:183], v[120:123], v[36:39]
    ds_read_b128 v[200:203], v20 offset:2048
    ds_read_b128 v[204:207], v20 offset:3072
    v_mfma_f32_16x16x32_bf16 v[40:43], v[184:187], v[120:123], v[40:43]
    ds_read_b128 v[208:211], v20 offset:4096
    v_mfma_f32_16x16x32_bf16 v[44:47], v[188:191], v[120:123], v[44:47]
    ds_read_b128 v[212:215], v20 offset:5120
    ds_read_b128 v[216:219], v20 offset:6144
    v_mfma_f32_16x16x32_bf16 v[48:51], v[176:179], v[124:127], v[48:51]
    ds_read_b128 v[220:223], v20 offset:7168
    v_mfma_f32_16x16x32_bf16 v[52:55], v[180:183], v[124:127], v[52:55]
    v_mfma_f32_16x16x32_bf16 v[56:59], v[184:187], v[124:127], v[56:59]
    v_mfma_f32_16x16x32_bf16 v[60:63], v[188:191], v[124:127], v[60:63]
    s_waitcnt lgkmcnt(4)
    v_pk_fma_f32 v[64:65], v[32:33], v[192:193], v[64:65]
    v_pk_fma_f32 v[66:67], v[34:35], v[194:195], v[66:67]
    v_pk_fma_f32 v[68:69], v[36:37], v[196:197], v[68:69]
    v_pk_fma_f32 v[70:71], v[38:39], v[198:199], v[70:71]
    v_pk_fma_f32 v[72:73], v[40:41], v[200:201], v[72:73]
    v_pk_fma_f32 v[74:75], v[42:43], v[202:203], v[74:75]
    v_pk_fma_f32 v[76:77], v[44:45], v[204:205], v[76:77]
    v_pk_fma_f32 v[78:79], v[46:47], v[206:207], v[78:79]
    v_cvt_pk_bf16_f32 v96, v64, v65
    v_cvt_pk_bf16_f32 v97, v66, v67
    ds_write_b64 v8, v[96:97] offset:0
    v_cvt_pk_bf16_f32 v98, v68, v69
    v_cvt_pk_bf16_f32 v99, v70, v71
    ds_write_b64 v28, v[98:99] offset:0
    v_cvt_pk_bf16_f32 v100, v72, v73
    v_cvt_pk_bf16_f32 v101, v74, v75
    ds_write_b64 v29, v[100:101] offset:0
    v_cvt_pk_bf16_f32 v102, v76, v77
    v_cvt_pk_bf16_f32 v103, v78, v79
    ds_write_b64 v30, v[102:103] offset:0
    ds_read_b128 v[224:227], v17 offset:0
    ds_read_b128 v[228:231], v17 offset:1024
    s_cmp_eq_u32 s101, 1
    s_cbranch_scc1 G2_ONE
    s_waitcnt lgkmcnt(6)
    v_pk_fma_f32 v[80:81], v[48:49], v[208:209], v[80:81]
    v_pk_fma_f32 v[82:83], v[50:51], v[210:211], v[82:83]
    v_pk_fma_f32 v[84:85], v[52:53], v[212:213], v[84:85]
    v_pk_fma_f32 v[86:87], v[54:55], v[214:215], v[86:87]
    v_pk_fma_f32 v[88:89], v[56:57], v[216:217], v[88:89]
    v_pk_fma_f32 v[90:91], v[58:59], v[218:219], v[90:91]
    v_pk_fma_f32 v[92:93], v[60:61], v[220:221], v[92:93]
    v_pk_fma_f32 v[94:95], v[62:63], v[222:223], v[94:95]
    v_cvt_pk_bf16_f32 v104, v80, v81
    v_cvt_pk_bf16_f32 v105, v82, v83
    ds_write_b64 v8, v[104:105] offset:2048
    v_cvt_pk_bf16_f32 v106, v84, v85
    v_cvt_pk_bf16_f32 v107, v86, v87
    ds_write_b64 v28, v[106:107] offset:2048
    v_cvt_pk_bf16_f32 v108, v88, v89
    v_cvt_pk_bf16_f32 v109, v90, v91
    ds_write_b64 v29, v[108:109] offset:2048
    v_cvt_pk_bf16_f32 v110, v92, v93
    v_cvt_pk_bf16_f32 v111, v94, v95
    ds_write_b64 v30, v[110:111] offset:2048
    ds_read_b128 v[232:235], v17 offset:2048
    ds_read_b128 v[236:239], v17 offset:3072
    s_waitcnt lgkmcnt(7)
    buffer_store_dwordx4 v[224:227], v7, s[44:47], s97 offen
    s_waitcnt lgkmcnt(6)
    buffer_store_dwordx4 v[228:231], v7, s[44:47], s94 offen
    s_add_u32 s94, s94, 20480
    s_waitcnt lgkmcnt(1)
    buffer_store_dwordx4 v[232:235], v7, s[44:47], s94 offen
    s_add_u32 s94, s94, 20480
    s_waitcnt lgkmcnt(0)
    buffer_store_dwordx4 v[236:239], v7, s[44:47], s94 offen
    s_endpgm
G2_ONE:
    s_waitcnt lgkmcnt(1)
    buffer_store_dwordx4 v[224:227], v7, s[44:47], s97 offen
    s_waitcnt lgkmcnt(0)
    buffer_store_dwordx4 v[228:231], v7, s[44:47], s94 offen
    s_endpgm
K_P1:
    ds_read2_b32 v[240:241], v17 offset0:0 offset1:2
    ds_read_b64 v[48:49], v8 offset:0
    v_xor_b32 v56, 32, v8
    ds_read_b64 v[50:51], v56 offset:0
    v_xor_b32 v56, 64, v8
    ds_read_b64 v[52:53], v56 offset:0
    v_xor_b32 v56, 96, v8
    ds_read_b64 v[54:55], v56 offset:0
    s_waitcnt lgkmcnt(0)
    v_mul_f32 v240, v240, v241
    v_mul_f32 v242, 0xbfb8aa3b, v241
    v_mul_f32 v243, 0xbfb8aa3b, v240
    v_lshlrev_b32 v208, 16, v48
    v_and_b32 v209, 0xffff0000, v48
    v_lshlrev_b32 v210, 16, v49
    v_and_b32 v211, 0xffff0000, v49
    v_lshlrev_b32 v212, 16, v50
    v_and_b32 v213, 0xffff0000, v50
    v_lshlrev_b32 v214, 16, v51
    v_and_b32 v215, 0xffff0000, v51
    v_fma_f32 v56, v208, v242, v243
    v_fma_f32 v57, v209, v242, v243
    v_fma_f32 v58, v210, v242, v243
    v_fma_f32 v59, v211, v242, v243
    v_fma_f32 v60, v212, v242, v243
    v_fma_f32 v61, v213, v242, v243
    v_fma_f32 v62, v214, v242, v243
    v_fma_f32 v63, v215, v242, v243
    v_exp_f32 v56, v56
    v_fma_f32 v208, v208, v241, v240
    v_exp_f32 v57, v57
    v_fma_f32 v209, v209, v241, v240
    v_exp_f32 v58, v58
    v_fma_f32 v210, v210, v241, v240
    v_exp_f32 v59, v59
    v_fma_f32 v211, v211, v241, v240
    v_exp_f32 v60, v60
    v_fma_f32 v212, v212, v241, v240
    v_exp_f32 v61, v61
    v_fma_f32 v213, v213, v241, v240
    v_exp_f32 v62, v62
    v_fma_f32 v214, v214, v241, v240
    v_exp_f32 v63, v63
    v_fma_f32 v215, v215, v241, v240
    v_add_f32 v56, 1.0, v56
    v_add_f32 v57, 1.0, v57
    v_add_f32 v58, 1.0, v58
    v_add_f32 v59, 1.0, v59
    v_add_f32 v60, 1.0, v60
    v_add_f32 v61, 1.0, v61
    v_add_f32 v62, 1.0, v62
    v_add_f32 v63, 1.0, v63
    v_rcp_f32 v56, v56
    v_rcp_f32 v57, v57
    v_rcp_f32 v58, v58
    v_rcp_f32 v59, v59
    v_rcp_f32 v60, v60
    v_rcp_f32 v61, v61
    v_rcp_f32 v62, v62
    v_rcp_f32 v63, v63
    v_mul_f32 v208, v208, v56
    v_mul_f32 v209, v209, v57
    v_mul_f32 v210, v210, v58
    v_mul_f32 v211, v211, v59
    v_mul_f32 v212, v212, v60
    v_mul_f32 v213, v213, v61
    v_mul_f32 v214, v214, v62
    v_mul_f32 v215, v215, v63
    s_setpc_b64 s[20:21]
K_P2:
    v_lshlrev_b32 v216, 16, v52
    v_and_b32 v217, 0xffff0000, v52
    v_lshlrev_b32 v218, 16, v53
    v_and_b32 v219, 0xffff0000, v53
    v_lshlrev_b32 v220, 16, v54
    v_and_b32 v221, 0xffff0000, v54
    v_lshlrev_b32 v222, 16, v55
    v_and_b32 v223, 0xffff0000, v55
    v_fma_f32 v56, v216, v242, v243
    v_fma_f32 v57, v217, v242, v243
    v_fma_f32 v58, v218, v242, v243
    v_fma_f32 v59, v219, v242, v243
    v_fma_f32 v60, v220, v242, v243
    v_fma_f32 v61, v221, v242, v243
    v_fma_f32 v62, v222, v242, v243
    v_fma_f32 v63, v223, v242, v243
    v_exp_f32 v56, v56
    v_fma_f32 v216, v216, v241, v240
    v_exp_f32 v57, v57
    v_fma_f32 v217, v217, v241, v240
    v_exp_f32 v58, v58
    v_fma_f32 v218, v218, v241, v240
    v_exp_f32 v59, v59
    v_fma_f32 v219, v219, v241, v240
    v_exp_f32 v60, v60
    v_fma_f32 v220, v220, v241, v240
    v_exp_f32 v61, v61
    v_fma_f32 v221, v221, v241, v240
    v_exp_f32 v62, v62
    v_fma_f32 v222, v222, v241, v240
    v_exp_f32 v63, v63
    v_fma_f32 v223, v223, v241, v240
    v_add_f32 v56, 1.0, v56
    v_add_f32 v57, 1.0, v57
    v_add_f32 v58, 1.0, v58
    v_add_f32 v59, 1.0, v59
    v_add_f32 v60, 1.0, v60
    v_add_f32 v61, 1.0, v61
    v_add_f32 v62, 1.0, v62
    v_add_f32 v63, 1.0, v63
    v_rcp_f32 v56, v56
    v_rcp_f32 v57, v57
    v_rcp_f32 v58, v58
    v_rcp_f32 v59, v59
    v_rcp_f32 v60, v60
    v_rcp_f32 v61, v61
    v_rcp_f32 v62, v62
    v_rcp_f32 v63, v63
    v_mul_f32 v216, v216, v56
    v_mul_f32 v217, v217, v57
    v_mul_f32 v218, v218, v58
    v_mul_f32 v219, v219, v59
    v_mul_f32 v220, v220, v60
    v_mul_f32 v221, v221, v61
    v_mul_f32 v222, v222, v62
    v_mul_f32 v223, v223, v63
    s_setpc_b64 s[20:21]
P_TAIL:
    s_setprio 0
    s_cmp_eq_u32 s13, 1
    s_cbranch_scc1 P_ST
    s_sub_u32 s64, s54, s53
    s_mul_i32 s65, s64, 8192
    s_add_u32 s65, s65, 204800
    s_mul_hi_u32 s64, s65, 429496730
    s_mov_b32 s60, 5
    s_lshl_b32 s66, s59, 10
    s_add_u32 s66, s66, 55296
P_WO:
    s_add_u32 m0, s64, s66
    s_add_u32 s61, s65, s23
    s_add_u32 s64, s64, 4096
    buffer_load_dwordx4 v16, s[40:43], s61 offen lds
    s_add_u32 s65, s65, 40960
    s_cmp_eq_u32 s64, 40960
    s_cselect_b32 s64, 20480, s64
    s_cselect_b32 s65, 204800, s65
    s_sub_u32 s60, s60, 1
    s_cmp_lg_u32 s60, 0
    s_cbranch_scc1 P_WO
    s_call_b64 s[20:21], K_P1
    s_call_b64 s[20:21], K_P2
    s_waitcnt vmcnt(0)
    v_mov_b32 v2, 1
    ds_write_b8 v18, v2 offset:16
P_ST:
    v_mov_b32 v2, 1
    ds_write_b8 v18, v2 offset:0
    s_cmp_lt_u32 s101, 2
    s_cbranch_scc1 P_NOB
    ds_read2_b32 v[240:241], v17 offset0:64 offset1:66
    ds_read_b64 v[48:49], v8 offset:2048
    v_xor_b32 v56, 32, v8
    ds_read_b64 v[50:51], v56 offset:2048
    v_xor_b32 v56, 64, v8
    ds_read_b64 v[52:53], v56 offset:2048
    v_xor_b32 v56, 96, v8
    ds_read_b64 v[54:55], v56 offset:2048
    s_waitcnt lgkmcnt(0)
    v_mul_f32 v240, v240, v241
    v_mul_f32 v242, 0xbfb8aa3b, v241
    v_mul_f32 v243, 0xbfb8aa3b, v240
    v_lshlrev_b32 v224, 16, v48
    v_and_b32 v225, 0xffff0000, v48
    v_lshlrev_b32 v226, 16, v49
    v_and_b32 v227, 0xffff0000, v49
    v_lshlrev_b32 v228, 16, v50
    v_and_b32 v229, 0xffff0000, v50
    v_lshlrev_b32 v230, 16, v51
    v_and_b32 v231, 0xffff0000, v51
    v_fma_f32 v56, v224, v242, v243
    v_fma_f32 v57, v225, v242, v243
    v_fma_f32 v58, v226, v242, v243
    v_fma_f32 v59, v227, v242, v243
    v_fma_f32 v60, v228, v242, v243
    v_fma_f32 v61, v229, v242, v243
    v_fma_f32 v62, v230, v242, v243
    v_fma_f32 v63, v231, v242, v243
    v_exp_f32 v56, v56
    v_fma_f32 v224, v224, v241, v240
    v_exp_f32 v57, v57
    v_fma_f32 v225, v225, v241, v240
    v_exp_f32 v58, v58
    v_fma_f32 v226, v226, v241, v240
    v_exp_f32 v59, v59
    v_fma_f32 v227, v227, v241, v240
    v_exp_f32 v60, v60
    v_fma_f32 v228, v228, v241, v240
    v_exp_f32 v61, v61
    v_fma_f32 v229, v229, v241, v240
    v_exp_f32 v62, v62
    v_fma_f32 v230, v230, v241, v240
    v_exp_f32 v63, v63
    v_fma_f32 v231, v231, v241, v240
    v_add_f32 v56, 1.0, v56
    v_add_f32 v57, 1.0, v57
    v_add_f32 v58, 1.0, v58
    v_add_f32 v59, 1.0, v59
    v_add_f32 v60, 1.0, v60
    v_add_f32 v61, 1.0, v61
    v_add_f32 v62, 1.0, v62
    v_add_f32 v63, 1.0, v63
    v_rcp_f32 v56, v56
    v_rcp_f32 v57, v57
    v_rcp_f32 v58, v58
    v_rcp_f32 v59, v59
    v_rcp_f32 v60, v60
    v_rcp_f32 v61, v61
    v_rcp_f32 v62, v62
    v_rcp_f32 v63, v63
    v_mul_f32 v224, v224, v56
    v_mul_f32 v225, v225, v57
    v_mul_f32 v226, v226, v58
    v_mul_f32 v227, v227, v59
    v_mul_f32 v228, v228, v60
    v_mul_f32 v229, v229, v61
    v_mul_f32 v230, v230, v62
    v_mul_f32 v231, v231, v63
    v_lshlrev_b32 v232, 16, v52
    v_and_b32 v233, 0xffff0000, v52
    v_lshlrev_b32 v234, 16, v53
    v_and_b32 v235, 0xffff0000, v53
    v_lshlrev_b32 v236, 16, v54
    v_and_b32 v237, 0xffff0000, v54
    v_lshlrev_b32 v238, 16, v55
    v_and_b32 v239, 0xffff0000, v55
    v_fma_f32 v56, v232, v242, v243
    v_fma_f32 v57, v233, v242, v243
    v_fma_f32 v58, v234, v242, v243
    v_fma_f32 v59, v235, v242, v243
    v_fma_f32 v60, v236, v242, v243
    v_fma_f32 v61, v237, v242, v243
    v_fma_f32 v62, v238, v242, v243
    v_fma_f32 v63, v239, v242, v243
    v_exp_f32 v56, v56
    v_fma_f32 v232, v232, v241, v240
    v_exp_f32 v57, v57
    v_fma_f32 v233, v233, v241, v240
    v_exp_f32 v58, v58
    v_fma_f32 v234, v234, v241, v240
    v_exp_f32 v59, v59
    v_fma_f32 v235, v235, v241, v240
    v_exp_f32 v60, v60
    v_fma_f32 v236, v236, v241, v240
    v_exp_f32 v61, v61
    v_fma_f32 v237, v237, v241, v240
    v_exp_f32 v62, v62
    v_fma_f32 v238, v238, v241, v240
    v_exp_f32 v63, v63
    v_fma_f32 v239, v239, v241, v240
    v_add_f32 v56, 1.0, v56
    v_add_f32 v57, 1.0, v57
    v_add_f32 v58, 1.0, v58
    v_add_f32 v59, 1.0, v59
    v_add_f32 v60, 1.0, v60
    v_add_f32 v61, 1.0, v61
    v_add_f32 v62, 1.0, v62
    v_add_f32 v63, 1.0, v63
    v_rcp_f32 v56, v56
    v_rcp_f32 v57, v57
    v_rcp_f32 v58, v58
    v_rcp_f32 v59, v59
    v_rcp_f32 v60, v60
    v_rcp_f32 v61, v61
    v_rcp_f32 v62, v62
    v_rcp_f32 v63, v63
    v_mul_f32 v232, v232, v56
    v_mul_f32 v233, v233, v57
    v_mul_f32 v234, v234, v58
    v_mul_f32 v235, v235, v59
    v_mul_f32 v236, v236, v60
    v_mul_f32 v237, v237, v61
    v_mul_f32 v238, v238, v62
    v_mul_f32 v239, v239, v63
P_NOB:
    ds_read_b64 v[2:3], v19 offset:40
    s_lshl_b32 s61, s58, 1
    s_add_u32 s61, s61, 65536
    s_lshl_b32 s62, s101, 4
    s_mov_b32 s100, 0
    s_waitcnt lgkmcnt(0)
    v_readfirstlane_b32 s90, v2
    v_readfirstlane_b32 s91, v3
    v_and_b32 v3, 48, v1
    s_sub_u32 s60, s90, s95
    s_cmp_ge_u32 s60, s62
    s_cbranch_scc1 FIX_N0
    s_and_b32 s63, s60, 15
    v_cmp_eq_u32 vcc, s63, v4
    s_nop 0
    s_mov_b64 exec, vcc
    buffer_load_dwordx4 v[96:99], v3, s[28:31], s61 offen offset:0 sc1
    buffer_load_dwordx4 v[100:103], v3, s[28:31], s61 offen offset:64 sc1
    buffer_load_dwordx4 v[104:107], v3, s[28:31], s61 offen offset:128 sc1
    buffer_load_dwordx4 v[108:111], v3, s[28:31], s61 offen offset:192 sc1
    s_waitcnt vmcnt(0)
FIX_U0_CHK:
    v_xor_b32 v2, s52, v97
    v_bitop3_b32 v2, v99, s52, v2 bitop3:0xbe
    v_bitop3_b32 v2, v101, s52, v2 bitop3:0xbe
    v_bitop3_b32 v2, v103, s52, v2 bitop3:0xbe
    v_bitop3_b32 v2, v105, s52, v2 bitop3:0xbe
    v_bitop3_b32 v2, v107, s52, v2 bitop3:0xbe
    v_bitop3_b32 v2, v109, s52, v2 bitop3:0xbe
    v_bitop3_b32 v2, v111, s52, v2 bitop3:0xbe
    v_cmp_ne_u32 vcc, 0, v2
    s_cbranch_vccz FIX_U0_OK
FIX_U0_RETRY:
    s_add_u32 s100, s100, 1
    s_cmp_gt_u32 s100, 20000
    s_cbranch_scc1 FIX_U0_OK
    s_sleep 4
    buffer_load_dwordx4 v[96:99], v3, s[28:31], s61 offen offset:0 sc1
    buffer_load_dwordx4 v[100:103], v3, s[28:31], s61 offen offset:64 sc1
    buffer_load_dwordx4 v[104:107], v3, s[28:31], s61 offen offset:128 sc1
    buffer_load_dwordx4 v[108:111], v3, s[28:31], s61 offen offset:192 sc1
    s_waitcnt vmcnt(0)
    s_branch FIX_U0_CHK
FIX_U0_OK:
    s_cmp_ge_u32 s60, 16
    s_cbranch_scc1 FIX_B0
    v_lshlrev_b32 v208, 16, v96
    v_and_b32 v209, 0xffff0000, v96
    v_lshlrev_b32 v210, 16, v98
    v_and_b32 v211, 0xffff0000, v98
    v_lshlrev_b32 v212, 16, v100
    v_and_b32 v213, 0xffff0000, v100
    v_lshlrev_b32 v214, 16, v102
    v_and_b32 v215, 0xffff0000, v102
    v_lshlrev_b32 v216, 16, v104
    v_and_b32 v217, 0xffff0000, v104
    v_lshlrev_b32 v218, 16, v106
    v_and_b32 v219, 0xffff0000, v106
    v_lshlrev_b32 v220, 16, v108
    v_and_b32 v221, 0xffff0000, v108
    v_lshlrev_b32 v222, 16, v110
    v_and_b32 v223, 0xffff0000, v110
    s_mov_b64 exec, -1
    s_branch FIX_N0
FIX_B0:
    v_lshlrev_b32 v224, 16, v96
    v_and_b32 v225, 0xffff0000, v96
    v_lshlrev_b32 v226, 16, v98
    v_and_b32 v227, 0xffff0000, v98
    v_lshlrev_b32 v228, 16, v100
    v_and_b32 v229, 0xffff0000, v100
    v_lshlrev_b32 v230, 16, v102
    v_and_b32 v231, 0xffff0000, v102
    v_lshlrev_b32 v232, 16, v104
    v_and_b32 v233, 0xffff0000, v104
    v_lshlrev_b32 v234, 16, v106
    v_and_b32 v235, 0xffff0000, v106
    v_lshlrev_b32 v236, 16, v108
    v_and_b32 v237, 0xffff0000, v108
    v_lshlrev_b32 v238, 16, v110
    v_and_b32 v239, 0xffff0000, v110
    s_mov_b64 exec, -1
FIX_N0:
    s_sub_u32 s60, s91, s95
    s_cmp_ge_u32 s60, s62
    s_cbranch_scc1 FIX_N1
    s_and_b32 s63, s60, 15
    v_cmp_eq_u32 vcc, s63, v4
    s_nop 0
    s_mov_b64 exec, vcc
    buffer_load_dwordx4 v[96:99], v3, s[28:31], s61 offen offset:2560 sc1
    buffer_load_dwordx4 v[100:103], v3, s[28:31], s61 offen offset:2624 sc1
    buffer_load_dwordx4 v[104:107], v3, s[28:31], s61 offen offset:2688 sc1
    buffer_load_dwordx4 v[108:111], v3, s[28:31], s61 offen offset:2752 sc1
    s_waitcnt vmcnt(0)
FIX_U1_CHK:
    v_xor_b32 v2, s52, v97
    v_bitop3_b32 v2, v99, s52, v2 bitop3:0xbe
    v_bitop3_b32 v2, v101, s52, v2 bitop3:0xbe
    v_bitop3_b32 v2, v103, s52, v2 bitop3:0xbe
    v_bitop3_b32 v2, v105, s52, v2 bitop3:0xbe
    v_bitop3_b32 v2, v107, s52, v2 bitop3:0xbe
    v_bitop3_b32 v2, v109, s52, v2 bitop3:0xbe
    v_bitop3_b32 v2, v111, s52, v2 bitop3:0xbe
    v_cmp_ne_u32 vcc, 0, v2
    s_cbranch_vccz FIX_U1_OK
FIX_U1_RETRY:
    s_add_u32 s100, s100, 1
    s_cmp_gt_u32 s100, 20000
    s_cbranch_scc1 FIX_U1_OK
    s_sleep 4
    buffer_load_dwordx4 v[96:99], v3, s[28:31], s61 offen offset:2560 sc1
    buffer_load_dwordx4 v[100:103], v3, s[28:31], s61 offen offset:2624 sc1
    buffer_load_dwordx4 v[104:107], v3, s[28:31], s61 offen offset:2688 sc1
    buffer_load_dwordx4 v[108:111], v3, s[28:31], s61 offen offset:2752 sc1
    s_waitcnt vmcnt(0)
    s_branch FIX_U1_CHK
FIX_U1_OK:
    s_cmp_ge_u32 s60, 16
    s_cbranch_scc1 FIX_B1
    v_lshlrev_b32 v208, 16, v96
    v_and_b32 v209, 0xffff0000, v96
    v_lshlrev_b32 v210, 16, v98
    v_and_b32 v211, 0xffff0000, v98
    v_lshlrev_b32 v212, 16, v100
    v_and_b32 v213, 0xffff0000, v100
    v_lshlrev_b32 v214, 16, v102
    v_and_b32 v215, 0xffff0000, v102
    v_lshlrev_b32 v216, 16, v104
    v_and_b32 v217, 0xffff0000, v104
    v_lshlrev_b32 v218, 16, v106
    v_and_b32 v219, 0xffff0000, v106
    v_lshlrev_b32 v220, 16, v108
    v_and_b32 v221, 0xffff0000, v108
    v_lshlrev_b32 v222, 16, v110
    v_and_b32 v223, 0xffff0000, v110
    s_mov_b64 exec, -1
    s_branch FIX_N1
FIX_B1:
    v_lshlrev_b32 v224, 16, v96
    v_and_b32 v225, 0xffff0000, v96
    v_lshlrev_b32 v226, 16, v98
    v_and_b32 v227, 0xffff0000, v98
    v_lshlrev_b32 v228, 16, v100
    v_and_b32 v229, 0xffff0000, v100
    v_lshlrev_b32 v230, 16, v102
    v_and_b32 v231, 0xffff0000, v102
    v_lshlrev_b32 v232, 16, v104
    v_and_b32 v233, 0xffff0000, v104
    v_lshlrev_b32 v234, 16, v106
    v_and_b32 v235, 0xffff0000, v106
    v_lshlrev_b32 v236, 16, v108
    v_and_b32 v237, 0xffff0000, v108
    v_lshlrev_b32 v238, 16, v110
    v_and_b32 v239, 0xffff0000, v110
    s_mov_b64 exec, -1
FIX_N1:
    s_lshl_b32 s60, s8, 12
    s_add_u32 s60, s60, 116736
    v_add_u32 v20, s60, v6
    s_mov_b32 s100, 0
    ds_read_b64 v[2:3], v19 offset:0
P_Z:
    s_waitcnt lgkmcnt(0)
    v_and_b32 v2, v2, v3
    v_cmp_ne_u32 vcc, 0x01010101, v2
    s_cbranch_vccnz P_ZR
P_ZOK:
    ds_write_b128 v20, v[208:211] offset:0
    ds_write_b128 v20, v[212:215] offset:1024
    ds_write_b128 v20, v[216:219] offset:2048
    ds_write_b128 v20, v[220:223] offset:3072
    ds_write_b128 v20, v[224:227] offset:4096
    ds_write_b128 v20, v[228:231] offset:5120
    ds_write_b128 v20, v[232:235] offset:6144
    ds_write_b128 v20, v[236:239] offset:7168
    v_mov_b32 v2, 1
    ds_write_b8 v18, v2 offset:8
    s_endpgm
L_CONT:
    s_lshr_b32 s64, 4099, s67
    s_and_b32 s64, s64, 15
    s_add_u32 s64, s64, s68
    s_cmp_ge_u32 s64, 10
    s_cselect_b32 s65, 10, 0
    s_sub_u32 s64, s64, s65
    s_mul_i32 s65, s64, 245760
    s_lshl_b32 s64, s64, 7
    s_add_u32 s64, s64, s57
    s_add_u32 m0, s69, 0
    s_mov_b32 exec_lo, s70
    buffer_load_dwordx4 v196, s[24:27], s64 offen lds
    s_add_u32 m0, s69, 4096
    s_mov_b32 exec_lo, -1
    buffer_load_dwordx4 v197, s[24:27], s64 offen lds
    s_add_u32 m0, s69, 8192
    s_add_u32 s65, s65, s58
    buffer_load_dwordx4 v198, s[24:27], s64 offen lds
    s_cbranch_vccz L_SK1
    s_add_u32 m0, s69, 12288
    s_nop 0
    buffer_load_dwordx4 v199, s[24:27], s64 offen lds
L_SK1:
    s_add_u32 m0, s69, 14336
    s_add_u32 s66, s65, 122880
    buffer_load_dwordx4 v200, s[32:35], s65 offen offset:0 lds
    s_add_u32 m0, s69, 21248
    s_nop 0
    buffer_load_dwordx4 v200, s[32:35], s65 offen offset:1280 lds
    s_add_u32 m0, s69, 28160
    s_nop 0
    buffer_load_dwordx4 v200, s[32:35], s65 offen offset:2560 lds
    s_add_u32 m0, s69, 18432
    s_nop 0
    buffer_load_dwordx4 v200, s[32:35], s66 offen offset:0 lds
    s_add_u32 m0, s69, 25344
    s_nop 0
    buffer_load_dwordx4 v200, s[32:35], s66 offen offset:1280 lds
    s_add_u32 m0, s69, 32256
    s_nop 0
    buffer_load_dwordx4 v200, s[32:35], s66 offen offset:2560 lds
    s_mul_i32 s60, s3, 5
    s_lshl_b32 s61, s53, 6
    s_add_u32 s60, s60, s61
    s_add_u32 s60, s60, K_TAB-K_PC
    s_load_dwordx16 s[4:19], s[20:21], s60
    s_load_dwordx2 s[44:45], s[0:1], 64
    s_load_dwordx2 s[40:41], s[0:1], 16
    s_mov_b32 s46, 2621440
    s_mov_b32 s47, 0x20000
    s_mov_b32 s30, 7077888
    s_mov_b32 s31, 0x20000
    s_mov_b32 s42, 819200
    s_mov_b32 s43, 0x20000
    s_lshr_b32 s3, s3, 6
    s_and_b32 s59, s3, 3
    s_mov_b32 s55, 0xffff0000
    s_mov_b32 s100, 0
    v_and_b32 v1, 63, v0
    v_and_b32 v4, 15, v1
    v_lshrrev_b32 v5, 4, v1
    v_mov_b32 v19, 163584
    v_add_u32 v18, s3, v19
    s_cbranch_vccz L_W0a
    s_waitcnt vmcnt(10)
    s_branch L_W0b
L_W0a:
    s_waitcnt vmcnt(9)
L_W0b:
    s_barrier
    s_lshr_b32 s64, 139585, s67
    s_and_b32 s64, s64, 15
    s_add_u32 s64, s64, s68
    s_cmp_ge_u32 s64, 10
    s_cselect_b32 s65, 10, 0
    s_sub_u32 s64, s64, s65
    s_mul_i32 s65, s64, 245760
    s_lshl_b32 s64, s64, 7
    s_add_u32 s64, s64, s57
    s_add_u32 m0, s69, 38912
    s_mov_b32 exec_lo, s70
    buffer_load_dwordx4 v196, s[24:27], s64 offen lds
    s_add_u32 m0, s69, 43008
    s_mov_b32 exec_lo, -1
    buffer_load_dwordx4 v197, s[24:27], s64 offen lds
    s_add_u32 m0, s69, 47104
    s_add_u32 s65, s65, s58
    buffer_load_dwordx4 v198, s[24:27], s64 offen lds
    s_cbranch_vccz L_SK2
    s_add_u32 m0, s69, 51200
    s_nop 0
    buffer_load_dwordx4 v199, s[24:27], s64 offen lds
L_SK2:
    s_add_u32 m0, s69, 53248
    s_add_u32 s66, s65, 122880
    buffer_load_dwordx4 v200, s[32:35], s65 offen offset:0 lds
    v_lshlrev_b32 v6, 4, v1
    v_mov_b32 v28, 0x3f803f80
    v_mov_b32 v29, 0x3f803f80
    v_mov_b32 v30, 0x3f803f80
    v_mov_b32 v31, 0x3f803f80
    s_add_u32 m0, s69, 60160
    s_nop 0
    buffer_load_dwordx4 v200, s[32:35], s65 offen offset:1280 lds
    v_lshlrev_b32 v2, 2, v5
    v_sub_u32 v3, v4, v2
    v_add_u32 v3, 12, v3
    s_mov_b32 s60, 267390975
    v_bfe_i32 v32, s60, v3, 1
    s_add_u32 m0, s69, 67072
    s_nop 0
    buffer_load_dwordx4 v200, s[32:35], s65 offen offset:2560 lds
    v_and_b32 v32, 0xff800000, v32
    s_mov_b32 s60, 268435440
    v_bfe_i32 v36, s60, v3, 1
    v_and_b32 v36, 0xff800000, v36
    s_mov_b32 s60, 266346495
    s_add_u32 m0, s69, 57344
    s_nop 0
    buffer_load_dwordx4 v200, s[32:35], s66 offen offset:0 lds
    v_bfe_i32 v33, s60, v3, 1
    v_and_b32 v33, 0xff800000, v33
    s_mov_b32 s60, 268435424
    v_bfe_i32 v37, s60, v3, 1
    v_and_b32 v37, 0xff800000, v37
    s_add_u32 m0, s69, 64256
    s_nop 0
    buffer_load_dwordx4 v200, s[32:35], s66 offen offset:1280 lds
    s_mov_b32 s60, 264257535
    v_bfe_i32 v34, s60, v3, 1
    v_and_b32 v34, 0xff800000, v34
    s_mov_b32 s60, 268435392
    v_bfe_i32 v38, s60, v3, 1
    s_add_u32 m0, s69, 71168
    s_nop 0
    buffer_load_dwordx4 v200, s[32:35], s66 offen offset:2560 lds
    v_and_b32 v38, 0xff800000, v38
    s_mov_b32 s60, 260079615
    v_bfe_i32 v35, s60, v3, 1
    v_and_b32 v35, 0xff800000, v35
    s_waitcnt vmcnt(9)
    s_barrier
    s_lshr_b32 s64, 217890, s67
    s_and_b32 s64, s64, 15
    s_add_u32 s64, s64, s68
    s_cmp_ge_u32 s64, 10
    s_cselect_b32 s65, 10, 0
    s_sub_u32 s64, s64, s65
    s_mul_i32 s65, s64, 245760
    s_lshl_b32 s64, s64, 7
    s_add_u32 s64, s64, s57
    s_add_u32 m0, s69, 77824
    s_mov_b32 exec_lo, s70
    buffer_load_dwordx4 v196, s[24:27], s64 offen lds
    s_add_u32 m0, s69, 81920
    s_mov_b32 exec_lo, -1
    buffer_load_dwordx4 v197, s[24:27], s64 offen lds
    s_add_u32 m0, s69, 86016
    s_add_u32 s65, s65, s58
    buffer_load_dwordx4 v198, s[24:27], s64 offen lds
    s_cbranch_vccz L_SK3
    s_add_u32 m0, s69, 90112
    s_nop 0
    buffer_load_dwordx4 v199, s[24:27], s64 offen lds
L_SK3:
    s_add_u32 m0, s69, 92160
    s_add_u32 s66, s65, 122880
    buffer_load_dwordx4 v200, s[32:35], s65 offen offset:0 lds
    s_mov_b32 s60, 268435328
    v_bfe_i32 v39, s60, v3, 1
    v_and_b32 v39, 0xff800000, v39
    v_sub_u32 v2, 13, v3
    v_med3_i32 v2, v2, 0, 2
    s_add_u32 m0, s69, 99072
    s_nop 0
    buffer_load_dwordx4 v200, s[32:35], s65 offen offset:1280 lds
    v_lshlrev_b32 v2, 3, v2
    v_mov_b32 v40, -1
    v_lshrrev_b32 v40, v2, v40
    v_lshrrev_b32 v40, v2, v40
    v_sub_u32 v2, 15, v3
    s_add_u32 m0, s69, 105984
    s_nop 0
    buffer_load_dwordx4 v200, s[32:35], s65 offen offset:2560 lds
    v_med3_i32 v2, v2, 0, 2
    v_lshlrev_b32 v2, 3, v2
    v_mov_b32 v41, -1
    v_lshrrev_b32 v41, v2, v41
    v_lshrrev_b32 v41, v2, v41
    s_add_u32 m0, s69, 96256
    s_nop 0
    buffer_load_dwordx4 v200, s[32:35], s66 offen offset:0 lds
    s_ashr_i32 s60, s56, 31
    s_and_b32 s60, s60, 0xff800000
    v_lshrrev_b32 v2, 3, v1
    v_bfe_i32 v2, 10, v2, 1
    v_and_b32 v2, s60, v2
    s_add_u32 m0, s69, 103168
    s_nop 0
    buffer_load_dwordx4 v200, s[32:35], s66 offen offset:1280 lds
    v_or_b32 v42, v32, v2
    v_or_b32 v43, v33, v2
    v_or_b32 v44, v34, v2
    v_or_b32 v45, v35, v2
    v_mul_u32_u24 v25, 20224, v5
    s_add_u32 m0, s69, 110080
    s_nop 0
    buffer_load_dwordx4 v200, s[32:35], s66 offen offset:2560 lds
    v_add_u32 v25, v25, v6
    v_lshrrev_b32 v24, 5, v1
    v_mul_u32_u24 v24, 19968, v24
    v_add_u32 v24, v24, v6
    v_lshlrev_b32 v26, 4, v4
    s_waitcnt vmcnt(9)
    s_barrier
    s_lshr_b32 s64, 406580, s67
    s_and_b32 s64, s64, 15
    s_add_u32 s64, s64, s68
    s_cmp_ge_u32 s64, 10
    s_cselect_b32 s65, 10, 0
    s_sub_u32 s64, s64, s65
    s_mul_i32 s65, s64, 245760
    s_lshl_b32 s64, s64, 7
    s_add_u32 s64, s64, s57
    s_add_u32 m0, s69, 0
    s_mov_b32 exec_lo, s70
    buffer_load_dwordx4 v196, s[24:27], s64 offen lds
    s_add_u32 m0, s69, 4096
    s_mov_b32 exec_lo, -1
    buffer_load_dwordx4 v197, s[24:27], s64 offen lds
    s_add_u32 m0, s69, 8192
    s_add_u32 s65, s65, s58
    buffer_load_dwordx4 v198, s[24:27], s64 offen lds
    s_cbranch_vccz L_SK4
    s_add_u32 m0, s69, 12288
    s_nop 0
    buffer_load_dwordx4 v199, s[24:27], s64 offen lds
L_SK4:
    s_add_u32 m0, s69, 14336
    s_add_u32 s66, s65, 122880
    buffer_load_dwordx4 v200, s[32:35], s65 offen offset:0 lds
    v_add_u32 v26, 161544, v26
    v_bfe_u32 v2, v1, 2, 2
    v_lshlrev_b32 v2, 7, v2
    v_and_b32 v3, 8, v1
    v_lshl_add_u32 v2, v3, 2, v2
    s_add_u32 m0, s69, 21248
    s_nop 0
    buffer_load_dwordx4 v200, s[32:35], s65 offen offset:1280 lds
    v_and_b32 v3, 3, v1
    v_lshl_add_u32 v2, v3, 3, v2
    v_and_b32 v3, 48, v1
    s_mov_b32 s62, 0xffff
    s_mov_b32 s60, 1140867648
    s_add_u32 m0, s69, 28160
    s_nop 0
    buffer_load_dwordx4 v200, s[32:35], s65 offen offset:2560 lds
    s_mov_b32 s61, 1312836608
    v_lshrrev_b64 v[46:47], v3, s[60:61]
    v_and_or_b32 v9, v46, s62, v2
    s_mov_b32 s60, 977287168
    s_mov_b32 s61, 3489713728
    s_add_u32 m0, s69, 18432
    s_nop 0
    buffer_load_dwordx4 v200, s[32:35], s66 offen offset:0 lds
    v_lshrrev_b64 v[46:47], v3, s[60:61]
    v_and_or_b32 v10, v46, s62, v2
    s_mov_b32 s60, 1409305152
    s_mov_b32 s61, 1916823552
    v_lshrrev_b64 v[46:47], v3, s[60:61]
    s_add_u32 m0, s69, 25344
    s_nop 0
    buffer_load_dwordx4 v200, s[32:35], s66 offen offset:1280 lds
    v_and_or_b32 v11, v46, s62, v2
    s_mov_b32 s60, 3422601792
    s_mov_b32 s61, 3594534912
    v_lshrrev_b64 v[46:47], v3, s[60:61]
    v_and_or_b32 v12, v46, s62, v2
    s_add_u32 m0, s69, 32256
    s_nop 0
    buffer_load_dwordx4 v200, s[32:35], s66 offen offset:2560 lds
    s_mov_b32 s60, 1514166272
    s_mov_b32 s61, 2990583808
    v_lshrrev_b64 v[46:47], v3, s[60:61]
    v_and_or_b32 v13, v46, s62, v2
    s_waitcnt vmcnt(9)
    s_barrier
    s_lshr_b32 s64, 280405, s67
    s_and_b32 s64, s64, 15
    s_add_u32 s64, s64, s68
    s_cmp_ge_u32 s64, 10
    s_cselect_b32 s65, 10, 0
    s_sub_u32 s64, s64, s65
    s_mul_i32 s65, s64, 245760
    s_lshl_b32 s64, s64, 7
    s_add_u32 s64, s64, s57
    s_add_u32 m0, s69, 38912
    s_mov_b32 exec_lo, s70
    buffer_load_dwordx4 v196, s[24:27], s64 offen lds
    s_add_u32 m0, s69, 43008
    s_mov_b32 exec_lo, -1
    buffer_load_dwordx4 v197, s[24:27], s64 offen lds
    s_add_u32 m0, s69, 47104
    s_add_u32 s65, s65, s58
    buffer_load_dwordx4 v198, s[24:27], s64 offen lds
    s_cbranch_vccz L_SK5
    s_add_u32 m0, s69, 51200
    s_nop 0
    buffer_load_dwordx4 v199, s[24:27], s64 offen lds
L_SK5:
    s_add_u32 m0, s69, 53248
    s_add_u32 s66, s65, 122880
    buffer_load_dwordx4 v200, s[32:35], s65 offen offset:0 lds
    s_mov_b32 s60, 2013295616
    s_mov_b32 s61, 2550174272
    v_lshrrev_b64 v[46:47], v3, s[60:61]
    v_and_or_b32 v14, v46, s62, v2
    s_mov_b32 s60, 2080396864
    s_add_u32 m0, s69, 60160
    s_nop 0
    buffer_load_dwordx4 v200, s[32:35], s65 offen offset:1280 lds
    s_mov_b32 s61, 3087046208
    v_lshrrev_b64 v[46:47], v3, s[60:61]
    v_and_or_b32 v15, v46, s62, v2
    v_lshrrev_b32 v2, 3, v1
    v_bitop3_b32 v3, v1, v2, 7 bitop3:0x28
    s_add_u32 m0, s69, 67072
    s_nop 0
    buffer_load_dwordx4 v200, s[32:35], s65 offen offset:2560 lds
    v_mul_u32_u24 v7, 2560, v2
    v_lshl_add_u32 v7, v3, 4, v7
    v_lshrrev_b32 v2, 5, v1
    v_bitop3_b32 v2, v2, v4, 7 bitop3:0x28
    v_lshlrev_b32 v8, 7, v4
    s_add_u32 m0, s69, 57344
    s_nop 0
    buffer_load_dwordx4 v200, s[32:35], s66 offen offset:0 lds
    v_lshl_add_u32 v8, v2, 4, v8
    v_and_b32 v2, 1, v5
    v_lshl_add_u32 v8, v2, 3, v8
    v_bfe_u32 v2, v0, 3, 5
    v_and_b32 v3, 6, v2
    s_add_u32 m0, s69, 64256
    s_nop 0
    buffer_load_dwordx4 v200, s[32:35], s66 offen offset:1280 lds
    v_bitop3_b32 v3, v0, v3, 7 bitop3:0x28
    v_mul_u32_u24 v16, 1280, v2
    v_lshl_add_u32 v16, v3, 4, v16
    s_lshl_b32 s98, s56, 4
    s_mul_i32 s60, s57, 13
    s_add_u32 m0, s69, 71168
    s_nop 0
    buffer_load_dwordx4 v200, s[32:35], s66 offen offset:2560 lds
    s_add_u32 s98, s98, s60
    s_add_u32 s98, s98, 458880
    s_add_u32 s96, s56, 8
    s_mulk_i32 s96, 1408
    s_mul_i32 s60, s57, 1144
    s_waitcnt vmcnt(9)
    s_barrier
    s_lshr_b32 s64, 353640, s67
    s_and_b32 s64, s64, 15
    s_add_u32 s64, s64, s68
    s_cmp_ge_u32 s64, 10
    s_cselect_b32 s65, 10, 0
    s_sub_u32 s64, s64, s65
    s_mul_i32 s65, s64, 245760
    s_lshl_b32 s64, s64, 7
    s_add_u32 s64, s64, s57
    s_add_u32 m0, s69, 77824
    s_mov_b32 exec_lo, s70
    buffer_load_dwordx4 v196, s[24:27], s64 offen lds
    s_add_u32 m0, s69, 81920
    s_mov_b32 exec_lo, -1
    buffer_load_dwordx4 v197, s[24:27], s64 offen lds
    s_add_u32 m0, s69, 86016
    s_add_u32 s65, s65, s58
    buffer_load_dwordx4 v198, s[24:27], s64 offen lds
    s_cbranch_vccz L_SK6
    s_add_u32 m0, s69, 90112
    s_nop 0
    buffer_load_dwordx4 v199, s[24:27], s64 offen lds
L_SK6:
    s_add_u32 m0, s69, 92160
    s_add_u32 s66, s65, 122880
    buffer_load_dwordx4 v200, s[32:35], s65 offen offset:0 lds
    s_add_u32 s96, s96, s60
    s_add_u32 s96, s96, 1048576
    s_and_b32 s62, s2, 1
    s_mulk_i32 s62, 10240
    s_add_u32 s62, s62, s96
    s_add_u32 m0, s69, 99072
    s_nop 0
    buffer_load_dwordx4 v200, s[32:35], s65 offen offset:1280 lds
    s_sub_u32 s63, s54, s53
    s_and_b32 s60, s2, 7
    s_mul_i32 s60, s60, 25
    s_add_u32 s63, s63, s60
    s_mulk_i32 s63, 11520
    s_add_u32 m0, s69, 105984
    s_nop 0
    buffer_load_dwordx4 v200, s[32:35], s65 offen offset:2560 lds
    s_add_u32 s63, s63, 4194304
    v_mul_u32_u24 v2, 392, v4
    v_add_u32 v2, 110464, v2
    v_lshlrev_b32 v3, 3, v5
    s_waitcnt lgkmcnt(0)
    s_add_u32 m0, s69, 96256
    s_nop 0
    buffer_load_dwordx4 v200, s[32:35], s66 offen offset:0 lds
    v_bfe_u32 v20, s4, v3, 8
    v_bfe_u32 v21, s5, v3, 8
    v_add_u32 v20, v20, v2
    v_add_u32 v21, v21, v2
    v_lshrrev_b32 v2, 2, v1
    s_add_u32 m0, s69, 103168
    s_nop 0
    buffer_load_dwordx4 v200, s[32:35], s66 offen offset:1280 lds
    v_mul_u32_u24 v2, 392, v2
    v_add_u32 v2, 110464, v2
    v_add_u32 v23, s7, v2
    v_lshlrev_b32 v3, 3, v1
    v_bfe_u32 v22, s6, v3, 8
    s_add_u32 m0, s69, 110080
    s_nop 0
    buffer_load_dwordx4 v200, s[32:35], s66 offen offset:2560 lds
    v_add_u32 v22, v22, v2
    s_add_u32 s9, s9, s62
    s_add_u32 s10, s10, s62
    s_add_u32 s11, s11, s63
    s_waitcnt vmcnt(9)
    s_barrier
    s_lshr_b32 s64, 489110, s67
    s_and_b32 s64, s64, 15
    s_add_u32 s64, s64, s68
    s_cmp_ge_u32 s64, 10
    s_cselect_b32 s65, 10, 0
    s_sub_u32 s64, s64, s65
    s_mul_i32 s65, s64, 245760
    s_lshl_b32 s64, s64, 7
    s_add_u32 s64, s64, s57
    s_add_u32 m0, s69, 0
    s_mov_b32 exec_lo, s70
    buffer_load_dwordx4 v196, s[24:27], s64 offen lds
    s_add_u32 m0, s69, 4096
    s_mov_b32 exec_lo, -1
    buffer_load_dwordx4 v197, s[24:27], s64 offen lds
    s_add_u32 m0, s69, 8192
    s_add_u32 s65, s65, s58
    buffer_load_dwordx4 v198, s[24:27], s64 offen lds
    s_cbranch_vccz L_SK7
    s_add_u32 m0, s69, 12288
    s_nop 0
    buffer_load_dwordx4 v199, s[24:27], s64 offen lds
L_SK7:
    s_add_u32 m0, s69, 14336
    s_add_u32 s66, s65, 122880
    buffer_load_dwordx4 v200, s[32:35], s65 offen offset:0 lds
    s_add_u32 s12, s12, s63
    s_add_u32 s5, s9, 40960
    s_mul_i32 s60, s8, 20480
    s_add_u32 s96, s96, s60
    s_lshl4_add_u32 s95, s8, s56
    s_add_u32 m0, s69, 21248
    s_nop 0
    buffer_load_dwordx4 v200, s[32:35], s65 offen offset:1280 lds
    s_cmp_eq_u32 s8, 6
    s_cselect_b32 s101, 1, 2
    s_cmpk_ge_i32 s95, 1024
    s_cselect_b32 s101, 0, s101
    s_mul_i32 s97, s95, 2560
    s_add_u32 m0, s69, 28160
    s_nop 0
    buffer_load_dwordx4 v200, s[32:35], s65 offen offset:2560 lds
    s_add_u32 s97, s97, s57
    s_add_u32 s97, s97, s58
    s_add_u32 s94, s97, 20480
    s_cmp_eq_u32 s8, 0
    s_cselect_b32 s97, 2146435072, s97
    s_cselect_b32 s61, 2146435072, 0
    s_add_u32 m0, s69, 18432
    s_nop 0
    buffer_load_dwordx4 v200, s[32:35], s66 offen offset:0 lds
    s_and_b32 s60, s53, 2
    s_mul_i32 s22, s60, 204800
    s_sub_u32 s23, 409600, s22
    s_add_u32 s22, s22, s58
    s_add_u32 s23, s23, s58
    s_add_u32 m0, s69, 25344
    s_nop 0
    buffer_load_dwordx4 v200, s[32:35], s66 offen offset:1280 lds
    s_mulk_i32 s60, 5120
    s_sub_u32 s4, s96, s60
    s_add_u32 s4, s4, 10240
    s_add_u32 s96, s96, s60
    s_add_u32 s92, s96, 4096
    s_add_u32 m0, s69, 32256
    s_nop 0
    buffer_load_dwordx4 v200, s[32:35], s66 offen offset:2560 lds
    s_add_u32 s93, s92, 4096
    s_add_u32 s6, s4, 4096
    s_add_u32 s7, s6, 4096
    v_bfe_i32 v2, v1, 3, 1
    s_waitcnt vmcnt(9)
    s_barrier
    s_lshr_b32 s64, 559223, s67
    s_and_b32 s64, s64, 15
    s_add_u32 s64, s64, s68
    s_cmp_ge_u32 s64, 10
    s_cselect_b32 s65, 10, 0
    s_sub_u32 s64, s64, s65
    s_mul_i32 s65, s64, 245760
    s_lshl_b32 s64, s64, 7
    s_add_u32 s64, s64, s57
    s_add_u32 m0, s69, 38912
    s_mov_b32 exec_lo, s70
    buffer_load_dwordx4 v196, s[24:27], s64 offen lds
    s_add_u32 m0, s69, 43008
    s_mov_b32 exec_lo, -1
    buffer_load_dwordx4 v197, s[24:27], s64 offen lds
    s_add_u32 m0, s69, 47104
    s_add_u32 s65, s65, s58
    buffer_load_dwordx4 v198, s[24:27], s64 offen lds
    s_cbranch_vccz L_SK8
    s_add_u32 m0, s69, 51200
    s_nop 0
    buffer_load_dwordx4 v199, s[24:27], s64 offen lds
L_SK8:
    s_add_u32 m0, s69, 53248
    s_add_u32 s66, s65, 122880
    buffer_load_dwordx4 v200, s[32:35], s65 offen offset:0 lds
    v_bfi_b32 v2, v2, 0, s61
    v_or_b32 v27, v2, v6
    s_and_b32 s60, s2, 4
    s_lshl_b32 s60, s60, 8
    s_add_u32 s95, s95, s60
    s_add_u32 m0, s69, 60160
    s_nop 0
    buffer_load_dwordx4 v200, s[32:35], s65 offen offset:1280 lds
    s_lshl_b32 s60, s8, 11
    s_add_u32 s60, s60, 0
    v_add_u32 v8, s60, v8
    s_lshl_b32 s60, s8, 8
    s_add_u32 s60, s60, 161536
    s_add_u32 m0, s69, 67072
    s_nop 0
    buffer_load_dwordx4 v200, s[32:35], s65 offen offset:2560 lds
    v_lshl_add_u32 v17, v4, 4, s60
    ds_read_b32 v202, v19 offset:32
    s_mul_i32 s60, s59, 28
    v_min_u32 v2, 27, v1
    v_add_u32 v2, s60, v2
    s_add_u32 m0, s69, 57344
    s_nop 0
    buffer_load_dwordx4 v200, s[32:35], s66 offen offset:0 lds
    v_lshlrev_b32 v82, 4, v2
    v_add_u32 v82, 161536, v82
    v_add_u32 v2, s56, v2
    v_max_i32 v2, 0, v2
    v_min_u32 v2, 1023, v2
    s_add_u32 m0, s69, 64256
    s_nop 0
    buffer_load_dwordx4 v200, s[32:35], s66 offen offset:1280 lds
    s_and_b32 s60, s2, 4
    s_lshl_b32 s60, s60, 12
    s_add_u32 s60, s60, 16384
    v_lshl_add_u32 v81, v2, 4, s60
    s_lshr_b32 s60, s58, 7
    s_add_u32 m0, s69, 71168
    s_nop 0
    buffer_load_dwordx4 v200, s[32:35], s66 offen offset:2560 lds
    s_movk_i32 s99, 0x3ff
    s_bitset0_b32 s99, s60
    v_lshlrev_b32 v201, 7, v1
    s_waitcnt lgkmcnt(0)
    v_readfirstlane_b32 s52, v202
    s_mul_i32 s60, s59, 448
    s_add_u32 m0, s60, 161536
    s_mov_b64 exec, 0xfffffff
    buffer_load_dwordx4 v81, s[28:31], 0 offen  lds
    s_mov_b64 exec, -1
    s_waitcnt vmcnt(10)
    s_barrier
    s_lshr_b32 s64, 629129, s67
    s_and_b32 s64, s64, 15
    s_add_u32 s64, s64, s68
    s_cmp_ge_u32 s64, 10
    s_cselect_b32 s65, 10, 0
    s_sub_u32 s64, s64, s65
    s_mul_i32 s65, s64, 245760
    s_lshl_b32 s64, s64, 7
    s_add_u32 s64, s64, s57
    s_add_u32 m0, s69, 77824
    s_mov_b32 exec_lo, s70
    buffer_load_dwordx4 v196, s[24:27], s64 offen lds
    s_add_u32 m0, s69, 81920
    s_mov_b32 exec_lo, -1
    buffer_load_dwordx4 v197, s[24:27], s64 offen lds
    s_add_u32 m0, s69, 86016
    s_add_u32 s65, s65, s58
    buffer_load_dwordx4 v198, s[24:27], s64 offen lds
    s_cbranch_vccz L_SK9
    s_add_u32 m0, s69, 90112
    s_nop 0
    buffer_load_dwordx4 v199, s[24:27], s64 offen lds
L_SK9:
    s_add_u32 m0, s69, 92160
    s_add_u32 s66, s65, 122880
    buffer_load_dwordx4 v200, s[32:35], s65 offen offset:0 lds
    s_add_u32 m0, s69, 99072
    s_nop 0
    buffer_load_dwordx4 v200, s[32:35], s65 offen offset:1280 lds
    s_add_u32 m0, s69, 105984
    s_nop 0
    buffer_load_dwordx4 v200, s[32:35], s65 offen offset:2560 lds
    s_add_u32 m0, s69, 96256
    s_nop 0
    buffer_load_dwordx4 v200, s[32:35], s66 offen offset:0 lds
    s_add_u32 m0, s69, 103168
    s_nop 0
    buffer_load_dwordx4 v200, s[32:35], s66 offen offset:1280 lds
    s_add_u32 m0, s69, 110080
    s_nop 0
    buffer_load_dwordx4 v200, s[32:35], s66 offen offset:2560 lds
    s_waitcnt vmcnt(9)
    s_barrier
    ds_read_b128 v[84:87], v82
    s_add_u32 s60, s58, s57
    s_add_u32 m0, s69, 0
    s_nop 0
    buffer_load_dwordx4 v196, s[24:27], s60 offen lds
    s_add_u32 m0, s69, 4096
    s_nop 0
    buffer_load_dwordx4 v197, s[24:27], s60 offen lds
    s_add_u32 m0, s69, 8192
    s_nop 0
    buffer_load_dwordx4 v198, s[24:27], s60 offen lds
    s_cbranch_vccz L_SKX
    s_add_u32 m0, s69, 12288
    s_nop 0
    buffer_load_dwordx4 v199, s[24:27], s60 offen lds
L_SKX:
    s_waitcnt lgkmcnt(0)
L_RC_CHK:
    v_xor_b32 v2, s52, v85
    v_bitop3_b32 v2, v87, s52, v2 bitop3:0xbe
    v_cmp_ne_u32 vcc, 0, v2
    s_cbranch_vccnz L_RC_RETRY
L_RC_OK:
    s_sub_u32 s64, s54, s53
    s_mul_i32 s65, s64, 8192
    s_add_u32 s65, s65, 0
    s_mul_hi_u32 s64, s65, 429496730
    s_mov_b32 s60, 6
    s_lshl_b32 s66, s59, 10
    s_add_u32 s66, s66, 14336
L_WO1:
    s_add_u32 m0, s64, s66
    s_add_u32 s61, s65, s22
    s_add_u32 s64, s64, 4096
    buffer_load_dwordx4 v16, s[40:43], s61 offen lds
    s_add_u32 s65, s65, 40960
    s_cmp_eq_u32 s64, 24576
    s_cselect_b32 s64, 0, s64
    s_cselect_b32 s65, 0, s65
    s_sub_u32 s60, s60, 1
    s_cmp_lg_u32 s60, 0
    s_cbranch_scc1 L_WO1
    s_waitcnt vmcnt(9)
    s_barrier
    s_sub_u32 s64, s54, s53
    s_min_u32 s64, s64, 15
    s_mul_i32 s65, s64, 8192
    s_add_u32 s65, s65, 245760
    s_mul_hi_u32 s64, s65, 429496730
    s_mov_b32 s60, 4
    s_lshl_b32 s66, s59, 10
    s_add_u32 s66, s66, 14336
L_WO2:
    s_add_u32 m0, s64, s66
    s_add_u32 s61, s65, s22
    s_add_u32 s64, s64, 4096
    buffer_load_dwordx4 v16, s[40:43], s61 offen lds
    s_add_u32 s65, s65, 40960
    s_cmp_eq_u32 s64, 40960
    s_cselect_b32 s64, 24576, s64
    s_cselect_b32 s65, 245760, s65
    s_sub_u32 s60, s60, 1
    s_cmp_lg_u32 s60, 0
    s_cbranch_scc1 L_WO2
    s_add_u32 m0, s69, 55296
    s_add_u32 s60, s23, 0
    buffer_load_dwordx4 v16, s[40:43], s60 offen lds
    s_add_u32 m0, s69, 59392
    s_add_u32 s60, s23, 40960
    buffer_load_dwordx4 v16, s[40:43], s60 offen lds
    s_add_u32 m0, s69, 63488
    s_add_u32 s60, s23, 81920
    buffer_load_dwordx4 v16, s[40:43], s60 offen lds
    s_add_u32 m0, s69, 67584
    s_add_u32 s60, s23, 122880
    buffer_load_dwordx4 v16, s[40:43], s60 offen lds
    s_add_u32 m0, s69, 71680
    s_add_u32 s60, s23, 163840
    buffer_load_dwordx4 v16, s[40:43], s60 offen lds
    s_mov_b64 exec, 1
    buffer_load_dwordx4 v[204:207], v6, s[28:31], 0 offen offset:256
    s_mov_b64 exec, -1
    s_waitcnt vmcnt(1)
    s_barrier
    s_setprio 1
    ds_read_b64 v[64:65], v20 offset:6272
    ds_read_b64 v[66:67], v21 offset:6272
    ds_read_b64 v[84:85], v20 offset:6408
    ds_read_b64 v[86:87], v21 offset:6408
    ds_read_b64 v[68:69], v20 offset:12544
    ds_read_b64 v[70:71], v21 offset:12544
    ds_read_b64 v[88:89], v20 offset:12680
    ds_read_b64 v[90:91], v21 offset:12680
    ds_read_b64 v[72:73], v20 offset:18816
    ds_read_b64 v[74:75], v21 offset:18816
    ds_read_b64 v[92:93], v20 offset:18952
    ds_read_b64 v[94:95], v21 offset:18952
    ds_read_b64 v[76:77], v20 offset:25088
    ds_read_b64 v[78:79], v21 offset:25088
    ds_read_b64 v[96:97], v20 offset:25224
    ds_read_b64 v[98:99], v21 offset:25224
    s_mov_b64 exec, 1
    s_waitcnt vmcnt(0)
L_FL_CHK:
    v_xor_b32 v2, s52, v205
    v_bitop3_b32 v2, v207, s52, v2 bitop3:0xbe
    v_cmp_ne_u32 vcc, 0, v2
    s_cbranch_vccnz L_FL_RETRY
L_FL_OK:
    ds_write2_b32 v19, v204, v206 offset0:10 offset1:11
    s_mov_b64 exec, -1
    s_cmp_lg_u32 s8, 6
    s_cbranch_scc1 AL_NOR0
    s_mov_b32 exec_lo, s99
    s_mov_b32 exec_hi, 0
    buffer_load_dword v202, v201, s[28:31], s98 offen sc1
    s_mov_b64 exec, -1
AL_NOR0:
    v_lshl_add_u32 v3, v5, 8, v26
    v_mov_b32 v0, v27
    s_waitcnt lgkmcnt(13)
    v_mfma_f32_16x16x32_bf16 v[120:123], v[84:87], v[64:67], v[42:45]
    s_waitcnt lgkmcnt(9)
    v_mfma_f32_16x16x32_bf16 v[124:127], v[88:91], v[68:71], v[32:35]
    v_mfma_f32_16x16x32_bf16 v[104:107], v[84:87], v[68:71], v[36:39]
    s_waitcnt lgkmcnt(5)
    v_mfma_f32_16x16x32_bf16 v[128:131], v[92:95], v[72:75], v[32:35]
    v_mfma_f32_16x16x32_bf16 v[108:111], v[88:91], v[72:75], v[36:39]
    s_waitcnt lgkmcnt(1)
    v_mfma_f32_16x16x32_bf16 v[132:135], v[96:99], v[76:79], v[32:35]
    v_mfma_f32_16x16x32_bf16 v[112:115], v[92:95], v[76:79], v[36:39]
    ds_read_b32 v27, v3
    ds_read2st64_b32 v[36:37], v26 offset1:1
    ds_read2st64_b32 v[38:39], v26 offset0:2 offset1:3
    ds_read_b64_tr_b16 v[168:169], v22 offset:6536
    ds_read_b64_tr_b16 v[178:179], v23 offset:6272
    ds_read_b64_tr_b16 v[170:171], v22 offset:6536
    ds_read_b64_tr_b16 v[180:181], v23 offset:6272
    ds_read_b64_tr_b16 v[172:173], v22 offset:12808
    ds_read_b64_tr_b16 v[182:183], v23 offset:12544
    ds_read_b64_tr_b16 v[174:175], v22 offset:19080
    ds_read_b64_tr_b16 v[184:185], v23 offset:18816
    ds_read_b64_tr_b16 v[176:177], v22 offset:25352
    ds_read_b64_tr_b16 v[186:187], v23 offset:25088
    s_waitcnt lgkmcnt(13)
    s_cmp_lg_u32 s8, 6
    s_cbranch_scc1 AL_NOR1
    s_mov_b32 exec_lo, s99
    s_mov_b32 exec_hi, 0
    s_waitcnt vmcnt(0)
AL_RD_CHK:
    v_xor_b32 v2, s52, v202
    v_cmp_ne_u32 vcc, 0, v2
    s_cbranch_vccz AL_RD_OK
AL_RD_RETRY:
    s_add_u32 s100, s100, 1
    s_cmp_gt_u32 s100, 20000
    s_cbranch_scc1 AL_RD_OK
    s_sleep 1
    buffer_load_dword v202, v201, s[28:31], s98 offen sc1
    s_waitcnt vmcnt(0)
    s_branch AL_RD_CHK
AL_RD_OK:
    s_mov_b64 exec, -1
AL_NOR1:
    s_barrier
    v_max_f32 v124, v124, v104
    v_max_f32 v125, v125, v105
    v_max_f32 v126, v126, v106
    v_max_f32 v127, v127, v107
    v_max_f32 v128, v128, v108
    v_max_f32 v129, v129, v109
    v_max_f32 v130, v130, v110
    v_max_f32 v131, v131, v111
    v_max_f32 v132, v132, v112
    v_max_f32 v133, v133, v113
    v_max_f32 v134, v134, v114
    v_max_f32 v135, v135, v115
    s_cmp_lg_u32 s13, 1
    s_cbranch_scc1 AL_SM
    v_cvt_pk_bf16_f32 v64, v120, v121
    v_mov_b32 v65, s52
    v_cvt_pk_bf16_f32 v66, v122, v123
    v_mov_b32 v67, s52
    buffer_store_dwordx4 v[64:67], v6, s[28:31], s11 offen offset:0 sc1
    v_cvt_pk_bf16_f32 v68, v124, v125
    v_mov_b32 v69, s52
    v_cvt_pk_bf16_f32 v70, v126, v127
    v_mov_b32 v71, s52
    buffer_store_dwordx4 v[68:71], v6, s[28:31], s11 offen offset:1024 sc1
    v_cvt_pk_bf16_f32 v72, v128, v129
    v_mov_b32 v73, s52
    v_cvt_pk_bf16_f32 v74, v130, v131
    v_mov_b32 v75, s52
    buffer_store_dwordx4 v[72:75], v6, s[28:31], s11 offen offset:2048 sc1
    v_cvt_pk_bf16_f32 v76, v132, v133
    v_mov_b32 v77, s52
    v_cvt_pk_bf16_f32 v78, v134, v135
    v_mov_b32 v79, s52
    buffer_store_dwordx4 v[76:79], v6, s[28:31], s11 offen offset:3072 sc1
    s_setprio 0
    s_branch AL_X
AL_SM:
    v_max3_f32 v136, v120, v121, v122
    v_max3_f32 v138, v124, v125, v126
    v_max3_f32 v140, v128, v129, v130
    v_max3_f32 v142, v132, v133, v134
    v_max_f32 v136, v136, v123
    v_max_f32 v138, v138, v127
    v_max_f32 v140, v140, v131
    v_max_f32 v142, v142, v135
    s_nop 0
    v_permlane32_swap_b32 v136, v140
    v_permlane32_swap_b32 v138, v142
    v_max_f32 v136, v136, v140
    v_max_f32 v138, v138, v142
    s_waitcnt lgkmcnt(10)
    v_mul_f32 v27, 0x3ea52b5c, v27
    v_permlane16_swap_b32 v136, v138
    v_max_f32 v136, v136, v138
    v_mul_f32 v138, v136, v27
    v_mul_f32 v136, v136, v27
    v_mul_f32 v32, 0x3ea52b5c, v36
    v_mul_f32 v34, 0x3ea52b5c, v37
    v_permlane16_swap_b32 v136, v138
    v_mov_b32 v140, v136
    v_mov_b32 v142, v138
    v_mul_f32 v36, 0x3ea52b5c, v38
    v_mul_f32 v38, 0x3ea52b5c, v39
    v_permlane32_swap_b32 v136, v140
    v_permlane32_swap_b32 v138, v142
    v_pk_fma_f32 v[120:121], v[120:121], v[32:33], v[136:137] op_sel_hi:[1,0,0] neg_lo:[0,0,1] neg_hi:[0,0,1]
    v_pk_fma_f32 v[122:123], v[122:123], v[32:33], v[136:137] op_sel_hi:[1,0,0] neg_lo:[0,0,1] neg_hi:[0,0,1]
    v_pk_fma_f32 v[124:125], v[124:125], v[34:35], v[138:139] op_sel_hi:[1,0,0] neg_lo:[0,0,1] neg_hi:[0,0,1]
    v_pk_fma_f32 v[126:127], v[126:127], v[34:35], v[138:139] op_sel_hi:[1,0,0] neg_lo:[0,0,1] neg_hi:[0,0,1]
    v_pk_fma_f32 v[128:129], v[128:129], v[36:37], v[140:141] op_sel_hi:[1,0,0] neg_lo:[0,0,1] neg_hi:[0,0,1]
    v_pk_fma_f32 v[130:131], v[130:131], v[36:37], v[140:141] op_sel_hi:[1,0,0] neg_lo:[0,0,1] neg_hi:[0,0,1]
    v_pk_fma_f32 v[132:133], v[132:133], v[38:39], v[142:143] op_sel_hi:[1,0,0] neg_lo:[0,0,1] neg_hi:[0,0,1]
    v_pk_fma_f32 v[134:135], v[134:135], v[38:39], v[142:143] op_sel_hi:[1,0,0] neg_lo:[0,0,1] neg_hi:[0,0,1]
    v_exp_f32 v120, v120
    v_exp_f32 v121, v121
    v_exp_f32 v122, v122
    v_exp_f32 v123, v123
    v_cvt_pk_bf16_f32 v2, v120, v121
    v_cvt_pk_bf16_f32 v3, v122, v123
    v_bfi_b32 v120, v40, 0, v2
    v_bfi_b32 v121, v41, 0, v3
    v_and_b32 v122, v40, v2
    v_and_b32 v123, v41, v3
    s_waitcnt lgkmcnt(0)
    v_exp_f32 v124, v124
    v_mfma_f32_16x16x32_bf16 v[188:191], v[28:31], v[120:123], 0
    v_exp_f32 v125, v125
    v_mfma_f32_16x16x32_bf16 v[136:139], v[168:171], v[120:123], 0
    v_exp_f32 v126, v126
    v_mfma_f32_16x16x32_bf16 v[152:155], v[178:181], v[120:123], 0
    v_exp_f32 v127, v127
    v_cvt_pk_bf16_f32 v2, v124, v125
    v_cvt_pk_bf16_f32 v3, v126, v127
    v_bfi_b32 v124, v40, 0, v2
    v_bfi_b32 v125, v41, 0, v3
    v_and_b32 v126, v40, v2
    v_and_b32 v127, v41, v3
    v_rcp_f32 v32, v188
    v_exp_f32 v128, v128
    v_mfma_f32_16x16x32_bf16 v[192:195], v[28:31], v[124:127], 0
    v_exp_f32 v129, v129
    v_mfma_f32_16x16x32_bf16 v[140:143], v[170:173], v[124:127], 0
    v_exp_f32 v130, v130
    v_mfma_f32_16x16x32_bf16 v[156:159], v[180:183], v[124:127], 0
    v_exp_f32 v131, v131
    v_cvt_pk_bf16_f32 v2, v128, v129
    v_cvt_pk_bf16_f32 v3, v130, v131
    v_bfi_b32 v128, v40, 0, v2
    v_bfi_b32 v129, v41, 0, v3
    v_and_b32 v130, v40, v2
    v_and_b32 v131, v41, v3
    v_rcp_f32 v34, v192
    v_exp_f32 v132, v132
    v_mfma_f32_16x16x32_bf16 v[188:191], v[28:31], v[128:131], 0
    v_exp_f32 v133, v133
    v_mfma_f32_16x16x32_bf16 v[144:147], v[172:175], v[128:131], 0
    v_exp_f32 v134, v134
    v_mfma_f32_16x16x32_bf16 v[160:163], v[182:185], v[128:131], 0
    v_exp_f32 v135, v135
    v_cvt_pk_bf16_f32 v2, v132, v133
    v_cvt_pk_bf16_f32 v3, v134, v135
    v_bfi_b32 v132, v40, 0, v2
    v_bfi_b32 v133, v41, 0, v3
    v_and_b32 v134, v40, v2
    v_and_b32 v135, v41, v3
    v_rcp_f32 v36, v188
    v_mul_f32 v136, v136, v32
    v_mfma_f32_16x16x32_bf16 v[192:195], v[28:31], v[132:135], 0
    v_mul_f32 v137, v137, v32
    v_mfma_f32_16x16x32_bf16 v[148:151], v[174:177], v[132:135], 0
    v_mul_f32 v138, v138, v32
    v_mfma_f32_16x16x32_bf16 v[164:167], v[184:187], v[132:135], 0
    v_mul_f32 v139, v139, v32
    v_cvt_pk_bf16_f32 v136, v136, v137
    v_cvt_pk_bf16_f32 v137, v138, v139
    v_mul_f32 v140, v140, v34
    v_mul_f32 v141, v141, v34
    v_mul_f32 v142, v142, v34
    v_mul_f32 v143, v143, v34
    v_cvt_pk_bf16_f32 v138, v140, v141
    v_cvt_pk_bf16_f32 v139, v142, v143
    v_rcp_f32 v38, v192
    v_pk_mul_f32 v[144:145], v[144:145], v[36:37] op_sel_hi:[1,0]
    v_pk_mul_f32 v[146:147], v[146:147], v[36:37] op_sel_hi:[1,0]
    v_permlane32_swap_b32 v136, v138
    v_permlane32_swap_b32 v137, v139
    v_pk_mul_f32 v[148:149], v[148:149], v[38:39] op_sel_hi:[1,0]
    v_pk_mul_f32 v[150:151], v[150:151], v[38:39] op_sel_hi:[1,0]
    v_cvt_pk_bf16_f32 v144, v144, v145
    v_cvt_pk_bf16_f32 v145, v146, v147
    v_cvt_pk_bf16_f32 v146, v148, v149
    v_cvt_pk_bf16_f32 v147, v150, v151
    s_mov_b64 exec, s[14:15]
    buffer_store_dwordx4 v[136:139], v24, s[28:31], s9 offen sc1
    s_mov_b64 exec, -1
    v_permlane32_swap_b32 v144, v146
    v_permlane32_swap_b32 v145, v147
    v_pk_mul_f32 v[152:153], v[152:153], v[32:33] op_sel_hi:[1,0]
    v_pk_mul_f32 v[154:155], v[154:155], v[32:33] op_sel_hi:[1,0]
    s_mov_b64 exec, s[16:17]
    buffer_store_dwordx4 v[144:147], v24, s[28:31], s5 offen sc1
    s_lshl_b64 exec, -1, 16
    v_pk_mul_f32 v[152:153], v[156:157], v[34:35] op_sel_hi:[1,0]
    v_pk_mul_f32 v[154:155], v[158:159], v[34:35] op_sel_hi:[1,0]
    s_lshl_b64 exec, -1, 32
    v_pk_mul_f32 v[152:153], v[160:161], v[36:37] op_sel_hi:[1,0]
    v_pk_mul_f32 v[154:155], v[162:163], v[36:37] op_sel_hi:[1,0]
    s_lshl_b64 exec, -1, 48
    v_pk_mul_f32 v[152:153], v[164:165], v[38:39] op_sel_hi:[1,0]
    v_pk_mul_f32 v[154:155], v[166:167], v[38:39] op_sel_hi:[1,0]
    s_mov_b64 exec, s[18:19]
    v_cvt_pk_bf16_f32 v152, v152, v153
    v_cvt_pk_bf16_f32 v153, v154, v155
    buffer_store_dwordx2 v[152:153], v25, s[28:31], s10 offen sc1
    s_mov_b64 exec, -1
    s_branch A_DONE
AC_X:
    s_sub_u32 s64, s54, s53
    s_mul_i32 s65, s64, 8192
    s_add_u32 s65, s65, 204800
    s_mul_hi_u32 s64, s65, 429496730
    s_mov_b32 s60, 5
    s_lshl_b32 s66, s59, 10
    s_add_u32 s66, s66, 55296
AC_WO:
    s_add_u32 m0, s64, s66
    s_add_u32 s61, s65, s23
    s_add_u32 s64, s64, 4096
    buffer_load_dwordx4 v16, s[40:43], s61 offen lds
    s_add_u32 s65, s65, 40960
    s_cmp_eq_u32 s64, 40960
    s_cselect_b32 s64, 20480, s64
    s_cselect_b32 s65, 204800, s65
    s_sub_u32 s60, s60, 1
    s_cmp_lg_u32 s60, 0
    s_cbranch_scc1 AC_WO
    s_call_b64 s[20:21], K_P1
    s_setprio 2
    buffer_load_dwordx4 v[136:139], v6, s[28:31], s12 offen offset:0 sc1
    buffer_load_dwordx4 v[140:143], v6, s[28:31], s12 offen offset:1024 sc1
    buffer_load_dwordx4 v[144:147], v6, s[28:31], s12 offen offset:2048 sc1
    s_call_b64 s[20:21], K_P2
    s_waitcnt vmcnt(0)
AC_MB_CHK:
    v_xor_b32 v2, s52, v137
    v_bitop3_b32 v2, v139, s52, v2 bitop3:0xbe
    v_bitop3_b32 v2, v141, s52, v2 bitop3:0xbe
    v_bitop3_b32 v2, v143, s52, v2 bitop3:0xbe
    v_bitop3_b32 v2, v145, s52, v2 bitop3:0xbe
    v_bitop3_b32 v2, v147, s52, v2 bitop3:0xbe
    v_cmp_ne_u32 vcc, 0, v2
    s_cbranch_vccnz AC_MB_RETRY
AC_MB_OK:
    v_mov_b32 v2, 1
    ds_write_b8 v18, v2 offset:16
    v_lshlrev_b32 v137, 16, v136
    v_and_b32 v136, s55, v136
    v_lshlrev_b32 v139, 16, v138
    v_and_b32 v138, s55, v138
    v_add_f32 v120, v120, v137
    v_add_f32 v121, v121, v136
    v_add_f32 v122, v122, v139
    v_add_f32 v123, v123, v138
    v_lshlrev_b32 v141, 16, v140
    v_and_b32 v140, s55, v140
    v_lshlrev_b32 v143, 16, v142
    v_and_b32 v142, s55, v142
    v_add_f32 v124, v124, v141
    v_add_f32 v125, v125, v140
    v_add_f32 v126, v126, v143
    v_add_f32 v127, v127, v142
    v_lshlrev_b32 v145, 16, v144
    v_and_b32 v144, s55, v144
    v_lshlrev_b32 v147, 16, v146
    v_and_b32 v146, s55, v146
    v_add_f32 v128, v128, v145
    v_add_f32 v129, v129, v144
    v_add_f32 v130, v130, v147
    v_add_f32 v131, v131, v146
    s_branch AC_SM
AL_X:
    s_sub_u32 s64, s54, s53
    s_mul_i32 s65, s64, 8192
    s_add_u32 s65, s65, 204800
    s_mul_hi_u32 s64, s65, 429496730
    s_mov_b32 s60, 5
    s_lshl_b32 s66, s59, 10
    s_add_u32 s66, s66, 55296
AL_WO:
    s_add_u32 m0, s64, s66
    s_add_u32 s61, s65, s23
    s_add_u32 s64, s64, 4096
    buffer_load_dwordx4 v16, s[40:43], s61 offen lds
    s_add_u32 s65, s65, 40960
    s_cmp_eq_u32 s64, 40960
    s_cselect_b32 s64, 20480, s64
    s_cselect_b32 s65, 204800, s65
    s_sub_u32 s60, s60, 1
    s_cmp_lg_u32 s60, 0
    s_cbranch_scc1 AL_WO
    s_call_b64 s[20:21], K_P1
    s_setprio 2
    buffer_load_dwordx4 v[136:139], v6, s[28:31], s12 offen offset:0 sc1
    buffer_load_dwordx4 v[140:143], v6, s[28:31], s12 offen offset:1024 sc1
    buffer_load_dwordx4 v[144:147], v6, s[28:31], s12 offen offset:2048 sc1
    buffer_load_dwordx4 v[148:151], v6, s[28:31], s12 offen offset:3072 sc1
    s_call_b64 s[20:21], K_P2
    s_waitcnt vmcnt(0)
AL_MB_CHK:
    v_xor_b32 v2, s52, v137
    v_bitop3_b32 v2, v139, s52, v2 bitop3:0xbe
    v_bitop3_b32 v2, v141, s52, v2 bitop3:0xbe
    v_bitop3_b32 v2, v143, s52, v2 bitop3:0xbe
    v_bitop3_b32 v2, v145, s52, v2 bitop3:0xbe
    v_bitop3_b32 v2, v147, s52, v2 bitop3:0xbe
    v_bitop3_b32 v2, v149, s52, v2 bitop3:0xbe
    v_bitop3_b32 v2, v151, s52, v2 bitop3:0xbe
    v_cmp_ne_u32 vcc, 0, v2
    s_cbranch_vccnz AL_MB_RETRY
AL_MB_OK:
    v_mov_b32 v2, 1
    ds_write_b8 v18, v2 offset:16
    v_lshlrev_b32 v137, 16, v136
    v_and_b32 v136, s55, v136
    v_lshlrev_b32 v139, 16, v138
    v_and_b32 v138, s55, v138
    v_add_f32 v120, v120, v137
    v_add_f32 v121, v121, v136
    v_add_f32 v122, v122, v139
    v_add_f32 v123, v123, v138
    v_lshlrev_b32 v141, 16, v140
    v_and_b32 v140, s55, v140
    v_lshlrev_b32 v143, 16, v142
    v_and_b32 v142, s55, v142
    v_add_f32 v124, v124, v141
    v_add_f32 v125, v125, v140
    v_add_f32 v126, v126, v143
    v_add_f32 v127, v127, v142
    v_lshlrev_b32 v145, 16, v144
    v_and_b32 v144, s55, v144
    v_lshlrev_b32 v147, 16, v146
    v_and_b32 v146, s55, v146
    v_add_f32 v128, v128, v145
    v_add_f32 v129, v129, v144
    v_add_f32 v130, v130, v147
    v_add_f32 v131, v131, v146
    v_lshlrev_b32 v149, 16, v148
    v_and_b32 v148, s55, v148
    v_lshlrev_b32 v151, 16, v150
    v_and_b32 v150, s55, v150
    v_add_f32 v132, v132, v149
    v_add_f32 v133, v133, v148
    v_add_f32 v134, v134, v151
    v_add_f32 v135, v135, v150
    s_branch AL_SM
K_AUX0:
    s_sub_u32 s56, s2, 200
K_AUX:
    s_lshr_b32 s3, s3, 6
    s_and_b32 s59, s3, 3
    s_mov_b32 s55, 0xffff0000
    s_mov_b32 s100, 0
    v_and_b32 v1, 63, v0
    v_and_b32 v4, 15, v1
    v_lshrrev_b32 v5, 4, v1
    v_mov_b32 v19, 163584
    v_add_u32 v18, s3, v19
    s_mov_b32 s30, 7077888
    s_mov_b32 s31, 0x20000
    s_cmp_ge_u32 s3, 4
    s_cbranch_scc1 K_FC
    s_cmp_lg_u32 s101, 5
    s_cbranch_scc1 FL_SPARE
    s_waitcnt vmcnt(16)
    s_barrier
    s_mov_b32 s70, 4
FL_GU1b:
    s_mov_b32 m0, s69
    s_sub_u32 s70, s70, 1
    buffer_load_dwordx4 v30, s[48:51], s68 offen nt lds
    s_add_u32 m0, s69, 16384
    s_add_u32 s69, s69, 4096
    buffer_load_dwordx4 v30, s[36:39], s68 offen nt lds
    s_add_u32 s68, s68, 110592
    s_and_b32 s60, s70, 3
    s_cselect_b32 s60, 0, 16384
    s_add_u32 s69, s69, s60
    s_cmp_lg_u32 s70, 0
    s_cbranch_scc1 FL_GU1b
    s_barrier
    s_lshl_b32 s69, s59, 10
    s_add_u32 m0, s69, 0
    s_nop 0
    buffer_load_dwordx4 v30, s[48:51], s68 offen nt lds
    s_add_u32 m0, s69, 16384
    s_nop 0
    buffer_load_dwordx4 v30, s[36:39], s68 offen nt lds
    s_add_u32 s68, s68, 110592
    s_add_u32 m0, s69, 4096
    s_nop 0
    buffer_load_dwordx4 v30, s[48:51], s68 offen nt lds
    s_add_u32 m0, s69, 20480
    s_nop 0
    buffer_load_dwordx4 v30, s[36:39], s68 offen nt lds
    s_add_u32 s68, s68, 110592
    s_add_u32 m0, s69, 8192
    s_nop 0
    buffer_load_dwordx4 v30, s[48:51], s68 offen nt lds
    s_add_u32 m0, s69, 24576
    s_nop 0
    buffer_load_dwordx4 v30, s[36:39], s68 offen nt lds
    s_add_u32 s68, s68, 110592
    s_waitcnt vmcnt(14)
    s_barrier
    s_add_u32 m0, s69, 12288
    s_nop 0
    buffer_load_dwordx4 v30, s[48:51], s68 offen nt lds
    s_add_u32 m0, s69, 28672
    s_nop 0
    buffer_load_dwordx4 v30, s[36:39], s68 offen nt lds
    s_add_u32 s68, s68, 110592
    s_waitcnt vmcnt(0)
    s_barrier
    s_branch K_END
FL_SPARE:
    s_waitcnt lgkmcnt(0)
    s_load_dwordx2 s[48:49], s[0:1], 56
    s_load_dwordx2 s[40:41], s[0:1], 16
    s_load_dwordx2 s[32:33], s[0:1], 40
    s_load_dwordx2 s[36:37], s[0:1], 48
    s_mov_b32 s42, 819200
    s_mov_b32 s43, 0x20000
    s_mov_b32 s34, 2211840
    s_mov_b32 s35, 0x20000
    s_mov_b32 s38, 2211840
    s_mov_b32 s39, 0x20000
    s_sub_u32 s64, s56, 32
    s_sub_u32 s65, s56, 3
    s_min_u32 s64, s64, s65
    s_lshl_b32 s64, s64, 7
    s_add_u32 s64, s64, 2211840
    v_lshrrev_b32 v30, 3, v0
    v_mul_u32_u24 v30, 3328, v30
    v_lshl_add_u32 v30, v0, 4, v30
    s_and_b32 s60, s59, 2
    s_lshl_b32 s60, s60, 2
    v_lshl_or_b32 v2, v5, 1, s60
    v_xor_b32 v2, v2, v1
    v_and_b32 v2, 15, v2
    v_lshrrev_b32 v31, 4, v0
    v_mul_u32_u24 v31, 1280, v31
    v_lshl_add_u32 v31, v2, 4, v31
    s_sub_u32 s61, s56, 27
    s_mul_i32 s61, s61, 81920
    v_add_u32 v31, s61, v31
    s_lshl_b32 s63, s59, 10
    s_mov_b32 s50, 2211840
    s_mov_b32 s51, 0x20000
    s_waitcnt lgkmcnt(0)
    s_lshl3_add_u32 s60, s56, s3
    s_lshl_b32 s60, s60, 10
    s_add_u32 s60, s60, 827392
    v_mov_b32 v108, -1
    v_mov_b32 v109, -1
    v_mov_b32 v110, -1
    v_mov_b32 v111, -1
    v_lshlrev_b32 v15, 4, v1
FL_CLR:
    buffer_store_dwordx4 v[108:111], v15, s[28:31], s60 offen sc1
    s_add_u32 s60, s60, 237568
    s_cmp_lt_u32 s60, 3977216
    s_cbranch_scc1 FL_CLR
    s_waitcnt vmcnt(0)
    s_barrier
    s_add_u32 m0, s63, 0
    s_mov_b32 s60, 0
    buffer_load_dwordx4 v31, s[48:51], s60 offen nt lds
    s_add_u32 m0, s63, 4096
    s_mov_b32 s60, 20480
    buffer_load_dwordx4 v31, s[48:51], s60 offen nt lds
    s_add_u32 m0, s63, 8192
    s_mov_b32 s60, 40960
    buffer_load_dwordx4 v31, s[48:51], s60 offen nt lds
    s_add_u32 m0, s63, 12288
    s_mov_b32 s60, 61440
    buffer_load_dwordx4 v31, s[48:51], s60 offen nt lds
    s_add_u32 m0, s63, 16384
    s_mov_b32 s60, 256
    buffer_load_dwordx4 v31, s[48:51], s60 offen nt lds
    s_add_u32 m0, s63, 20480
    s_mov_b32 s60, 20736
    buffer_load_dwordx4 v31, s[48:51], s60 offen nt lds
    s_add_u32 m0, s63, 24576
    s_mov_b32 s60, 41216
    buffer_load_dwordx4 v31, s[48:51], s60 offen nt lds
    s_add_u32 m0, s63, 28672
    s_mov_b32 s60, 61696
    buffer_load_dwordx4 v31, s[48:51], s60 offen nt lds
    s_add_u32 m0, s63, 32768
    s_mov_b32 s60, 512
    buffer_load_dwordx4 v31, s[48:51], s60 offen nt lds
    s_add_u32 m0, s63, 36864
    s_mov_b32 s60, 20992
    buffer_load_dwordx4 v31, s[48:51], s60 offen nt lds
    s_add_u32 m0, s63, 40960
    s_mov_b32 s60, 41472
    buffer_load_dwordx4 v31, s[48:51], s60 offen nt lds
    s_add_u32 m0, s63, 45056
    s_mov_b32 s60, 61952
    buffer_load_dwordx4 v31, s[48:51], s60 offen nt lds
    s_add_u32 m0, s63, 49152
    s_mov_b32 s60, 768
    buffer_load_dwordx4 v31, s[48:51], s60 offen nt lds
    s_add_u32 m0, s63, 53248
    s_mov_b32 s60, 21248
    buffer_load_dwordx4 v31, s[48:51], s60 offen nt lds
    s_add_u32 m0, s63, 57344
    s_mov_b32 s60, 41728
    buffer_load_dwordx4 v31, s[48:51], s60 offen nt lds
    s_add_u32 m0, s63, 61440
    s_mov_b32 s60, 62208
    buffer_load_dwordx4 v31, s[48:51], s60 offen nt lds
    s_add_u32 m0, s63, 65536
    s_mov_b32 s60, 1024
    buffer_load_dwordx4 v31, s[48:51], s60 offen nt lds
    s_add_u32 m0, s63, 69632
    s_mov_b32 s60, 21504
    buffer_load_dwordx4 v31, s[48:51], s60 offen nt lds
    s_add_u32 m0, s63, 73728
    s_mov_b32 s60, 41984
    buffer_load_dwordx4 v31, s[48:51], s60 offen nt lds
    s_add_u32 m0, s63, 77824
    s_mov_b32 s60, 62464
    buffer_load_dwordx4 v31, s[48:51], s60 offen nt lds
    s_sub_u32 s60, s56, 27
    s_mul_i32 s60, s60, 28672
    v_lshlrev_b32 v30, 4, v0
    s_add_u32 m0, s63, 81920
    s_nop 0
    buffer_load_dwordx4 v30, s[40:43], s60 offen lds
    s_add_u32 s60, s60, 4096
    buffer_load_dwordx4 v30, s[40:43], s60 offen lds
    s_add_u32 s60, s60, 4096
    buffer_load_dwordx4 v30, s[40:43], s60 offen lds
    s_add_u32 s60, s60, 4096
    buffer_load_dwordx4 v30, s[40:43], s60 offen lds
    s_add_u32 s60, s60, 4096
    buffer_load_dwordx4 v30, s[40:43], s60 offen lds
    s_add_u32 s60, s60, 4096
    buffer_load_dwordx4 v30, s[40:43], s60 offen lds
    s_add_u32 s60, s60, 4096
    buffer_load_dwordx4 v30, s[40:43], s60 offen lds
    s_add_u32 s60, s60, 4096
    s_waitcnt vmcnt(7)
    s_barrier
    s_branch K_END
K_FC:
    s_waitcnt lgkmcnt(0)
    v_mov_b32 v241, 0x3f803f80
    s_mul_i32 s52, s52, 0x9E3779B1
    s_add_u32 s52, s52, 0x7F4A7C15
    s_or_b32 s52, s52, 1
    v_mov_b32 v245, s52
    v_mov_b32 v247, s52
    s_bfe_u32 s60, s2, 0x10002
    s_lshl4_add_u32 s60, s68, s60
    s_sub_u32 s60, 0xffff, s60
    v_lshlrev_b32 v239, 1, v232
    v_sub_u32 v239, s60, v239
    v_lshlrev_b32 v243, 3, v232
    v_lshlrev_b32 v232, 4, v232
    v_mov_b32 v249, s52
    s_setprio 3
    s_waitcnt vmcnt(3)
    v_dot2_f32_bf16 v233, v212, v241, 0
    v_dot2_f32_bf16 v234, v212, v212, 0
    v_dot2_f32_bf16 v233, v213, v241, v233
    v_dot2_f32_bf16 v234, v213, v213, v234
    v_dot2_f32_bf16 v233, v214, v241, v233
    v_dot2_f32_bf16 v234, v214, v214, v234
    v_dot2_f32_bf16 v233, v215, v241, v233
    v_dot2_f32_bf16 v234, v215, v215, v234
    v_dot2_f32_bf16 v233, v216, v241, v233
    v_dot2_f32_bf16 v234, v216, v216, v234
    v_dot2_f32_bf16 v233, v217, v241, v233
    v_dot2_f32_bf16 v234, v217, v217, v234
    v_dot2_f32_bf16 v233, v218, v241, v233
    v_dot2_f32_bf16 v234, v218, v218, v234
    v_dot2_f32_bf16 v233, v219, v241, v233
    v_dot2_f32_bf16 v234, v219, v219, v234
    v_dot2_f32_bf16 v233, v220, v241, v233
    v_dot2_f32_bf16 v234, v220, v220, v234
    v_dot2_f32_bf16 v233, v221, v241, v233
    v_dot2_f32_bf16 v234, v221, v221, v234
    s_waitcnt vmcnt(0)
    v_dot2_f32_bf16 v235, v212, v222, 0
    v_dot2_f32_bf16 v236, v222, v241, 0
    v_dot2_f32_bf16 v235, v213, v223, v235
    v_dot2_f32_bf16 v236, v223, v241, v236
    v_dot2_f32_bf16 v235, v214, v224, v235
    v_dot2_f32_bf16 v236, v224, v241, v236
    v_dot2_f32_bf16 v235, v215, v225, v235
    v_dot2_f32_bf16 v236, v225, v241, v236
    v_dot2_f32_bf16 v235, v216, v226, v235
    v_dot2_f32_bf16 v236, v226, v241, v236
    v_dot2_f32_bf16 v235, v217, v227, v235
    v_dot2_f32_bf16 v236, v227, v241, v236
    v_dot2_f32_bf16 v235, v218, v228, v235
    v_dot2_f32_bf16 v236, v228, v241, v236
    v_dot2_f32_bf16 v235, v219, v229, v235
    v_dot2_f32_bf16 v236, v229, v241, v236
    v_dot2_f32_bf16 v235, v220, v230, v235
    v_dot2_f32_bf16 v236, v230, v241, v236
    v_dot2_f32_bf16 v235, v221, v231, v235
    v_dot2_f32_bf16 v236, v231, v241, v236
    v_permlane16_swap_b32 v233, v234
    v_add_f32 v233, v233, v234
    s_nop 0
    v_permlane16_swap_b32 v235, v236
    v_add_f32 v235, v235, v236
    v_add_f32_dpp v233, v233, v233 row_ror:8 row_mask:0xf bank_mask:0xf
    s_nop 0
    v_add_f32_dpp v235, v235, v235 row_ror:8 row_mask:0xf bank_mask:0xf
    v_add_f32_dpp v233, v233, v233 row_ror:4 row_mask:0xf bank_mask:0xf
    s_nop 0
    v_add_f32_dpp v235, v235, v235 row_ror:4 row_mask:0xf bank_mask:0xf
    v_add_f32_dpp v233, v233, v233 row_ror:2 row_mask:0xf bank_mask:0xf
    s_nop 0
    v_add_f32_dpp v235, v235, v235 row_ror:2 row_mask:0xf bank_mask:0xf
    v_add_f32_dpp v233, v233, v233 row_ror:1 row_mask:0xf bank_mask:0xf
    s_nop 0
    v_add_f32_dpp v235, v235, v235 row_ror:1 row_mask:0xf bank_mask:0xf
    v_mul_f32 v233, 0x3acccccd, v233
    v_mov_b32 v236, v235
    v_mov_b32 v234, v233
    s_nop 0
    v_permlane16_swap_b32 v235, v236
    v_permlane16_swap_b32 v233, v234
    v_fma_f32 v234, -v233, v233, v234
    v_max_f32 v234, 0, v234
    v_cvt_pk_bf16_f32 v237, v233, v234
    v_lshlrev_b32 v233, 16, v237
    v_and_b32 v234, 0xffff0000, v237
    v_add_f32 v234, 0x3727c5ac, v234
    v_cvt_pk_bf16_f32 v234, v234, v234
    v_lshlrev_b32 v234, 16, v234
    v_sqrt_f32 v234, v234
    v_fma_f32 v235, -v233, v236, v235
    v_cvt_pk_bf16_f32 v234, v234, v234
    v_lshlrev_b32 v234, 16, v234
    v_rcp_f32 v246, v234
    s_mov_b32 exec_lo, 1
    s_mov_b32 exec_hi, 1
    v_mul_f32 v235, v235, v246
    v_xor_b32 v244, 0x80000000, v233
    v_cvt_pk_bf16_f32 v235, v235, v235
    buffer_store_dwordx4 v[244:247], v232, s[28:31], s70 offen sc1
    v_ashrrev_i32 v237, 31, v235
    v_or_b32 v237, 0x80000000, v237
    v_xor_b32 v235, v235, v237
    v_bfi_b32 v248, s55, v235, v239
    buffer_store_dwordx2 v[248:249], v243, s[28:31], s71 offen sc1
    s_mov_b64 exec, -1
    s_cmp_ge_u32 s56, 27
    s_cbranch_scc1 FC_SPARE
    v_bfe_u32 v7, v1, 2, 2
    v_and_b32 v8, 3, v1
    v_lshl_add_u32 v6, v5, 3, v7
    v_bfe_u32 v2, v1, 3, 2
    v_xor_b32 v2, s59, v2
    v_lshlrev_b32 v9, 5, v2
    v_lshl_add_u32 v9, v8, 3, v9
    v_lshl_add_u32 v9, v6, 7, v9
    v_add_u32 v8, 65536, v9
    v_mov_b32 v176, 0x3f803f80
    v_mov_b32 v177, 0x3f803f80
    v_mov_b32 v178, 0x3f803f80
    v_mov_b32 v179, 0x3f803f80
    v_mov_b32 v180, 0x3f803f80
    v_mov_b32 v181, 0x3f803f80
    v_mov_b32 v182, 0x3f803f80
    v_mov_b32 v183, 0x3f803f80
    v_mov_b32 v184, 0x3f803f80
    v_mov_b32 v185, 0x3f803f80
    v_mov_b32 v186, 0x3f803f80
    v_mov_b32 v187, 0x3f803f80
    v_mov_b32 v188, 0x3f803f80
    v_mov_b32 v189, 0x3f803f80
    v_mov_b32 v190, 0x3f803f80
    v_mov_b32 v191, 0x3f803f80
    v_mov_b32 v192, 0x3f803f80
    v_mov_b32 v193, 0x3f803f80
    v_mov_b32 v194, 0x3f803f80
    v_mov_b32 v195, 0x3f803f80
    v_mov_b32 v196, 0x3f803f80
    v_mov_b32 v197, 0x3f803f80
    v_mov_b32 v198, 0x3f803f80
    v_mov_b32 v199, 0x3f803f80
    v_mov_b32 v200, 0x3f803f80
    v_mov_b32 v201, 0x3f803f80
    v_mov_b32 v202, 0x3f803f80
    v_mov_b32 v203, 0x3f803f80
    v_mov_b32 v204, 0x3f803f80
    v_mov_b32 v205, 0x3f803f80
    v_mov_b32 v206, 0x3f803f80
    v_mov_b32 v207, 0x3f803f80
    v_mov_b32 v208, 0x3f803f80
    v_mov_b32 v209, 0x3f803f80
    v_mov_b32 v210, 0x3f803f80
    v_mov_b32 v211, 0x3f803f80
    v_mov_b32 v212, 0x3f803f80
    v_mov_b32 v213, 0x3f803f80
    v_mov_b32 v214, 0x3f803f80
    v_mov_b32 v215, 0x3f803f80
    v_mov_b32 v216, 0x3f803f80
    v_mov_b32 v217, 0x3f803f80
    v_mov_b32 v218, 0x3f803f80
    v_mov_b32 v219, 0x3f803f80
    v_mov_b32 v220, 0x3f803f80
    v_mov_b32 v221, 0x3f803f80
    v_mov_b32 v222, 0x3f803f80
    v_mov_b32 v223, 0x3f803f80
    v_mov_b32 v224, 0x3f803f80
    v_mov_b32 v225, 0x3f803f80
    v_mov_b32 v226, 0x3f803f80
    v_mov_b32 v227, 0x3f803f80
    v_mov_b32 v228, 0x3f803f80
    v_mov_b32 v229, 0x3f803f80
    v_mov_b32 v230, 0x3f803f80
    v_mov_b32 v231, 0x3f803f80
    v_mov_b32 v232, 0x3f803f80
    v_mov_b32 v233, 0x3f803f80
    v_mov_b32 v234, 0x3f803f80
    v_mov_b32 v235, 0x3f803f80
    v_mov_b32 v236, 0x3f803f80
    v_mov_b32 v237, 0x3f803f80
    v_mov_b32 v238, 0x3f803f80
    v_mov_b32 v239, 0x3f803f80
    v_mov_b32 v240, 0x3f803f80
    v_mov_b32 v241, 0x3f803f80
    v_mov_b32 v242, 0x3f803f80
    v_mov_b32 v243, 0x3f803f80
    v_mov_b32 v244, 0x3f803f80
    v_mov_b32 v245, 0x3f803f80
    v_mov_b32 v246, 0x3f803f80
    v_mov_b32 v247, 0x3f803f80
    v_mov_b32 v248, 0x3f803f80
    v_mov_b32 v249, 0x3f803f80
    v_mov_b32 v250, 0x3f803f80
    v_mov_b32 v251, 0x3f803f80
    v_mov_b32 v252, 0x3f803f80
    v_mov_b32 v253, 0x3f803f80
    v_mov_b32 v254, 0x3f803f80
    v_mov_b32 v255, 0x3f803f80
    s_lshl2_add_u32 s65, s56, s59
    s_min_u32 s61, s65, 79
    s_lshl_b32 s61, s61, 3
    v_and_b32 v13, 7, v1
    v_add_u32 v13, s61, v13
    v_lshlrev_b32 v11, 1, v13
    v_bfe_i32 v17, v1, 0, 1
    v_bfe_u32 v6, v0, 4, 4
    v_lshlrev_b32 v6, 3, v6
    v_add_u32 v6, 157952, v6
    v_lshlrev_b32 v7, 3, v4
    v_add_u32 v7, 157952, v7
    s_barrier
    v_lshlrev_b32 v12, 4, v1
    s_lshl_b32 s62, s59, 12
    s_add_u32 s60, s62, 49152
    buffer_load_dwordx4 v[120:123], v12, s[28:31], s60 offen offset:0 sc1
    buffer_load_dwordx4 v[124:127], v12, s[28:31], s60 offen offset:1024 sc1
    buffer_load_dwordx4 v[128:131], v12, s[28:31], s60 offen offset:2048 sc1
    buffer_load_dwordx4 v[132:135], v12, s[28:31], s60 offen offset:3072 sc1
    ds_read_b64_tr_b16 v[24:25], v9 offset:0
    ds_read_b64_tr_b16 v[26:27], v9 offset:512
    ds_read_b64_tr_b16 v[72:73], v9 offset:16384
    ds_read_b64_tr_b16 v[74:75], v9 offset:16896
    ds_read_b64_tr_b16 v[28:29], v9 offset:4096
    ds_read_b64_tr_b16 v[30:31], v9 offset:4608
    ds_read_b64_tr_b16 v[76:77], v9 offset:20480
    ds_read_b64_tr_b16 v[78:79], v9 offset:20992
    ds_read_b64_tr_b16 v[32:33], v9 offset:8192
    ds_read_b64_tr_b16 v[34:35], v9 offset:8704
    ds_read_b64_tr_b16 v[80:81], v9 offset:24576
    ds_read_b64_tr_b16 v[82:83], v9 offset:25088
    ds_read_b64_tr_b16 v[36:37], v9 offset:12288
    ds_read_b64_tr_b16 v[38:39], v9 offset:12800
    ds_read_b64_tr_b16 v[84:85], v9 offset:28672
    ds_read_b64_tr_b16 v[86:87], v9 offset:29184
    s_waitcnt lgkmcnt(0)
    s_barrier
    s_waitcnt vmcnt(0)
FC_KY_CHK:
    v_xor_b32 v2, s52, v121
    v_bitop3_b32 v2, v123, s52, v2 bitop3:0xbe
    v_bitop3_b32 v2, v125, s52, v2 bitop3:0xbe
    v_bitop3_b32 v2, v127, s52, v2 bitop3:0xbe
    v_bitop3_b32 v2, v129, s52, v2 bitop3:0xbe
    v_bitop3_b32 v2, v131, s52, v2 bitop3:0xbe
    v_bitop3_b32 v2, v133, s52, v2 bitop3:0xbe
    v_bitop3_b32 v2, v135, s52, v2 bitop3:0xbe
    v_cmp_ne_u32 vcc, 0, v2
    s_cbranch_vccz FC_KY_OK
FC_KY_RETRY:
    s_add_u32 s100, s100, 1
    s_cmp_gt_u32 s100, 20000
    s_cbranch_scc1 FC_KY_OK
    s_sleep 16
    s_add_u32 s60, s62, 49152
    buffer_load_dwordx4 v[120:123], v12, s[28:31], s60 offen offset:0 sc1
    buffer_load_dwordx4 v[124:127], v12, s[28:31], s60 offen offset:1024 sc1
    buffer_load_dwordx4 v[128:131], v12, s[28:31], s60 offen offset:2048 sc1
    buffer_load_dwordx4 v[132:135], v12, s[28:31], s60 offen offset:3072 sc1
    s_waitcnt vmcnt(0)
    s_branch FC_KY_CHK
FC_KY_OK:
    v_max_u32 v20, v120, v122
    v_min_u32 v21, v120, v122
    v_med3_u32 v21, v20, v21, v124
    v_max_u32 v20, v20, v124
    v_med3_u32 v21, v20, v21, v126
    v_max_u32 v20, v20, v126
    v_med3_u32 v21, v20, v21, v128
    v_max_u32 v20, v20, v128
    v_med3_u32 v21, v20, v21, v130
    v_max_u32 v20, v20, v130
    v_med3_u32 v21, v20, v21, v132
    v_max_u32 v20, v20, v132
    v_med3_u32 v21, v20, v21, v134
    v_max_u32 v20, v20, v134
    s_nop 1
    v_mov_b32_dpp v22, v20 row_ror:8 row_mask:0xf bank_mask:0xf
    v_mov_b32_dpp v23, v21 row_ror:8 row_mask:0xf bank_mask:0xf
    v_min_u32 v2, v20, v22
    v_max_u32 v20, v20, v22
    v_max3_u32 v21, v21, v23, v2
    s_nop 0
    v_mov_b32_dpp v22, v20 row_ror:4 row_mask:0xf bank_mask:0xf
    v_mov_b32_dpp v23, v21 row_ror:4 row_mask:0xf bank_mask:0xf
    v_min_u32 v2, v20, v22
    v_max_u32 v20, v20, v22
    v_max3_u32 v21, v21, v23, v2
    s_nop 0
    v_mov_b32_dpp v22, v20 row_ror:2 row_mask:0xf bank_mask:0xf
    v_mov_b32_dpp v23, v21 row_ror:2 row_mask:0xf bank_mask:0xf
    v_min_u32 v2, v20, v22
    v_max_u32 v20, v20, v22
    v_max3_u32 v21, v21, v23, v2
    s_nop 0
    v_mov_b32_dpp v22, v20 row_ror:1 row_mask:0xf bank_mask:0xf
    v_mov_b32_dpp v23, v21 row_ror:1 row_mask:0xf bank_mask:0xf
    v_min_u32 v2, v20, v22
    v_max_u32 v20, v20, v22
    v_max3_u32 v21, v21, v23, v2
    ds_write_b64 v6, v[20:21]
    s_waitcnt lgkmcnt(0)
    s_barrier
    ds_read_b64 v[20:21], v7
    s_waitcnt lgkmcnt(0)
    v_mov_b32_dpp v22, v20 row_ror:8 row_mask:0xf bank_mask:0xf
    v_mov_b32_dpp v23, v21 row_ror:8 row_mask:0xf bank_mask:0xf
    v_min_u32 v2, v20, v22
    v_max_u32 v20, v20, v22
    v_max3_u32 v21, v21, v23, v2
    s_nop 0
    v_mov_b32_dpp v22, v20 row_ror:4 row_mask:0xf bank_mask:0xf
    v_mov_b32_dpp v23, v21 row_ror:4 row_mask:0xf bank_mask:0xf
    v_min_u32 v2, v20, v22
    v_max_u32 v20, v20, v22
    v_max3_u32 v21, v21, v23, v2
    s_nop 0
    v_mov_b32_dpp v22, v20 row_ror:2 row_mask:0xf bank_mask:0xf
    v_mov_b32_dpp v23, v21 row_ror:2 row_mask:0xf bank_mask:0xf
    v_min_u32 v2, v20, v22
    v_max_u32 v20, v20, v22
    v_max3_u32 v21, v21, v23, v2
    s_nop 0
    v_mov_b32_dpp v22, v20 row_ror:1 row_mask:0xf bank_mask:0xf
    v_mov_b32_dpp v23, v21 row_ror:1 row_mask:0xf bank_mask:0xf
    v_min_u32 v2, v20, v22
    v_max_u32 v20, v20, v22
    v_max3_u32 v21, v21, v23, v2
    v_bfi_b32 v10, v17, v21, v20
    v_not_b32 v2, v10
    v_and_b32 v2, 2047, v2
    v_mul_u32_u24 v17, 1280, v2
    v_lshrrev_b32 v16, 1, v2
    v_and_b32 v3, 1, v2
    v_lshl_add_u32 v16, v3, 10, v16
    v_readlane_b32 s60, v17, 0
    v_readlane_b32 s61, v17, 1
    v_lshlrev_b32 v16, 4, v16
    v_add_u32 v16, 16384, v16
    s_mul_i32 s62, s59, 2624
    s_add_u32 s62, s62, 147456
    s_add_u32 m0, s62, 0
    s_nop 0
    buffer_load_dwordx4 v12, s[24:27], s60 offen lds
    s_add_u32 m0, s62, 1344
    s_nop 0
    buffer_load_dwordx4 v12, s[24:27], s61 offen lds
    s_mov_b64 exec, 0xffff
    s_add_u32 m0, s62, 0
    s_nop 0
    buffer_load_dwordx4 v12, s[24:27], s60 offen offset:1024 lds
    s_add_u32 m0, s62, 1344
    s_nop 0
    buffer_load_dwordx4 v12, s[24:27], s61 offen offset:1024 lds
    s_mov_b32 exec_lo, 0x00030003
    s_mov_b32 exec_hi, 0x00030003
    buffer_load_dwordx4 v[20:23], v16, s[28:31], 0 offen
    s_mov_b64 exec, -1
    buffer_load_ushort v14, v11, s[24:27], s60 offen
    buffer_load_ushort v15, v11, s[24:27], s61 offen
    v_ashrrev_i32 v2, 31, v10
    v_not_b32 v2, v2
    v_or_b32 v2, 0x80000000, v2
    v_xor_b32 v10, v10, v2
    v_and_b32 v10, 0xffff0000, v10
    v_and_b32 v17, 1, v1
    v_mul_u32_u24 v17, 1344, v17
    v_lshl_add_u32 v17, v5, 4, v17
    v_add_u32 v17, s62, v17
    ds_read_b64_tr_b16 v[40:41], v9 offset:32768
    ds_read_b64_tr_b16 v[42:43], v9 offset:33280
    ds_read_b64_tr_b16 v[88:89], v9 offset:49152
    ds_read_b64_tr_b16 v[90:91], v9 offset:49664
    ds_read_b64_tr_b16 v[44:45], v9 offset:36864
    ds_read_b64_tr_b16 v[46:47], v9 offset:37376
    ds_read_b64_tr_b16 v[92:93], v9 offset:53248
    ds_read_b64_tr_b16 v[94:95], v9 offset:53760
    ds_read_b64_tr_b16 v[48:49], v9 offset:40960
    ds_read_b64_tr_b16 v[50:51], v9 offset:41472
    ds_read_b64_tr_b16 v[96:97], v9 offset:57344
    ds_read_b64_tr_b16 v[98:99], v9 offset:57856
    ds_read_b64_tr_b16 v[52:53], v9 offset:45056
    ds_read_b64_tr_b16 v[54:55], v9 offset:45568
    ds_read_b64_tr_b16 v[100:101], v9 offset:61440
    ds_read_b64_tr_b16 v[102:103], v9 offset:61952
    ds_read_b64_tr_b16 v[56:57], v8 offset:0
    ds_read_b64_tr_b16 v[58:59], v8 offset:512
    ds_read_b64_tr_b16 v[104:105], v8 offset:16384
    ds_read_b64_tr_b16 v[106:107], v8 offset:16896
    ds_read_b64_tr_b16 v[60:61], v8 offset:4096
    ds_read_b64_tr_b16 v[62:63], v8 offset:4608
    ds_read_b64_tr_b16 v[108:109], v8 offset:20480
    ds_read_b64_tr_b16 v[110:111], v8 offset:20992
    ds_read_b64_tr_b16 v[64:65], v8 offset:8192
    ds_read_b64_tr_b16 v[66:67], v8 offset:8704
    ds_read_b64_tr_b16 v[112:113], v8 offset:24576
    ds_read_b64_tr_b16 v[114:115], v8 offset:25088
    ds_read_b64_tr_b16 v[68:69], v8 offset:12288
    ds_read_b64_tr_b16 v[70:71], v8 offset:12800
    ds_read_b64_tr_b16 v[116:117], v8 offset:28672
    ds_read_b64_tr_b16 v[118:119], v8 offset:29184
    s_waitcnt vmcnt(0)
    s_mov_b32 exec_lo, 0x00030003
    s_mov_b32 exec_hi, 0x00030003
    ds_read_b128 v[176:179], v17 offset:0
    ds_read_b128 v[180:183], v17 offset:64
    ds_read_b128 v[184:187], v17 offset:128
    ds_read_b128 v[188:191], v17 offset:192
    ds_read_b128 v[192:195], v17 offset:256
    ds_read_b128 v[196:199], v17 offset:320
    ds_read_b128 v[200:203], v17 offset:384
    ds_read_b128 v[204:207], v17 offset:448
    ds_read_b128 v[208:211], v17 offset:512
    ds_read_b128 v[212:215], v17 offset:576
    ds_read_b128 v[216:219], v17 offset:640
    ds_read_b128 v[220:223], v17 offset:704
    ds_read_b128 v[224:227], v17 offset:768
    ds_read_b128 v[228:231], v17 offset:832
    ds_read_b128 v[232:235], v17 offset:896
    ds_read_b128 v[236:239], v17 offset:960
    ds_read_b128 v[240:243], v17 offset:1024
    ds_read_b128 v[244:247], v17 offset:1088
    ds_read_b128 v[248:251], v17 offset:1152
    ds_read_b128 v[252:255], v17 offset:1216
    s_mov_b64 exec, -1
    s_waitcnt lgkmcnt(15)
    v_mfma_f32_16x16x32_bf16 v[152:155], v[24:27], v[176:179], 0
    v_mfma_f32_16x16x32_bf16 v[156:159], v[72:75], v[176:179], 0
    v_mfma_f32_16x16x32_bf16 v[152:155], v[28:31], v[180:183], v[152:155]
    v_mfma_f32_16x16x32_bf16 v[156:159], v[76:79], v[180:183], v[156:159]
    v_mfma_f32_16x16x32_bf16 v[152:155], v[32:35], v[184:187], v[152:155]
    v_mfma_f32_16x16x32_bf16 v[156:159], v[80:83], v[184:187], v[156:159]
    v_mfma_f32_16x16x32_bf16 v[152:155], v[36:39], v[188:191], v[152:155]
    v_mfma_f32_16x16x32_bf16 v[156:159], v[84:87], v[188:191], v[156:159]
    s_waitcnt lgkmcnt(12)
    v_mfma_f32_16x16x32_bf16 v[152:155], v[40:43], v[192:195], v[152:155]
    v_mfma_f32_16x16x32_bf16 v[156:159], v[88:91], v[192:195], v[156:159]
    v_mfma_f32_16x16x32_bf16 v[152:155], v[44:47], v[196:199], v[152:155]
    v_mfma_f32_16x16x32_bf16 v[156:159], v[92:95], v[196:199], v[156:159]
    v_mfma_f32_16x16x32_bf16 v[152:155], v[48:51], v[200:203], v[152:155]
    v_mfma_f32_16x16x32_bf16 v[156:159], v[96:99], v[200:203], v[156:159]
    v_mfma_f32_16x16x32_bf16 v[152:155], v[52:55], v[204:207], v[152:155]
    v_mfma_f32_16x16x32_bf16 v[156:159], v[100:103], v[204:207], v[156:159]
    s_waitcnt lgkmcnt(8)
    v_mfma_f32_16x16x32_bf16 v[152:155], v[56:59], v[208:211], v[152:155]
    v_mfma_f32_16x16x32_bf16 v[156:159], v[104:107], v[208:211], v[156:159]
    v_mfma_f32_16x16x32_bf16 v[152:155], v[60:63], v[212:215], v[152:155]
    v_mfma_f32_16x16x32_bf16 v[156:159], v[108:111], v[212:215], v[156:159]
    v_mfma_f32_16x16x32_bf16 v[152:155], v[64:67], v[216:219], v[152:155]
    v_mfma_f32_16x16x32_bf16 v[156:159], v[112:115], v[216:219], v[156:159]
    v_mfma_f32_16x16x32_bf16 v[152:155], v[68:71], v[220:223], v[152:155]
    v_mfma_f32_16x16x32_bf16 v[156:159], v[116:119], v[220:223], v[156:159]
    s_barrier
    ds_read_b64_tr_b16 v[120:121], v8 offset:32768
    ds_read_b64_tr_b16 v[122:123], v8 offset:33280
    ds_read_b64_tr_b16 v[136:137], v8 offset:49152
    ds_read_b64_tr_b16 v[138:139], v8 offset:49664
    ds_read_b64_tr_b16 v[124:125], v8 offset:36864
    ds_read_b64_tr_b16 v[126:127], v8 offset:37376
    ds_read_b64_tr_b16 v[140:141], v8 offset:53248
    ds_read_b64_tr_b16 v[142:143], v8 offset:53760
    ds_read_b64_tr_b16 v[128:129], v8 offset:40960
    ds_read_b64_tr_b16 v[130:131], v8 offset:41472
    ds_read_b64_tr_b16 v[144:145], v8 offset:57344
    ds_read_b64_tr_b16 v[146:147], v8 offset:57856
    ds_read_b64_tr_b16 v[132:133], v8 offset:45056
    ds_read_b64_tr_b16 v[134:135], v8 offset:45568
    ds_read_b64_tr_b16 v[148:149], v8 offset:61440
    ds_read_b64_tr_b16 v[150:151], v8 offset:61952
    ds_read_b64_tr_b16 v[24:25], v9 offset:0
    ds_read_b64_tr_b16 v[26:27], v9 offset:512
    ds_read_b64_tr_b16 v[72:73], v9 offset:16384
    ds_read_b64_tr_b16 v[74:75], v9 offset:16896
    ds_read_b64_tr_b16 v[28:29], v9 offset:4096
    ds_read_b64_tr_b16 v[30:31], v9 offset:4608
    ds_read_b64_tr_b16 v[76:77], v9 offset:20480
    ds_read_b64_tr_b16 v[78:79], v9 offset:20992
    ds_read_b64_tr_b16 v[32:33], v9 offset:8192
    ds_read_b64_tr_b16 v[34:35], v9 offset:8704
    ds_read_b64_tr_b16 v[80:81], v9 offset:24576
    ds_read_b64_tr_b16 v[82:83], v9 offset:25088
    ds_read_b64_tr_b16 v[36:37], v9 offset:12288
    ds_read_b64_tr_b16 v[38:39], v9 offset:12800
    ds_read_b64_tr_b16 v[84:85], v9 offset:28672
    ds_read_b64_tr_b16 v[86:87], v9 offset:29184
    s_waitcnt lgkmcnt(15)
    v_mfma_f32_16x16x32_bf16 v[152:155], v[120:123], v[224:227], v[152:155]
    v_mfma_f32_16x16x32_bf16 v[156:159], v[136:139], v[224:227], v[156:159]
    v_mfma_f32_16x16x32_bf16 v[152:155], v[124:127], v[228:231], v[152:155]
    v_mfma_f32_16x16x32_bf16 v[156:159], v[140:143], v[228:231], v[156:159]
    v_mfma_f32_16x16x32_bf16 v[152:155], v[128:131], v[232:235], v[152:155]
    v_mfma_f32_16x16x32_bf16 v[156:159], v[144:147], v[232:235], v[156:159]
    v_mfma_f32_16x16x32_bf16 v[152:155], v[132:135], v[236:239], v[152:155]
    v_mfma_f32_16x16x32_bf16 v[156:159], v[148:151], v[236:239], v[156:159]
    s_waitcnt lgkmcnt(0)
    v_mfma_f32_16x16x32_bf16 v[152:155], v[24:27], v[240:243], v[152:155]
    v_mfma_f32_16x16x32_bf16 v[156:159], v[72:75], v[240:243], v[156:159]
    v_mfma_f32_16x16x32_bf16 v[152:155], v[28:31], v[244:247], v[152:155]
    v_mfma_f32_16x16x32_bf16 v[156:159], v[76:79], v[244:247], v[156:159]
    v_mfma_f32_16x16x32_bf16 v[152:155], v[32:35], v[248:251], v[152:155]
    v_mfma_f32_16x16x32_bf16 v[156:159], v[80:83], v[248:251], v[156:159]
    v_mfma_f32_16x16x32_bf16 v[152:155], v[36:39], v[252:255], v[152:155]
    v_mfma_f32_16x16x32_bf16 v[156:159], v[84:87], v[252:255], v[156:159]
    s_mov_b32 exec_lo, 0x00030003
    s_mov_b32 exec_hi, 0x00030003
    s_waitcnt vmcnt(0)
FC_RC_CHK:
    v_xor_b32 v2, s52, v21
    v_bitop3_b32 v2, v23, s52, v2 bitop3:0xbe
    v_cmp_ne_u32 vcc, 0, v2
    s_cbranch_vccz FC_RC_OK
FC_RC_RETRY:
    s_add_u32 s100, s100, 1
    s_cmp_gt_u32 s100, 20000
    s_cbranch_scc1 FC_RC_OK
    s_sleep 2
    buffer_load_dwordx4 v[20:23], v16, s[28:31], 0 offen sc1
    s_waitcnt vmcnt(0)
    s_branch FC_RC_CHK
FC_RC_OK:
    v_mov_b32 v21, v10
    s_mov_b64 exec, -1
    v_mov_b32_dpp v160, v152 row_newbcast:2 row_mask:0xf bank_mask:0xf
    v_mov_b32_dpp v164, v156 row_newbcast:2 row_mask:0xf bank_mask:0xf
    v_mov_b32_dpp v161, v153 row_newbcast:2 row_mask:0xf bank_mask:0xf
    v_mov_b32_dpp v165, v157 row_newbcast:2 row_mask:0xf bank_mask:0xf
    v_mov_b32_dpp v162, v154 row_newbcast:2 row_mask:0xf bank_mask:0xf
    v_mov_b32_dpp v166, v158 row_newbcast:2 row_mask:0xf bank_mask:0xf
    v_mov_b32_dpp v163, v155 row_newbcast:2 row_mask:0xf bank_mask:0xf
    v_mov_b32_dpp v167, v159 row_newbcast:2 row_mask:0xf bank_mask:0xf
    v_fma_f32 v152, v20, v160, v152
    v_fma_f32 v156, v20, v164, v156
    v_fma_f32 v153, v20, v161, v153
    v_fma_f32 v157, v20, v165, v157
    v_fma_f32 v154, v20, v162, v154
    v_fma_f32 v158, v20, v166, v158
    v_fma_f32 v155, v20, v163, v155
    v_fma_f32 v159, v20, v167, v159
    v_mul_f32 v152, v152, v22
    v_mul_f32 v156, v156, v22
    v_mul_f32 v153, v153, v22
    v_mul_f32 v157, v157, v22
    v_mul_f32 v154, v154, v22
    v_mul_f32 v158, v158, v22
    v_mul_f32 v155, v155, v22
    v_mul_f32 v159, v159, v22
    v_cvt_pk_bf16_f32 v152, v152, v156
    v_cvt_pk_bf16_f32 v153, v153, v157
    v_cvt_pk_bf16_f32 v154, v154, v158
    v_cvt_pk_bf16_f32 v155, v155, v159
    v_and_b32 v156, s55, v152
    v_lshlrev_b32 v152, 16, v152
    v_and_b32 v157, s55, v153
    v_lshlrev_b32 v153, 16, v153
    v_and_b32 v158, s55, v154
    v_lshlrev_b32 v154, 16, v154
    v_and_b32 v159, s55, v155
    v_lshlrev_b32 v155, 16, v155
    v_mul_f32 v160, 0xbfb8aa3b, v152
    v_mul_f32 v161, 0xbfb8aa3b, v153
    v_mul_f32 v162, 0xbfb8aa3b, v154
    v_mul_f32 v163, 0xbfb8aa3b, v155
    v_exp_f32 v160, v160
    v_exp_f32 v161, v161
    v_exp_f32 v162, v162
    v_exp_f32 v163, v163
    v_add_f32 v160, 1.0, v160
    v_add_f32 v161, 1.0, v161
    v_add_f32 v162, 1.0, v162
    v_add_f32 v163, 1.0, v163
    v_rcp_f32 v160, v160
    v_rcp_f32 v161, v161
    v_rcp_f32 v162, v162
    v_rcp_f32 v163, v163
    v_mul_f32 v152, v152, v160
    v_mul_f32 v153, v153, v161
    v_mul_f32 v154, v154, v162
    v_mul_f32 v155, v155, v163
    v_cvt_pk_bf16_f32 v152, v152, v152
    v_cvt_pk_bf16_f32 v153, v153, v153
    v_cvt_pk_bf16_f32 v154, v154, v154
    v_cvt_pk_bf16_f32 v155, v155, v155
    v_lshlrev_b32 v152, 16, v152
    v_lshlrev_b32 v153, 16, v153
    v_lshlrev_b32 v154, 16, v154
    v_lshlrev_b32 v155, 16, v155
    v_mul_f32 v152, v152, v156
    v_mul_f32 v153, v153, v157
    v_mul_f32 v154, v154, v158
    v_mul_f32 v155, v155, v159
    v_cvt_pk_bf16_f32 v152, v152, v153
    v_cvt_pk_bf16_f32 v154, v154, v155
    v_mov_b32 v153, s52
    v_mov_b32 v155, s52
    v_lshlrev_b32 v3, 6, v4
    v_lshl_add_u32 v3, v5, 4, v3
    s_lshl_b32 s60, s65, 7
    s_add_u32 s60, s60, 425984
    s_mov_b32 exec_lo, 0x00030003
    s_mov_b32 exec_hi, 0x00030003
    buffer_store_dwordx4 v[152:155], v3, s[28:31], s60 offen sc1
    s_mov_b64 exec, -1
    s_cmp_ge_u32 s65, 80
    s_cbranch_scc1 K_END
    v_mul_f32 v21, 0xbfb8aa3b, v21
    v_exp_f32 v21, v21
    v_lshrrev_b32 v31, 3, v1
    v_mul_u32_u24 v31, 10240, v31
    v_add_f32 v21, 1.0, v21
    v_rcp_f32 v21, v21
    v_lshl_add_u32 v31, v13, 4, v31
    v_lshlrev_b32 v30, 2, v13
    v_cvt_pk_bf16_f32 v21, v21, v21
    v_lshlrev_b32 v21, 16, v21
    s_nop 0
    v_readlane_b32 s4, v21, 0
    v_lshlrev_b32 v40, 16, v14
    v_readlane_b32 s64, v20, 0
    s_nop 1
    v_add_f32 v40, s64, v40
    v_readlane_b32 s5, v21, 1
    v_lshlrev_b32 v41, 16, v15
    v_readlane_b32 s64, v20, 1
    s_nop 1
    v_add_f32 v41, s64, v41
    v_cvt_pk_bf16_f32 v116, v40, v41
    v_lshlrev_b32 v40, 16, v116
    v_and_b32 v41, s55, v116
    v_readlane_b32 s64, v22, 0
    s_nop 1
    v_mul_f32 v40, s64, v40
    v_readlane_b32 s64, v22, 1
    s_nop 1
    v_mul_f32 v41, s64, v41
    v_cvt_pk_bf16_f32 v116, v40, v41
    v_lshlrev_b32 v40, 16, v116
    v_and_b32 v41, s55, v116
    s_sleep 60
    s_branch R_RUN
FC_SPARE:
    v_bfe_u32 v7, v1, 2, 2
    v_and_b32 v8, 3, v1
    v_and_b32 v3, 1, v5
    v_lshl_or_b32 v12, v3, 2, v7
    v_lshl_add_u32 v6, v5, 3, v7
    v_lshlrev_b32 v13, 8, v6
    v_lshl_add_u32 v13, v8, 3, v13
    s_lshl3_add_u32 s60, s56, s3
    s_lshl_b32 s60, s60, 10
    s_add_u32 s60, s60, 827392
    v_mov_b32 v108, -1
    v_mov_b32 v109, -1
    v_mov_b32 v110, -1
    v_mov_b32 v111, -1
    v_lshlrev_b32 v15, 4, v1
FC_CLR:
    buffer_store_dwordx4 v[108:111], v15, s[28:31], s60 offen sc1
    s_add_u32 s60, s60, 237568
    s_cmp_lt_u32 s60, 3977216
    s_cbranch_scc1 FC_CLR
    s_lshl_b32 s64, s56, 7
    s_add_u32 s64, s64, 4736
    v_mov_b32 v104, s52
    v_mov_b32 v105, s52
    v_mov_b32 v106, s52
    v_mov_b32 v107, s52
    s_waitcnt vmcnt(0)
    s_barrier
    s_cmp_lg_u32 s59, 0
    s_cbranch_scc1 FC_NOFL
    s_mov_b64 exec, 0xff
    buffer_store_dwordx4 v[104:107], v15, s[28:31], s64 offen sc1
    s_mov_b64 exec, -1
FC_NOFL:
    s_lshl2_add_u32 s60, s56, s59
    s_cmp_eq_u32 s60, 221
    s_cbranch_scc1 FC_TOP
    s_cmp_lg_u32 s54, 30
    s_cbranch_scc1 FC_NOWR
    s_and_b32 s60, s2, 4
    s_add_u32 s60, s60, s59
    s_lshl_b32 s60, s60, 12
    s_add_u32 s60, s60, 16384
    buffer_load_dwordx4 v[168:171], v15, s[28:31], s60 offen offset:0
    buffer_load_dwordx4 v[168:171], v15, s[28:31], s60 offen offset:1024
    buffer_load_dwordx4 v[168:171], v15, s[28:31], s60 offen offset:2048
    buffer_load_dwordx4 v[168:171], v15, s[28:31], s60 offen offset:3072
FC_NOWR:
    s_barrier
    s_mul_i32 s60, s59, 10
    s_add_u32 s60, s60, 0
    s_and_b32 s61, s60, 7
    s_lshr_b32 s60, s60, 3
    s_lshl_b32 s60, s60, 14
    v_xor_b32 v2, s61, v12
    v_lshl_add_u32 v2, v2, 5, v13
    v_add_u32 v2, s60, v2
    ds_read_b64_tr_b16 v[24:25], v2 offset:0
    ds_read_b64_tr_b16 v[26:27], v2 offset:1024
    ds_read_b64_tr_b16 v[28:29], v2 offset:8192
    ds_read_b64_tr_b16 v[30:31], v2 offset:9216
    s_mul_i32 s60, s59, 10
    s_add_u32 s60, s60, 1
    s_and_b32 s61, s60, 7
    s_lshr_b32 s60, s60, 3
    s_lshl_b32 s60, s60, 14
    v_xor_b32 v2, s61, v12
    v_lshl_add_u32 v2, v2, 5, v13
    v_add_u32 v2, s60, v2
    ds_read_b64_tr_b16 v[32:33], v2 offset:0
    ds_read_b64_tr_b16 v[34:35], v2 offset:1024
    ds_read_b64_tr_b16 v[36:37], v2 offset:8192
    ds_read_b64_tr_b16 v[38:39], v2 offset:9216
    s_mul_i32 s60, s59, 10
    s_add_u32 s60, s60, 2
    s_and_b32 s61, s60, 7
    s_lshr_b32 s60, s60, 3
    s_lshl_b32 s60, s60, 14
    v_xor_b32 v2, s61, v12
    v_lshl_add_u32 v2, v2, 5, v13
    v_add_u32 v2, s60, v2
    ds_read_b64_tr_b16 v[40:41], v2 offset:0
    ds_read_b64_tr_b16 v[42:43], v2 offset:1024
    ds_read_b64_tr_b16 v[44:45], v2 offset:8192
    ds_read_b64_tr_b16 v[46:47], v2 offset:9216
    s_mul_i32 s60, s59, 10
    s_add_u32 s60, s60, 3
    s_and_b32 s61, s60, 7
    s_lshr_b32 s60, s60, 3
    s_lshl_b32 s60, s60, 14
    v_xor_b32 v2, s61, v12
    v_lshl_add_u32 v2, v2, 5, v13
    v_add_u32 v2, s60, v2
    ds_read_b64_tr_b16 v[48:49], v2 offset:0
    ds_read_b64_tr_b16 v[50:51], v2 offset:1024
    ds_read_b64_tr_b16 v[52:53], v2 offset:8192
    ds_read_b64_tr_b16 v[54:55], v2 offset:9216
    s_mul_i32 s60, s59, 10
    s_add_u32 s60, s60, 4
    s_and_b32 s61, s60, 7
    s_lshr_b32 s60, s60, 3
    s_lshl_b32 s60, s60, 14
    v_xor_b32 v2, s61, v12
    v_lshl_add_u32 v2, v2, 5, v13
    v_add_u32 v2, s60, v2
    ds_read_b64_tr_b16 v[56:57], v2 offset:0
    ds_read_b64_tr_b16 v[58:59], v2 offset:1024
    ds_read_b64_tr_b16 v[60:61], v2 offset:8192
    ds_read_b64_tr_b16 v[62:63], v2 offset:9216
    s_mul_i32 s60, s59, 10
    s_add_u32 s60, s60, 5
    s_and_b32 s61, s60, 7
    s_lshr_b32 s60, s60, 3
    s_lshl_b32 s60, s60, 14
    v_xor_b32 v2, s61, v12
    v_lshl_add_u32 v2, v2, 5, v13
    v_add_u32 v2, s60, v2
    ds_read_b64_tr_b16 v[64:65], v2 offset:0
    ds_read_b64_tr_b16 v[66:67], v2 offset:1024
    ds_read_b64_tr_b16 v[68:69], v2 offset:8192
    ds_read_b64_tr_b16 v[70:71], v2 offset:9216
    s_mul_i32 s60, s59, 10
    s_add_u32 s60, s60, 6
    s_and_b32 s61, s60, 7
    s_lshr_b32 s60, s60, 3
    s_lshl_b32 s60, s60, 14
    v_xor_b32 v2, s61, v12
    v_lshl_add_u32 v2, v2, 5, v13
    v_add_u32 v2, s60, v2
    ds_read_b64_tr_b16 v[72:73], v2 offset:0
    ds_read_b64_tr_b16 v[74:75], v2 offset:1024
    ds_read_b64_tr_b16 v[76:77], v2 offset:8192
    ds_read_b64_tr_b16 v[78:79], v2 offset:9216
    s_mul_i32 s60, s59, 10
    s_add_u32 s60, s60, 7
    s_and_b32 s61, s60, 7
    s_lshr_b32 s60, s60, 3
    s_lshl_b32 s60, s60, 14
    v_xor_b32 v2, s61, v12
    v_lshl_add_u32 v2, v2, 5, v13
    v_add_u32 v2, s60, v2
    ds_read_b64_tr_b16 v[80:81], v2 offset:0
    ds_read_b64_tr_b16 v[82:83], v2 offset:1024
    ds_read_b64_tr_b16 v[84:85], v2 offset:8192
    ds_read_b64_tr_b16 v[86:87], v2 offset:9216
    s_mul_i32 s60, s59, 10
    s_add_u32 s60, s60, 8
    s_and_b32 s61, s60, 7
    s_lshr_b32 s60, s60, 3
    s_lshl_b32 s60, s60, 14
    v_xor_b32 v2, s61, v12
    v_lshl_add_u32 v2, v2, 5, v13
    v_add_u32 v2, s60, v2
    ds_read_b64_tr_b16 v[88:89], v2 offset:0
    ds_read_b64_tr_b16 v[90:91], v2 offset:1024
    ds_read_b64_tr_b16 v[92:93], v2 offset:8192
    ds_read_b64_tr_b16 v[94:95], v2 offset:9216
    s_mul_i32 s60, s59, 10
    s_add_u32 s60, s60, 9
    s_and_b32 s61, s60, 7
    s_lshr_b32 s60, s60, 3
    s_lshl_b32 s60, s60, 14
    v_xor_b32 v2, s61, v12
    v_lshl_add_u32 v2, v2, 5, v13
    v_add_u32 v2, s60, v2
    ds_read_b64_tr_b16 v[96:97], v2 offset:0
    ds_read_b64_tr_b16 v[98:99], v2 offset:1024
    ds_read_b64_tr_b16 v[100:101], v2 offset:8192
    ds_read_b64_tr_b16 v[102:103], v2 offset:9216
    v_lshrrev_b32 v14, 1, v5
    v_lshlrev_b32 v14, 7, v14
    v_and_b32 v2, 1, v1
    v_lshl_add_u32 v14, v2, 6, v14
    v_lshl_add_u32 v14, v3, 5, v14
    s_sub_u32 s63, s56, 27
    s_waitcnt lgkmcnt(0)
    s_cmp_ge_u32 s63, 27
    s_cbranch_scc1 K_END
    s_lshl_b32 s65, s63, 9
    s_add_u32 s65, s65, 425984
    s_mov_b32 exec_lo, 0x33333333
    s_mov_b32 exec_hi, 0x33333333
    buffer_load_dwordx4 v[112:115], v14, s[28:31], s65 offen offset:0 sc1
    buffer_load_dwordx4 v[116:119], v14, s[28:31], s65 offen offset:16 sc1
    buffer_load_dwordx4 v[120:123], v14, s[28:31], s65 offen offset:256 sc1
    buffer_load_dwordx4 v[124:127], v14, s[28:31], s65 offen offset:272 sc1
    s_waitcnt vmcnt(0)
D_H_CHK:
    v_xor_b32 v2, s52, v113
    v_bitop3_b32 v2, v115, s52, v2 bitop3:0xbe
    v_bitop3_b32 v2, v117, s52, v2 bitop3:0xbe
    v_bitop3_b32 v2, v119, s52, v2 bitop3:0xbe
    v_bitop3_b32 v2, v121, s52, v2 bitop3:0xbe
    v_bitop3_b32 v2, v123, s52, v2 bitop3:0xbe
    v_bitop3_b32 v2, v125, s52, v2 bitop3:0xbe
    v_bitop3_b32 v2, v127, s52, v2 bitop3:0xbe
    v_cmp_ne_u32 vcc, 0, v2
    s_cbranch_vccz D_H_OK
D_H_RETRY:
    s_add_u32 s100, s100, 1
    s_cmp_gt_u32 s100, 20000
    s_cbranch_scc1 D_H_OK
    s_sleep 6
    buffer_load_dwordx4 v[112:115], v14, s[28:31], s65 offen offset:0 sc1
    buffer_load_dwordx4 v[116:119], v14, s[28:31], s65 offen offset:16 sc1
    buffer_load_dwordx4 v[120:123], v14, s[28:31], s65 offen offset:256 sc1
    buffer_load_dwordx4 v[124:127], v14, s[28:31], s65 offen offset:272 sc1
    s_waitcnt vmcnt(0)
    s_branch D_H_CHK
D_H_OK:
    s_mov_b64 exec, -1
    v_mov_b32 v132, v112
    v_mov_b32 v133, v114
    v_mov_b32 v134, v116
    v_mov_b32 v135, v118
    v_mov_b32 v136, v120
    v_mov_b32 v137, v122
    v_mov_b32 v138, v124
    v_mov_b32 v139, v126
    v_mfma_f32_16x16x32_bf16 v[176:179], v[132:135], v[24:27], 0
    v_mfma_f32_16x16x32_bf16 v[180:183], v[132:135], v[32:35], 0
    v_mfma_f32_16x16x32_bf16 v[184:187], v[132:135], v[40:43], 0
    v_mfma_f32_16x16x32_bf16 v[188:191], v[132:135], v[48:51], 0
    v_mfma_f32_16x16x32_bf16 v[192:195], v[132:135], v[56:59], 0
    v_mfma_f32_16x16x32_bf16 v[196:199], v[132:135], v[64:67], 0
    v_mfma_f32_16x16x32_bf16 v[200:203], v[132:135], v[72:75], 0
    v_mfma_f32_16x16x32_bf16 v[204:207], v[132:135], v[80:83], 0
    v_mfma_f32_16x16x32_bf16 v[208:211], v[132:135], v[88:91], 0
    v_mfma_f32_16x16x32_bf16 v[212:215], v[132:135], v[96:99], 0
    v_mfma_f32_16x16x32_bf16 v[176:179], v[136:139], v[28:31], v[176:179]
    v_mfma_f32_16x16x32_bf16 v[180:183], v[136:139], v[36:39], v[180:183]
    v_mfma_f32_16x16x32_bf16 v[184:187], v[136:139], v[44:47], v[184:187]
    v_mfma_f32_16x16x32_bf16 v[188:191], v[136:139], v[52:55], v[188:191]
    v_mfma_f32_16x16x32_bf16 v[192:195], v[136:139], v[60:63], v[192:195]
    v_mfma_f32_16x16x32_bf16 v[196:199], v[136:139], v[68:71], v[196:199]
    v_mfma_f32_16x16x32_bf16 v[200:203], v[136:139], v[76:79], v[200:203]
    v_mfma_f32_16x16x32_bf16 v[204:207], v[136:139], v[84:87], v[204:207]
    v_mfma_f32_16x16x32_bf16 v[208:211], v[136:139], v[92:95], v[208:211]
    v_mfma_f32_16x16x32_bf16 v[212:215], v[136:139], v[100:103], v[212:215]
    v_lshlrev_b32 v2, 4, v1
    s_mul_i32 s60, s59, 2560
    s_mul_i32 s61, s63, 10240
    s_add_u32 s60, s60, s61
    s_add_u32 s60, s60, 131072
    v_mov_b32 v141, s52
    v_mov_b32 v143, s52
    v_mov_b32 v145, s52
    v_mov_b32 v147, s52
    v_mov_b32 v149, s52
    v_mov_b32 v151, s52
    s_mov_b32 exec_lo, 0xffff
    s_mov_b32 exec_hi, 0
    v_mov_b32 v140, v176
    v_mov_b32 v142, v177
    v_mov_b32 v144, v192
    v_mov_b32 v146, v193
    v_mov_b32 v148, v208
    v_mov_b32 v150, v209
    s_mov_b32 exec_lo, 0xffff0000
    s_mov_b32 exec_hi, 0
    v_mov_b32 v140, v180
    v_mov_b32 v142, v181
    v_mov_b32 v144, v196
    v_mov_b32 v146, v197
    v_mov_b32 v148, v212
    v_mov_b32 v150, v213
    s_mov_b32 exec_lo, 0
    s_mov_b32 exec_hi, 0xffff
    v_mov_b32 v140, v184
    v_mov_b32 v142, v185
    v_mov_b32 v144, v200
    v_mov_b32 v146, v201
    s_mov_b32 exec_lo, 0
    s_mov_b32 exec_hi, 0xffff0000
    v_mov_b32 v140, v188
    v_mov_b32 v142, v189
    v_mov_b32 v144, v204
    v_mov_b32 v146, v205
    s_mov_b64 exec, -1
    buffer_store_dwordx4 v[140:143], v2, s[28:31], s60 offen offset:0 sc1
    buffer_store_dwordx4 v[144:147], v2, s[28:31], s60 offen offset:1024 sc1
    s_mov_b32 exec_hi, 0
    buffer_store_dwordx4 v[148:151], v2, s[28:31], s60 offen offset:2048 sc1
    s_mov_b64 exec, -1
    s_branch K_END
FC_TOP:
    v_lshlrev_b32 v12, 4, v1
    s_mov_b32 s62, 0
    s_add_u32 s60, s62, 49152
    buffer_load_dwordx4 v[88:91], v12, s[28:31], s60 offen offset:0 sc1
    buffer_load_dwordx4 v[92:95], v12, s[28:31], s60 offen offset:1024 sc1
    buffer_load_dwordx4 v[96:99], v12, s[28:31], s60 offen offset:2048 sc1
    buffer_load_dwordx4 v[100:103], v12, s[28:31], s60 offen offset:3072 sc1
    s_add_u32 s60, s62, 53248
    buffer_load_dwordx4 v[104:107], v12, s[28:31], s60 offen offset:0 sc1
    buffer_load_dwordx4 v[108:111], v12, s[28:31], s60 offen offset:1024 sc1
    buffer_load_dwordx4 v[112:115], v12, s[28:31], s60 offen offset:2048 sc1
    buffer_load_dwordx4 v[116:119], v12, s[28:31], s60 offen offset:3072 sc1
    s_add_u32 s60, s62, 57344
    buffer_load_dwordx4 v[120:123], v12, s[28:31], s60 offen offset:0 sc1
    buffer_load_dwordx4 v[124:127], v12, s[28:31], s60 offen offset:1024 sc1
    buffer_load_dwordx4 v[128:131], v12, s[28:31], s60 offen offset:2048 sc1
    buffer_load_dwordx4 v[132:135], v12, s[28:31], s60 offen offset:3072 sc1
    s_add_u32 s60, s62, 61440
    buffer_load_dwordx4 v[136:139], v12, s[28:31], s60 offen offset:0 sc1
    buffer_load_dwordx4 v[140:143], v12, s[28:31], s60 offen offset:1024 sc1
    buffer_load_dwordx4 v[144:147], v12, s[28:31], s60 offen offset:2048 sc1
    buffer_load_dwordx4 v[148:151], v12, s[28:31], s60 offen offset:3072 sc1
    s_waitcnt vmcnt(0)
T_KY_CHK:
    v_xor_b32 v2, s52, v89
    v_bitop3_b32 v2, v91, s52, v2 bitop3:0xbe
    v_bitop3_b32 v2, v93, s52, v2 bitop3:0xbe
    v_bitop3_b32 v2, v95, s52, v2 bitop3:0xbe
    v_bitop3_b32 v2, v97, s52, v2 bitop3:0xbe
    v_bitop3_b32 v2, v99, s52, v2 bitop3:0xbe
    v_bitop3_b32 v2, v101, s52, v2 bitop3:0xbe
    v_bitop3_b32 v2, v103, s52, v2 bitop3:0xbe
    v_bitop3_b32 v2, v105, s52, v2 bitop3:0xbe
    v_bitop3_b32 v2, v107, s52, v2 bitop3:0xbe
    v_bitop3_b32 v2, v109, s52, v2 bitop3:0xbe
    v_bitop3_b32 v2, v111, s52, v2 bitop3:0xbe
    v_bitop3_b32 v2, v113, s52, v2 bitop3:0xbe
    v_bitop3_b32 v2, v115, s52, v2 bitop3:0xbe
    v_bitop3_b32 v2, v117, s52, v2 bitop3:0xbe
    v_bitop3_b32 v2, v119, s52, v2 bitop3:0xbe
    v_bitop3_b32 v2, v121, s52, v2 bitop3:0xbe
    v_bitop3_b32 v2, v123, s52, v2 bitop3:0xbe
    v_bitop3_b32 v2, v125, s52, v2 bitop3:0xbe
    v_bitop3_b32 v2, v127, s52, v2 bitop3:0xbe
    v_bitop3_b32 v2, v129, s52, v2 bitop3:0xbe
    v_bitop3_b32 v2, v131, s52, v2 bitop3:0xbe
    v_bitop3_b32 v2, v133, s52, v2 bitop3:0xbe
    v_bitop3_b32 v2, v135, s52, v2 bitop3:0xbe
    v_bitop3_b32 v2, v137, s52, v2 bitop3:0xbe
    v_bitop3_b32 v2, v139, s52, v2 bitop3:0xbe
    v_bitop3_b32 v2, v141, s52, v2 bitop3:0xbe
    v_bitop3_b32 v2, v143, s52, v2 bitop3:0xbe
    v_bitop3_b32 v2, v145, s52, v2 bitop3:0xbe
    v_bitop3_b32 v2, v147, s52, v2 bitop3:0xbe
    v_bitop3_b32 v2, v149, s52, v2 bitop3:0xbe
    v_bitop3_b32 v2, v151, s52, v2 bitop3:0xbe
    v_cmp_ne_u32 vcc, 0, v2
    s_cbranch_vccz T_KY_OK
T_KY_RETRY:
    s_add_u32 s100, s100, 1
    s_cmp_gt_u32 s100, 20000
    s_cbranch_scc1 T_KY_OK
    s_sleep 16
    s_add_u32 s60, s62, 49152
    buffer_load_dwordx4 v[88:91], v12, s[28:31], s60 offen offset:0 sc1
    buffer_load_dwordx4 v[92:95], v12, s[28:31], s60 offen offset:1024 sc1
    buffer_load_dwordx4 v[96:99], v12, s[28:31], s60 offen offset:2048 sc1
    buffer_load_dwordx4 v[100:103], v12, s[28:31], s60 offen offset:3072 sc1
    s_add_u32 s60, s62, 53248
    buffer_load_dwordx4 v[104:107], v12, s[28:31], s60 offen offset:0 sc1
    buffer_load_dwordx4 v[108:111], v12, s[28:31], s60 offen offset:1024 sc1
    buffer_load_dwordx4 v[112:115], v12, s[28:31], s60 offen offset:2048 sc1
    buffer_load_dwordx4 v[116:119], v12, s[28:31], s60 offen offset:3072 sc1
    s_add_u32 s60, s62, 57344
    buffer_load_dwordx4 v[120:123], v12, s[28:31], s60 offen offset:0 sc1
    buffer_load_dwordx4 v[124:127], v12, s[28:31], s60 offen offset:1024 sc1
    buffer_load_dwordx4 v[128:131], v12, s[28:31], s60 offen offset:2048 sc1
    buffer_load_dwordx4 v[132:135], v12, s[28:31], s60 offen offset:3072 sc1
    s_add_u32 s60, s62, 61440
    buffer_load_dwordx4 v[136:139], v12, s[28:31], s60 offen offset:0 sc1
    buffer_load_dwordx4 v[140:143], v12, s[28:31], s60 offen offset:1024 sc1
    buffer_load_dwordx4 v[144:147], v12, s[28:31], s60 offen offset:2048 sc1
    buffer_load_dwordx4 v[148:151], v12, s[28:31], s60 offen offset:3072 sc1
    s_waitcnt vmcnt(0)
    s_branch T_KY_CHK
T_KY_OK:
    v_max_u32 v20, v88, v90
    v_min_u32 v21, v88, v90
    v_med3_u32 v21, v20, v21, v92
    v_max_u32 v20, v20, v92
    v_med3_u32 v21, v20, v21, v94
    v_max_u32 v20, v20, v94
    v_med3_u32 v21, v20, v21, v96
    v_max_u32 v20, v20, v96
    v_med3_u32 v21, v20, v21, v98
    v_max_u32 v20, v20, v98
    v_med3_u32 v21, v20, v21, v100
    v_max_u32 v20, v20, v100
    v_med3_u32 v21, v20, v21, v102
    v_max_u32 v20, v20, v102
    v_med3_u32 v21, v20, v21, v104
    v_max_u32 v20, v20, v104
    v_med3_u32 v21, v20, v21, v106
    v_max_u32 v20, v20, v106
    v_med3_u32 v21, v20, v21, v108
    v_max_u32 v20, v20, v108
    v_med3_u32 v21, v20, v21, v110
    v_max_u32 v20, v20, v110
    v_med3_u32 v21, v20, v21, v112
    v_max_u32 v20, v20, v112
    v_med3_u32 v21, v20, v21, v114
    v_max_u32 v20, v20, v114
    v_med3_u32 v21, v20, v21, v116
    v_max_u32 v20, v20, v116
    v_med3_u32 v21, v20, v21, v118
    v_max_u32 v20, v20, v118
    v_med3_u32 v21, v20, v21, v120
    v_max_u32 v20, v20, v120
    v_med3_u32 v21, v20, v21, v122
    v_max_u32 v20, v20, v122
    v_med3_u32 v21, v20, v21, v124
    v_max_u32 v20, v20, v124
    v_med3_u32 v21, v20, v21, v126
    v_max_u32 v20, v20, v126
    v_med3_u32 v21, v20, v21, v128
    v_max_u32 v20, v20, v128
    v_med3_u32 v21, v20, v21, v130
    v_max_u32 v20, v20, v130
    v_med3_u32 v21, v20, v21, v132
    v_max_u32 v20, v20, v132
    v_med3_u32 v21, v20, v21, v134
    v_max_u32 v20, v20, v134
    v_med3_u32 v21, v20, v21, v136
    v_max_u32 v20, v20, v136
    v_med3_u32 v21, v20, v21, v138
    v_max_u32 v20, v20, v138
    v_med3_u32 v21, v20, v21, v140
    v_max_u32 v20, v20, v140
    v_med3_u32 v21, v20, v21, v142
    v_max_u32 v20, v20, v142
    v_med3_u32 v21, v20, v21, v144
    v_max_u32 v20, v20, v144
    v_med3_u32 v21, v20, v21, v146
    v_max_u32 v20, v20, v146
    v_med3_u32 v21, v20, v21, v148
    v_max_u32 v20, v20, v148
    v_med3_u32 v21, v20, v21, v150
    v_max_u32 v20, v20, v150
    s_nop 1
    v_mov_b32_dpp v22, v20 row_ror:8 row_mask:0xf bank_mask:0xf
    v_mov_b32_dpp v23, v21 row_ror:8 row_mask:0xf bank_mask:0xf
    v_min_u32 v2, v20, v22
    v_max_u32 v20, v20, v22
    v_max3_u32 v21, v21, v23, v2
    s_nop 0
    v_mov_b32_dpp v22, v20 row_ror:4 row_mask:0xf bank_mask:0xf
    v_mov_b32_dpp v23, v21 row_ror:4 row_mask:0xf bank_mask:0xf
    v_min_u32 v2, v20, v22
    v_max_u32 v20, v20, v22
    v_max3_u32 v21, v21, v23, v2
    s_nop 0
    v_mov_b32_dpp v22, v20 row_ror:2 row_mask:0xf bank_mask:0xf
    v_mov_b32_dpp v23, v21 row_ror:2 row_mask:0xf bank_mask:0xf
    v_min_u32 v2, v20, v22
    v_max_u32 v20, v20, v22
    v_max3_u32 v21, v21, v23, v2
    s_nop 0
    v_mov_b32_dpp v22, v20 row_ror:1 row_mask:0xf bank_mask:0xf
    v_mov_b32_dpp v23, v21 row_ror:1 row_mask:0xf bank_mask:0xf
    v_min_u32 v2, v20, v22
    v_max_u32 v20, v20, v22
    v_max3_u32 v21, v21, v23, v2
    v_mov_b32 v22, v20
    v_mov_b32 v23, v21
    s_nop 0
    v_permlane16_swap_b32 v20, v22
    v_permlane16_swap_b32 v21, v23
    v_min_u32 v2, v20, v22
    v_max_u32 v20, v20, v22
    v_max3_u32 v21, v21, v23, v2
    v_mov_b32 v22, v20
    v_mov_b32 v23, v21
    s_nop 0
    v_permlane32_swap_b32 v20, v22
    v_permlane32_swap_b32 v21, v23
    v_min_u32 v2, v20, v22
    v_max_u32 v20, v20, v22
    v_max3_u32 v21, v21, v23, v2
    s_mov_b64 exec, 0x1fffffff
    v_lshlrev_b32 v11, 7, v1
    s_movk_i32 s63, 8192
    buffer_load_dword v16, v11, s[28:31], s63 offen sc1
    v_not_b32 v2, v20
    v_bfe_u32 v104, v2, 1, 10
    v_and_b32 v2, 1, v2
    v_lshl_add_u32 v104, v2, 10, v104
    v_not_b32 v2, v21
    v_bfe_u32 v106, v2, 1, 10
    v_and_b32 v2, 1, v2
    v_lshl_add_u32 v106, v2, 10, v106
    s_waitcnt vmcnt(0)
T_FL_CHK:
    v_xor_b32 v2, s52, v16
    v_cmp_ne_u32 vcc, 0, v2
    s_cbranch_vccz T_FL_OK
T_FL_RETRY:
    s_add_u32 s100, s100, 1
    s_cmp_gt_u32 s100, 20000
    s_cbranch_scc1 T_FL_OK
    s_sleep 8
    s_movk_i32 s63, 8192
    buffer_load_dword v16, v11, s[28:31], s63 offen sc1
    s_waitcnt vmcnt(0)
    s_branch T_FL_CHK
T_FL_OK:
    s_mov_b64 exec, 0xff
    buffer_store_dwordx4 v[104:107], v15, s[28:31], 0 offen offset:256 sc1
    s_mov_b64 exec, 1
    buffer_store_dword v105, v15, s[28:31], 0 offen offset:0 sc1
    s_mov_b64 exec, -1
    s_branch K_END
R_RUN:
    v_mov_b32 v76, 0
    v_mov_b32 v77, 0
    v_mov_b32 v78, 0
    v_mov_b32 v79, 0
    s_mov_b64 s[60:61], -1
    s_mov_b64 s[62:63], -1
    s_mov_b64 s[64:65], -1
    s_mov_b64 s[66:67], 0xffffff
    s_mov_b32 s100, 0
R_LOOP:
    s_mov_b64 exec, s[60:61]
    s_cbranch_execz R_NL0
    s_mov_b32 s70, 131072
    buffer_load_dwordx4 v[64:67], v31, s[28:31], s70 offen sc1
R_NL0:
    s_mov_b64 exec, s[62:63]
    s_cbranch_execz R_NL1
    s_mov_b32 s70, 212992
    buffer_load_dwordx4 v[68:71], v31, s[28:31], s70 offen sc1
R_NL1:
    s_mov_b64 exec, s[64:65]
    s_cbranch_execz R_NL2
    s_mov_b32 s70, 294912
    buffer_load_dwordx4 v[72:75], v31, s[28:31], s70 offen sc1
R_NL2:
    s_mov_b64 exec, s[66:67]
    s_cbranch_execz R_NL3
    s_mov_b32 s70, 376832
    buffer_load_dwordx4 v[76:79], v31, s[28:31], s70 offen sc1
R_NL3:
    s_waitcnt vmcnt(0)
    s_mov_b64 exec, s[60:61]
    v_xor_b32 v2, s52, v65
    v_bitop3_b32 v2, v67, s52, v2 bitop3:0xbe
    v_cmp_ne_u32 vcc, 0, v2
    s_nop 0
    s_mov_b64 s[60:61], vcc
    s_mov_b64 exec, s[62:63]
    v_xor_b32 v2, s52, v69
    v_bitop3_b32 v2, v71, s52, v2 bitop3:0xbe
    v_cmp_ne_u32 vcc, 0, v2
    s_nop 0
    s_mov_b64 s[62:63], vcc
    s_mov_b64 exec, s[64:65]
    v_xor_b32 v2, s52, v73
    v_bitop3_b32 v2, v75, s52, v2 bitop3:0xbe
    v_cmp_ne_u32 vcc, 0, v2
    s_nop 0
    s_mov_b64 s[64:65], vcc
    s_mov_b64 exec, s[66:67]
    v_xor_b32 v2, s52, v77
    v_bitop3_b32 v2, v79, s52, v2 bitop3:0xbe
    v_cmp_ne_u32 vcc, 0, v2
    s_nop 0
    s_mov_b64 s[66:67], vcc
    s_or_b64 vcc, s[60:61], s[62:63]
    s_or_b64 vcc, vcc, s[64:65]
    s_or_b64 vcc, vcc, s[66:67]
    s_cbranch_scc0 R_OK
    s_add_u32 s100, s100, 1
    s_cmp_gt_u32 s100, 20000
    s_sleep 8
    s_cbranch_scc0 R_LOOP
R_OK:
    s_mov_b64 exec, -1
    v_add_f32 v64, v64, v68
    v_add_f32 v66, v66, v70
    v_add_f32 v64, v64, v72
    v_add_f32 v66, v66, v74
    v_add_f32 v64, v64, v76
    v_add_f32 v66, v66, v78
    s_nop 0
    v_add_f32_dpp v64, v64, v64 row_ror:8 row_mask:0xf bank_mask:0xf
    v_add_f32_dpp v66, v66, v66 row_ror:8 row_mask:0xf bank_mask:0xf
    v_mov_b32 v84, v64
    v_mov_b32 v85, v66
    s_nop 0
    v_permlane16_swap_b32 v64, v84
    v_permlane16_swap_b32 v66, v85
    v_add_f32 v64, v64, v84
    v_add_f32 v66, v66, v85
    v_mov_b32 v84, v64
    v_mov_b32 v85, v66
    s_nop 0
    v_permlane32_swap_b32 v64, v84
    v_permlane32_swap_b32 v66, v85
    v_add_f32 v64, v64, v84
    v_add_f32 v66, v66, v85
    v_cvt_pk_bf16_f32 v2, v64, v66
    v_lshlrev_b32 v64, 16, v2
    v_and_b32 v66, s55, v2
    v_mul_f32 v64, s4, v64
    v_mul_f32 v66, s5, v66
    v_cvt_pk_bf16_f32 v2, v64, v66
    v_lshlrev_b32 v64, 16, v2
    v_and_b32 v66, s55, v2
    v_add_f32 v40, v40, v64
    v_add_f32 v41, v41, v66
    v_cvt_pk_bf16_f32 v94, v40, v41
    v_lshlrev_b32 v40, 16, v94
    v_and_b32 v41, s55, v94
    v_mul_f32 v84, 0xbfb8aa3b, v40
    v_mul_f32 v85, 0xbfb8aa3b, v41
    v_exp_f32 v84, v84
    v_exp_f32 v85, v85
    v_add_f32 v84, 1.0, v84
    v_add_f32 v85, 1.0, v85
    v_rcp_f32 v84, v84
    v_rcp_f32 v85, v85
    v_mul_f32 v40, v40, v84
    v_mul_f32 v41, v41, v85
    s_nop 0
    v_mov_b32_dpp v84, v40 quad_perm:[1,0,3,2] row_mask:0xf bank_mask:0xf
    v_mov_b32_dpp v85, v41 quad_perm:[1,0,3,2] row_mask:0xf bank_mask:0xf
    v_cvt_pk_bf16_f32 v64, v40, v84
    v_cvt_pk_bf16_f32 v66, v41, v85
    s_mov_b32 s70, 65536
    s_mov_b64 exec, 0x55
    buffer_store_dwordx2 v[64:65], v30, s[28:31], s70 offen offset:0 sc1
    buffer_store_dwordx2 v[66:67], v30, s[28:31], s70 offen offset:2560 sc1
    s_mov_b64 exec, -1
    s_branch K_END
AC_MB_RETRY:
    s_add_u32 s100, s100, 1
    s_cmp_gt_u32 s100, 20000
    s_cbranch_scc1 AC_MB_OK
    s_sleep 2
    buffer_load_dwordx4 v[136:139], v6, s[28:31], s12 offen offset:0 sc1
    buffer_load_dwordx4 v[140:143], v6, s[28:31], s12 offen offset:1024 sc1
    buffer_load_dwordx4 v[144:147], v6, s[28:31], s12 offen offset:2048 sc1
    s_waitcnt vmcnt(0)
    s_branch AC_MB_CHK
G2_R0:
    s_sleep 2
    buffer_load_dwordx4 v[96:99], v0, s[28:31], s96 offen offset:0 sc1
    buffer_load_dwordx4 v[100:103], v31, s[28:31], s96 offen offset:0 sc1
    buffer_load_dwordx4 v[104:107], v0, s[28:31], s96 offen offset:1024 sc1
    buffer_load_dwordx4 v[108:111], v31, s[28:31], s96 offen offset:1024 sc1
    buffer_load_dwordx4 v[112:115], v0, s[28:31], s96 offen offset:2048 sc1
    buffer_load_dwordx4 v[116:119], v31, s[28:31], s96 offen offset:2048 sc1
    buffer_load_dwordx4 v[120:123], v0, s[28:31], s96 offen offset:3072 sc1
    buffer_load_dwordx4 v[124:127], v31, s[28:31], s96 offen offset:3072 sc1
    buffer_load_dwordx4 v[128:131], v0, s[28:31], s92 offen offset:0 sc1
    buffer_load_dwordx4 v[132:135], v31, s[28:31], s92 offen offset:0 sc1
    s_add_u32 s100, s100, 1
    s_cmp_gt_u32 s100, 20000
    s_waitcnt vmcnt(0)
    s_cbranch_scc1 G2_OK0
    v_max3_u32 v2, v96, v97, v98
    v_max3_u32 v3, v99, v100, v101
    v_max3_u32 v2, v2, v102, v103
    v_max_u32 v2, v2, v3
    v_cmp_eq_u32 vcc, -1, v2
    s_cbranch_vccnz G2_R0
    s_branch G2_OK0
G2_R1:
    s_sleep 2
    buffer_load_dwordx4 v[104:107], v0, s[28:31], s96 offen offset:1024 sc1
    buffer_load_dwordx4 v[108:111], v31, s[28:31], s96 offen offset:1024 sc1
    buffer_load_dwordx4 v[112:115], v0, s[28:31], s96 offen offset:2048 sc1
    buffer_load_dwordx4 v[116:119], v31, s[28:31], s96 offen offset:2048 sc1
    buffer_load_dwordx4 v[120:123], v0, s[28:31], s96 offen offset:3072 sc1
    buffer_load_dwordx4 v[124:127], v31, s[28:31], s96 offen offset:3072 sc1
    buffer_load_dwordx4 v[128:131], v0, s[28:31], s92 offen offset:0 sc1
    buffer_load_dwordx4 v[132:135], v31, s[28:31], s92 offen offset:0 sc1
    buffer_load_dwordx4 v[136:139], v0, s[28:31], s92 offen offset:1024 sc1
    buffer_load_dwordx4 v[140:143], v31, s[28:31], s92 offen offset:1024 sc1
    s_add_u32 s100, s100, 1
    s_cmp_gt_u32 s100, 20000
    s_waitcnt vmcnt(0)
    s_cbranch_scc1 G2_OK1
    v_max3_u32 v2, v104, v105, v106
    v_max3_u32 v3, v107, v108, v109
    v_max3_u32 v2, v2, v110, v111
    v_max_u32 v2, v2, v3
    v_cmp_eq_u32 vcc, -1, v2
    s_cbranch_vccnz G2_R1
    s_branch G2_OK1
G2_R2:
    s_sleep 2
    buffer_load_dwordx4 v[112:115], v0, s[28:31], s96 offen offset:2048 sc1
    buffer_load_dwordx4 v[116:119], v31, s[28:31], s96 offen offset:2048 sc1
    buffer_load_dwordx4 v[120:123], v0, s[28:31], s96 offen offset:3072 sc1
    buffer_load_dwordx4 v[124:127], v31, s[28:31], s96 offen offset:3072 sc1
    buffer_load_dwordx4 v[128:131], v0, s[28:31], s92 offen offset:0 sc1
    buffer_load_dwordx4 v[132:135], v31, s[28:31], s92 offen offset:0 sc1
    buffer_load_dwordx4 v[136:139], v0, s[28:31], s92 offen offset:1024 sc1
    buffer_load_dwordx4 v[140:143], v31, s[28:31], s92 offen offset:1024 sc1
    buffer_load_dwordx4 v[144:147], v0, s[28:31], s92 offen offset:2048 sc1
    buffer_load_dwordx4 v[148:151], v31, s[28:31], s92 offen offset:2048 sc1
    s_add_u32 s100, s100, 1
    s_cmp_gt_u32 s100, 20000
    s_waitcnt vmcnt(0)
    s_cbranch_scc1 G2_OK2
    v_max3_u32 v2, v112, v113, v114
    v_max3_u32 v3, v115, v116, v117
    v_max3_u32 v2, v2, v118, v119
    v_max_u32 v2, v2, v3
    v_cmp_eq_u32 vcc, -1, v2
    s_cbranch_vccnz G2_R2
    s_branch G2_OK2
G2_R3:
    s_sleep 2
    buffer_load_dwordx4 v[120:123], v0, s[28:31], s96 offen offset:3072 sc1
    buffer_load_dwordx4 v[124:127], v31, s[28:31], s96 offen offset:3072 sc1
    buffer_load_dwordx4 v[128:131], v0, s[28:31], s92 offen offset:0 sc1
    buffer_load_dwordx4 v[132:135], v31, s[28:31], s92 offen offset:0 sc1
    buffer_load_dwordx4 v[136:139], v0, s[28:31], s92 offen offset:1024 sc1
    buffer_load_dwordx4 v[140:143], v31, s[28:31], s92 offen offset:1024 sc1
    buffer_load_dwordx4 v[144:147], v0, s[28:31], s92 offen offset:2048 sc1
    buffer_load_dwordx4 v[148:151], v31, s[28:31], s92 offen offset:2048 sc1
    buffer_load_dwordx4 v[152:155], v0, s[28:31], s4 offen offset:0 sc1
    buffer_load_dwordx4 v[156:159], v31, s[28:31], s4 offen offset:0 sc1
    s_add_u32 s100, s100, 1
    s_cmp_gt_u32 s100, 20000
    s_waitcnt vmcnt(0)
    s_cbranch_scc1 G2_OK3
    v_max3_u32 v2, v120, v121, v122
    v_max3_u32 v3, v123, v124, v125
    v_max3_u32 v2, v2, v126, v127
    v_max_u32 v2, v2, v3
    v_cmp_eq_u32 vcc, -1, v2
    s_cbranch_vccnz G2_R3
    s_branch G2_OK3
G2_R4:
    s_sleep 2
    buffer_load_dwordx4 v[128:131], v0, s[28:31], s92 offen offset:0 sc1
    buffer_load_dwordx4 v[132:135], v31, s[28:31], s92 offen offset:0 sc1
    buffer_load_dwordx4 v[136:139], v0, s[28:31], s92 offen offset:1024 sc1
    buffer_load_dwordx4 v[140:143], v31, s[28:31], s92 offen offset:1024 sc1
    buffer_load_dwordx4 v[144:147], v0, s[28:31], s92 offen offset:2048 sc1
    buffer_load_dwordx4 v[148:151], v31, s[28:31], s92 offen offset:2048 sc1
    buffer_load_dwordx4 v[152:155], v0, s[28:31], s4 offen offset:0 sc1
    buffer_load_dwordx4 v[156:159], v31, s[28:31], s4 offen offset:0 sc1
    buffer_load_dwordx4 v[96:99], v0, s[28:31], s4 offen offset:1024 sc1
    buffer_load_dwordx4 v[100:103], v31, s[28:31], s4 offen offset:1024 sc1
    s_add_u32 s100, s100, 1
    s_cmp_gt_u32 s100, 20000
    s_waitcnt vmcnt(0)
    s_cbranch_scc1 G2_OK4
    v_max3_u32 v2, v128, v129, v130
    v_max3_u32 v3, v131, v132, v133
    v_max3_u32 v2, v2, v134, v135
    v_max_u32 v2, v2, v3
    v_cmp_eq_u32 vcc, -1, v2
    s_cbranch_vccnz G2_R4
    s_branch G2_OK4
G2_ZA:
    s_waitcnt lgkmcnt(0)
    v_and_b32 v2, v2, v3
    v_cmp_ne_u32 vcc, 0x01010101, v2
    s_cbranch_vccz G2_ZAOK
G2_ZAR:
    s_add_u32 s100, s100, 1
    s_cmp_gt_u32 s100, 200000
    s_cbranch_scc1 G2_ZAOK
    s_sleep 1
    ds_read_b64 v[2:3], v19 offset:16
    s_branch G2_ZA
G2_R5:
    s_sleep 2
    buffer_load_dwordx4 v[136:139], v0, s[28:31], s92 offen offset:1024 sc1
    buffer_load_dwordx4 v[140:143], v31, s[28:31], s92 offen offset:1024 sc1
    buffer_load_dwordx4 v[144:147], v0, s[28:31], s92 offen offset:2048 sc1
    buffer_load_dwordx4 v[148:151], v31, s[28:31], s92 offen offset:2048 sc1
    buffer_load_dwordx4 v[152:155], v0, s[28:31], s4 offen offset:0 sc1
    buffer_load_dwordx4 v[156:159], v31, s[28:31], s4 offen offset:0 sc1
    buffer_load_dwordx4 v[96:99], v0, s[28:31], s4 offen offset:1024 sc1
    buffer_load_dwordx4 v[100:103], v31, s[28:31], s4 offen offset:1024 sc1
    buffer_load_dwordx4 v[104:107], v0, s[28:31], s4 offen offset:2048 sc1
    buffer_load_dwordx4 v[108:111], v31, s[28:31], s4 offen offset:2048 sc1
    s_add_u32 s100, s100, 1
    s_cmp_gt_u32 s100, 20000
    s_waitcnt vmcnt(0)
    s_cbranch_scc1 G2_OK5
    v_max3_u32 v2, v136, v137, v138
    v_max3_u32 v3, v139, v140, v141
    v_max3_u32 v2, v2, v142, v143
    v_max_u32 v2, v2, v3
    v_cmp_eq_u32 vcc, -1, v2
    s_cbranch_vccnz G2_R5
    s_branch G2_OK5
G2_R6:
    s_sleep 2
    buffer_load_dwordx4 v[144:147], v0, s[28:31], s92 offen offset:2048 sc1
    buffer_load_dwordx4 v[148:151], v31, s[28:31], s92 offen offset:2048 sc1
    buffer_load_dwordx4 v[152:155], v0, s[28:31], s4 offen offset:0 sc1
    buffer_load_dwordx4 v[156:159], v31, s[28:31], s4 offen offset:0 sc1
    buffer_load_dwordx4 v[96:99], v0, s[28:31], s4 offen offset:1024 sc1
    buffer_load_dwordx4 v[100:103], v31, s[28:31], s4 offen offset:1024 sc1
    buffer_load_dwordx4 v[104:107], v0, s[28:31], s4 offen offset:2048 sc1
    buffer_load_dwordx4 v[108:111], v31, s[28:31], s4 offen offset:2048 sc1
    buffer_load_dwordx4 v[112:115], v0, s[28:31], s4 offen offset:3072 sc1
    buffer_load_dwordx4 v[116:119], v31, s[28:31], s4 offen offset:3072 sc1
    s_add_u32 s100, s100, 1
    s_cmp_gt_u32 s100, 20000
    s_waitcnt vmcnt(0)
    s_cbranch_scc1 G2_OK6
    v_max3_u32 v2, v144, v145, v146
    v_max3_u32 v3, v147, v148, v149
    v_max3_u32 v2, v2, v150, v151
    v_max_u32 v2, v2, v3
    v_cmp_eq_u32 vcc, -1, v2
    s_cbranch_vccnz G2_R6
    s_branch G2_OK6
G2_R7:
    s_sleep 2
    buffer_load_dwordx4 v[152:155], v0, s[28:31], s4 offen offset:0 sc1
    buffer_load_dwordx4 v[156:159], v31, s[28:31], s4 offen offset:0 sc1
    buffer_load_dwordx4 v[96:99], v0, s[28:31], s4 offen offset:1024 sc1
    buffer_load_dwordx4 v[100:103], v31, s[28:31], s4 offen offset:1024 sc1
    buffer_load_dwordx4 v[104:107], v0, s[28:31], s4 offen offset:2048 sc1
    buffer_load_dwordx4 v[108:111], v31, s[28:31], s4 offen offset:2048 sc1
    buffer_load_dwordx4 v[112:115], v0, s[28:31], s4 offen offset:3072 sc1
    buffer_load_dwordx4 v[116:119], v31, s[28:31], s4 offen offset:3072 sc1
    buffer_load_dwordx4 v[120:123], v0, s[28:31], s6 offen offset:0 sc1
    buffer_load_dwordx4 v[124:127], v31, s[28:31], s6 offen offset:0 sc1
    s_add_u32 s100, s100, 1
    s_cmp_gt_u32 s100, 20000
    s_waitcnt vmcnt(0)
    s_cbranch_scc1 G2_OK7
    v_max3_u32 v2, v152, v153, v154
    v_max3_u32 v3, v155, v156, v157
    v_max3_u32 v2, v2, v158, v159
    v_max_u32 v2, v2, v3
    v_cmp_eq_u32 vcc, -1, v2
    s_cbranch_vccnz G2_R7
    s_branch G2_OK7
G2_ZL:
    s_waitcnt lgkmcnt(0)
    v_and_b32 v2, v2, v3
    v_cmp_ne_u32 vcc, 0x01010101, v2
    s_cbranch_vccz G2_ZLOK
G2_ZLR:
    s_add_u32 s100, s100, 1
    s_cmp_gt_u32 s100, 200000
    s_cbranch_scc1 G2_ZLOK
    s_sleep 1
    ds_read_b64 v[2:3], v19 offset:0
    s_branch G2_ZL
G2_R8:
    s_sleep 2
    buffer_load_dwordx4 v[96:99], v0, s[28:31], s4 offen offset:1024 sc1
    buffer_load_dwordx4 v[100:103], v31, s[28:31], s4 offen offset:1024 sc1
    buffer_load_dwordx4 v[104:107], v0, s[28:31], s4 offen offset:2048 sc1
    buffer_load_dwordx4 v[108:111], v31, s[28:31], s4 offen offset:2048 sc1
    buffer_load_dwordx4 v[112:115], v0, s[28:31], s4 offen offset:3072 sc1
    buffer_load_dwordx4 v[116:119], v31, s[28:31], s4 offen offset:3072 sc1
    buffer_load_dwordx4 v[120:123], v0, s[28:31], s6 offen offset:0 sc1
    buffer_load_dwordx4 v[124:127], v31, s[28:31], s6 offen offset:0 sc1
    buffer_load_dwordx4 v[128:131], v0, s[28:31], s6 offen offset:1024 sc1
    buffer_load_dwordx4 v[132:135], v31, s[28:31], s6 offen offset:1024 sc1
    s_add_u32 s100, s100, 1
    s_cmp_gt_u32 s100, 20000
    s_waitcnt vmcnt(0)
    s_cbranch_scc1 G2_OK8
    v_max3_u32 v2, v96, v97, v98
    v_max3_u32 v3, v99, v100, v101
    v_max3_u32 v2, v2, v102, v103
    v_max_u32 v2, v2, v3
    v_cmp_eq_u32 vcc, -1, v2
    s_cbranch_vccnz G2_R8
    s_branch G2_OK8
G2_R9:
    s_sleep 2
    buffer_load_dwordx4 v[104:107], v0, s[28:31], s4 offen offset:2048 sc1
    buffer_load_dwordx4 v[108:111], v31, s[28:31], s4 offen offset:2048 sc1
    buffer_load_dwordx4 v[112:115], v0, s[28:31], s4 offen offset:3072 sc1
    buffer_load_dwordx4 v[116:119], v31, s[28:31], s4 offen offset:3072 sc1
    buffer_load_dwordx4 v[120:123], v0, s[28:31], s6 offen offset:0 sc1
    buffer_load_dwordx4 v[124:127], v31, s[28:31], s6 offen offset:0 sc1
    buffer_load_dwordx4 v[128:131], v0, s[28:31], s6 offen offset:1024 sc1
    buffer_load_dwordx4 v[132:135], v31, s[28:31], s6 offen offset:1024 sc1
    buffer_load_dwordx4 v[136:139], v0, s[28:31], s6 offen offset:2048 sc1
    buffer_load_dwordx4 v[140:143], v31, s[28:31], s6 offen offset:2048 sc1
    s_add_u32 s100, s100, 1
    s_cmp_gt_u32 s100, 20000
    s_waitcnt vmcnt(0)
    s_cbranch_scc1 G2_OK9
    v_max3_u32 v2, v104, v105, v106
    v_max3_u32 v3, v107, v108, v109
    v_max3_u32 v2, v2, v110, v111
    v_max_u32 v2, v2, v3
    v_cmp_eq_u32 vcc, -1, v2
    s_cbranch_vccnz G2_R9
    s_branch G2_OK9
G2_R10:
    s_sleep 2
    buffer_load_dwordx4 v[112:115], v0, s[28:31], s4 offen offset:3072 sc1
    buffer_load_dwordx4 v[116:119], v31, s[28:31], s4 offen offset:3072 sc1
    buffer_load_dwordx4 v[120:123], v0, s[28:31], s6 offen offset:0 sc1
    buffer_load_dwordx4 v[124:127], v31, s[28:31], s6 offen offset:0 sc1
    buffer_load_dwordx4 v[128:131], v0, s[28:31], s6 offen offset:1024 sc1
    buffer_load_dwordx4 v[132:135], v31, s[28:31], s6 offen offset:1024 sc1
    buffer_load_dwordx4 v[136:139], v0, s[28:31], s6 offen offset:2048 sc1
    buffer_load_dwordx4 v[140:143], v31, s[28:31], s6 offen offset:2048 sc1
    s_add_u32 s100, s100, 1
    s_cmp_gt_u32 s100, 20000
    s_waitcnt vmcnt(0)
    s_cbranch_scc1 G2_OK10
    v_max3_u32 v2, v112, v113, v114
    v_max3_u32 v3, v115, v116, v117
    v_max3_u32 v2, v2, v118, v119
    v_max_u32 v2, v2, v3
    v_cmp_eq_u32 vcc, -1, v2
    s_cbranch_vccnz G2_R10
    s_branch G2_OK10
G2_R11:
    s_sleep 2
    buffer_load_dwordx4 v[120:123], v0, s[28:31], s6 offen offset:0 sc1
    buffer_load_dwordx4 v[124:127], v31, s[28:31], s6 offen offset:0 sc1
    buffer_load_dwordx4 v[128:131], v0, s[28:31], s6 offen offset:1024 sc1
    buffer_load_dwordx4 v[132:135], v31, s[28:31], s6 offen offset:1024 sc1
    buffer_load_dwordx4 v[136:139], v0, s[28:31], s6 offen offset:2048 sc1
    buffer_load_dwordx4 v[140:143], v31, s[28:31], s6 offen offset:2048 sc1
    buffer_load_dwordx4 v[144:147], v0, s[28:31], s93 offen offset:0 sc1
    buffer_load_dwordx4 v[148:151], v31, s[28:31], s93 offen offset:0 sc1
    buffer_load_dwordx4 v[152:155], v0, s[28:31], s7 offen offset:0 sc1
    buffer_load_dwordx4 v[156:159], v31, s[28:31], s7 offen offset:0 sc1
    s_add_u32 s100, s100, 1
    s_cmp_gt_u32 s100, 20000
    s_waitcnt vmcnt(0)
    s_cbranch_scc1 G2_OK11
    v_max3_u32 v2, v120, v121, v122
    v_max3_u32 v3, v123, v124, v125
    v_max3_u32 v2, v2, v126, v127
    v_max_u32 v2, v2, v3
    v_cmp_eq_u32 vcc, -1, v2
    s_cbranch_vccnz G2_R11
    s_branch G2_OK11
G2_R12:
    s_sleep 2
    buffer_load_dwordx4 v[128:131], v0, s[28:31], s6 offen offset:1024 sc1
    buffer_load_dwordx4 v[132:135], v31, s[28:31], s6 offen offset:1024 sc1
    buffer_load_dwordx4 v[136:139], v0, s[28:31], s6 offen offset:2048 sc1
    buffer_load_dwordx4 v[140:143], v31, s[28:31], s6 offen offset:2048 sc1
    buffer_load_dwordx4 v[144:147], v0, s[28:31], s93 offen offset:0 sc1
    buffer_load_dwordx4 v[148:151], v31, s[28:31], s93 offen offset:0 sc1
    buffer_load_dwordx4 v[152:155], v0, s[28:31], s7 offen offset:0 sc1
    buffer_load_dwordx4 v[156:159], v31, s[28:31], s7 offen offset:0 sc1
    buffer_load_dwordx4 v[96:99], v0, s[28:31], s93 offen offset:1024 sc1
    buffer_load_dwordx4 v[100:103], v31, s[28:31], s93 offen offset:1024 sc1
    s_add_u32 s100, s100, 1
    s_cmp_gt_u32 s100, 20000
    s_waitcnt vmcnt(0)
    s_cbranch_scc1 G2_OK12
    v_max3_u32 v2, v128, v129, v130
    v_max3_u32 v3, v131, v132, v133
    v_max3_u32 v2, v2, v134, v135
    v_max_u32 v2, v2, v3
    v_cmp_eq_u32 vcc, -1, v2
    s_cbranch_vccnz G2_R12
    s_branch G2_OK12
G2_R13:
    s_sleep 2
    buffer_load_dwordx4 v[136:139], v0, s[28:31], s6 offen offset:2048 sc1
    buffer_load_dwordx4 v[140:143], v31, s[28:31], s6 offen offset:2048 sc1
    buffer_load_dwordx4 v[144:147], v0, s[28:31], s93 offen offset:0 sc1
    buffer_load_dwordx4 v[148:151], v31, s[28:31], s93 offen offset:0 sc1
    buffer_load_dwordx4 v[152:155], v0, s[28:31], s7 offen offset:0 sc1
    buffer_load_dwordx4 v[156:159], v31, s[28:31], s7 offen offset:0 sc1
    buffer_load_dwordx4 v[96:99], v0, s[28:31], s93 offen offset:1024 sc1
    buffer_load_dwordx4 v[100:103], v31, s[28:31], s93 offen offset:1024 sc1
    buffer_load_dwordx4 v[104:107], v0, s[28:31], s7 offen offset:1024 sc1
    buffer_load_dwordx4 v[108:111], v31, s[28:31], s7 offen offset:1024 sc1
    s_add_u32 s100, s100, 1
    s_cmp_gt_u32 s100, 20000
    s_waitcnt vmcnt(0)
    s_cbranch_scc1 G2_OK13
    v_max3_u32 v2, v136, v137, v138
    v_max3_u32 v3, v139, v140, v141
    v_max3_u32 v2, v2, v142, v143
    v_max_u32 v2, v2, v3
    v_cmp_eq_u32 vcc, -1, v2
    s_cbranch_vccnz G2_R13
    s_branch G2_OK13
G2_R14:
    s_sleep 2
    buffer_load_dwordx4 v[144:147], v0, s[28:31], s93 offen offset:0 sc1
    buffer_load_dwordx4 v[148:151], v31, s[28:31], s93 offen offset:0 sc1
    buffer_load_dwordx4 v[152:155], v0, s[28:31], s7 offen offset:0 sc1
    buffer_load_dwordx4 v[156:159], v31, s[28:31], s7 offen offset:0 sc1
    buffer_load_dwordx4 v[96:99], v0, s[28:31], s93 offen offset:1024 sc1
    buffer_load_dwordx4 v[100:103], v31, s[28:31], s93 offen offset:1024 sc1
    buffer_load_dwordx4 v[104:107], v0, s[28:31], s7 offen offset:1024 sc1
    buffer_load_dwordx4 v[108:111], v31, s[28:31], s7 offen offset:1024 sc1
    buffer_load_dwordx4 v[112:115], v0, s[28:31], s92 offen offset:3072 sc1
    buffer_load_dwordx4 v[116:119], v31, s[28:31], s92 offen offset:3072 sc1
    s_add_u32 s100, s100, 1
    s_cmp_gt_u32 s100, 20000
    s_waitcnt vmcnt(0)
    s_cbranch_scc1 G2_OK14
    v_max3_u32 v2, v144, v145, v146
    v_max3_u32 v3, v147, v148, v149
    v_max3_u32 v2, v2, v150, v151
    v_max_u32 v2, v2, v3
    v_cmp_eq_u32 vcc, -1, v2
    s_cbranch_vccnz G2_R14
    s_branch G2_OK14
G2_R15:
    s_sleep 2
    buffer_load_dwordx4 v[152:155], v0, s[28:31], s7 offen offset:0 sc1
    buffer_load_dwordx4 v[156:159], v31, s[28:31], s7 offen offset:0 sc1
    buffer_load_dwordx4 v[96:99], v0, s[28:31], s93 offen offset:1024 sc1
    buffer_load_dwordx4 v[100:103], v31, s[28:31], s93 offen offset:1024 sc1
    buffer_load_dwordx4 v[104:107], v0, s[28:31], s7 offen offset:1024 sc1
    buffer_load_dwordx4 v[108:111], v31, s[28:31], s7 offen offset:1024 sc1
    buffer_load_dwordx4 v[112:115], v0, s[28:31], s92 offen offset:3072 sc1
    buffer_load_dwordx4 v[116:119], v31, s[28:31], s92 offen offset:3072 sc1
    buffer_load_dwordx4 v[120:123], v0, s[28:31], s6 offen offset:3072 sc1
    buffer_load_dwordx4 v[124:127], v31, s[28:31], s6 offen offset:3072 sc1
    s_add_u32 s100, s100, 1
    s_cmp_gt_u32 s100, 20000
    s_waitcnt vmcnt(0)
    s_cbranch_scc1 G2_OK15
    v_max3_u32 v2, v152, v153, v154
    v_max3_u32 v3, v155, v156, v157
    v_max3_u32 v2, v2, v158, v159
    v_max_u32 v2, v2, v3
    v_cmp_eq_u32 vcc, -1, v2
    s_cbranch_vccnz G2_R15
    s_branch G2_OK15
G2_R16:
    s_sleep 2
    buffer_load_dwordx4 v[96:99], v0, s[28:31], s93 offen offset:1024 sc1
    buffer_load_dwordx4 v[100:103], v31, s[28:31], s93 offen offset:1024 sc1
    buffer_load_dwordx4 v[104:107], v0, s[28:31], s7 offen offset:1024 sc1
    buffer_load_dwordx4 v[108:111], v31, s[28:31], s7 offen offset:1024 sc1
    buffer_load_dwordx4 v[112:115], v0, s[28:31], s92 offen offset:3072 sc1
    buffer_load_dwordx4 v[116:119], v31, s[28:31], s92 offen offset:3072 sc1
    buffer_load_dwordx4 v[120:123], v0, s[28:31], s6 offen offset:3072 sc1
    buffer_load_dwordx4 v[124:127], v31, s[28:31], s6 offen offset:3072 sc1
    s_add_u32 s100, s100, 1
    s_cmp_gt_u32 s100, 20000
    s_waitcnt vmcnt(0)
    s_cbranch_scc1 G2_OK16
    v_max3_u32 v2, v96, v97, v98
    v_max3_u32 v3, v99, v100, v101
    v_max3_u32 v2, v2, v102, v103
    v_max_u32 v2, v2, v3
    v_cmp_eq_u32 vcc, -1, v2
    s_cbranch_vccnz G2_R16
    s_branch G2_OK16
G2_R17:
    s_sleep 2
    buffer_load_dwordx4 v[104:107], v0, s[28:31], s7 offen offset:1024 sc1
    buffer_load_dwordx4 v[108:111], v31, s[28:31], s7 offen offset:1024 sc1
    buffer_load_dwordx4 v[112:115], v0, s[28:31], s92 offen offset:3072 sc1
    buffer_load_dwordx4 v[116:119], v31, s[28:31], s92 offen offset:3072 sc1
    buffer_load_dwordx4 v[120:123], v0, s[28:31], s6 offen offset:3072 sc1
    buffer_load_dwordx4 v[124:127], v31, s[28:31], s6 offen offset:3072 sc1
    s_add_u32 s100, s100, 1
    s_cmp_gt_u32 s100, 20000
    s_waitcnt vmcnt(0)
    s_cbranch_scc1 G2_OK17
    v_max3_u32 v2, v104, v105, v106
    v_max3_u32 v3, v107, v108, v109
    v_max3_u32 v2, v2, v110, v111
    v_max_u32 v2, v2, v3
    v_cmp_eq_u32 vcc, -1, v2
    s_cbranch_vccnz G2_R17
    s_branch G2_OK17
G2_R18:
    s_sleep 2
    buffer_load_dwordx4 v[112:115], v0, s[28:31], s92 offen offset:3072 sc1
    buffer_load_dwordx4 v[116:119], v31, s[28:31], s92 offen offset:3072 sc1
    buffer_load_dwordx4 v[120:123], v0, s[28:31], s6 offen offset:3072 sc1
    buffer_load_dwordx4 v[124:127], v31, s[28:31], s6 offen offset:3072 sc1
    s_add_u32 s100, s100, 1
    s_cmp_gt_u32 s100, 20000
    s_waitcnt vmcnt(0)
    s_cbranch_scc1 G2_OK18
    v_max3_u32 v2, v112, v113, v114
    v_max3_u32 v3, v115, v116, v117
    v_max3_u32 v2, v2, v118, v119
    v_max_u32 v2, v2, v3
    v_cmp_eq_u32 vcc, -1, v2
    s_cbranch_vccnz G2_R18
    s_branch G2_OK18
G2_R19:
    s_sleep 2
    buffer_load_dwordx4 v[120:123], v0, s[28:31], s6 offen offset:3072 sc1
    buffer_load_dwordx4 v[124:127], v31, s[28:31], s6 offen offset:3072 sc1
    s_add_u32 s100, s100, 1
    s_cmp_gt_u32 s100, 20000
    s_waitcnt vmcnt(0)
    s_cbranch_scc1 G2_OK19
    v_max3_u32 v2, v120, v121, v122
    v_max3_u32 v3, v123, v124, v125
    v_max3_u32 v2, v2, v126, v127
    v_max_u32 v2, v2, v3
    v_cmp_eq_u32 vcc, -1, v2
    s_cbranch_vccnz G2_R19
    s_branch G2_OK19
G2_ZG:
    s_waitcnt lgkmcnt(0)
    v_and_b32 v2, v2, v3
    v_cmp_ne_u32 vcc, 0x01010101, v2
    s_cbranch_vccz G2_ZGOK
G2_ZGR:
    s_add_u32 s100, s100, 1
    s_cmp_gt_u32 s100, 200000
    s_cbranch_scc1 G2_ZGOK
    s_sleep 1
    ds_read_b64 v[2:3], v19 offset:8
    s_branch G2_ZG
P_ZR:
    s_add_u32 s100, s100, 1
    s_cmp_gt_u32 s100, 200000
    s_cbranch_scc1 P_ZOK
    s_sleep 1
    ds_read_b64 v[2:3], v19 offset:0
    s_branch P_Z
L_RC_RETRY:
    s_add_u32 s100, s100, 1
    s_cmp_gt_u32 s100, 20000
    s_cbranch_scc1 L_RC_OK
    s_sleep 4
    s_mul_i32 s60, s59, 448
    s_add_u32 m0, s60, 161536
    s_mov_b64 exec, 0xfffffff
    buffer_load_dwordx4 v81, s[28:31], 0 offen sc1 lds
    s_mov_b64 exec, -1
    s_waitcnt vmcnt(0)
    ds_read_b128 v[84:87], v82
    s_waitcnt lgkmcnt(0)
    s_waitcnt vmcnt(0)
    s_branch L_RC_CHK
L_FL_RETRY:
    s_add_u32 s100, s100, 1
    s_cmp_gt_u32 s100, 20000
    s_cbranch_scc1 L_FL_OK
    s_sleep 8
    s_mov_b64 exec, 1
    buffer_load_dwordx4 v[204:207], v6, s[28:31], 0 offen offset:256 sc1
    s_waitcnt vmcnt(0)
    s_branch L_FL_CHK
AL_MB_RETRY:
    s_add_u32 s100, s100, 1
    s_cmp_gt_u32 s100, 20000
    s_cbranch_scc1 AL_MB_OK
    s_sleep 2
    buffer_load_dwordx4 v[136:139], v6, s[28:31], s12 offen offset:0 sc1
    buffer_load_dwordx4 v[140:143], v6, s[28:31], s12 offen offset:1024 sc1
    buffer_load_dwordx4 v[144:147], v6, s[28:31], s12 offen offset:2048 sc1
    buffer_load_dwordx4 v[148:151], v6, s[28:31], s12 offen offset:3072 sc1
    s_waitcnt vmcnt(0)
    s_branch AL_MB_CHK
K_END:
K_EXIT:
    s_endpgm
    .p2align 6
    .type K_TAB,@object
K_TAB:
    .long 0x18100800, 0x80808020, 0x18100800, 0x128, 0x0, 0x1400, 0x1e00, 0x0
    .long 0x0, 0x2, 0xff00ff00, 0xffffffff, 0xffffffff, 0xffffffff, 0xffffff00, 0xffffffff
    .long 0x18100800, 0x80808080, 0x18100800, 0x120, 0x6, 0x2000, 0x7ff00000, 0x1c00
    .long 0x0, 0x1, 0xff00ff00, 0xffffffff, 0xffffffff, 0xffffffff, 0xffffff00, 0xffffffff
    .long 0x80100800, 0x80808080, 0x8080000, 0x118, 0x6, 0x2500, 0x1d08, 0x5400
    .long 0x3800, 0x1, 0xff00, 0xffff, 0xffff, 0xffff, 0xffffff00, 0xffffffff
    .long 0x80800800, 0x80808080, 0x8080000, 0x110, 0x6, 0x2700, 0x7ff00000, 0x8c00
    .long 0x7000, 0x1, 0xff00, 0xffff, 0xffff, 0xffff, 0xffffff00, 0xffffffff
    .long 0x80808000, 0x80808080, 0x8080000, 0x108, 0x6, 0x7ff00000, 0x1f08, 0xc400
    .long 0xa800, 0x1, 0xff00, 0xffff, 0xffff, 0xffff, 0xffffff00, 0xffffffff
    .long 0x40383028, 0x80808048, 0x40383028, 0x150, 0x2, 0x0, 0x1800, 0x0
    .long 0x0, 0x0, 0xff00ff00, 0xffffffff, 0xffffffff, 0xffffffff, 0xffffff00, 0xffffffff
    .long 0x38302820, 0x80808040, 0x38302820, 0x148, 0x0, 0x400, 0x1a00, 0x0
    .long 0x0, 0x0, 0xff00ff00, 0xffffffff, 0xffffffff, 0xffffffff, 0xffffff00, 0xffffffff
    .long 0x30282018, 0x80808038, 0x30282018, 0x140, 0x0, 0x800, 0x1808, 0x0
    .long 0x0, 0x0, 0xff00ff00, 0xffffffff, 0xffffffff, 0xffffffff, 0xffffff00, 0xffffffff
    .long 0x28201810, 0x80808030, 0x28201810, 0x138, 0x0, 0xc00, 0x1a08, 0x0
    .long 0x0, 0x0, 0xff00ff00, 0xffffffff, 0xffffffff, 0xffffffff, 0xffffff00, 0xffffffff
    .long 0x20181008, 0x80808028, 0x20181008, 0x130, 0x0, 0x1000, 0x1c00, 0x0
    .long 0x0, 0x0, 0xff00ff00, 0xffffffff, 0xffffffff, 0xffffffff, 0xffffff00, 0xffffffff
    .long 0x68605850, 0x80808070, 0x68605850, 0x178, 0x4, 0x200, 0x1900, 0x0
    .long 0x0, 0x0, 0xff00ff00, 0xffffffff, 0xffffffff, 0xffffffff, 0xffffff00, 0xffffffff
    .long 0x60585048, 0x80808068, 0x60585048, 0x170, 0x2, 0x600, 0x1b00, 0x0
    .long 0x0, 0x0, 0xff00ff00, 0xffffffff, 0xffffffff, 0xffffffff, 0xffffff00, 0xffffffff
    .long 0x58504840, 0x80808060, 0x58504840, 0x168, 0x2, 0xa00, 0x1908, 0x0
    .long 0x0, 0x0, 0xff00ff00, 0xffffffff, 0xffffffff, 0xffffffff, 0xffffff00, 0xffffffff
    .long 0x50484038, 0x80808058, 0x50484038, 0x160, 0x2, 0xe00, 0x1b08, 0x0
    .long 0x0, 0x0, 0xff00ff00, 0xffffffff, 0xffffffff, 0xffffffff, 0xffffff00, 0xffffffff
    .long 0x48403830, 0x80808050, 0x48403830, 0x158, 0x2, 0x1200, 0x1d00, 0x0
    .long 0x0, 0x0, 0xff00ff00, 0xffffffff, 0xffffffff, 0xffffffff, 0xffffff00, 0xffffffff
    .long 0x80808078, 0x80808080, 0x80807878, 0x180, 0x6, 0x7ff00000, 0x1c08, 0x0
    .long 0x1c00, 0x1, 0xff00, 0xffff, 0xffff, 0xffff, 0xffffff00, 0xffffffff
    .long 0x80807870, 0x80808080, 0x78787070, 0x180, 0x4, 0x2400, 0x7ff00000, 0x3800
    .long 0x5400, 0x1, 0xff00, 0xffff, 0xffff, 0xffff, 0xffffff00, 0xffffffff
    .long 0x80787068, 0x80808080, 0x70706868, 0x180, 0x4, 0x2600, 0x1e08, 0x7000
    .long 0x8c00, 0x1, 0xff00, 0xffff, 0xffff, 0xffff, 0xffffff00, 0xffffffff
    .long 0x78706860, 0x80808080, 0x78706860, 0x180, 0x4, 0x2200, 0x7ff00000, 0xa800
    .long 0xc400, 0x1, 0xff00ff00, 0xffffffff, 0xffffffff, 0xffffffff, 0xffffff00, 0xffffffff
    .long 0x70686058, 0x80808078, 0x70686058, 0x180, 0x4, 0x1600, 0x1f00, 0x0
    .long 0x0, 0x2, 0xff00ff00, 0xffffffff, 0xffffffff, 0xffffffff, 0xffffff00, 0xffffffff
    .long 0x40383028, 0x80808048, 0x40383028, 0x150, 0x0, 0x14000, 0x15800, 0x0
    .long 0x0, 0x0, 0xffffffff, 0xffffffff, 0xffffffff, 0x0, 0xffffffff, 0xffff
    .long 0x38302820, 0x80808040, 0x38302820, 0x148, 0x6, 0x14400, 0x15a00, 0x0
    .long 0x0, 0x0, 0xffffffff, 0xffffffff, 0xffffffff, 0x0, 0xffffffff, 0xffff
    .long 0x30282018, 0x80808038, 0x30282018, 0x140, 0x6, 0x14800, 0x15808, 0x0
    .long 0x0, 0x0, 0xffffffff, 0xffffffff, 0xffffffff, 0x0, 0xffffffff, 0xffff
    .long 0x28201810, 0x80808030, 0x28201810, 0x138, 0x6, 0x14c00, 0x15a08, 0x0
    .long 0x0, 0x0, 0xffffffff, 0xffffffff, 0xffffffff, 0x0, 0xffffffff, 0xffff
    .long 0x20181008, 0x80808028, 0x20181008, 0x130, 0x6, 0x15000, 0x15c00, 0x0
    .long 0x0, 0x0, 0xffffffff, 0xffffffff, 0xffffffff, 0x0, 0xffffffff, 0xffff
    .long 0x18100800, 0x80808020, 0x18100800, 0x128, 0x2, 0x15400, 0x15e00, 0x0
    .long 0x0, 0x2, 0xffffffff, 0xffffffff, 0xffffffff, 0x0, 0xffffffff, 0xffff
    .long 0x18100800, 0x80808080, 0x18100800, 0x120, 0x0, 0x16000, 0x7ff00000, 0x2c00
    .long 0x1000, 0x1, 0xffffffff, 0xffffffff, 0xffffffff, 0x0, 0xffffffff, 0xffff
    .long 0x80100800, 0x80808080, 0x8080000, 0x118, 0x0, 0x16500, 0x15d08, 0x6400
    .long 0x4800, 0x1, 0xffff, 0xffff, 0xffff, 0x0, 0xffffffff, 0xffff
    .long 0x80800800, 0x80808080, 0x8080000, 0x110, 0x0, 0x16700, 0x7ff00000, 0x9c00
    .long 0x8000, 0x1, 0xffff, 0xffff, 0xffff, 0x0, 0xffffffff, 0xffff
    .long 0x80808000, 0x80808080, 0x8080000, 0x108, 0x0, 0x7ff00000, 0x15f08, 0xd400
    .long 0xb800, 0x1, 0xffff, 0xffff, 0xffff, 0x0, 0xffffffff, 0xffff
    .long 0x80808078, 0x80808080, 0x80807878, 0x180, 0x4, 0x7ff00000, 0x15c08, 0x1000
    .long 0x2c00, 0x1, 0xffff, 0xffff, 0xffff, 0x0, 0xffffffff, 0xffff
    .long 0x80807870, 0x80808080, 0x78787070, 0x180, 0x2, 0x16400, 0x7ff00000, 0x4800
    .long 0x6400, 0x1, 0xffff, 0xffff, 0xffff, 0x0, 0xffffffff, 0xffff
    .long 0x80787068, 0x80808080, 0x70706868, 0x180, 0x2, 0x16600, 0x15e08, 0x8000
    .long 0x9c00, 0x1, 0xffff, 0xffff, 0xffff, 0x0, 0xffffffff, 0xffff
    .long 0x78706860, 0x80808080, 0x78706860, 0x180, 0x2, 0x16200, 0x7ff00000, 0xb800
    .long 0xd400, 0x1, 0xffffffff, 0xffffffff, 0xffffffff, 0x0, 0xffffffff, 0xffff
    .long 0x70686058, 0x80808078, 0x70686058, 0x180, 0x2, 0x15600, 0x15f00, 0x0
    .long 0x0, 0x2, 0xffffffff, 0xffffffff, 0xffffffff, 0x0, 0xffffffff, 0xffff
    .long 0x68605850, 0x80808070, 0x68605850, 0x178, 0x6, 0x14200, 0x15900, 0x0
    .long 0x0, 0x0, 0xffffffff, 0xffffffff, 0xffffffff, 0x0, 0xffffffff, 0xffff
    .long 0x60585048, 0x80808068, 0x60585048, 0x170, 0x4, 0x14600, 0x15b00, 0x0
    .long 0x0, 0x0, 0xffffffff, 0xffffffff, 0xffffffff, 0x0, 0xffffffff, 0xffff
    .long 0x58504840, 0x80808060, 0x58504840, 0x168, 0x4, 0x14a00, 0x15908, 0x0
    .long 0x0, 0x0, 0xffffffff, 0xffffffff, 0xffffffff, 0x0, 0xffffffff, 0xffff
    .long 0x50484038, 0x80808058, 0x50484038, 0x160, 0x4, 0x14e00, 0x15b08, 0x0
    .long 0x0, 0x0, 0xffffffff, 0xffffffff, 0xffffffff, 0x0, 0xffffffff, 0xffff
    .long 0x48403830, 0x80808050, 0x48403830, 0x158, 0x4, 0x15200, 0x15d00, 0x0
    .long 0x0, 0x0, 0xffffffff, 0xffffffff, 0xffffffff, 0x0, 0xffffffff, 0xffff
    .fill (40960 - (. - recurrent_scan__sliding_local_dilated__moe_arch_mod__prompt_kernel)) / 4, 4, 0xbf810000
.section .rodata,"a"
.p2align 6
.amdhsa_kernel recurrent_scan__sliding_local_dilated__moe_arch_mod__prompt_kernel
  .amdhsa_next_free_vgpr 256
  .amdhsa_next_free_sgpr 102
  .amdhsa_accum_offset 256
  .amdhsa_group_segment_fixed_size 0
  .amdhsa_kernarg_size 88
  .amdhsa_user_sgpr_count 2
  .amdhsa_user_sgpr_kernarg_segment_ptr 1
  .amdhsa_system_sgpr_workgroup_id_x 1
.end_amdhsa_kernel
```

```asm
; @launch grid=(256,1,1) block=(512,1,1) lds=163840
.amdgcn_target "amdgcn-amd-amdhsa--gfx950"
.text
.globl recurrent_scan__sliding_local_dilated__moe_arch_mod__prompt_kernel
.p2align 8
.type recurrent_scan__sliding_local_dilated__moe_arch_mod__prompt_kernel,@function
recurrent_scan__sliding_local_dilated__moe_arch_mod__prompt_kernel:
    s_load_dwordx2 s[24:25], s[0:1], 0
    s_load_dwordx2 s[32:33], s[0:1], 8
    s_load_dwordx2 s[28:29], s[0:1], 80
    s_cmpk_ge_u32 s2, 256
    s_cbranch_scc1 K_EXIT
    v_readfirstlane_b32 s3, v0
    s_getpc_b64 s[20:21]
K_PC:
    s_lshr_b32 s54, s2, 3
    s_lshl_b32 s60, s54, 10
    v_lshl_add_u32 v2, v0, 1, s60
    global_load_ushort v255, v2, s[20:21]
    s_mul_i32 s60, s54, 52
    s_lshr_b32 s60, s60, 8
    s_mul_i32 s53, s60, 5
    s_sub_u32 s53, s54, s53
    s_add_u32 s67, s60, s53
    s_bitcmp1_b32 s2, 1
    s_cselect_b32 s61, 5, 0
    s_add_u32 s56, s60, s61
    s_mulk_i32 s56, 104
    s_sub_u32 s56, s56, 8
    s_and_b32 s57, s2, 4
    s_mulk_i32 s57, 320
    s_bitcmp1_b32 s2, 0
    s_cselect_b32 s61, 5, 0
    s_add_u32 s58, s53, s61
    s_lshl_b32 s58, s58, 7
    s_mov_b32 s26, 2621440
    s_mov_b32 s27, 0x20000
    s_lshr_b32 s60, s3, 3
    s_max_u32 s60, s60, s54
    s_cmp_ge_u32 s60, 25
    s_cbranch_scc1 K_NL
    v_lshrrev_b32 v2, 3, v0
    v_add_u32 v3, s56, v2
    v_mul_i32_i24 v3, 2560, v3
    v_bitop3_b32 v1, v0, v2, 7 bitop3:0x28
    v_lshl_add_u32 v196, v1, 4, v3
    v_and_b32 v3, 2, v2
    v_lshrrev_b32 v1, 1, v2
    v_and_or_b32 v3, v1, 4, v3
    v_bitop3_b32 v3, v0, v3, 7 bitop3:0x28
    v_mul_u32_u24 v200, 3840, v2
    v_lshl_add_u32 v200, v3, 4, v200
    s_cmp_ge_u32 s67, 5
    s_cselect_b32 s61, 5, 0
    s_sub_u32 s67, s67, s61
    s_lshl_b32 s67, s67, 2
    s_and_b32 s68, s2, 6
    s_mul_i32 s68, s68, 4
    s_lshr_b32 s68, s68, 2
    s_lshl_b32 s69, s3, 4
    s_mov_b32 s34, 2457600
    s_mov_b32 s35, s27
    s_cmp_eq_u32 s3, 0
    s_cselect_b32 s70, 0xffffff00, -1
    s_cmpk_lt_u32 s69, 2048
    s_cselect_b64 vcc, -1, 0
    s_lshr_b32 s64, 66064, s67
    s_and_b32 s64, s64, 15
    s_mul_i32 s65, s64, 245760
    s_lshl_b32 s64, s64, 7
    s_add_u32 s64, s64, s57
    s_add_u32 m0, s69, 77824
    s_mov_b32 exec_lo, s70
    s_waitcnt lgkmcnt(0)
    buffer_load_dwordx4 v196, s[24:27], s64 offen lds
    s_add_u32 m0, s69, 81920
    s_mov_b32 exec_lo, -1
    v_add_u32 v197, 81920, v196
    buffer_load_dwordx4 v197, s[24:27], s64 offen lds
    s_add_u32 m0, s69, 86016
    s_add_u32 s65, s65, s58
    v_add_u32 v198, 163840, v196
    buffer_load_dwordx4 v198, s[24:27], s64 offen lds
    v_add_u32 v199, 245760, v196
    s_cbranch_vccz L_SK0
    s_add_u32 m0, s69, 90112
    s_nop 0
    buffer_load_dwordx4 v199, s[24:27], s64 offen lds
L_SK0:
    s_add_u32 m0, s69, 92160
    s_add_u32 s66, s65, 122880
    buffer_load_dwordx4 v200, s[32:35], s65 offen offset:0 lds
    s_add_u32 m0, s69, 99072
    s_nop 0
    buffer_load_dwordx4 v200, s[32:35], s65 offen offset:1280 lds
    s_add_u32 m0, s69, 105984
    s_nop 0
    buffer_load_dwordx4 v200, s[32:35], s65 offen offset:2560 lds
    s_add_u32 m0, s69, 96256
    s_nop 0
    buffer_load_dwordx4 v200, s[32:35], s66 offen offset:0 lds
    s_add_u32 m0, s69, 103168
    s_nop 0
    buffer_load_dwordx4 v200, s[32:35], s66 offen offset:1280 lds
    s_add_u32 m0, s69, 110080
    s_nop 0
    buffer_load_dwordx4 v200, s[32:35], s66 offen offset:2560 lds
    s_branch L_CONT
K_NL:
    s_cmpk_ge_u32 s3, 256
    s_cbranch_scc1 K_ER
    s_sub_u32 s56, s2, 200
    s_mov_b32 s101, 1
    s_cmp_ge_u32 s56, 27
    s_cbranch_scc1 K_AUX
    s_load_dwordx2 s[48:49], s[0:1], 40
    s_load_dwordx2 s[36:37], s[0:1], 48
    v_lshrrev_b32 v2, 3, v0
    v_and_b32 v3, 2, v2
    v_lshrrev_b32 v1, 1, v2
    v_and_or_b32 v3, v1, 4, v3
    v_bitop3_b32 v3, v0, v3, 7 bitop3:0x28
    v_mul_u32_u24 v30, 3456, v2
    v_lshl_add_u32 v30, v3, 4, v30
    s_lshl_b32 s68, s56, 7
    s_lshl_b32 s69, s3, 4
    s_mov_b32 s70, 12
    s_mov_b32 s50, 2211840
    s_mov_b32 s51, 0x20000
    s_mov_b32 s38, 2211840
    s_mov_b32 s39, 0x20000
    s_waitcnt lgkmcnt(0)
FL_GU1:
    s_mov_b32 m0, s69
    s_sub_u32 s70, s70, 1
    buffer_load_dwordx4 v30, s[48:51], s68 offen nt lds
    s_add_u32 m0, s69, 16384
    s_add_u32 s69, s69, 4096
    buffer_load_dwordx4 v30, s[36:39], s68 offen nt lds
    s_add_u32 s68, s68, 110592
    s_and_b32 s60, s70, 3
    s_cselect_b32 s60, 0, 16384
    s_add_u32 s69, s69, s60
    s_cmp_lg_u32 s70, 0
    s_cbranch_scc1 FL_GU1
    s_mov_b32 s101, 5
    s_branch K_AUX
K_ER:
    s_setprio 3
    s_load_dwordx2 s[22:23], s[0:1], 32
    v_bfe_u32 v232, v0, 5, 3
    v_and_b32 v4, 31, v0
    v_mul_u32_u24 v7, 2560, v232
    v_lshlrev_b32 v5, 4, v4
    v_lshlrev_b32 v6, 3, v4
    v_add_u32 v8, v7, v6
    v_add_u32 v7, v7, v5
    s_and_b32 s68, s2, 3
    s_lshl_b32 s68, s68, 5
    s_add_u32 s68, s68, s54
    s_mul_i32 s69, s68, 20480
    s_add_u32 s69, s69, s57
    s_waitcnt lgkmcnt(0)
    buffer_load_dwordx4 v[212:215], v7, s[24:27], s69 offen
    buffer_load_dwordx4 v[216:219], v7, s[24:27], s69 offen offset:512
    buffer_load_dwordx2 v[220:221], v8, s[24:27], s69 offen offset:1024
    global_load_dwordx4 v[222:225], v5, s[22:23]
    global_load_dwordx4 v[226:229], v5, s[22:23] offset:512
    global_load_dwordx2 v[230:231], v6, s[22:23] offset:1024
    s_load_dword s52, s[28:29], 0
    s_mov_b32 s30, 7077888
    s_mov_b32 s31, 0x20000
    s_and_b32 s70, s2, 4
    s_lshl_b32 s70, s70, 5
    s_add_u32 s70, s70, s68
    s_lshl_b32 s71, s70, 6
    s_lshl_b32 s70, s70, 7
    s_add_u32 s70, s70, 16384
    s_add_u32 s71, s71, 49152
    s_setprio 0
    s_mov_b32 s101, 1
    s_cmp_ge_u32 s54, 25
    s_cbranch_scc1 K_AUX0
    s_mul_i32 s60, s3, 5
    s_lshl_b32 s61, s53, 6
    s_add_u32 s60, s60, s61
    s_add_u32 s60, s60, K_TAB-K_PC
    s_load_dwordx16 s[4:19], s[20:21], s60
    s_load_dwordx2 s[44:45], s[0:1], 64
    s_load_dwordx2 s[40:41], s[0:1], 16
    s_mov_b32 s46, 2621440
    s_mov_b32 s47, 0x20000
    s_mov_b32 s30, 7077888
    s_mov_b32 s31, 0x20000
    s_mov_b32 s42, 819200
    s_mov_b32 s43, 0x20000
    s_lshr_b32 s3, s3, 6
    s_and_b32 s59, s3, 3
    s_mov_b32 s55, 0xffff0000
    s_mov_b32 s100, 0
    v_and_b32 v1, 63, v0
    v_and_b32 v4, 15, v1
    v_lshrrev_b32 v5, 4, v1
    v_mov_b32 v19, 163584
    v_add_u32 v18, s3, v19
    v_mov_b32 v2, 0
    v_mov_b32 v3, 0
    v_mov_b32 v46, 0x00010100
    v_mov_b32 v47, 0x01000001
    ds_write2_b64 v19, v[2:3], v[46:47] offset1:1
    v_mov_b32 v45, 0x01010101
    ds_write2_b32 v19, v2, v45 offset0:4 offset1:5
    v_bfe_u32 v46, v0, 1, 7
    v_min_u32 v46, 111, v46
    v_mul_u32_u24 v46, 264, v46
    v_add_u32 v46, 116992, v46
    ds_write_b64 v46, v[2:3]
    s_min_u32 s60, s59, 2
    s_mul_i32 s60, s60, 38912
    v_and_b32 v46, 31, v0
    v_lshl_add_u32 v46, v46, 2, s60
    v_mov_b32 v47, 0x3f803f80
    ds_write_b32 v46, v47
    v_lshlrev_b32 v6, 4, v1
    v_mov_b32 v28, 0x3f803f80
    v_mov_b32 v29, 0x3f803f80
    v_mov_b32 v30, 0x3f803f80
    v_mov_b32 v31, 0x3f803f80
    v_lshlrev_b32 v2, 2, v5
    v_sub_u32 v3, v4, v2
    v_add_u32 v3, 12, v3
    s_mov_b32 s60, 267390975
    v_bfe_i32 v32, s60, v3, 1
    v_and_b32 v32, 0xff800000, v32
    s_mov_b32 s60, 268435440
    v_bfe_i32 v36, s60, v3, 1
    v_and_b32 v36, 0xff800000, v36
    s_mov_b32 s60, 266346495
    v_bfe_i32 v33, s60, v3, 1
    v_and_b32 v33, 0xff800000, v33
    s_mov_b32 s60, 268435424
    v_bfe_i32 v37, s60, v3, 1
    v_and_b32 v37, 0xff800000, v37
    s_mov_b32 s60, 264257535
    v_bfe_i32 v34, s60, v3, 1
    v_and_b32 v34, 0xff800000, v34
    s_mov_b32 s60, 268435392
    v_bfe_i32 v38, s60, v3, 1
    v_and_b32 v38, 0xff800000, v38
    s_mov_b32 s60, 260079615
    v_bfe_i32 v35, s60, v3, 1
    v_and_b32 v35, 0xff800000, v35
    s_mov_b32 s60, 268435328
    v_bfe_i32 v39, s60, v3, 1
    v_and_b32 v39, 0xff800000, v39
    v_sub_u32 v2, 13, v3
    v_med3_i32 v2, v2, 0, 2
    v_lshlrev_b32 v2, 3, v2
    v_mov_b32 v40, -1
    v_lshrrev_b32 v40, v2, v40
    v_lshrrev_b32 v40, v2, v40
    v_sub_u32 v2, 15, v3
    v_med3_i32 v2, v2, 0, 2
    v_lshlrev_b32 v2, 3, v2
    v_mov_b32 v41, -1
    v_lshrrev_b32 v41, v2, v41
    v_lshrrev_b32 v41, v2, v41
    v_mul_u32_u24 v25, 20224, v5
    v_add_u32 v25, v25, v6
    v_lshrrev_b32 v24, 5, v1
    v_mul_u32_u24 v24, 19968, v24
    v_add_u32 v24, v24, v6
    v_lshlrev_b32 v26, 4, v4
    v_add_u32 v26, 162568, v26
    v_bfe_u32 v2, v1, 2, 2
    v_lshlrev_b32 v2, 7, v2
    v_and_b32 v3, 8, v1
    v_lshl_add_u32 v2, v3, 2, v2
    v_and_b32 v3, 3, v1
    v_lshl_add_u32 v2, v3, 3, v2
    v_and_b32 v3, 48, v1
    s_mov_b32 s62, 0xffff
    s_mov_b32 s60, 201329216
    s_mov_b32 s61, 373298176
    v_lshrrev_b64 v[46:47], v3, s[60:61]
    v_and_or_b32 v9, v46, s62, v2
    s_mov_b32 s60, 37748736
    s_mov_b32 s61, 2550175296
    v_lshrrev_b64 v[46:47], v3, s[60:61]
    v_and_or_b32 v10, v46, s62, v2
    s_mov_b32 s60, 469766720
    s_mov_b32 s61, 977285120
    v_lshrrev_b64 v[46:47], v3, s[60:61]
    v_and_or_b32 v11, v46, s62, v2
    s_mov_b32 s60, 2483063360
    s_mov_b32 s61, 2654996480
    v_lshrrev_b64 v[46:47], v3, s[60:61]
    v_and_or_b32 v12, v46, s62, v2
    s_mov_b32 s60, 574627840
    s_mov_b32 s61, 2051045376
    v_lshrrev_b64 v[46:47], v3, s[60:61]
    v_and_or_b32 v13, v46, s62, v2
    s_mov_b32 s60, 1073757184
    s_mov_b32 s61, 1610635840
    v_lshrrev_b64 v[46:47], v3, s[60:61]
    v_and_or_b32 v14, v46, s62, v2
    s_mov_b32 s60, 1140858432
    s_mov_b32 s61, 2147507776
    v_lshrrev_b64 v[46:47], v3, s[60:61]
    v_and_or_b32 v15, v46, s62, v2
    v_lshrrev_b32 v2, 3, v1
    v_bitop3_b32 v3, v1, v2, 7 bitop3:0x28
    v_mul_u32_u24 v7, 2560, v2
    v_lshl_add_u32 v7, v3, 4, v7
    v_lshrrev_b32 v2, 5, v1
    v_bitop3_b32 v2, v2, v4, 7 bitop3:0x28
    v_lshlrev_b32 v8, 7, v4
    v_lshl_add_u32 v8, v2, 4, v8
    v_and_b32 v2, 1, v5
    v_lshl_add_u32 v8, v2, 3, v8
    v_bfe_u32 v2, v0, 3, 5
    v_and_b32 v3, 6, v2
    v_bitop3_b32 v3, v0, v3, 7 bitop3:0x28
    v_mul_u32_u24 v16, 1280, v2
    v_lshl_add_u32 v16, v3, 4, v16
    s_lshl_b32 s98, s56, 4
    s_mul_i32 s60, s57, 13
    s_add_u32 s98, s98, s60
    s_add_u32 s98, s98, 458880
    s_add_u32 s98, s98, s58
    s_cmp_eq_u32 s59, 0
    s_cselect_b32 s98, s98, 2146435072
    s_add_u32 s96, s56, 8
    s_mulk_i32 s96, 1408
    s_mul_i32 s60, s57, 1144
    s_add_u32 s96, s96, s60
    s_add_u32 s96, s96, 1048576
    s_and_b32 s62, s2, 1
    s_mulk_i32 s62, 10240
    s_add_u32 s62, s62, s96
    s_sub_u32 s63, s54, s53
    s_and_b32 s60, s2, 7
    s_mul_i32 s60, s60, 25
    s_add_u32 s63, s63, s60
    s_mulk_i32 s63, 11520
    s_add_u32 s63, s63, 4194304
    v_mul_u32_u24 v2, 264, v4
    v_add_u32 v2, 129408, v2
    v_lshlrev_b32 v3, 3, v5
    s_waitcnt lgkmcnt(0)
    s_mul_i32 s52, s52, 0x9E3779B1
    s_add_u32 s52, s52, 0x7F4A7C15
    s_or_b32 s52, s52, 1
    v_mov_b32 v46, s52
    ds_write_b32 v19, v46 offset:32
    v_bfe_u32 v20, s4, v3, 8
    v_bfe_u32 v21, s5, v3, 8
    v_add_u32 v20, v20, v2
    v_add_u32 v21, v21, v2
    v_lshrrev_b32 v2, 2, v1
    v_mul_u32_u24 v2, 136, v2
    v_add_u32 v2, 88448, v2
    v_add_u32 v23, s7, v2
    v_lshlrev_b32 v3, 3, v1
    v_bfe_u32 v22, s6, v3, 8
    v_add_u32 v22, v22, v2
    s_add_u32 s9, s9, s62
    s_add_u32 s10, s10, s62
    s_add_u32 s11, s11, s63
    s_add_u32 s12, s12, s63
    s_add_u32 s5, s9, 40960
    s_mul_i32 s60, s8, 20480
    s_add_u32 s96, s96, s60
    s_lshl4_add_u32 s95, s8, s56
    s_cmp_eq_u32 s8, 6
    s_cselect_b32 s101, 1, 2
    s_cmpk_ge_i32 s95, 1024
    s_cselect_b32 s101, 0, s101
    s_mul_i32 s97, s95, 2560
    s_add_u32 s97, s97, s57
    s_add_u32 s97, s97, s58
    s_add_u32 s94, s97, 20480
    s_cmp_eq_u32 s8, 0
    s_cselect_b32 s97, 2146435072, s97
    s_cselect_b32 s61, 2146435072, 0
    s_and_b32 s60, s53, 2
    s_mul_i32 s22, s60, 204800
    s_sub_u32 s23, 409600, s22
    s_add_u32 s22, s22, s58
    s_add_u32 s23, s23, s58
    s_mulk_i32 s60, 5120
    s_sub_u32 s4, s96, s60
    s_add_u32 s4, s4, 10240
    s_add_u32 s96, s96, s60
    s_add_u32 s92, s96, 4096
    s_add_u32 s93, s92, 4096
    s_add_u32 s6, s4, 4096
    s_add_u32 s7, s6, 4096
    v_bfe_i32 v2, v1, 3, 1
    v_bfi_b32 v2, v2, 0, s61
    v_or_b32 v27, v2, v6
    s_and_b32 s60, s2, 4
    s_lshl_b32 s60, s60, 8
    s_add_u32 s95, s95, s60
    s_lshl_b32 s60, s8, 11
    s_add_u32 s60, s60, 146304
    v_add_u32 v8, s60, v8
    s_lshl_b32 s60, s8, 8
    s_add_u32 s60, s60, 161536
    v_lshl_add_u32 v17, v4, 4, s60
    v_bitop3_b32 v2, v5, v4, 7 bitop3:0x28
    v_lshlrev_b32 v2, 4, v2
    v_lshl_add_u32 v42, v4, 7, v2
    v_add_u32 v42, 77824, v42
    v_xor_b32 v43, 64, v42
    v_bfe_u32 v2, v1, 3, 2
    v_xor_b32 v2, s59, v2
    v_lshlrev_b32 v2, 5, v2
    v_lshl_add_u32 v2, v5, 10, v2
    v_bfe_u32 v3, v1, 2, 2
    v_lshl_add_u32 v2, v3, 7, v2
    v_and_b32 v3, 3, v1
    v_lshl_add_u32 v2, v3, 3, v2
    v_add_u32 v44, 92160, v2
    s_lshl_b32 s60, s59, 5
    s_add_u32 s60, s60, 116736
    v_mul_u32_u24 v46, 264, v4
    v_lshl_add_u32 v2, v5, 3, s60
    v_add_u32 v46, v46, v2
    v_mul_u32_u24 v47, 136, v4
    v_add_u32 v47, v47, v2
    v_subrev_u32 v47, 34816, v47
    v_lshlrev_b32 v45, 4, v4
    v_add_u32 v45, 161536, v45
    v_mov_b32 v48, 0
    v_mov_b32 v49, 0
    v_mov_b32 v50, 0
    v_mov_b32 v51, 0
    v_mov_b32 v52, 0
    v_mov_b32 v53, 0
    v_mov_b32 v54, 0
    v_mov_b32 v55, 0
    v_mov_b32 v56, 0
    v_mov_b32 v57, 0
    v_mov_b32 v58, 0
    v_mov_b32 v59, 0
    v_mov_b32 v60, 0
    v_mov_b32 v61, 0
    v_mov_b32 v62, 0
    v_mov_b32 v63, 0
    v_mov_b32 v64, 0
    v_mov_b32 v65, 0
    v_mov_b32 v66, 0
    v_mov_b32 v67, 0
    v_mov_b32 v68, 0
    v_mov_b32 v69, 0
    v_mov_b32 v70, 0
    v_mov_b32 v71, 0
    v_mov_b32 v72, 0
    v_mov_b32 v73, 0
    v_mov_b32 v74, 0
    v_mov_b32 v75, 0
    v_mov_b32 v76, 0
    v_mov_b32 v77, 0
    v_mov_b32 v78, 0
    v_mov_b32 v79, 0
    v_mov_b32 v80, 0
    v_mov_b32 v81, 0
    v_mov_b32 v82, 0
    v_mov_b32 v83, 0
    v_mov_b32 v84, 0
    v_mov_b32 v85, 0
    v_mov_b32 v86, 0
    v_mov_b32 v87, 0
    v_mov_b32 v88, 0
    v_mov_b32 v89, 0
    v_mov_b32 v90, 0
    v_mov_b32 v91, 0
    v_mov_b32 v92, 0
    v_mov_b32 v93, 0
    v_mov_b32 v94, 0
    v_mov_b32 v95, 0
    v_mov_b32 v96, 0
    v_mov_b32 v97, 0
    v_mov_b32 v98, 0
    v_mov_b32 v99, 0
    v_mov_b32 v100, 0
    v_mov_b32 v101, 0
    v_mov_b32 v102, 0
    v_mov_b32 v103, 0
    v_mov_b32 v104, 0
    v_mov_b32 v105, 0
    v_mov_b32 v106, 0
    v_mov_b32 v107, 0
    v_mov_b32 v108, 0
    v_mov_b32 v109, 0
    v_mov_b32 v110, 0
    v_mov_b32 v111, 0
    v_mov_b32 v112, 0
    v_mov_b32 v113, 0
    v_mov_b32 v114, 0
    v_mov_b32 v115, 0
    v_mov_b32 v116, 0
    v_mov_b32 v117, 0
    v_mov_b32 v118, 0
    v_mov_b32 v119, 0
    v_mov_b32 v120, 0
    v_mov_b32 v121, 0
    v_mov_b32 v122, 0
    v_mov_b32 v123, 0
    v_mov_b32 v124, 0
    v_mov_b32 v125, 0
    v_mov_b32 v126, 0
    v_mov_b32 v127, 0
    v_mov_b32 v128, 0
    v_mov_b32 v129, 0
    v_mov_b32 v130, 0
    v_mov_b32 v131, 0
    s_mov_b64 exec, 0
    s_branch TL0
TL0_END:
    s_mov_b64 exec, -1
    v_mov_b32 v241, 0x3f803f80
    v_mov_b32 v245, s52
    v_mov_b32 v247, s52
    s_bfe_u32 s60, s2, 0x10002
    s_lshl4_add_u32 s60, s68, s60
    s_sub_u32 s60, 0xffff, s60
    v_lshlrev_b32 v239, 1, v232
    v_sub_u32 v239, s60, v239
    v_lshlrev_b32 v243, 3, v232
    v_lshlrev_b32 v232, 4, v232
    v_mov_b32 v249, s52
    s_setprio 3
    s_waitcnt vmcnt(3)
    v_dot2_f32_bf16 v233, v212, v241, 0
    v_dot2_f32_bf16 v234, v212, v212, 0
    v_dot2_f32_bf16 v233, v213, v241, v233
    v_dot2_f32_bf16 v234, v213, v213, v234
    v_dot2_f32_bf16 v233, v214, v241, v233
    v_dot2_f32_bf16 v234, v214, v214, v234
    v_dot2_f32_bf16 v233, v215, v241, v233
    v_dot2_f32_bf16 v234, v215, v215, v234
    v_dot2_f32_bf16 v233, v216, v241, v233
    v_dot2_f32_bf16 v234, v216, v216, v234
    v_dot2_f32_bf16 v233, v217, v241, v233
    v_dot2_f32_bf16 v234, v217, v217, v234
    v_dot2_f32_bf16 v233, v218, v241, v233
    v_dot2_f32_bf16 v234, v218, v218, v234
    v_dot2_f32_bf16 v233, v219, v241, v233
    v_dot2_f32_bf16 v234, v219, v219, v234
    v_dot2_f32_bf16 v233, v220, v241, v233
    v_dot2_f32_bf16 v234, v220, v220, v234
    v_dot2_f32_bf16 v233, v221, v241, v233
    v_dot2_f32_bf16 v234, v221, v221, v234
    s_waitcnt vmcnt(0)
    v_dot2_f32_bf16 v235, v212, v222, 0
    v_dot2_f32_bf16 v236, v222, v241, 0
    v_dot2_f32_bf16 v235, v213, v223, v235
    v_dot2_f32_bf16 v236, v223, v241, v236
    v_dot2_f32_bf16 v235, v214, v224, v235
    v_dot2_f32_bf16 v236, v224, v241, v236
    v_dot2_f32_bf16 v235, v215, v225, v235
    v_dot2_f32_bf16 v236, v225, v241, v236
    v_dot2_f32_bf16 v235, v216, v226, v235
    v_dot2_f32_bf16 v236, v226, v241, v236
    v_dot2_f32_bf16 v235, v217, v227, v235
    v_dot2_f32_bf16 v236, v227, v241, v236
    v_dot2_f32_bf16 v235, v218, v228, v235
    v_dot2_f32_bf16 v236, v228, v241, v236
    v_dot2_f32_bf16 v235, v219, v229, v235
    v_dot2_f32_bf16 v236, v229, v241, v236
    v_dot2_f32_bf16 v235, v220, v230, v235
    v_dot2_f32_bf16 v236, v230, v241, v236
    v_dot2_f32_bf16 v235, v221, v231, v235
    v_dot2_f32_bf16 v236, v231, v241, v236
    v_permlane16_swap_b32 v233, v234
    v_add_f32 v233, v233, v234
    s_nop 0
    v_permlane16_swap_b32 v235, v236
    v_add_f32 v235, v235, v236
    v_add_f32_dpp v233, v233, v233 row_ror:8 row_mask:0xf bank_mask:0xf
    s_nop 0
    v_add_f32_dpp v235, v235, v235 row_ror:8 row_mask:0xf bank_mask:0xf
    v_add_f32_dpp v233, v233, v233 row_ror:4 row_mask:0xf bank_mask:0xf
    s_nop 0
    v_add_f32_dpp v235, v235, v235 row_ror:4 row_mask:0xf bank_mask:0xf
    v_add_f32_dpp v233, v233, v233 row_ror:2 row_mask:0xf bank_mask:0xf
    s_nop 0
    v_add_f32_dpp v235, v235, v235 row_ror:2 row_mask:0xf bank_mask:0xf
    v_add_f32_dpp v233, v233, v233 row_ror:1 row_mask:0xf bank_mask:0xf
    s_nop 0
    v_add_f32_dpp v235, v235, v235 row_ror:1 row_mask:0xf bank_mask:0xf
    v_mul_f32 v233, 0x3acccccd, v233
    v_mov_b32 v236, v235
    v_mov_b32 v234, v233
    s_nop 0
    v_permlane16_swap_b32 v235, v236
    v_permlane16_swap_b32 v233, v234
    v_fma_f32 v234, -v233, v233, v234
    v_max_f32 v234, 0, v234
    v_cvt_pk_bf16_f32 v237, v233, v234
    v_lshlrev_b32 v233, 16, v237
    v_and_b32 v234, 0xffff0000, v237
    v_add_f32 v234, 0x3727c5ac, v234
    v_cvt_pk_bf16_f32 v234, v234, v234
    v_lshlrev_b32 v234, 16, v234
    v_sqrt_f32 v234, v234
    v_fma_f32 v235, -v233, v236, v235
    v_cvt_pk_bf16_f32 v234, v234, v234
    v_lshlrev_b32 v234, 16, v234
    v_rcp_f32 v246, v234
    s_mov_b32 exec_lo, 1
    s_mov_b32 exec_hi, 1
    v_mul_f32 v235, v235, v246
    v_xor_b32 v244, 0x80000000, v233
    v_cvt_pk_bf16_f32 v235, v235, v235
    buffer_store_dwordx4 v[244:247], v232, s[28:31], s70 offen sc1
    v_ashrrev_i32 v237, 31, v235
    v_or_b32 v237, 0x80000000, v237
    v_xor_b32 v235, v235, v237
    v_bfi_b32 v248, s55, v235, v239
    buffer_store_dwordx2 v[248:249], v243, s[28:31], s71 offen sc1
    s_mov_b64 exec, -1
    s_setprio 0
    v_mov_b32 v252, s52
    v_mov_b32 v253, s52
    v_mov_b32 v254, s52
    v_mov_b32 v255, s52
    s_mov_b32 s63, 0
    s_mov_b32 s64, 77824
    s_mov_b32 s67, 38912
    s_waitcnt lgkmcnt(0)
    s_barrier
    ds_read_b64_tr_b16 v[132:133], v44 offset:0
    ds_read_b64_tr_b16 v[134:135], v44 offset:512
    ds_read_b128 v[156:159], v42 offset:0
    ds_read_b64_tr_b16 v[136:137], v44 offset:8192
    ds_read_b64_tr_b16 v[138:139], v44 offset:8704
    ds_read_b128 v[160:163], v42 offset:2048
    ds_read_b64_tr_b16 v[140:141], v44 offset:16384
    ds_read_b64_tr_b16 v[142:143], v44 offset:16896
    ds_read_b128 v[164:167], v42 offset:4096
    ds_read_b128 v[168:171], v42 offset:6144
    ds_read_b128 v[172:175], v42 offset:8192
    ds_read_b128 v[176:179], v42 offset:10240
    ds_read_b128 v[180:183], v42 offset:12288
C_LOOP:
    s_waitcnt lgkmcnt(10)
    v_mfma_f32_16x16x32_bf16 v[48:51], v[132:135], v[156:159], v[48:51]
    ds_read_b64_tr_b16 v[144:145], v44 offset:4096
    s_waitcnt lgkmcnt(9)
    v_mfma_f32_16x16x32_bf16 v[76:79], v[136:139], v[156:159], v[76:79]
    ds_read_b64_tr_b16 v[146:147], v44 offset:4608
    s_waitcnt lgkmcnt(9)
    v_mfma_f32_16x16x32_bf16 v[52:55], v[132:135], v[160:163], v[52:55]
    ds_read_b128 v[184:187], v43 offset:0
    v_mfma_f32_16x16x32_bf16 v[80:83], v[136:139], v[160:163], v[80:83]
    ds_read_b64_tr_b16 v[148:149], v44 offset:12288
    s_waitcnt lgkmcnt(9)
    v_mfma_f32_16x16x32_bf16 v[104:107], v[140:143], v[156:159], v[104:107]
    ds_read_b64_tr_b16 v[150:151], v44 offset:12800
    v_mfma_f32_16x16x32_bf16 v[108:111], v[140:143], v[160:163], v[108:111]
    ds_read_b128 v[188:191], v43 offset:2048
    s_waitcnt lgkmcnt(10)
    v_mfma_f32_16x16x32_bf16 v[56:59], v[132:135], v[164:167], v[56:59]
    ds_read_b64_tr_b16 v[152:153], v44 offset:20480
    v_mfma_f32_16x16x32_bf16 v[84:87], v[136:139], v[164:167], v[84:87]
    ds_read_b64_tr_b16 v[154:155], v44 offset:20992
    v_mfma_f32_16x16x32_bf16 v[112:115], v[140:143], v[164:167], v[112:115]
    ds_read_b128 v[192:195], v43 offset:4096
    s_waitcnt lgkmcnt(12)
    v_mfma_f32_16x16x32_bf16 v[60:63], v[132:135], v[168:171], v[60:63]
    ds_read_b128 v[196:199], v43 offset:6144
    v_mfma_f32_16x16x32_bf16 v[88:91], v[136:139], v[168:171], v[88:91]
    ds_read_b128 v[200:203], v43 offset:8192
    v_mfma_f32_16x16x32_bf16 v[116:119], v[140:143], v[168:171], v[116:119]
    ds_read_b128 v[204:207], v43 offset:10240
    s_waitcnt lgkmcnt(14)
    v_mfma_f32_16x16x32_bf16 v[64:67], v[132:135], v[172:175], v[64:67]
    ds_read_b128 v[208:211], v43 offset:12288
    v_mfma_f32_16x16x32_bf16 v[92:95], v[136:139], v[172:175], v[92:95]
    v_mfma_f32_16x16x32_bf16 v[120:123], v[140:143], v[172:175], v[120:123]
    s_cmp_eq_u32 s64, 77824
    s_cselect_b32 s66, 4294889472, s67
    s_waitcnt lgkmcnt(14)
    v_mfma_f32_16x16x32_bf16 v[68:71], v[132:135], v[176:179], v[68:71]
    s_add_u32 s64, s64, s66
    s_add_u32 s63, s63, 1
    v_mfma_f32_16x16x32_bf16 v[96:99], v[136:139], v[176:179], v[96:99]
    v_add_u32 v44, s66, v44
    v_mfma_f32_16x16x32_bf16 v[124:127], v[140:143], v[176:179], v[124:127]
    v_add_u32 v42, s66, v42
    s_waitcnt lgkmcnt(13)
    v_mfma_f32_16x16x32_bf16 v[72:75], v[132:135], v[180:183], v[72:75]
    v_add_u32 v43, s66, v43
    v_mfma_f32_16x16x32_bf16 v[100:103], v[136:139], v[180:183], v[100:103]
    s_cmp_lt_u32 s63, 9
    v_mfma_f32_16x16x32_bf16 v[128:131], v[140:143], v[180:183], v[128:131]
    s_waitcnt lgkmcnt(0)
    v_mfma_f32_16x16x32_bf16 v[48:51], v[144:147], v[184:187], v[48:51]
    v_mfma_f32_16x16x32_bf16 v[76:79], v[148:151], v[184:187], v[76:79]
    v_mfma_f32_16x16x32_bf16 v[104:107], v[152:155], v[184:187], v[104:107]
    v_mfma_f32_16x16x32_bf16 v[52:55], v[144:147], v[188:191], v[52:55]
    v_mfma_f32_16x16x32_bf16 v[80:83], v[148:151], v[188:191], v[80:83]
    v_mfma_f32_16x16x32_bf16 v[108:111], v[152:155], v[188:191], v[108:111]
    s_barrier
    ds_read_b64_tr_b16 v[132:133], v44 offset:0
    v_mfma_f32_16x16x32_bf16 v[56:59], v[144:147], v[192:195], v[56:59]
    ds_read_b64_tr_b16 v[134:135], v44 offset:512
    v_mfma_f32_16x16x32_bf16 v[84:87], v[148:151], v[192:195], v[84:87]
    ds_read_b128 v[156:159], v42 offset:0
    v_mfma_f32_16x16x32_bf16 v[112:115], v[152:155], v[192:195], v[112:115]
    ds_read_b64_tr_b16 v[136:137], v44 offset:8192
    v_mfma_f32_16x16x32_bf16 v[60:63], v[144:147], v[196:199], v[60:63]
    ds_read_b64_tr_b16 v[138:139], v44 offset:8704
    v_mfma_f32_16x16x32_bf16 v[88:91], v[148:151], v[196:199], v[88:91]
    ds_read_b128 v[160:163], v42 offset:2048
    v_mfma_f32_16x16x32_bf16 v[116:119], v[152:155], v[196:199], v[116:119]
    ds_read_b64_tr_b16 v[140:141], v44 offset:16384
    v_mfma_f32_16x16x32_bf16 v[64:67], v[144:147], v[200:203], v[64:67]
    ds_read_b64_tr_b16 v[142:143], v44 offset:16896
    v_mfma_f32_16x16x32_bf16 v[92:95], v[148:151], v[200:203], v[92:95]
    ds_read_b128 v[164:167], v42 offset:4096
    v_mfma_f32_16x16x32_bf16 v[120:123], v[152:155], v[200:203], v[120:123]
    ds_read_b128 v[168:171], v42 offset:6144
    v_mfma_f32_16x16x32_bf16 v[68:71], v[144:147], v[204:207], v[68:71]
    ds_read_b128 v[172:175], v42 offset:8192
    v_mfma_f32_16x16x32_bf16 v[96:99], v[148:151], v[204:207], v[96:99]
    ds_read_b128 v[176:179], v42 offset:10240
    v_mfma_f32_16x16x32_bf16 v[124:127], v[152:155], v[204:207], v[124:127]
    ds_read_b128 v[180:183], v42 offset:12288
    v_mfma_f32_16x16x32_bf16 v[72:75], v[144:147], v[208:211], v[72:75]
    v_mfma_f32_16x16x32_bf16 v[100:103], v[148:151], v[208:211], v[100:103]
    v_mfma_f32_16x16x32_bf16 v[128:131], v[152:155], v[208:211], v[128:131]
    s_cbranch_scc1 C_LOOP
TL0:
    s_cbranch_execz TL0_END
    s_setprio 2
    s_waitcnt lgkmcnt(10)
    v_mfma_f32_16x16x32_bf16 v[48:51], v[132:135], v[156:159], v[48:51]
    ds_read_b64_tr_b16 v[144:145], v44 offset:4096
    s_waitcnt lgkmcnt(9)
    v_mfma_f32_16x16x32_bf16 v[76:79], v[136:139], v[156:159], v[76:79]
    ds_read_b64_tr_b16 v[146:147], v44 offset:4608
    s_waitcnt lgkmcnt(9)
    v_mfma_f32_16x16x32_bf16 v[52:55], v[132:135], v[160:163], v[52:55]
    ds_read_b64_tr_b16 v[148:149], v44 offset:12288
    v_mfma_f32_16x16x32_bf16 v[80:83], v[136:139], v[160:163], v[80:83]
    ds_read_b64_tr_b16 v[150:151], v44 offset:12800
    s_waitcnt lgkmcnt(8)
    v_mfma_f32_16x16x32_bf16 v[56:59], v[132:135], v[164:167], v[56:59]
    ds_read_b128 v[184:187], v43 offset:0
    v_mfma_f32_16x16x32_bf16 v[84:87], v[136:139], v[164:167], v[84:87]
    ds_read_b128 v[188:191], v43 offset:2048
    s_waitcnt lgkmcnt(9)
    v_mfma_f32_16x16x32_bf16 v[60:63], v[132:135], v[168:171], v[60:63]
    ds_read_b128 v[192:195], v43 offset:4096
    v_mfma_f32_16x16x32_bf16 v[88:91], v[136:139], v[168:171], v[88:91]
    ds_read_b128 v[196:199], v43 offset:6144
    s_waitcnt lgkmcnt(10)
    v_mfma_f32_16x16x32_bf16 v[64:67], v[132:135], v[172:175], v[64:67]
    ds_read_b128 v[200:203], v43 offset:8192
    v_mfma_f32_16x16x32_bf16 v[92:95], v[136:139], v[172:175], v[92:95]
    ds_read_b128 v[204:207], v43 offset:10240
    s_waitcnt lgkmcnt(11)
    v_mfma_f32_16x16x32_bf16 v[68:71], v[132:135], v[176:179], v[68:71]
    ds_read_b128 v[208:211], v43 offset:12288
    v_mfma_f32_16x16x32_bf16 v[96:99], v[136:139], v[176:179], v[96:99]
    ds_read_b128 v[212:215], v45 offset:0
    s_waitcnt lgkmcnt(12)
    v_mfma_f32_16x16x32_bf16 v[72:75], v[132:135], v[180:183], v[72:75]
    ds_read_b128 v[216:219], v45 offset:256
    v_mfma_f32_16x16x32_bf16 v[100:103], v[136:139], v[180:183], v[100:103]
    ds_read_b128 v[220:223], v45 offset:512
    s_waitcnt lgkmcnt(7)
    v_mfma_f32_16x16x32_bf16 v[48:51], v[144:147], v[184:187], v[48:51]
    ds_read_b64_tr_b16 v[152:153], v44 offset:20480
    v_mfma_f32_16x16x32_bf16 v[76:79], v[148:151], v[184:187], v[76:79]
    ds_read_b64_tr_b16 v[154:155], v44 offset:20992
    v_mfma_f32_16x16x32_bf16 v[52:55], v[144:147], v[188:191], v[52:55]
    ds_read_b128 v[224:227], v45 offset:768
    s_waitcnt lgkmcnt(3)
    v_mfma_f32_16x16x32_bf16 v[80:83], v[148:151], v[188:191], v[80:83]
    ds_read_b128 v[228:231], v45 offset:1024
    v_mov_b32_dpp v240, v48 row_newbcast:0 row_mask:0xf bank_mask:0xf
    v_mov_b32_dpp v241, v49 row_newbcast:0 row_mask:0xf bank_mask:0xf
    v_mfma_f32_16x16x32_bf16 v[56:59], v[144:147], v[192:195], v[56:59]
    ds_read_b128 v[232:235], v45 offset:1280
    v_mov_b32_dpp v242, v50 row_newbcast:0 row_mask:0xf bank_mask:0xf
    v_mov_b32_dpp v243, v51 row_newbcast:0 row_mask:0xf bank_mask:0xf
    v_mfma_f32_16x16x32_bf16 v[84:87], v[148:151], v[192:195], v[84:87]
    ds_read_b128 v[236:239], v45 offset:1536
    v_mov_b32_dpp v244, v76 row_newbcast:0 row_mask:0xf bank_mask:0xf
    v_mov_b32_dpp v245, v77 row_newbcast:0 row_mask:0xf bank_mask:0xf
    v_mfma_f32_16x16x32_bf16 v[60:63], v[144:147], v[196:199], v[60:63]
    v_mov_b32_dpp v246, v78 row_newbcast:0 row_mask:0xf bank_mask:0xf
    v_mov_b32_dpp v247, v79 row_newbcast:0 row_mask:0xf bank_mask:0xf
    v_mfma_f32_16x16x32_bf16 v[88:91], v[148:151], v[196:199], v[88:91]
    v_fmac_f32 v48, v212, v240
    v_fmac_f32 v49, v212, v241
    v_mfma_f32_16x16x32_bf16 v[64:67], v[144:147], v[200:203], v[64:67]
    v_fmac_f32 v50, v212, v242
    v_fmac_f32 v51, v212, v243
    s_waitcnt lgkmcnt(0)
    v_mfma_f32_16x16x32_bf16 v[92:95], v[148:151], v[200:203], v[92:95]
    v_cvt_pk_bf16_f32 v48, v48, v49
    v_cvt_pk_bf16_f32 v49, v50, v51
    v_mfma_f32_16x16x32_bf16 v[68:71], v[144:147], v[204:207], v[68:71]
    ds_write_b64 v46, v[48:49] offset:128
    v_fmac_f32 v76, v212, v244
    v_mfma_f32_16x16x32_bf16 v[96:99], v[148:151], v[204:207], v[96:99]
    v_fmac_f32 v77, v212, v245
    v_fmac_f32 v78, v212, v246
    v_mfma_f32_16x16x32_bf16 v[72:75], v[144:147], v[208:211], v[72:75]
    v_fmac_f32 v79, v212, v247
    v_mul_f32 v76, v76, v214
    v_mfma_f32_16x16x32_bf16 v[100:103], v[148:151], v[208:211], v[100:103]
    v_mul_f32 v77, v77, v214
    v_mul_f32 v78, v78, v214
    v_mfma_f32_16x16x32_bf16 v[104:107], v[140:143], v[156:159], v[104:107]
    v_mul_f32 v79, v79, v214
    v_cvt_pk_bf16_f32 v76, v76, v77
    v_mfma_f32_16x16x32_bf16 v[108:111], v[140:143], v[160:163], v[108:111]
    v_cvt_pk_bf16_f32 v77, v78, v79
    ds_write_b64 v46, v[76:77] offset:0
    v_mfma_f32_16x16x32_bf16 v[104:107], v[152:155], v[184:187], v[104:107]
    v_fmac_f32 v52, v216, v240
    v_fmac_f32 v53, v216, v241
    v_mfma_f32_16x16x32_bf16 v[108:111], v[152:155], v[188:191], v[108:111]
    v_fmac_f32 v54, v216, v242
    v_fmac_f32 v55, v216, v243
    v_mfma_f32_16x16x32_bf16 v[112:115], v[140:143], v[164:167], v[112:115]
    v_cvt_pk_bf16_f32 v52, v52, v53
    v_cvt_pk_bf16_f32 v53, v54, v55
    v_mfma_f32_16x16x32_bf16 v[116:119], v[140:143], v[168:171], v[116:119]
    ds_write_b64 v46, v[52:53] offset:4352
    v_fmac_f32 v80, v216, v244
    v_mfma_f32_16x16x32_bf16 v[112:115], v[152:155], v[192:195], v[112:115]
    s_mov_b64 exec, 0xff
    buffer_store_dwordx4 v[252:255], v6, s[28:31], s98 offen sc1
    s_mov_b64 exec, -1
    v_fmac_f32 v81, v216, v245
    v_fmac_f32 v82, v216, v246
    v_mfma_f32_16x16x32_bf16 v[116:119], v[152:155], v[196:199], v[116:119]
    v_fmac_f32 v83, v216, v247
    v_mul_f32 v80, v80, v218
    v_mfma_f32_16x16x32_bf16 v[120:123], v[140:143], v[172:175], v[120:123]
    v_mul_f32 v81, v81, v218
    v_mul_f32 v82, v82, v218
    v_mfma_f32_16x16x32_bf16 v[124:127], v[140:143], v[176:179], v[124:127]
    v_mul_f32 v83, v83, v218
    v_cvt_pk_bf16_f32 v80, v80, v81
    v_mfma_f32_16x16x32_bf16 v[120:123], v[152:155], v[200:203], v[120:123]
    v_cvt_pk_bf16_f32 v81, v82, v83
    ds_write_b64 v46, v[80:81] offset:4224
    v_mfma_f32_16x16x32_bf16 v[124:127], v[152:155], v[204:207], v[124:127]
    v_fmac_f32 v56, v220, v240
    v_fmac_f32 v57, v220, v241
    v_mfma_f32_16x16x32_bf16 v[128:131], v[140:143], v[180:183], v[128:131]
    v_fmac_f32 v58, v220, v242
    v_fmac_f32 v59, v220, v243
    v_mfma_f32_16x16x32_bf16 v[128:131], v[152:155], v[208:211], v[128:131]
    v_cvt_pk_bf16_f32 v56, v56, v57
    v_cvt_pk_bf16_f32 v57, v58, v59
    ds_write_b64 v46, v[56:57] offset:8576
    v_fmac_f32 v84, v220, v244
    v_fmac_f32 v85, v220, v245
    v_fmac_f32 v86, v220, v246
    v_fmac_f32 v87, v220, v247
    v_mul_f32 v84, v84, v222
    v_mul_f32 v85, v85, v222
    v_mul_f32 v86, v86, v222
    v_mul_f32 v87, v87, v222
    v_cvt_pk_bf16_f32 v84, v84, v85
    v_cvt_pk_bf16_f32 v85, v86, v87
    ds_write_b64 v46, v[84:85] offset:8448
    v_pk_fma_f32 v[88:89], v[224:225], v[244:245], v[88:89] op_sel_hi:[0,1,1]
    v_pk_fma_f32 v[90:91], v[224:225], v[246:247], v[90:91] op_sel_hi:[0,1,1]
    v_pk_fma_f32 v[60:61], v[224:225], v[240:241], v[60:61] op_sel_hi:[0,1,1]
    v_pk_fma_f32 v[62:63], v[224:225], v[242:243], v[62:63] op_sel_hi:[0,1,1]
    v_pk_mul_f32 v[88:89], v[88:89], v[226:227] op_sel_hi:[1,0]
    v_pk_mul_f32 v[90:91], v[90:91], v[226:227] op_sel_hi:[1,0]
    v_cvt_pk_bf16_f32 v60, v60, v61
    v_cvt_pk_bf16_f32 v61, v62, v63
    ds_write_b64 v46, v[60:61] offset:12800
    v_cvt_pk_bf16_f32 v88, v88, v89
    v_cvt_pk_bf16_f32 v89, v90, v91
    ds_write_b64 v46, v[88:89] offset:12672
    v_pk_fma_f32 v[92:93], v[228:229], v[244:245], v[92:93] op_sel_hi:[0,1,1]
    v_pk_fma_f32 v[94:95], v[228:229], v[246:247], v[94:95] op_sel_hi:[0,1,1]
    v_pk_fma_f32 v[64:65], v[228:229], v[240:241], v[64:65] op_sel_hi:[0,1,1]
    v_pk_fma_f32 v[66:67], v[228:229], v[242:243], v[66:67] op_sel_hi:[0,1,1]
    v_pk_mul_f32 v[92:93], v[92:93], v[230:231] op_sel_hi:[1,0]
    v_pk_mul_f32 v[94:95], v[94:95], v[230:231] op_sel_hi:[1,0]
    v_cvt_pk_bf16_f32 v64, v64, v65
    v_cvt_pk_bf16_f32 v65, v66, v67
    ds_write_b64 v46, v[64:65] offset:17024
    v_cvt_pk_bf16_f32 v92, v92, v93
    v_cvt_pk_bf16_f32 v93, v94, v95
    ds_write_b64 v46, v[92:93] offset:16896
    v_pk_fma_f32 v[96:97], v[232:233], v[244:245], v[96:97] op_sel_hi:[0,1,1]
    v_pk_fma_f32 v[98:99], v[232:233], v[246:247], v[98:99] op_sel_hi:[0,1,1]
    v_pk_fma_f32 v[68:69], v[232:233], v[240:241], v[68:69] op_sel_hi:[0,1,1]
    v_pk_fma_f32 v[70:71], v[232:233], v[242:243], v[70:71] op_sel_hi:[0,1,1]
    v_pk_mul_f32 v[96:97], v[96:97], v[234:235] op_sel_hi:[1,0]
    v_pk_mul_f32 v[98:99], v[98:99], v[234:235] op_sel_hi:[1,0]
    v_cvt_pk_bf16_f32 v68, v68, v69
    v_cvt_pk_bf16_f32 v69, v70, v71
    ds_write_b64 v46, v[68:69] offset:21248
    v_cvt_pk_bf16_f32 v96, v96, v97
    v_cvt_pk_bf16_f32 v97, v98, v99
    ds_write_b64 v46, v[96:97] offset:21120
    v_pk_fma_f32 v[100:101], v[236:237], v[244:245], v[100:101] op_sel_hi:[0,1,1]
    v_pk_fma_f32 v[102:103], v[236:237], v[246:247], v[102:103] op_sel_hi:[0,1,1]
    v_pk_fma_f32 v[72:73], v[236:237], v[240:241], v[72:73] op_sel_hi:[0,1,1]
    v_pk_fma_f32 v[74:75], v[236:237], v[242:243], v[74:75] op_sel_hi:[0,1,1]
    v_pk_mul_f32 v[100:101], v[100:101], v[238:239] op_sel_hi:[1,0]
    v_pk_mul_f32 v[102:103], v[102:103], v[238:239] op_sel_hi:[1,0]
    v_cvt_pk_bf16_f32 v72, v72, v73
    v_cvt_pk_bf16_f32 v73, v74, v75
    ds_write_b64 v46, v[72:73] offset:25472
    v_cvt_pk_bf16_f32 v100, v100, v101
    v_cvt_pk_bf16_f32 v101, v102, v103
    ds_write_b64 v46, v[100:101] offset:25344
    s_waitcnt lgkmcnt(0)
    s_barrier
    ds_read_b64 v[80:81], v20 offset:0
    ds_read_b64 v[82:83], v21 offset:0
    ds_read_b64 v[64:65], v20 offset:4352
    ds_read_b64 v[66:67], v21 offset:4352
    ds_read_b64 v[84:85], v20 offset:4224
    ds_read_b64 v[86:87], v21 offset:4224
    ds_read_b64 v[68:69], v20 offset:8576
    ds_read_b64 v[70:71], v21 offset:8576
    ds_read_b64 v[88:89], v20 offset:8448
    ds_read_b64 v[90:91], v21 offset:8448
    ds_read_b64 v[72:73], v20 offset:12800
    ds_read_b64 v[74:75], v21 offset:12800
    ds_read_b64 v[92:93], v20 offset:12672
    ds_read_b64 v[94:95], v21 offset:12672
    v_lshl_add_u32 v3, v5, 8, v26
    v_mov_b32 v0, v27
    v_mov_b32_dpp v248, v104 row_newbcast:0 row_mask:0xf bank_mask:0xf
    v_mov_b32_dpp v249, v105 row_newbcast:0 row_mask:0xf bank_mask:0xf
    v_mov_b32_dpp v250, v106 row_newbcast:0 row_mask:0xf bank_mask:0xf
    v_mov_b32_dpp v251, v107 row_newbcast:0 row_mask:0xf bank_mask:0xf
    v_pk_fma_f32 v[104:105], v[212:213], v[248:249], v[104:105] op_sel_hi:[0,1,1]
    v_pk_fma_f32 v[106:107], v[212:213], v[250:251], v[106:107] op_sel_hi:[0,1,1]
    v_pk_fma_f32 v[108:109], v[216:217], v[248:249], v[108:109] op_sel_hi:[0,1,1]
    v_pk_fma_f32 v[110:111], v[216:217], v[250:251], v[110:111] op_sel_hi:[0,1,1]
    v_pk_mul_f32 v[104:105], v[104:105], v[214:215] op_sel_hi:[1,0]
    v_pk_mul_f32 v[106:107], v[106:107], v[214:215] op_sel_hi:[1,0]
    v_pk_mul_f32 v[108:109], v[108:109], v[218:219] op_sel_hi:[1,0]
    v_pk_mul_f32 v[110:111], v[110:111], v[218:219] op_sel_hi:[1,0]
    v_cvt_pk_bf16_f32 v104, v104, v105
    v_cvt_pk_bf16_f32 v105, v106, v107
    ds_write_b64 v47, v[104:105] offset:0
    v_cvt_pk_bf16_f32 v108, v108, v109
    v_cvt_pk_bf16_f32 v109, v110, v111
    ds_write_b64 v47, v[108:109] offset:2176
    s_waitcnt lgkmcnt(10)
    v_mfma_f32_16x16x32_bf16 v[168:171], v[84:87], v[64:67], v[32:35]
    v_mfma_f32_16x16x32_bf16 v[48:51], v[80:83], v[64:67], v[36:39]
    s_waitcnt lgkmcnt(6)
    v_mfma_f32_16x16x32_bf16 v[172:175], v[88:91], v[68:71], v[32:35]
    v_mfma_f32_16x16x32_bf16 v[52:55], v[84:87], v[68:71], v[36:39]
    s_waitcnt lgkmcnt(2)
    v_mfma_f32_16x16x32_bf16 v[176:179], v[92:95], v[72:75], v[32:35]
    v_mfma_f32_16x16x32_bf16 v[56:59], v[88:91], v[72:75], v[36:39]
    ds_read_b32 v27, v3
    ds_read2st64_b32 v[36:37], v26 offset1:1
    ds_read2st64_b32 v[38:39], v26 offset0:2 offset1:3
    v_max_f32 v168, v168, v48
    v_max_f32 v169, v169, v49
    v_max_f32 v170, v170, v50
    v_max_f32 v171, v171, v51
    v_max_f32 v172, v172, v52
    v_max_f32 v173, v173, v53
    v_max_f32 v174, v174, v54
    v_max_f32 v175, v175, v55
    v_max_f32 v176, v176, v56
    v_max_f32 v177, v177, v57
    v_max_f32 v178, v178, v58
    v_max_f32 v179, v179, v59
    s_cmp_lg_u32 s13, 1
    s_cbranch_scc1 AC_NS
    v_cvt_pk_bf16_f32 v64, v168, v169
    v_mov_b32 v65, s52
    v_cvt_pk_bf16_f32 v66, v170, v171
    v_mov_b32 v67, s52
    buffer_store_dwordx4 v[64:67], v6, s[28:31], s11 offen offset:0 sc1
    v_cvt_pk_bf16_f32 v68, v172, v173
    v_mov_b32 v69, s52
    v_cvt_pk_bf16_f32 v70, v174, v175
    v_mov_b32 v71, s52
    buffer_store_dwordx4 v[68:71], v6, s[28:31], s11 offen offset:1024 sc1
    v_cvt_pk_bf16_f32 v72, v176, v177
    v_mov_b32 v73, s52
    v_cvt_pk_bf16_f32 v74, v178, v179
    v_mov_b32 v75, s52
    buffer_store_dwordx4 v[72:75], v6, s[28:31], s11 offen offset:2048 sc1
AC_NS:
    v_pk_fma_f32 v[112:113], v[220:221], v[248:249], v[112:113] op_sel_hi:[0,1,1]
    v_pk_fma_f32 v[114:115], v[220:221], v[250:251], v[114:115] op_sel_hi:[0,1,1]
    v_pk_fma_f32 v[116:117], v[224:225], v[248:249], v[116:117] op_sel_hi:[0,1,1]
    v_pk_fma_f32 v[118:119], v[224:225], v[250:251], v[118:119] op_sel_hi:[0,1,1]
    v_pk_mul_f32 v[112:113], v[112:113], v[222:223] op_sel_hi:[1,0]
    v_pk_mul_f32 v[114:115], v[114:115], v[222:223] op_sel_hi:[1,0]
    v_pk_mul_f32 v[116:117], v[116:117], v[226:227] op_sel_hi:[1,0]
    v_pk_mul_f32 v[118:119], v[118:119], v[226:227] op_sel_hi:[1,0]
    v_cvt_pk_bf16_f32 v112, v112, v113
    v_cvt_pk_bf16_f32 v113, v114, v115
    ds_write_b64 v47, v[112:113] offset:4352
    v_cvt_pk_bf16_f32 v116, v116, v117
    v_cvt_pk_bf16_f32 v117, v118, v119
    ds_write_b64 v47, v[116:117] offset:6528
    v_pk_fma_f32 v[120:121], v[228:229], v[248:249], v[120:121] op_sel_hi:[0,1,1]
    v_pk_fma_f32 v[122:123], v[228:229], v[250:251], v[122:123] op_sel_hi:[0,1,1]
    v_pk_fma_f32 v[124:125], v[232:233], v[248:249], v[124:125] op_sel_hi:[0,1,1]
    v_pk_fma_f32 v[126:127], v[232:233], v[250:251], v[126:127] op_sel_hi:[0,1,1]
    v_pk_mul_f32 v[120:121], v[120:121], v[230:231] op_sel_hi:[1,0]
    v_pk_mul_f32 v[122:123], v[122:123], v[230:231] op_sel_hi:[1,0]
    v_pk_mul_f32 v[124:125], v[124:125], v[234:235] op_sel_hi:[1,0]
    v_pk_mul_f32 v[126:127], v[126:127], v[234:235] op_sel_hi:[1,0]
    v_cvt_pk_bf16_f32 v120, v120, v121
    v_cvt_pk_bf16_f32 v121, v122, v123
    ds_write_b64 v47, v[120:121] offset:8704
    v_cvt_pk_bf16_f32 v124, v124, v125
    v_cvt_pk_bf16_f32 v125, v126, v127
    ds_write_b64 v47, v[124:125] offset:10880
    v_pk_fma_f32 v[128:129], v[236:237], v[248:249], v[128:129] op_sel_hi:[0,1,1]
    v_pk_fma_f32 v[130:131], v[236:237], v[250:251], v[130:131] op_sel_hi:[0,1,1]
    v_pk_mul_f32 v[128:129], v[128:129], v[238:239] op_sel_hi:[1,0]
    v_pk_mul_f32 v[130:131], v[130:131], v[238:239] op_sel_hi:[1,0]
    v_cvt_pk_bf16_f32 v128, v128, v129
    v_cvt_pk_bf16_f32 v129, v130, v131
    ds_write_b64 v47, v[128:129] offset:13056
    s_waitcnt lgkmcnt(0)
    s_barrier
    ds_read_b64_tr_b16 v[184:185], v22 offset:0
    ds_read_b64_tr_b16 v[194:195], v23 offset:0
    ds_read_b64_tr_b16 v[186:187], v22 offset:2176
    ds_read_b64_tr_b16 v[196:197], v23 offset:2176
    ds_read_b64_tr_b16 v[188:189], v22 offset:4352
    ds_read_b64_tr_b16 v[198:199], v23 offset:4352
    ds_read_b64_tr_b16 v[190:191], v22 offset:6528
    ds_read_b64_tr_b16 v[200:201], v23 offset:6528
    s_cbranch_scc0 AC_X
AC_SM:
    v_max3_f32 v136, v168, v169, v170
    v_max3_f32 v138, v172, v173, v174
    v_max3_f32 v140, v176, v177, v178
    v_max_f32 v136, v136, v171
    v_max_f32 v138, v138, v175
    v_max_f32 v140, v140, v179
    s_nop 1
    v_permlane32_swap_b32 v136, v140
    v_permlane32_swap_b32 v138, v142
    v_max_f32 v136, v136, v140
    v_max_f32 v138, v138, v142
    v_mul_f32 v27, 0x3ea52b5c, v27
    s_nop 0
    v_permlane16_swap_b32 v136, v138
    v_max_f32 v136, v136, v138
    v_mul_f32 v138, v136, v27
    v_mul_f32 v136, v136, v27
    v_mul_f32 v32, 0x3ea52b5c, v36
    v_mul_f32 v34, 0x3ea52b5c, v37
    v_permlane16_swap_b32 v136, v138
    v_mov_b32 v140, v136
    v_mov_b32 v142, v138
    v_mul_f32 v36, 0x3ea52b5c, v38
    v_permlane32_swap_b32 v136, v140
    v_permlane32_swap_b32 v138, v142
    v_pk_fma_f32 v[168:169], v[168:169], v[32:33], v[136:137] op_sel_hi:[1,0,0] neg_lo:[0,0,1] neg_hi:[0,0,1]
    v_pk_fma_f32 v[170:171], v[170:171], v[32:33], v[136:137] op_sel_hi:[1,0,0] neg_lo:[0,0,1] neg_hi:[0,0,1]
    v_pk_fma_f32 v[172:173], v[172:173], v[34:35], v[138:139] op_sel_hi:[1,0,0] neg_lo:[0,0,1] neg_hi:[0,0,1]
    v_pk_fma_f32 v[174:175], v[174:175], v[34:35], v[138:139] op_sel_hi:[1,0,0] neg_lo:[0,0,1] neg_hi:[0,0,1]
    v_pk_fma_f32 v[176:177], v[176:177], v[36:37], v[140:141] op_sel_hi:[1,0,0] neg_lo:[0,0,1] neg_hi:[0,0,1]
    v_pk_fma_f32 v[178:179], v[178:179], v[36:37], v[140:141] op_sel_hi:[1,0,0] neg_lo:[0,0,1] neg_hi:[0,0,1]
    v_exp_f32 v168, v168
    v_exp_f32 v169, v169
    v_exp_f32 v170, v170
    v_exp_f32 v171, v171
    v_cvt_pk_bf16_f32 v2, v168, v169
    v_cvt_pk_bf16_f32 v3, v170, v171
    v_bfi_b32 v168, v40, 0, v2
    v_bfi_b32 v169, v41, 0, v3
    v_and_b32 v170, v40, v2
    v_and_b32 v171, v41, v3
    s_waitcnt lgkmcnt(0)
    v_exp_f32 v172, v172
    v_mfma_f32_16x16x32_bf16 v[116:119], v[28:31], v[168:171], 0
    v_exp_f32 v173, v173
    v_mfma_f32_16x16x32_bf16 v[136:139], v[184:187], v[168:171], 0
    v_exp_f32 v174, v174
    v_mfma_f32_16x16x32_bf16 v[152:155], v[194:197], v[168:171], 0
    v_exp_f32 v175, v175
    v_cvt_pk_bf16_f32 v2, v172, v173
    v_cvt_pk_bf16_f32 v3, v174, v175
    v_bfi_b32 v172, v40, 0, v2
    v_bfi_b32 v173, v41, 0, v3
    v_and_b32 v174, v40, v2
    v_and_b32 v175, v41, v3
    v_rcp_f32 v32, v116
    v_exp_f32 v176, v176
    v_mfma_f32_16x16x32_bf16 v[120:123], v[28:31], v[172:175], 0
    v_exp_f32 v177, v177
    v_mfma_f32_16x16x32_bf16 v[140:143], v[186:189], v[172:175], 0
    v_exp_f32 v178, v178
    v_mfma_f32_16x16x32_bf16 v[156:159], v[196:199], v[172:175], 0
    v_exp_f32 v179, v179
    v_cvt_pk_bf16_f32 v2, v176, v177
    v_cvt_pk_bf16_f32 v3, v178, v179
    v_bfi_b32 v176, v40, 0, v2
    v_bfi_b32 v177, v41, 0, v3
    v_and_b32 v178, v40, v2
    v_and_b32 v179, v41, v3
    v_rcp_f32 v34, v120
    v_mul_f32 v136, v136, v32
    v_mfma_f32_16x16x32_bf16 v[116:119], v[28:31], v[176:179], 0
    v_mul_f32 v137, v137, v32
    v_mfma_f32_16x16x32_bf16 v[144:147], v[188:191], v[176:179], 0
    v_mul_f32 v138, v138, v32
    v_mfma_f32_16x16x32_bf16 v[160:163], v[198:201], v[176:179], 0
    v_mul_f32 v139, v139, v32
    v_cvt_pk_bf16_f32 v136, v136, v137
    v_cvt_pk_bf16_f32 v137, v138, v139
    v_mul_f32 v140, v140, v34
    v_mul_f32 v141, v141, v34
    v_mul_f32 v142, v142, v34
    v_mul_f32 v143, v143, v34
    v_cvt_pk_bf16_f32 v138, v140, v141
    v_cvt_pk_bf16_f32 v139, v142, v143
    v_rcp_f32 v36, v116
    v_permlane32_swap_b32 v136, v138
    v_permlane32_swap_b32 v137, v139
    v_pk_mul_f32 v[144:145], v[144:145], v[36:37] op_sel_hi:[1,0]
    v_pk_mul_f32 v[146:147], v[146:147], v[36:37] op_sel_hi:[1,0]
    v_cvt_pk_bf16_f32 v144, v144, v145
    v_cvt_pk_bf16_f32 v145, v146, v147
    s_mov_b64 exec, s[14:15]
    buffer_store_dwordx4 v[136:139], v24, s[28:31], s9 offen sc1
    s_mov_b64 exec, -1
    v_permlane32_swap_b32 v144, v146
    v_permlane32_swap_b32 v145, v147
    v_pk_mul_f32 v[152:153], v[152:153], v[32:33] op_sel_hi:[1,0]
    v_pk_mul_f32 v[154:155], v[154:155], v[32:33] op_sel_hi:[1,0]
    s_mov_b64 exec, s[16:17]
    buffer_store_dwordx4 v[144:147], v24, s[28:31], s5 offen sc1
    s_lshl_b64 exec, -1, 16
    v_pk_mul_f32 v[152:153], v[156:157], v[34:35] op_sel_hi:[1,0]
    v_pk_mul_f32 v[154:155], v[158:159], v[34:35] op_sel_hi:[1,0]
    s_lshl_b64 exec, -1, 32
    v_pk_mul_f32 v[152:153], v[160:161], v[36:37] op_sel_hi:[1,0]
    v_pk_mul_f32 v[154:155], v[162:163], v[36:37] op_sel_hi:[1,0]
    s_mov_b64 exec, s[18:19]
    v_cvt_pk_bf16_f32 v152, v152, v153
    v_cvt_pk_bf16_f32 v153, v154, v155
    buffer_store_dwordx2 v[152:153], v25, s[28:31], s10 offen sc1
    s_mov_b64 exec, -1
A_DONE:
TC1:
    s_cbranch_execz TC2
    s_cmp_lg_u32 s13, 0
    s_cbranch_scc1 P_TAIL
    s_setprio 1
    v_mov_b32 v2, 1
    ds_write_b8 v18, v2 offset:0
    s_cmp_eq_u32 s101, 0
    s_cbranch_scc1 K_END
    v_xor_b32 v28, 32, v8
    v_xor_b32 v29, 64, v8
    v_xor_b32 v30, 96, v8
    ds_read_b64 v[48:49], v8 offset:0
    ds_read_b64 v[50:51], v28 offset:0
    ds_read_b64 v[52:53], v29 offset:0
    ds_read_b64 v[54:55], v30 offset:0
    ds_read_b64 v[56:57], v8 offset:2048
    ds_read_b64 v[58:59], v28 offset:2048
    ds_read_b64 v[60:61], v29 offset:2048
    ds_read_b64 v[62:63], v30 offset:2048
    s_cmp_eq_u32 s101, 2
    s_cselect_b32 s60, 0, 2146435072
    s_add_u32 s60, s60, 20480
    v_add_u32 v31, s60, v6
    s_mov_b32 s100, 0
    v_xor_b32 v28, 32, v9
    v_xor_b32 v29, 64, v9
    v_xor_b32 v30, 96, v9
    ds_read_b64_tr_b16 v[160:161], v9 offset:0
    ds_read_b64_tr_b16 v[164:165], v28 offset:0
    ds_read_b64_tr_b16 v[168:169], v29 offset:0
    ds_read_b64_tr_b16 v[172:173], v30 offset:0
    ds_read_b64_tr_b16 v[162:163], v9 offset:1024
    ds_read_b64_tr_b16 v[166:167], v28 offset:1024
    ds_read_b64_tr_b16 v[170:171], v29 offset:1024
    ds_read_b64_tr_b16 v[174:175], v30 offset:1024
    s_waitcnt lgkmcnt(8)
    v_lshlrev_b32 v64, 16, v48
    ds_read_b64_tr_b16 v[176:177], v29 offset:7680
    v_and_b32 v65, 0xffff0000, v48
    ds_read_b64_tr_b16 v[180:181], v30 offset:7680
    v_lshlrev_b32 v66, 16, v49
    ds_read_b64_tr_b16 v[184:185], v9 offset:7680
    v_and_b32 v67, 0xffff0000, v49
    ds_read_b64_tr_b16 v[188:189], v28 offset:7680
    v_lshlrev_b32 v68, 16, v50
    ds_read_b64_tr_b16 v[178:179], v29 offset:8704
    v_and_b32 v69, 0xffff0000, v50
    ds_read_b64_tr_b16 v[182:183], v30 offset:8704
    v_lshlrev_b32 v70, 16, v51
    ds_read_b64_tr_b16 v[186:187], v9 offset:8704
    v_and_b32 v71, 0xffff0000, v51
    ds_read_b64_tr_b16 v[190:191], v28 offset:8704
    v_lshlrev_b32 v72, 16, v52
    ds_read_b64_tr_b16 v[192:193], v9 offset:15360
    v_and_b32 v73, 0xffff0000, v52
    ds_read_b64_tr_b16 v[196:197], v28 offset:15360
    v_lshlrev_b32 v74, 16, v53
    ds_read_b64_tr_b16 v[200:201], v29 offset:15360
    v_and_b32 v75, 0xffff0000, v53
    ds_read_b64_tr_b16 v[204:205], v30 offset:15360
    v_lshlrev_b32 v76, 16, v54
    ds_read_b64_tr_b16 v[194:195], v9 offset:16384
    v_and_b32 v77, 0xffff0000, v54
    ds_read_b64_tr_b16 v[198:199], v28 offset:16384
    v_lshlrev_b32 v78, 16, v55
    ds_read_b64_tr_b16 v[202:203], v29 offset:16384
    v_and_b32 v79, 0xffff0000, v55
    ds_read_b64_tr_b16 v[206:207], v30 offset:16384
    v_lshlrev_b32 v80, 16, v56
    ds_read_b64_tr_b16 v[208:209], v29 offset:23040
    v_and_b32 v81, 0xffff0000, v56
    ds_read_b64_tr_b16 v[212:213], v30 offset:23040
    v_lshlrev_b32 v82, 16, v57
    ds_read_b64_tr_b16 v[216:217], v9 offset:23040
    v_and_b32 v83, 0xffff0000, v57
    ds_read_b64_tr_b16 v[220:221], v28 offset:23040
    v_lshlrev_b32 v84, 16, v58
    ds_read_b64_tr_b16 v[210:211], v29 offset:24064
    v_and_b32 v85, 0xffff0000, v58
    ds_read_b64_tr_b16 v[214:215], v30 offset:24064
    v_lshlrev_b32 v86, 16, v59
    ds_read_b64_tr_b16 v[218:219], v9 offset:24064
    v_and_b32 v87, 0xffff0000, v59
    ds_read_b64_tr_b16 v[222:223], v28 offset:24064
    v_lshlrev_b32 v88, 16, v60
    ds_read_b64_tr_b16 v[224:225], v9 offset:30720
    v_and_b32 v89, 0xffff0000, v60
    ds_read_b64_tr_b16 v[228:229], v28 offset:30720
    v_lshlrev_b32 v90, 16, v61
    ds_read_b64_tr_b16 v[232:233], v29 offset:30720
    v_and_b32 v91, 0xffff0000, v61
    ds_read_b64_tr_b16 v[236:237], v30 offset:30720
    v_lshlrev_b32 v92, 16, v62
    ds_read_b64_tr_b16 v[226:227], v9 offset:31744
    v_and_b32 v93, 0xffff0000, v62
    ds_read_b64_tr_b16 v[230:231], v28 offset:31744
    v_lshlrev_b32 v94, 16, v63
    ds_read_b64_tr_b16 v[234:235], v29 offset:31744
    v_and_b32 v95, 0xffff0000, v63
    ds_read_b64_tr_b16 v[238:239], v30 offset:31744
    v_xor_b32 v28, 32, v10
    v_xor_b32 v29, 64, v10
    v_xor_b32 v30, 96, v10
    ds_read_b64_tr_b16 v[240:241], v10 offset:0
    ds_read_b64_tr_b16 v[244:245], v28 offset:0
    ds_read_b64_tr_b16 v[248:249], v29 offset:0
    ds_read_b64_tr_b16 v[252:253], v30 offset:0
    ds_read_b64_tr_b16 v[242:243], v10 offset:1024
    ds_read_b64_tr_b16 v[246:247], v28 offset:1024
    ds_read_b64_tr_b16 v[250:251], v29 offset:1024
    ds_read_b64_tr_b16 v[254:255], v30 offset:1024
    s_cmp_lt_u32 s3, 4
    s_cbranch_scc1 G_NOS
    s_sleep 6
G_NOS:
    buffer_load_dwordx4 v[96:99], v0, s[28:31], s96 offen offset:0 sc1
    buffer_load_dwordx4 v[100:103], v31, s[28:31], s96 offen offset:0 sc1
    buffer_load_dwordx4 v[104:107], v0, s[28:31], s96 offen offset:1024 sc1
    buffer_load_dwordx4 v[108:111], v31, s[28:31], s96 offen offset:1024 sc1
    buffer_load_dwordx4 v[112:115], v0, s[28:31], s96 offen offset:2048 sc1
    buffer_load_dwordx4 v[116:119], v31, s[28:31], s96 offen offset:2048 sc1
    buffer_load_dwordx4 v[120:123], v0, s[28:31], s96 offen offset:3072 sc1
    buffer_load_dwordx4 v[124:127], v31, s[28:31], s96 offen offset:3072 sc1
    s_waitcnt vmcnt(6)
    v_max3_u32 v2, v96, v98, v100
    v_max_u32 v2, v2, v102
    v_cmp_eq_u32 vcc, -1, v2
    s_waitcnt lgkmcnt(15)
    s_cbranch_vccnz G2_R0
G2_OK0:
    v_mfma_f32_16x16x32_bf16 v[32:35], v[160:163], v[96:99], 0
    ds_read_b64 v[24:25], v19 offset:16
    buffer_load_dwordx4 v[128:131], v0, s[28:31], s92 offen offset:0 sc1
    v_mfma_f32_16x16x32_bf16 v[48:51], v[160:163], v[100:103], 0
    buffer_load_dwordx4 v[132:135], v31, s[28:31], s92 offen offset:0 sc1
    v_mfma_f32_16x16x32_bf16 v[36:39], v[164:167], v[96:99], 0
    v_mfma_f32_16x16x32_bf16 v[52:55], v[164:167], v[100:103], 0
    s_waitcnt vmcnt(6)
    v_max3_u32 v2, v104, v106, v108
    v_mfma_f32_16x16x32_bf16 v[40:43], v[168:171], v[96:99], 0
    v_max_u32 v2, v2, v110
    v_mfma_f32_16x16x32_bf16 v[56:59], v[168:171], v[100:103], 0
    v_cmp_eq_u32 vcc, -1, v2
    v_mfma_f32_16x16x32_bf16 v[44:47], v[172:175], v[96:99], 0
    s_waitcnt lgkmcnt(0)
    v_mfma_f32_16x16x32_bf16 v[60:63], v[172:175], v[100:103], 0
    s_cbranch_vccnz G2_R1
G2_OK1:
    v_mfma_f32_16x16x32_bf16 v[32:35], v[176:179], v[104:107], v[32:35]
    v_xor_b32 v28, 32, v11
    v_xor_b32 v29, 64, v11
    v_and_b32 v3, v24, v25
    v_cmp_ne_u32 vcc, 0x01010101, v3
    v_mfma_f32_16x16x32_bf16 v[48:51], v[176:179], v[108:111], v[48:51]
    v_xor_b32 v30, 96, v11
    s_cbranch_vccnz G2_ZAR
G2_ZAOK:
    v_mfma_f32_16x16x32_bf16 v[36:39], v[180:183], v[104:107], v[36:39]
    ds_read_b64_tr_b16 v[160:161], v11 offset:0
    ds_read_b64_tr_b16 v[164:165], v28 offset:0
    buffer_load_dwordx4 v[136:139], v0, s[28:31], s92 offen offset:1024 sc1
    v_mfma_f32_16x16x32_bf16 v[52:55], v[180:183], v[108:111], v[52:55]
    ds_read_b64_tr_b16 v[168:169], v29 offset:0
    buffer_load_dwordx4 v[140:143], v31, s[28:31], s92 offen offset:1024 sc1
    s_waitcnt vmcnt(6)
    v_max3_u32 v2, v112, v114, v116
    v_mfma_f32_16x16x32_bf16 v[40:43], v[184:187], v[104:107], v[40:43]
    ds_read_b64_tr_b16 v[172:173], v30 offset:0
    v_max_u32 v2, v2, v118
    v_mfma_f32_16x16x32_bf16 v[56:59], v[184:187], v[108:111], v[56:59]
    ds_read_b64_tr_b16 v[162:163], v11 offset:15360
    ds_read_b64_tr_b16 v[166:167], v28 offset:15360
    v_cmp_eq_u32 vcc, -1, v2
    v_mfma_f32_16x16x32_bf16 v[44:47], v[188:191], v[104:107], v[44:47]
    ds_read_b64_tr_b16 v[170:171], v29 offset:15360
    v_mfma_f32_16x16x32_bf16 v[60:63], v[188:191], v[108:111], v[60:63]
    ds_read_b64_tr_b16 v[174:175], v30 offset:15360
    s_cbranch_vccnz G2_R2
G2_OK2:
    v_mfma_f32_16x16x32_bf16 v[32:35], v[192:195], v[112:115], v[32:35]
    v_add_u32 v9, 40960, v9
    v_xor_b32 v28, 32, v9
    buffer_load_dwordx4 v[144:147], v0, s[28:31], s92 offen offset:2048 sc1
    v_mfma_f32_16x16x32_bf16 v[48:51], v[192:195], v[116:119], v[48:51]
    v_xor_b32 v29, 64, v9
    buffer_load_dwordx4 v[148:151], v31, s[28:31], s92 offen offset:2048 sc1
    v_mfma_f32_16x16x32_bf16 v[36:39], v[196:199], v[112:115], v[36:39]
    v_xor_b32 v30, 96, v9
    ds_read_b64_tr_b16 v[176:177], v9 offset:0
    v_mfma_f32_16x16x32_bf16 v[52:55], v[196:199], v[116:119], v[52:55]
    ds_read_b64_tr_b16 v[180:181], v28 offset:0
    s_waitcnt vmcnt(6)
    v_max3_u32 v2, v120, v122, v124
    v_mfma_f32_16x16x32_bf16 v[40:43], v[200:203], v[112:115], v[40:43]
    ds_read_b64_tr_b16 v[184:185], v29 offset:0
    ds_read_b64_tr_b16 v[188:189], v30 offset:0
    v_max_u32 v2, v2, v126
    v_mfma_f32_16x16x32_bf16 v[56:59], v[200:203], v[116:119], v[56:59]
    ds_read_b64_tr_b16 v[178:179], v9 offset:1024
    v_cmp_eq_u32 vcc, -1, v2
    v_mfma_f32_16x16x32_bf16 v[44:47], v[204:207], v[112:115], v[44:47]
    ds_read_b64_tr_b16 v[182:183], v28 offset:1024
    ds_read_b64_tr_b16 v[186:187], v29 offset:1024
    v_mfma_f32_16x16x32_bf16 v[60:63], v[204:207], v[116:119], v[60:63]
    ds_read_b64_tr_b16 v[190:191], v30 offset:1024
    s_cbranch_vccnz G2_R3
G2_OK3:
    v_mfma_f32_16x16x32_bf16 v[32:35], v[208:211], v[120:123], v[32:35]
    ds_read_b64_tr_b16 v[192:193], v29 offset:7680
    buffer_load_dwordx4 v[152:155], v0, s[28:31], s4 offen offset:0 sc1
    v_mfma_f32_16x16x32_bf16 v[48:51], v[208:211], v[124:127], v[48:51]
    ds_read_b64_tr_b16 v[196:197], v30 offset:7680
    buffer_load_dwordx4 v[156:159], v31, s[28:31], s4 offen offset:0 sc1
    v_mfma_f32_16x16x32_bf16 v[36:39], v[212:215], v[120:123], v[36:39]
    ds_read_b64_tr_b16 v[200:201], v9 offset:7680
    v_mfma_f32_16x16x32_bf16 v[52:55], v[212:215], v[124:127], v[52:55]
    ds_read_b64_tr_b16 v[204:205], v28 offset:7680
    s_waitcnt vmcnt(6)
    v_max3_u32 v2, v128, v130, v132
    v_mfma_f32_16x16x32_bf16 v[40:43], v[216:219], v[120:123], v[40:43]
    ds_read_b64_tr_b16 v[194:195], v29 offset:8704
    v_max_u32 v2, v2, v134
    v_mfma_f32_16x16x32_bf16 v[56:59], v[216:219], v[124:127], v[56:59]
    ds_read_b64_tr_b16 v[198:199], v30 offset:8704
    v_cmp_eq_u32 vcc, -1, v2
    v_mfma_f32_16x16x32_bf16 v[44:47], v[220:223], v[120:123], v[44:47]
    ds_read_b64_tr_b16 v[202:203], v9 offset:8704
    v_mfma_f32_16x16x32_bf16 v[60:63], v[220:223], v[124:127], v[60:63]
    ds_read_b64_tr_b16 v[206:207], v28 offset:8704
    s_cbranch_vccnz G2_R4
G2_OK4:
    v_mfma_f32_16x16x32_bf16 v[32:35], v[224:227], v[128:131], v[32:35]
    ds_read_b64_tr_b16 v[208:209], v9 offset:15360
    buffer_load_dwordx4 v[96:99], v0, s[28:31], s4 offen offset:1024 sc1
    v_mfma_f32_16x16x32_bf16 v[48:51], v[224:227], v[132:135], v[48:51]
    ds_read_b64_tr_b16 v[212:213], v28 offset:15360
    buffer_load_dwordx4 v[100:103], v31, s[28:31], s4 offen offset:1024 sc1
    v_mfma_f32_16x16x32_bf16 v[36:39], v[228:231], v[128:131], v[36:39]
    ds_read_b64_tr_b16 v[216:217], v29 offset:15360
    v_mfma_f32_16x16x32_bf16 v[52:55], v[228:231], v[132:135], v[52:55]
    ds_read_b64_tr_b16 v[220:221], v30 offset:15360
    s_waitcnt vmcnt(6)
    v_max3_u32 v2, v136, v138, v140
    v_mfma_f32_16x16x32_bf16 v[40:43], v[232:235], v[128:131], v[40:43]
    ds_read_b64_tr_b16 v[210:211], v9 offset:16384
    v_max_u32 v2, v2, v142
    v_mfma_f32_16x16x32_bf16 v[56:59], v[232:235], v[132:135], v[56:59]
    ds_read_b64_tr_b16 v[214:215], v28 offset:16384
    v_cmp_eq_u32 vcc, -1, v2
    v_mfma_f32_16x16x32_bf16 v[44:47], v[236:239], v[128:131], v[44:47]
    ds_read_b64_tr_b16 v[218:219], v29 offset:16384
    v_mfma_f32_16x16x32_bf16 v[60:63], v[236:239], v[132:135], v[60:63]
    ds_read_b64_tr_b16 v[222:223], v30 offset:16384
    s_cbranch_vccnz G2_R5
G2_OK5:
    v_mfma_f32_16x16x32_bf16 v[32:35], v[240:243], v[136:139], v[32:35]
    ds_read_b64_tr_b16 v[224:225], v29 offset:23040
    buffer_load_dwordx4 v[104:107], v0, s[28:31], s4 offen offset:2048 sc1
    v_mfma_f32_16x16x32_bf16 v[48:51], v[240:243], v[140:143], v[48:51]
    ds_read_b64_tr_b16 v[228:229], v30 offset:23040
    buffer_load_dwordx4 v[108:111], v31, s[28:31], s4 offen offset:2048 sc1
    v_mfma_f32_16x16x32_bf16 v[36:39], v[244:247], v[136:139], v[36:39]
    ds_read_b64_tr_b16 v[232:233], v9 offset:23040
    v_mfma_f32_16x16x32_bf16 v[52:55], v[244:247], v[140:143], v[52:55]
    ds_read_b64_tr_b16 v[236:237], v28 offset:23040
    s_waitcnt vmcnt(6)
    v_max3_u32 v2, v144, v146, v148
    v_mfma_f32_16x16x32_bf16 v[40:43], v[248:251], v[136:139], v[40:43]
    ds_read_b64_tr_b16 v[226:227], v29 offset:24064
    v_max_u32 v2, v2, v150
    v_mfma_f32_16x16x32_bf16 v[56:59], v[248:251], v[140:143], v[56:59]
    ds_read_b64_tr_b16 v[230:231], v30 offset:24064
    v_cmp_eq_u32 vcc, -1, v2
    v_mfma_f32_16x16x32_bf16 v[44:47], v[252:255], v[136:139], v[44:47]
    ds_read_b64_tr_b16 v[234:235], v9 offset:24064
    s_waitcnt lgkmcnt(15)
    v_mfma_f32_16x16x32_bf16 v[60:63], v[252:255], v[140:143], v[60:63]
    ds_read_b64_tr_b16 v[238:239], v28 offset:24064
    s_cbranch_vccnz G2_R6
G2_OK6:
    v_mfma_f32_16x16x32_bf16 v[32:35], v[160:163], v[144:147], v[32:35]
    ds_read_b64 v[24:25], v19 offset:0
    ds_read_b64_tr_b16 v[240:241], v9 offset:30720
    buffer_load_dwordx4 v[112:115], v0, s[28:31], s4 offen offset:3072 sc1
    v_mfma_f32_16x16x32_bf16 v[48:51], v[160:163], v[148:151], v[48:51]
    ds_read_b64_tr_b16 v[244:245], v28 offset:30720
    buffer_load_dwordx4 v[116:119], v31, s[28:31], s4 offen offset:3072 sc1
    v_mfma_f32_16x16x32_bf16 v[36:39], v[164:167], v[144:147], v[36:39]
    ds_read_b64_tr_b16 v[248:249], v29 offset:30720
    v_mfma_f32_16x16x32_bf16 v[52:55], v[164:167], v[148:151], v[52:55]
    ds_read_b64_tr_b16 v[252:253], v30 offset:30720
    s_waitcnt vmcnt(6)
    v_max3_u32 v2, v152, v154, v156
    v_mfma_f32_16x16x32_bf16 v[40:43], v[168:171], v[144:147], v[40:43]
    ds_read_b64_tr_b16 v[242:243], v9 offset:31744
    v_max_u32 v2, v2, v158
    v_mfma_f32_16x16x32_bf16 v[56:59], v[168:171], v[148:151], v[56:59]
    ds_read_b64_tr_b16 v[246:247], v28 offset:31744
    v_cmp_eq_u32 vcc, -1, v2
    v_mfma_f32_16x16x32_bf16 v[44:47], v[172:175], v[144:147], v[44:47]
    ds_read_b64_tr_b16 v[250:251], v29 offset:31744
    s_waitcnt lgkmcnt(7)
    v_mfma_f32_16x16x32_bf16 v[60:63], v[172:175], v[148:151], v[60:63]
    ds_read_b64_tr_b16 v[254:255], v30 offset:31744
    s_cbranch_vccnz G2_R7
G2_OK7:
    v_mfma_f32_16x16x32_bf16 v[32:35], v[176:179], v[152:155], v[32:35]
    v_xor_b32 v28, 32, v10
    v_xor_b32 v29, 64, v10
    v_and_b32 v3, v24, v25
    v_cmp_ne_u32 vcc, 0x01010101, v3
    v_mfma_f32_16x16x32_bf16 v[48:51], v[176:179], v[156:159], v[48:51]
    v_xor_b32 v30, 96, v10
    s_cbranch_vccnz G2_ZLR
G2_ZLOK:
    v_mfma_f32_16x16x32_bf16 v[36:39], v[180:183], v[152:155], v[36:39]
    ds_read_b64_tr_b16 v[160:161], v10 offset:40960
    ds_read_b64_tr_b16 v[164:165], v28 offset:40960
    buffer_load_dwordx4 v[120:123], v0, s[28:31], s6 offen offset:0 sc1
    v_mfma_f32_16x16x32_bf16 v[52:55], v[180:183], v[156:159], v[52:55]
    ds_read_b64_tr_b16 v[168:169], v29 offset:40960
    buffer_load_dwordx4 v[124:127], v31, s[28:31], s6 offen offset:0 sc1
    s_waitcnt vmcnt(6)
    v_max3_u32 v2, v96, v98, v100
    v_mfma_f32_16x16x32_bf16 v[40:43], v[184:187], v[152:155], v[40:43]
    ds_read_b64_tr_b16 v[172:173], v30 offset:40960
    v_max_u32 v2, v2, v102
    v_mfma_f32_16x16x32_bf16 v[56:59], v[184:187], v[156:159], v[56:59]
    ds_read_b64_tr_b16 v[162:163], v10 offset:41984
    ds_read_b64_tr_b16 v[166:167], v28 offset:41984
    v_cmp_eq_u32 vcc, -1, v2
    v_mfma_f32_16x16x32_bf16 v[44:47], v[188:191], v[152:155], v[44:47]
    ds_read_b64_tr_b16 v[170:171], v29 offset:41984
    v_mfma_f32_16x16x32_bf16 v[60:63], v[188:191], v[156:159], v[60:63]
    ds_read_b64_tr_b16 v[174:175], v30 offset:41984
    s_cbranch_vccnz G2_R8
G2_OK8:
    v_mfma_f32_16x16x32_bf16 v[32:35], v[192:195], v[96:99], v[32:35]
    v_xor_b32 v28, 32, v11
    v_xor_b32 v29, 64, v11
    buffer_load_dwordx4 v[128:131], v0, s[28:31], s6 offen offset:1024 sc1
    v_mfma_f32_16x16x32_bf16 v[48:51], v[192:195], v[100:103], v[48:51]
    v_xor_b32 v30, 96, v11
    buffer_load_dwordx4 v[132:135], v31, s[28:31], s6 offen offset:1024 sc1
    v_mfma_f32_16x16x32_bf16 v[36:39], v[196:199], v[96:99], v[36:39]
    ds_read_b64_tr_b16 v[176:177], v11 offset:40960
    ds_read_b64_tr_b16 v[180:181], v28 offset:40960
    v_mfma_f32_16x16x32_bf16 v[52:55], v[196:199], v[100:103], v[52:55]
    ds_read_b64_tr_b16 v[184:185], v29 offset:40960
    s_waitcnt vmcnt(6)
    v_max3_u32 v2, v104, v106, v108
    v_mfma_f32_16x16x32_bf16 v[40:43], v[200:203], v[96:99], v[40:43]
    ds_read_b64_tr_b16 v[188:189], v30 offset:40960
    v_max_u32 v2, v2, v110
    v_mfma_f32_16x16x32_bf16 v[56:59], v[200:203], v[100:103], v[56:59]
    ds_read_b64_tr_b16 v[178:179], v11 offset:56320
    ds_read_b64_tr_b16 v[182:183], v28 offset:56320
    v_cmp_eq_u32 vcc, -1, v2
    v_mfma_f32_16x16x32_bf16 v[44:47], v[204:207], v[96:99], v[44:47]
    ds_read_b64_tr_b16 v[186:187], v29 offset:56320
    v_mfma_f32_16x16x32_bf16 v[60:63], v[204:207], v[100:103], v[60:63]
    ds_read_b64_tr_b16 v[190:191], v30 offset:56320
    s_cbranch_vccnz G2_R9
G2_OK9:
    v_mfma_f32_16x16x32_bf16 v[32:35], v[208:211], v[104:107], v[32:35]
    v_xor_b32 v28, 32, v13
    v_xor_b32 v29, 64, v13
    buffer_load_dwordx4 v[136:139], v0, s[28:31], s6 offen offset:2048 sc1
    v_mfma_f32_16x16x32_bf16 v[48:51], v[208:211], v[108:111], v[48:51]
    v_xor_b32 v30, 96, v13
    buffer_load_dwordx4 v[140:143], v31, s[28:31], s6 offen offset:2048 sc1
    v_mfma_f32_16x16x32_bf16 v[36:39], v[212:215], v[104:107], v[36:39]
    ds_read_b64_tr_b16 v[192:193], v13 offset:0
    ds_read_b64_tr_b16 v[196:197], v28 offset:0
    v_mfma_f32_16x16x32_bf16 v[52:55], v[212:215], v[108:111], v[52:55]
    ds_read_b64_tr_b16 v[200:201], v29 offset:0
    s_waitcnt vmcnt(6)
    v_max3_u32 v2, v112, v114, v116
    v_mfma_f32_16x16x32_bf16 v[40:43], v[216:219], v[104:107], v[40:43]
    ds_read_b64_tr_b16 v[204:205], v30 offset:0
    v_max_u32 v2, v2, v118
    v_mfma_f32_16x16x32_bf16 v[56:59], v[216:219], v[108:111], v[56:59]
    ds_read_b64_tr_b16 v[194:195], v13 offset:1024
    ds_read_b64_tr_b16 v[198:199], v28 offset:1024
    v_cmp_eq_u32 vcc, -1, v2
    v_mfma_f32_16x16x32_bf16 v[44:47], v[220:223], v[104:107], v[44:47]
    ds_read_b64_tr_b16 v[202:203], v29 offset:1024
    v_mfma_f32_16x16x32_bf16 v[60:63], v[220:223], v[108:111], v[60:63]
    ds_read_b64_tr_b16 v[206:207], v30 offset:1024
    s_cbranch_vccnz G2_R10
G2_OK10:
    v_mfma_f32_16x16x32_bf16 v[32:35], v[224:227], v[112:115], v[32:35]
    ds_read_b64_tr_b16 v[208:209], v13 offset:40960
    buffer_load_dwordx4 v[144:147], v0, s[28:31], s93 offen offset:0 sc1
    v_mfma_f32_16x16x32_bf16 v[48:51], v[224:227], v[116:119], v[48:51]
    ds_read_b64_tr_b16 v[212:213], v28 offset:40960
    buffer_load_dwordx4 v[148:151], v31, s[28:31], s93 offen offset:0 sc1
    v_mfma_f32_16x16x32_bf16 v[36:39], v[228:231], v[112:115], v[36:39]
    ds_read_b64_tr_b16 v[216:217], v29 offset:40960
    v_mfma_f32_16x16x32_bf16 v[52:55], v[228:231], v[116:119], v[52:55]
    ds_read_b64_tr_b16 v[220:221], v30 offset:40960
    s_waitcnt vmcnt(6)
    v_max3_u32 v2, v120, v122, v124
    v_mfma_f32_16x16x32_bf16 v[40:43], v[232:235], v[112:115], v[40:43]
    ds_read_b64_tr_b16 v[210:211], v13 offset:41984
    v_max_u32 v2, v2, v126
    v_mfma_f32_16x16x32_bf16 v[56:59], v[232:235], v[116:119], v[56:59]
    ds_read_b64_tr_b16 v[214:215], v28 offset:41984
    v_cmp_eq_u32 vcc, -1, v2
    v_mfma_f32_16x16x32_bf16 v[44:47], v[236:239], v[112:115], v[44:47]
    ds_read_b64_tr_b16 v[218:219], v29 offset:41984
    s_waitcnt lgkmcnt(15)
    v_mfma_f32_16x16x32_bf16 v[60:63], v[236:239], v[116:119], v[60:63]
    ds_read_b64_tr_b16 v[222:223], v30 offset:41984
    s_cbranch_vccnz G2_R11
G2_OK11:
    v_mfma_f32_16x16x32_bf16 v[32:35], v[240:243], v[120:123], v[32:35]
    v_xor_b32 v28, 32, v14
    v_xor_b32 v29, 64, v14
    buffer_load_dwordx4 v[152:155], v0, s[28:31], s7 offen offset:0 sc1
    v_mfma_f32_16x16x32_bf16 v[48:51], v[240:243], v[124:127], v[48:51]
    v_xor_b32 v30, 96, v14
    buffer_load_dwordx4 v[156:159], v31, s[28:31], s7 offen offset:0 sc1
    v_mfma_f32_16x16x32_bf16 v[36:39], v[244:247], v[120:123], v[36:39]
    ds_read_b64_tr_b16 v[224:225], v14 offset:0
    ds_read_b64_tr_b16 v[228:229], v28 offset:0
    v_mfma_f32_16x16x32_bf16 v[52:55], v[244:247], v[124:127], v[52:55]
    ds_read_b64_tr_b16 v[232:233], v29 offset:0
    s_waitcnt vmcnt(6)
    v_max3_u32 v2, v128, v130, v132
    v_mfma_f32_16x16x32_bf16 v[40:43], v[248:251], v[120:123], v[40:43]
    ds_read_b64_tr_b16 v[236:237], v30 offset:0
    v_max_u32 v2, v2, v134
    v_mfma_f32_16x16x32_bf16 v[56:59], v[248:251], v[124:127], v[56:59]
    ds_read_b64_tr_b16 v[226:227], v29 offset:512
    ds_read_b64_tr_b16 v[230:231], v30 offset:512
    v_cmp_eq_u32 vcc, -1, v2
    v_mfma_f32_16x16x32_bf16 v[44:47], v[252:255], v[120:123], v[44:47]
    ds_read_b64_tr_b16 v[234:235], v14 offset:512
    s_waitcnt lgkmcnt(15)
    v_mfma_f32_16x16x32_bf16 v[60:63], v[252:255], v[124:127], v[60:63]
    ds_read_b64_tr_b16 v[238:239], v28 offset:512
    s_cbranch_vccnz G2_R12
G2_OK12:
    v_mfma_f32_16x16x32_bf16 v[32:35], v[160:163], v[128:131], v[32:35]
    ds_read_b64_tr_b16 v[240:241], v14 offset:40960
    buffer_load_dwordx4 v[96:99], v0, s[28:31], s93 offen offset:1024 sc1
    v_mfma_f32_16x16x32_bf16 v[48:51], v[160:163], v[132:135], v[48:51]
    ds_read_b64_tr_b16 v[244:245], v28 offset:40960
    buffer_load_dwordx4 v[100:103], v31, s[28:31], s93 offen offset:1024 sc1
    v_mfma_f32_16x16x32_bf16 v[36:39], v[164:167], v[128:131], v[36:39]
    ds_read_b64_tr_b16 v[248:249], v29 offset:40960
    v_mfma_f32_16x16x32_bf16 v[52:55], v[164:167], v[132:135], v[52:55]
    ds_read_b64_tr_b16 v[252:253], v30 offset:40960
    s_waitcnt vmcnt(6)
    v_max3_u32 v2, v136, v138, v140
    v_mfma_f32_16x16x32_bf16 v[40:43], v[168:171], v[128:131], v[40:43]
    ds_read_b64_tr_b16 v[242:243], v29 offset:41472
    v_max_u32 v2, v2, v142
    v_mfma_f32_16x16x32_bf16 v[56:59], v[168:171], v[132:135], v[56:59]
    ds_read_b64_tr_b16 v[246:247], v30 offset:41472
    v_cmp_eq_u32 vcc, -1, v2
    v_mfma_f32_16x16x32_bf16 v[44:47], v[172:175], v[128:131], v[44:47]
    ds_read_b64_tr_b16 v[250:251], v14 offset:41472
    s_waitcnt lgkmcnt(15)
    v_mfma_f32_16x16x32_bf16 v[60:63], v[172:175], v[132:135], v[60:63]
    ds_read_b64_tr_b16 v[254:255], v28 offset:41472
    s_cbranch_vccnz G2_R13
G2_OK13:
    v_mfma_f32_16x16x32_bf16 v[32:35], v[176:179], v[136:139], v[32:35]
    v_xor_b32 v28, 32, v12
    v_xor_b32 v29, 64, v12
    buffer_load_dwordx4 v[104:107], v0, s[28:31], s7 offen offset:1024 sc1
    v_mfma_f32_16x16x32_bf16 v[48:51], v[176:179], v[140:143], v[48:51]
    v_xor_b32 v30, 96, v12
    ds_read_b64_tr_b16 v[160:161], v12 offset:0
    buffer_load_dwordx4 v[108:111], v31, s[28:31], s7 offen offset:1024 sc1
    v_mfma_f32_16x16x32_bf16 v[36:39], v[180:183], v[136:139], v[36:39]
    ds_read_b64_tr_b16 v[164:165], v28 offset:0
    ds_read_b64_tr_b16 v[168:169], v29 offset:0
    v_mfma_f32_16x16x32_bf16 v[52:55], v[180:183], v[140:143], v[52:55]
    ds_read_b64_tr_b16 v[172:173], v30 offset:0
    s_waitcnt vmcnt(6)
    v_max3_u32 v2, v144, v146, v148
    v_mfma_f32_16x16x32_bf16 v[40:43], v[184:187], v[136:139], v[40:43]
    v_xor_b32 v28, 32, v15
    v_xor_b32 v29, 64, v15
    v_max_u32 v2, v2, v150
    v_mfma_f32_16x16x32_bf16 v[56:59], v[184:187], v[140:143], v[56:59]
    v_xor_b32 v30, 96, v15
    ds_read_b64_tr_b16 v[162:163], v15 offset:0
    v_cmp_eq_u32 vcc, -1, v2
    v_mfma_f32_16x16x32_bf16 v[44:47], v[188:191], v[136:139], v[44:47]
    ds_read_b64_tr_b16 v[166:167], v28 offset:0
    ds_read_b64_tr_b16 v[170:171], v29 offset:0
    s_waitcnt lgkmcnt(15)
    v_mfma_f32_16x16x32_bf16 v[60:63], v[188:191], v[140:143], v[60:63]
    ds_read_b64_tr_b16 v[174:175], v30 offset:0
    s_cbranch_vccnz G2_R14
G2_OK14:
    v_mfma_f32_16x16x32_bf16 v[32:35], v[192:195], v[144:147], v[32:35]
    v_xor_b32 v28, 32, v12
    v_xor_b32 v29, 64, v12
    buffer_load_dwordx4 v[112:115], v0, s[28:31], s92 offen offset:3072 sc1
    v_mfma_f32_16x16x32_bf16 v[48:51], v[192:195], v[148:151], v[48:51]
    v_xor_b32 v30, 96, v12
    ds_read_b64_tr_b16 v[176:177], v12 offset:40960
    buffer_load_dwordx4 v[116:119], v31, s[28:31], s92 offen offset:3072 sc1
    v_mfma_f32_16x16x32_bf16 v[36:39], v[196:199], v[144:147], v[36:39]
    ds_read_b64_tr_b16 v[180:181], v28 offset:40960
    ds_read_b64_tr_b16 v[184:185], v29 offset:40960
    v_mfma_f32_16x16x32_bf16 v[52:55], v[196:199], v[148:151], v[52:55]
    ds_read_b64_tr_b16 v[188:189], v30 offset:40960
    s_waitcnt vmcnt(6)
    v_max3_u32 v2, v152, v154, v156
    v_mfma_f32_16x16x32_bf16 v[40:43], v[200:203], v[144:147], v[40:43]
    v_xor_b32 v28, 32, v15
    v_xor_b32 v29, 64, v15
    v_max_u32 v2, v2, v158
    v_mfma_f32_16x16x32_bf16 v[56:59], v[200:203], v[148:151], v[56:59]
    v_xor_b32 v30, 96, v15
    ds_read_b64_tr_b16 v[178:179], v15 offset:40960
    v_cmp_eq_u32 vcc, -1, v2
    v_mfma_f32_16x16x32_bf16 v[44:47], v[204:207], v[144:147], v[44:47]
    ds_read_b64_tr_b16 v[182:183], v28 offset:40960
    ds_read_b64_tr_b16 v[186:187], v29 offset:40960
    s_waitcnt lgkmcnt(15)
    v_mfma_f32_16x16x32_bf16 v[60:63], v[204:207], v[148:151], v[60:63]
    ds_read_b64_tr_b16 v[190:191], v30 offset:40960
    s_cbranch_vccnz G2_R15
G2_OK15:
    v_mfma_f32_16x16x32_bf16 v[32:35], v[208:211], v[152:155], v[32:35]
    buffer_load_dwordx4 v[120:123], v0, s[28:31], s6 offen offset:3072 sc1
    v_mfma_f32_16x16x32_bf16 v[48:51], v[208:211], v[156:159], v[48:51]
    buffer_load_dwordx4 v[124:127], v31, s[28:31], s6 offen offset:3072 sc1
    v_mfma_f32_16x16x32_bf16 v[36:39], v[212:215], v[152:155], v[36:39]
    v_mfma_f32_16x16x32_bf16 v[52:55], v[212:215], v[156:159], v[52:55]
    s_waitcnt vmcnt(6)
    v_max3_u32 v2, v96, v98, v100
    v_mfma_f32_16x16x32_bf16 v[40:43], v[216:219], v[152:155], v[40:43]
    v_max_u32 v2, v2, v102
    v_mfma_f32_16x16x32_bf16 v[56:59], v[216:219], v[156:159], v[56:59]
    v_cmp_eq_u32 vcc, -1, v2
    v_mfma_f32_16x16x32_bf16 v[44:47], v[220:223], v[152:155], v[44:47]
    s_waitcnt lgkmcnt(15)
    v_mfma_f32_16x16x32_bf16 v[60:63], v[220:223], v[156:159], v[60:63]
    s_cbranch_vccnz G2_R16
G2_OK16:
    v_mfma_f32_16x16x32_bf16 v[32:35], v[224:227], v[96:99], v[32:35]
    v_mfma_f32_16x16x32_bf16 v[48:51], v[224:227], v[100:103], v[48:51]
    v_mfma_f32_16x16x32_bf16 v[36:39], v[228:231], v[96:99], v[36:39]
    v_mfma_f32_16x16x32_bf16 v[52:55], v[228:231], v[100:103], v[52:55]
    s_waitcnt vmcnt(4)
    v_max3_u32 v2, v104, v106, v108
    v_mfma_f32_16x16x32_bf16 v[40:43], v[232:235], v[96:99], v[40:43]
    v_max_u32 v2, v2, v110
    v_mfma_f32_16x16x32_bf16 v[56:59], v[232:235], v[100:103], v[56:59]
    v_cmp_eq_u32 vcc, -1, v2
    v_mfma_f32_16x16x32_bf16 v[44:47], v[236:239], v[96:99], v[44:47]
    s_waitcnt lgkmcnt(15)
    v_mfma_f32_16x16x32_bf16 v[60:63], v[236:239], v[100:103], v[60:63]
    s_cbranch_vccnz G2_R17
G2_OK17:
    v_mfma_f32_16x16x32_bf16 v[32:35], v[240:243], v[104:107], v[32:35]
    v_mfma_f32_16x16x32_bf16 v[48:51], v[240:243], v[108:111], v[48:51]
    v_mfma_f32_16x16x32_bf16 v[36:39], v[244:247], v[104:107], v[36:39]
    v_mfma_f32_16x16x32_bf16 v[52:55], v[244:247], v[108:111], v[52:55]
    s_waitcnt vmcnt(2)
    v_max3_u32 v2, v112, v114, v116
    v_mfma_f32_16x16x32_bf16 v[40:43], v[248:251], v[104:107], v[40:43]
    v_max_u32 v2, v2, v118
    v_mfma_f32_16x16x32_bf16 v[56:59], v[248:251], v[108:111], v[56:59]
    v_cmp_eq_u32 vcc, -1, v2
    v_mfma_f32_16x16x32_bf16 v[44:47], v[252:255], v[104:107], v[44:47]
    s_waitcnt lgkmcnt(8)
    v_mfma_f32_16x16x32_bf16 v[60:63], v[252:255], v[108:111], v[60:63]
    s_cbranch_vccnz G2_R18
G2_OK18:
    v_mfma_f32_16x16x32_bf16 v[32:35], v[160:163], v[112:115], v[32:35]
    ds_read_b64 v[24:25], v19 offset:8
    v_xor_b32 v28, 32, v8
    v_mfma_f32_16x16x32_bf16 v[48:51], v[160:163], v[116:119], v[48:51]
    v_xor_b32 v29, 64, v8
    v_mfma_f32_16x16x32_bf16 v[36:39], v[164:167], v[112:115], v[36:39]
    v_xor_b32 v30, 96, v8
    v_mfma_f32_16x16x32_bf16 v[52:55], v[164:167], v[116:119], v[52:55]
    s_lshl_b32 s60, s8, 11
    s_waitcnt vmcnt(0)
    v_max3_u32 v2, v120, v122, v124
    v_mfma_f32_16x16x32_bf16 v[40:43], v[168:171], v[112:115], v[40:43]
    s_add_u32 s61, s60, 146304
    v_max_u32 v2, v2, v126
    v_mfma_f32_16x16x32_bf16 v[56:59], v[168:171], v[116:119], v[56:59]
    v_add_u32 v17, s61, v6
    v_cmp_eq_u32 vcc, -1, v2
    v_mfma_f32_16x16x32_bf16 v[44:47], v[172:175], v[112:115], v[44:47]
    s_lshl1_add_u32 s60, s60, 81920
    s_waitcnt lgkmcnt(0)
    v_mfma_f32_16x16x32_bf16 v[60:63], v[172:175], v[116:119], v[60:63]
    v_add_u32 v20, s60, v6
    s_cbranch_vccnz G2_R19
G2_OK19:
    v_mfma_f32_16x16x32_bf16 v[32:35], v[176:179], v[120:123], v[32:35]
    v_and_b32 v3, v24, v25
    v_cmp_ne_u32 vcc, 0x01010101, v3
    v_mfma_f32_16x16x32_bf16 v[36:39], v[180:183], v[120:123], v[36:39]
    s_cbranch_vccnz G2_ZGR
G2_ZGOK:
    v_mfma_f32_16x16x32_bf16 v[40:43], v[184:187], v[120:123], v[40:43]
    ds_read_b128 v[192:195], v20 offset:0
    ds_read_b128 v[196:199], v20 offset:1024
    v_mfma_f32_16x16x32_bf16 v[44:47], v[188:191], v[120:123], v[44:47]
    ds_read_b128 v[200:203], v20 offset:2048
    ds_read_b128 v[204:207], v20 offset:3072
    v_mfma_f32_16x16x32_bf16 v[48:51], v[176:179], v[124:127], v[48:51]
    ds_read_b128 v[208:211], v20 offset:4096
    ds_read_b128 v[212:215], v20 offset:5120
    v_mfma_f32_16x16x32_bf16 v[52:55], v[180:183], v[124:127], v[52:55]
    ds_read_b128 v[216:219], v20 offset:6144
    ds_read_b128 v[220:223], v20 offset:7168
    v_mfma_f32_16x16x32_bf16 v[56:59], v[184:187], v[124:127], v[56:59]
    v_mfma_f32_16x16x32_bf16 v[60:63], v[188:191], v[124:127], v[60:63]
    s_waitcnt lgkmcnt(4)
    v_pk_fma_f32 v[64:65], v[32:33], v[192:193], v[64:65]
    v_pk_fma_f32 v[66:67], v[34:35], v[194:195], v[66:67]
    v_pk_fma_f32 v[68:69], v[36:37], v[196:197], v[68:69]
    v_pk_fma_f32 v[70:71], v[38:39], v[198:199], v[70:71]
    v_pk_fma_f32 v[72:73], v[40:41], v[200:201], v[72:73]
    v_pk_fma_f32 v[74:75], v[42:43], v[202:203], v[74:75]
    v_pk_fma_f32 v[76:77], v[44:45], v[204:205], v[76:77]
    v_pk_fma_f32 v[78:79], v[46:47], v[206:207], v[78:79]
    v_cvt_pk_bf16_f32 v96, v64, v65
    v_cvt_pk_bf16_f32 v97, v66, v67
    ds_write_b64 v8, v[96:97] offset:0
    v_cvt_pk_bf16_f32 v98, v68, v69
    v_cvt_pk_bf16_f32 v99, v70, v71
    ds_write_b64 v28, v[98:99] offset:0
    v_cvt_pk_bf16_f32 v100, v72, v73
    v_cvt_pk_bf16_f32 v101, v74, v75
    ds_write_b64 v29, v[100:101] offset:0
    v_cvt_pk_bf16_f32 v102, v76, v77
    v_cvt_pk_bf16_f32 v103, v78, v79
    ds_write_b64 v30, v[102:103] offset:0
    ds_read_b128 v[224:227], v17 offset:0
    ds_read_b128 v[228:231], v17 offset:1024
    s_cmp_eq_u32 s101, 1
    s_cbranch_scc1 G2_ONE
    s_waitcnt lgkmcnt(6)
    v_pk_fma_f32 v[80:81], v[48:49], v[208:209], v[80:81]
    v_pk_fma_f32 v[82:83], v[50:51], v[210:211], v[82:83]
    v_pk_fma_f32 v[84:85], v[52:53], v[212:213], v[84:85]
    v_pk_fma_f32 v[86:87], v[54:55], v[214:215], v[86:87]
    v_pk_fma_f32 v[88:89], v[56:57], v[216:217], v[88:89]
    v_pk_fma_f32 v[90:91], v[58:59], v[218:219], v[90:91]
    v_pk_fma_f32 v[92:93], v[60:61], v[220:221], v[92:93]
    v_pk_fma_f32 v[94:95], v[62:63], v[222:223], v[94:95]
    v_cvt_pk_bf16_f32 v104, v80, v81
    v_cvt_pk_bf16_f32 v105, v82, v83
    ds_write_b64 v8, v[104:105] offset:2048
    v_cvt_pk_bf16_f32 v106, v84, v85
    v_cvt_pk_bf16_f32 v107, v86, v87
    ds_write_b64 v28, v[106:107] offset:2048
    v_cvt_pk_bf16_f32 v108, v88, v89
    v_cvt_pk_bf16_f32 v109, v90, v91
    ds_write_b64 v29, v[108:109] offset:2048
    v_cvt_pk_bf16_f32 v110, v92, v93
    v_cvt_pk_bf16_f32 v111, v94, v95
    ds_write_b64 v30, v[110:111] offset:2048
    ds_read_b128 v[232:235], v17 offset:2048
    ds_read_b128 v[236:239], v17 offset:3072
    s_waitcnt lgkmcnt(7)
    buffer_store_dwordx4 v[224:227], v7, s[44:47], s97 offen
    s_waitcnt lgkmcnt(6)
    buffer_store_dwordx4 v[228:231], v7, s[44:47], s94 offen
    s_add_u32 s94, s94, 20480
    s_waitcnt lgkmcnt(1)
    buffer_store_dwordx4 v[232:235], v7, s[44:47], s94 offen
    s_add_u32 s94, s94, 20480
    s_waitcnt lgkmcnt(0)
    buffer_store_dwordx4 v[236:239], v7, s[44:47], s94 offen
    s_endpgm
G2_ONE:
    s_waitcnt lgkmcnt(1)
    buffer_store_dwordx4 v[224:227], v7, s[44:47], s97 offen
    s_waitcnt lgkmcnt(0)
    buffer_store_dwordx4 v[228:231], v7, s[44:47], s94 offen
    s_endpgm
K_P1:
TC2:
    s_cbranch_execz TC3
    ds_read_b128 v[240:243], v17 offset:0
    ds_read_b128 v[248:251], v17 offset:256
    ds_read_b64 v[48:49], v8 offset:0
    ds_read_b64 v[56:57], v8 offset:2048
    v_xor_b32 v100, 32, v8
    ds_read_b64 v[50:51], v100 offset:0
    ds_read_b64 v[58:59], v100 offset:2048
    v_xor_b32 v100, 64, v8
    ds_read_b64 v[52:53], v100 offset:0
    ds_read_b64 v[60:61], v100 offset:2048
    v_xor_b32 v100, 96, v8
    ds_read_b64 v[54:55], v100 offset:0
    ds_read_b64 v[62:63], v100 offset:2048
    s_waitcnt lgkmcnt(0)
    v_mul_f32 v240, v240, v242
    v_mul_f32 v244, 0xbfb8aa3b, v242
    v_mul_f32 v246, 0xbfb8aa3b, v240
    v_lshlrev_b32 v208, 16, v48
    v_and_b32 v209, 0xffff0000, v48
    v_lshlrev_b32 v210, 16, v49
    v_and_b32 v211, 0xffff0000, v49
    v_lshlrev_b32 v212, 16, v50
    v_and_b32 v213, 0xffff0000, v50
    v_lshlrev_b32 v214, 16, v51
    v_and_b32 v215, 0xffff0000, v51
    v_pk_fma_f32 v[100:101], v[208:209], v[244:245], v[246:247] op_sel_hi:[1,0,0]
    v_pk_fma_f32 v[102:103], v[210:211], v[244:245], v[246:247] op_sel_hi:[1,0,0]
    v_pk_fma_f32 v[104:105], v[212:213], v[244:245], v[246:247] op_sel_hi:[1,0,0]
    v_pk_fma_f32 v[106:107], v[214:215], v[244:245], v[246:247] op_sel_hi:[1,0,0]
    v_pk_fma_f32 v[208:209], v[208:209], v[242:243], v[240:241] op_sel_hi:[1,0,0]
    v_pk_fma_f32 v[210:211], v[210:211], v[242:243], v[240:241] op_sel_hi:[1,0,0]
    v_pk_fma_f32 v[212:213], v[212:213], v[242:243], v[240:241] op_sel_hi:[1,0,0]
    v_pk_fma_f32 v[214:215], v[214:215], v[242:243], v[240:241] op_sel_hi:[1,0,0]
    v_exp_f32 v100, v100
    v_exp_f32 v101, v101
    v_exp_f32 v102, v102
    v_exp_f32 v103, v103
    v_exp_f32 v104, v104
    v_exp_f32 v105, v105
    v_exp_f32 v106, v106
    v_exp_f32 v107, v107
    v_pk_add_f32 v[100:101], v[100:101], 1.0 op_sel_hi:[1,0]
    v_pk_add_f32 v[102:103], v[102:103], 1.0 op_sel_hi:[1,0]
    v_pk_add_f32 v[104:105], v[104:105], 1.0 op_sel_hi:[1,0]
    v_pk_add_f32 v[106:107], v[106:107], 1.0 op_sel_hi:[1,0]
    v_rcp_f32 v100, v100
    v_rcp_f32 v101, v101
    v_rcp_f32 v102, v102
    v_rcp_f32 v103, v103
    v_rcp_f32 v104, v104
    v_rcp_f32 v105, v105
    v_rcp_f32 v106, v106
    v_rcp_f32 v107, v107
    v_pk_mul_f32 v[208:209], v[208:209], v[100:101]
    v_pk_mul_f32 v[210:211], v[210:211], v[102:103]
    v_pk_mul_f32 v[212:213], v[212:213], v[104:105]
    v_pk_mul_f32 v[214:215], v[214:215], v[106:107]
    s_setpc_b64 s[20:21]
K_P2:
    v_lshlrev_b32 v216, 16, v52
    v_and_b32 v217, 0xffff0000, v52
    v_lshlrev_b32 v218, 16, v53
    v_and_b32 v219, 0xffff0000, v53
    v_lshlrev_b32 v220, 16, v54
    v_and_b32 v221, 0xffff0000, v54
    v_lshlrev_b32 v222, 16, v55
    v_and_b32 v223, 0xffff0000, v55
    v_pk_fma_f32 v[100:101], v[216:217], v[244:245], v[246:247] op_sel_hi:[1,0,0]
    v_pk_fma_f32 v[102:103], v[218:219], v[244:245], v[246:247] op_sel_hi:[1,0,0]
    v_pk_fma_f32 v[104:105], v[220:221], v[244:245], v[246:247] op_sel_hi:[1,0,0]
    v_pk_fma_f32 v[106:107], v[222:223], v[244:245], v[246:247] op_sel_hi:[1,0,0]
    v_pk_fma_f32 v[216:217], v[216:217], v[242:243], v[240:241] op_sel_hi:[1,0,0]
    v_pk_fma_f32 v[218:219], v[218:219], v[242:243], v[240:241] op_sel_hi:[1,0,0]
    v_pk_fma_f32 v[220:221], v[220:221], v[242:243], v[240:241] op_sel_hi:[1,0,0]
    v_pk_fma_f32 v[222:223], v[222:223], v[242:243], v[240:241] op_sel_hi:[1,0,0]
    v_exp_f32 v100, v100
    v_exp_f32 v101, v101
    v_exp_f32 v102, v102
    v_exp_f32 v103, v103
    v_exp_f32 v104, v104
    v_exp_f32 v105, v105
    v_exp_f32 v106, v106
    v_exp_f32 v107, v107
    v_pk_add_f32 v[100:101], v[100:101], 1.0 op_sel_hi:[1,0]
    v_pk_add_f32 v[102:103], v[102:103], 1.0 op_sel_hi:[1,0]
    v_pk_add_f32 v[104:105], v[104:105], 1.0 op_sel_hi:[1,0]
    v_pk_add_f32 v[106:107], v[106:107], 1.0 op_sel_hi:[1,0]
    v_rcp_f32 v100, v100
    v_rcp_f32 v101, v101
    v_rcp_f32 v102, v102
    v_rcp_f32 v103, v103
    v_rcp_f32 v104, v104
    v_rcp_f32 v105, v105
    v_rcp_f32 v106, v106
    v_rcp_f32 v107, v107
    v_pk_mul_f32 v[216:217], v[216:217], v[100:101]
    v_pk_mul_f32 v[218:219], v[218:219], v[102:103]
    v_pk_mul_f32 v[220:221], v[220:221], v[104:105]
    v_pk_mul_f32 v[222:223], v[222:223], v[106:107]
    s_setpc_b64 s[20:21]
P_TAIL:
TC3:
    s_cbranch_execz TC4
    s_setprio 0
    v_mov_b32 v2, 1
    ds_write_b8 v18, v2 offset:0
    s_cmp_eq_u32 s13, 1
    s_cbranch_scc1 P_ST
    s_call_b64 s[20:21], K_P1
    s_call_b64 s[20:21], K_P2
P_ST:
    ds_read_b64 v[22:23], v19 offset:40
    s_lshl_b32 s60, s8, 12
    s_add_u32 s60, s60, 81920
    v_add_u32 v20, s60, v6
    s_lshl_b32 s62, s101, 4
    s_mov_b32 s100, 0
    s_waitcnt lgkmcnt(0)
    v_readfirstlane_b32 s90, v22
    v_readfirstlane_b32 s91, v23
    s_lshl_b32 s67, s58, 2
    s_add_u32 s67, s67, 131072
    s_mov_b32 s68, 2
FIX_L:
    v_mov_b32 v45, v49
    v_mov_b32 v46, v50
    v_mov_b32 v47, v51
    v_mov_b32 v49, 114688
    s_not_b32 s60, s90
    s_bfe_u32 s61, s60, 655361
    s_and_b32 s60, s60, 1
    s_lshl_b32 s60, s60, 10
    s_add_u32 s60, s60, s61
    s_sub_u32 s63, s60, s95
    s_cmp_lt_u32 s63, s62
    s_cbranch_scc1 FIX_RUN
FIX_N:
    s_mov_b32 s90, s91
    s_add_u32 s67, s67, 138240
    s_sub_u32 s68, s68, 1
    s_cmp_lg_u32 s68, 0
    s_cbranch_scc1 FIX_L
    s_setprio 0
    s_cmp_lt_u32 s101, 2
    s_cbranch_scc1 P_NOB
    v_mul_f32 v248, v248, v250
    v_mul_f32 v252, 0xbfb8aa3b, v250
    v_mul_f32 v254, 0xbfb8aa3b, v248
    v_lshlrev_b32 v224, 16, v56
    v_and_b32 v225, 0xffff0000, v56
    v_lshlrev_b32 v226, 16, v57
    v_and_b32 v227, 0xffff0000, v57
    v_lshlrev_b32 v228, 16, v58
    v_and_b32 v229, 0xffff0000, v58
    v_lshlrev_b32 v230, 16, v59
    v_and_b32 v231, 0xffff0000, v59
    v_fma_f32 v100, v224, v252, v254
    v_fma_f32 v101, v225, v252, v254
    v_fma_f32 v102, v226, v252, v254
    v_fma_f32 v103, v227, v252, v254
    v_fma_f32 v104, v228, v252, v254
    v_fma_f32 v105, v229, v252, v254
    v_fma_f32 v106, v230, v252, v254
    v_fma_f32 v107, v231, v252, v254
    v_exp_f32 v100, v100
    v_fma_f32 v224, v224, v250, v248
    v_exp_f32 v101, v101
    v_fma_f32 v225, v225, v250, v248
    v_exp_f32 v102, v102
    v_fma_f32 v226, v226, v250, v248
    v_exp_f32 v103, v103
    v_fma_f32 v227, v227, v250, v248
    v_exp_f32 v104, v104
    v_fma_f32 v228, v228, v250, v248
    v_exp_f32 v105, v105
    v_fma_f32 v229, v229, v250, v248
    v_exp_f32 v106, v106
    v_fma_f32 v230, v230, v250, v248
    v_exp_f32 v107, v107
    v_fma_f32 v231, v231, v250, v248
    v_add_f32 v100, 1.0, v100
    v_add_f32 v101, 1.0, v101
    v_add_f32 v102, 1.0, v102
    v_add_f32 v103, 1.0, v103
    v_add_f32 v104, 1.0, v104
    v_add_f32 v105, 1.0, v105
    v_add_f32 v106, 1.0, v106
    v_add_f32 v107, 1.0, v107
    v_rcp_f32 v100, v100
    v_rcp_f32 v101, v101
    v_rcp_f32 v102, v102
    v_rcp_f32 v103, v103
    v_rcp_f32 v104, v104
    v_rcp_f32 v105, v105
    v_rcp_f32 v106, v106
    v_rcp_f32 v107, v107
    v_mul_f32 v224, v224, v100
    v_mul_f32 v225, v225, v101
    v_mul_f32 v226, v226, v102
    v_mul_f32 v227, v227, v103
    v_mul_f32 v228, v228, v104
    v_mul_f32 v229, v229, v105
    v_mul_f32 v230, v230, v106
    v_mul_f32 v231, v231, v107
    v_lshlrev_b32 v232, 16, v60
    v_and_b32 v233, 0xffff0000, v60
    v_lshlrev_b32 v234, 16, v61
    v_and_b32 v235, 0xffff0000, v61
    v_lshlrev_b32 v236, 16, v62
    v_and_b32 v237, 0xffff0000, v62
    v_lshlrev_b32 v238, 16, v63
    v_and_b32 v239, 0xffff0000, v63
    v_fma_f32 v100, v232, v252, v254
    v_fma_f32 v101, v233, v252, v254
    v_fma_f32 v102, v234, v252, v254
    v_fma_f32 v103, v235, v252, v254
    v_fma_f32 v104, v236, v252, v254
    v_fma_f32 v105, v237, v252, v254
    v_fma_f32 v106, v238, v252, v254
    v_fma_f32 v107, v239, v252, v254
    v_exp_f32 v100, v100
    v_fma_f32 v232, v232, v250, v248
    v_exp_f32 v101, v101
    v_fma_f32 v233, v233, v250, v248
    v_exp_f32 v102, v102
    v_fma_f32 v234, v234, v250, v248
    v_exp_f32 v103, v103
    v_fma_f32 v235, v235, v250, v248
    v_exp_f32 v104, v104
    v_fma_f32 v236, v236, v250, v248
    v_exp_f32 v105, v105
    v_fma_f32 v237, v237, v250, v248
    v_exp_f32 v106, v106
    v_fma_f32 v238, v238, v250, v248
    v_exp_f32 v107, v107
    v_fma_f32 v239, v239, v250, v248
    v_add_f32 v100, 1.0, v100
    v_add_f32 v101, 1.0, v101
    v_add_f32 v102, 1.0, v102
    v_add_f32 v103, 1.0, v103
    v_add_f32 v104, 1.0, v104
    v_add_f32 v105, 1.0, v105
    v_add_f32 v106, 1.0, v106
    v_add_f32 v107, 1.0, v107
    v_rcp_f32 v100, v100
    v_rcp_f32 v101, v101
    v_rcp_f32 v102, v102
    v_rcp_f32 v103, v103
    v_rcp_f32 v104, v104
    v_rcp_f32 v105, v105
    v_rcp_f32 v106, v106
    v_rcp_f32 v107, v107
    v_mul_f32 v232, v232, v100
    v_mul_f32 v233, v233, v101
    v_mul_f32 v234, v234, v102
    v_mul_f32 v235, v235, v103
    v_mul_f32 v236, v236, v104
    v_mul_f32 v237, v237, v105
    v_mul_f32 v238, v238, v106
    v_mul_f32 v239, v239, v107
P_NOB:
    s_mov_b32 s100, 0
    ds_read_b64 v[2:3], v19 offset:0
P_Z:
    s_waitcnt lgkmcnt(0)
    v_and_b32 v2, v2, v3
    v_cmp_ne_u32 vcc, 0x01010101, v2
    s_cbranch_vccnz P_ZR
P_ZOK:
    ds_write_b128 v20, v[208:211] offset:0
    ds_write_b128 v20, v[212:215] offset:1024
    ds_write_b128 v20, v[216:219] offset:2048
    ds_write_b128 v20, v[220:223] offset:3072
    ds_write_b128 v20, v[224:227] offset:4096
    ds_write_b128 v20, v[228:231] offset:5120
    ds_write_b128 v20, v[232:235] offset:6144
    ds_write_b128 v20, v[236:239] offset:7168
    s_mov_b32 exec_hi, 0
    ds_write_b64 v49, v[50:51]
    ds_write_b64 v45, v[46:47]
    v_mov_b32 v2, 1
    ds_write_b8 v18, v2 offset:8
    s_endpgm
FIX_RUN:
    s_setprio 3
    v_lshrrev_b32 v48, 5, v1
    v_mul_u32_u24 v48, 4608, v48
    v_add_u32 v48, v48, v6
    v_mov_b32 v116, 0
    v_mov_b32 v117, s52
    v_mov_b32 v118, 0
    v_mov_b32 v119, s52
    s_add_u32 s60, s67, 0
    buffer_load_dwordx4 v[64:67], v48, s[28:31], s60 offen sc1
    s_add_u32 s60, s67, 10240
    buffer_load_dwordx4 v[68:71], v48, s[28:31], s60 offen sc1
    s_add_u32 s60, s67, 20480
    buffer_load_dwordx4 v[72:75], v48, s[28:31], s60 offen sc1
    s_add_u32 s60, s67, 30720
    buffer_load_dwordx4 v[76:79], v48, s[28:31], s60 offen sc1
    s_add_u32 s60, s67, 40960
    buffer_load_dwordx4 v[80:83], v48, s[28:31], s60 offen sc1
    s_add_u32 s60, s67, 51200
    buffer_load_dwordx4 v[84:87], v48, s[28:31], s60 offen sc1
    s_add_u32 s60, s67, 61440
    buffer_load_dwordx4 v[88:91], v48, s[28:31], s60 offen sc1
    s_add_u32 s60, s67, 71680
    buffer_load_dwordx4 v[92:95], v48, s[28:31], s60 offen sc1
    s_add_u32 s60, s67, 81920
    buffer_load_dwordx4 v[96:99], v48, s[28:31], s60 offen sc1
    s_add_u32 s60, s67, 92160
    buffer_load_dwordx4 v[100:103], v48, s[28:31], s60 offen sc1
    s_add_u32 s60, s67, 102400
    buffer_load_dwordx4 v[104:107], v48, s[28:31], s60 offen sc1
    s_add_u32 s60, s67, 112640
    buffer_load_dwordx4 v[108:111], v48, s[28:31], s60 offen sc1
    s_add_u32 s60, s67, 122880
    buffer_load_dwordx4 v[112:115], v48, s[28:31], s60 offen sc1
    s_add_u32 s60, s67, 133120
    s_mov_b32 exec_hi, 0
    buffer_load_dwordx4 v[116:119], v48, s[28:31], s60 offen sc1
    s_mov_b32 exec_hi, -1
    s_lshl4_add_u32 s64, s8, s63
    s_lshl_b32 s60, s64, 4
    s_add_u32 s60, s60, 161536
    v_mov_b32 v2, s60
    ds_read_b96 v[52:54], v2
    v_bfe_u32 v2, v1, 2, 3
    s_and_b32 s60, s64, 7
    v_xor_b32 v2, s60, v2
    v_and_b32 v3, 3, v1
    v_lshl_add_u32 v2, v2, 2, v3
    s_lshl_b32 s60, s64, 7
    s_add_u32 s60, s60, 146304
    v_lshl_add_u32 v2, v2, 2, s60
    ds_read_b32 v50, v2
    s_ashr_i32 s60, s90, 31
    s_orn2_b32 s60, 0x80000000, s60
    s_xor_b32 s60, s60, s90
    s_and_b32 s60, s60, s55
    v_mov_b32 v55, 0xbfb8aa3b
    v_mul_f32 v55, s60, v55
    v_exp_f32 v55, v55
    s_nop 0
    v_add_f32 v55, 1.0, v55
    v_rcp_f32 v55, v55
    s_nop 0
    v_cvt_pk_bf16_f32 v55, v55, v55
    v_lshlrev_b32 v55, 16, v55
    s_lshr_b32 s60, s64, 4
    s_lshl_b32 s60, s60, 12
    s_and_b32 s61, s64, 15
    s_lshl4_add_u32 s60, s61, s60
    s_add_u32 s60, s60, 81920
    v_lshrrev_b32 v49, 1, v1
    v_lshl_add_u32 v49, v49, 8, s60
    v_and_b32 v3, 1, v1
    v_lshl_add_u32 v49, v3, 3, v49
    s_waitcnt lgkmcnt(0)
    v_and_b32 v51, 0xffff0000, v50
    v_lshlrev_b32 v50, 16, v50
    v_add_f32 v50, v50, v52
    v_add_f32 v51, v51, v52
    v_cvt_pk_bf16_f32 v3, v50, v51
    v_lshlrev_b32 v50, 16, v3
    v_and_b32 v51, s55, v3
    v_mul_f32 v50, v50, v54
    v_mul_f32 v51, v51, v54
    v_cvt_pk_bf16_f32 v3, v50, v51
    v_lshlrev_b32 v50, 16, v3
    v_and_b32 v51, s55, v3
    s_waitcnt vmcnt(0)
FIX_Y_CHK:
    v_xor_b32 v2, s52, v65
    v_bitop3_b32 v2, v67, s52, v2 bitop3:0xbe
    v_bitop3_b32 v2, v69, s52, v2 bitop3:0xbe
    v_bitop3_b32 v2, v71, s52, v2 bitop3:0xbe
    v_bitop3_b32 v2, v73, s52, v2 bitop3:0xbe
    v_bitop3_b32 v2, v75, s52, v2 bitop3:0xbe
    v_bitop3_b32 v2, v77, s52, v2 bitop3:0xbe
    v_bitop3_b32 v2, v79, s52, v2 bitop3:0xbe
    v_bitop3_b32 v2, v81, s52, v2 bitop3:0xbe
    v_bitop3_b32 v2, v83, s52, v2 bitop3:0xbe
    v_bitop3_b32 v2, v85, s52, v2 bitop3:0xbe
    v_bitop3_b32 v2, v87, s52, v2 bitop3:0xbe
    v_bitop3_b32 v2, v89, s52, v2 bitop3:0xbe
    v_bitop3_b32 v2, v91, s52, v2 bitop3:0xbe
    v_bitop3_b32 v2, v93, s52, v2 bitop3:0xbe
    v_bitop3_b32 v2, v95, s52, v2 bitop3:0xbe
    v_bitop3_b32 v2, v97, s52, v2 bitop3:0xbe
    v_bitop3_b32 v2, v99, s52, v2 bitop3:0xbe
    v_bitop3_b32 v2, v101, s52, v2 bitop3:0xbe
    v_bitop3_b32 v2, v103, s52, v2 bitop3:0xbe
    v_bitop3_b32 v2, v105, s52, v2 bitop3:0xbe
    v_bitop3_b32 v2, v107, s52, v2 bitop3:0xbe
    v_bitop3_b32 v2, v109, s52, v2 bitop3:0xbe
    v_bitop3_b32 v2, v111, s52, v2 bitop3:0xbe
    v_bitop3_b32 v2, v113, s52, v2 bitop3:0xbe
    v_bitop3_b32 v2, v115, s52, v2 bitop3:0xbe
    v_bitop3_b32 v2, v117, s52, v2 bitop3:0xbe
    v_bitop3_b32 v2, v119, s52, v2 bitop3:0xbe
    v_cmp_ne_u32 vcc, 0, v2
    s_cbranch_vccz FIX_Y_OK
FIX_Y_RETRY:
    s_add_u32 s100, s100, 1
    s_cmp_gt_u32 s100, 20000
    s_cbranch_scc1 FIX_Y_OK
    s_sleep 8
    s_add_u32 s60, s67, 0
    buffer_load_dwordx4 v[64:67], v48, s[28:31], s60 offen sc1
    s_add_u32 s60, s67, 10240
    buffer_load_dwordx4 v[68:71], v48, s[28:31], s60 offen sc1
    s_add_u32 s60, s67, 20480
    buffer_load_dwordx4 v[72:75], v48, s[28:31], s60 offen sc1
    s_add_u32 s60, s67, 30720
    buffer_load_dwordx4 v[76:79], v48, s[28:31], s60 offen sc1
    s_add_u32 s60, s67, 40960
    buffer_load_dwordx4 v[80:83], v48, s[28:31], s60 offen sc1
    s_add_u32 s60, s67, 51200
    buffer_load_dwordx4 v[84:87], v48, s[28:31], s60 offen sc1
    s_add_u32 s60, s67, 61440
    buffer_load_dwordx4 v[88:91], v48, s[28:31], s60 offen sc1
    s_add_u32 s60, s67, 71680
    buffer_load_dwordx4 v[92:95], v48, s[28:31], s60 offen sc1
    s_add_u32 s60, s67, 81920
    buffer_load_dwordx4 v[96:99], v48, s[28:31], s60 offen sc1
    s_add_u32 s60, s67, 92160
    buffer_load_dwordx4 v[100:103], v48, s[28:31], s60 offen sc1
    s_add_u32 s60, s67, 102400
    buffer_load_dwordx4 v[104:107], v48, s[28:31], s60 offen sc1
    s_add_u32 s60, s67, 112640
    buffer_load_dwordx4 v[108:111], v48, s[28:31], s60 offen sc1
    s_add_u32 s60, s67, 122880
    buffer_load_dwordx4 v[112:115], v48, s[28:31], s60 offen sc1
    s_add_u32 s60, s67, 133120
    s_mov_b32 exec_hi, 0
    buffer_load_dwordx4 v[116:119], v48, s[28:31], s60 offen sc1
    s_mov_b32 exec_hi, -1
    s_waitcnt vmcnt(0)
    s_branch FIX_Y_CHK
FIX_Y_OK:
    v_add_f32 v64, v64, v68
    v_add_f32 v66, v66, v70
    v_add_f32 v64, v64, v72
    v_add_f32 v66, v66, v74
    v_add_f32 v64, v64, v76
    v_add_f32 v66, v66, v78
    v_add_f32 v64, v64, v80
    v_add_f32 v66, v66, v82
    v_add_f32 v64, v64, v84
    v_add_f32 v66, v66, v86
    v_add_f32 v64, v64, v88
    v_add_f32 v66, v66, v90
    v_add_f32 v64, v64, v92
    v_add_f32 v66, v66, v94
    v_add_f32 v64, v64, v96
    v_add_f32 v66, v66, v98
    v_add_f32 v64, v64, v100
    v_add_f32 v66, v66, v102
    v_add_f32 v64, v64, v104
    v_add_f32 v66, v66, v106
    v_add_f32 v64, v64, v108
    v_add_f32 v66, v66, v110
    v_add_f32 v64, v64, v112
    v_add_f32 v66, v66, v114
    v_add_f32 v64, v64, v116
    v_add_f32 v66, v66, v118
    v_mov_b32 v65, v66
    v_mov_b32 v66, v64
    v_mov_b32 v67, v65
    s_nop 0
    v_permlane32_swap_b32 v64, v66
    v_permlane32_swap_b32 v65, v67
    v_add_f32 v64, v64, v66
    v_add_f32 v65, v65, v67
    v_cvt_pk_bf16_f32 v3, v64, v65
    v_lshlrev_b32 v64, 16, v3
    v_and_b32 v65, s55, v3
    v_mul_f32 v64, v64, v55
    v_mul_f32 v65, v65, v55
    v_cvt_pk_bf16_f32 v3, v64, v65
    v_lshlrev_b32 v64, 16, v3
    v_and_b32 v65, s55, v3
    v_add_f32 v50, v50, v64
    v_add_f32 v51, v51, v65
    v_cvt_pk_bf16_f32 v3, v50, v51
    v_lshlrev_b32 v50, 16, v3
    v_and_b32 v51, s55, v3
    v_mul_f32 v64, 0xbfb8aa3b, v50
    v_mul_f32 v65, 0xbfb8aa3b, v51
    v_exp_f32 v64, v64
    v_exp_f32 v65, v65
    v_add_f32 v64, 1.0, v64
    v_add_f32 v65, 1.0, v65
    v_rcp_f32 v64, v64
    v_rcp_f32 v65, v65
    v_mul_f32 v50, v50, v64
    v_mul_f32 v51, v51, v65
    s_branch FIX_N
L_CONT:
    s_lshr_b32 s64, 4099, s67
    s_and_b32 s64, s64, 15
    s_cmp_ge_u32 s64, 3
    s_cselect_b32 s65, s68, 0
    s_add_u32 s64, s64, s65
    s_cmp_ge_u32 s64, 10
    s_cselect_b32 s65, 7, 0
    s_sub_u32 s64, s64, s65
    s_mul_i32 s65, s64, 245760
    s_lshl_b32 s64, s64, 7
    s_add_u32 s64, s64, s57
    s_add_u32 m0, s69, 0
    s_mov_b32 exec_lo, s70
    buffer_load_dwordx4 v196, s[24:27], s64 offen lds
    s_add_u32 m0, s69, 4096
    s_mov_b32 exec_lo, -1
    buffer_load_dwordx4 v197, s[24:27], s64 offen lds
    s_add_u32 m0, s69, 8192
    s_add_u32 s65, s65, s58
    buffer_load_dwordx4 v198, s[24:27], s64 offen lds
    s_cbranch_vccz L_SK1
    s_add_u32 m0, s69, 12288
    s_nop 0
    buffer_load_dwordx4 v199, s[24:27], s64 offen lds
L_SK1:
    s_add_u32 m0, s69, 14336
    s_add_u32 s66, s65, 122880
    buffer_load_dwordx4 v200, s[32:35], s65 offen offset:0 lds
    s_add_u32 m0, s69, 21248
    s_nop 0
    buffer_load_dwordx4 v200, s[32:35], s65 offen offset:1280 lds
    s_add_u32 m0, s69, 28160
    s_nop 0
    buffer_load_dwordx4 v200, s[32:35], s65 offen offset:2560 lds
    s_add_u32 m0, s69, 18432
    s_nop 0
    buffer_load_dwordx4 v200, s[32:35], s66 offen offset:0 lds
    s_add_u32 m0, s69, 25344
    s_nop 0
    buffer_load_dwordx4 v200, s[32:35], s66 offen offset:1280 lds
    s_add_u32 m0, s69, 32256
    s_nop 0
    buffer_load_dwordx4 v200, s[32:35], s66 offen offset:2560 lds
    s_mul_i32 s60, s3, 5
    s_lshl_b32 s61, s53, 6
    s_add_u32 s60, s60, s61
    s_add_u32 s60, s60, K_TAB-K_PC
    s_load_dwordx16 s[4:19], s[20:21], s60
    s_load_dwordx2 s[44:45], s[0:1], 64
    s_load_dwordx2 s[40:41], s[0:1], 16
    s_mov_b32 s46, 2621440
    s_mov_b32 s47, 0x20000
    s_mov_b32 s30, 7077888
    s_mov_b32 s31, 0x20000
    s_mov_b32 s42, 819200
    s_mov_b32 s43, 0x20000
    s_lshr_b32 s3, s3, 6
    s_and_b32 s59, s3, 3
    s_mov_b32 s55, 0xffff0000
    s_mov_b32 s100, 0
    v_and_b32 v1, 63, v0
    v_and_b32 v4, 15, v1
    v_lshrrev_b32 v5, 4, v1
    v_mov_b32 v19, 163584
    v_add_u32 v18, s3, v19
    s_cbranch_vccz L_W0a
    s_waitcnt vmcnt(10)
    s_branch L_W0b
L_W0a:
    s_waitcnt vmcnt(9)
L_W0b:
    s_barrier
    s_lshr_b32 s64, 139585, s67
    s_and_b32 s64, s64, 15
    s_cmp_ge_u32 s64, 3
    s_cselect_b32 s65, s68, 0
    s_add_u32 s64, s64, s65
    s_cmp_ge_u32 s64, 10
    s_cselect_b32 s65, 7, 0
    s_sub_u32 s64, s64, s65
    s_mul_i32 s65, s64, 245760
    s_lshl_b32 s64, s64, 7
    s_add_u32 s64, s64, s57
    s_add_u32 m0, s69, 38912
    s_mov_b32 exec_lo, s70
    buffer_load_dwordx4 v196, s[24:27], s64 offen lds
    s_add_u32 m0, s69, 43008
    s_mov_b32 exec_lo, -1
    buffer_load_dwordx4 v197, s[24:27], s64 offen lds
    s_add_u32 m0, s69, 47104
    s_add_u32 s65, s65, s58
    buffer_load_dwordx4 v198, s[24:27], s64 offen lds
    s_cbranch_vccz L_SK2
    s_add_u32 m0, s69, 51200
    s_nop 0
    buffer_load_dwordx4 v199, s[24:27], s64 offen lds
L_SK2:
    s_add_u32 m0, s69, 53248
    s_add_u32 s66, s65, 122880
    buffer_load_dwordx4 v200, s[32:35], s65 offen offset:0 lds
    v_lshlrev_b32 v6, 4, v1
    v_mov_b32 v28, 0x3f803f80
    v_mov_b32 v29, 0x3f803f80
    v_mov_b32 v30, 0x3f803f80
    v_mov_b32 v31, 0x3f803f80
    s_add_u32 m0, s69, 60160
    s_nop 0
    buffer_load_dwordx4 v200, s[32:35], s65 offen offset:1280 lds
    v_lshlrev_b32 v2, 2, v5
    v_sub_u32 v3, v4, v2
    v_add_u32 v3, 12, v3
    s_mov_b32 s60, 267390975
    v_bfe_i32 v32, s60, v3, 1
    s_add_u32 m0, s69, 67072
    s_nop 0
    buffer_load_dwordx4 v200, s[32:35], s65 offen offset:2560 lds
    v_and_b32 v32, 0xff800000, v32
    s_mov_b32 s60, 268435440
    v_bfe_i32 v36, s60, v3, 1
    v_and_b32 v36, 0xff800000, v36
    s_mov_b32 s60, 266346495
    s_add_u32 m0, s69, 57344
    s_nop 0
    buffer_load_dwordx4 v200, s[32:35], s66 offen offset:0 lds
    v_bfe_i32 v33, s60, v3, 1
    v_and_b32 v33, 0xff800000, v33
    s_mov_b32 s60, 268435424
    v_bfe_i32 v37, s60, v3, 1
    v_and_b32 v37, 0xff800000, v37
    s_add_u32 m0, s69, 64256
    s_nop 0
    buffer_load_dwordx4 v200, s[32:35], s66 offen offset:1280 lds
    s_mov_b32 s60, 264257535
    v_bfe_i32 v34, s60, v3, 1
    v_and_b32 v34, 0xff800000, v34
    s_mov_b32 s60, 268435392
    v_bfe_i32 v38, s60, v3, 1
    s_add_u32 m0, s69, 71168
    s_nop 0
    buffer_load_dwordx4 v200, s[32:35], s66 offen offset:2560 lds
    v_and_b32 v38, 0xff800000, v38
    s_mov_b32 s60, 260079615
    v_bfe_i32 v35, s60, v3, 1
    v_and_b32 v35, 0xff800000, v35
    s_mov_b32 s60, 268435328
    s_waitcnt vmcnt(9)
    s_barrier
    s_lshr_b32 s64, 217890, s67
    s_and_b32 s64, s64, 15
    s_cmp_ge_u32 s64, 3
    s_cselect_b32 s65, s68, 0
    s_add_u32 s64, s64, s65
    s_cmp_ge_u32 s64, 10
    s_cselect_b32 s65, 7, 0
    s_sub_u32 s64, s64, s65
    s_mul_i32 s65, s64, 245760
    s_lshl_b32 s64, s64, 7
    s_add_u32 s64, s64, s57
    s_add_u32 m0, s69, 77824
    s_mov_b32 exec_lo, s70
    buffer_load_dwordx4 v196, s[24:27], s64 offen lds
    s_add_u32 m0, s69, 81920
    s_mov_b32 exec_lo, -1
    buffer_load_dwordx4 v197, s[24:27], s64 offen lds
    s_add_u32 m0, s69, 86016
    s_add_u32 s65, s65, s58
    buffer_load_dwordx4 v198, s[24:27], s64 offen lds
    s_cbranch_vccz L_SK3
    s_add_u32 m0, s69, 90112
    s_nop 0
    buffer_load_dwordx4 v199, s[24:27], s64 offen lds
L_SK3:
    s_add_u32 m0, s69, 92160
    s_add_u32 s66, s65, 122880
    buffer_load_dwordx4 v200, s[32:35], s65 offen offset:0 lds
    v_bfe_i32 v39, s60, v3, 1
    v_and_b32 v39, 0xff800000, v39
    v_sub_u32 v2, 13, v3
    v_med3_i32 v2, v2, 0, 2
    v_lshlrev_b32 v2, 3, v2
    s_add_u32 m0, s69, 99072
    s_nop 0
    buffer_load_dwordx4 v200, s[32:35], s65 offen offset:1280 lds
    v_mov_b32 v40, -1
    v_lshrrev_b32 v40, v2, v40
    v_lshrrev_b32 v40, v2, v40
    v_sub_u32 v2, 15, v3
    v_med3_i32 v2, v2, 0, 2
    s_add_u32 m0, s69, 105984
    s_nop 0
    buffer_load_dwordx4 v200, s[32:35], s65 offen offset:2560 lds
    v_lshlrev_b32 v2, 3, v2
    v_mov_b32 v41, -1
    v_lshrrev_b32 v41, v2, v41
    v_lshrrev_b32 v41, v2, v41
    s_ashr_i32 s60, s56, 31
    s_add_u32 m0, s69, 96256
    s_nop 0
    buffer_load_dwordx4 v200, s[32:35], s66 offen offset:0 lds
    s_and_b32 s60, s60, 0xff800000
    v_lshrrev_b32 v2, 3, v1
    v_bfe_i32 v2, 10, v2, 1
    v_and_b32 v2, s60, v2
    v_or_b32 v42, v32, v2
    s_add_u32 m0, s69, 103168
    s_nop 0
    buffer_load_dwordx4 v200, s[32:35], s66 offen offset:1280 lds
    v_or_b32 v43, v33, v2
    v_or_b32 v44, v34, v2
    v_or_b32 v45, v35, v2
    v_mul_u32_u24 v25, 20224, v5
    v_add_u32 v25, v25, v6
    s_add_u32 m0, s69, 110080
    s_nop 0
    buffer_load_dwordx4 v200, s[32:35], s66 offen offset:2560 lds
    v_lshrrev_b32 v24, 5, v1
    v_mul_u32_u24 v24, 19968, v24
    v_add_u32 v24, v24, v6
    v_lshlrev_b32 v26, 4, v4
    v_add_u32 v26, 161544, v26
    s_waitcnt vmcnt(9)
    s_barrier
    s_lshr_b32 s64, 406580, s67
    s_and_b32 s64, s64, 15
    s_add_u32 s64, s64, s68
    s_cmp_ge_u32 s64, 10
    s_cselect_b32 s65, 7, 0
    s_sub_u32 s64, s64, s65
    s_mul_i32 s65, s64, 245760
    s_lshl_b32 s64, s64, 7
    s_add_u32 s64, s64, s57
    s_add_u32 m0, s69, 0
    s_mov_b32 exec_lo, s70
    buffer_load_dwordx4 v196, s[24:27], s64 offen lds
    s_add_u32 m0, s69, 4096
    s_mov_b32 exec_lo, -1
    buffer_load_dwordx4 v197, s[24:27], s64 offen lds
    s_add_u32 m0, s69, 8192
    s_add_u32 s65, s65, s58
    buffer_load_dwordx4 v198, s[24:27], s64 offen lds
    s_cbranch_vccz L_SK4
    s_add_u32 m0, s69, 12288
    s_nop 0
    buffer_load_dwordx4 v199, s[24:27], s64 offen lds
L_SK4:
    s_add_u32 m0, s69, 14336
    s_add_u32 s66, s65, 122880
    buffer_load_dwordx4 v200, s[32:35], s65 offen offset:0 lds
    v_bfe_u32 v2, v1, 2, 2
    v_lshlrev_b32 v2, 7, v2
    v_and_b32 v3, 8, v1
    v_lshl_add_u32 v2, v3, 2, v2
    v_and_b32 v3, 3, v1
    s_add_u32 m0, s69, 21248
    s_nop 0
    buffer_load_dwordx4 v200, s[32:35], s65 offen offset:1280 lds
    v_lshl_add_u32 v2, v3, 3, v2
    v_and_b32 v3, 48, v1
    s_mov_b32 s62, 0xffff
    s_mov_b32 s60, 201329216
    s_mov_b32 s61, 373298176
    s_add_u32 m0, s69, 28160
    s_nop 0
    buffer_load_dwordx4 v200, s[32:35], s65 offen offset:2560 lds
    v_lshrrev_b64 v[46:47], v3, s[60:61]
    v_and_or_b32 v9, v46, s62, v2
    s_mov_b32 s60, 37748736
    s_mov_b32 s61, 2550175296
    v_lshrrev_b64 v[46:47], v3, s[60:61]
    s_add_u32 m0, s69, 18432
    s_nop 0
    buffer_load_dwordx4 v200, s[32:35], s66 offen offset:0 lds
    v_and_or_b32 v10, v46, s62, v2
    s_mov_b32 s60, 469766720
    s_mov_b32 s61, 977285120
    v_lshrrev_b64 v[46:47], v3, s[60:61]
    v_and_or_b32 v11, v46, s62, v2
    s_add_u32 m0, s69, 25344
    s_nop 0
    buffer_load_dwordx4 v200, s[32:35], s66 offen offset:1280 lds
    s_mov_b32 s60, 2483063360
    s_mov_b32 s61, 2654996480
    v_lshrrev_b64 v[46:47], v3, s[60:61]
    v_and_or_b32 v12, v46, s62, v2
    s_mov_b32 s60, 574627840
    s_add_u32 m0, s69, 32256
    s_nop 0
    buffer_load_dwordx4 v200, s[32:35], s66 offen offset:2560 lds
    s_mov_b32 s61, 2051045376
    v_lshrrev_b64 v[46:47], v3, s[60:61]
    v_and_or_b32 v13, v46, s62, v2
    s_mov_b32 s60, 1073757184
    s_mov_b32 s61, 1610635840
    s_add_u32 m0, s69, 146304
    s_add_u32 s64, s58, s57
    buffer_load_dwordx4 v196, s[24:27], s64 offen lds
    s_waitcnt vmcnt(10)
    s_barrier
    s_lshr_b32 s64, 280405, s67
    s_and_b32 s64, s64, 15
    s_add_u32 s64, s64, s68
    s_cmp_ge_u32 s64, 10
    s_cselect_b32 s65, 7, 0
    s_sub_u32 s64, s64, s65
    s_mul_i32 s65, s64, 245760
    s_lshl_b32 s64, s64, 7
    s_add_u32 s64, s64, s57
    s_add_u32 m0, s69, 38912
    s_mov_b32 exec_lo, s70
    buffer_load_dwordx4 v196, s[24:27], s64 offen lds
    s_add_u32 m0, s69, 43008
    s_mov_b32 exec_lo, -1
    buffer_load_dwordx4 v197, s[24:27], s64 offen lds
    s_add_u32 m0, s69, 47104
    s_add_u32 s65, s65, s58
    buffer_load_dwordx4 v198, s[24:27], s64 offen lds
    s_cbranch_vccz L_SK5
    s_add_u32 m0, s69, 51200
    s_nop 0
    buffer_load_dwordx4 v199, s[24:27], s64 offen lds
L_SK5:
    s_add_u32 m0, s69, 53248
    s_add_u32 s66, s65, 122880
    buffer_load_dwordx4 v200, s[32:35], s65 offen offset:0 lds
    v_lshrrev_b64 v[46:47], v3, s[60:61]
    v_and_or_b32 v14, v46, s62, v2
    s_mov_b32 s60, 1140858432
    s_mov_b32 s61, 2147507776
    v_lshrrev_b64 v[46:47], v3, s[60:61]
    s_add_u32 m0, s69, 60160
    s_nop 0
    buffer_load_dwordx4 v200, s[32:35], s65 offen offset:1280 lds
    v_and_or_b32 v15, v46, s62, v2
    v_lshrrev_b32 v2, 3, v1
    v_bitop3_b32 v3, v1, v2, 7 bitop3:0x28
    v_mul_u32_u24 v7, 2560, v2
    v_lshl_add_u32 v7, v3, 4, v7
    s_add_u32 m0, s69, 67072
    s_nop 0
    buffer_load_dwordx4 v200, s[32:35], s65 offen offset:2560 lds
    v_lshrrev_b32 v2, 5, v1
    v_bitop3_b32 v2, v2, v4, 7 bitop3:0x28
    v_lshlrev_b32 v8, 7, v4
    v_lshl_add_u32 v8, v2, 4, v8
    v_and_b32 v2, 1, v5
    s_add_u32 m0, s69, 57344
    s_nop 0
    buffer_load_dwordx4 v200, s[32:35], s66 offen offset:0 lds
    v_lshl_add_u32 v8, v2, 3, v8
    v_bfe_u32 v2, v0, 3, 5
    v_and_b32 v3, 6, v2
    v_bitop3_b32 v3, v0, v3, 7 bitop3:0x28
    v_mul_u32_u24 v16, 1280, v2
    s_add_u32 m0, s69, 64256
    s_nop 0
    buffer_load_dwordx4 v200, s[32:35], s66 offen offset:1280 lds
    v_lshl_add_u32 v16, v3, 4, v16
    s_lshl_b32 s98, s56, 4
    s_mul_i32 s60, s57, 13
    s_add_u32 s98, s98, s60
    s_add_u32 s98, s98, 458880
    s_add_u32 m0, s69, 71168
    s_nop 0
    buffer_load_dwordx4 v200, s[32:35], s66 offen offset:2560 lds
    s_add_u32 s96, s56, 8
    s_mulk_i32 s96, 1408
    s_mul_i32 s60, s57, 1144
    s_add_u32 s96, s96, s60
    s_add_u32 s96, s96, 1048576
    s_add_u32 m0, s69, 150400
    s_add_u32 s64, s58, s57
    buffer_load_dwordx4 v197, s[24:27], s64 offen lds
    s_waitcnt vmcnt(10)
    s_barrier
    s_lshr_b32 s64, 353640, s67
    s_and_b32 s64, s64, 15
    s_add_u32 s64, s64, s68
    s_cmp_ge_u32 s64, 10
    s_cselect_b32 s65, 7, 0
    s_sub_u32 s64, s64, s65
    s_mul_i32 s65, s64, 245760
    s_lshl_b32 s64, s64, 7
    s_add_u32 s64, s64, s57
    s_add_u32 m0, s69, 77824
    s_mov_b32 exec_lo, s70
    buffer_load_dwordx4 v196, s[24:27], s64 offen lds
    s_add_u32 m0, s69, 81920
    s_mov_b32 exec_lo, -1
    buffer_load_dwordx4 v197, s[24:27], s64 offen lds
    s_add_u32 m0, s69, 86016
    s_add_u32 s65, s65, s58
    buffer_load_dwordx4 v198, s[24:27], s64 offen lds
    s_cbranch_vccz L_SK6
    s_add_u32 m0, s69, 90112
    s_nop 0
    buffer_load_dwordx4 v199, s[24:27], s64 offen lds
L_SK6:
    s_add_u32 m0, s69, 92160
    s_add_u32 s66, s65, 122880
    buffer_load_dwordx4 v200, s[32:35], s65 offen offset:0 lds
    s_and_b32 s62, s2, 1
    s_mulk_i32 s62, 10240
    s_add_u32 s62, s62, s96
    s_sub_u32 s63, s54, s53
    s_and_b32 s60, s2, 7
    s_add_u32 m0, s69, 99072
    s_nop 0
    buffer_load_dwordx4 v200, s[32:35], s65 offen offset:1280 lds
    s_mul_i32 s60, s60, 25
    s_add_u32 s63, s63, s60
    s_mulk_i32 s63, 11520
    s_add_u32 s63, s63, 4194304
    v_mul_u32_u24 v2, 264, v4
    s_add_u32 m0, s69, 105984
    s_nop 0
    buffer_load_dwordx4 v200, s[32:35], s65 offen offset:2560 lds
    v_add_u32 v2, 112512, v2
    v_lshlrev_b32 v3, 3, v5
    s_waitcnt lgkmcnt(0)
    v_bfe_u32 v20, s4, v3, 8
    v_bfe_u32 v21, s5, v3, 8
    s_add_u32 m0, s69, 96256
    s_nop 0
    buffer_load_dwordx4 v200, s[32:35], s66 offen offset:0 lds
    v_add_u32 v20, v20, v2
    v_add_u32 v21, v21, v2
    v_lshrrev_b32 v2, 2, v1
    v_mul_u32_u24 v2, 136, v2
    v_add_u32 v2, 79744, v2
    s_add_u32 m0, s69, 103168
    s_nop 0
    buffer_load_dwordx4 v200, s[32:35], s66 offen offset:1280 lds
    v_add_u32 v23, s7, v2
    v_lshlrev_b32 v3, 3, v1
    v_bfe_u32 v22, s6, v3, 8
    v_add_u32 v22, v22, v2
    s_add_u32 s9, s9, s62
    s_add_u32 m0, s69, 110080
    s_nop 0
    buffer_load_dwordx4 v200, s[32:35], s66 offen offset:2560 lds
    s_add_u32 s10, s10, s62
    s_add_u32 s11, s11, s63
    s_add_u32 s12, s12, s63
    s_add_u32 s5, s9, 40960
    s_mul_i32 s60, s8, 20480
    s_add_u32 m0, s69, 154496
    s_add_u32 s64, s58, s57
    buffer_load_dwordx4 v198, s[24:27], s64 offen lds
    s_waitcnt vmcnt(10)
    s_barrier
    s_lshr_b32 s64, 489110, s67
    s_and_b32 s64, s64, 15
    s_add_u32 s64, s64, s68
    s_cmp_ge_u32 s64, 10
    s_cselect_b32 s65, 7, 0
    s_sub_u32 s64, s64, s65
    s_mul_i32 s65, s64, 245760
    s_lshl_b32 s64, s64, 7
    s_add_u32 s64, s64, s57
    s_add_u32 m0, s69, 0
    s_mov_b32 exec_lo, s70
    buffer_load_dwordx4 v196, s[24:27], s64 offen lds
    s_add_u32 m0, s69, 4096
    s_mov_b32 exec_lo, -1
    buffer_load_dwordx4 v197, s[24:27], s64 offen lds
    s_add_u32 m0, s69, 8192
    s_add_u32 s65, s65, s58
    buffer_load_dwordx4 v198, s[24:27], s64 offen lds
    s_cbranch_vccz L_SK7
    s_add_u32 m0, s69, 12288
    s_nop 0
    buffer_load_dwordx4 v199, s[24:27], s64 offen lds
L_SK7:
    s_add_u32 m0, s69, 14336
    s_add_u32 s66, s65, 122880
    buffer_load_dwordx4 v200, s[32:35], s65 offen offset:0 lds
    s_add_u32 s96, s96, s60
    s_lshl4_add_u32 s95, s8, s56
    s_cmp_eq_u32 s8, 6
    s_cselect_b32 s101, 1, 2
    s_cmpk_ge_i32 s95, 1024
    s_cselect_b32 s101, 0, s101
    s_add_u32 m0, s69, 21248
    s_nop 0
    buffer_load_dwordx4 v200, s[32:35], s65 offen offset:1280 lds
    s_mul_i32 s97, s95, 2560
    s_add_u32 s97, s97, s57
    s_add_u32 s97, s97, s58
    s_add_u32 s94, s97, 20480
    s_cmp_eq_u32 s8, 0
    s_cselect_b32 s97, 2146435072, s97
    s_cselect_b32 s61, 2146435072, 0
    s_add_u32 m0, s69, 28160
    s_nop 0
    buffer_load_dwordx4 v200, s[32:35], s65 offen offset:2560 lds
    s_and_b32 s60, s53, 2
    s_mul_i32 s22, s60, 204800
    s_sub_u32 s23, 409600, s22
    s_add_u32 s22, s22, s58
    s_add_u32 s23, s23, s58
    s_add_u32 m0, s69, 18432
    s_nop 0
    buffer_load_dwordx4 v200, s[32:35], s66 offen offset:0 lds
    s_mulk_i32 s60, 5120
    s_sub_u32 s4, s96, s60
    s_add_u32 s4, s4, 10240
    s_add_u32 s96, s96, s60
    s_add_u32 s92, s96, 4096
    s_add_u32 m0, s69, 25344
    s_nop 0
    buffer_load_dwordx4 v200, s[32:35], s66 offen offset:1280 lds
    s_add_u32 s93, s92, 4096
    s_add_u32 s6, s4, 4096
    s_add_u32 s7, s6, 4096
    v_bfe_i32 v2, v1, 3, 1
    v_bfi_b32 v2, v2, 0, s61
    s_add_u32 m0, s69, 32256
    s_nop 0
    buffer_load_dwordx4 v200, s[32:35], s66 offen offset:2560 lds
    v_or_b32 v27, v2, v6
    s_and_b32 s60, s2, 4
    s_cbranch_vccz L_SKX
    s_add_u32 m0, s69, 158592
    s_add_u32 s64, s58, s57
    buffer_load_dwordx4 v199, s[24:27], s64 offen lds
L_SKX:
    s_waitcnt vmcnt(9)
    s_barrier
    s_lshr_b32 s64, 559223, s67
    s_and_b32 s64, s64, 15
    s_add_u32 s64, s64, s68
    s_cmp_ge_u32 s64, 10
    s_cselect_b32 s65, 7, 0
    s_sub_u32 s64, s64, s65
    s_mul_i32 s65, s64, 245760
    s_lshl_b32 s64, s64, 7
    s_add_u32 s64, s64, s57
    s_add_u32 m0, s69, 38912
    s_mov_b32 exec_lo, s70
    buffer_load_dwordx4 v196, s[24:27], s64 offen lds
    s_add_u32 m0, s69, 43008
    s_mov_b32 exec_lo, -1
    buffer_load_dwordx4 v197, s[24:27], s64 offen lds
    s_add_u32 m0, s69, 47104
    s_add_u32 s65, s65, s58
    buffer_load_dwordx4 v198, s[24:27], s64 offen lds
    s_cbranch_vccz L_SK8
    s_add_u32 m0, s69, 51200
    s_nop 0
    buffer_load_dwordx4 v199, s[24:27], s64 offen lds
L_SK8:
    s_add_u32 m0, s69, 53248
    s_add_u32 s66, s65, 122880
    buffer_load_dwordx4 v200, s[32:35], s65 offen offset:0 lds
    s_lshl_b32 s60, s60, 8
    s_add_u32 s95, s95, s60
    s_lshl_b32 s60, s8, 11
    s_add_u32 s60, s60, 146304
    v_add_u32 v8, s60, v8
    s_add_u32 m0, s69, 60160
    s_nop 0
    buffer_load_dwordx4 v200, s[32:35], s65 offen offset:1280 lds
    s_lshl_b32 s60, s8, 8
    s_add_u32 s60, s60, 161536
    v_lshl_add_u32 v17, v4, 4, s60
    ds_read_b32 v109, v19 offset:32
    s_mul_i32 s60, s59, 28
    s_add_u32 m0, s69, 67072
    s_nop 0
    buffer_load_dwordx4 v200, s[32:35], s65 offen offset:2560 lds
    v_min_u32 v2, 27, v1
    v_add_u32 v2, s60, v2
    v_lshlrev_b32 v82, 4, v2
    v_add_u32 v82, 161536, v82
    v_add_u32 v2, s56, v2
    s_add_u32 m0, s69, 57344
    s_nop 0
    buffer_load_dwordx4 v200, s[32:35], s66 offen offset:0 lds
    v_max_i32 v2, 0, v2
    v_min_u32 v2, 1023, v2
    s_and_b32 s60, s2, 4
    s_lshl_b32 s60, s60, 12
    s_add_u32 s60, s60, 16384
    s_add_u32 m0, s69, 64256
    s_nop 0
    buffer_load_dwordx4 v200, s[32:35], s66 offen offset:1280 lds
    v_lshl_add_u32 v81, v2, 4, s60
    s_lshr_b32 s60, s58, 7
    s_movk_i32 s99, 0x3ff
    s_bitset0_b32 s99, s60
    v_lshlrev_b32 v108, 7, v1
    s_add_u32 m0, s69, 71168
    s_nop 0
    buffer_load_dwordx4 v200, s[32:35], s66 offen offset:2560 lds
    s_mul_i32 s71, s54, 52
    s_lshr_b32 s71, s71, 8
    s_lshl_b32 s71, s71, 13
    s_waitcnt lgkmcnt(0)
    v_readfirstlane_b32 s52, v109
    s_mul_i32 s60, s59, 448
    s_add_u32 m0, s60, 161536
    s_mov_b64 exec, 0xfffffff
    buffer_load_dwordx4 v81, s[28:31], 0 offen  lds
    s_mov_b64 exec, -1
    s_waitcnt vmcnt(10)
    s_barrier
    s_lshr_b32 s64, 629129, s67
    s_and_b32 s64, s64, 15
    s_add_u32 s64, s64, s68
    s_cmp_ge_u32 s64, 10
    s_cselect_b32 s65, 7, 0
    s_sub_u32 s64, s64, s65
    s_mul_i32 s65, s64, 245760
    s_lshl_b32 s64, s64, 7
    s_add_u32 s64, s64, s57
    s_add_u32 m0, s69, 77824
    s_mov_b32 exec_lo, s70
    buffer_load_dwordx4 v196, s[24:27], s64 offen lds
    s_add_u32 m0, s69, 81920
    s_mov_b32 exec_lo, -1
    buffer_load_dwordx4 v197, s[24:27], s64 offen lds
    s_add_u32 m0, s69, 86016
    s_add_u32 s65, s65, s58
    buffer_load_dwordx4 v198, s[24:27], s64 offen lds
    s_cbranch_vccz L_SK9
    s_add_u32 m0, s69, 90112
    s_nop 0
    buffer_load_dwordx4 v199, s[24:27], s64 offen lds
L_SK9:
    s_add_u32 m0, s69, 92160
    s_add_u32 s66, s65, 122880
    buffer_load_dwordx4 v200, s[32:35], s65 offen offset:0 lds
    s_add_u32 m0, s69, 99072
    s_nop 0
    buffer_load_dwordx4 v200, s[32:35], s65 offen offset:1280 lds
    s_add_u32 m0, s69, 105984
    s_nop 0
    buffer_load_dwordx4 v200, s[32:35], s65 offen offset:2560 lds
    s_add_u32 m0, s69, 96256
    s_nop 0
    buffer_load_dwordx4 v200, s[32:35], s66 offen offset:0 lds
    s_add_u32 m0, s69, 103168
    s_nop 0
    buffer_load_dwordx4 v200, s[32:35], s66 offen offset:1280 lds
    s_add_u32 m0, s69, 110080
    s_nop 0
    buffer_load_dwordx4 v200, s[32:35], s66 offen offset:2560 lds
    s_waitcnt vmcnt(9)
    s_barrier
    ds_read_b128 v[84:87], v82
    s_mov_b32 s64, s71
    s_add_u32 s65, s69, 0
    s_add_u32 m0, s64, s65
    s_mul_i32 s61, s64, 10
    s_add_u32 s61, s61, s22
    buffer_load_dwordx4 v16, s[40:43], s61 offen lds
    s_add_u32 s64, s64, 4096
    s_cmp_eq_u32 s64, 36864
    s_cselect_b32 s64, 0, s64
    s_add_u32 m0, s64, s65
    s_mul_i32 s61, s64, 10
    s_add_u32 s61, s61, s22
    buffer_load_dwordx4 v16, s[40:43], s61 offen lds
    s_add_u32 s64, s64, 4096
    s_add_u32 m0, s64, s65
    s_mul_i32 s61, s64, 10
    s_add_u32 s61, s61, s22
    buffer_load_dwordx4 v16, s[40:43], s61 offen lds
    s_add_u32 s64, s64, 4096
    s_cmp_eq_u32 s64, 36864
    s_cselect_b32 s64, 0, s64
    s_add_u32 m0, s64, s65
    s_mul_i32 s61, s64, 10
    s_add_u32 s61, s61, s22
    buffer_load_dwordx4 v16, s[40:43], s61 offen lds
    s_add_u32 s64, s64, 4096
    s_add_u32 m0, s64, s65
    s_mul_i32 s61, s64, 10
    s_add_u32 s61, s61, s22
    buffer_load_dwordx4 v16, s[40:43], s61 offen lds
    s_add_u32 s64, s64, 4096
    s_cmp_eq_u32 s64, 36864
    s_cselect_b32 s64, 0, s64
    s_add_u32 m0, s64, s65
    s_mul_i32 s61, s64, 10
    s_add_u32 s61, s61, s22
    buffer_load_dwordx4 v16, s[40:43], s61 offen lds
    s_add_u32 s64, s64, 4096
    s_add_u32 m0, s64, s65
    s_mul_i32 s61, s64, 10
    s_add_u32 s61, s61, s22
    buffer_load_dwordx4 v16, s[40:43], s61 offen lds
    s_add_u32 s64, s64, 4096
    s_cmp_eq_u32 s64, 36864
    s_cselect_b32 s64, 0, s64
    s_add_u32 m0, s64, s65
    s_mul_i32 s61, s64, 10
    s_add_u32 s61, s61, s22
    buffer_load_dwordx4 v16, s[40:43], s61 offen lds
    s_add_u32 s64, s64, 4096
    s_add_u32 m0, s64, s65
    s_mul_i32 s61, s64, 10
    s_add_u32 s61, s61, s22
    buffer_load_dwordx4 v16, s[40:43], s61 offen lds
    s_waitcnt lgkmcnt(0)
L_RC_CHK:
    v_xor_b32 v2, s52, v85
    v_bitop3_b32 v2, v87, s52, v2 bitop3:0xbe
    v_cmp_ne_u32 vcc, 0, v2
    s_cbranch_vccnz L_RC_RETRY
L_RC_OK:
    s_waitcnt vmcnt(9)
    s_barrier
    s_lshl_b32 s60, s59, 10
    s_add_u32 m0, s60, 36864
    s_add_u32 s60, s22, 368640
    buffer_load_dwordx4 v16, s[40:43], s60 offen lds
    s_mov_b64 exec, 1
    buffer_load_dwordx4 v[112:115], v6, s[28:31], 0 offen offset:256
    s_mov_b64 exec, -1
    s_mul_i32 s64, s71, 10
    s_add_u32 s61, s64, s23
    buffer_load_dwordx4 v[216:219], v16, s[40:43], s61 offen
    s_add_u32 s64, s64, 40960
    s_add_u32 s61, s64, s23
    buffer_load_dwordx4 v[220:223], v16, s[40:43], s61 offen
    s_add_u32 s64, s64, 40960
    s_cmp_eq_u32 s64, 409600
    s_cselect_b32 s64, 0, s64
    s_add_u32 s61, s64, s23
    buffer_load_dwordx4 v[224:227], v16, s[40:43], s61 offen
    s_add_u32 s64, s64, 40960
    s_add_u32 s61, s64, s23
    buffer_load_dwordx4 v[228:231], v16, s[40:43], s61 offen
    s_add_u32 s64, s64, 40960
    s_cmp_eq_u32 s64, 409600
    s_cselect_b32 s64, 0, s64
    s_add_u32 s61, s64, s23
    buffer_load_dwordx4 v[232:235], v16, s[40:43], s61 offen
    s_add_u32 s64, s64, 40960
    s_add_u32 s61, s64, s23
    buffer_load_dwordx4 v[236:239], v16, s[40:43], s61 offen
    s_add_u32 s64, s64, 40960
    s_cmp_eq_u32 s64, 409600
    s_cselect_b32 s64, 0, s64
    s_add_u32 s61, s64, s23
    buffer_load_dwordx4 v[240:243], v16, s[40:43], s61 offen
    s_add_u32 s64, s64, 40960
    s_add_u32 s61, s64, s23
    buffer_load_dwordx4 v[244:247], v16, s[40:43], s61 offen
    s_add_u32 s64, s64, 40960
    s_cmp_eq_u32 s64, 409600
    s_cselect_b32 s64, 0, s64
    s_add_u32 s61, s64, s23
    buffer_load_dwordx4 v[248:251], v16, s[40:43], s61 offen
    s_add_u32 s64, s64, 40960
    s_add_u32 s61, s64, s23
    buffer_load_dwordx4 v[252:255], v16, s[40:43], s61 offen
    s_mov_b64 exec, 0
    s_branch TC0
TC_END:
    s_mov_b64 exec, -1
    s_barrier
    s_setprio 1
    ds_read_b64 v[64:65], v20 offset:4352
    ds_read_b64 v[66:67], v21 offset:4352
    ds_read_b64 v[84:85], v20 offset:4224
    ds_read_b64 v[86:87], v21 offset:4224
    ds_read_b64 v[68:69], v20 offset:8576
    ds_read_b64 v[70:71], v21 offset:8576
    ds_read_b64 v[88:89], v20 offset:8448
    ds_read_b64 v[90:91], v21 offset:8448
    ds_read_b64 v[72:73], v20 offset:12800
    ds_read_b64 v[74:75], v21 offset:12800
    ds_read_b64 v[92:93], v20 offset:12672
    ds_read_b64 v[94:95], v21 offset:12672
    ds_read_b64 v[76:77], v20 offset:17024
    ds_read_b64 v[78:79], v21 offset:17024
    ds_read_b64 v[96:97], v20 offset:16896
    ds_read_b64 v[98:99], v21 offset:16896
    s_cmp_lg_u32 s8, 6
    s_cbranch_scc1 AL_NOR0
    s_mov_b32 exec_lo, s99
    s_mov_b32 exec_hi, 0
    buffer_load_dword v109, v108, s[28:31], s98 offen sc1
    s_mov_b64 exec, -1
AL_NOR0:
    v_lshl_add_u32 v3, v5, 8, v26
    v_mov_b32 v0, v27
    s_waitcnt lgkmcnt(12)
    v_mfma_f32_16x16x32_bf16 v[168:171], v[84:87], v[64:67], v[42:45]
    s_waitcnt lgkmcnt(8)
    v_mfma_f32_16x16x32_bf16 v[172:175], v[88:91], v[68:71], v[32:35]
    v_mfma_f32_16x16x32_bf16 v[52:55], v[84:87], v[68:71], v[36:39]
    s_waitcnt lgkmcnt(4)
    v_mfma_f32_16x16x32_bf16 v[176:179], v[92:95], v[72:75], v[32:35]
    v_mfma_f32_16x16x32_bf16 v[56:59], v[88:91], v[72:75], v[36:39]
    s_waitcnt lgkmcnt(0)
    v_mfma_f32_16x16x32_bf16 v[180:183], v[96:99], v[76:79], v[32:35]
    v_mfma_f32_16x16x32_bf16 v[60:63], v[92:95], v[76:79], v[36:39]
    ds_read_b32 v27, v3
    ds_read2st64_b32 v[36:37], v26 offset1:1
    ds_read2st64_b32 v[38:39], v26 offset0:2 offset1:3
    v_max_f32 v172, v172, v52
    v_max_f32 v173, v173, v53
    v_max_f32 v174, v174, v54
    v_max_f32 v175, v175, v55
    v_max_f32 v176, v176, v56
    v_max_f32 v177, v177, v57
    v_max_f32 v178, v178, v58
    v_max_f32 v179, v179, v59
    v_max_f32 v180, v180, v60
    v_max_f32 v181, v181, v61
    v_max_f32 v182, v182, v62
    v_max_f32 v183, v183, v63
    s_mov_b64 exec, 1
    s_waitcnt vmcnt(0)
L_FL_CHK:
    v_xor_b32 v2, s52, v113
    v_bitop3_b32 v2, v115, s52, v2 bitop3:0xbe
    v_cmp_ne_u32 vcc, 0, v2
    s_cbranch_vccnz L_FL_RETRY
L_FL_OK:
    ds_write2_b32 v19, v112, v114 offset0:10 offset1:11
    s_mov_b64 exec, -1
    s_cmp_lg_u32 s8, 6
    s_cbranch_scc1 AL_NOR1
    s_mov_b32 exec_lo, s99
    s_mov_b32 exec_hi, 0
    s_waitcnt vmcnt(0)
AL_RD_CHK:
    v_xor_b32 v2, s52, v109
    v_cmp_ne_u32 vcc, 0, v2
    s_cbranch_vccz AL_RD_OK
AL_RD_RETRY:
    s_add_u32 s100, s100, 1
    s_cmp_gt_u32 s100, 20000
    s_cbranch_scc1 AL_RD_OK
    s_sleep 1
    buffer_load_dword v109, v108, s[28:31], s98 offen sc1
    s_waitcnt vmcnt(0)
    s_branch AL_RD_CHK
AL_RD_OK:
    s_mov_b64 exec, -1
AL_NOR1:
    s_cmp_lg_u32 s13, 1
    s_cbranch_scc1 AL_SM
    v_cvt_pk_bf16_f32 v64, v168, v169
    v_mov_b32 v65, s52
    v_cvt_pk_bf16_f32 v66, v170, v171
    v_mov_b32 v67, s52
    buffer_store_dwordx4 v[64:67], v6, s[28:31], s11 offen offset:0 sc1
    v_cvt_pk_bf16_f32 v68, v172, v173
    v_mov_b32 v69, s52
    v_cvt_pk_bf16_f32 v70, v174, v175
    v_mov_b32 v71, s52
    buffer_store_dwordx4 v[68:71], v6, s[28:31], s11 offen offset:1024 sc1
    v_cvt_pk_bf16_f32 v72, v176, v177
    v_mov_b32 v73, s52
    v_cvt_pk_bf16_f32 v74, v178, v179
    v_mov_b32 v75, s52
    buffer_store_dwordx4 v[72:75], v6, s[28:31], s11 offen offset:2048 sc1
    v_cvt_pk_bf16_f32 v76, v180, v181
    v_mov_b32 v77, s52
    v_cvt_pk_bf16_f32 v78, v182, v183
    v_mov_b32 v79, s52
    buffer_store_dwordx4 v[76:79], v6, s[28:31], s11 offen offset:3072 sc1
    s_branch AL_X
AL_SM:
    v_max3_f32 v136, v168, v169, v170
    v_max3_f32 v138, v172, v173, v174
    v_max3_f32 v140, v176, v177, v178
    v_max3_f32 v142, v180, v181, v182
    v_max_f32 v136, v136, v171
    v_max_f32 v138, v138, v175
    v_max_f32 v140, v140, v179
    v_max_f32 v142, v142, v183
    s_nop 0
    v_permlane32_swap_b32 v136, v140
    v_permlane32_swap_b32 v138, v142
    v_max_f32 v136, v136, v140
    v_max_f32 v138, v138, v142
    s_waitcnt lgkmcnt(0)
    v_mul_f32 v27, 0x3ea52b5c, v27
    v_permlane16_swap_b32 v136, v138
    v_max_f32 v136, v136, v138
    v_mul_f32 v138, v136, v27
    v_mul_f32 v136, v136, v27
    v_mul_f32 v32, 0x3ea52b5c, v36
    v_mul_f32 v34, 0x3ea52b5c, v37
    v_permlane16_swap_b32 v136, v138
    v_mov_b32 v140, v136
    v_mov_b32 v142, v138
    v_mul_f32 v36, 0x3ea52b5c, v38
    v_mul_f32 v38, 0x3ea52b5c, v39
    v_permlane32_swap_b32 v136, v140
    v_permlane32_swap_b32 v138, v142
    v_pk_fma_f32 v[168:169], v[168:169], v[32:33], v[136:137] op_sel_hi:[1,0,0] neg_lo:[0,0,1] neg_hi:[0,0,1]
    v_pk_fma_f32 v[170:171], v[170:171], v[32:33], v[136:137] op_sel_hi:[1,0,0] neg_lo:[0,0,1] neg_hi:[0,0,1]
    v_pk_fma_f32 v[172:173], v[172:173], v[34:35], v[138:139] op_sel_hi:[1,0,0] neg_lo:[0,0,1] neg_hi:[0,0,1]
    v_pk_fma_f32 v[174:175], v[174:175], v[34:35], v[138:139] op_sel_hi:[1,0,0] neg_lo:[0,0,1] neg_hi:[0,0,1]
    v_pk_fma_f32 v[176:177], v[176:177], v[36:37], v[140:141] op_sel_hi:[1,0,0] neg_lo:[0,0,1] neg_hi:[0,0,1]
    v_pk_fma_f32 v[178:179], v[178:179], v[36:37], v[140:141] op_sel_hi:[1,0,0] neg_lo:[0,0,1] neg_hi:[0,0,1]
    v_pk_fma_f32 v[180:181], v[180:181], v[38:39], v[142:143] op_sel_hi:[1,0,0] neg_lo:[0,0,1] neg_hi:[0,0,1]
    v_pk_fma_f32 v[182:183], v[182:183], v[38:39], v[142:143] op_sel_hi:[1,0,0] neg_lo:[0,0,1] neg_hi:[0,0,1]
    s_cmp_eq_u32 s13, 1
    s_cbranch_scc1 AL_NOY
    s_barrier
    ds_read_b64_tr_b16 v[184:185], v22 offset:2176
    ds_read_b64_tr_b16 v[194:195], v23 offset:2176
    ds_read_b64_tr_b16 v[186:187], v22 offset:2176
    ds_read_b64_tr_b16 v[196:197], v23 offset:2176
    ds_read_b64_tr_b16 v[188:189], v22 offset:4352
    ds_read_b64_tr_b16 v[198:199], v23 offset:4352
    ds_read_b64_tr_b16 v[190:191], v22 offset:6528
    ds_read_b64_tr_b16 v[200:201], v23 offset:6528
    ds_read_b64_tr_b16 v[192:193], v22 offset:8704
    ds_read_b64_tr_b16 v[202:203], v23 offset:8704
AL_NOY:
    v_exp_f32 v168, v168
    v_exp_f32 v169, v169
    v_exp_f32 v170, v170
    v_exp_f32 v171, v171
    v_cvt_pk_bf16_f32 v2, v168, v169
    v_cvt_pk_bf16_f32 v3, v170, v171
    v_bfi_b32 v168, v40, 0, v2
    v_bfi_b32 v169, v41, 0, v3
    v_and_b32 v170, v40, v2
    v_and_b32 v171, v41, v3
    s_waitcnt lgkmcnt(0)
    v_exp_f32 v172, v172
    v_mfma_f32_16x16x32_bf16 v[116:119], v[28:31], v[168:171], 0
    v_exp_f32 v173, v173
    v_mfma_f32_16x16x32_bf16 v[136:139], v[184:187], v[168:171], 0
    v_exp_f32 v174, v174
    v_mfma_f32_16x16x32_bf16 v[152:155], v[194:197], v[168:171], 0
    v_exp_f32 v175, v175
    v_cvt_pk_bf16_f32 v2, v172, v173
    v_cvt_pk_bf16_f32 v3, v174, v175
    v_bfi_b32 v172, v40, 0, v2
    v_bfi_b32 v173, v41, 0, v3
    v_and_b32 v174, v40, v2
    v_and_b32 v175, v41, v3
    v_rcp_f32 v32, v116
    v_exp_f32 v176, v176
    v_mfma_f32_16x16x32_bf16 v[120:123], v[28:31], v[172:175], 0
    v_exp_f32 v177, v177
    v_mfma_f32_16x16x32_bf16 v[140:143], v[186:189], v[172:175], 0
    v_exp_f32 v178, v178
    v_mfma_f32_16x16x32_bf16 v[156:159], v[196:199], v[172:175], 0
    v_exp_f32 v179, v179
    v_cvt_pk_bf16_f32 v2, v176, v177
    v_cvt_pk_bf16_f32 v3, v178, v179
    v_bfi_b32 v176, v40, 0, v2
    v_bfi_b32 v177, v41, 0, v3
    v_and_b32 v178, v40, v2
    v_and_b32 v179, v41, v3
    v_rcp_f32 v34, v120
    v_exp_f32 v180, v180
    v_mfma_f32_16x16x32_bf16 v[116:119], v[28:31], v[176:179], 0
    v_exp_f32 v181, v181
    v_mfma_f32_16x16x32_bf16 v[144:147], v[188:191], v[176:179], 0
    v_exp_f32 v182, v182
    v_mfma_f32_16x16x32_bf16 v[160:163], v[198:201], v[176:179], 0
    v_exp_f32 v183, v183
    v_cvt_pk_bf16_f32 v2, v180, v181
    v_cvt_pk_bf16_f32 v3, v182, v183
    v_bfi_b32 v180, v40, 0, v2
    v_bfi_b32 v181, v41, 0, v3
    v_and_b32 v182, v40, v2
    v_and_b32 v183, v41, v3
    v_rcp_f32 v36, v116
    v_mul_f32 v136, v136, v32
    v_mfma_f32_16x16x32_bf16 v[120:123], v[28:31], v[180:183], 0
    v_mul_f32 v137, v137, v32
    v_mfma_f32_16x16x32_bf16 v[148:151], v[190:193], v[180:183], 0
    v_mul_f32 v138, v138, v32
    v_mfma_f32_16x16x32_bf16 v[164:167], v[200:203], v[180:183], 0
    v_mul_f32 v139, v139, v32
    v_cvt_pk_bf16_f32 v136, v136, v137
    v_cvt_pk_bf16_f32 v137, v138, v139
    v_mul_f32 v140, v140, v34
    v_mul_f32 v141, v141, v34
    v_mul_f32 v142, v142, v34
    v_mul_f32 v143, v143, v34
    v_cvt_pk_bf16_f32 v138, v140, v141
    v_cvt_pk_bf16_f32 v139, v142, v143
    v_rcp_f32 v38, v120
    v_pk_mul_f32 v[144:145], v[144:145], v[36:37] op_sel_hi:[1,0]
    v_pk_mul_f32 v[146:147], v[146:147], v[36:37] op_sel_hi:[1,0]
    v_permlane32_swap_b32 v136, v138
    v_permlane32_swap_b32 v137, v139
    v_pk_mul_f32 v[148:149], v[148:149], v[38:39] op_sel_hi:[1,0]
    v_pk_mul_f32 v[150:151], v[150:151], v[38:39] op_sel_hi:[1,0]
    v_cvt_pk_bf16_f32 v144, v144, v145
    v_cvt_pk_bf16_f32 v145, v146, v147
    v_cvt_pk_bf16_f32 v146, v148, v149
    v_cvt_pk_bf16_f32 v147, v150, v151
    s_mov_b64 exec, s[14:15]
    buffer_store_dwordx4 v[136:139], v24, s[28:31], s9 offen sc1
    s_mov_b64 exec, -1
    v_permlane32_swap_b32 v144, v146
    v_permlane32_swap_b32 v145, v147
    v_pk_mul_f32 v[152:153], v[152:153], v[32:33] op_sel_hi:[1,0]
    v_pk_mul_f32 v[154:155], v[154:155], v[32:33] op_sel_hi:[1,0]
    s_mov_b64 exec, s[16:17]
    buffer_store_dwordx4 v[144:147], v24, s[28:31], s5 offen sc1
    s_lshl_b64 exec, -1, 16
    v_pk_mul_f32 v[152:153], v[156:157], v[34:35] op_sel_hi:[1,0]
    v_pk_mul_f32 v[154:155], v[158:159], v[34:35] op_sel_hi:[1,0]
    s_lshl_b64 exec, -1, 32
    v_pk_mul_f32 v[152:153], v[160:161], v[36:37] op_sel_hi:[1,0]
    v_pk_mul_f32 v[154:155], v[162:163], v[36:37] op_sel_hi:[1,0]
    s_lshl_b64 exec, -1, 48
    v_pk_mul_f32 v[152:153], v[164:165], v[38:39] op_sel_hi:[1,0]
    v_pk_mul_f32 v[154:155], v[166:167], v[38:39] op_sel_hi:[1,0]
    s_mov_b64 exec, s[18:19]
    v_cvt_pk_bf16_f32 v152, v152, v153
    v_cvt_pk_bf16_f32 v153, v154, v155
    buffer_store_dwordx2 v[152:153], v25, s[28:31], s10 offen sc1
    s_mov_b64 exec, -1
    s_cmp_eq_u32 s13, 1
    s_cbranch_scc1 P_TAIL
    s_mov_b32 s64, s71
    s_add_u32 s65, s69, 40960
    s_add_u32 s61, s64, s65
    v_add_u32 v3, s61, v6
    ds_write_b128 v3, v[216:219] offset:0
    ds_write_b128 v3, v[220:223] offset:4096
    s_add_u32 s64, s64, 8192
    s_cmp_eq_u32 s64, 40960
    s_cselect_b32 s64, 0, s64
    s_add_u32 s61, s64, s65
    v_add_u32 v3, s61, v6
    ds_write_b128 v3, v[224:227] offset:0
    ds_write_b128 v3, v[228:231] offset:4096
    s_add_u32 s64, s64, 8192
    s_cmp_eq_u32 s64, 40960
    s_cselect_b32 s64, 0, s64
    s_add_u32 s61, s64, s65
    v_add_u32 v3, s61, v6
    ds_write_b128 v3, v[232:235] offset:0
    ds_write_b128 v3, v[236:239] offset:4096
    s_add_u32 s64, s64, 8192
    s_cmp_eq_u32 s64, 40960
    s_cselect_b32 s64, 0, s64
    s_add_u32 s61, s64, s65
    v_add_u32 v3, s61, v6
    ds_write_b128 v3, v[240:243] offset:0
    ds_write_b128 v3, v[244:247] offset:4096
    s_add_u32 s64, s64, 8192
    s_cmp_eq_u32 s64, 40960
    s_cselect_b32 s64, 0, s64
    s_add_u32 s61, s64, s65
    v_add_u32 v3, s61, v6
    ds_write_b128 v3, v[248:251] offset:0
    ds_write_b128 v3, v[252:255] offset:4096
    v_mov_b32 v2, 1
    ds_write_b8 v18, v2 offset:16
    s_branch A_DONE
AC_X:
TC0:
    s_cbranch_execz TC1
    s_setprio 0
    s_sleep 12
    s_setprio 2
    buffer_load_dwordx4 v[136:139], v6, s[28:31], s12 offen offset:0 sc1
    buffer_load_dwordx4 v[140:143], v6, s[28:31], s12 offen offset:1024 sc1
    buffer_load_dwordx4 v[144:147], v6, s[28:31], s12 offen offset:2048 sc1
    s_setprio 0
    s_call_b64 s[20:21], K_P1
    s_call_b64 s[20:21], K_P2
    s_setprio 2
    s_waitcnt vmcnt(0)
AC_MB_CHK:
    v_xor_b32 v2, s52, v137
    v_bitop3_b32 v2, v139, s52, v2 bitop3:0xbe
    v_bitop3_b32 v2, v141, s52, v2 bitop3:0xbe
    v_bitop3_b32 v2, v143, s52, v2 bitop3:0xbe
    v_bitop3_b32 v2, v145, s52, v2 bitop3:0xbe
    v_bitop3_b32 v2, v147, s52, v2 bitop3:0xbe
    v_cmp_ne_u32 vcc, 0, v2
    s_cbranch_vccnz AC_MB_RETRY
AC_MB_OK:
    v_lshlrev_b32 v137, 16, v136
    v_and_b32 v136, s55, v136
    v_lshlrev_b32 v139, 16, v138
    v_and_b32 v138, s55, v138
    v_add_f32 v168, v168, v137
    v_add_f32 v169, v169, v136
    v_add_f32 v170, v170, v139
    v_add_f32 v171, v171, v138
    v_lshlrev_b32 v141, 16, v140
    v_and_b32 v140, s55, v140
    v_lshlrev_b32 v143, 16, v142
    v_and_b32 v142, s55, v142
    v_add_f32 v172, v172, v141
    v_add_f32 v173, v173, v140
    v_add_f32 v174, v174, v143
    v_add_f32 v175, v175, v142
    v_lshlrev_b32 v145, 16, v144
    v_and_b32 v144, s55, v144
    v_lshlrev_b32 v147, 16, v146
    v_and_b32 v146, s55, v146
    v_add_f32 v176, v176, v145
    v_add_f32 v177, v177, v144
    v_add_f32 v178, v178, v147
    v_add_f32 v179, v179, v146
    s_branch AC_SM
AL_X:
TC4:
    s_cbranch_execz TC_END
    s_setprio 0
    s_waitcnt lgkmcnt(0)
    s_barrier
    ds_read_b64_tr_b16 v[184:185], v22 offset:2176
    ds_read_b64_tr_b16 v[194:195], v23 offset:2176
    ds_read_b64_tr_b16 v[186:187], v22 offset:2176
    ds_read_b64_tr_b16 v[196:197], v23 offset:2176
    ds_read_b64_tr_b16 v[188:189], v22 offset:4352
    ds_read_b64_tr_b16 v[198:199], v23 offset:4352
    ds_read_b64_tr_b16 v[190:191], v22 offset:6528
    ds_read_b64_tr_b16 v[200:201], v23 offset:6528
    ds_read_b64_tr_b16 v[192:193], v22 offset:8704
    ds_read_b64_tr_b16 v[202:203], v23 offset:8704
    s_mov_b32 s64, s71
    s_add_u32 s65, s69, 40960
    s_add_u32 s61, s64, s65
    v_add_u32 v3, s61, v6
    ds_write_b128 v3, v[216:219] offset:0
    ds_write_b128 v3, v[220:223] offset:4096
    s_add_u32 s64, s64, 8192
    s_cmp_eq_u32 s64, 40960
    s_cselect_b32 s64, 0, s64
    s_add_u32 s61, s64, s65
    v_add_u32 v3, s61, v6
    ds_write_b128 v3, v[224:227] offset:0
    ds_write_b128 v3, v[228:231] offset:4096
    s_add_u32 s64, s64, 8192
    s_cmp_eq_u32 s64, 40960
    s_cselect_b32 s64, 0, s64
    s_add_u32 s61, s64, s65
    v_add_u32 v3, s61, v6
    ds_write_b128 v3, v[232:235] offset:0
    ds_write_b128 v3, v[236:239] offset:4096
    s_add_u32 s64, s64, 8192
    s_cmp_eq_u32 s64, 40960
    s_cselect_b32 s64, 0, s64
    s_add_u32 s61, s64, s65
    v_add_u32 v3, s61, v6
    ds_write_b128 v3, v[240:243] offset:0
    ds_write_b128 v3, v[244:247] offset:4096
    s_add_u32 s64, s64, 8192
    s_cmp_eq_u32 s64, 40960
    s_cselect_b32 s64, 0, s64
    s_add_u32 s61, s64, s65
    v_add_u32 v3, s61, v6
    ds_write_b128 v3, v[248:251] offset:0
    ds_write_b128 v3, v[252:255] offset:4096
    v_mov_b32 v2, 1
    ds_write_b8 v18, v2 offset:16
    s_sleep 6
    s_setprio 2
    buffer_load_dwordx4 v[136:139], v6, s[28:31], s12 offen offset:0 sc1
    buffer_load_dwordx4 v[140:143], v6, s[28:31], s12 offen offset:1024 sc1
    buffer_load_dwordx4 v[144:147], v6, s[28:31], s12 offen offset:2048 sc1
    buffer_load_dwordx4 v[148:151], v6, s[28:31], s12 offen offset:3072 sc1
    s_setprio 0
    s_call_b64 s[20:21], K_P1
    s_call_b64 s[20:21], K_P2
    s_setprio 2
    s_waitcnt vmcnt(0)
AL_MB_CHK:
    v_xor_b32 v2, s52, v137
    v_bitop3_b32 v2, v139, s52, v2 bitop3:0xbe
    v_bitop3_b32 v2, v141, s52, v2 bitop3:0xbe
    v_bitop3_b32 v2, v143, s52, v2 bitop3:0xbe
    v_bitop3_b32 v2, v145, s52, v2 bitop3:0xbe
    v_bitop3_b32 v2, v147, s52, v2 bitop3:0xbe
    v_bitop3_b32 v2, v149, s52, v2 bitop3:0xbe
    v_bitop3_b32 v2, v151, s52, v2 bitop3:0xbe
    v_cmp_ne_u32 vcc, 0, v2
    s_cbranch_vccnz AL_MB_RETRY
AL_MB_OK:
    v_lshlrev_b32 v137, 16, v136
    v_and_b32 v136, s55, v136
    v_lshlrev_b32 v139, 16, v138
    v_and_b32 v138, s55, v138
    v_add_f32 v168, v168, v137
    v_add_f32 v169, v169, v136
    v_add_f32 v170, v170, v139
    v_add_f32 v171, v171, v138
    v_lshlrev_b32 v141, 16, v140
    v_and_b32 v140, s55, v140
    v_lshlrev_b32 v143, 16, v142
    v_and_b32 v142, s55, v142
    v_add_f32 v172, v172, v141
    v_add_f32 v173, v173, v140
    v_add_f32 v174, v174, v143
    v_add_f32 v175, v175, v142
    v_lshlrev_b32 v145, 16, v144
    v_and_b32 v144, s55, v144
    v_lshlrev_b32 v147, 16, v146
    v_and_b32 v146, s55, v146
    v_add_f32 v176, v176, v145
    v_add_f32 v177, v177, v144
    v_add_f32 v178, v178, v147
    v_add_f32 v179, v179, v146
    v_lshlrev_b32 v149, 16, v148
    v_and_b32 v148, s55, v148
    v_lshlrev_b32 v151, 16, v150
    v_and_b32 v150, s55, v150
    v_add_f32 v180, v180, v149
    v_add_f32 v181, v181, v148
    v_add_f32 v182, v182, v151
    v_add_f32 v183, v183, v150
    s_branch AL_SM
K_AUX0:
    s_sub_u32 s56, s2, 200
K_AUX:
    s_lshr_b32 s3, s3, 6
    s_and_b32 s59, s3, 3
    s_mov_b32 s55, 0xffff0000
    s_mov_b32 s100, 0
    v_and_b32 v1, 63, v0
    v_and_b32 v4, 15, v1
    v_lshrrev_b32 v5, 4, v1
    v_mov_b32 v19, 163584
    v_add_u32 v18, s3, v19
    s_mov_b32 s30, 7077888
    s_mov_b32 s31, 0x20000
    s_cmp_ge_u32 s3, 4
    s_cbranch_scc1 K_FC
    s_cmp_lg_u32 s101, 5
    s_cbranch_scc1 FL_SPARE
    s_waitcnt vmcnt(16)
    s_barrier
    s_mov_b32 s70, 4
FL_GU1b:
    s_mov_b32 m0, s69
    s_sub_u32 s70, s70, 1
    buffer_load_dwordx4 v30, s[48:51], s68 offen nt lds
    s_add_u32 m0, s69, 16384
    s_add_u32 s69, s69, 4096
    buffer_load_dwordx4 v30, s[36:39], s68 offen nt lds
    s_add_u32 s68, s68, 110592
    s_and_b32 s60, s70, 3
    s_cselect_b32 s60, 0, 16384
    s_add_u32 s69, s69, s60
    s_cmp_lg_u32 s70, 0
    s_cbranch_scc1 FL_GU1b
    s_barrier
    s_lshl_b32 s69, s59, 10
    s_add_u32 m0, s69, 0
    s_nop 0
    buffer_load_dwordx4 v30, s[48:51], s68 offen nt lds
    s_add_u32 m0, s69, 16384
    s_nop 0
    buffer_load_dwordx4 v30, s[36:39], s68 offen nt lds
    s_add_u32 s68, s68, 110592
    s_add_u32 m0, s69, 4096
    s_nop 0
    buffer_load_dwordx4 v30, s[48:51], s68 offen nt lds
    s_add_u32 m0, s69, 20480
    s_nop 0
    buffer_load_dwordx4 v30, s[36:39], s68 offen nt lds
    s_add_u32 s68, s68, 110592
    s_add_u32 m0, s69, 8192
    s_nop 0
    buffer_load_dwordx4 v30, s[48:51], s68 offen nt lds
    s_add_u32 m0, s69, 24576
    s_nop 0
    buffer_load_dwordx4 v30, s[36:39], s68 offen nt lds
    s_add_u32 s68, s68, 110592
    s_waitcnt vmcnt(14)
    s_barrier
    s_add_u32 m0, s69, 12288
    s_nop 0
    buffer_load_dwordx4 v30, s[48:51], s68 offen nt lds
    s_add_u32 m0, s69, 28672
    s_nop 0
    buffer_load_dwordx4 v30, s[36:39], s68 offen nt lds
    s_add_u32 s68, s68, 110592
    s_waitcnt vmcnt(0)
    s_barrier
    s_branch K_END
FL_SPARE:
    s_waitcnt lgkmcnt(0)
    s_load_dwordx2 s[48:49], s[0:1], 56
    s_load_dwordx2 s[40:41], s[0:1], 16
    s_mov_b32 s42, 819200
    s_mov_b32 s43, 0x20000
    s_and_b32 s60, s59, 2
    s_lshl_b32 s60, s60, 2
    v_lshl_or_b32 v2, v5, 1, s60
    v_xor_b32 v2, v2, v1
    v_and_b32 v2, 15, v2
    v_lshrrev_b32 v31, 4, v0
    v_mul_u32_u24 v31, 1280, v31
    v_lshl_add_u32 v31, v2, 4, v31
    s_sub_u32 s61, s56, 27
    s_mul_i32 s61, s61, 81920
    v_add_u32 v31, s61, v31
    s_lshl_b32 s63, s59, 10
    s_mov_b32 s50, 2211840
    s_mov_b32 s51, 0x20000
    s_waitcnt lgkmcnt(0)
    s_sleep 30
    s_lshl3_add_u32 s60, s56, s3
    s_lshl_b32 s60, s60, 10
    s_add_u32 s60, s60, 827392
    v_mov_b32 v108, -1
    v_mov_b32 v109, -1
    v_mov_b32 v110, -1
    v_mov_b32 v111, -1
    v_lshlrev_b32 v15, 4, v1
FL_CLR:
    buffer_store_dwordx4 v[108:111], v15, s[28:31], s60 offen sc1
    s_add_u32 s60, s60, 237568
    s_cmp_lt_u32 s60, 3977216
    s_cbranch_scc1 FL_CLR
    s_waitcnt vmcnt(0)
    s_barrier
    s_add_u32 m0, s63, 0
    s_mov_b32 s60, 0
    buffer_load_dwordx4 v31, s[48:51], s60 offen nt lds
    s_add_u32 m0, s63, 4096
    s_mov_b32 s60, 20480
    buffer_load_dwordx4 v31, s[48:51], s60 offen nt lds
    s_add_u32 m0, s63, 8192
    s_mov_b32 s60, 40960
    buffer_load_dwordx4 v31, s[48:51], s60 offen nt lds
    s_add_u32 m0, s63, 12288
    s_mov_b32 s60, 61440
    buffer_load_dwordx4 v31, s[48:51], s60 offen nt lds
    s_add_u32 m0, s63, 16384
    s_mov_b32 s60, 256
    buffer_load_dwordx4 v31, s[48:51], s60 offen nt lds
    s_add_u32 m0, s63, 20480
    s_mov_b32 s60, 20736
    buffer_load_dwordx4 v31, s[48:51], s60 offen nt lds
    s_add_u32 m0, s63, 24576
    s_mov_b32 s60, 41216
    buffer_load_dwordx4 v31, s[48:51], s60 offen nt lds
    s_add_u32 m0, s63, 28672
    s_mov_b32 s60, 61696
    buffer_load_dwordx4 v31, s[48:51], s60 offen nt lds
    s_add_u32 m0, s63, 32768
    s_mov_b32 s60, 512
    buffer_load_dwordx4 v31, s[48:51], s60 offen nt lds
    s_add_u32 m0, s63, 36864
    s_mov_b32 s60, 20992
    buffer_load_dwordx4 v31, s[48:51], s60 offen nt lds
    s_add_u32 m0, s63, 40960
    s_mov_b32 s60, 41472
    buffer_load_dwordx4 v31, s[48:51], s60 offen nt lds
    s_add_u32 m0, s63, 45056
    s_mov_b32 s60, 61952
    buffer_load_dwordx4 v31, s[48:51], s60 offen nt lds
    s_add_u32 m0, s63, 49152
    s_mov_b32 s60, 768
    buffer_load_dwordx4 v31, s[48:51], s60 offen nt lds
    s_add_u32 m0, s63, 53248
    s_mov_b32 s60, 21248
    buffer_load_dwordx4 v31, s[48:51], s60 offen nt lds
    s_add_u32 m0, s63, 57344
    s_mov_b32 s60, 41728
    buffer_load_dwordx4 v31, s[48:51], s60 offen nt lds
    s_add_u32 m0, s63, 61440
    s_mov_b32 s60, 62208
    buffer_load_dwordx4 v31, s[48:51], s60 offen nt lds
    s_add_u32 m0, s63, 65536
    s_mov_b32 s60, 1024
    buffer_load_dwordx4 v31, s[48:51], s60 offen nt lds
    s_add_u32 m0, s63, 69632
    s_mov_b32 s60, 21504
    buffer_load_dwordx4 v31, s[48:51], s60 offen nt lds
    s_add_u32 m0, s63, 73728
    s_mov_b32 s60, 41984
    buffer_load_dwordx4 v31, s[48:51], s60 offen nt lds
    s_add_u32 m0, s63, 77824
    s_mov_b32 s60, 62464
    buffer_load_dwordx4 v31, s[48:51], s60 offen nt lds
    s_sub_u32 s60, s56, 27
    s_mul_i32 s60, s60, 28672
    v_lshlrev_b32 v30, 4, v0
    s_add_u32 m0, s63, 81920
    s_nop 0
    buffer_load_dwordx4 v30, s[40:43], s60 offen lds
    s_add_u32 s60, s60, 4096
    buffer_load_dwordx4 v30, s[40:43], s60 offen lds
    s_add_u32 s60, s60, 4096
    buffer_load_dwordx4 v30, s[40:43], s60 offen lds
    s_add_u32 s60, s60, 4096
    buffer_load_dwordx4 v30, s[40:43], s60 offen lds
    s_add_u32 s60, s60, 4096
    buffer_load_dwordx4 v30, s[40:43], s60 offen lds
    s_add_u32 s60, s60, 4096
    buffer_load_dwordx4 v30, s[40:43], s60 offen lds
    s_add_u32 s60, s60, 4096
    buffer_load_dwordx4 v30, s[40:43], s60 offen lds
    s_add_u32 s60, s60, 4096
    s_waitcnt vmcnt(7)
    s_barrier
    s_branch K_END
K_FC:
    s_waitcnt lgkmcnt(0)
    v_mov_b32 v241, 0x3f803f80
    s_mul_i32 s52, s52, 0x9E3779B1
    s_add_u32 s52, s52, 0x7F4A7C15
    s_or_b32 s52, s52, 1
    v_mov_b32 v245, s52
    v_mov_b32 v247, s52
    s_bfe_u32 s60, s2, 0x10002
    s_lshl4_add_u32 s60, s68, s60
    s_sub_u32 s60, 0xffff, s60
    v_lshlrev_b32 v239, 1, v232
    v_sub_u32 v239, s60, v239
    v_lshlrev_b32 v243, 3, v232
    v_lshlrev_b32 v232, 4, v232
    v_mov_b32 v249, s52
    s_setprio 3
    s_waitcnt vmcnt(3)
    v_dot2_f32_bf16 v233, v212, v241, 0
    v_dot2_f32_bf16 v234, v212, v212, 0
    v_dot2_f32_bf16 v233, v213, v241, v233
    v_dot2_f32_bf16 v234, v213, v213, v234
    v_dot2_f32_bf16 v233, v214, v241, v233
    v_dot2_f32_bf16 v234, v214, v214, v234
    v_dot2_f32_bf16 v233, v215, v241, v233
    v_dot2_f32_bf16 v234, v215, v215, v234
    v_dot2_f32_bf16 v233, v216, v241, v233
    v_dot2_f32_bf16 v234, v216, v216, v234
    v_dot2_f32_bf16 v233, v217, v241, v233
    v_dot2_f32_bf16 v234, v217, v217, v234
    v_dot2_f32_bf16 v233, v218, v241, v233
    v_dot2_f32_bf16 v234, v218, v218, v234
    v_dot2_f32_bf16 v233, v219, v241, v233
    v_dot2_f32_bf16 v234, v219, v219, v234
    v_dot2_f32_bf16 v233, v220, v241, v233
    v_dot2_f32_bf16 v234, v220, v220, v234
    v_dot2_f32_bf16 v233, v221, v241, v233
    v_dot2_f32_bf16 v234, v221, v221, v234
    s_waitcnt vmcnt(0)
    v_dot2_f32_bf16 v235, v212, v222, 0
    v_dot2_f32_bf16 v236, v222, v241, 0
    v_dot2_f32_bf16 v235, v213, v223, v235
    v_dot2_f32_bf16 v236, v223, v241, v236
    v_dot2_f32_bf16 v235, v214, v224, v235
    v_dot2_f32_bf16 v236, v224, v241, v236
    v_dot2_f32_bf16 v235, v215, v225, v235
    v_dot2_f32_bf16 v236, v225, v241, v236
    v_dot2_f32_bf16 v235, v216, v226, v235
    v_dot2_f32_bf16 v236, v226, v241, v236
    v_dot2_f32_bf16 v235, v217, v227, v235
    v_dot2_f32_bf16 v236, v227, v241, v236
    v_dot2_f32_bf16 v235, v218, v228, v235
    v_dot2_f32_bf16 v236, v228, v241, v236
    v_dot2_f32_bf16 v235, v219, v229, v235
    v_dot2_f32_bf16 v236, v229, v241, v236
    v_dot2_f32_bf16 v235, v220, v230, v235
    v_dot2_f32_bf16 v236, v230, v241, v236
    v_dot2_f32_bf16 v235, v221, v231, v235
    v_dot2_f32_bf16 v236, v231, v241, v236
    v_permlane16_swap_b32 v233, v234
    v_add_f32 v233, v233, v234
    s_nop 0
    v_permlane16_swap_b32 v235, v236
    v_add_f32 v235, v235, v236
    v_add_f32_dpp v233, v233, v233 row_ror:8 row_mask:0xf bank_mask:0xf
    s_nop 0
    v_add_f32_dpp v235, v235, v235 row_ror:8 row_mask:0xf bank_mask:0xf
    v_add_f32_dpp v233, v233, v233 row_ror:4 row_mask:0xf bank_mask:0xf
    s_nop 0
    v_add_f32_dpp v235, v235, v235 row_ror:4 row_mask:0xf bank_mask:0xf
    v_add_f32_dpp v233, v233, v233 row_ror:2 row_mask:0xf bank_mask:0xf
    s_nop 0
    v_add_f32_dpp v235, v235, v235 row_ror:2 row_mask:0xf bank_mask:0xf
    v_add_f32_dpp v233, v233, v233 row_ror:1 row_mask:0xf bank_mask:0xf
    s_nop 0
    v_add_f32_dpp v235, v235, v235 row_ror:1 row_mask:0xf bank_mask:0xf
    v_mul_f32 v233, 0x3acccccd, v233
    v_mov_b32 v236, v235
    v_mov_b32 v234, v233
    s_nop 0
    v_permlane16_swap_b32 v235, v236
    v_permlane16_swap_b32 v233, v234
    v_fma_f32 v234, -v233, v233, v234
    v_max_f32 v234, 0, v234
    v_cvt_pk_bf16_f32 v237, v233, v234
    v_lshlrev_b32 v233, 16, v237
    v_and_b32 v234, 0xffff0000, v237
    v_add_f32 v234, 0x3727c5ac, v234
    v_cvt_pk_bf16_f32 v234, v234, v234
    v_lshlrev_b32 v234, 16, v234
    v_sqrt_f32 v234, v234
    v_fma_f32 v235, -v233, v236, v235
    v_cvt_pk_bf16_f32 v234, v234, v234
    v_lshlrev_b32 v234, 16, v234
    v_rcp_f32 v246, v234
    s_mov_b32 exec_lo, 1
    s_mov_b32 exec_hi, 1
    v_mul_f32 v235, v235, v246
    v_xor_b32 v244, 0x80000000, v233
    v_cvt_pk_bf16_f32 v235, v235, v235
    buffer_store_dwordx4 v[244:247], v232, s[28:31], s70 offen sc1
    v_ashrrev_i32 v237, 31, v235
    v_or_b32 v237, 0x80000000, v237
    v_xor_b32 v235, v235, v237
    v_bfi_b32 v248, s55, v235, v239
    buffer_store_dwordx2 v[248:249], v243, s[28:31], s71 offen sc1
    s_mov_b64 exec, -1
    s_cmp_ge_u32 s56, 27
    s_cbranch_scc1 FC_SPARE
    v_bfe_u32 v7, v1, 2, 2
    v_and_b32 v8, 3, v1
    v_lshl_add_u32 v6, v5, 3, v7
    v_bfe_u32 v2, v1, 3, 2
    v_xor_b32 v2, s59, v2
    v_lshlrev_b32 v9, 5, v2
    v_lshl_add_u32 v9, v8, 3, v9
    v_lshl_add_u32 v9, v6, 7, v9
    v_add_u32 v8, 65536, v9
    v_mov_b32 v176, 0x3f803f80
    v_mov_b32 v177, 0x3f803f80
    v_mov_b32 v178, 0x3f803f80
    v_mov_b32 v179, 0x3f803f80
    v_mov_b32 v180, 0x3f803f80
    v_mov_b32 v181, 0x3f803f80
    v_mov_b32 v182, 0x3f803f80
    v_mov_b32 v183, 0x3f803f80
    v_mov_b32 v184, 0x3f803f80
    v_mov_b32 v185, 0x3f803f80
    v_mov_b32 v186, 0x3f803f80
    v_mov_b32 v187, 0x3f803f80
    v_mov_b32 v188, 0x3f803f80
    v_mov_b32 v189, 0x3f803f80
    v_mov_b32 v190, 0x3f803f80
    v_mov_b32 v191, 0x3f803f80
    v_mov_b32 v192, 0x3f803f80
    v_mov_b32 v193, 0x3f803f80
    v_mov_b32 v194, 0x3f803f80
    v_mov_b32 v195, 0x3f803f80
    v_mov_b32 v196, 0x3f803f80
    v_mov_b32 v197, 0x3f803f80
    v_mov_b32 v198, 0x3f803f80
    v_mov_b32 v199, 0x3f803f80
    v_mov_b32 v200, 0x3f803f80
    v_mov_b32 v201, 0x3f803f80
    v_mov_b32 v202, 0x3f803f80
    v_mov_b32 v203, 0x3f803f80
    v_mov_b32 v204, 0x3f803f80
    v_mov_b32 v205, 0x3f803f80
    v_mov_b32 v206, 0x3f803f80
    v_mov_b32 v207, 0x3f803f80
    v_mov_b32 v208, 0x3f803f80
    v_mov_b32 v209, 0x3f803f80
    v_mov_b32 v210, 0x3f803f80
    v_mov_b32 v211, 0x3f803f80
    v_mov_b32 v212, 0x3f803f80
    v_mov_b32 v213, 0x3f803f80
    v_mov_b32 v214, 0x3f803f80
    v_mov_b32 v215, 0x3f803f80
    v_mov_b32 v216, 0x3f803f80
    v_mov_b32 v217, 0x3f803f80
    v_mov_b32 v218, 0x3f803f80
    v_mov_b32 v219, 0x3f803f80
    v_mov_b32 v220, 0x3f803f80
    v_mov_b32 v221, 0x3f803f80
    v_mov_b32 v222, 0x3f803f80
    v_mov_b32 v223, 0x3f803f80
    v_mov_b32 v224, 0x3f803f80
    v_mov_b32 v225, 0x3f803f80
    v_mov_b32 v226, 0x3f803f80
    v_mov_b32 v227, 0x3f803f80
    v_mov_b32 v228, 0x3f803f80
    v_mov_b32 v229, 0x3f803f80
    v_mov_b32 v230, 0x3f803f80
    v_mov_b32 v231, 0x3f803f80
    v_mov_b32 v232, 0x3f803f80
    v_mov_b32 v233, 0x3f803f80
    v_mov_b32 v234, 0x3f803f80
    v_mov_b32 v235, 0x3f803f80
    v_mov_b32 v236, 0x3f803f80
    v_mov_b32 v237, 0x3f803f80
    v_mov_b32 v238, 0x3f803f80
    v_mov_b32 v239, 0x3f803f80
    v_mov_b32 v240, 0x3f803f80
    v_mov_b32 v241, 0x3f803f80
    v_mov_b32 v242, 0x3f803f80
    v_mov_b32 v243, 0x3f803f80
    v_mov_b32 v244, 0x3f803f80
    v_mov_b32 v245, 0x3f803f80
    v_mov_b32 v246, 0x3f803f80
    v_mov_b32 v247, 0x3f803f80
    v_mov_b32 v248, 0x3f803f80
    v_mov_b32 v249, 0x3f803f80
    v_mov_b32 v250, 0x3f803f80
    v_mov_b32 v251, 0x3f803f80
    v_mov_b32 v252, 0x3f803f80
    v_mov_b32 v253, 0x3f803f80
    v_mov_b32 v254, 0x3f803f80
    v_mov_b32 v255, 0x3f803f80
    s_lshl2_add_u32 s65, s56, s59
    v_bfe_i32 v17, v1, 0, 1
    v_bfe_u32 v6, v0, 4, 4
    v_lshlrev_b32 v6, 3, v6
    v_add_u32 v6, 157952, v6
    v_lshlrev_b32 v7, 3, v4
    v_add_u32 v7, 157952, v7
    s_barrier
    v_lshlrev_b32 v12, 4, v1
    s_lshl_b32 s62, s59, 12
    s_add_u32 s60, s62, 49152
    buffer_load_dwordx4 v[120:123], v12, s[28:31], s60 offen offset:0 sc1
    buffer_load_dwordx4 v[124:127], v12, s[28:31], s60 offen offset:1024 sc1
    buffer_load_dwordx4 v[128:131], v12, s[28:31], s60 offen offset:2048 sc1
    buffer_load_dwordx4 v[132:135], v12, s[28:31], s60 offen offset:3072 sc1
    ds_read_b64_tr_b16 v[24:25], v9 offset:0
    ds_read_b64_tr_b16 v[26:27], v9 offset:512
    ds_read_b64_tr_b16 v[72:73], v9 offset:16384
    ds_read_b64_tr_b16 v[74:75], v9 offset:16896
    ds_read_b64_tr_b16 v[28:29], v9 offset:4096
    ds_read_b64_tr_b16 v[30:31], v9 offset:4608
    ds_read_b64_tr_b16 v[76:77], v9 offset:20480
    ds_read_b64_tr_b16 v[78:79], v9 offset:20992
    ds_read_b64_tr_b16 v[32:33], v9 offset:8192
    ds_read_b64_tr_b16 v[34:35], v9 offset:8704
    ds_read_b64_tr_b16 v[80:81], v9 offset:24576
    ds_read_b64_tr_b16 v[82:83], v9 offset:25088
    ds_read_b64_tr_b16 v[36:37], v9 offset:12288
    ds_read_b64_tr_b16 v[38:39], v9 offset:12800
    ds_read_b64_tr_b16 v[84:85], v9 offset:28672
    ds_read_b64_tr_b16 v[86:87], v9 offset:29184
    s_waitcnt lgkmcnt(0)
    s_barrier
    s_waitcnt vmcnt(0)
FC_KY_CHK:
    v_xor_b32 v2, s52, v121
    v_bitop3_b32 v2, v123, s52, v2 bitop3:0xbe
    v_bitop3_b32 v2, v125, s52, v2 bitop3:0xbe
    v_bitop3_b32 v2, v127, s52, v2 bitop3:0xbe
    v_bitop3_b32 v2, v129, s52, v2 bitop3:0xbe
    v_bitop3_b32 v2, v131, s52, v2 bitop3:0xbe
    v_bitop3_b32 v2, v133, s52, v2 bitop3:0xbe
    v_bitop3_b32 v2, v135, s52, v2 bitop3:0xbe
    v_cmp_ne_u32 vcc, 0, v2
    s_cbranch_vccz FC_KY_OK
FC_KY_RETRY:
    s_add_u32 s100, s100, 1
    s_cmp_gt_u32 s100, 20000
    s_cbranch_scc1 FC_KY_OK
    s_sleep 16
    s_add_u32 s60, s62, 49152
    buffer_load_dwordx4 v[120:123], v12, s[28:31], s60 offen offset:0 sc1
    buffer_load_dwordx4 v[124:127], v12, s[28:31], s60 offen offset:1024 sc1
    buffer_load_dwordx4 v[128:131], v12, s[28:31], s60 offen offset:2048 sc1
    buffer_load_dwordx4 v[132:135], v12, s[28:31], s60 offen offset:3072 sc1
    s_waitcnt vmcnt(0)
    s_branch FC_KY_CHK
FC_KY_OK:
    v_max_u32 v20, v120, v122
    v_min_u32 v21, v120, v122
    v_med3_u32 v21, v20, v21, v124
    v_max_u32 v20, v20, v124
    v_med3_u32 v21, v20, v21, v126
    v_max_u32 v20, v20, v126
    v_med3_u32 v21, v20, v21, v128
    v_max_u32 v20, v20, v128
    v_med3_u32 v21, v20, v21, v130
    v_max_u32 v20, v20, v130
    v_med3_u32 v21, v20, v21, v132
    v_max_u32 v20, v20, v132
    v_med3_u32 v21, v20, v21, v134
    v_max_u32 v20, v20, v134
    s_nop 1
    v_mov_b32_dpp v22, v20 row_ror:8 row_mask:0xf bank_mask:0xf
    v_mov_b32_dpp v23, v21 row_ror:8 row_mask:0xf bank_mask:0xf
    v_min_u32 v2, v20, v22
    v_max_u32 v20, v20, v22
    v_max3_u32 v21, v21, v23, v2
    s_nop 0
    v_mov_b32_dpp v22, v20 row_ror:4 row_mask:0xf bank_mask:0xf
    v_mov_b32_dpp v23, v21 row_ror:4 row_mask:0xf bank_mask:0xf
    v_min_u32 v2, v20, v22
    v_max_u32 v20, v20, v22
    v_max3_u32 v21, v21, v23, v2
    s_nop 0
    v_mov_b32_dpp v22, v20 row_ror:2 row_mask:0xf bank_mask:0xf
    v_mov_b32_dpp v23, v21 row_ror:2 row_mask:0xf bank_mask:0xf
    v_min_u32 v2, v20, v22
    v_max_u32 v20, v20, v22
    v_max3_u32 v21, v21, v23, v2
    s_nop 0
    v_mov_b32_dpp v22, v20 row_ror:1 row_mask:0xf bank_mask:0xf
    v_mov_b32_dpp v23, v21 row_ror:1 row_mask:0xf bank_mask:0xf
    v_min_u32 v2, v20, v22
    v_max_u32 v20, v20, v22
    v_max3_u32 v21, v21, v23, v2
    ds_write_b64 v6, v[20:21]
    s_waitcnt lgkmcnt(0)
    s_barrier
    ds_read_b64 v[20:21], v7
    s_waitcnt lgkmcnt(0)
    v_mov_b32_dpp v22, v20 row_ror:8 row_mask:0xf bank_mask:0xf
    v_mov_b32_dpp v23, v21 row_ror:8 row_mask:0xf bank_mask:0xf
    v_min_u32 v2, v20, v22
    v_max_u32 v20, v20, v22
    v_max3_u32 v21, v21, v23, v2
    s_nop 0
    v_mov_b32_dpp v22, v20 row_ror:4 row_mask:0xf bank_mask:0xf
    v_mov_b32_dpp v23, v21 row_ror:4 row_mask:0xf bank_mask:0xf
    v_min_u32 v2, v20, v22
    v_max_u32 v20, v20, v22
    v_max3_u32 v21, v21, v23, v2
    s_nop 0
    v_mov_b32_dpp v22, v20 row_ror:2 row_mask:0xf bank_mask:0xf
    v_mov_b32_dpp v23, v21 row_ror:2 row_mask:0xf bank_mask:0xf
    v_min_u32 v2, v20, v22
    v_max_u32 v20, v20, v22
    v_max3_u32 v21, v21, v23, v2
    s_nop 0
    v_mov_b32_dpp v22, v20 row_ror:1 row_mask:0xf bank_mask:0xf
    v_mov_b32_dpp v23, v21 row_ror:1 row_mask:0xf bank_mask:0xf
    v_min_u32 v2, v20, v22
    v_max_u32 v20, v20, v22
    v_max3_u32 v21, v21, v23, v2
    v_bfi_b32 v10, v17, v21, v20
    v_not_b32 v2, v10
    v_and_b32 v2, 2047, v2
    v_mul_u32_u24 v17, 1280, v2
    v_lshrrev_b32 v16, 1, v2
    v_and_b32 v3, 1, v2
    v_lshl_add_u32 v16, v3, 10, v16
    v_readlane_b32 s60, v17, 0
    v_readlane_b32 s61, v17, 1
    v_lshlrev_b32 v16, 4, v16
    v_add_u32 v16, 16384, v16
    s_mul_i32 s62, s59, 2624
    s_add_u32 s62, s62, 147456
    s_add_u32 m0, s62, 0
    s_nop 0
    buffer_load_dwordx4 v12, s[24:27], s60 offen lds
    s_add_u32 m0, s62, 1344
    s_nop 0
    buffer_load_dwordx4 v12, s[24:27], s61 offen lds
    s_mov_b64 exec, 0xffff
    s_add_u32 m0, s62, 0
    s_nop 0
    buffer_load_dwordx4 v12, s[24:27], s60 offen offset:1024 lds
    s_add_u32 m0, s62, 1344
    s_nop 0
    buffer_load_dwordx4 v12, s[24:27], s61 offen offset:1024 lds
    s_mov_b32 exec_lo, 0x00030003
    s_mov_b32 exec_hi, 0x00030003
    buffer_load_dwordx4 v[20:23], v16, s[28:31], 0 offen
    s_mov_b64 exec, -1
    v_and_b32 v17, 1, v1
    v_mul_u32_u24 v17, 1344, v17
    v_lshl_add_u32 v17, v5, 4, v17
    v_add_u32 v17, s62, v17
    ds_read_b64_tr_b16 v[40:41], v9 offset:32768
    ds_read_b64_tr_b16 v[42:43], v9 offset:33280
    ds_read_b64_tr_b16 v[88:89], v9 offset:49152
    ds_read_b64_tr_b16 v[90:91], v9 offset:49664
    ds_read_b64_tr_b16 v[44:45], v9 offset:36864
    ds_read_b64_tr_b16 v[46:47], v9 offset:37376
    ds_read_b64_tr_b16 v[92:93], v9 offset:53248
    ds_read_b64_tr_b16 v[94:95], v9 offset:53760
    ds_read_b64_tr_b16 v[48:49], v9 offset:40960
    ds_read_b64_tr_b16 v[50:51], v9 offset:41472
    ds_read_b64_tr_b16 v[96:97], v9 offset:57344
    ds_read_b64_tr_b16 v[98:99], v9 offset:57856
    ds_read_b64_tr_b16 v[52:53], v9 offset:45056
    ds_read_b64_tr_b16 v[54:55], v9 offset:45568
    ds_read_b64_tr_b16 v[100:101], v9 offset:61440
    ds_read_b64_tr_b16 v[102:103], v9 offset:61952
    ds_read_b64_tr_b16 v[56:57], v8 offset:0
    ds_read_b64_tr_b16 v[58:59], v8 offset:512
    ds_read_b64_tr_b16 v[104:105], v8 offset:16384
    ds_read_b64_tr_b16 v[106:107], v8 offset:16896
    ds_read_b64_tr_b16 v[60:61], v8 offset:4096
    ds_read_b64_tr_b16 v[62:63], v8 offset:4608
    ds_read_b64_tr_b16 v[108:109], v8 offset:20480
    ds_read_b64_tr_b16 v[110:111], v8 offset:20992
    ds_read_b64_tr_b16 v[64:65], v8 offset:8192
    ds_read_b64_tr_b16 v[66:67], v8 offset:8704
    ds_read_b64_tr_b16 v[112:113], v8 offset:24576
    ds_read_b64_tr_b16 v[114:115], v8 offset:25088
    ds_read_b64_tr_b16 v[68:69], v8 offset:12288
    ds_read_b64_tr_b16 v[70:71], v8 offset:12800
    ds_read_b64_tr_b16 v[116:117], v8 offset:28672
    ds_read_b64_tr_b16 v[118:119], v8 offset:29184
    s_waitcnt vmcnt(0)
    s_mov_b32 exec_lo, 0x00030003
    s_mov_b32 exec_hi, 0x00030003
    ds_read_b128 v[176:179], v17 offset:0
    ds_read_b128 v[180:183], v17 offset:64
    ds_read_b128 v[184:187], v17 offset:128
    ds_read_b128 v[188:191], v17 offset:192
    ds_read_b128 v[192:195], v17 offset:256
    ds_read_b128 v[196:199], v17 offset:320
    ds_read_b128 v[200:203], v17 offset:384
    ds_read_b128 v[204:207], v17 offset:448
    ds_read_b128 v[208:211], v17 offset:512
    ds_read_b128 v[212:215], v17 offset:576
    ds_read_b128 v[216:219], v17 offset:640
    ds_read_b128 v[220:223], v17 offset:704
    ds_read_b128 v[224:227], v17 offset:768
    ds_read_b128 v[228:231], v17 offset:832
    ds_read_b128 v[232:235], v17 offset:896
    ds_read_b128 v[236:239], v17 offset:960
    ds_read_b128 v[240:243], v17 offset:1024
    ds_read_b128 v[244:247], v17 offset:1088
    ds_read_b128 v[248:251], v17 offset:1152
    ds_read_b128 v[252:255], v17 offset:1216
    s_mov_b64 exec, -1
    s_waitcnt lgkmcnt(15)
    v_mfma_f32_16x16x32_bf16 v[152:155], v[24:27], v[176:179], 0
    v_mfma_f32_16x16x32_bf16 v[156:159], v[72:75], v[176:179], 0
    v_mfma_f32_16x16x32_bf16 v[152:155], v[28:31], v[180:183], v[152:155]
    v_mfma_f32_16x16x32_bf16 v[156:159], v[76:79], v[180:183], v[156:159]
    v_mfma_f32_16x16x32_bf16 v[152:155], v[32:35], v[184:187], v[152:155]
    v_mfma_f32_16x16x32_bf16 v[156:159], v[80:83], v[184:187], v[156:159]
    v_mfma_f32_16x16x32_bf16 v[152:155], v[36:39], v[188:191], v[152:155]
    v_mfma_f32_16x16x32_bf16 v[156:159], v[84:87], v[188:191], v[156:159]
    s_waitcnt lgkmcnt(12)
    v_mfma_f32_16x16x32_bf16 v[152:155], v[40:43], v[192:195], v[152:155]
    v_mfma_f32_16x16x32_bf16 v[156:159], v[88:91], v[192:195], v[156:159]
    v_mfma_f32_16x16x32_bf16 v[152:155], v[44:47], v[196:199], v[152:155]
    v_mfma_f32_16x16x32_bf16 v[156:159], v[92:95], v[196:199], v[156:159]
    v_mfma_f32_16x16x32_bf16 v[152:155], v[48:51], v[200:203], v[152:155]
    v_mfma_f32_16x16x32_bf16 v[156:159], v[96:99], v[200:203], v[156:159]
    v_mfma_f32_16x16x32_bf16 v[152:155], v[52:55], v[204:207], v[152:155]
    v_mfma_f32_16x16x32_bf16 v[156:159], v[100:103], v[204:207], v[156:159]
    s_waitcnt lgkmcnt(8)
    v_mfma_f32_16x16x32_bf16 v[152:155], v[56:59], v[208:211], v[152:155]
    v_mfma_f32_16x16x32_bf16 v[156:159], v[104:107], v[208:211], v[156:159]
    v_mfma_f32_16x16x32_bf16 v[152:155], v[60:63], v[212:215], v[152:155]
    v_mfma_f32_16x16x32_bf16 v[156:159], v[108:111], v[212:215], v[156:159]
    v_mfma_f32_16x16x32_bf16 v[152:155], v[64:67], v[216:219], v[152:155]
    v_mfma_f32_16x16x32_bf16 v[156:159], v[112:115], v[216:219], v[156:159]
    v_mfma_f32_16x16x32_bf16 v[152:155], v[68:71], v[220:223], v[152:155]
    v_mfma_f32_16x16x32_bf16 v[156:159], v[116:119], v[220:223], v[156:159]
    s_barrier
    ds_read_b64_tr_b16 v[120:121], v8 offset:32768
    ds_read_b64_tr_b16 v[122:123], v8 offset:33280
    ds_read_b64_tr_b16 v[136:137], v8 offset:49152
    ds_read_b64_tr_b16 v[138:139], v8 offset:49664
    ds_read_b64_tr_b16 v[124:125], v8 offset:36864
    ds_read_b64_tr_b16 v[126:127], v8 offset:37376
    ds_read_b64_tr_b16 v[140:141], v8 offset:53248
    ds_read_b64_tr_b16 v[142:143], v8 offset:53760
    ds_read_b64_tr_b16 v[128:129], v8 offset:40960
    ds_read_b64_tr_b16 v[130:131], v8 offset:41472
    ds_read_b64_tr_b16 v[144:145], v8 offset:57344
    ds_read_b64_tr_b16 v[146:147], v8 offset:57856
    ds_read_b64_tr_b16 v[132:133], v8 offset:45056
    ds_read_b64_tr_b16 v[134:135], v8 offset:45568
    ds_read_b64_tr_b16 v[148:149], v8 offset:61440
    ds_read_b64_tr_b16 v[150:151], v8 offset:61952
    ds_read_b64_tr_b16 v[24:25], v9 offset:0
    ds_read_b64_tr_b16 v[26:27], v9 offset:512
    ds_read_b64_tr_b16 v[72:73], v9 offset:16384
    ds_read_b64_tr_b16 v[74:75], v9 offset:16896
    ds_read_b64_tr_b16 v[28:29], v9 offset:4096
    ds_read_b64_tr_b16 v[30:31], v9 offset:4608
    ds_read_b64_tr_b16 v[76:77], v9 offset:20480
    ds_read_b64_tr_b16 v[78:79], v9 offset:20992
    ds_read_b64_tr_b16 v[32:33], v9 offset:8192
    ds_read_b64_tr_b16 v[34:35], v9 offset:8704
    ds_read_b64_tr_b16 v[80:81], v9 offset:24576
    ds_read_b64_tr_b16 v[82:83], v9 offset:25088
    ds_read_b64_tr_b16 v[36:37], v9 offset:12288
    ds_read_b64_tr_b16 v[38:39], v9 offset:12800
    ds_read_b64_tr_b16 v[84:85], v9 offset:28672
    ds_read_b64_tr_b16 v[86:87], v9 offset:29184
    s_waitcnt lgkmcnt(15)
    v_mfma_f32_16x16x32_bf16 v[152:155], v[120:123], v[224:227], v[152:155]
    v_mfma_f32_16x16x32_bf16 v[156:159], v[136:139], v[224:227], v[156:159]
    v_mfma_f32_16x16x32_bf16 v[152:155], v[124:127], v[228:231], v[152:155]
    v_mfma_f32_16x16x32_bf16 v[156:159], v[140:143], v[228:231], v[156:159]
    v_mfma_f32_16x16x32_bf16 v[152:155], v[128:131], v[232:235], v[152:155]
    v_mfma_f32_16x16x32_bf16 v[156:159], v[144:147], v[232:235], v[156:159]
    v_mfma_f32_16x16x32_bf16 v[152:155], v[132:135], v[236:239], v[152:155]
    v_mfma_f32_16x16x32_bf16 v[156:159], v[148:151], v[236:239], v[156:159]
    s_waitcnt lgkmcnt(0)
    v_mfma_f32_16x16x32_bf16 v[152:155], v[24:27], v[240:243], v[152:155]
    v_mfma_f32_16x16x32_bf16 v[156:159], v[72:75], v[240:243], v[156:159]
    v_mfma_f32_16x16x32_bf16 v[152:155], v[28:31], v[244:247], v[152:155]
    v_mfma_f32_16x16x32_bf16 v[156:159], v[76:79], v[244:247], v[156:159]
    v_mfma_f32_16x16x32_bf16 v[152:155], v[32:35], v[248:251], v[152:155]
    v_mfma_f32_16x16x32_bf16 v[156:159], v[80:83], v[248:251], v[156:159]
    v_mfma_f32_16x16x32_bf16 v[152:155], v[36:39], v[252:255], v[152:155]
    v_mfma_f32_16x16x32_bf16 v[156:159], v[84:87], v[252:255], v[156:159]
    s_mov_b32 exec_lo, 0x00030003
    s_mov_b32 exec_hi, 0x00030003
    s_waitcnt vmcnt(0)
FC_RC_CHK:
    v_xor_b32 v2, s52, v21
    v_bitop3_b32 v2, v23, s52, v2 bitop3:0xbe
    v_cmp_ne_u32 vcc, 0, v2
    s_cbranch_vccz FC_RC_OK
FC_RC_RETRY:
    s_add_u32 s100, s100, 1
    s_cmp_gt_u32 s100, 20000
    s_cbranch_scc1 FC_RC_OK
    s_sleep 2
    buffer_load_dwordx4 v[20:23], v16, s[28:31], 0 offen sc1
    s_waitcnt vmcnt(0)
    s_branch FC_RC_CHK
FC_RC_OK:
    s_mov_b64 exec, -1
    v_mov_b32_dpp v160, v152 row_newbcast:2 row_mask:0xf bank_mask:0xf
    v_mov_b32_dpp v164, v156 row_newbcast:2 row_mask:0xf bank_mask:0xf
    v_mov_b32_dpp v161, v153 row_newbcast:2 row_mask:0xf bank_mask:0xf
    v_mov_b32_dpp v165, v157 row_newbcast:2 row_mask:0xf bank_mask:0xf
    v_mov_b32_dpp v162, v154 row_newbcast:2 row_mask:0xf bank_mask:0xf
    v_mov_b32_dpp v166, v158 row_newbcast:2 row_mask:0xf bank_mask:0xf
    v_mov_b32_dpp v163, v155 row_newbcast:2 row_mask:0xf bank_mask:0xf
    v_mov_b32_dpp v167, v159 row_newbcast:2 row_mask:0xf bank_mask:0xf
    v_fma_f32 v152, v20, v160, v152
    v_fma_f32 v156, v20, v164, v156
    v_fma_f32 v153, v20, v161, v153
    v_fma_f32 v157, v20, v165, v157
    v_fma_f32 v154, v20, v162, v154
    v_fma_f32 v158, v20, v166, v158
    v_fma_f32 v155, v20, v163, v155
    v_fma_f32 v159, v20, v167, v159
    v_mul_f32 v152, v152, v22
    v_mul_f32 v156, v156, v22
    v_mul_f32 v153, v153, v22
    v_mul_f32 v157, v157, v22
    v_mul_f32 v154, v154, v22
    v_mul_f32 v158, v158, v22
    v_mul_f32 v155, v155, v22
    v_mul_f32 v159, v159, v22
    v_cvt_pk_bf16_f32 v152, v152, v156
    v_cvt_pk_bf16_f32 v153, v153, v157
    v_cvt_pk_bf16_f32 v154, v154, v158
    v_cvt_pk_bf16_f32 v155, v155, v159
    v_and_b32 v156, s55, v152
    v_lshlrev_b32 v152, 16, v152
    v_and_b32 v157, s55, v153
    v_lshlrev_b32 v153, 16, v153
    v_and_b32 v158, s55, v154
    v_lshlrev_b32 v154, 16, v154
    v_and_b32 v159, s55, v155
    v_lshlrev_b32 v155, 16, v155
    v_mul_f32 v160, 0xbfb8aa3b, v152
    v_mul_f32 v161, 0xbfb8aa3b, v153
    v_mul_f32 v162, 0xbfb8aa3b, v154
    v_mul_f32 v163, 0xbfb8aa3b, v155
    v_exp_f32 v160, v160
    v_exp_f32 v161, v161
    v_exp_f32 v162, v162
    v_exp_f32 v163, v163
    v_add_f32 v160, 1.0, v160
    v_add_f32 v161, 1.0, v161
    v_add_f32 v162, 1.0, v162
    v_add_f32 v163, 1.0, v163
    v_rcp_f32 v160, v160
    v_rcp_f32 v161, v161
    v_rcp_f32 v162, v162
    v_rcp_f32 v163, v163
    v_mul_f32 v152, v152, v160
    v_mul_f32 v153, v153, v161
    v_mul_f32 v154, v154, v162
    v_mul_f32 v155, v155, v163
    v_cvt_pk_bf16_f32 v152, v152, v152
    v_cvt_pk_bf16_f32 v153, v153, v153
    v_cvt_pk_bf16_f32 v154, v154, v154
    v_cvt_pk_bf16_f32 v155, v155, v155
    v_lshlrev_b32 v152, 16, v152
    v_lshlrev_b32 v153, 16, v153
    v_lshlrev_b32 v154, 16, v154
    v_lshlrev_b32 v155, 16, v155
    v_mul_f32 v152, v152, v156
    v_mul_f32 v153, v153, v157
    v_mul_f32 v154, v154, v158
    v_mul_f32 v155, v155, v159
    v_cvt_pk_bf16_f32 v152, v152, v153
    v_cvt_pk_bf16_f32 v154, v154, v155
    v_mov_b32 v153, s52
    v_mov_b32 v155, s52
    v_lshlrev_b32 v3, 6, v4
    v_lshl_add_u32 v3, v5, 4, v3
    s_lshl_b32 s60, s65, 7
    s_add_u32 s60, s60, 425984
    s_mov_b32 exec_lo, 0x00030003
    s_mov_b32 exec_hi, 0x00030003
    buffer_store_dwordx4 v[152:155], v3, s[28:31], s60 offen sc1
    s_mov_b64 exec, -1
    s_branch K_END
FC_SPARE:
    v_bfe_u32 v7, v1, 2, 2
    v_and_b32 v8, 3, v1
    v_and_b32 v3, 1, v5
    v_lshl_or_b32 v12, v3, 2, v7
    v_lshl_add_u32 v6, v5, 3, v7
    v_lshlrev_b32 v13, 8, v6
    v_lshl_add_u32 v13, v8, 3, v13
    s_lshl3_add_u32 s60, s56, s3
    s_lshl_b32 s60, s60, 10
    s_add_u32 s60, s60, 827392
    v_mov_b32 v108, -1
    v_mov_b32 v109, -1
    v_mov_b32 v110, -1
    v_mov_b32 v111, -1
    v_lshlrev_b32 v15, 4, v1
FC_CLR:
    buffer_store_dwordx4 v[108:111], v15, s[28:31], s60 offen sc1
    s_add_u32 s60, s60, 237568
    s_cmp_lt_u32 s60, 3977216
    s_cbranch_scc1 FC_CLR
    s_lshl_b32 s64, s56, 7
    s_add_u32 s64, s64, 4736
    v_mov_b32 v104, s52
    v_mov_b32 v105, s52
    v_mov_b32 v106, s52
    v_mov_b32 v107, s52
    s_waitcnt vmcnt(0)
    s_barrier
    s_cmp_lg_u32 s59, 0
    s_cbranch_scc1 FC_NOFL
    s_mov_b64 exec, 0xff
    buffer_store_dwordx4 v[104:107], v15, s[28:31], s64 offen sc1
    s_mov_b64 exec, -1
FC_NOFL:
    s_lshl2_add_u32 s60, s56, s59
    s_cmp_eq_u32 s60, 221
    s_cbranch_scc1 FC_TOP
    s_cmp_lg_u32 s54, 30
    s_cbranch_scc1 FC_NOWR
    s_and_b32 s60, s2, 4
    s_add_u32 s60, s60, s59
    s_lshl_b32 s60, s60, 12
    s_add_u32 s60, s60, 16384
    buffer_load_dwordx4 v[168:171], v15, s[28:31], s60 offen offset:0
    buffer_load_dwordx4 v[168:171], v15, s[28:31], s60 offen offset:1024
    buffer_load_dwordx4 v[168:171], v15, s[28:31], s60 offen offset:2048
    buffer_load_dwordx4 v[168:171], v15, s[28:31], s60 offen offset:3072
FC_NOWR:
    s_barrier
    s_mul_i32 s60, s59, 10
    s_add_u32 s60, s60, 0
    s_and_b32 s61, s60, 7
    s_lshr_b32 s60, s60, 3
    s_lshl_b32 s60, s60, 14
    v_xor_b32 v2, s61, v12
    v_lshl_add_u32 v2, v2, 5, v13
    v_add_u32 v2, s60, v2
    ds_read_b64_tr_b16 v[24:25], v2 offset:0
    ds_read_b64_tr_b16 v[26:27], v2 offset:1024
    ds_read_b64_tr_b16 v[28:29], v2 offset:8192
    ds_read_b64_tr_b16 v[30:31], v2 offset:9216
    s_mul_i32 s60, s59, 10
    s_add_u32 s60, s60, 1
    s_and_b32 s61, s60, 7
    s_lshr_b32 s60, s60, 3
    s_lshl_b32 s60, s60, 14
    v_xor_b32 v2, s61, v12
    v_lshl_add_u32 v2, v2, 5, v13
    v_add_u32 v2, s60, v2
    ds_read_b64_tr_b16 v[32:33], v2 offset:0
    ds_read_b64_tr_b16 v[34:35], v2 offset:1024
    ds_read_b64_tr_b16 v[36:37], v2 offset:8192
    ds_read_b64_tr_b16 v[38:39], v2 offset:9216
    s_mul_i32 s60, s59, 10
    s_add_u32 s60, s60, 2
    s_and_b32 s61, s60, 7
    s_lshr_b32 s60, s60, 3
    s_lshl_b32 s60, s60, 14
    v_xor_b32 v2, s61, v12
    v_lshl_add_u32 v2, v2, 5, v13
    v_add_u32 v2, s60, v2
    ds_read_b64_tr_b16 v[40:41], v2 offset:0
    ds_read_b64_tr_b16 v[42:43], v2 offset:1024
    ds_read_b64_tr_b16 v[44:45], v2 offset:8192
    ds_read_b64_tr_b16 v[46:47], v2 offset:9216
    s_mul_i32 s60, s59, 10
    s_add_u32 s60, s60, 3
    s_and_b32 s61, s60, 7
    s_lshr_b32 s60, s60, 3
    s_lshl_b32 s60, s60, 14
    v_xor_b32 v2, s61, v12
    v_lshl_add_u32 v2, v2, 5, v13
    v_add_u32 v2, s60, v2
    ds_read_b64_tr_b16 v[48:49], v2 offset:0
    ds_read_b64_tr_b16 v[50:51], v2 offset:1024
    ds_read_b64_tr_b16 v[52:53], v2 offset:8192
    ds_read_b64_tr_b16 v[54:55], v2 offset:9216
    s_mul_i32 s60, s59, 10
    s_add_u32 s60, s60, 4
    s_and_b32 s61, s60, 7
    s_lshr_b32 s60, s60, 3
    s_lshl_b32 s60, s60, 14
    v_xor_b32 v2, s61, v12
    v_lshl_add_u32 v2, v2, 5, v13
    v_add_u32 v2, s60, v2
    ds_read_b64_tr_b16 v[56:57], v2 offset:0
    ds_read_b64_tr_b16 v[58:59], v2 offset:1024
    ds_read_b64_tr_b16 v[60:61], v2 offset:8192
    ds_read_b64_tr_b16 v[62:63], v2 offset:9216
    s_mul_i32 s60, s59, 10
    s_add_u32 s60, s60, 5
    s_and_b32 s61, s60, 7
    s_lshr_b32 s60, s60, 3
    s_lshl_b32 s60, s60, 14
    v_xor_b32 v2, s61, v12
    v_lshl_add_u32 v2, v2, 5, v13
    v_add_u32 v2, s60, v2
    ds_read_b64_tr_b16 v[64:65], v2 offset:0
    ds_read_b64_tr_b16 v[66:67], v2 offset:1024
    ds_read_b64_tr_b16 v[68:69], v2 offset:8192
    ds_read_b64_tr_b16 v[70:71], v2 offset:9216
    s_mul_i32 s60, s59, 10
    s_add_u32 s60, s60, 6
    s_and_b32 s61, s60, 7
    s_lshr_b32 s60, s60, 3
    s_lshl_b32 s60, s60, 14
    v_xor_b32 v2, s61, v12
    v_lshl_add_u32 v2, v2, 5, v13
    v_add_u32 v2, s60, v2
    ds_read_b64_tr_b16 v[72:73], v2 offset:0
    ds_read_b64_tr_b16 v[74:75], v2 offset:1024
    ds_read_b64_tr_b16 v[76:77], v2 offset:8192
    ds_read_b64_tr_b16 v[78:79], v2 offset:9216
    s_mul_i32 s60, s59, 10
    s_add_u32 s60, s60, 7
    s_and_b32 s61, s60, 7
    s_lshr_b32 s60, s60, 3
    s_lshl_b32 s60, s60, 14
    v_xor_b32 v2, s61, v12
    v_lshl_add_u32 v2, v2, 5, v13
    v_add_u32 v2, s60, v2
    ds_read_b64_tr_b16 v[80:81], v2 offset:0
    ds_read_b64_tr_b16 v[82:83], v2 offset:1024
    ds_read_b64_tr_b16 v[84:85], v2 offset:8192
    ds_read_b64_tr_b16 v[86:87], v2 offset:9216
    s_mul_i32 s60, s59, 10
    s_add_u32 s60, s60, 8
    s_and_b32 s61, s60, 7
    s_lshr_b32 s60, s60, 3
    s_lshl_b32 s60, s60, 14
    v_xor_b32 v2, s61, v12
    v_lshl_add_u32 v2, v2, 5, v13
    v_add_u32 v2, s60, v2
    ds_read_b64_tr_b16 v[88:89], v2 offset:0
    ds_read_b64_tr_b16 v[90:91], v2 offset:1024
    ds_read_b64_tr_b16 v[92:93], v2 offset:8192
    ds_read_b64_tr_b16 v[94:95], v2 offset:9216
    s_mul_i32 s60, s59, 10
    s_add_u32 s60, s60, 9
    s_and_b32 s61, s60, 7
    s_lshr_b32 s60, s60, 3
    s_lshl_b32 s60, s60, 14
    v_xor_b32 v2, s61, v12
    v_lshl_add_u32 v2, v2, 5, v13
    v_add_u32 v2, s60, v2
    ds_read_b64_tr_b16 v[96:97], v2 offset:0
    ds_read_b64_tr_b16 v[98:99], v2 offset:1024
    ds_read_b64_tr_b16 v[100:101], v2 offset:8192
    ds_read_b64_tr_b16 v[102:103], v2 offset:9216
    v_lshrrev_b32 v14, 1, v5
    v_lshlrev_b32 v14, 7, v14
    v_and_b32 v2, 1, v1
    v_lshl_add_u32 v14, v2, 6, v14
    v_lshl_add_u32 v14, v3, 5, v14
    s_sub_u32 s63, s56, 27
    s_waitcnt lgkmcnt(0)
    s_cmp_ge_u32 s63, 27
    s_cbranch_scc1 K_END
    s_lshl_b32 s65, s63, 9
    s_add_u32 s65, s65, 425984
    s_mov_b32 exec_lo, 0x33333333
    s_mov_b32 exec_hi, 0x33333333
    buffer_load_dwordx4 v[112:115], v14, s[28:31], s65 offen offset:0 sc1
    buffer_load_dwordx4 v[116:119], v14, s[28:31], s65 offen offset:16 sc1
    buffer_load_dwordx4 v[120:123], v14, s[28:31], s65 offen offset:256 sc1
    buffer_load_dwordx4 v[124:127], v14, s[28:31], s65 offen offset:272 sc1
    s_waitcnt vmcnt(0)
D_H_CHK:
    v_xor_b32 v2, s52, v113
    v_bitop3_b32 v2, v115, s52, v2 bitop3:0xbe
    v_bitop3_b32 v2, v117, s52, v2 bitop3:0xbe
    v_bitop3_b32 v2, v119, s52, v2 bitop3:0xbe
    v_bitop3_b32 v2, v121, s52, v2 bitop3:0xbe
    v_bitop3_b32 v2, v123, s52, v2 bitop3:0xbe
    v_bitop3_b32 v2, v125, s52, v2 bitop3:0xbe
    v_bitop3_b32 v2, v127, s52, v2 bitop3:0xbe
    v_cmp_ne_u32 vcc, 0, v2
    s_cbranch_vccz D_H_OK
D_H_RETRY:
    s_add_u32 s100, s100, 1
    s_cmp_gt_u32 s100, 20000
    s_cbranch_scc1 D_H_OK
    s_sleep 6
    buffer_load_dwordx4 v[112:115], v14, s[28:31], s65 offen offset:0 sc1
    buffer_load_dwordx4 v[116:119], v14, s[28:31], s65 offen offset:16 sc1
    buffer_load_dwordx4 v[120:123], v14, s[28:31], s65 offen offset:256 sc1
    buffer_load_dwordx4 v[124:127], v14, s[28:31], s65 offen offset:272 sc1
    s_waitcnt vmcnt(0)
    s_branch D_H_CHK
D_H_OK:
    s_mov_b64 exec, -1
    v_mov_b32 v132, v112
    v_mov_b32 v133, v114
    v_mov_b32 v134, v116
    v_mov_b32 v135, v118
    v_mov_b32 v136, v120
    v_mov_b32 v137, v122
    v_mov_b32 v138, v124
    v_mov_b32 v139, v126
    v_mfma_f32_16x16x32_bf16 v[176:179], v[132:135], v[24:27], 0
    v_mfma_f32_16x16x32_bf16 v[180:183], v[132:135], v[32:35], 0
    v_mfma_f32_16x16x32_bf16 v[184:187], v[132:135], v[40:43], 0
    v_mfma_f32_16x16x32_bf16 v[188:191], v[132:135], v[48:51], 0
    v_mfma_f32_16x16x32_bf16 v[192:195], v[132:135], v[56:59], 0
    v_mfma_f32_16x16x32_bf16 v[196:199], v[132:135], v[64:67], 0
    v_mfma_f32_16x16x32_bf16 v[200:203], v[132:135], v[72:75], 0
    v_mfma_f32_16x16x32_bf16 v[204:207], v[132:135], v[80:83], 0
    v_mfma_f32_16x16x32_bf16 v[208:211], v[132:135], v[88:91], 0
    v_mfma_f32_16x16x32_bf16 v[212:215], v[132:135], v[96:99], 0
    v_mfma_f32_16x16x32_bf16 v[176:179], v[136:139], v[28:31], v[176:179]
    v_mfma_f32_16x16x32_bf16 v[180:183], v[136:139], v[36:39], v[180:183]
    v_mfma_f32_16x16x32_bf16 v[184:187], v[136:139], v[44:47], v[184:187]
    v_mfma_f32_16x16x32_bf16 v[188:191], v[136:139], v[52:55], v[188:191]
    v_mfma_f32_16x16x32_bf16 v[192:195], v[136:139], v[60:63], v[192:195]
    v_mfma_f32_16x16x32_bf16 v[196:199], v[136:139], v[68:71], v[196:199]
    v_mfma_f32_16x16x32_bf16 v[200:203], v[136:139], v[76:79], v[200:203]
    v_mfma_f32_16x16x32_bf16 v[204:207], v[136:139], v[84:87], v[204:207]
    v_mfma_f32_16x16x32_bf16 v[208:211], v[136:139], v[92:95], v[208:211]
    v_mfma_f32_16x16x32_bf16 v[212:215], v[136:139], v[100:103], v[212:215]
    v_lshlrev_b32 v2, 3, v1
    s_mul_i32 s60, s59, 1280
    s_mul_i32 s61, s63, 5120
    s_add_u32 s60, s60, s61
    s_add_u32 s60, s60, 131072
    s_add_u32 s61, s60, 138240
    v_mov_b32 v141, s52
    v_mov_b32 v143, s52
    v_mov_b32 v145, s52
    v_mov_b32 v147, s52
    v_mov_b32 v149, s52
    v_mov_b32 v151, s52
    s_mov_b32 exec_lo, 0xffff
    s_mov_b32 exec_hi, 0
    v_mov_b32 v140, v176
    v_mov_b32 v142, v177
    v_mov_b32 v144, v192
    v_mov_b32 v146, v193
    v_mov_b32 v148, v208
    v_mov_b32 v150, v209
    s_mov_b32 exec_lo, 0xffff0000
    s_mov_b32 exec_hi, 0
    v_mov_b32 v140, v180
    v_mov_b32 v142, v181
    v_mov_b32 v144, v196
    v_mov_b32 v146, v197
    v_mov_b32 v148, v212
    v_mov_b32 v150, v213
    s_mov_b32 exec_lo, 0
    s_mov_b32 exec_hi, 0xffff
    v_mov_b32 v140, v184
    v_mov_b32 v142, v185
    v_mov_b32 v144, v200
    v_mov_b32 v146, v201
    s_mov_b32 exec_lo, 0
    s_mov_b32 exec_hi, 0xffff0000
    v_mov_b32 v140, v188
    v_mov_b32 v142, v189
    v_mov_b32 v144, v204
    v_mov_b32 v146, v205
    s_mov_b64 exec, -1
    buffer_store_dwordx2 v[140:141], v2, s[28:31], s60 offen offset:0 sc1
    buffer_store_dwordx2 v[142:143], v2, s[28:31], s61 offen offset:0 sc1
    buffer_store_dwordx2 v[144:145], v2, s[28:31], s60 offen offset:512 sc1
    buffer_store_dwordx2 v[146:147], v2, s[28:31], s61 offen offset:512 sc1
    s_mov_b32 exec_hi, 0
    buffer_store_dwordx2 v[148:149], v2, s[28:31], s60 offen offset:1024 sc1
    buffer_store_dwordx2 v[150:151], v2, s[28:31], s61 offen offset:1024 sc1
    s_mov_b64 exec, -1
    s_branch K_END
FC_TOP:
    v_lshlrev_b32 v12, 4, v1
    s_mov_b32 s62, 0
    s_add_u32 s60, s62, 49152
    buffer_load_dwordx4 v[88:91], v12, s[28:31], s60 offen offset:0 sc1
    buffer_load_dwordx4 v[92:95], v12, s[28:31], s60 offen offset:1024 sc1
    buffer_load_dwordx4 v[96:99], v12, s[28:31], s60 offen offset:2048 sc1
    buffer_load_dwordx4 v[100:103], v12, s[28:31], s60 offen offset:3072 sc1
    s_add_u32 s60, s62, 53248
    buffer_load_dwordx4 v[104:107], v12, s[28:31], s60 offen offset:0 sc1
    buffer_load_dwordx4 v[108:111], v12, s[28:31], s60 offen offset:1024 sc1
    buffer_load_dwordx4 v[112:115], v12, s[28:31], s60 offen offset:2048 sc1
    buffer_load_dwordx4 v[116:119], v12, s[28:31], s60 offen offset:3072 sc1
    s_add_u32 s60, s62, 57344
    buffer_load_dwordx4 v[120:123], v12, s[28:31], s60 offen offset:0 sc1
    buffer_load_dwordx4 v[124:127], v12, s[28:31], s60 offen offset:1024 sc1
    buffer_load_dwordx4 v[128:131], v12, s[28:31], s60 offen offset:2048 sc1
    buffer_load_dwordx4 v[132:135], v12, s[28:31], s60 offen offset:3072 sc1
    s_add_u32 s60, s62, 61440
    buffer_load_dwordx4 v[136:139], v12, s[28:31], s60 offen offset:0 sc1
    buffer_load_dwordx4 v[140:143], v12, s[28:31], s60 offen offset:1024 sc1
    buffer_load_dwordx4 v[144:147], v12, s[28:31], s60 offen offset:2048 sc1
    buffer_load_dwordx4 v[148:151], v12, s[28:31], s60 offen offset:3072 sc1
    s_waitcnt vmcnt(0)
T_KY_CHK:
    v_xor_b32 v2, s52, v89
    v_bitop3_b32 v2, v91, s52, v2 bitop3:0xbe
    v_bitop3_b32 v2, v93, s52, v2 bitop3:0xbe
    v_bitop3_b32 v2, v95, s52, v2 bitop3:0xbe
    v_bitop3_b32 v2, v97, s52, v2 bitop3:0xbe
    v_bitop3_b32 v2, v99, s52, v2 bitop3:0xbe
    v_bitop3_b32 v2, v101, s52, v2 bitop3:0xbe
    v_bitop3_b32 v2, v103, s52, v2 bitop3:0xbe
    v_bitop3_b32 v2, v105, s52, v2 bitop3:0xbe
    v_bitop3_b32 v2, v107, s52, v2 bitop3:0xbe
    v_bitop3_b32 v2, v109, s52, v2 bitop3:0xbe
    v_bitop3_b32 v2, v111, s52, v2 bitop3:0xbe
    v_bitop3_b32 v2, v113, s52, v2 bitop3:0xbe
    v_bitop3_b32 v2, v115, s52, v2 bitop3:0xbe
    v_bitop3_b32 v2, v117, s52, v2 bitop3:0xbe
    v_bitop3_b32 v2, v119, s52, v2 bitop3:0xbe
    v_bitop3_b32 v2, v121, s52, v2 bitop3:0xbe
    v_bitop3_b32 v2, v123, s52, v2 bitop3:0xbe
    v_bitop3_b32 v2, v125, s52, v2 bitop3:0xbe
    v_bitop3_b32 v2, v127, s52, v2 bitop3:0xbe
    v_bitop3_b32 v2, v129, s52, v2 bitop3:0xbe
    v_bitop3_b32 v2, v131, s52, v2 bitop3:0xbe
    v_bitop3_b32 v2, v133, s52, v2 bitop3:0xbe
    v_bitop3_b32 v2, v135, s52, v2 bitop3:0xbe
    v_bitop3_b32 v2, v137, s52, v2 bitop3:0xbe
    v_bitop3_b32 v2, v139, s52, v2 bitop3:0xbe
    v_bitop3_b32 v2, v141, s52, v2 bitop3:0xbe
    v_bitop3_b32 v2, v143, s52, v2 bitop3:0xbe
    v_bitop3_b32 v2, v145, s52, v2 bitop3:0xbe
    v_bitop3_b32 v2, v147, s52, v2 bitop3:0xbe
    v_bitop3_b32 v2, v149, s52, v2 bitop3:0xbe
    v_bitop3_b32 v2, v151, s52, v2 bitop3:0xbe
    v_cmp_ne_u32 vcc, 0, v2
    s_cbranch_vccz T_KY_OK
T_KY_RETRY:
    s_add_u32 s100, s100, 1
    s_cmp_gt_u32 s100, 20000
    s_cbranch_scc1 T_KY_OK
    s_sleep 16
    s_add_u32 s60, s62, 49152
    buffer_load_dwordx4 v[88:91], v12, s[28:31], s60 offen offset:0 sc1
    buffer_load_dwordx4 v[92:95], v12, s[28:31], s60 offen offset:1024 sc1
    buffer_load_dwordx4 v[96:99], v12, s[28:31], s60 offen offset:2048 sc1
    buffer_load_dwordx4 v[100:103], v12, s[28:31], s60 offen offset:3072 sc1
    s_add_u32 s60, s62, 53248
    buffer_load_dwordx4 v[104:107], v12, s[28:31], s60 offen offset:0 sc1
    buffer_load_dwordx4 v[108:111], v12, s[28:31], s60 offen offset:1024 sc1
    buffer_load_dwordx4 v[112:115], v12, s[28:31], s60 offen offset:2048 sc1
    buffer_load_dwordx4 v[116:119], v12, s[28:31], s60 offen offset:3072 sc1
    s_add_u32 s60, s62, 57344
    buffer_load_dwordx4 v[120:123], v12, s[28:31], s60 offen offset:0 sc1
    buffer_load_dwordx4 v[124:127], v12, s[28:31], s60 offen offset:1024 sc1
    buffer_load_dwordx4 v[128:131], v12, s[28:31], s60 offen offset:2048 sc1
    buffer_load_dwordx4 v[132:135], v12, s[28:31], s60 offen offset:3072 sc1
    s_add_u32 s60, s62, 61440
    buffer_load_dwordx4 v[136:139], v12, s[28:31], s60 offen offset:0 sc1
    buffer_load_dwordx4 v[140:143], v12, s[28:31], s60 offen offset:1024 sc1
    buffer_load_dwordx4 v[144:147], v12, s[28:31], s60 offen offset:2048 sc1
    buffer_load_dwordx4 v[148:151], v12, s[28:31], s60 offen offset:3072 sc1
    s_waitcnt vmcnt(0)
    s_branch T_KY_CHK
T_KY_OK:
    v_max_u32 v20, v88, v90
    v_min_u32 v21, v88, v90
    v_med3_u32 v21, v20, v21, v92
    v_max_u32 v20, v20, v92
    v_med3_u32 v21, v20, v21, v94
    v_max_u32 v20, v20, v94
    v_med3_u32 v21, v20, v21, v96
    v_max_u32 v20, v20, v96
    v_med3_u32 v21, v20, v21, v98
    v_max_u32 v20, v20, v98
    v_med3_u32 v21, v20, v21, v100
    v_max_u32 v20, v20, v100
    v_med3_u32 v21, v20, v21, v102
    v_max_u32 v20, v20, v102
    v_med3_u32 v21, v20, v21, v104
    v_max_u32 v20, v20, v104
    v_med3_u32 v21, v20, v21, v106
    v_max_u32 v20, v20, v106
    v_med3_u32 v21, v20, v21, v108
    v_max_u32 v20, v20, v108
    v_med3_u32 v21, v20, v21, v110
    v_max_u32 v20, v20, v110
    v_med3_u32 v21, v20, v21, v112
    v_max_u32 v20, v20, v112
    v_med3_u32 v21, v20, v21, v114
    v_max_u32 v20, v20, v114
    v_med3_u32 v21, v20, v21, v116
    v_max_u32 v20, v20, v116
    v_med3_u32 v21, v20, v21, v118
    v_max_u32 v20, v20, v118
    v_med3_u32 v21, v20, v21, v120
    v_max_u32 v20, v20, v120
    v_med3_u32 v21, v20, v21, v122
    v_max_u32 v20, v20, v122
    v_med3_u32 v21, v20, v21, v124
    v_max_u32 v20, v20, v124
    v_med3_u32 v21, v20, v21, v126
    v_max_u32 v20, v20, v126
    v_med3_u32 v21, v20, v21, v128
    v_max_u32 v20, v20, v128
    v_med3_u32 v21, v20, v21, v130
    v_max_u32 v20, v20, v130
    v_med3_u32 v21, v20, v21, v132
    v_max_u32 v20, v20, v132
    v_med3_u32 v21, v20, v21, v134
    v_max_u32 v20, v20, v134
    v_med3_u32 v21, v20, v21, v136
    v_max_u32 v20, v20, v136
    v_med3_u32 v21, v20, v21, v138
    v_max_u32 v20, v20, v138
    v_med3_u32 v21, v20, v21, v140
    v_max_u32 v20, v20, v140
    v_med3_u32 v21, v20, v21, v142
    v_max_u32 v20, v20, v142
    v_med3_u32 v21, v20, v21, v144
    v_max_u32 v20, v20, v144
    v_med3_u32 v21, v20, v21, v146
    v_max_u32 v20, v20, v146
    v_med3_u32 v21, v20, v21, v148
    v_max_u32 v20, v20, v148
    v_med3_u32 v21, v20, v21, v150
    v_max_u32 v20, v20, v150
    s_nop 1
    v_mov_b32_dpp v22, v20 row_ror:8 row_mask:0xf bank_mask:0xf
    v_mov_b32_dpp v23, v21 row_ror:8 row_mask:0xf bank_mask:0xf
    v_min_u32 v2, v20, v22
    v_max_u32 v20, v20, v22
    v_max3_u32 v21, v21, v23, v2
    s_nop 0
    v_mov_b32_dpp v22, v20 row_ror:4 row_mask:0xf bank_mask:0xf
    v_mov_b32_dpp v23, v21 row_ror:4 row_mask:0xf bank_mask:0xf
    v_min_u32 v2, v20, v22
    v_max_u32 v20, v20, v22
    v_max3_u32 v21, v21, v23, v2
    s_nop 0
    v_mov_b32_dpp v22, v20 row_ror:2 row_mask:0xf bank_mask:0xf
    v_mov_b32_dpp v23, v21 row_ror:2 row_mask:0xf bank_mask:0xf
    v_min_u32 v2, v20, v22
    v_max_u32 v20, v20, v22
    v_max3_u32 v21, v21, v23, v2
    s_nop 0
    v_mov_b32_dpp v22, v20 row_ror:1 row_mask:0xf bank_mask:0xf
    v_mov_b32_dpp v23, v21 row_ror:1 row_mask:0xf bank_mask:0xf
    v_min_u32 v2, v20, v22
    v_max_u32 v20, v20, v22
    v_max3_u32 v21, v21, v23, v2
    v_mov_b32 v22, v20
    v_mov_b32 v23, v21
    s_nop 0
    v_permlane16_swap_b32 v20, v22
    v_permlane16_swap_b32 v21, v23
    v_min_u32 v2, v20, v22
    v_max_u32 v20, v20, v22
    v_max3_u32 v21, v21, v23, v2
    v_mov_b32 v22, v20
    v_mov_b32 v23, v21
    s_nop 0
    v_permlane32_swap_b32 v20, v22
    v_permlane32_swap_b32 v21, v23
    v_min_u32 v2, v20, v22
    v_max_u32 v20, v20, v22
    v_max3_u32 v21, v21, v23, v2
    s_mov_b64 exec, 0x1fffffff
    v_lshlrev_b32 v11, 7, v1
    s_movk_i32 s63, 8192
    buffer_load_dword v16, v11, s[28:31], s63 offen sc1
    v_mov_b32 v104, v20
    v_mov_b32 v106, v21
    s_waitcnt vmcnt(0)
T_FL_CHK:
    v_xor_b32 v2, s52, v16
    v_cmp_ne_u32 vcc, 0, v2
    s_cbranch_vccz T_FL_OK
T_FL_RETRY:
    s_add_u32 s100, s100, 1
    s_cmp_gt_u32 s100, 20000
    s_cbranch_scc1 T_FL_OK
    s_sleep 8
    s_movk_i32 s63, 8192
    buffer_load_dword v16, v11, s[28:31], s63 offen sc1
    s_waitcnt vmcnt(0)
    s_branch T_FL_CHK
T_FL_OK:
    s_mov_b64 exec, 0xff
    buffer_store_dwordx4 v[104:107], v15, s[28:31], 0 offen offset:256 sc1
    s_mov_b64 exec, 1
    buffer_store_dword v105, v15, s[28:31], 0 offen offset:0 sc1
    s_mov_b64 exec, -1
    s_branch K_END
AC_MB_RETRY:
    s_add_u32 s100, s100, 1
    s_cmp_gt_u32 s100, 20000
    s_cbranch_scc1 AC_MB_OK
    s_sleep 6
    buffer_load_dwordx4 v[136:139], v6, s[28:31], s12 offen offset:0 sc1
    buffer_load_dwordx4 v[140:143], v6, s[28:31], s12 offen offset:1024 sc1
    buffer_load_dwordx4 v[144:147], v6, s[28:31], s12 offen offset:2048 sc1
    s_waitcnt vmcnt(0)
    s_branch AC_MB_CHK
G2_R0:
    s_sleep 6
    buffer_load_dwordx4 v[96:99], v0, s[28:31], s96 offen offset:0 sc1
    buffer_load_dwordx4 v[100:103], v31, s[28:31], s96 offen offset:0 sc1
    buffer_load_dwordx4 v[104:107], v0, s[28:31], s96 offen offset:1024 sc1
    buffer_load_dwordx4 v[108:111], v31, s[28:31], s96 offen offset:1024 sc1
    buffer_load_dwordx4 v[112:115], v0, s[28:31], s96 offen offset:2048 sc1
    buffer_load_dwordx4 v[116:119], v31, s[28:31], s96 offen offset:2048 sc1
    buffer_load_dwordx4 v[120:123], v0, s[28:31], s96 offen offset:3072 sc1
    buffer_load_dwordx4 v[124:127], v31, s[28:31], s96 offen offset:3072 sc1
    s_add_u32 s100, s100, 1
    s_cmp_gt_u32 s100, 20000
    s_waitcnt vmcnt(0)
    s_cbranch_scc1 G2_OK0
    v_max3_u32 v2, v96, v98, v100
    v_max_u32 v2, v2, v102
    v_cmp_eq_u32 vcc, -1, v2
    s_cbranch_vccnz G2_R0
    s_branch G2_OK0
G2_R1:
    s_sleep 6
    buffer_load_dwordx4 v[104:107], v0, s[28:31], s96 offen offset:1024 sc1
    buffer_load_dwordx4 v[108:111], v31, s[28:31], s96 offen offset:1024 sc1
    buffer_load_dwordx4 v[112:115], v0, s[28:31], s96 offen offset:2048 sc1
    buffer_load_dwordx4 v[116:119], v31, s[28:31], s96 offen offset:2048 sc1
    buffer_load_dwordx4 v[120:123], v0, s[28:31], s96 offen offset:3072 sc1
    buffer_load_dwordx4 v[124:127], v31, s[28:31], s96 offen offset:3072 sc1
    buffer_load_dwordx4 v[128:131], v0, s[28:31], s92 offen offset:0 sc1
    buffer_load_dwordx4 v[132:135], v31, s[28:31], s92 offen offset:0 sc1
    s_add_u32 s100, s100, 1
    s_cmp_gt_u32 s100, 20000
    s_waitcnt vmcnt(0)
    s_cbranch_scc1 G2_OK1
    v_max3_u32 v2, v104, v106, v108
    v_max_u32 v2, v2, v110
    v_cmp_eq_u32 vcc, -1, v2
    s_cbranch_vccnz G2_R1
    s_branch G2_OK1
G2_R2:
    s_sleep 6
    buffer_load_dwordx4 v[112:115], v0, s[28:31], s96 offen offset:2048 sc1
    buffer_load_dwordx4 v[116:119], v31, s[28:31], s96 offen offset:2048 sc1
    buffer_load_dwordx4 v[120:123], v0, s[28:31], s96 offen offset:3072 sc1
    buffer_load_dwordx4 v[124:127], v31, s[28:31], s96 offen offset:3072 sc1
    buffer_load_dwordx4 v[128:131], v0, s[28:31], s92 offen offset:0 sc1
    buffer_load_dwordx4 v[132:135], v31, s[28:31], s92 offen offset:0 sc1
    buffer_load_dwordx4 v[136:139], v0, s[28:31], s92 offen offset:1024 sc1
    buffer_load_dwordx4 v[140:143], v31, s[28:31], s92 offen offset:1024 sc1
    s_add_u32 s100, s100, 1
    s_cmp_gt_u32 s100, 20000
    s_waitcnt vmcnt(0)
    s_cbranch_scc1 G2_OK2
    v_max3_u32 v2, v112, v114, v116
    v_max_u32 v2, v2, v118
    v_cmp_eq_u32 vcc, -1, v2
    s_cbranch_vccnz G2_R2
    s_branch G2_OK2
G2_ZA:
    s_waitcnt lgkmcnt(0)
    v_and_b32 v2, v2, v3
    v_cmp_ne_u32 vcc, 0x01010101, v2
    s_cbranch_vccz G2_ZAOK
G2_ZAR:
    s_add_u32 s100, s100, 1
    s_cmp_gt_u32 s100, 200000
    s_cbranch_scc1 G2_ZAOK
    s_sleep 1
    ds_read_b64 v[2:3], v19 offset:16
    s_branch G2_ZA
G2_R3:
    s_sleep 6
    buffer_load_dwordx4 v[120:123], v0, s[28:31], s96 offen offset:3072 sc1
    buffer_load_dwordx4 v[124:127], v31, s[28:31], s96 offen offset:3072 sc1
    buffer_load_dwordx4 v[128:131], v0, s[28:31], s92 offen offset:0 sc1
    buffer_load_dwordx4 v[132:135], v31, s[28:31], s92 offen offset:0 sc1
    buffer_load_dwordx4 v[136:139], v0, s[28:31], s92 offen offset:1024 sc1
    buffer_load_dwordx4 v[140:143], v31, s[28:31], s92 offen offset:1024 sc1
    buffer_load_dwordx4 v[144:147], v0, s[28:31], s92 offen offset:2048 sc1
    buffer_load_dwordx4 v[148:151], v31, s[28:31], s92 offen offset:2048 sc1
    s_add_u32 s100, s100, 1
    s_cmp_gt_u32 s100, 20000
    s_waitcnt vmcnt(0)
    s_cbranch_scc1 G2_OK3
    v_max3_u32 v2, v120, v122, v124
    v_max_u32 v2, v2, v126
    v_cmp_eq_u32 vcc, -1, v2
    s_cbranch_vccnz G2_R3
    s_branch G2_OK3
G2_R4:
    s_sleep 6
    buffer_load_dwordx4 v[128:131], v0, s[28:31], s92 offen offset:0 sc1
    buffer_load_dwordx4 v[132:135], v31, s[28:31], s92 offen offset:0 sc1
    buffer_load_dwordx4 v[136:139], v0, s[28:31], s92 offen offset:1024 sc1
    buffer_load_dwordx4 v[140:143], v31, s[28:31], s92 offen offset:1024 sc1
    buffer_load_dwordx4 v[144:147], v0, s[28:31], s92 offen offset:2048 sc1
    buffer_load_dwordx4 v[148:151], v31, s[28:31], s92 offen offset:2048 sc1
    buffer_load_dwordx4 v[152:155], v0, s[28:31], s4 offen offset:0 sc1
    buffer_load_dwordx4 v[156:159], v31, s[28:31], s4 offen offset:0 sc1
    s_add_u32 s100, s100, 1
    s_cmp_gt_u32 s100, 20000
    s_waitcnt vmcnt(0)
    s_cbranch_scc1 G2_OK4
    v_max3_u32 v2, v128, v130, v132
    v_max_u32 v2, v2, v134
    v_cmp_eq_u32 vcc, -1, v2
    s_cbranch_vccnz G2_R4
    s_branch G2_OK4
G2_R5:
    s_sleep 6
    buffer_load_dwordx4 v[136:139], v0, s[28:31], s92 offen offset:1024 sc1
    buffer_load_dwordx4 v[140:143], v31, s[28:31], s92 offen offset:1024 sc1
    buffer_load_dwordx4 v[144:147], v0, s[28:31], s92 offen offset:2048 sc1
    buffer_load_dwordx4 v[148:151], v31, s[28:31], s92 offen offset:2048 sc1
    buffer_load_dwordx4 v[152:155], v0, s[28:31], s4 offen offset:0 sc1
    buffer_load_dwordx4 v[156:159], v31, s[28:31], s4 offen offset:0 sc1
    buffer_load_dwordx4 v[96:99], v0, s[28:31], s4 offen offset:1024 sc1
    buffer_load_dwordx4 v[100:103], v31, s[28:31], s4 offen offset:1024 sc1
    s_add_u32 s100, s100, 1
    s_cmp_gt_u32 s100, 20000
    s_waitcnt vmcnt(0)
    s_cbranch_scc1 G2_OK5
    v_max3_u32 v2, v136, v138, v140
    v_max_u32 v2, v2, v142
    v_cmp_eq_u32 vcc, -1, v2
    s_cbranch_vccnz G2_R5
    s_branch G2_OK5
G2_R6:
    s_sleep 6
    buffer_load_dwordx4 v[144:147], v0, s[28:31], s92 offen offset:2048 sc1
    buffer_load_dwordx4 v[148:151], v31, s[28:31], s92 offen offset:2048 sc1
    buffer_load_dwordx4 v[152:155], v0, s[28:31], s4 offen offset:0 sc1
    buffer_load_dwordx4 v[156:159], v31, s[28:31], s4 offen offset:0 sc1
    buffer_load_dwordx4 v[96:99], v0, s[28:31], s4 offen offset:1024 sc1
    buffer_load_dwordx4 v[100:103], v31, s[28:31], s4 offen offset:1024 sc1
    buffer_load_dwordx4 v[104:107], v0, s[28:31], s4 offen offset:2048 sc1
    buffer_load_dwordx4 v[108:111], v31, s[28:31], s4 offen offset:2048 sc1
    s_add_u32 s100, s100, 1
    s_cmp_gt_u32 s100, 20000
    s_waitcnt vmcnt(0)
    s_cbranch_scc1 G2_OK6
    v_max3_u32 v2, v144, v146, v148
    v_max_u32 v2, v2, v150
    v_cmp_eq_u32 vcc, -1, v2
    s_cbranch_vccnz G2_R6
    s_branch G2_OK6
G2_R7:
    s_sleep 6
    buffer_load_dwordx4 v[152:155], v0, s[28:31], s4 offen offset:0 sc1
    buffer_load_dwordx4 v[156:159], v31, s[28:31], s4 offen offset:0 sc1
    buffer_load_dwordx4 v[96:99], v0, s[28:31], s4 offen offset:1024 sc1
    buffer_load_dwordx4 v[100:103], v31, s[28:31], s4 offen offset:1024 sc1
    buffer_load_dwordx4 v[104:107], v0, s[28:31], s4 offen offset:2048 sc1
    buffer_load_dwordx4 v[108:111], v31, s[28:31], s4 offen offset:2048 sc1
    buffer_load_dwordx4 v[112:115], v0, s[28:31], s4 offen offset:3072 sc1
    buffer_load_dwordx4 v[116:119], v31, s[28:31], s4 offen offset:3072 sc1
    s_add_u32 s100, s100, 1
    s_cmp_gt_u32 s100, 20000
    s_waitcnt vmcnt(0)
    s_cbranch_scc1 G2_OK7
    v_max3_u32 v2, v152, v154, v156
    v_max_u32 v2, v2, v158
    v_cmp_eq_u32 vcc, -1, v2
    s_cbranch_vccnz G2_R7
    s_branch G2_OK7
G2_R8:
    s_sleep 6
    buffer_load_dwordx4 v[96:99], v0, s[28:31], s4 offen offset:1024 sc1
    buffer_load_dwordx4 v[100:103], v31, s[28:31], s4 offen offset:1024 sc1
    buffer_load_dwordx4 v[104:107], v0, s[28:31], s4 offen offset:2048 sc1
    buffer_load_dwordx4 v[108:111], v31, s[28:31], s4 offen offset:2048 sc1
    buffer_load_dwordx4 v[112:115], v0, s[28:31], s4 offen offset:3072 sc1
    buffer_load_dwordx4 v[116:119], v31, s[28:31], s4 offen offset:3072 sc1
    buffer_load_dwordx4 v[120:123], v0, s[28:31], s6 offen offset:0 sc1
    buffer_load_dwordx4 v[124:127], v31, s[28:31], s6 offen offset:0 sc1
    s_add_u32 s100, s100, 1
    s_cmp_gt_u32 s100, 20000
    s_waitcnt vmcnt(0)
    s_cbranch_scc1 G2_OK8
    v_max3_u32 v2, v96, v98, v100
    v_max_u32 v2, v2, v102
    v_cmp_eq_u32 vcc, -1, v2
    s_cbranch_vccnz G2_R8
    s_branch G2_OK8
G2_ZL:
    s_waitcnt lgkmcnt(0)
    v_and_b32 v2, v2, v3
    v_cmp_ne_u32 vcc, 0x01010101, v2
    s_cbranch_vccz G2_ZLOK
G2_ZLR:
    s_add_u32 s100, s100, 1
    s_cmp_gt_u32 s100, 200000
    s_cbranch_scc1 G2_ZLOK
    s_sleep 1
    ds_read_b64 v[2:3], v19 offset:0
    s_branch G2_ZL
G2_R9:
    s_sleep 6
    buffer_load_dwordx4 v[104:107], v0, s[28:31], s4 offen offset:2048 sc1
    buffer_load_dwordx4 v[108:111], v31, s[28:31], s4 offen offset:2048 sc1
    buffer_load_dwordx4 v[112:115], v0, s[28:31], s4 offen offset:3072 sc1
    buffer_load_dwordx4 v[116:119], v31, s[28:31], s4 offen offset:3072 sc1
    buffer_load_dwordx4 v[120:123], v0, s[28:31], s6 offen offset:0 sc1
    buffer_load_dwordx4 v[124:127], v31, s[28:31], s6 offen offset:0 sc1
    buffer_load_dwordx4 v[128:131], v0, s[28:31], s6 offen offset:1024 sc1
    buffer_load_dwordx4 v[132:135], v31, s[28:31], s6 offen offset:1024 sc1
    s_add_u32 s100, s100, 1
    s_cmp_gt_u32 s100, 20000
    s_waitcnt vmcnt(0)
    s_cbranch_scc1 G2_OK9
    v_max3_u32 v2, v104, v106, v108
    v_max_u32 v2, v2, v110
    v_cmp_eq_u32 vcc, -1, v2
    s_cbranch_vccnz G2_R9
    s_branch G2_OK9
G2_R10:
    s_sleep 6
    buffer_load_dwordx4 v[112:115], v0, s[28:31], s4 offen offset:3072 sc1
    buffer_load_dwordx4 v[116:119], v31, s[28:31], s4 offen offset:3072 sc1
    buffer_load_dwordx4 v[120:123], v0, s[28:31], s6 offen offset:0 sc1
    buffer_load_dwordx4 v[124:127], v31, s[28:31], s6 offen offset:0 sc1
    buffer_load_dwordx4 v[128:131], v0, s[28:31], s6 offen offset:1024 sc1
    buffer_load_dwordx4 v[132:135], v31, s[28:31], s6 offen offset:1024 sc1
    buffer_load_dwordx4 v[136:139], v0, s[28:31], s6 offen offset:2048 sc1
    buffer_load_dwordx4 v[140:143], v31, s[28:31], s6 offen offset:2048 sc1
    s_add_u32 s100, s100, 1
    s_cmp_gt_u32 s100, 20000
    s_waitcnt vmcnt(0)
    s_cbranch_scc1 G2_OK10
    v_max3_u32 v2, v112, v114, v116
    v_max_u32 v2, v2, v118
    v_cmp_eq_u32 vcc, -1, v2
    s_cbranch_vccnz G2_R10
    s_branch G2_OK10
G2_R11:
    s_sleep 6
    buffer_load_dwordx4 v[120:123], v0, s[28:31], s6 offen offset:0 sc1
    buffer_load_dwordx4 v[124:127], v31, s[28:31], s6 offen offset:0 sc1
    buffer_load_dwordx4 v[128:131], v0, s[28:31], s6 offen offset:1024 sc1
    buffer_load_dwordx4 v[132:135], v31, s[28:31], s6 offen offset:1024 sc1
    buffer_load_dwordx4 v[136:139], v0, s[28:31], s6 offen offset:2048 sc1
    buffer_load_dwordx4 v[140:143], v31, s[28:31], s6 offen offset:2048 sc1
    buffer_load_dwordx4 v[144:147], v0, s[28:31], s93 offen offset:0 sc1
    buffer_load_dwordx4 v[148:151], v31, s[28:31], s93 offen offset:0 sc1
    s_add_u32 s100, s100, 1
    s_cmp_gt_u32 s100, 20000
    s_waitcnt vmcnt(0)
    s_cbranch_scc1 G2_OK11
    v_max3_u32 v2, v120, v122, v124
    v_max_u32 v2, v2, v126
    v_cmp_eq_u32 vcc, -1, v2
    s_cbranch_vccnz G2_R11
    s_branch G2_OK11
G2_R12:
    s_sleep 6
    buffer_load_dwordx4 v[128:131], v0, s[28:31], s6 offen offset:1024 sc1
    buffer_load_dwordx4 v[132:135], v31, s[28:31], s6 offen offset:1024 sc1
    buffer_load_dwordx4 v[136:139], v0, s[28:31], s6 offen offset:2048 sc1
    buffer_load_dwordx4 v[140:143], v31, s[28:31], s6 offen offset:2048 sc1
    buffer_load_dwordx4 v[144:147], v0, s[28:31], s93 offen offset:0 sc1
    buffer_load_dwordx4 v[148:151], v31, s[28:31], s93 offen offset:0 sc1
    buffer_load_dwordx4 v[152:155], v0, s[28:31], s7 offen offset:0 sc1
    buffer_load_dwordx4 v[156:159], v31, s[28:31], s7 offen offset:0 sc1
    s_add_u32 s100, s100, 1
    s_cmp_gt_u32 s100, 20000
    s_waitcnt vmcnt(0)
    s_cbranch_scc1 G2_OK12
    v_max3_u32 v2, v128, v130, v132
    v_max_u32 v2, v2, v134
    v_cmp_eq_u32 vcc, -1, v2
    s_cbranch_vccnz G2_R12
    s_branch G2_OK12
G2_R13:
    s_sleep 6
    buffer_load_dwordx4 v[136:139], v0, s[28:31], s6 offen offset:2048 sc1
    buffer_load_dwordx4 v[140:143], v31, s[28:31], s6 offen offset:2048 sc1
    buffer_load_dwordx4 v[144:147], v0, s[28:31], s93 offen offset:0 sc1
    buffer_load_dwordx4 v[148:151], v31, s[28:31], s93 offen offset:0 sc1
    buffer_load_dwordx4 v[152:155], v0, s[28:31], s7 offen offset:0 sc1
    buffer_load_dwordx4 v[156:159], v31, s[28:31], s7 offen offset:0 sc1
    buffer_load_dwordx4 v[96:99], v0, s[28:31], s93 offen offset:1024 sc1
    buffer_load_dwordx4 v[100:103], v31, s[28:31], s93 offen offset:1024 sc1
    s_add_u32 s100, s100, 1
    s_cmp_gt_u32 s100, 20000
    s_waitcnt vmcnt(0)
    s_cbranch_scc1 G2_OK13
    v_max3_u32 v2, v136, v138, v140
    v_max_u32 v2, v2, v142
    v_cmp_eq_u32 vcc, -1, v2
    s_cbranch_vccnz G2_R13
    s_branch G2_OK13
G2_R14:
    s_sleep 6
    buffer_load_dwordx4 v[144:147], v0, s[28:31], s93 offen offset:0 sc1
    buffer_load_dwordx4 v[148:151], v31, s[28:31], s93 offen offset:0 sc1
    buffer_load_dwordx4 v[152:155], v0, s[28:31], s7 offen offset:0 sc1
    buffer_load_dwordx4 v[156:159], v31, s[28:31], s7 offen offset:0 sc1
    buffer_load_dwordx4 v[96:99], v0, s[28:31], s93 offen offset:1024 sc1
    buffer_load_dwordx4 v[100:103], v31, s[28:31], s93 offen offset:1024 sc1
    buffer_load_dwordx4 v[104:107], v0, s[28:31], s7 offen offset:1024 sc1
    buffer_load_dwordx4 v[108:111], v31, s[28:31], s7 offen offset:1024 sc1
    s_add_u32 s100, s100, 1
    s_cmp_gt_u32 s100, 20000
    s_waitcnt vmcnt(0)
    s_cbranch_scc1 G2_OK14
    v_max3_u32 v2, v144, v146, v148
    v_max_u32 v2, v2, v150
    v_cmp_eq_u32 vcc, -1, v2
    s_cbranch_vccnz G2_R14
    s_branch G2_OK14
G2_R15:
    s_sleep 6
    buffer_load_dwordx4 v[152:155], v0, s[28:31], s7 offen offset:0 sc1
    buffer_load_dwordx4 v[156:159], v31, s[28:31], s7 offen offset:0 sc1
    buffer_load_dwordx4 v[96:99], v0, s[28:31], s93 offen offset:1024 sc1
    buffer_load_dwordx4 v[100:103], v31, s[28:31], s93 offen offset:1024 sc1
    buffer_load_dwordx4 v[104:107], v0, s[28:31], s7 offen offset:1024 sc1
    buffer_load_dwordx4 v[108:111], v31, s[28:31], s7 offen offset:1024 sc1
    buffer_load_dwordx4 v[112:115], v0, s[28:31], s92 offen offset:3072 sc1
    buffer_load_dwordx4 v[116:119], v31, s[28:31], s92 offen offset:3072 sc1
    s_add_u32 s100, s100, 1
    s_cmp_gt_u32 s100, 20000
    s_waitcnt vmcnt(0)
    s_cbranch_scc1 G2_OK15
    v_max3_u32 v2, v152, v154, v156
    v_max_u32 v2, v2, v158
    v_cmp_eq_u32 vcc, -1, v2
    s_cbranch_vccnz G2_R15
    s_branch G2_OK15
G2_R16:
    s_sleep 6
    buffer_load_dwordx4 v[96:99], v0, s[28:31], s93 offen offset:1024 sc1
    buffer_load_dwordx4 v[100:103], v31, s[28:31], s93 offen offset:1024 sc1
    buffer_load_dwordx4 v[104:107], v0, s[28:31], s7 offen offset:1024 sc1
    buffer_load_dwordx4 v[108:111], v31, s[28:31], s7 offen offset:1024 sc1
    buffer_load_dwordx4 v[112:115], v0, s[28:31], s92 offen offset:3072 sc1
    buffer_load_dwordx4 v[116:119], v31, s[28:31], s92 offen offset:3072 sc1
    buffer_load_dwordx4 v[120:123], v0, s[28:31], s6 offen offset:3072 sc1
    buffer_load_dwordx4 v[124:127], v31, s[28:31], s6 offen offset:3072 sc1
    s_add_u32 s100, s100, 1
    s_cmp_gt_u32 s100, 20000
    s_waitcnt vmcnt(0)
    s_cbranch_scc1 G2_OK16
    v_max3_u32 v2, v96, v98, v100
    v_max_u32 v2, v2, v102
    v_cmp_eq_u32 vcc, -1, v2
    s_cbranch_vccnz G2_R16
    s_branch G2_OK16
G2_R17:
    s_sleep 6
    buffer_load_dwordx4 v[104:107], v0, s[28:31], s7 offen offset:1024 sc1
    buffer_load_dwordx4 v[108:111], v31, s[28:31], s7 offen offset:1024 sc1
    buffer_load_dwordx4 v[112:115], v0, s[28:31], s92 offen offset:3072 sc1
    buffer_load_dwordx4 v[116:119], v31, s[28:31], s92 offen offset:3072 sc1
    buffer_load_dwordx4 v[120:123], v0, s[28:31], s6 offen offset:3072 sc1
    buffer_load_dwordx4 v[124:127], v31, s[28:31], s6 offen offset:3072 sc1
    s_add_u32 s100, s100, 1
    s_cmp_gt_u32 s100, 20000
    s_waitcnt vmcnt(0)
    s_cbranch_scc1 G2_OK17
    v_max3_u32 v2, v104, v106, v108
    v_max_u32 v2, v2, v110
    v_cmp_eq_u32 vcc, -1, v2
    s_cbranch_vccnz G2_R17
    s_branch G2_OK17
G2_R18:
    s_sleep 6
    buffer_load_dwordx4 v[112:115], v0, s[28:31], s92 offen offset:3072 sc1
    buffer_load_dwordx4 v[116:119], v31, s[28:31], s92 offen offset:3072 sc1
    buffer_load_dwordx4 v[120:123], v0, s[28:31], s6 offen offset:3072 sc1
    buffer_load_dwordx4 v[124:127], v31, s[28:31], s6 offen offset:3072 sc1
    s_add_u32 s100, s100, 1
    s_cmp_gt_u32 s100, 20000
    s_waitcnt vmcnt(0)
    s_cbranch_scc1 G2_OK18
    v_max3_u32 v2, v112, v114, v116
    v_max_u32 v2, v2, v118
    v_cmp_eq_u32 vcc, -1, v2
    s_cbranch_vccnz G2_R18
    s_branch G2_OK18
G2_R19:
    s_sleep 6
    buffer_load_dwordx4 v[120:123], v0, s[28:31], s6 offen offset:3072 sc1
    buffer_load_dwordx4 v[124:127], v31, s[28:31], s6 offen offset:3072 sc1
    s_add_u32 s100, s100, 1
    s_cmp_gt_u32 s100, 20000
    s_waitcnt vmcnt(0)
    s_cbranch_scc1 G2_OK19
    v_max3_u32 v2, v120, v122, v124
    v_max_u32 v2, v2, v126
    v_cmp_eq_u32 vcc, -1, v2
    s_cbranch_vccnz G2_R19
    s_branch G2_OK19
G2_ZG:
    s_waitcnt lgkmcnt(0)
    v_and_b32 v2, v2, v3
    v_cmp_ne_u32 vcc, 0x01010101, v2
    s_cbranch_vccz G2_ZGOK
G2_ZGR:
    s_add_u32 s100, s100, 1
    s_cmp_gt_u32 s100, 200000
    s_cbranch_scc1 G2_ZGOK
    s_sleep 1
    ds_read_b64 v[2:3], v19 offset:8
    s_branch G2_ZG
P_ZR:
    s_add_u32 s100, s100, 1
    s_cmp_gt_u32 s100, 200000
    s_cbranch_scc1 P_ZOK
    s_sleep 1
    ds_read_b64 v[2:3], v19 offset:0
    s_branch P_Z
L_RC_RETRY:
    s_add_u32 s100, s100, 1
    s_cmp_gt_u32 s100, 20000
    s_cbranch_scc1 L_RC_OK
    s_sleep 4
    s_mul_i32 s60, s59, 448
    s_add_u32 m0, s60, 161536
    s_mov_b64 exec, 0xfffffff
    buffer_load_dwordx4 v81, s[28:31], 0 offen sc1 lds
    s_mov_b64 exec, -1
    s_waitcnt vmcnt(0)
    ds_read_b128 v[84:87], v82
    s_waitcnt lgkmcnt(0)
    s_waitcnt vmcnt(0)
    s_branch L_RC_CHK
L_FL_RETRY:
    s_add_u32 s100, s100, 1
    s_cmp_gt_u32 s100, 20000
    s_cbranch_scc1 L_FL_OK
    s_sleep 8
    s_mov_b64 exec, 1
    buffer_load_dwordx4 v[112:115], v6, s[28:31], 0 offen offset:256 sc1
    s_waitcnt vmcnt(0)
    s_branch L_FL_CHK
AL_MB_RETRY:
    s_add_u32 s100, s100, 1
    s_cmp_gt_u32 s100, 20000
    s_cbranch_scc1 AL_MB_OK
    s_sleep 6
    buffer_load_dwordx4 v[136:139], v6, s[28:31], s12 offen offset:0 sc1
    buffer_load_dwordx4 v[140:143], v6, s[28:31], s12 offen offset:1024 sc1
    buffer_load_dwordx4 v[144:147], v6, s[28:31], s12 offen offset:2048 sc1
    buffer_load_dwordx4 v[148:151], v6, s[28:31], s12 offen offset:3072 sc1
    s_waitcnt vmcnt(0)
    s_branch AL_MB_CHK
K_END:
K_EXIT:
    s_endpgm
    .p2align 6
    .type K_TAB,@object
K_TAB:
    .long 0x18100800, 0x80808020, 0x18100800, 0x20, 0x0, 0x1400, 0x1e00, 0x0
    .long 0x0, 0x2, 0xff00ff00, 0xffffffff, 0xffffffff, 0xffffffff, 0xffffff00, 0xffffffff
    .long 0x18100800, 0x80808080, 0x18100800, 0x18, 0x6, 0x2000, 0x7ff00000, 0x1c00
    .long 0x0, 0x1, 0xff00ff00, 0xffffffff, 0xffffffff, 0xffffffff, 0xffffff00, 0xffffffff
    .long 0x80100800, 0x80808080, 0x8080000, 0x10, 0x6, 0x2500, 0x1d08, 0x5400
    .long 0x3800, 0x1, 0xff00, 0xffff, 0xffff, 0xffff, 0xffffff00, 0xffffffff
    .long 0x80800800, 0x80808080, 0x8080000, 0x8, 0x6, 0x2700, 0x7ff00000, 0x8c00
    .long 0x7000, 0x1, 0xff00, 0xffff, 0xffff, 0xffff, 0xffffff00, 0xffffffff
    .long 0x80808000, 0x80808080, 0x8080000, 0x0, 0x6, 0x7ff00000, 0x1f08, 0xc400
    .long 0xa800, 0x1, 0xff00, 0xffff, 0xffff, 0xffff, 0xffffff00, 0xffffffff
    .long 0x40383028, 0x80808048, 0x40383028, 0x48, 0x2, 0x0, 0x1800, 0x0
    .long 0x0, 0x0, 0xff00ff00, 0xffffffff, 0xffffffff, 0xffffffff, 0xffffff00, 0xffffffff
    .long 0x38302820, 0x80808040, 0x38302820, 0x40, 0x0, 0x400, 0x1a00, 0x0
    .long 0x0, 0x0, 0xff00ff00, 0xffffffff, 0xffffffff, 0xffffffff, 0xffffff00, 0xffffffff
    .long 0x30282018, 0x80808038, 0x30282018, 0x38, 0x0, 0x800, 0x1808, 0x0
    .long 0x0, 0x0, 0xff00ff00, 0xffffffff, 0xffffffff, 0xffffffff, 0xffffff00, 0xffffffff
    .long 0x28201810, 0x80808030, 0x28201810, 0x30, 0x0, 0xc00, 0x1a08, 0x0
    .long 0x0, 0x0, 0xff00ff00, 0xffffffff, 0xffffffff, 0xffffffff, 0xffffff00, 0xffffffff
    .long 0x20181008, 0x80808028, 0x20181008, 0x28, 0x0, 0x1000, 0x1c00, 0x0
    .long 0x0, 0x0, 0xff00ff00, 0xffffffff, 0xffffffff, 0xffffffff, 0xffffff00, 0xffffffff
    .long 0x68605850, 0x80808070, 0x68605850, 0x70, 0x4, 0x200, 0x1900, 0x0
    .long 0x0, 0x0, 0xff00ff00, 0xffffffff, 0xffffffff, 0xffffffff, 0xffffff00, 0xffffffff
    .long 0x60585048, 0x80808068, 0x60585048, 0x68, 0x2, 0x600, 0x1b00, 0x0
    .long 0x0, 0x0, 0xff00ff00, 0xffffffff, 0xffffffff, 0xffffffff, 0xffffff00, 0xffffffff
    .long 0x58504840, 0x80808060, 0x58504840, 0x60, 0x2, 0xa00, 0x1908, 0x0
    .long 0x0, 0x0, 0xff00ff00, 0xffffffff, 0xffffffff, 0xffffffff, 0xffffff00, 0xffffffff
    .long 0x50484038, 0x80808058, 0x50484038, 0x58, 0x2, 0xe00, 0x1b08, 0x0
    .long 0x0, 0x0, 0xff00ff00, 0xffffffff, 0xffffffff, 0xffffffff, 0xffffff00, 0xffffffff
    .long 0x48403830, 0x80808050, 0x48403830, 0x50, 0x2, 0x1200, 0x1d00, 0x0
    .long 0x0, 0x0, 0xff00ff00, 0xffffffff, 0xffffffff, 0xffffffff, 0xffffff00, 0xffffffff
    .long 0x80808078, 0x80808080, 0x80807878, 0x78, 0x6, 0x7ff00000, 0x1c08, 0x0
    .long 0x1c00, 0x1, 0xff00, 0xffff, 0xffff, 0xffff, 0xffffff00, 0xffffffff
    .long 0x80807870, 0x80808080, 0x78787070, 0x78, 0x4, 0x2400, 0x7ff00000, 0x3800
    .long 0x5400, 0x1, 0xff00, 0xffff, 0xffff, 0xffff, 0xffffff00, 0xffffffff
    .long 0x80787068, 0x80808080, 0x70706868, 0x78, 0x4, 0x2600, 0x1e08, 0x7000
    .long 0x8c00, 0x1, 0xff00, 0xffff, 0xffff, 0xffff, 0xffffff00, 0xffffffff
    .long 0x78706860, 0x80808080, 0x78706860, 0x78, 0x4, 0x2200, 0x7ff00000, 0xa800
    .long 0xc400, 0x1, 0xff00ff00, 0xffffffff, 0xffffffff, 0xffffffff, 0xffffff00, 0xffffffff
    .long 0x70686058, 0x80808078, 0x70686058, 0x78, 0x4, 0x1600, 0x1f00, 0x0
    .long 0x0, 0x2, 0xff00ff00, 0xffffffff, 0xffffffff, 0xffffffff, 0xffffff00, 0xffffffff
    .long 0x40383028, 0x80808048, 0x40383028, 0x48, 0x0, 0x14000, 0x15800, 0x0
    .long 0x0, 0x0, 0xffffffff, 0xffffffff, 0xffffffff, 0x0, 0xffffffff, 0xffff
    .long 0x38302820, 0x80808040, 0x38302820, 0x40, 0x6, 0x14400, 0x15a00, 0x0
    .long 0x0, 0x0, 0xffffffff, 0xffffffff, 0xffffffff, 0x0, 0xffffffff, 0xffff
    .long 0x30282018, 0x80808038, 0x30282018, 0x38, 0x6, 0x14800, 0x15808, 0x0
    .long 0x0, 0x0, 0xffffffff, 0xffffffff, 0xffffffff, 0x0, 0xffffffff, 0xffff
    .long 0x28201810, 0x80808030, 0x28201810, 0x30, 0x6, 0x14c00, 0x15a08, 0x0
    .long 0x0, 0x0, 0xffffffff, 0xffffffff, 0xffffffff, 0x0, 0xffffffff, 0xffff
    .long 0x20181008, 0x80808028, 0x20181008, 0x28, 0x6, 0x15000, 0x15c00, 0x0
    .long 0x0, 0x0, 0xffffffff, 0xffffffff, 0xffffffff, 0x0, 0xffffffff, 0xffff
    .long 0x18100800, 0x80808020, 0x18100800, 0x20, 0x2, 0x15400, 0x15e00, 0x0
    .long 0x0, 0x2, 0xffffffff, 0xffffffff, 0xffffffff, 0x0, 0xffffffff, 0xffff
    .long 0x18100800, 0x80808080, 0x18100800, 0x18, 0x0, 0x16000, 0x7ff00000, 0x2c00
    .long 0x1000, 0x1, 0xffffffff, 0xffffffff, 0xffffffff, 0x0, 0xffffffff, 0xffff
    .long 0x80100800, 0x80808080, 0x8080000, 0x10, 0x0, 0x16500, 0x15d08, 0x6400
    .long 0x4800, 0x1, 0xffff, 0xffff, 0xffff, 0x0, 0xffffffff, 0xffff
    .long 0x80800800, 0x80808080, 0x8080000, 0x8, 0x0, 0x16700, 0x7ff00000, 0x9c00
    .long 0x8000, 0x1, 0xffff, 0xffff, 0xffff, 0x0, 0xffffffff, 0xffff
    .long 0x80808000, 0x80808080, 0x8080000, 0x0, 0x0, 0x7ff00000, 0x15f08, 0xd400
    .long 0xb800, 0x1, 0xffff, 0xffff, 0xffff, 0x0, 0xffffffff, 0xffff
    .long 0x80808078, 0x80808080, 0x80807878, 0x78, 0x4, 0x7ff00000, 0x15c08, 0x1000
    .long 0x2c00, 0x1, 0xffff, 0xffff, 0xffff, 0x0, 0xffffffff, 0xffff
    .long 0x80807870, 0x80808080, 0x78787070, 0x78, 0x2, 0x16400, 0x7ff00000, 0x4800
    .long 0x6400, 0x1, 0xffff, 0xffff, 0xffff, 0x0, 0xffffffff, 0xffff
    .long 0x80787068, 0x80808080, 0x70706868, 0x78, 0x2, 0x16600, 0x15e08, 0x8000
    .long 0x9c00, 0x1, 0xffff, 0xffff, 0xffff, 0x0, 0xffffffff, 0xffff
    .long 0x78706860, 0x80808080, 0x78706860, 0x78, 0x2, 0x16200, 0x7ff00000, 0xb800
    .long 0xd400, 0x1, 0xffffffff, 0xffffffff, 0xffffffff, 0x0, 0xffffffff, 0xffff
    .long 0x70686058, 0x80808078, 0x70686058, 0x78, 0x2, 0x15600, 0x15f00, 0x0
    .long 0x0, 0x2, 0xffffffff, 0xffffffff, 0xffffffff, 0x0, 0xffffffff, 0xffff
    .long 0x68605850, 0x80808070, 0x68605850, 0x70, 0x6, 0x14200, 0x15900, 0x0
    .long 0x0, 0x0, 0xffffffff, 0xffffffff, 0xffffffff, 0x0, 0xffffffff, 0xffff
    .long 0x60585048, 0x80808068, 0x60585048, 0x68, 0x4, 0x14600, 0x15b00, 0x0
    .long 0x0, 0x0, 0xffffffff, 0xffffffff, 0xffffffff, 0x0, 0xffffffff, 0xffff
    .long 0x58504840, 0x80808060, 0x58504840, 0x60, 0x4, 0x14a00, 0x15908, 0x0
    .long 0x0, 0x0, 0xffffffff, 0xffffffff, 0xffffffff, 0x0, 0xffffffff, 0xffff
    .long 0x50484038, 0x80808058, 0x50484038, 0x58, 0x4, 0x14e00, 0x15b08, 0x0
    .long 0x0, 0x0, 0xffffffff, 0xffffffff, 0xffffffff, 0x0, 0xffffffff, 0xffff
    .long 0x48403830, 0x80808050, 0x48403830, 0x50, 0x4, 0x15200, 0x15d00, 0x0
    .long 0x0, 0x0, 0xffffffff, 0xffffffff, 0xffffffff, 0x0, 0xffffffff, 0xffff
    .fill (40960 - (. - recurrent_scan__sliding_local_dilated__moe_arch_mod__prompt_kernel)) / 4, 4, 0xbf810000
.section .rodata,"a"
.p2align 6
.amdhsa_kernel recurrent_scan__sliding_local_dilated__moe_arch_mod__prompt_kernel
  .amdhsa_next_free_vgpr 256
  .amdhsa_next_free_sgpr 102
  .amdhsa_accum_offset 256
  .amdhsa_group_segment_fixed_size 0
  .amdhsa_kernarg_size 88
  .amdhsa_user_sgpr_count 2
  .amdhsa_user_sgpr_kernarg_segment_ptr 1
  .amdhsa_system_sgpr_workgroup_id_x 1
.end_amdhsa_kernel
```

```asm
; @launch grid=(256,1,1) block=(512,1,1) lds=163840
.amdgcn_target "amdgcn-amd-amdhsa--gfx950"
.text
.globl recurrent_scan__sliding_local_dilated__moe_arch_mod__prompt_kernel
.p2align 8
.type recurrent_scan__sliding_local_dilated__moe_arch_mod__prompt_kernel,@function
recurrent_scan__sliding_local_dilated__moe_arch_mod__prompt_kernel:
    s_load_dwordx2 s[24:25], s[0:1], 0
    s_load_dwordx2 s[32:33], s[0:1], 8
    s_load_dwordx2 s[28:29], s[0:1], 80
    s_cmpk_ge_u32 s2, 256
    s_cbranch_scc1 K_EXIT
    v_readfirstlane_b32 s3, v0
    s_getpc_b64 s[20:21]
K_PC:
    s_lshr_b32 s54, s2, 3
    s_lshl_b32 s60, s54, 10
    v_lshl_add_u32 v2, v0, 1, s60
    global_load_ushort v255, v2, s[20:21]
    s_mul_i32 s60, s54, 52
    s_lshr_b32 s60, s60, 8
    s_mul_i32 s53, s60, 5
    s_sub_u32 s53, s54, s53
    s_add_u32 s67, s60, s53
    s_bitcmp1_b32 s2, 1
    s_cselect_b32 s61, 5, 0
    s_add_u32 s56, s60, s61
    s_mulk_i32 s56, 104
    s_sub_u32 s56, s56, 8
    s_and_b32 s57, s2, 4
    s_mulk_i32 s57, 320
    s_bitcmp1_b32 s2, 0
    s_cselect_b32 s61, 5, 0
    s_add_u32 s58, s53, s61
    s_lshl_b32 s58, s58, 7
    s_mov_b32 s26, 2621440
    s_mov_b32 s27, 0x20000
    s_lshr_b32 s60, s3, 3
    s_max_u32 s60, s60, s54
    s_cmp_ge_u32 s60, 25
    s_cbranch_scc1 K_NL
    v_lshrrev_b32 v2, 3, v0
    v_add_u32 v3, s56, v2
    v_mul_i32_i24 v3, 2560, v3
    v_bitop3_b32 v1, v0, v2, 7 bitop3:0x28
    v_lshl_add_u32 v196, v1, 4, v3
    v_and_b32 v3, 2, v2
    v_lshrrev_b32 v1, 1, v2
    v_and_or_b32 v3, v1, 4, v3
    v_bitop3_b32 v3, v0, v3, 7 bitop3:0x28
    v_mul_u32_u24 v200, 3840, v2
    v_lshl_add_u32 v200, v3, 4, v200
    s_cmp_ge_u32 s67, 5
    s_cselect_b32 s61, 5, 0
    s_sub_u32 s67, s67, s61
    s_lshl_b32 s67, s67, 2
    s_and_b32 s68, s2, 6
    s_mul_i32 s68, s68, 4
    s_lshr_b32 s68, s68, 2
    s_lshl_b32 s69, s3, 4
    s_mov_b32 s34, 2457600
    s_mov_b32 s35, s27
    s_cmp_eq_u32 s3, 0
    s_cselect_b32 s70, 0xffffff00, -1
    s_cmpk_lt_u32 s69, 2048
    s_cselect_b64 vcc, -1, 0
    s_lshr_b32 s64, 66064, s67
    s_and_b32 s64, s64, 15
    s_mul_i32 s65, s64, 245760
    s_lshl_b32 s64, s64, 7
    s_add_u32 s64, s64, s57
    s_add_u32 m0, s69, 77824
    s_mov_b32 exec_lo, s70
    s_waitcnt lgkmcnt(0)
    buffer_load_dwordx4 v196, s[24:27], s64 offen lds
    s_add_u32 m0, s69, 81920
    s_mov_b32 exec_lo, -1
    v_add_u32 v197, 81920, v196
    buffer_load_dwordx4 v197, s[24:27], s64 offen lds
    s_add_u32 m0, s69, 86016
    s_add_u32 s65, s65, s58
    v_add_u32 v198, 163840, v196
    buffer_load_dwordx4 v198, s[24:27], s64 offen lds
    v_add_u32 v199, 245760, v196
    s_cbranch_vccz L_SK0
    s_add_u32 m0, s69, 90112
    s_nop 0
    buffer_load_dwordx4 v199, s[24:27], s64 offen lds
L_SK0:
    s_add_u32 m0, s69, 92160
    s_add_u32 s66, s65, 122880
    buffer_load_dwordx4 v200, s[32:35], s65 offen offset:0 lds
    s_add_u32 m0, s69, 99072
    s_nop 0
    buffer_load_dwordx4 v200, s[32:35], s65 offen offset:1280 lds
    s_add_u32 m0, s69, 105984
    s_nop 0
    buffer_load_dwordx4 v200, s[32:35], s65 offen offset:2560 lds
    s_add_u32 m0, s69, 96256
    s_nop 0
    buffer_load_dwordx4 v200, s[32:35], s66 offen offset:0 lds
    s_add_u32 m0, s69, 103168
    s_nop 0
    buffer_load_dwordx4 v200, s[32:35], s66 offen offset:1280 lds
    s_add_u32 m0, s69, 110080
    s_nop 0
    buffer_load_dwordx4 v200, s[32:35], s66 offen offset:2560 lds
    s_branch L_CONT
K_NL:
    s_cmpk_ge_u32 s3, 256
    s_cbranch_scc1 K_ER
    s_sub_u32 s56, s2, 200
    s_mov_b32 s101, 1
    s_cmp_ge_u32 s56, 27
    s_cbranch_scc1 K_AUX
    s_load_dwordx2 s[48:49], s[0:1], 40
    s_load_dwordx2 s[36:37], s[0:1], 48
    v_lshrrev_b32 v2, 3, v0
    v_and_b32 v3, 2, v2
    v_lshrrev_b32 v1, 1, v2
    v_and_or_b32 v3, v1, 4, v3
    v_bitop3_b32 v3, v0, v3, 7 bitop3:0x28
    v_mul_u32_u24 v30, 3456, v2
    v_lshl_add_u32 v30, v3, 4, v30
    s_lshl_b32 s68, s56, 7
    s_lshl_b32 s69, s3, 4
    s_mov_b32 s70, 12
    s_mov_b32 s50, 2211840
    s_mov_b32 s51, 0x20000
    s_mov_b32 s38, 2211840
    s_mov_b32 s39, 0x20000
    s_waitcnt lgkmcnt(0)
FL_GU1:
    s_mov_b32 m0, s69
    s_sub_u32 s70, s70, 1
    buffer_load_dwordx4 v30, s[48:51], s68 offen nt lds
    s_add_u32 m0, s69, 16384
    s_add_u32 s69, s69, 4096
    buffer_load_dwordx4 v30, s[36:39], s68 offen nt lds
    s_add_u32 s68, s68, 110592
    s_and_b32 s60, s70, 3
    s_cselect_b32 s60, 0, 16384
    s_add_u32 s69, s69, s60
    s_cmp_lg_u32 s70, 0
    s_cbranch_scc1 FL_GU1
    s_mov_b32 s101, 5
    s_branch K_AUX
K_ER:
    s_setprio 3
    s_load_dwordx2 s[22:23], s[0:1], 32
    v_bfe_u32 v232, v0, 5, 3
    v_and_b32 v4, 31, v0
    v_mul_u32_u24 v7, 2560, v232
    v_lshlrev_b32 v5, 4, v4
    v_lshlrev_b32 v6, 3, v4
    v_add_u32 v8, v7, v6
    v_add_u32 v7, v7, v5
    s_and_b32 s68, s2, 3
    s_lshl_b32 s68, s68, 5
    s_add_u32 s68, s68, s54
    s_mul_i32 s69, s68, 20480
    s_add_u32 s69, s69, s57
    s_waitcnt lgkmcnt(0)
    buffer_load_dwordx4 v[212:215], v7, s[24:27], s69 offen
    buffer_load_dwordx4 v[216:219], v7, s[24:27], s69 offen offset:512
    buffer_load_dwordx2 v[220:221], v8, s[24:27], s69 offen offset:1024
    global_load_dwordx4 v[222:225], v5, s[22:23]
    global_load_dwordx4 v[226:229], v5, s[22:23] offset:512
    global_load_dwordx2 v[230:231], v6, s[22:23] offset:1024
    s_load_dword s52, s[28:29], 0
    s_mov_b32 s30, 7077888
    s_mov_b32 s31, 0x20000
    s_and_b32 s70, s2, 4
    s_lshl_b32 s70, s70, 5
    s_add_u32 s70, s70, s68
    s_lshl_b32 s71, s70, 6
    s_lshl_b32 s70, s70, 7
    s_add_u32 s70, s70, 16384
    s_add_u32 s71, s71, 49152
    s_setprio 0
    s_mov_b32 s101, 1
    s_cmp_ge_u32 s54, 25
    s_cbranch_scc1 K_AUX0
    s_mul_i32 s60, s3, 5
    s_lshl_b32 s61, s53, 6
    s_add_u32 s60, s60, s61
    s_add_u32 s60, s60, K_TAB-K_PC
    s_load_dwordx16 s[4:19], s[20:21], s60
    s_load_dwordx2 s[44:45], s[0:1], 64
    s_load_dwordx2 s[40:41], s[0:1], 16
    s_mov_b32 s46, 2621440
    s_mov_b32 s47, 0x20000
    s_mov_b32 s30, 7077888
    s_mov_b32 s31, 0x20000
    s_mov_b32 s42, 819200
    s_mov_b32 s43, 0x20000
    s_lshr_b32 s3, s3, 6
    s_and_b32 s59, s3, 3
    s_mov_b32 s55, 0xffff0000
    s_mov_b32 s100, 0
    v_and_b32 v1, 63, v0
    v_and_b32 v4, 15, v1
    v_lshrrev_b32 v5, 4, v1
    v_mov_b32 v19, 163584
    v_add_u32 v18, s3, v19
    v_mov_b32 v2, 0
    v_mov_b32 v3, 0
    v_mov_b32 v46, 0x00010100
    v_mov_b32 v47, 0x01000001
    ds_write2_b64 v19, v[2:3], v[46:47] offset1:1
    v_mov_b32 v45, 0x01010101
    ds_write2_b32 v19, v2, v45 offset0:4 offset1:5
    v_bfe_u32 v46, v0, 1, 7
    v_min_u32 v46, 111, v46
    v_mul_u32_u24 v46, 272, v46
    v_add_u32 v46, 116992, v46
    ds_write_b64 v46, v[2:3]
    s_min_u32 s60, s59, 2
    s_mul_i32 s60, s60, 38912
    v_and_b32 v46, 31, v0
    v_lshl_add_u32 v46, v46, 2, s60
    v_mov_b32 v47, 0x3f803f80
    ds_write_b32 v46, v47
    v_lshlrev_b32 v6, 4, v1
    v_mov_b32 v28, 0x3f803f80
    v_mov_b32 v29, 0x3f803f80
    v_mov_b32 v30, 0x3f803f80
    v_mov_b32 v31, 0x3f803f80
    v_lshlrev_b32 v2, 2, v5
    v_sub_u32 v3, v4, v2
    v_add_u32 v3, 12, v3
    s_mov_b32 s60, 267390975
    v_bfe_i32 v32, s60, v3, 1
    v_and_b32 v32, 0xff800000, v32
    s_mov_b32 s60, 268435440
    v_bfe_i32 v36, s60, v3, 1
    v_and_b32 v36, 0xff800000, v36
    s_mov_b32 s60, 266346495
    v_bfe_i32 v33, s60, v3, 1
    v_and_b32 v33, 0xff800000, v33
    s_mov_b32 s60, 268435424
    v_bfe_i32 v37, s60, v3, 1
    v_and_b32 v37, 0xff800000, v37
    s_mov_b32 s60, 264257535
    v_bfe_i32 v34, s60, v3, 1
    v_and_b32 v34, 0xff800000, v34
    s_mov_b32 s60, 268435392
    v_bfe_i32 v38, s60, v3, 1
    v_and_b32 v38, 0xff800000, v38
    s_mov_b32 s60, 260079615
    v_bfe_i32 v35, s60, v3, 1
    v_and_b32 v35, 0xff800000, v35
    s_mov_b32 s60, 268435328
    v_bfe_i32 v39, s60, v3, 1
    v_and_b32 v39, 0xff800000, v39
    v_sub_u32 v2, 13, v3
    v_med3_i32 v2, v2, 0, 2
    v_lshlrev_b32 v2, 3, v2
    v_mov_b32 v40, -1
    v_lshrrev_b32 v40, v2, v40
    v_lshrrev_b32 v40, v2, v40
    v_sub_u32 v2, 15, v3
    v_med3_i32 v2, v2, 0, 2
    v_lshlrev_b32 v2, 3, v2
    v_mov_b32 v41, -1
    v_lshrrev_b32 v41, v2, v41
    v_lshrrev_b32 v41, v2, v41
    v_mul_u32_u24 v25, 20224, v5
    v_add_u32 v25, v25, v6
    v_lshrrev_b32 v24, 5, v1
    v_mul_u32_u24 v24, 19968, v24
    v_add_u32 v24, v24, v6
    v_lshlrev_b32 v26, 4, v4
    v_add_u32 v26, 162568, v26
    v_bfe_u32 v2, v1, 2, 2
    v_lshlrev_b32 v2, 7, v2
    v_and_b32 v3, 8, v1
    v_lshl_add_u32 v2, v3, 2, v2
    v_and_b32 v3, 3, v1
    v_lshl_add_u32 v2, v3, 3, v2
    v_and_b32 v3, 48, v1
    s_mov_b32 s62, 0xffff
    s_mov_b32 s60, 201329216
    s_mov_b32 s61, 373298176
    v_lshrrev_b64 v[46:47], v3, s[60:61]
    v_and_or_b32 v9, v46, s62, v2
    s_mov_b32 s60, 37748736
    s_mov_b32 s61, 2550175296
    v_lshrrev_b64 v[46:47], v3, s[60:61]
    v_and_or_b32 v10, v46, s62, v2
    s_mov_b32 s60, 469766720
    s_mov_b32 s61, 977285120
    v_lshrrev_b64 v[46:47], v3, s[60:61]
    v_and_or_b32 v11, v46, s62, v2
    s_mov_b32 s60, 2483063360
    s_mov_b32 s61, 2654996480
    v_lshrrev_b64 v[46:47], v3, s[60:61]
    v_and_or_b32 v12, v46, s62, v2
    s_mov_b32 s60, 574627840
    s_mov_b32 s61, 2051045376
    v_lshrrev_b64 v[46:47], v3, s[60:61]
    v_and_or_b32 v13, v46, s62, v2
    s_mov_b32 s60, 1073757184
    s_mov_b32 s61, 1610635840
    v_lshrrev_b64 v[46:47], v3, s[60:61]
    v_and_or_b32 v14, v46, s62, v2
    s_mov_b32 s60, 1140858432
    s_mov_b32 s61, 2147507776
    v_lshrrev_b64 v[46:47], v3, s[60:61]
    v_and_or_b32 v15, v46, s62, v2
    v_lshrrev_b32 v2, 3, v1
    v_bitop3_b32 v3, v1, v2, 7 bitop3:0x28
    v_mul_u32_u24 v7, 2560, v2
    v_lshl_add_u32 v7, v3, 4, v7
    v_lshrrev_b32 v2, 5, v1
    v_bitop3_b32 v2, v2, v4, 7 bitop3:0x28
    v_lshlrev_b32 v8, 7, v4
    v_lshl_add_u32 v8, v2, 4, v8
    v_and_b32 v2, 1, v5
    v_lshl_add_u32 v8, v2, 3, v8
    v_bfe_u32 v2, v0, 3, 5
    v_and_b32 v3, 6, v2
    v_bitop3_b32 v3, v0, v3, 7 bitop3:0x28
    v_mul_u32_u24 v16, 1280, v2
    v_lshl_add_u32 v16, v3, 4, v16
    s_lshl_b32 s98, s56, 4
    s_mul_i32 s60, s57, 13
    s_add_u32 s98, s98, s60
    s_add_u32 s98, s98, 458880
    s_add_u32 s98, s98, s58
    s_cmp_eq_u32 s59, 0
    s_cselect_b32 s98, s98, 2146435072
    s_add_u32 s96, s56, 8
    s_mulk_i32 s96, 1408
    s_mul_i32 s60, s57, 1144
    s_add_u32 s96, s96, s60
    s_add_u32 s96, s96, 1048576
    s_and_b32 s62, s2, 1
    s_mulk_i32 s62, 10240
    s_add_u32 s62, s62, s96
    s_sub_u32 s63, s54, s53
    s_and_b32 s60, s2, 7
    s_mul_i32 s60, s60, 25
    s_add_u32 s63, s63, s60
    s_mulk_i32 s63, 11520
    s_add_u32 s63, s63, 4194304
    v_mul_u32_u24 v2, 272, v4
    v_add_u32 v2, 129792, v2
    v_lshlrev_b32 v3, 3, v5
    s_waitcnt lgkmcnt(0)
    s_mul_i32 s52, s52, 0x9E3779B1
    s_add_u32 s52, s52, 0x7F4A7C15
    s_or_b32 s52, s52, 1
    v_mov_b32 v46, s52
    ds_write_b32 v19, v46 offset:32
    v_bfe_u32 v20, s4, v3, 8
    v_bfe_u32 v21, s5, v3, 8
    v_add_u32 v20, v20, v2
    v_add_u32 v21, v21, v2
    v_lshrrev_b32 v2, 2, v1
    v_mul_u32_u24 v2, 136, v2
    v_add_u32 v2, 88448, v2
    v_add_u32 v23, s7, v2
    v_lshlrev_b32 v3, 3, v1
    v_bfe_u32 v22, s6, v3, 8
    v_add_u32 v22, v22, v2
    s_add_u32 s9, s9, s62
    s_add_u32 s10, s10, s62
    s_add_u32 s11, s11, s63
    s_add_u32 s12, s12, s63
    s_add_u32 s5, s9, 40960
    s_mul_i32 s60, s8, 20480
    s_add_u32 s96, s96, s60
    s_lshl4_add_u32 s95, s8, s56
    s_cmp_eq_u32 s8, 6
    s_cselect_b32 s101, 1, 2
    s_cmpk_ge_i32 s95, 1024
    s_cselect_b32 s101, 0, s101
    s_mul_i32 s97, s95, 2560
    s_add_u32 s97, s97, s57
    s_add_u32 s97, s97, s58
    s_add_u32 s94, s97, 20480
    s_cmp_eq_u32 s8, 0
    s_cselect_b32 s97, 2146435072, s97
    s_cselect_b32 s61, 2146435072, 0
    s_and_b32 s60, s53, 2
    s_mul_i32 s22, s60, 204800
    s_sub_u32 s23, 409600, s22
    s_add_u32 s22, s22, s58
    s_add_u32 s23, s23, s58
    s_mulk_i32 s60, 5120
    s_sub_u32 s4, s96, s60
    s_add_u32 s4, s4, 10240
    s_add_u32 s96, s96, s60
    s_add_u32 s92, s96, 4096
    s_add_u32 s93, s92, 4096
    s_add_u32 s6, s4, 4096
    s_add_u32 s7, s6, 4096
    v_bfe_i32 v2, v1, 3, 1
    v_bfi_b32 v2, v2, 0, s61
    v_or_b32 v27, v2, v6
    s_and_b32 s60, s2, 4
    s_lshl_b32 s60, s60, 8
    s_add_u32 s95, s95, s60
    s_lshl_b32 s60, s8, 11
    s_add_u32 s60, s60, 147200
    v_add_u32 v8, s60, v8
    s_lshl_b32 s60, s8, 8
    s_add_u32 s60, s60, 161536
    v_lshl_add_u32 v17, v4, 4, s60
    v_bitop3_b32 v2, v5, v4, 7 bitop3:0x28
    v_lshlrev_b32 v2, 4, v2
    v_lshl_add_u32 v42, v4, 7, v2
    v_add_u32 v42, 77824, v42
    v_xor_b32 v43, 64, v42
    v_bfe_u32 v2, v1, 3, 2
    v_xor_b32 v2, s59, v2
    v_lshlrev_b32 v2, 5, v2
    v_lshl_add_u32 v2, v5, 10, v2
    v_bfe_u32 v3, v1, 2, 2
    v_lshl_add_u32 v2, v3, 7, v2
    v_and_b32 v3, 3, v1
    v_lshl_add_u32 v2, v3, 3, v2
    v_add_u32 v44, 92160, v2
    s_lshl_b32 s60, s59, 5
    s_add_u32 s60, s60, 116736
    v_mul_u32_u24 v46, 272, v4
    v_lshl_add_u32 v2, v5, 3, s60
    v_add_u32 v46, v46, v2
    v_mul_u32_u24 v47, 136, v4
    v_add_u32 v47, v47, v2
    v_subrev_u32 v47, 34816, v47
    v_lshlrev_b32 v45, 4, v4
    v_add_u32 v45, 161536, v45
    v_mov_b32 v48, 0
    v_mov_b32 v49, 0
    v_mov_b32 v50, 0
    v_mov_b32 v51, 0
    v_mov_b32 v52, 0
    v_mov_b32 v53, 0
    v_mov_b32 v54, 0
    v_mov_b32 v55, 0
    v_mov_b32 v56, 0
    v_mov_b32 v57, 0
    v_mov_b32 v58, 0
    v_mov_b32 v59, 0
    v_mov_b32 v60, 0
    v_mov_b32 v61, 0
    v_mov_b32 v62, 0
    v_mov_b32 v63, 0
    v_mov_b32 v64, 0
    v_mov_b32 v65, 0
    v_mov_b32 v66, 0
    v_mov_b32 v67, 0
    v_mov_b32 v68, 0
    v_mov_b32 v69, 0
    v_mov_b32 v70, 0
    v_mov_b32 v71, 0
    v_mov_b32 v72, 0
    v_mov_b32 v73, 0
    v_mov_b32 v74, 0
    v_mov_b32 v75, 0
    v_mov_b32 v76, 0
    v_mov_b32 v77, 0
    v_mov_b32 v78, 0
    v_mov_b32 v79, 0
    v_mov_b32 v80, 0
    v_mov_b32 v81, 0
    v_mov_b32 v82, 0
    v_mov_b32 v83, 0
    v_mov_b32 v84, 0
    v_mov_b32 v85, 0
    v_mov_b32 v86, 0
    v_mov_b32 v87, 0
    v_mov_b32 v88, 0
    v_mov_b32 v89, 0
    v_mov_b32 v90, 0
    v_mov_b32 v91, 0
    v_mov_b32 v92, 0
    v_mov_b32 v93, 0
    v_mov_b32 v94, 0
    v_mov_b32 v95, 0
    v_mov_b32 v96, 0
    v_mov_b32 v97, 0
    v_mov_b32 v98, 0
    v_mov_b32 v99, 0
    v_mov_b32 v100, 0
    v_mov_b32 v101, 0
    v_mov_b32 v102, 0
    v_mov_b32 v103, 0
    v_mov_b32 v104, 0
    v_mov_b32 v105, 0
    v_mov_b32 v106, 0
    v_mov_b32 v107, 0
    v_mov_b32 v108, 0
    v_mov_b32 v109, 0
    v_mov_b32 v110, 0
    v_mov_b32 v111, 0
    v_mov_b32 v112, 0
    v_mov_b32 v113, 0
    v_mov_b32 v114, 0
    v_mov_b32 v115, 0
    v_mov_b32 v116, 0
    v_mov_b32 v117, 0
    v_mov_b32 v118, 0
    v_mov_b32 v119, 0
    v_mov_b32 v120, 0
    v_mov_b32 v121, 0
    v_mov_b32 v122, 0
    v_mov_b32 v123, 0
    v_mov_b32 v124, 0
    v_mov_b32 v125, 0
    v_mov_b32 v126, 0
    v_mov_b32 v127, 0
    v_mov_b32 v128, 0
    v_mov_b32 v129, 0
    v_mov_b32 v130, 0
    v_mov_b32 v131, 0
    s_mov_b64 exec, 0
    s_branch TL0
TL0_END:
    s_mov_b64 exec, -1
    v_mov_b32 v241, 0x3f803f80
    v_mov_b32 v245, s52
    v_mov_b32 v247, s52
    s_bfe_u32 s60, s2, 0x10002
    s_lshl4_add_u32 s60, s68, s60
    s_sub_u32 s60, 0xffff, s60
    v_lshlrev_b32 v239, 1, v232
    v_sub_u32 v239, s60, v239
    v_lshlrev_b32 v243, 3, v232
    v_lshlrev_b32 v232, 4, v232
    v_mov_b32 v249, s52
    s_setprio 3
    s_waitcnt vmcnt(3)
    v_dot2_f32_bf16 v233, v212, v241, 0
    v_dot2_f32_bf16 v234, v212, v212, 0
    v_dot2_f32_bf16 v233, v213, v241, v233
    v_dot2_f32_bf16 v234, v213, v213, v234
    v_dot2_f32_bf16 v233, v214, v241, v233
    v_dot2_f32_bf16 v234, v214, v214, v234
    v_dot2_f32_bf16 v233, v215, v241, v233
    v_dot2_f32_bf16 v234, v215, v215, v234
    v_dot2_f32_bf16 v233, v216, v241, v233
    v_dot2_f32_bf16 v234, v216, v216, v234
    v_dot2_f32_bf16 v233, v217, v241, v233
    v_dot2_f32_bf16 v234, v217, v217, v234
    v_dot2_f32_bf16 v233, v218, v241, v233
    v_dot2_f32_bf16 v234, v218, v218, v234
    v_dot2_f32_bf16 v233, v219, v241, v233
    v_dot2_f32_bf16 v234, v219, v219, v234
    v_dot2_f32_bf16 v233, v220, v241, v233
    v_dot2_f32_bf16 v234, v220, v220, v234
    v_dot2_f32_bf16 v233, v221, v241, v233
    v_dot2_f32_bf16 v234, v221, v221, v234
    s_waitcnt vmcnt(0)
    v_dot2_f32_bf16 v235, v212, v222, 0
    v_dot2_f32_bf16 v236, v222, v241, 0
    v_dot2_f32_bf16 v235, v213, v223, v235
    v_dot2_f32_bf16 v236, v223, v241, v236
    v_dot2_f32_bf16 v235, v214, v224, v235
    v_dot2_f32_bf16 v236, v224, v241, v236
    v_dot2_f32_bf16 v235, v215, v225, v235
    v_dot2_f32_bf16 v236, v225, v241, v236
    v_dot2_f32_bf16 v235, v216, v226, v235
    v_dot2_f32_bf16 v236, v226, v241, v236
    v_dot2_f32_bf16 v235, v217, v227, v235
    v_dot2_f32_bf16 v236, v227, v241, v236
    v_dot2_f32_bf16 v235, v218, v228, v235
    v_dot2_f32_bf16 v236, v228, v241, v236
    v_dot2_f32_bf16 v235, v219, v229, v235
    v_dot2_f32_bf16 v236, v229, v241, v236
    v_dot2_f32_bf16 v235, v220, v230, v235
    v_dot2_f32_bf16 v236, v230, v241, v236
    v_dot2_f32_bf16 v235, v221, v231, v235
    v_dot2_f32_bf16 v236, v231, v241, v236
    v_permlane16_swap_b32 v233, v234
    v_add_f32 v233, v233, v234
    s_nop 0
    v_permlane16_swap_b32 v235, v236
    v_add_f32 v235, v235, v236
    v_add_f32_dpp v233, v233, v233 row_ror:8 row_mask:0xf bank_mask:0xf
    s_nop 0
    v_add_f32_dpp v235, v235, v235 row_ror:8 row_mask:0xf bank_mask:0xf
    v_add_f32_dpp v233, v233, v233 row_ror:4 row_mask:0xf bank_mask:0xf
    s_nop 0
    v_add_f32_dpp v235, v235, v235 row_ror:4 row_mask:0xf bank_mask:0xf
    v_add_f32_dpp v233, v233, v233 row_ror:2 row_mask:0xf bank_mask:0xf
    s_nop 0
    v_add_f32_dpp v235, v235, v235 row_ror:2 row_mask:0xf bank_mask:0xf
    v_add_f32_dpp v233, v233, v233 row_ror:1 row_mask:0xf bank_mask:0xf
    s_nop 0
    v_add_f32_dpp v235, v235, v235 row_ror:1 row_mask:0xf bank_mask:0xf
    v_mul_f32 v233, 0x3acccccd, v233
    v_mov_b32 v236, v235
    v_mov_b32 v234, v233
    s_nop 0
    v_permlane16_swap_b32 v235, v236
    v_permlane16_swap_b32 v233, v234
    v_fma_f32 v234, -v233, v233, v234
    v_max_f32 v234, 0, v234
    v_cvt_pk_bf16_f32 v237, v233, v234
    v_lshlrev_b32 v233, 16, v237
    v_and_b32 v234, 0xffff0000, v237
    v_add_f32 v234, 0x3727c5ac, v234
    v_cvt_pk_bf16_f32 v234, v234, v234
    v_lshlrev_b32 v234, 16, v234
    v_sqrt_f32 v234, v234
    v_fma_f32 v235, -v233, v236, v235
    v_cvt_pk_bf16_f32 v234, v234, v234
    v_lshlrev_b32 v234, 16, v234
    v_rcp_f32 v246, v234
    s_mov_b32 exec_lo, 1
    s_mov_b32 exec_hi, 1
    v_mul_f32 v235, v235, v246
    v_xor_b32 v244, 0x80000000, v233
    v_cvt_pk_bf16_f32 v235, v235, v235
    buffer_store_dwordx4 v[244:247], v232, s[28:31], s70 offen sc1
    v_ashrrev_i32 v237, 31, v235
    v_or_b32 v237, 0x80000000, v237
    v_xor_b32 v235, v235, v237
    v_bfi_b32 v248, s55, v235, v239
    buffer_store_dwordx2 v[248:249], v243, s[28:31], s71 offen sc1
    s_mov_b64 exec, -1
    s_setprio 0
    v_mov_b32 v252, s52
    v_mov_b32 v253, s52
    v_mov_b32 v254, s52
    v_mov_b32 v255, s52
    s_mov_b32 s63, 0
    s_mov_b32 s64, 77824
    s_mov_b32 s67, 38912
    s_waitcnt lgkmcnt(0)
    s_barrier
    ds_read_b64_tr_b16 v[132:133], v44 offset:0
    ds_read_b64_tr_b16 v[134:135], v44 offset:512
    ds_read_b128 v[156:159], v42 offset:0
    ds_read_b64_tr_b16 v[136:137], v44 offset:8192
    ds_read_b64_tr_b16 v[138:139], v44 offset:8704
    ds_read_b128 v[160:163], v42 offset:2048
    ds_read_b64_tr_b16 v[140:141], v44 offset:16384
    ds_read_b64_tr_b16 v[142:143], v44 offset:16896
    ds_read_b128 v[164:167], v42 offset:4096
    ds_read_b128 v[168:171], v42 offset:6144
    ds_read_b128 v[172:175], v42 offset:8192
    ds_read_b128 v[176:179], v42 offset:10240
    ds_read_b128 v[180:183], v42 offset:12288
C_LOOP:
    s_waitcnt lgkmcnt(10)
    v_mfma_f32_16x16x32_bf16 v[48:51], v[132:135], v[156:159], v[48:51]
    ds_read_b64_tr_b16 v[144:145], v44 offset:4096
    s_waitcnt lgkmcnt(9)
    v_mfma_f32_16x16x32_bf16 v[76:79], v[136:139], v[156:159], v[76:79]
    ds_read_b64_tr_b16 v[146:147], v44 offset:4608
    s_waitcnt lgkmcnt(9)
    v_mfma_f32_16x16x32_bf16 v[52:55], v[132:135], v[160:163], v[52:55]
    ds_read_b128 v[184:187], v43 offset:0
    v_mfma_f32_16x16x32_bf16 v[80:83], v[136:139], v[160:163], v[80:83]
    ds_read_b64_tr_b16 v[148:149], v44 offset:12288
    s_waitcnt lgkmcnt(9)
    v_mfma_f32_16x16x32_bf16 v[104:107], v[140:143], v[156:159], v[104:107]
    ds_read_b64_tr_b16 v[150:151], v44 offset:12800
    v_mfma_f32_16x16x32_bf16 v[108:111], v[140:143], v[160:163], v[108:111]
    ds_read_b128 v[188:191], v43 offset:2048
    s_waitcnt lgkmcnt(10)
    v_mfma_f32_16x16x32_bf16 v[56:59], v[132:135], v[164:167], v[56:59]
    ds_read_b64_tr_b16 v[152:153], v44 offset:20480
    v_mfma_f32_16x16x32_bf16 v[84:87], v[136:139], v[164:167], v[84:87]
    ds_read_b64_tr_b16 v[154:155], v44 offset:20992
    v_mfma_f32_16x16x32_bf16 v[112:115], v[140:143], v[164:167], v[112:115]
    ds_read_b128 v[192:195], v43 offset:4096
    s_waitcnt lgkmcnt(12)
    v_mfma_f32_16x16x32_bf16 v[60:63], v[132:135], v[168:171], v[60:63]
    ds_read_b128 v[196:199], v43 offset:6144
    v_mfma_f32_16x16x32_bf16 v[88:91], v[136:139], v[168:171], v[88:91]
    ds_read_b128 v[200:203], v43 offset:8192
    v_mfma_f32_16x16x32_bf16 v[116:119], v[140:143], v[168:171], v[116:119]
    ds_read_b128 v[204:207], v43 offset:10240
    s_waitcnt lgkmcnt(14)
    v_mfma_f32_16x16x32_bf16 v[64:67], v[132:135], v[172:175], v[64:67]
    ds_read_b128 v[208:211], v43 offset:12288
    v_mfma_f32_16x16x32_bf16 v[92:95], v[136:139], v[172:175], v[92:95]
    v_mfma_f32_16x16x32_bf16 v[120:123], v[140:143], v[172:175], v[120:123]
    s_cmp_eq_u32 s64, 77824
    s_cselect_b32 s66, 4294889472, s67
    s_waitcnt lgkmcnt(14)
    v_mfma_f32_16x16x32_bf16 v[68:71], v[132:135], v[176:179], v[68:71]
    s_add_u32 s64, s64, s66
    s_add_u32 s63, s63, 1
    v_mfma_f32_16x16x32_bf16 v[96:99], v[136:139], v[176:179], v[96:99]
    v_add_u32 v44, s66, v44
    v_mfma_f32_16x16x32_bf16 v[124:127], v[140:143], v[176:179], v[124:127]
    v_add_u32 v42, s66, v42
    s_waitcnt lgkmcnt(13)
    v_mfma_f32_16x16x32_bf16 v[72:75], v[132:135], v[180:183], v[72:75]
    v_add_u32 v43, s66, v43
    v_mfma_f32_16x16x32_bf16 v[100:103], v[136:139], v[180:183], v[100:103]
    s_cmp_lt_u32 s63, 9
    v_mfma_f32_16x16x32_bf16 v[128:131], v[140:143], v[180:183], v[128:131]
    s_waitcnt lgkmcnt(0)
    v_mfma_f32_16x16x32_bf16 v[48:51], v[144:147], v[184:187], v[48:51]
    v_mfma_f32_16x16x32_bf16 v[76:79], v[148:151], v[184:187], v[76:79]
    v_mfma_f32_16x16x32_bf16 v[104:107], v[152:155], v[184:187], v[104:107]
    v_mfma_f32_16x16x32_bf16 v[52:55], v[144:147], v[188:191], v[52:55]
    v_mfma_f32_16x16x32_bf16 v[80:83], v[148:151], v[188:191], v[80:83]
    v_mfma_f32_16x16x32_bf16 v[108:111], v[152:155], v[188:191], v[108:111]
    s_barrier
    ds_read_b64_tr_b16 v[132:133], v44 offset:0
    v_mfma_f32_16x16x32_bf16 v[56:59], v[144:147], v[192:195], v[56:59]
    ds_read_b64_tr_b16 v[134:135], v44 offset:512
    v_mfma_f32_16x16x32_bf16 v[84:87], v[148:151], v[192:195], v[84:87]
    ds_read_b128 v[156:159], v42 offset:0
    v_mfma_f32_16x16x32_bf16 v[112:115], v[152:155], v[192:195], v[112:115]
    ds_read_b64_tr_b16 v[136:137], v44 offset:8192
    v_mfma_f32_16x16x32_bf16 v[60:63], v[144:147], v[196:199], v[60:63]
    ds_read_b64_tr_b16 v[138:139], v44 offset:8704
    v_mfma_f32_16x16x32_bf16 v[88:91], v[148:151], v[196:199], v[88:91]
    ds_read_b128 v[160:163], v42 offset:2048
    v_mfma_f32_16x16x32_bf16 v[116:119], v[152:155], v[196:199], v[116:119]
    ds_read_b64_tr_b16 v[140:141], v44 offset:16384
    v_mfma_f32_16x16x32_bf16 v[64:67], v[144:147], v[200:203], v[64:67]
    ds_read_b64_tr_b16 v[142:143], v44 offset:16896
    v_mfma_f32_16x16x32_bf16 v[92:95], v[148:151], v[200:203], v[92:95]
    ds_read_b128 v[164:167], v42 offset:4096
    v_mfma_f32_16x16x32_bf16 v[120:123], v[152:155], v[200:203], v[120:123]
    ds_read_b128 v[168:171], v42 offset:6144
    v_mfma_f32_16x16x32_bf16 v[68:71], v[144:147], v[204:207], v[68:71]
    ds_read_b128 v[172:175], v42 offset:8192
    v_mfma_f32_16x16x32_bf16 v[96:99], v[148:151], v[204:207], v[96:99]
    ds_read_b128 v[176:179], v42 offset:10240
    v_mfma_f32_16x16x32_bf16 v[124:127], v[152:155], v[204:207], v[124:127]
    ds_read_b128 v[180:183], v42 offset:12288
    v_mfma_f32_16x16x32_bf16 v[72:75], v[144:147], v[208:211], v[72:75]
    v_mfma_f32_16x16x32_bf16 v[100:103], v[148:151], v[208:211], v[100:103]
    v_mfma_f32_16x16x32_bf16 v[128:131], v[152:155], v[208:211], v[128:131]
    s_cbranch_scc1 C_LOOP
TL0:
    s_cbranch_execz TL0_END
    s_setprio 2
    s_waitcnt lgkmcnt(10)
    v_mfma_f32_16x16x32_bf16 v[48:51], v[132:135], v[156:159], v[48:51]
    ds_read_b64_tr_b16 v[144:145], v44 offset:4096
    s_waitcnt lgkmcnt(9)
    v_mfma_f32_16x16x32_bf16 v[76:79], v[136:139], v[156:159], v[76:79]
    ds_read_b64_tr_b16 v[146:147], v44 offset:4608
    s_waitcnt lgkmcnt(9)
    v_mfma_f32_16x16x32_bf16 v[52:55], v[132:135], v[160:163], v[52:55]
    ds_read_b64_tr_b16 v[148:149], v44 offset:12288
    v_mfma_f32_16x16x32_bf16 v[80:83], v[136:139], v[160:163], v[80:83]
    ds_read_b64_tr_b16 v[150:151], v44 offset:12800
    s_waitcnt lgkmcnt(8)
    v_mfma_f32_16x16x32_bf16 v[56:59], v[132:135], v[164:167], v[56:59]
    ds_read_b128 v[184:187], v43 offset:0
    v_mfma_f32_16x16x32_bf16 v[84:87], v[136:139], v[164:167], v[84:87]
    ds_read_b128 v[188:191], v43 offset:2048
    s_waitcnt lgkmcnt(9)
    v_mfma_f32_16x16x32_bf16 v[60:63], v[132:135], v[168:171], v[60:63]
    ds_read_b128 v[192:195], v43 offset:4096
    v_mfma_f32_16x16x32_bf16 v[88:91], v[136:139], v[168:171], v[88:91]
    ds_read_b128 v[196:199], v43 offset:6144
    s_waitcnt lgkmcnt(10)
    v_mfma_f32_16x16x32_bf16 v[64:67], v[132:135], v[172:175], v[64:67]
    ds_read_b128 v[200:203], v43 offset:8192
    v_mfma_f32_16x16x32_bf16 v[92:95], v[136:139], v[172:175], v[92:95]
    ds_read_b128 v[204:207], v43 offset:10240
    s_waitcnt lgkmcnt(11)
    v_mfma_f32_16x16x32_bf16 v[68:71], v[132:135], v[176:179], v[68:71]
    ds_read_b128 v[208:211], v43 offset:12288
    v_mfma_f32_16x16x32_bf16 v[96:99], v[136:139], v[176:179], v[96:99]
    ds_read_b128 v[212:215], v45 offset:0
    s_waitcnt lgkmcnt(12)
    v_mfma_f32_16x16x32_bf16 v[72:75], v[132:135], v[180:183], v[72:75]
    ds_read_b128 v[216:219], v45 offset:256
    v_mfma_f32_16x16x32_bf16 v[100:103], v[136:139], v[180:183], v[100:103]
    ds_read_b128 v[220:223], v45 offset:512
    s_waitcnt lgkmcnt(7)
    v_mfma_f32_16x16x32_bf16 v[48:51], v[144:147], v[184:187], v[48:51]
    ds_read_b64_tr_b16 v[152:153], v44 offset:20480
    v_mfma_f32_16x16x32_bf16 v[76:79], v[148:151], v[184:187], v[76:79]
    ds_read_b64_tr_b16 v[154:155], v44 offset:20992
    v_mfma_f32_16x16x32_bf16 v[52:55], v[144:147], v[188:191], v[52:55]
    ds_read_b128 v[224:227], v45 offset:768
    s_waitcnt lgkmcnt(3)
    v_mfma_f32_16x16x32_bf16 v[80:83], v[148:151], v[188:191], v[80:83]
    ds_read_b128 v[228:231], v45 offset:1024
    v_mov_b32_dpp v240, v48 row_newbcast:0 row_mask:0xf bank_mask:0xf
    v_mov_b32_dpp v241, v49 row_newbcast:0 row_mask:0xf bank_mask:0xf
    v_mfma_f32_16x16x32_bf16 v[56:59], v[144:147], v[192:195], v[56:59]
    ds_read_b128 v[232:235], v45 offset:1280
    v_mov_b32_dpp v242, v50 row_newbcast:0 row_mask:0xf bank_mask:0xf
    v_mov_b32_dpp v243, v51 row_newbcast:0 row_mask:0xf bank_mask:0xf
    v_mfma_f32_16x16x32_bf16 v[84:87], v[148:151], v[192:195], v[84:87]
    ds_read_b128 v[236:239], v45 offset:1536
    v_mov_b32_dpp v244, v76 row_newbcast:0 row_mask:0xf bank_mask:0xf
    v_mov_b32_dpp v245, v77 row_newbcast:0 row_mask:0xf bank_mask:0xf
    v_mfma_f32_16x16x32_bf16 v[60:63], v[144:147], v[196:199], v[60:63]
    v_mov_b32_dpp v246, v78 row_newbcast:0 row_mask:0xf bank_mask:0xf
    v_mov_b32_dpp v247, v79 row_newbcast:0 row_mask:0xf bank_mask:0xf
    v_mfma_f32_16x16x32_bf16 v[88:91], v[148:151], v[196:199], v[88:91]
    v_fmac_f32 v48, v212, v240
    v_fmac_f32 v49, v212, v241
    v_mfma_f32_16x16x32_bf16 v[64:67], v[144:147], v[200:203], v[64:67]
    v_fmac_f32 v50, v212, v242
    v_fmac_f32 v51, v212, v243
    s_waitcnt lgkmcnt(0)
    v_mfma_f32_16x16x32_bf16 v[92:95], v[148:151], v[200:203], v[92:95]
    v_cvt_pk_bf16_f32 v48, v48, v49
    v_cvt_pk_bf16_f32 v49, v50, v51
    v_mfma_f32_16x16x32_bf16 v[68:71], v[144:147], v[204:207], v[68:71]
    ds_write_b64 v46, v[48:49] offset:128
    v_fmac_f32 v76, v212, v244
    v_mfma_f32_16x16x32_bf16 v[96:99], v[148:151], v[204:207], v[96:99]
    v_fmac_f32 v77, v212, v245
    v_fmac_f32 v78, v212, v246
    v_mfma_f32_16x16x32_bf16 v[72:75], v[144:147], v[208:211], v[72:75]
    s_mov_b64 exec, 0xff
    buffer_store_dwordx4 v[252:255], v6, s[28:31], s98 offen sc1
    s_mov_b64 exec, -1
    v_fmac_f32 v79, v212, v247
    v_mul_f32 v76, v76, v214
    v_mfma_f32_16x16x32_bf16 v[100:103], v[148:151], v[208:211], v[100:103]
    v_mul_f32 v77, v77, v214
    v_mul_f32 v78, v78, v214
    v_mfma_f32_16x16x32_bf16 v[104:107], v[140:143], v[156:159], v[104:107]
    v_mul_f32 v79, v79, v214
    v_cvt_pk_bf16_f32 v76, v76, v77
    v_mfma_f32_16x16x32_bf16 v[108:111], v[140:143], v[160:163], v[108:111]
    v_cvt_pk_bf16_f32 v77, v78, v79
    ds_write_b64 v46, v[76:77] offset:0
    v_mfma_f32_16x16x32_bf16 v[104:107], v[152:155], v[184:187], v[104:107]
    v_fmac_f32 v52, v216, v240
    v_fmac_f32 v53, v216, v241
    v_mfma_f32_16x16x32_bf16 v[108:111], v[152:155], v[188:191], v[108:111]
    v_fmac_f32 v54, v216, v242
    v_fmac_f32 v55, v216, v243
    v_mfma_f32_16x16x32_bf16 v[112:115], v[140:143], v[164:167], v[112:115]
    v_cvt_pk_bf16_f32 v52, v52, v53
    v_cvt_pk_bf16_f32 v53, v54, v55
    v_mfma_f32_16x16x32_bf16 v[116:119], v[140:143], v[168:171], v[116:119]
    ds_write_b64 v46, v[52:53] offset:4480
    v_fmac_f32 v80, v216, v244
    v_mfma_f32_16x16x32_bf16 v[112:115], v[152:155], v[192:195], v[112:115]
    v_fmac_f32 v81, v216, v245
    v_fmac_f32 v82, v216, v246
    v_mfma_f32_16x16x32_bf16 v[116:119], v[152:155], v[196:199], v[116:119]
    v_fmac_f32 v83, v216, v247
    v_mul_f32 v80, v80, v218
    v_mfma_f32_16x16x32_bf16 v[120:123], v[140:143], v[172:175], v[120:123]
    v_mul_f32 v81, v81, v218
    v_mul_f32 v82, v82, v218
    v_mfma_f32_16x16x32_bf16 v[124:127], v[140:143], v[176:179], v[124:127]
    v_mul_f32 v83, v83, v218
    v_cvt_pk_bf16_f32 v80, v80, v81
    v_mfma_f32_16x16x32_bf16 v[120:123], v[152:155], v[200:203], v[120:123]
    v_cvt_pk_bf16_f32 v81, v82, v83
    ds_write_b64 v46, v[80:81] offset:4352
    v_mfma_f32_16x16x32_bf16 v[124:127], v[152:155], v[204:207], v[124:127]
    v_fmac_f32 v56, v220, v240
    v_fmac_f32 v57, v220, v241
    v_mfma_f32_16x16x32_bf16 v[128:131], v[140:143], v[180:183], v[128:131]
    v_fmac_f32 v58, v220, v242
    v_fmac_f32 v59, v220, v243
    v_mfma_f32_16x16x32_bf16 v[128:131], v[152:155], v[208:211], v[128:131]
    v_cvt_pk_bf16_f32 v56, v56, v57
    v_cvt_pk_bf16_f32 v57, v58, v59
    ds_write_b64 v46, v[56:57] offset:8832
    v_fmac_f32 v84, v220, v244
    v_fmac_f32 v85, v220, v245
    v_fmac_f32 v86, v220, v246
    v_fmac_f32 v87, v220, v247
    v_mul_f32 v84, v84, v222
    v_mul_f32 v85, v85, v222
    v_mul_f32 v86, v86, v222
    v_mul_f32 v87, v87, v222
    v_cvt_pk_bf16_f32 v84, v84, v85
    v_cvt_pk_bf16_f32 v85, v86, v87
    ds_write_b64 v46, v[84:85] offset:8704
    v_pk_fma_f32 v[88:89], v[224:225], v[244:245], v[88:89] op_sel_hi:[0,1,1]
    v_pk_fma_f32 v[90:91], v[224:225], v[246:247], v[90:91] op_sel_hi:[0,1,1]
    v_pk_fma_f32 v[60:61], v[224:225], v[240:241], v[60:61] op_sel_hi:[0,1,1]
    v_pk_fma_f32 v[62:63], v[224:225], v[242:243], v[62:63] op_sel_hi:[0,1,1]
    v_pk_mul_f32 v[88:89], v[88:89], v[226:227] op_sel_hi:[1,0]
    v_pk_mul_f32 v[90:91], v[90:91], v[226:227] op_sel_hi:[1,0]
    v_cvt_pk_bf16_f32 v60, v60, v61
    v_cvt_pk_bf16_f32 v61, v62, v63
    ds_write_b64 v46, v[60:61] offset:13184
    v_cvt_pk_bf16_f32 v88, v88, v89
    v_cvt_pk_bf16_f32 v89, v90, v91
    ds_write_b64 v46, v[88:89] offset:13056
    v_pk_fma_f32 v[92:93], v[228:229], v[244:245], v[92:93] op_sel_hi:[0,1,1]
    v_pk_fma_f32 v[94:95], v[228:229], v[246:247], v[94:95] op_sel_hi:[0,1,1]
    v_pk_fma_f32 v[64:65], v[228:229], v[240:241], v[64:65] op_sel_hi:[0,1,1]
    v_pk_fma_f32 v[66:67], v[228:229], v[242:243], v[66:67] op_sel_hi:[0,1,1]
    v_pk_mul_f32 v[92:93], v[92:93], v[230:231] op_sel_hi:[1,0]
    v_pk_mul_f32 v[94:95], v[94:95], v[230:231] op_sel_hi:[1,0]
    v_cvt_pk_bf16_f32 v64, v64, v65
    v_cvt_pk_bf16_f32 v65, v66, v67
    ds_write_b64 v46, v[64:65] offset:17536
    v_cvt_pk_bf16_f32 v92, v92, v93
    v_cvt_pk_bf16_f32 v93, v94, v95
    ds_write_b64 v46, v[92:93] offset:17408
    v_pk_fma_f32 v[96:97], v[232:233], v[244:245], v[96:97] op_sel_hi:[0,1,1]
    v_pk_fma_f32 v[98:99], v[232:233], v[246:247], v[98:99] op_sel_hi:[0,1,1]
    v_pk_fma_f32 v[68:69], v[232:233], v[240:241], v[68:69] op_sel_hi:[0,1,1]
    v_pk_fma_f32 v[70:71], v[232:233], v[242:243], v[70:71] op_sel_hi:[0,1,1]
    v_pk_mul_f32 v[96:97], v[96:97], v[234:235] op_sel_hi:[1,0]
    v_pk_mul_f32 v[98:99], v[98:99], v[234:235] op_sel_hi:[1,0]
    v_cvt_pk_bf16_f32 v68, v68, v69
    v_cvt_pk_bf16_f32 v69, v70, v71
    ds_write_b64 v46, v[68:69] offset:21888
    v_cvt_pk_bf16_f32 v96, v96, v97
    v_cvt_pk_bf16_f32 v97, v98, v99
    ds_write_b64 v46, v[96:97] offset:21760
    v_pk_fma_f32 v[100:101], v[236:237], v[244:245], v[100:101] op_sel_hi:[0,1,1]
    v_pk_fma_f32 v[102:103], v[236:237], v[246:247], v[102:103] op_sel_hi:[0,1,1]
    v_pk_fma_f32 v[72:73], v[236:237], v[240:241], v[72:73] op_sel_hi:[0,1,1]
    v_pk_fma_f32 v[74:75], v[236:237], v[242:243], v[74:75] op_sel_hi:[0,1,1]
    v_pk_mul_f32 v[100:101], v[100:101], v[238:239] op_sel_hi:[1,0]
    v_pk_mul_f32 v[102:103], v[102:103], v[238:239] op_sel_hi:[1,0]
    v_cvt_pk_bf16_f32 v72, v72, v73
    v_cvt_pk_bf16_f32 v73, v74, v75
    ds_write_b64 v46, v[72:73] offset:26240
    v_cvt_pk_bf16_f32 v100, v100, v101
    v_cvt_pk_bf16_f32 v101, v102, v103
    ds_write_b64 v46, v[100:101] offset:26112
    s_waitcnt lgkmcnt(0)
    s_barrier
    s_cmp_eq_u32 s13, 1
    s_cbranch_scc1 AC_S
    ds_read_b64 v[80:81], v20 offset:0
    ds_read_b64 v[82:83], v21 offset:0
    ds_read_b64 v[64:65], v20 offset:4480
    ds_read_b64 v[66:67], v21 offset:4480
    ds_read_b64 v[84:85], v20 offset:4352
    ds_read_b64 v[86:87], v21 offset:4352
    ds_read_b64 v[68:69], v20 offset:8832
    ds_read_b64 v[70:71], v21 offset:8832
    ds_read_b64 v[88:89], v20 offset:8704
    ds_read_b64 v[90:91], v21 offset:8704
    ds_read_b64 v[72:73], v20 offset:13184
    ds_read_b64 v[74:75], v21 offset:13184
    ds_read_b64 v[92:93], v20 offset:13056
    ds_read_b64 v[94:95], v21 offset:13056
    v_lshl_add_u32 v3, v5, 8, v26
    v_mov_b32 v0, v27
    v_mov_b32_dpp v248, v104 row_newbcast:0 row_mask:0xf bank_mask:0xf
    v_mov_b32_dpp v249, v105 row_newbcast:0 row_mask:0xf bank_mask:0xf
    v_mov_b32_dpp v250, v106 row_newbcast:0 row_mask:0xf bank_mask:0xf
    v_mov_b32_dpp v251, v107 row_newbcast:0 row_mask:0xf bank_mask:0xf
    v_pk_fma_f32 v[104:105], v[212:213], v[248:249], v[104:105] op_sel_hi:[0,1,1]
    v_pk_fma_f32 v[106:107], v[212:213], v[250:251], v[106:107] op_sel_hi:[0,1,1]
    v_pk_fma_f32 v[108:109], v[216:217], v[248:249], v[108:109] op_sel_hi:[0,1,1]
    v_pk_fma_f32 v[110:111], v[216:217], v[250:251], v[110:111] op_sel_hi:[0,1,1]
    v_pk_mul_f32 v[104:105], v[104:105], v[214:215] op_sel_hi:[1,0]
    v_pk_mul_f32 v[106:107], v[106:107], v[214:215] op_sel_hi:[1,0]
    v_pk_mul_f32 v[108:109], v[108:109], v[218:219] op_sel_hi:[1,0]
    v_pk_mul_f32 v[110:111], v[110:111], v[218:219] op_sel_hi:[1,0]
    v_cvt_pk_bf16_f32 v104, v104, v105
    v_cvt_pk_bf16_f32 v105, v106, v107
    ds_write_b64 v47, v[104:105] offset:0
    v_cvt_pk_bf16_f32 v108, v108, v109
    v_cvt_pk_bf16_f32 v109, v110, v111
    ds_write_b64 v47, v[108:109] offset:2176
    s_waitcnt lgkmcnt(10)
    v_mfma_f32_16x16x32_bf16 v[168:171], v[84:87], v[64:67], v[32:35]
    v_mfma_f32_16x16x32_bf16 v[48:51], v[80:83], v[64:67], v[36:39]
    s_waitcnt lgkmcnt(6)
    v_mfma_f32_16x16x32_bf16 v[172:175], v[88:91], v[68:71], v[32:35]
    v_mfma_f32_16x16x32_bf16 v[52:55], v[84:87], v[68:71], v[36:39]
    s_waitcnt lgkmcnt(2)
    v_mfma_f32_16x16x32_bf16 v[176:179], v[92:95], v[72:75], v[32:35]
    v_mfma_f32_16x16x32_bf16 v[56:59], v[88:91], v[72:75], v[36:39]
    s_branch AC_J
AC_S:
    ds_read_b64 v[80:81], v20 offset:0
    ds_read_b64 v[64:65], v20 offset:4480
    ds_read_b64 v[84:85], v20 offset:4352
    ds_read_b64 v[68:69], v20 offset:8832
    ds_read_b64 v[88:89], v20 offset:8704
    ds_read_b64 v[72:73], v20 offset:13184
    ds_read_b64 v[92:93], v20 offset:13056
    v_lshl_add_u32 v3, v5, 8, v26
    v_mov_b32 v0, v27
    v_mov_b32_dpp v248, v104 row_newbcast:0 row_mask:0xf bank_mask:0xf
    v_mov_b32_dpp v249, v105 row_newbcast:0 row_mask:0xf bank_mask:0xf
    v_mov_b32_dpp v250, v106 row_newbcast:0 row_mask:0xf bank_mask:0xf
    v_mov_b32_dpp v251, v107 row_newbcast:0 row_mask:0xf bank_mask:0xf
    v_pk_fma_f32 v[104:105], v[212:213], v[248:249], v[104:105] op_sel_hi:[0,1,1]
    v_pk_fma_f32 v[106:107], v[212:213], v[250:251], v[106:107] op_sel_hi:[0,1,1]
    v_pk_fma_f32 v[108:109], v[216:217], v[248:249], v[108:109] op_sel_hi:[0,1,1]
    v_pk_fma_f32 v[110:111], v[216:217], v[250:251], v[110:111] op_sel_hi:[0,1,1]
    v_pk_mul_f32 v[104:105], v[104:105], v[214:215] op_sel_hi:[1,0]
    v_pk_mul_f32 v[106:107], v[106:107], v[214:215] op_sel_hi:[1,0]
    v_pk_mul_f32 v[108:109], v[108:109], v[218:219] op_sel_hi:[1,0]
    v_pk_mul_f32 v[110:111], v[110:111], v[218:219] op_sel_hi:[1,0]
    v_cvt_pk_bf16_f32 v104, v104, v105
    v_cvt_pk_bf16_f32 v105, v106, v107
    ds_write_b64 v47, v[104:105] offset:0
    v_cvt_pk_bf16_f32 v108, v108, v109
    v_cvt_pk_bf16_f32 v109, v110, v111
    ds_write_b64 v47, v[108:109] offset:2176
    s_waitcnt lgkmcnt(6)
    v_mfma_f32_16x16x16_bf16 v[168:171], v[84:85], v[64:65], v[32:35]
    v_mfma_f32_16x16x16_bf16 v[48:51], v[80:81], v[64:65], v[36:39]
    s_waitcnt lgkmcnt(4)
    v_mfma_f32_16x16x16_bf16 v[172:175], v[88:89], v[68:69], v[32:35]
    v_mfma_f32_16x16x16_bf16 v[52:55], v[84:85], v[68:69], v[36:39]
    s_waitcnt lgkmcnt(2)
    v_mfma_f32_16x16x16_bf16 v[176:179], v[92:93], v[72:73], v[32:35]
    v_mfma_f32_16x16x16_bf16 v[56:59], v[88:89], v[72:73], v[36:39]
AC_J:
    ds_read_b32 v27, v3
    ds_read2st64_b32 v[36:37], v26 offset1:1
    ds_read2st64_b32 v[38:39], v26 offset0:2 offset1:3
    v_max_f32 v168, v168, v48
    v_max_f32 v169, v169, v49
    v_max_f32 v170, v170, v50
    v_max_f32 v171, v171, v51
    v_max_f32 v172, v172, v52
    v_max_f32 v173, v173, v53
    v_max_f32 v174, v174, v54
    v_max_f32 v175, v175, v55
    v_max_f32 v176, v176, v56
    v_max_f32 v177, v177, v57
    v_max_f32 v178, v178, v58
    v_max_f32 v179, v179, v59
    s_cmp_lg_u32 s13, 1
    s_cbranch_scc1 AC_NS
    v_cvt_pk_bf16_f32 v64, v168, v169
    v_mov_b32 v65, s52
    v_cvt_pk_bf16_f32 v66, v170, v171
    v_mov_b32 v67, s52
    buffer_store_dwordx4 v[64:67], v6, s[28:31], s11 offen offset:0 sc1
    v_cvt_pk_bf16_f32 v68, v172, v173
    v_mov_b32 v69, s52
    v_cvt_pk_bf16_f32 v70, v174, v175
    v_mov_b32 v71, s52
    buffer_store_dwordx4 v[68:71], v6, s[28:31], s11 offen offset:1024 sc1
    v_cvt_pk_bf16_f32 v72, v176, v177
    v_mov_b32 v73, s52
    v_cvt_pk_bf16_f32 v74, v178, v179
    v_mov_b32 v75, s52
    buffer_store_dwordx4 v[72:75], v6, s[28:31], s11 offen offset:2048 sc1
AC_NS:
    v_pk_fma_f32 v[112:113], v[220:221], v[248:249], v[112:113] op_sel_hi:[0,1,1]
    v_pk_fma_f32 v[114:115], v[220:221], v[250:251], v[114:115] op_sel_hi:[0,1,1]
    v_pk_fma_f32 v[116:117], v[224:225], v[248:249], v[116:117] op_sel_hi:[0,1,1]
    v_pk_fma_f32 v[118:119], v[224:225], v[250:251], v[118:119] op_sel_hi:[0,1,1]
    v_pk_mul_f32 v[112:113], v[112:113], v[222:223] op_sel_hi:[1,0]
    v_pk_mul_f32 v[114:115], v[114:115], v[222:223] op_sel_hi:[1,0]
    v_pk_mul_f32 v[116:117], v[116:117], v[226:227] op_sel_hi:[1,0]
    v_pk_mul_f32 v[118:119], v[118:119], v[226:227] op_sel_hi:[1,0]
    v_cvt_pk_bf16_f32 v112, v112, v113
    v_cvt_pk_bf16_f32 v113, v114, v115
    ds_write_b64 v47, v[112:113] offset:4352
    v_cvt_pk_bf16_f32 v116, v116, v117
    v_cvt_pk_bf16_f32 v117, v118, v119
    ds_write_b64 v47, v[116:117] offset:6528
    v_pk_fma_f32 v[120:121], v[228:229], v[248:249], v[120:121] op_sel_hi:[0,1,1]
    v_pk_fma_f32 v[122:123], v[228:229], v[250:251], v[122:123] op_sel_hi:[0,1,1]
    v_pk_fma_f32 v[124:125], v[232:233], v[248:249], v[124:125] op_sel_hi:[0,1,1]
    v_pk_fma_f32 v[126:127], v[232:233], v[250:251], v[126:127] op_sel_hi:[0,1,1]
    v_pk_mul_f32 v[120:121], v[120:121], v[230:231] op_sel_hi:[1,0]
    v_pk_mul_f32 v[122:123], v[122:123], v[230:231] op_sel_hi:[1,0]
    v_pk_mul_f32 v[124:125], v[124:125], v[234:235] op_sel_hi:[1,0]
    v_pk_mul_f32 v[126:127], v[126:127], v[234:235] op_sel_hi:[1,0]
    v_cvt_pk_bf16_f32 v120, v120, v121
    v_cvt_pk_bf16_f32 v121, v122, v123
    ds_write_b64 v47, v[120:121] offset:8704
    v_cvt_pk_bf16_f32 v124, v124, v125
    v_cvt_pk_bf16_f32 v125, v126, v127
    ds_write_b64 v47, v[124:125] offset:10880
    v_pk_fma_f32 v[128:129], v[236:237], v[248:249], v[128:129] op_sel_hi:[0,1,1]
    v_pk_fma_f32 v[130:131], v[236:237], v[250:251], v[130:131] op_sel_hi:[0,1,1]
    v_pk_mul_f32 v[128:129], v[128:129], v[238:239] op_sel_hi:[1,0]
    v_pk_mul_f32 v[130:131], v[130:131], v[238:239] op_sel_hi:[1,0]
    v_cvt_pk_bf16_f32 v128, v128, v129
    v_cvt_pk_bf16_f32 v129, v130, v131
    ds_write_b64 v47, v[128:129] offset:13056
    s_waitcnt lgkmcnt(0)
    s_barrier
    ds_read_b64_tr_b16 v[184:185], v22 offset:0
    ds_read_b64_tr_b16 v[194:195], v23 offset:0
    ds_read_b64_tr_b16 v[186:187], v22 offset:2176
    ds_read_b64_tr_b16 v[196:197], v23 offset:2176
    ds_read_b64_tr_b16 v[188:189], v22 offset:4352
    ds_read_b64_tr_b16 v[198:199], v23 offset:4352
    ds_read_b64_tr_b16 v[190:191], v22 offset:6528
    ds_read_b64_tr_b16 v[200:201], v23 offset:6528
    s_cbranch_scc0 AC_X
AC_SM:
    v_max3_f32 v136, v168, v169, v170
    v_max3_f32 v138, v172, v173, v174
    v_max3_f32 v140, v176, v177, v178
    v_max_f32 v136, v136, v171
    v_max_f32 v138, v138, v175
    v_max_f32 v140, v140, v179
    s_nop 1
    v_permlane32_swap_b32 v136, v140
    v_permlane32_swap_b32 v138, v142
    v_max_f32 v136, v136, v140
    v_max_f32 v138, v138, v142
    v_mul_f32 v27, 0x3ea52b5c, v27
    s_nop 0
    v_permlane16_swap_b32 v136, v138
    v_max_f32 v136, v136, v138
    v_mul_f32 v138, v136, v27
    v_mul_f32 v136, v136, v27
    v_mul_f32 v32, 0x3ea52b5c, v36
    v_mul_f32 v34, 0x3ea52b5c, v37
    v_permlane16_swap_b32 v136, v138
    v_mov_b32 v140, v136
    v_mov_b32 v142, v138
    v_mul_f32 v36, 0x3ea52b5c, v38
    v_permlane32_swap_b32 v136, v140
    v_permlane32_swap_b32 v138, v142
    v_pk_fma_f32 v[168:169], v[168:169], v[32:33], v[136:137] op_sel_hi:[1,0,0] neg_lo:[0,0,1] neg_hi:[0,0,1]
    v_pk_fma_f32 v[170:171], v[170:171], v[32:33], v[136:137] op_sel_hi:[1,0,0] neg_lo:[0,0,1] neg_hi:[0,0,1]
    v_pk_fma_f32 v[172:173], v[172:173], v[34:35], v[138:139] op_sel_hi:[1,0,0] neg_lo:[0,0,1] neg_hi:[0,0,1]
    v_pk_fma_f32 v[174:175], v[174:175], v[34:35], v[138:139] op_sel_hi:[1,0,0] neg_lo:[0,0,1] neg_hi:[0,0,1]
    v_pk_fma_f32 v[176:177], v[176:177], v[36:37], v[140:141] op_sel_hi:[1,0,0] neg_lo:[0,0,1] neg_hi:[0,0,1]
    v_pk_fma_f32 v[178:179], v[178:179], v[36:37], v[140:141] op_sel_hi:[1,0,0] neg_lo:[0,0,1] neg_hi:[0,0,1]
    v_exp_f32 v168, v168
    v_exp_f32 v169, v169
    v_exp_f32 v170, v170
    v_exp_f32 v171, v171
    v_cvt_pk_bf16_f32 v2, v168, v169
    v_cvt_pk_bf16_f32 v3, v170, v171
    v_bfi_b32 v168, v40, 0, v2
    v_bfi_b32 v169, v41, 0, v3
    v_and_b32 v170, v40, v2
    v_and_b32 v171, v41, v3
    s_waitcnt lgkmcnt(0)
    v_exp_f32 v172, v172
    v_mfma_f32_16x16x32_bf16 v[116:119], v[28:31], v[168:171], 0
    v_exp_f32 v173, v173
    v_mfma_f32_16x16x32_bf16 v[136:139], v[184:187], v[168:171], 0
    v_exp_f32 v174, v174
    v_mfma_f32_16x16x32_bf16 v[152:155], v[194:197], v[168:171], 0
    v_exp_f32 v175, v175
    v_cvt_pk_bf16_f32 v2, v172, v173
    v_cvt_pk_bf16_f32 v3, v174, v175
    v_bfi_b32 v172, v40, 0, v2
    v_bfi_b32 v173, v41, 0, v3
    v_and_b32 v174, v40, v2
    v_and_b32 v175, v41, v3
    v_rcp_f32 v32, v116
    v_exp_f32 v176, v176
    v_mfma_f32_16x16x32_bf16 v[120:123], v[28:31], v[172:175], 0
    v_exp_f32 v177, v177
    v_mfma_f32_16x16x32_bf16 v[140:143], v[186:189], v[172:175], 0
    v_exp_f32 v178, v178
    v_mfma_f32_16x16x32_bf16 v[156:159], v[196:199], v[172:175], 0
    v_exp_f32 v179, v179
    v_cvt_pk_bf16_f32 v2, v176, v177
    v_cvt_pk_bf16_f32 v3, v178, v179
    v_bfi_b32 v176, v40, 0, v2
    v_bfi_b32 v177, v41, 0, v3
    v_and_b32 v178, v40, v2
    v_and_b32 v179, v41, v3
    v_rcp_f32 v34, v120
    v_mul_f32 v136, v136, v32
    v_mfma_f32_16x16x32_bf16 v[116:119], v[28:31], v[176:179], 0
    v_mul_f32 v137, v137, v32
    v_mfma_f32_16x16x32_bf16 v[144:147], v[188:191], v[176:179], 0
    v_mul_f32 v138, v138, v32
    v_mfma_f32_16x16x32_bf16 v[160:163], v[198:201], v[176:179], 0
    v_mul_f32 v139, v139, v32
    v_cvt_pk_bf16_f32 v136, v136, v137
    v_cvt_pk_bf16_f32 v137, v138, v139
    v_mul_f32 v140, v140, v34
    v_mul_f32 v141, v141, v34
    v_mul_f32 v142, v142, v34
    v_mul_f32 v143, v143, v34
    v_cvt_pk_bf16_f32 v138, v140, v141
    v_cvt_pk_bf16_f32 v139, v142, v143
    v_rcp_f32 v36, v116
    v_permlane32_swap_b32 v136, v138
    v_permlane32_swap_b32 v137, v139
    v_pk_mul_f32 v[144:145], v[144:145], v[36:37] op_sel_hi:[1,0]
    v_pk_mul_f32 v[146:147], v[146:147], v[36:37] op_sel_hi:[1,0]
    v_cvt_pk_bf16_f32 v144, v144, v145
    v_cvt_pk_bf16_f32 v145, v146, v147
    s_mov_b64 exec, s[14:15]
    buffer_store_dwordx4 v[136:139], v24, s[28:31], s9 offen sc1
    s_mov_b64 exec, -1
    v_permlane32_swap_b32 v144, v146
    v_permlane32_swap_b32 v145, v147
    v_pk_mul_f32 v[152:153], v[152:153], v[32:33] op_sel_hi:[1,0]
    v_pk_mul_f32 v[154:155], v[154:155], v[32:33] op_sel_hi:[1,0]
    s_mov_b64 exec, s[16:17]
    buffer_store_dwordx4 v[144:147], v24, s[28:31], s5 offen sc1
    s_lshl_b64 exec, -1, 16
    v_pk_mul_f32 v[152:153], v[156:157], v[34:35] op_sel_hi:[1,0]
    v_pk_mul_f32 v[154:155], v[158:159], v[34:35] op_sel_hi:[1,0]
    s_lshl_b64 exec, -1, 32
    v_pk_mul_f32 v[152:153], v[160:161], v[36:37] op_sel_hi:[1,0]
    v_pk_mul_f32 v[154:155], v[162:163], v[36:37] op_sel_hi:[1,0]
    s_mov_b64 exec, s[18:19]
    v_cvt_pk_bf16_f32 v152, v152, v153
    v_cvt_pk_bf16_f32 v153, v154, v155
    buffer_store_dwordx2 v[152:153], v25, s[28:31], s10 offen sc1
    s_mov_b64 exec, -1
A_DONE:
TC1:
    s_cbranch_execz TC2
    s_cmp_lg_u32 s13, 0
    s_cbranch_scc1 P_TAIL
    s_setprio 1
    v_mov_b32 v2, 1
    ds_write_b8 v18, v2 offset:0
    s_cmp_eq_u32 s101, 0
    s_cbranch_scc1 K_END
    v_xor_b32 v28, 32, v8
    v_xor_b32 v29, 64, v8
    v_xor_b32 v30, 96, v8
    ds_read_b64 v[48:49], v8 offset:0
    ds_read_b64 v[50:51], v28 offset:0
    ds_read_b64 v[52:53], v29 offset:0
    ds_read_b64 v[54:55], v30 offset:0
    ds_read_b64 v[56:57], v8 offset:2048
    ds_read_b64 v[58:59], v28 offset:2048
    ds_read_b64 v[60:61], v29 offset:2048
    ds_read_b64 v[62:63], v30 offset:2048
    s_cmp_eq_u32 s101, 2
    s_cselect_b32 s60, 0, 2146435072
    s_add_u32 s60, s60, 20480
    v_add_u32 v31, s60, v6
    s_mov_b32 s100, 0
    v_xor_b32 v28, 32, v9
    v_xor_b32 v29, 64, v9
    v_xor_b32 v30, 96, v9
    ds_read_b64_tr_b16 v[160:161], v9 offset:0
    ds_read_b64_tr_b16 v[164:165], v28 offset:0
    ds_read_b64_tr_b16 v[168:169], v29 offset:0
    ds_read_b64_tr_b16 v[172:173], v30 offset:0
    ds_read_b64_tr_b16 v[162:163], v9 offset:1024
    ds_read_b64_tr_b16 v[166:167], v28 offset:1024
    ds_read_b64_tr_b16 v[170:171], v29 offset:1024
    ds_read_b64_tr_b16 v[174:175], v30 offset:1024
    s_waitcnt lgkmcnt(8)
    v_lshlrev_b32 v64, 16, v48
    ds_read_b64_tr_b16 v[176:177], v29 offset:7680
    v_and_b32 v65, 0xffff0000, v48
    ds_read_b64_tr_b16 v[180:181], v30 offset:7680
    v_lshlrev_b32 v66, 16, v49
    ds_read_b64_tr_b16 v[184:185], v9 offset:7680
    v_and_b32 v67, 0xffff0000, v49
    ds_read_b64_tr_b16 v[188:189], v28 offset:7680
    v_lshlrev_b32 v68, 16, v50
    ds_read_b64_tr_b16 v[178:179], v29 offset:8704
    v_and_b32 v69, 0xffff0000, v50
    ds_read_b64_tr_b16 v[182:183], v30 offset:8704
    v_lshlrev_b32 v70, 16, v51
    ds_read_b64_tr_b16 v[186:187], v9 offset:8704
    v_and_b32 v71, 0xffff0000, v51
    ds_read_b64_tr_b16 v[190:191], v28 offset:8704
    v_lshlrev_b32 v72, 16, v52
    ds_read_b64_tr_b16 v[192:193], v9 offset:15360
    v_and_b32 v73, 0xffff0000, v52
    ds_read_b64_tr_b16 v[196:197], v28 offset:15360
    v_lshlrev_b32 v74, 16, v53
    ds_read_b64_tr_b16 v[200:201], v29 offset:15360
    v_and_b32 v75, 0xffff0000, v53
    ds_read_b64_tr_b16 v[204:205], v30 offset:15360
    v_lshlrev_b32 v76, 16, v54
    ds_read_b64_tr_b16 v[194:195], v9 offset:16384
    v_and_b32 v77, 0xffff0000, v54
    ds_read_b64_tr_b16 v[198:199], v28 offset:16384
    v_lshlrev_b32 v78, 16, v55
    ds_read_b64_tr_b16 v[202:203], v29 offset:16384
    v_and_b32 v79, 0xffff0000, v55
    ds_read_b64_tr_b16 v[206:207], v30 offset:16384
    v_lshlrev_b32 v80, 16, v56
    ds_read_b64_tr_b16 v[208:209], v29 offset:23040
    v_and_b32 v81, 0xffff0000, v56
    ds_read_b64_tr_b16 v[212:213], v30 offset:23040
    v_lshlrev_b32 v82, 16, v57
    ds_read_b64_tr_b16 v[216:217], v9 offset:23040
    v_and_b32 v83, 0xffff0000, v57
    ds_read_b64_tr_b16 v[220:221], v28 offset:23040
    v_lshlrev_b32 v84, 16, v58
    ds_read_b64_tr_b16 v[210:211], v29 offset:24064
    v_and_b32 v85, 0xffff0000, v58
    ds_read_b64_tr_b16 v[214:215], v30 offset:24064
    v_lshlrev_b32 v86, 16, v59
    ds_read_b64_tr_b16 v[218:219], v9 offset:24064
    v_and_b32 v87, 0xffff0000, v59
    ds_read_b64_tr_b16 v[222:223], v28 offset:24064
    v_lshlrev_b32 v88, 16, v60
    ds_read_b64_tr_b16 v[224:225], v9 offset:30720
    v_and_b32 v89, 0xffff0000, v60
    ds_read_b64_tr_b16 v[228:229], v28 offset:30720
    v_lshlrev_b32 v90, 16, v61
    ds_read_b64_tr_b16 v[232:233], v29 offset:30720
    v_and_b32 v91, 0xffff0000, v61
    ds_read_b64_tr_b16 v[236:237], v30 offset:30720
    v_lshlrev_b32 v92, 16, v62
    ds_read_b64_tr_b16 v[226:227], v9 offset:31744
    v_and_b32 v93, 0xffff0000, v62
    ds_read_b64_tr_b16 v[230:231], v28 offset:31744
    v_lshlrev_b32 v94, 16, v63
    ds_read_b64_tr_b16 v[234:235], v29 offset:31744
    v_and_b32 v95, 0xffff0000, v63
    ds_read_b64_tr_b16 v[238:239], v30 offset:31744
    v_xor_b32 v28, 32, v10
    v_xor_b32 v29, 64, v10
    v_xor_b32 v30, 96, v10
    ds_read_b64_tr_b16 v[240:241], v10 offset:0
    ds_read_b64_tr_b16 v[244:245], v28 offset:0
    ds_read_b64_tr_b16 v[248:249], v29 offset:0
    ds_read_b64_tr_b16 v[252:253], v30 offset:0
    ds_read_b64_tr_b16 v[242:243], v10 offset:1024
    ds_read_b64_tr_b16 v[246:247], v28 offset:1024
    ds_read_b64_tr_b16 v[250:251], v29 offset:1024
    ds_read_b64_tr_b16 v[254:255], v30 offset:1024
    s_cmp_lt_u32 s3, 4
    s_cbranch_scc1 G_NOS
    s_sleep 6
G_NOS:
    buffer_load_dwordx4 v[96:99], v0, s[28:31], s96 offen offset:0 sc1
    buffer_load_dwordx4 v[100:103], v31, s[28:31], s96 offen offset:0 sc1
    buffer_load_dwordx4 v[104:107], v0, s[28:31], s96 offen offset:1024 sc1
    buffer_load_dwordx4 v[108:111], v31, s[28:31], s96 offen offset:1024 sc1
    buffer_load_dwordx4 v[112:115], v0, s[28:31], s96 offen offset:2048 sc1
    buffer_load_dwordx4 v[116:119], v31, s[28:31], s96 offen offset:2048 sc1
    buffer_load_dwordx4 v[120:123], v0, s[28:31], s96 offen offset:3072 sc1
    buffer_load_dwordx4 v[124:127], v31, s[28:31], s96 offen offset:3072 sc1
    s_waitcnt vmcnt(6)
    v_max3_u32 v2, v96, v98, v100
    v_max_u32 v2, v2, v102
    v_cmp_eq_u32 vcc, -1, v2
    s_waitcnt lgkmcnt(15)
    s_cbranch_vccnz G2_R0
G2_OK0:
    v_mfma_f32_16x16x32_bf16 v[32:35], v[160:163], v[96:99], 0
    ds_read_b64 v[24:25], v19 offset:16
    buffer_load_dwordx4 v[128:131], v0, s[28:31], s92 offen offset:0 sc1
    v_mfma_f32_16x16x32_bf16 v[48:51], v[160:163], v[100:103], 0
    buffer_load_dwordx4 v[132:135], v31, s[28:31], s92 offen offset:0 sc1
    v_mfma_f32_16x16x32_bf16 v[36:39], v[164:167], v[96:99], 0
    v_mfma_f32_16x16x32_bf16 v[52:55], v[164:167], v[100:103], 0
    s_waitcnt vmcnt(6)
    v_max3_u32 v2, v104, v106, v108
    v_mfma_f32_16x16x32_bf16 v[40:43], v[168:171], v[96:99], 0
    v_max_u32 v2, v2, v110
    v_mfma_f32_16x16x32_bf16 v[56:59], v[168:171], v[100:103], 0
    v_cmp_eq_u32 vcc, -1, v2
    v_mfma_f32_16x16x32_bf16 v[44:47], v[172:175], v[96:99], 0
    s_waitcnt lgkmcnt(0)
    v_mfma_f32_16x16x32_bf16 v[60:63], v[172:175], v[100:103], 0
    s_cbranch_vccnz G2_R1
G2_OK1:
    v_mfma_f32_16x16x32_bf16 v[32:35], v[176:179], v[104:107], v[32:35]
    v_xor_b32 v28, 32, v11
    v_xor_b32 v29, 64, v11
    v_and_b32 v3, v24, v25
    v_cmp_ne_u32 vcc, 0x01010101, v3
    v_mfma_f32_16x16x32_bf16 v[48:51], v[176:179], v[108:111], v[48:51]
    v_xor_b32 v30, 96, v11
    s_cbranch_vccnz G2_ZAR
G2_ZAOK:
    v_mfma_f32_16x16x32_bf16 v[36:39], v[180:183], v[104:107], v[36:39]
    ds_read_b64_tr_b16 v[160:161], v11 offset:0
    ds_read_b64_tr_b16 v[164:165], v28 offset:0
    buffer_load_dwordx4 v[136:139], v0, s[28:31], s92 offen offset:1024 sc1
    v_mfma_f32_16x16x32_bf16 v[52:55], v[180:183], v[108:111], v[52:55]
    ds_read_b64_tr_b16 v[168:169], v29 offset:0
    buffer_load_dwordx4 v[140:143], v31, s[28:31], s92 offen offset:1024 sc1
    s_waitcnt vmcnt(6)
    v_max3_u32 v2, v112, v114, v116
    v_mfma_f32_16x16x32_bf16 v[40:43], v[184:187], v[104:107], v[40:43]
    ds_read_b64_tr_b16 v[172:173], v30 offset:0
    v_max_u32 v2, v2, v118
    v_mfma_f32_16x16x32_bf16 v[56:59], v[184:187], v[108:111], v[56:59]
    ds_read_b64_tr_b16 v[162:163], v11 offset:15360
    ds_read_b64_tr_b16 v[166:167], v28 offset:15360
    v_cmp_eq_u32 vcc, -1, v2
    v_mfma_f32_16x16x32_bf16 v[44:47], v[188:191], v[104:107], v[44:47]
    ds_read_b64_tr_b16 v[170:171], v29 offset:15360
    v_mfma_f32_16x16x32_bf16 v[60:63], v[188:191], v[108:111], v[60:63]
    ds_read_b64_tr_b16 v[174:175], v30 offset:15360
    s_cbranch_vccnz G2_R2
G2_OK2:
    v_mfma_f32_16x16x32_bf16 v[32:35], v[192:195], v[112:115], v[32:35]
    v_add_u32 v9, 40960, v9
    v_xor_b32 v28, 32, v9
    buffer_load_dwordx4 v[144:147], v0, s[28:31], s92 offen offset:2048 sc1
    v_mfma_f32_16x16x32_bf16 v[48:51], v[192:195], v[116:119], v[48:51]
    v_xor_b32 v29, 64, v9
    buffer_load_dwordx4 v[148:151], v31, s[28:31], s92 offen offset:2048 sc1
    v_mfma_f32_16x16x32_bf16 v[36:39], v[196:199], v[112:115], v[36:39]
    v_xor_b32 v30, 96, v9
    ds_read_b64_tr_b16 v[176:177], v9 offset:0
    v_mfma_f32_16x16x32_bf16 v[52:55], v[196:199], v[116:119], v[52:55]
    ds_read_b64_tr_b16 v[180:181], v28 offset:0
    s_waitcnt vmcnt(6)
    v_max3_u32 v2, v120, v122, v124
    v_mfma_f32_16x16x32_bf16 v[40:43], v[200:203], v[112:115], v[40:43]
    ds_read_b64_tr_b16 v[184:185], v29 offset:0
    ds_read_b64_tr_b16 v[188:189], v30 offset:0
    v_max_u32 v2, v2, v126
    v_mfma_f32_16x16x32_bf16 v[56:59], v[200:203], v[116:119], v[56:59]
    ds_read_b64_tr_b16 v[178:179], v9 offset:1024
    v_cmp_eq_u32 vcc, -1, v2
    v_mfma_f32_16x16x32_bf16 v[44:47], v[204:207], v[112:115], v[44:47]
    ds_read_b64_tr_b16 v[182:183], v28 offset:1024
    ds_read_b64_tr_b16 v[186:187], v29 offset:1024
    v_mfma_f32_16x16x32_bf16 v[60:63], v[204:207], v[116:119], v[60:63]
    ds_read_b64_tr_b16 v[190:191], v30 offset:1024
    s_cbranch_vccnz G2_R3
G2_OK3:
    v_mfma_f32_16x16x32_bf16 v[32:35], v[208:211], v[120:123], v[32:35]
    ds_read_b64_tr_b16 v[192:193], v29 offset:7680
    buffer_load_dwordx4 v[152:155], v0, s[28:31], s4 offen offset:0 sc1
    v_mfma_f32_16x16x32_bf16 v[48:51], v[208:211], v[124:127], v[48:51]
    ds_read_b64_tr_b16 v[196:197], v30 offset:7680
    buffer_load_dwordx4 v[156:159], v31, s[28:31], s4 offen offset:0 sc1
    v_mfma_f32_16x16x32_bf16 v[36:39], v[212:215], v[120:123], v[36:39]
    ds_read_b64_tr_b16 v[200:201], v9 offset:7680
    v_mfma_f32_16x16x32_bf16 v[52:55], v[212:215], v[124:127], v[52:55]
    ds_read_b64_tr_b16 v[204:205], v28 offset:7680
    s_waitcnt vmcnt(6)
    v_max3_u32 v2, v128, v130, v132
    v_mfma_f32_16x16x32_bf16 v[40:43], v[216:219], v[120:123], v[40:43]
    ds_read_b64_tr_b16 v[194:195], v29 offset:8704
    v_max_u32 v2, v2, v134
    v_mfma_f32_16x16x32_bf16 v[56:59], v[216:219], v[124:127], v[56:59]
    ds_read_b64_tr_b16 v[198:199], v30 offset:8704
    v_cmp_eq_u32 vcc, -1, v2
    v_mfma_f32_16x16x32_bf16 v[44:47], v[220:223], v[120:123], v[44:47]
    ds_read_b64_tr_b16 v[202:203], v9 offset:8704
    v_mfma_f32_16x16x32_bf16 v[60:63], v[220:223], v[124:127], v[60:63]
    ds_read_b64_tr_b16 v[206:207], v28 offset:8704
    s_cbranch_vccnz G2_R4
G2_OK4:
    v_mfma_f32_16x16x32_bf16 v[32:35], v[224:227], v[128:131], v[32:35]
    ds_read_b64_tr_b16 v[208:209], v9 offset:15360
    buffer_load_dwordx4 v[96:99], v0, s[28:31], s4 offen offset:1024 sc1
    v_mfma_f32_16x16x32_bf16 v[48:51], v[224:227], v[132:135], v[48:51]
    ds_read_b64_tr_b16 v[212:213], v28 offset:15360
    buffer_load_dwordx4 v[100:103], v31, s[28:31], s4 offen offset:1024 sc1
    v_mfma_f32_16x16x32_bf16 v[36:39], v[228:231], v[128:131], v[36:39]
    ds_read_b64_tr_b16 v[216:217], v29 offset:15360
    v_mfma_f32_16x16x32_bf16 v[52:55], v[228:231], v[132:135], v[52:55]
    ds_read_b64_tr_b16 v[220:221], v30 offset:15360
    s_waitcnt vmcnt(6)
    v_max3_u32 v2, v136, v138, v140
    v_mfma_f32_16x16x32_bf16 v[40:43], v[232:235], v[128:131], v[40:43]
    ds_read_b64_tr_b16 v[210:211], v9 offset:16384
    v_max_u32 v2, v2, v142
    v_mfma_f32_16x16x32_bf16 v[56:59], v[232:235], v[132:135], v[56:59]
    ds_read_b64_tr_b16 v[214:215], v28 offset:16384
    v_cmp_eq_u32 vcc, -1, v2
    v_mfma_f32_16x16x32_bf16 v[44:47], v[236:239], v[128:131], v[44:47]
    ds_read_b64_tr_b16 v[218:219], v29 offset:16384
    v_mfma_f32_16x16x32_bf16 v[60:63], v[236:239], v[132:135], v[60:63]
    ds_read_b64_tr_b16 v[222:223], v30 offset:16384
    s_cbranch_vccnz G2_R5
G2_OK5:
    v_mfma_f32_16x16x32_bf16 v[32:35], v[240:243], v[136:139], v[32:35]
    ds_read_b64_tr_b16 v[224:225], v29 offset:23040
    buffer_load_dwordx4 v[104:107], v0, s[28:31], s4 offen offset:2048 sc1
    v_mfma_f32_16x16x32_bf16 v[48:51], v[240:243], v[140:143], v[48:51]
    ds_read_b64_tr_b16 v[228:229], v30 offset:23040
    buffer_load_dwordx4 v[108:111], v31, s[28:31], s4 offen offset:2048 sc1
    v_mfma_f32_16x16x32_bf16 v[36:39], v[244:247], v[136:139], v[36:39]
    ds_read_b64_tr_b16 v[232:233], v9 offset:23040
    v_mfma_f32_16x16x32_bf16 v[52:55], v[244:247], v[140:143], v[52:55]
    ds_read_b64_tr_b16 v[236:237], v28 offset:23040
    s_waitcnt vmcnt(6)
    v_max3_u32 v2, v144, v146, v148
    v_mfma_f32_16x16x32_bf16 v[40:43], v[248:251], v[136:139], v[40:43]
    ds_read_b64_tr_b16 v[226:227], v29 offset:24064
    v_max_u32 v2, v2, v150
    v_mfma_f32_16x16x32_bf16 v[56:59], v[248:251], v[140:143], v[56:59]
    ds_read_b64_tr_b16 v[230:231], v30 offset:24064
    v_cmp_eq_u32 vcc, -1, v2
    v_mfma_f32_16x16x32_bf16 v[44:47], v[252:255], v[136:139], v[44:47]
    ds_read_b64_tr_b16 v[234:235], v9 offset:24064
    s_waitcnt lgkmcnt(15)
    v_mfma_f32_16x16x32_bf16 v[60:63], v[252:255], v[140:143], v[60:63]
    ds_read_b64_tr_b16 v[238:239], v28 offset:24064
    s_cbranch_vccnz G2_R6
G2_OK6:
    v_mfma_f32_16x16x32_bf16 v[32:35], v[160:163], v[144:147], v[32:35]
    ds_read_b64 v[24:25], v19 offset:0
    ds_read_b64_tr_b16 v[240:241], v9 offset:30720
    buffer_load_dwordx4 v[112:115], v0, s[28:31], s4 offen offset:3072 sc1
    v_mfma_f32_16x16x32_bf16 v[48:51], v[160:163], v[148:151], v[48:51]
    ds_read_b64_tr_b16 v[244:245], v28 offset:30720
    buffer_load_dwordx4 v[116:119], v31, s[28:31], s4 offen offset:3072 sc1
    v_mfma_f32_16x16x32_bf16 v[36:39], v[164:167], v[144:147], v[36:39]
    ds_read_b64_tr_b16 v[248:249], v29 offset:30720
    v_mfma_f32_16x16x32_bf16 v[52:55], v[164:167], v[148:151], v[52:55]
    ds_read_b64_tr_b16 v[252:253], v30 offset:30720
    s_waitcnt vmcnt(6)
    v_max3_u32 v2, v152, v154, v156
    v_mfma_f32_16x16x32_bf16 v[40:43], v[168:171], v[144:147], v[40:43]
    ds_read_b64_tr_b16 v[242:243], v9 offset:31744
    v_max_u32 v2, v2, v158
    v_mfma_f32_16x16x32_bf16 v[56:59], v[168:171], v[148:151], v[56:59]
    ds_read_b64_tr_b16 v[246:247], v28 offset:31744
    v_cmp_eq_u32 vcc, -1, v2
    v_mfma_f32_16x16x32_bf16 v[44:47], v[172:175], v[144:147], v[44:47]
    ds_read_b64_tr_b16 v[250:251], v29 offset:31744
    s_waitcnt lgkmcnt(7)
    v_mfma_f32_16x16x32_bf16 v[60:63], v[172:175], v[148:151], v[60:63]
    ds_read_b64_tr_b16 v[254:255], v30 offset:31744
    s_cbranch_vccnz G2_R7
G2_OK7:
    v_mfma_f32_16x16x32_bf16 v[32:35], v[176:179], v[152:155], v[32:35]
    v_xor_b32 v28, 32, v10
    v_xor_b32 v29, 64, v10
    v_and_b32 v3, v24, v25
    v_cmp_ne_u32 vcc, 0x01010101, v3
    v_mfma_f32_16x16x32_bf16 v[48:51], v[176:179], v[156:159], v[48:51]
    v_xor_b32 v30, 96, v10
    s_cbranch_vccnz G2_ZLR
G2_ZLOK:
    v_mfma_f32_16x16x32_bf16 v[36:39], v[180:183], v[152:155], v[36:39]
    ds_read_b64_tr_b16 v[160:161], v10 offset:40960
    ds_read_b64_tr_b16 v[164:165], v28 offset:40960
    buffer_load_dwordx4 v[120:123], v0, s[28:31], s6 offen offset:0 sc1
    v_mfma_f32_16x16x32_bf16 v[52:55], v[180:183], v[156:159], v[52:55]
    ds_read_b64_tr_b16 v[168:169], v29 offset:40960
    buffer_load_dwordx4 v[124:127], v31, s[28:31], s6 offen offset:0 sc1
    s_waitcnt vmcnt(6)
    v_max3_u32 v2, v96, v98, v100
    v_mfma_f32_16x16x32_bf16 v[40:43], v[184:187], v[152:155], v[40:43]
    ds_read_b64_tr_b16 v[172:173], v30 offset:40960
    v_max_u32 v2, v2, v102
    v_mfma_f32_16x16x32_bf16 v[56:59], v[184:187], v[156:159], v[56:59]
    ds_read_b64_tr_b16 v[162:163], v10 offset:41984
    ds_read_b64_tr_b16 v[166:167], v28 offset:41984
    v_cmp_eq_u32 vcc, -1, v2
    v_mfma_f32_16x16x32_bf16 v[44:47], v[188:191], v[152:155], v[44:47]
    ds_read_b64_tr_b16 v[170:171], v29 offset:41984
    v_mfma_f32_16x16x32_bf16 v[60:63], v[188:191], v[156:159], v[60:63]
    ds_read_b64_tr_b16 v[174:175], v30 offset:41984
    s_cbranch_vccnz G2_R8
G2_OK8:
    v_mfma_f32_16x16x32_bf16 v[32:35], v[192:195], v[96:99], v[32:35]
    v_xor_b32 v28, 32, v11
    v_xor_b32 v29, 64, v11
    buffer_load_dwordx4 v[128:131], v0, s[28:31], s6 offen offset:1024 sc1
    v_mfma_f32_16x16x32_bf16 v[48:51], v[192:195], v[100:103], v[48:51]
    v_xor_b32 v30, 96, v11
    buffer_load_dwordx4 v[132:135], v31, s[28:31], s6 offen offset:1024 sc1
    v_mfma_f32_16x16x32_bf16 v[36:39], v[196:199], v[96:99], v[36:39]
    ds_read_b64_tr_b16 v[176:177], v11 offset:40960
    ds_read_b64_tr_b16 v[180:181], v28 offset:40960
    v_mfma_f32_16x16x32_bf16 v[52:55], v[196:199], v[100:103], v[52:55]
    ds_read_b64_tr_b16 v[184:185], v29 offset:40960
    s_waitcnt vmcnt(6)
    v_max3_u32 v2, v104, v106, v108
    v_mfma_f32_16x16x32_bf16 v[40:43], v[200:203], v[96:99], v[40:43]
    ds_read_b64_tr_b16 v[188:189], v30 offset:40960
    v_max_u32 v2, v2, v110
    v_mfma_f32_16x16x32_bf16 v[56:59], v[200:203], v[100:103], v[56:59]
    ds_read_b64_tr_b16 v[178:179], v11 offset:56320
    ds_read_b64_tr_b16 v[182:183], v28 offset:56320
    v_cmp_eq_u32 vcc, -1, v2
    v_mfma_f32_16x16x32_bf16 v[44:47], v[204:207], v[96:99], v[44:47]
    ds_read_b64_tr_b16 v[186:187], v29 offset:56320
    v_mfma_f32_16x16x32_bf16 v[60:63], v[204:207], v[100:103], v[60:63]
    ds_read_b64_tr_b16 v[190:191], v30 offset:56320
    s_cbranch_vccnz G2_R9
G2_OK9:
    v_mfma_f32_16x16x32_bf16 v[32:35], v[208:211], v[104:107], v[32:35]
    v_xor_b32 v28, 32, v13
    v_xor_b32 v29, 64, v13
    buffer_load_dwordx4 v[136:139], v0, s[28:31], s6 offen offset:2048 sc1
    v_mfma_f32_16x16x32_bf16 v[48:51], v[208:211], v[108:111], v[48:51]
    v_xor_b32 v30, 96, v13
    buffer_load_dwordx4 v[140:143], v31, s[28:31], s6 offen offset:2048 sc1
    v_mfma_f32_16x16x32_bf16 v[36:39], v[212:215], v[104:107], v[36:39]
    ds_read_b64_tr_b16 v[192:193], v13 offset:0
    ds_read_b64_tr_b16 v[196:197], v28 offset:0
    v_mfma_f32_16x16x32_bf16 v[52:55], v[212:215], v[108:111], v[52:55]
    ds_read_b64_tr_b16 v[200:201], v29 offset:0
    s_waitcnt vmcnt(6)
    v_max3_u32 v2, v112, v114, v116
    v_mfma_f32_16x16x32_bf16 v[40:43], v[216:219], v[104:107], v[40:43]
    ds_read_b64_tr_b16 v[204:205], v30 offset:0
    v_max_u32 v2, v2, v118
    v_mfma_f32_16x16x32_bf16 v[56:59], v[216:219], v[108:111], v[56:59]
    ds_read_b64_tr_b16 v[194:195], v13 offset:1024
    ds_read_b64_tr_b16 v[198:199], v28 offset:1024
    v_cmp_eq_u32 vcc, -1, v2
    v_mfma_f32_16x16x32_bf16 v[44:47], v[220:223], v[104:107], v[44:47]
    ds_read_b64_tr_b16 v[202:203], v29 offset:1024
    v_mfma_f32_16x16x32_bf16 v[60:63], v[220:223], v[108:111], v[60:63]
    ds_read_b64_tr_b16 v[206:207], v30 offset:1024
    s_cbranch_vccnz G2_R10
G2_OK10:
    v_mfma_f32_16x16x32_bf16 v[32:35], v[224:227], v[112:115], v[32:35]
    ds_read_b64_tr_b16 v[208:209], v13 offset:40960
    buffer_load_dwordx4 v[144:147], v0, s[28:31], s93 offen offset:0 sc1
    v_mfma_f32_16x16x32_bf16 v[48:51], v[224:227], v[116:119], v[48:51]
    ds_read_b64_tr_b16 v[212:213], v28 offset:40960
    buffer_load_dwordx4 v[148:151], v31, s[28:31], s93 offen offset:0 sc1
    v_mfma_f32_16x16x32_bf16 v[36:39], v[228:231], v[112:115], v[36:39]
    ds_read_b64_tr_b16 v[216:217], v29 offset:40960
    v_mfma_f32_16x16x32_bf16 v[52:55], v[228:231], v[116:119], v[52:55]
    ds_read_b64_tr_b16 v[220:221], v30 offset:40960
    s_waitcnt vmcnt(6)
    v_max3_u32 v2, v120, v122, v124
    v_mfma_f32_16x16x32_bf16 v[40:43], v[232:235], v[112:115], v[40:43]
    ds_read_b64_tr_b16 v[210:211], v13 offset:41984
    v_max_u32 v2, v2, v126
    v_mfma_f32_16x16x32_bf16 v[56:59], v[232:235], v[116:119], v[56:59]
    ds_read_b64_tr_b16 v[214:215], v28 offset:41984
    v_cmp_eq_u32 vcc, -1, v2
    v_mfma_f32_16x16x32_bf16 v[44:47], v[236:239], v[112:115], v[44:47]
    ds_read_b64_tr_b16 v[218:219], v29 offset:41984
    s_waitcnt lgkmcnt(15)
    v_mfma_f32_16x16x32_bf16 v[60:63], v[236:239], v[116:119], v[60:63]
    ds_read_b64_tr_b16 v[222:223], v30 offset:41984
    s_cbranch_vccnz G2_R11
G2_OK11:
    v_mfma_f32_16x16x32_bf16 v[32:35], v[240:243], v[120:123], v[32:35]
    v_xor_b32 v28, 32, v14
    v_xor_b32 v29, 64, v14
    buffer_load_dwordx4 v[152:155], v0, s[28:31], s7 offen offset:0 sc1
    v_mfma_f32_16x16x32_bf16 v[48:51], v[240:243], v[124:127], v[48:51]
    v_xor_b32 v30, 96, v14
    buffer_load_dwordx4 v[156:159], v31, s[28:31], s7 offen offset:0 sc1
    v_mfma_f32_16x16x32_bf16 v[36:39], v[244:247], v[120:123], v[36:39]
    ds_read_b64_tr_b16 v[224:225], v14 offset:0
    ds_read_b64_tr_b16 v[228:229], v28 offset:0
    v_mfma_f32_16x16x32_bf16 v[52:55], v[244:247], v[124:127], v[52:55]
    ds_read_b64_tr_b16 v[232:233], v29 offset:0
    s_waitcnt vmcnt(6)
    v_max3_u32 v2, v128, v130, v132
    v_mfma_f32_16x16x32_bf16 v[40:43], v[248:251], v[120:123], v[40:43]
    ds_read_b64_tr_b16 v[236:237], v30 offset:0
    v_max_u32 v2, v2, v134
    v_mfma_f32_16x16x32_bf16 v[56:59], v[248:251], v[124:127], v[56:59]
    ds_read_b64_tr_b16 v[226:227], v29 offset:512
    ds_read_b64_tr_b16 v[230:231], v30 offset:512
    v_cmp_eq_u32 vcc, -1, v2
    v_mfma_f32_16x16x32_bf16 v[44:47], v[252:255], v[120:123], v[44:47]
    ds_read_b64_tr_b16 v[234:235], v14 offset:512
    s_waitcnt lgkmcnt(15)
    v_mfma_f32_16x16x32_bf16 v[60:63], v[252:255], v[124:127], v[60:63]
    ds_read_b64_tr_b16 v[238:239], v28 offset:512
    s_cbranch_vccnz G2_R12
G2_OK12:
    v_mfma_f32_16x16x32_bf16 v[32:35], v[160:163], v[128:131], v[32:35]
    ds_read_b64_tr_b16 v[240:241], v14 offset:40960
    buffer_load_dwordx4 v[96:99], v0, s[28:31], s93 offen offset:1024 sc1
    v_mfma_f32_16x16x32_bf16 v[48:51], v[160:163], v[132:135], v[48:51]
    ds_read_b64_tr_b16 v[244:245], v28 offset:40960
    buffer_load_dwordx4 v[100:103], v31, s[28:31], s93 offen offset:1024 sc1
    v_mfma_f32_16x16x32_bf16 v[36:39], v[164:167], v[128:131], v[36:39]
    ds_read_b64_tr_b16 v[248:249], v29 offset:40960
    v_mfma_f32_16x16x32_bf16 v[52:55], v[164:167], v[132:135], v[52:55]
    ds_read_b64_tr_b16 v[252:253], v30 offset:40960
    s_waitcnt vmcnt(6)
    v_max3_u32 v2, v136, v138, v140
    v_mfma_f32_16x16x32_bf16 v[40:43], v[168:171], v[128:131], v[40:43]
    ds_read_b64_tr_b16 v[242:243], v29 offset:41472
    v_max_u32 v2, v2, v142
    v_mfma_f32_16x16x32_bf16 v[56:59], v[168:171], v[132:135], v[56:59]
    ds_read_b64_tr_b16 v[246:247], v30 offset:41472
    v_cmp_eq_u32 vcc, -1, v2
    v_mfma_f32_16x16x32_bf16 v[44:47], v[172:175], v[128:131], v[44:47]
    ds_read_b64_tr_b16 v[250:251], v14 offset:41472
    s_waitcnt lgkmcnt(15)
    v_mfma_f32_16x16x32_bf16 v[60:63], v[172:175], v[132:135], v[60:63]
    ds_read_b64_tr_b16 v[254:255], v28 offset:41472
    s_cbranch_vccnz G2_R13
G2_OK13:
    v_mfma_f32_16x16x32_bf16 v[32:35], v[176:179], v[136:139], v[32:35]
    v_xor_b32 v28, 32, v12
    v_xor_b32 v29, 64, v12
    buffer_load_dwordx4 v[104:107], v0, s[28:31], s7 offen offset:1024 sc1
    v_mfma_f32_16x16x32_bf16 v[48:51], v[176:179], v[140:143], v[48:51]
    v_xor_b32 v30, 96, v12
    ds_read_b64_tr_b16 v[160:161], v12 offset:0
    buffer_load_dwordx4 v[108:111], v31, s[28:31], s7 offen offset:1024 sc1
    v_mfma_f32_16x16x32_bf16 v[36:39], v[180:183], v[136:139], v[36:39]
    ds_read_b64_tr_b16 v[164:165], v28 offset:0
    ds_read_b64_tr_b16 v[168:169], v29 offset:0
    v_mfma_f32_16x16x32_bf16 v[52:55], v[180:183], v[140:143], v[52:55]
    ds_read_b64_tr_b16 v[172:173], v30 offset:0
    s_waitcnt vmcnt(6)
    v_max3_u32 v2, v144, v146, v148
    v_mfma_f32_16x16x32_bf16 v[40:43], v[184:187], v[136:139], v[40:43]
    v_xor_b32 v28, 32, v15
    v_xor_b32 v29, 64, v15
    v_max_u32 v2, v2, v150
    v_mfma_f32_16x16x32_bf16 v[56:59], v[184:187], v[140:143], v[56:59]
    v_xor_b32 v30, 96, v15
    ds_read_b64_tr_b16 v[162:163], v15 offset:0
    v_cmp_eq_u32 vcc, -1, v2
    v_mfma_f32_16x16x32_bf16 v[44:47], v[188:191], v[136:139], v[44:47]
    ds_read_b64_tr_b16 v[166:167], v28 offset:0
    ds_read_b64_tr_b16 v[170:171], v29 offset:0
    s_waitcnt lgkmcnt(15)
    v_mfma_f32_16x16x32_bf16 v[60:63], v[188:191], v[140:143], v[60:63]
    ds_read_b64_tr_b16 v[174:175], v30 offset:0
    s_cbranch_vccnz G2_R14
G2_OK14:
    v_mfma_f32_16x16x32_bf16 v[32:35], v[192:195], v[144:147], v[32:35]
    v_xor_b32 v28, 32, v12
    v_xor_b32 v29, 64, v12
    buffer_load_dwordx4 v[112:115], v0, s[28:31], s92 offen offset:3072 sc1
    v_mfma_f32_16x16x32_bf16 v[48:51], v[192:195], v[148:151], v[48:51]
    v_xor_b32 v30, 96, v12
    ds_read_b64_tr_b16 v[176:177], v12 offset:40960
    buffer_load_dwordx4 v[116:119], v31, s[28:31], s92 offen offset:3072 sc1
    v_mfma_f32_16x16x32_bf16 v[36:39], v[196:199], v[144:147], v[36:39]
    ds_read_b64_tr_b16 v[180:181], v28 offset:40960
    ds_read_b64_tr_b16 v[184:185], v29 offset:40960
    v_mfma_f32_16x16x32_bf16 v[52:55], v[196:199], v[148:151], v[52:55]
    ds_read_b64_tr_b16 v[188:189], v30 offset:40960
    s_waitcnt vmcnt(6)
    v_max3_u32 v2, v152, v154, v156
    v_mfma_f32_16x16x32_bf16 v[40:43], v[200:203], v[144:147], v[40:43]
    v_xor_b32 v28, 32, v15
    v_xor_b32 v29, 64, v15
    v_max_u32 v2, v2, v158
    v_mfma_f32_16x16x32_bf16 v[56:59], v[200:203], v[148:151], v[56:59]
    v_xor_b32 v30, 96, v15
    ds_read_b64_tr_b16 v[178:179], v15 offset:40960
    v_cmp_eq_u32 vcc, -1, v2
    v_mfma_f32_16x16x32_bf16 v[44:47], v[204:207], v[144:147], v[44:47]
    ds_read_b64_tr_b16 v[182:183], v28 offset:40960
    ds_read_b64_tr_b16 v[186:187], v29 offset:40960
    s_waitcnt lgkmcnt(15)
    v_mfma_f32_16x16x32_bf16 v[60:63], v[204:207], v[148:151], v[60:63]
    ds_read_b64_tr_b16 v[190:191], v30 offset:40960
    s_cbranch_vccnz G2_R15
G2_OK15:
    v_mfma_f32_16x16x32_bf16 v[32:35], v[208:211], v[152:155], v[32:35]
    buffer_load_dwordx4 v[120:123], v0, s[28:31], s6 offen offset:3072 sc1
    v_mfma_f32_16x16x32_bf16 v[48:51], v[208:211], v[156:159], v[48:51]
    buffer_load_dwordx4 v[124:127], v31, s[28:31], s6 offen offset:3072 sc1
    v_mfma_f32_16x16x32_bf16 v[36:39], v[212:215], v[152:155], v[36:39]
    v_mfma_f32_16x16x32_bf16 v[52:55], v[212:215], v[156:159], v[52:55]
    s_waitcnt vmcnt(6)
    v_max3_u32 v2, v96, v98, v100
    v_mfma_f32_16x16x32_bf16 v[40:43], v[216:219], v[152:155], v[40:43]
    v_max_u32 v2, v2, v102
    v_mfma_f32_16x16x32_bf16 v[56:59], v[216:219], v[156:159], v[56:59]
    v_cmp_eq_u32 vcc, -1, v2
    v_mfma_f32_16x16x32_bf16 v[44:47], v[220:223], v[152:155], v[44:47]
    s_waitcnt lgkmcnt(15)
    v_mfma_f32_16x16x32_bf16 v[60:63], v[220:223], v[156:159], v[60:63]
    s_cbranch_vccnz G2_R16
G2_OK16:
    v_mfma_f32_16x16x32_bf16 v[32:35], v[224:227], v[96:99], v[32:35]
    v_mfma_f32_16x16x32_bf16 v[48:51], v[224:227], v[100:103], v[48:51]
    v_mfma_f32_16x16x32_bf16 v[36:39], v[228:231], v[96:99], v[36:39]
    v_mfma_f32_16x16x32_bf16 v[52:55], v[228:231], v[100:103], v[52:55]
    s_waitcnt vmcnt(4)
    v_max3_u32 v2, v104, v106, v108
    v_mfma_f32_16x16x32_bf16 v[40:43], v[232:235], v[96:99], v[40:43]
    v_max_u32 v2, v2, v110
    v_mfma_f32_16x16x32_bf16 v[56:59], v[232:235], v[100:103], v[56:59]
    v_cmp_eq_u32 vcc, -1, v2
    v_mfma_f32_16x16x32_bf16 v[44:47], v[236:239], v[96:99], v[44:47]
    s_waitcnt lgkmcnt(15)
    v_mfma_f32_16x16x32_bf16 v[60:63], v[236:239], v[100:103], v[60:63]
    s_cbranch_vccnz G2_R17
G2_OK17:
    v_mfma_f32_16x16x32_bf16 v[32:35], v[240:243], v[104:107], v[32:35]
    v_mfma_f32_16x16x32_bf16 v[48:51], v[240:243], v[108:111], v[48:51]
    v_mfma_f32_16x16x32_bf16 v[36:39], v[244:247], v[104:107], v[36:39]
    v_mfma_f32_16x16x32_bf16 v[52:55], v[244:247], v[108:111], v[52:55]
    s_waitcnt vmcnt(2)
    v_max3_u32 v2, v112, v114, v116
    v_mfma_f32_16x16x32_bf16 v[40:43], v[248:251], v[104:107], v[40:43]
    v_max_u32 v2, v2, v118
    v_mfma_f32_16x16x32_bf16 v[56:59], v[248:251], v[108:111], v[56:59]
    v_cmp_eq_u32 vcc, -1, v2
    v_mfma_f32_16x16x32_bf16 v[44:47], v[252:255], v[104:107], v[44:47]
    s_waitcnt lgkmcnt(8)
    v_mfma_f32_16x16x32_bf16 v[60:63], v[252:255], v[108:111], v[60:63]
    s_cbranch_vccnz G2_R18
G2_OK18:
    v_mfma_f32_16x16x32_bf16 v[32:35], v[160:163], v[112:115], v[32:35]
    ds_read_b64 v[24:25], v19 offset:8
    v_xor_b32 v28, 32, v8
    v_mfma_f32_16x16x32_bf16 v[48:51], v[160:163], v[116:119], v[48:51]
    v_xor_b32 v29, 64, v8
    v_mfma_f32_16x16x32_bf16 v[36:39], v[164:167], v[112:115], v[36:39]
    v_xor_b32 v30, 96, v8
    v_mfma_f32_16x16x32_bf16 v[52:55], v[164:167], v[116:119], v[52:55]
    s_lshl_b32 s60, s8, 11
    s_waitcnt vmcnt(0)
    v_max3_u32 v2, v120, v122, v124
    v_mfma_f32_16x16x32_bf16 v[40:43], v[168:171], v[112:115], v[40:43]
    s_add_u32 s61, s60, 147200
    v_max_u32 v2, v2, v126
    v_mfma_f32_16x16x32_bf16 v[56:59], v[168:171], v[116:119], v[56:59]
    v_add_u32 v17, s61, v6
    v_cmp_eq_u32 vcc, -1, v2
    v_mfma_f32_16x16x32_bf16 v[44:47], v[172:175], v[112:115], v[44:47]
    s_lshl1_add_u32 s60, s60, 81920
    s_waitcnt lgkmcnt(0)
    v_mfma_f32_16x16x32_bf16 v[60:63], v[172:175], v[116:119], v[60:63]
    v_add_u32 v20, s60, v6
    s_cbranch_vccnz G2_R19
G2_OK19:
    v_mfma_f32_16x16x32_bf16 v[32:35], v[176:179], v[120:123], v[32:35]
    v_and_b32 v3, v24, v25
    v_cmp_ne_u32 vcc, 0x01010101, v3
    v_mfma_f32_16x16x32_bf16 v[36:39], v[180:183], v[120:123], v[36:39]
    s_cbranch_vccnz G2_ZGR
G2_ZGOK:
    v_mfma_f32_16x16x32_bf16 v[40:43], v[184:187], v[120:123], v[40:43]
    ds_read_b128 v[192:195], v20 offset:0
    ds_read_b128 v[196:199], v20 offset:1024
    v_mfma_f32_16x16x32_bf16 v[44:47], v[188:191], v[120:123], v[44:47]
    ds_read_b128 v[200:203], v20 offset:2048
    ds_read_b128 v[204:207], v20 offset:3072
    v_mfma_f32_16x16x32_bf16 v[48:51], v[176:179], v[124:127], v[48:51]
    ds_read_b128 v[208:211], v20 offset:4096
    ds_read_b128 v[212:215], v20 offset:5120
    v_mfma_f32_16x16x32_bf16 v[52:55], v[180:183], v[124:127], v[52:55]
    ds_read_b128 v[216:219], v20 offset:6144
    ds_read_b128 v[220:223], v20 offset:7168
    v_mfma_f32_16x16x32_bf16 v[56:59], v[184:187], v[124:127], v[56:59]
    v_mfma_f32_16x16x32_bf16 v[60:63], v[188:191], v[124:127], v[60:63]
    s_waitcnt lgkmcnt(4)
    v_pk_fma_f32 v[64:65], v[32:33], v[192:193], v[64:65]
    v_pk_fma_f32 v[66:67], v[34:35], v[194:195], v[66:67]
    v_pk_fma_f32 v[68:69], v[36:37], v[196:197], v[68:69]
    v_pk_fma_f32 v[70:71], v[38:39], v[198:199], v[70:71]
    v_pk_fma_f32 v[72:73], v[40:41], v[200:201], v[72:73]
    v_pk_fma_f32 v[74:75], v[42:43], v[202:203], v[74:75]
    v_pk_fma_f32 v[76:77], v[44:45], v[204:205], v[76:77]
    v_pk_fma_f32 v[78:79], v[46:47], v[206:207], v[78:79]
    v_cvt_pk_bf16_f32 v96, v64, v65
    v_cvt_pk_bf16_f32 v97, v66, v67
    ds_write_b64 v8, v[96:97] offset:0
    v_cvt_pk_bf16_f32 v98, v68, v69
    v_cvt_pk_bf16_f32 v99, v70, v71
    ds_write_b64 v28, v[98:99] offset:0
    v_cvt_pk_bf16_f32 v100, v72, v73
    v_cvt_pk_bf16_f32 v101, v74, v75
    ds_write_b64 v29, v[100:101] offset:0
    v_cvt_pk_bf16_f32 v102, v76, v77
    v_cvt_pk_bf16_f32 v103, v78, v79
    ds_write_b64 v30, v[102:103] offset:0
    ds_read_b128 v[224:227], v17 offset:0
    ds_read_b128 v[228:231], v17 offset:1024
    s_cmp_eq_u32 s101, 1
    s_cbranch_scc1 G2_ONE
    s_waitcnt lgkmcnt(6)
    v_pk_fma_f32 v[80:81], v[48:49], v[208:209], v[80:81]
    v_pk_fma_f32 v[82:83], v[50:51], v[210:211], v[82:83]
    v_pk_fma_f32 v[84:85], v[52:53], v[212:213], v[84:85]
    v_pk_fma_f32 v[86:87], v[54:55], v[214:215], v[86:87]
    v_pk_fma_f32 v[88:89], v[56:57], v[216:217], v[88:89]
    v_pk_fma_f32 v[90:91], v[58:59], v[218:219], v[90:91]
    v_pk_fma_f32 v[92:93], v[60:61], v[220:221], v[92:93]
    v_pk_fma_f32 v[94:95], v[62:63], v[222:223], v[94:95]
    v_cvt_pk_bf16_f32 v104, v80, v81
    v_cvt_pk_bf16_f32 v105, v82, v83
    ds_write_b64 v8, v[104:105] offset:2048
    v_cvt_pk_bf16_f32 v106, v84, v85
    v_cvt_pk_bf16_f32 v107, v86, v87
    ds_write_b64 v28, v[106:107] offset:2048
    v_cvt_pk_bf16_f32 v108, v88, v89
    v_cvt_pk_bf16_f32 v109, v90, v91
    ds_write_b64 v29, v[108:109] offset:2048
    v_cvt_pk_bf16_f32 v110, v92, v93
    v_cvt_pk_bf16_f32 v111, v94, v95
    ds_write_b64 v30, v[110:111] offset:2048
    ds_read_b128 v[232:235], v17 offset:2048
    ds_read_b128 v[236:239], v17 offset:3072
    s_waitcnt lgkmcnt(7)
    buffer_store_dwordx4 v[224:227], v7, s[44:47], s97 offen sc1
    s_waitcnt lgkmcnt(6)
    buffer_store_dwordx4 v[228:231], v7, s[44:47], s94 offen sc1
    s_add_u32 s94, s94, 20480
    s_waitcnt lgkmcnt(1)
    buffer_store_dwordx4 v[232:235], v7, s[44:47], s94 offen sc1
    s_add_u32 s94, s94, 20480
    s_waitcnt lgkmcnt(0)
    buffer_store_dwordx4 v[236:239], v7, s[44:47], s94 offen sc1
    s_endpgm
G2_ONE:
    s_waitcnt lgkmcnt(1)
    buffer_store_dwordx4 v[224:227], v7, s[44:47], s97 offen sc1
    s_waitcnt lgkmcnt(0)
    buffer_store_dwordx4 v[228:231], v7, s[44:47], s94 offen sc1
    s_endpgm
K_P1:
TC5:
    s_cbranch_execz TC6
    ds_read_b128 v[240:243], v17 offset:0
    ds_read_b128 v[248:251], v17 offset:256
    ds_read_b64 v[48:49], v8 offset:0
    ds_read_b64 v[56:57], v8 offset:2048
    v_xor_b32 v100, 32, v8
    ds_read_b64 v[50:51], v100 offset:0
    ds_read_b64 v[58:59], v100 offset:2048
    v_xor_b32 v100, 64, v8
    ds_read_b64 v[52:53], v100 offset:0
    ds_read_b64 v[60:61], v100 offset:2048
    v_xor_b32 v100, 96, v8
    ds_read_b64 v[54:55], v100 offset:0
    ds_read_b64 v[62:63], v100 offset:2048
    s_waitcnt lgkmcnt(0)
    v_mul_f32 v240, v240, v242
    v_mul_f32 v244, 0xbfb8aa3b, v242
    v_mul_f32 v246, 0xbfb8aa3b, v240
    v_lshlrev_b32 v208, 16, v48
    v_and_b32 v209, 0xffff0000, v48
    v_lshlrev_b32 v210, 16, v49
    v_and_b32 v211, 0xffff0000, v49
    v_lshlrev_b32 v212, 16, v50
    v_and_b32 v213, 0xffff0000, v50
    v_lshlrev_b32 v214, 16, v51
    v_and_b32 v215, 0xffff0000, v51
    v_pk_fma_f32 v[100:101], v[208:209], v[244:245], v[246:247] op_sel_hi:[1,0,0]
    v_pk_fma_f32 v[102:103], v[210:211], v[244:245], v[246:247] op_sel_hi:[1,0,0]
    v_pk_fma_f32 v[104:105], v[212:213], v[244:245], v[246:247] op_sel_hi:[1,0,0]
    v_pk_fma_f32 v[106:107], v[214:215], v[244:245], v[246:247] op_sel_hi:[1,0,0]
    v_pk_fma_f32 v[208:209], v[208:209], v[242:243], v[240:241] op_sel_hi:[1,0,0]
    v_pk_fma_f32 v[210:211], v[210:211], v[242:243], v[240:241] op_sel_hi:[1,0,0]
    v_pk_fma_f32 v[212:213], v[212:213], v[242:243], v[240:241] op_sel_hi:[1,0,0]
    v_pk_fma_f32 v[214:215], v[214:215], v[242:243], v[240:241] op_sel_hi:[1,0,0]
    v_exp_f32 v100, v100
    v_exp_f32 v101, v101
    v_exp_f32 v102, v102
    v_exp_f32 v103, v103
    v_exp_f32 v104, v104
    v_exp_f32 v105, v105
    v_exp_f32 v106, v106
    v_exp_f32 v107, v107
    v_pk_add_f32 v[100:101], v[100:101], 1.0 op_sel_hi:[1,0]
    v_pk_add_f32 v[102:103], v[102:103], 1.0 op_sel_hi:[1,0]
    v_pk_add_f32 v[104:105], v[104:105], 1.0 op_sel_hi:[1,0]
    v_pk_add_f32 v[106:107], v[106:107], 1.0 op_sel_hi:[1,0]
    v_rcp_f32 v100, v100
    v_rcp_f32 v101, v101
    v_rcp_f32 v102, v102
    v_rcp_f32 v103, v103
    v_rcp_f32 v104, v104
    v_rcp_f32 v105, v105
    v_rcp_f32 v106, v106
    v_rcp_f32 v107, v107
    v_pk_mul_f32 v[208:209], v[208:209], v[100:101]
    v_pk_mul_f32 v[210:211], v[210:211], v[102:103]
    v_pk_mul_f32 v[212:213], v[212:213], v[104:105]
    v_pk_mul_f32 v[214:215], v[214:215], v[106:107]
    s_setpc_b64 s[20:21]
K_P2:
    v_lshlrev_b32 v216, 16, v52
    v_and_b32 v217, 0xffff0000, v52
    v_lshlrev_b32 v218, 16, v53
    v_and_b32 v219, 0xffff0000, v53
    v_lshlrev_b32 v220, 16, v54
    v_and_b32 v221, 0xffff0000, v54
    v_lshlrev_b32 v222, 16, v55
    v_and_b32 v223, 0xffff0000, v55
    v_pk_fma_f32 v[100:101], v[216:217], v[244:245], v[246:247] op_sel_hi:[1,0,0]
    v_pk_fma_f32 v[102:103], v[218:219], v[244:245], v[246:247] op_sel_hi:[1,0,0]
    v_pk_fma_f32 v[104:105], v[220:221], v[244:245], v[246:247] op_sel_hi:[1,0,0]
    v_pk_fma_f32 v[106:107], v[222:223], v[244:245], v[246:247] op_sel_hi:[1,0,0]
    v_pk_fma_f32 v[216:217], v[216:217], v[242:243], v[240:241] op_sel_hi:[1,0,0]
    v_pk_fma_f32 v[218:219], v[218:219], v[242:243], v[240:241] op_sel_hi:[1,0,0]
    v_pk_fma_f32 v[220:221], v[220:221], v[242:243], v[240:241] op_sel_hi:[1,0,0]
    v_pk_fma_f32 v[222:223], v[222:223], v[242:243], v[240:241] op_sel_hi:[1,0,0]
    v_exp_f32 v100, v100
    v_exp_f32 v101, v101
    v_exp_f32 v102, v102
    v_exp_f32 v103, v103
    v_exp_f32 v104, v104
    v_exp_f32 v105, v105
    v_exp_f32 v106, v106
    v_exp_f32 v107, v107
    v_pk_add_f32 v[100:101], v[100:101], 1.0 op_sel_hi:[1,0]
    v_pk_add_f32 v[102:103], v[102:103], 1.0 op_sel_hi:[1,0]
    v_pk_add_f32 v[104:105], v[104:105], 1.0 op_sel_hi:[1,0]
    v_pk_add_f32 v[106:107], v[106:107], 1.0 op_sel_hi:[1,0]
    v_rcp_f32 v100, v100
    v_rcp_f32 v101, v101
    v_rcp_f32 v102, v102
    v_rcp_f32 v103, v103
    v_rcp_f32 v104, v104
    v_rcp_f32 v105, v105
    v_rcp_f32 v106, v106
    v_rcp_f32 v107, v107
    v_pk_mul_f32 v[216:217], v[216:217], v[100:101]
    v_pk_mul_f32 v[218:219], v[218:219], v[102:103]
    v_pk_mul_f32 v[220:221], v[220:221], v[104:105]
    v_pk_mul_f32 v[222:223], v[222:223], v[106:107]
    s_setpc_b64 s[20:21]
P_TAIL:
TC6:
    s_cbranch_execz TC7
    s_setprio 0
    v_mov_b32 v2, 1
    ds_write_b8 v18, v2 offset:0
    s_cmp_eq_u32 s13, 1
    s_cbranch_scc1 P_ST
    s_call_b64 s[20:21], K_P1
    s_call_b64 s[20:21], K_P2
P_ST:
    ds_read_b64 v[22:23], v19 offset:40
    s_lshl_b32 s60, s8, 12
    s_add_u32 s60, s60, 81920
    v_add_u32 v20, s60, v6
    s_lshl_b32 s62, s101, 4
    s_mov_b32 s100, 0
    s_waitcnt lgkmcnt(0)
    v_readfirstlane_b32 s90, v22
    v_readfirstlane_b32 s91, v23
    s_lshl_b32 s67, s58, 2
    s_add_u32 s67, s67, 131072
    s_mov_b32 s68, 2
FIX_L:
    v_mov_b32 v45, v49
    v_mov_b32 v46, v50
    v_mov_b32 v47, v51
    v_mov_b32 v49, 114688
    s_not_b32 s60, s90
    s_bfe_u32 s61, s60, 655361
    s_and_b32 s60, s60, 1
    s_lshl_b32 s60, s60, 10
    s_add_u32 s60, s60, s61
    s_sub_u32 s63, s60, s95
    s_cmp_lt_u32 s63, s62
    s_cbranch_scc1 FIX_RUN
FIX_N:
    s_mov_b32 s90, s91
    s_add_u32 s67, s67, 138240
    s_sub_u32 s68, s68, 1
    s_cmp_lg_u32 s68, 0
    s_cbranch_scc1 FIX_L
    s_setprio 0
    s_cmp_lt_u32 s101, 2
    s_cbranch_scc1 P_NOB
    v_mul_f32 v248, v248, v250
    v_mul_f32 v252, 0xbfb8aa3b, v250
    v_mul_f32 v254, 0xbfb8aa3b, v248
    v_lshlrev_b32 v224, 16, v56
    v_and_b32 v225, 0xffff0000, v56
    v_lshlrev_b32 v226, 16, v57
    v_and_b32 v227, 0xffff0000, v57
    v_lshlrev_b32 v228, 16, v58
    v_and_b32 v229, 0xffff0000, v58
    v_lshlrev_b32 v230, 16, v59
    v_and_b32 v231, 0xffff0000, v59
    v_fma_f32 v100, v224, v252, v254
    v_fma_f32 v101, v225, v252, v254
    v_fma_f32 v102, v226, v252, v254
    v_fma_f32 v103, v227, v252, v254
    v_fma_f32 v104, v228, v252, v254
    v_fma_f32 v105, v229, v252, v254
    v_fma_f32 v106, v230, v252, v254
    v_fma_f32 v107, v231, v252, v254
    v_exp_f32 v100, v100
    v_fma_f32 v224, v224, v250, v248
    v_exp_f32 v101, v101
    v_fma_f32 v225, v225, v250, v248
    v_exp_f32 v102, v102
    v_fma_f32 v226, v226, v250, v248
    v_exp_f32 v103, v103
    v_fma_f32 v227, v227, v250, v248
    v_exp_f32 v104, v104
    v_fma_f32 v228, v228, v250, v248
    v_exp_f32 v105, v105
    v_fma_f32 v229, v229, v250, v248
    v_exp_f32 v106, v106
    v_fma_f32 v230, v230, v250, v248
    v_exp_f32 v107, v107
    v_fma_f32 v231, v231, v250, v248
    v_add_f32 v100, 1.0, v100
    v_add_f32 v101, 1.0, v101
    v_add_f32 v102, 1.0, v102
    v_add_f32 v103, 1.0, v103
    v_add_f32 v104, 1.0, v104
    v_add_f32 v105, 1.0, v105
    v_add_f32 v106, 1.0, v106
    v_add_f32 v107, 1.0, v107
    v_rcp_f32 v100, v100
    v_rcp_f32 v101, v101
    v_rcp_f32 v102, v102
    v_rcp_f32 v103, v103
    v_rcp_f32 v104, v104
    v_rcp_f32 v105, v105
    v_rcp_f32 v106, v106
    v_rcp_f32 v107, v107
    v_mul_f32 v224, v224, v100
    v_mul_f32 v225, v225, v101
    v_mul_f32 v226, v226, v102
    v_mul_f32 v227, v227, v103
    v_mul_f32 v228, v228, v104
    v_mul_f32 v229, v229, v105
    v_mul_f32 v230, v230, v106
    v_mul_f32 v231, v231, v107
    v_lshlrev_b32 v232, 16, v60
    v_and_b32 v233, 0xffff0000, v60
    v_lshlrev_b32 v234, 16, v61
    v_and_b32 v235, 0xffff0000, v61
    v_lshlrev_b32 v236, 16, v62
    v_and_b32 v237, 0xffff0000, v62
    v_lshlrev_b32 v238, 16, v63
    v_and_b32 v239, 0xffff0000, v63
    v_fma_f32 v100, v232, v252, v254
    v_fma_f32 v101, v233, v252, v254
    v_fma_f32 v102, v234, v252, v254
    v_fma_f32 v103, v235, v252, v254
    v_fma_f32 v104, v236, v252, v254
    v_fma_f32 v105, v237, v252, v254
    v_fma_f32 v106, v238, v252, v254
    v_fma_f32 v107, v239, v252, v254
    v_exp_f32 v100, v100
    v_fma_f32 v232, v232, v250, v248
    v_exp_f32 v101, v101
    v_fma_f32 v233, v233, v250, v248
    v_exp_f32 v102, v102
    v_fma_f32 v234, v234, v250, v248
    v_exp_f32 v103, v103
    v_fma_f32 v235, v235, v250, v248
    v_exp_f32 v104, v104
    v_fma_f32 v236, v236, v250, v248
    v_exp_f32 v105, v105
    v_fma_f32 v237, v237, v250, v248
    v_exp_f32 v106, v106
    v_fma_f32 v238, v238, v250, v248
    v_exp_f32 v107, v107
    v_fma_f32 v239, v239, v250, v248
    v_add_f32 v100, 1.0, v100
    v_add_f32 v101, 1.0, v101
    v_add_f32 v102, 1.0, v102
    v_add_f32 v103, 1.0, v103
    v_add_f32 v104, 1.0, v104
    v_add_f32 v105, 1.0, v105
    v_add_f32 v106, 1.0, v106
    v_add_f32 v107, 1.0, v107
    v_rcp_f32 v100, v100
    v_rcp_f32 v101, v101
    v_rcp_f32 v102, v102
    v_rcp_f32 v103, v103
    v_rcp_f32 v104, v104
    v_rcp_f32 v105, v105
    v_rcp_f32 v106, v106
    v_rcp_f32 v107, v107
    v_mul_f32 v232, v232, v100
    v_mul_f32 v233, v233, v101
    v_mul_f32 v234, v234, v102
    v_mul_f32 v235, v235, v103
    v_mul_f32 v236, v236, v104
    v_mul_f32 v237, v237, v105
    v_mul_f32 v238, v238, v106
    v_mul_f32 v239, v239, v107
P_NOB:
    s_mov_b32 s100, 0
    ds_read_b64 v[2:3], v19 offset:0
P_Z:
    s_waitcnt lgkmcnt(0)
    v_and_b32 v2, v2, v3
    v_cmp_ne_u32 vcc, 0x01010101, v2
    s_cbranch_vccnz P_ZR
P_ZOK:
    ds_write_b128 v20, v[208:211] offset:0
    ds_write_b128 v20, v[212:215] offset:1024
    ds_write_b128 v20, v[216:219] offset:2048
    ds_write_b128 v20, v[220:223] offset:3072
    ds_write_b128 v20, v[224:227] offset:4096
    ds_write_b128 v20, v[228:231] offset:5120
    ds_write_b128 v20, v[232:235] offset:6144
    ds_write_b128 v20, v[236:239] offset:7168
    s_mov_b32 exec_hi, 0
    ds_write_b64 v49, v[50:51]
    ds_write_b64 v45, v[46:47]
    v_mov_b32 v2, 1
    ds_write_b8 v18, v2 offset:8
    s_endpgm
FIX_RUN:
    s_setprio 3
    v_lshrrev_b32 v48, 5, v1
    v_mul_u32_u24 v48, 4608, v48
    v_add_u32 v48, v48, v6
    v_mov_b32 v116, 0
    v_mov_b32 v117, s52
    v_mov_b32 v118, 0
    v_mov_b32 v119, s52
    s_add_u32 s60, s67, 0
    buffer_load_dwordx4 v[64:67], v48, s[28:31], s60 offen sc1
    s_add_u32 s60, s67, 10240
    buffer_load_dwordx4 v[68:71], v48, s[28:31], s60 offen sc1
    s_add_u32 s60, s67, 20480
    buffer_load_dwordx4 v[72:75], v48, s[28:31], s60 offen sc1
    s_add_u32 s60, s67, 30720
    buffer_load_dwordx4 v[76:79], v48, s[28:31], s60 offen sc1
    s_add_u32 s60, s67, 40960
    buffer_load_dwordx4 v[80:83], v48, s[28:31], s60 offen sc1
    s_add_u32 s60, s67, 51200
    buffer_load_dwordx4 v[84:87], v48, s[28:31], s60 offen sc1
    s_add_u32 s60, s67, 61440
    buffer_load_dwordx4 v[88:91], v48, s[28:31], s60 offen sc1
    s_add_u32 s60, s67, 71680
    buffer_load_dwordx4 v[92:95], v48, s[28:31], s60 offen sc1
    s_add_u32 s60, s67, 81920
    buffer_load_dwordx4 v[96:99], v48, s[28:31], s60 offen sc1
    s_add_u32 s60, s67, 92160
    buffer_load_dwordx4 v[100:103], v48, s[28:31], s60 offen sc1
    s_add_u32 s60, s67, 102400
    buffer_load_dwordx4 v[104:107], v48, s[28:31], s60 offen sc1
    s_add_u32 s60, s67, 112640
    buffer_load_dwordx4 v[108:111], v48, s[28:31], s60 offen sc1
    s_add_u32 s60, s67, 122880
    buffer_load_dwordx4 v[112:115], v48, s[28:31], s60 offen sc1
    s_add_u32 s60, s67, 133120
    s_mov_b32 exec_hi, 0
    buffer_load_dwordx4 v[116:119], v48, s[28:31], s60 offen sc1
    s_mov_b32 exec_hi, -1
    s_lshl4_add_u32 s64, s8, s63
    s_lshl_b32 s60, s64, 4
    s_add_u32 s60, s60, 161536
    v_mov_b32 v2, s60
    ds_read_b96 v[52:54], v2
    v_bfe_u32 v2, v1, 2, 3
    s_and_b32 s60, s64, 7
    v_xor_b32 v2, s60, v2
    v_and_b32 v3, 3, v1
    v_lshl_add_u32 v2, v2, 2, v3
    s_lshl_b32 s60, s64, 7
    s_add_u32 s60, s60, 147200
    v_lshl_add_u32 v2, v2, 2, s60
    ds_read_b32 v50, v2
    s_ashr_i32 s60, s90, 31
    s_orn2_b32 s60, 0x80000000, s60
    s_xor_b32 s60, s60, s90
    s_and_b32 s60, s60, s55
    v_mov_b32 v55, 0xbfb8aa3b
    v_mul_f32 v55, s60, v55
    v_exp_f32 v55, v55
    s_nop 0
    v_add_f32 v55, 1.0, v55
    v_rcp_f32 v55, v55
    s_nop 0
    v_cvt_pk_bf16_f32 v55, v55, v55
    v_lshlrev_b32 v55, 16, v55
    s_lshr_b32 s60, s64, 4
    s_lshl_b32 s60, s60, 12
    s_and_b32 s61, s64, 15
    s_lshl4_add_u32 s60, s61, s60
    s_add_u32 s60, s60, 81920
    v_lshrrev_b32 v49, 1, v1
    v_lshl_add_u32 v49, v49, 8, s60
    v_and_b32 v3, 1, v1
    v_lshl_add_u32 v49, v3, 3, v49
    s_waitcnt lgkmcnt(0)
    v_and_b32 v51, 0xffff0000, v50
    v_lshlrev_b32 v50, 16, v50
    v_add_f32 v50, v50, v52
    v_add_f32 v51, v51, v52
    v_cvt_pk_bf16_f32 v3, v50, v51
    v_lshlrev_b32 v50, 16, v3
    v_and_b32 v51, s55, v3
    v_mul_f32 v50, v50, v54
    v_mul_f32 v51, v51, v54
    v_cvt_pk_bf16_f32 v3, v50, v51
    v_lshlrev_b32 v50, 16, v3
    v_and_b32 v51, s55, v3
    s_waitcnt vmcnt(0)
FIX_Y_CHK:
    v_xor_b32 v2, s52, v65
    v_bitop3_b32 v2, v67, s52, v2 bitop3:0xbe
    v_bitop3_b32 v2, v69, s52, v2 bitop3:0xbe
    v_bitop3_b32 v2, v71, s52, v2 bitop3:0xbe
    v_bitop3_b32 v2, v73, s52, v2 bitop3:0xbe
    v_bitop3_b32 v2, v75, s52, v2 bitop3:0xbe
    v_bitop3_b32 v2, v77, s52, v2 bitop3:0xbe
    v_bitop3_b32 v2, v79, s52, v2 bitop3:0xbe
    v_bitop3_b32 v2, v81, s52, v2 bitop3:0xbe
    v_bitop3_b32 v2, v83, s52, v2 bitop3:0xbe
    v_bitop3_b32 v2, v85, s52, v2 bitop3:0xbe
    v_bitop3_b32 v2, v87, s52, v2 bitop3:0xbe
    v_bitop3_b32 v2, v89, s52, v2 bitop3:0xbe
    v_bitop3_b32 v2, v91, s52, v2 bitop3:0xbe
    v_bitop3_b32 v2, v93, s52, v2 bitop3:0xbe
    v_bitop3_b32 v2, v95, s52, v2 bitop3:0xbe
    v_bitop3_b32 v2, v97, s52, v2 bitop3:0xbe
    v_bitop3_b32 v2, v99, s52, v2 bitop3:0xbe
    v_bitop3_b32 v2, v101, s52, v2 bitop3:0xbe
    v_bitop3_b32 v2, v103, s52, v2 bitop3:0xbe
    v_bitop3_b32 v2, v105, s52, v2 bitop3:0xbe
    v_bitop3_b32 v2, v107, s52, v2 bitop3:0xbe
    v_bitop3_b32 v2, v109, s52, v2 bitop3:0xbe
    v_bitop3_b32 v2, v111, s52, v2 bitop3:0xbe
    v_bitop3_b32 v2, v113, s52, v2 bitop3:0xbe
    v_bitop3_b32 v2, v115, s52, v2 bitop3:0xbe
    v_bitop3_b32 v2, v117, s52, v2 bitop3:0xbe
    v_bitop3_b32 v2, v119, s52, v2 bitop3:0xbe
    v_cmp_ne_u32 vcc, 0, v2
    s_cbranch_vccz FIX_Y_OK
FIX_Y_RETRY:
    s_add_u32 s100, s100, 1
    s_cmp_gt_u32 s100, 20000
    s_cbranch_scc1 FIX_Y_OK
    s_sleep 8
    s_add_u32 s60, s67, 0
    buffer_load_dwordx4 v[64:67], v48, s[28:31], s60 offen sc1
    s_add_u32 s60, s67, 10240
    buffer_load_dwordx4 v[68:71], v48, s[28:31], s60 offen sc1
    s_add_u32 s60, s67, 20480
    buffer_load_dwordx4 v[72:75], v48, s[28:31], s60 offen sc1
    s_add_u32 s60, s67, 30720
    buffer_load_dwordx4 v[76:79], v48, s[28:31], s60 offen sc1
    s_add_u32 s60, s67, 40960
    buffer_load_dwordx4 v[80:83], v48, s[28:31], s60 offen sc1
    s_add_u32 s60, s67, 51200
    buffer_load_dwordx4 v[84:87], v48, s[28:31], s60 offen sc1
    s_add_u32 s60, s67, 61440
    buffer_load_dwordx4 v[88:91], v48, s[28:31], s60 offen sc1
    s_add_u32 s60, s67, 71680
    buffer_load_dwordx4 v[92:95], v48, s[28:31], s60 offen sc1
    s_add_u32 s60, s67, 81920
    buffer_load_dwordx4 v[96:99], v48, s[28:31], s60 offen sc1
    s_add_u32 s60, s67, 92160
    buffer_load_dwordx4 v[100:103], v48, s[28:31], s60 offen sc1
    s_add_u32 s60, s67, 102400
    buffer_load_dwordx4 v[104:107], v48, s[28:31], s60 offen sc1
    s_add_u32 s60, s67, 112640
    buffer_load_dwordx4 v[108:111], v48, s[28:31], s60 offen sc1
    s_add_u32 s60, s67, 122880
    buffer_load_dwordx4 v[112:115], v48, s[28:31], s60 offen sc1
    s_add_u32 s60, s67, 133120
    s_mov_b32 exec_hi, 0
    buffer_load_dwordx4 v[116:119], v48, s[28:31], s60 offen sc1
    s_mov_b32 exec_hi, -1
    s_waitcnt vmcnt(0)
    s_branch FIX_Y_CHK
FIX_Y_OK:
    v_add_f32 v64, v64, v68
    v_add_f32 v66, v66, v70
    v_add_f32 v64, v64, v72
    v_add_f32 v66, v66, v74
    v_add_f32 v64, v64, v76
    v_add_f32 v66, v66, v78
    v_add_f32 v64, v64, v80
    v_add_f32 v66, v66, v82
    v_add_f32 v64, v64, v84
    v_add_f32 v66, v66, v86
    v_add_f32 v64, v64, v88
    v_add_f32 v66, v66, v90
    v_add_f32 v64, v64, v92
    v_add_f32 v66, v66, v94
    v_add_f32 v64, v64, v96
    v_add_f32 v66, v66, v98
    v_add_f32 v64, v64, v100
    v_add_f32 v66, v66, v102
    v_add_f32 v64, v64, v104
    v_add_f32 v66, v66, v106
    v_add_f32 v64, v64, v108
    v_add_f32 v66, v66, v110
    v_add_f32 v64, v64, v112
    v_add_f32 v66, v66, v114
    v_add_f32 v64, v64, v116
    v_add_f32 v66, v66, v118
    v_mov_b32 v65, v66
    v_mov_b32 v66, v64
    v_mov_b32 v67, v65
    s_nop 0
    v_permlane32_swap_b32 v64, v66
    v_permlane32_swap_b32 v65, v67
    v_add_f32 v64, v64, v66
    v_add_f32 v65, v65, v67
    v_cvt_pk_bf16_f32 v3, v64, v65
    v_lshlrev_b32 v64, 16, v3
    v_and_b32 v65, s55, v3
    v_mul_f32 v64, v64, v55
    v_mul_f32 v65, v65, v55
    v_cvt_pk_bf16_f32 v3, v64, v65
    v_lshlrev_b32 v64, 16, v3
    v_and_b32 v65, s55, v3
    v_add_f32 v50, v50, v64
    v_add_f32 v51, v51, v65
    v_cvt_pk_bf16_f32 v3, v50, v51
    v_lshlrev_b32 v50, 16, v3
    v_and_b32 v51, s55, v3
    v_mul_f32 v64, 0xbfb8aa3b, v50
    v_mul_f32 v65, 0xbfb8aa3b, v51
    v_exp_f32 v64, v64
    v_exp_f32 v65, v65
    v_add_f32 v64, 1.0, v64
    v_add_f32 v65, 1.0, v65
    v_rcp_f32 v64, v64
    v_rcp_f32 v65, v65
    v_mul_f32 v50, v50, v64
    v_mul_f32 v51, v51, v65
    s_branch FIX_N
L_CONT:
    s_lshr_b32 s64, 4099, s67
    s_and_b32 s64, s64, 15
    s_cmp_ge_u32 s64, 3
    s_cselect_b32 s65, s68, 0
    s_add_u32 s64, s64, s65
    s_cmp_ge_u32 s64, 10
    s_cselect_b32 s65, 7, 0
    s_sub_u32 s64, s64, s65
    s_mul_i32 s65, s64, 245760
    s_lshl_b32 s64, s64, 7
    s_add_u32 s64, s64, s57
    s_add_u32 m0, s69, 0
    s_mov_b32 exec_lo, s70
    buffer_load_dwordx4 v196, s[24:27], s64 offen lds
    s_add_u32 m0, s69, 4096
    s_mov_b32 exec_lo, -1
    buffer_load_dwordx4 v197, s[24:27], s64 offen lds
    s_add_u32 m0, s69, 8192
    s_add_u32 s65, s65, s58
    buffer_load_dwordx4 v198, s[24:27], s64 offen lds
    s_cbranch_vccz L_SK1
    s_add_u32 m0, s69, 12288
    s_nop 0
    buffer_load_dwordx4 v199, s[24:27], s64 offen lds
L_SK1:
    s_add_u32 m0, s69, 14336
    s_add_u32 s66, s65, 122880
    buffer_load_dwordx4 v200, s[32:35], s65 offen offset:0 lds
    s_add_u32 m0, s69, 21248
    s_nop 0
    buffer_load_dwordx4 v200, s[32:35], s65 offen offset:1280 lds
    s_add_u32 m0, s69, 28160
    s_nop 0
    buffer_load_dwordx4 v200, s[32:35], s65 offen offset:2560 lds
    s_add_u32 m0, s69, 18432
    s_nop 0
    buffer_load_dwordx4 v200, s[32:35], s66 offen offset:0 lds
    s_add_u32 m0, s69, 25344
    s_nop 0
    buffer_load_dwordx4 v200, s[32:35], s66 offen offset:1280 lds
    s_add_u32 m0, s69, 32256
    s_nop 0
    buffer_load_dwordx4 v200, s[32:35], s66 offen offset:2560 lds
    s_mul_i32 s60, s3, 5
    s_lshl_b32 s61, s53, 6
    s_add_u32 s60, s60, s61
    s_add_u32 s60, s60, K_TAB-K_PC
    s_load_dwordx16 s[4:19], s[20:21], s60
    s_load_dwordx2 s[44:45], s[0:1], 64
    s_load_dwordx2 s[40:41], s[0:1], 16
    s_mov_b32 s46, 2621440
    s_mov_b32 s47, 0x20000
    s_mov_b32 s30, 7077888
    s_mov_b32 s31, 0x20000
    s_mov_b32 s42, 819200
    s_mov_b32 s43, 0x20000
    s_lshr_b32 s3, s3, 6
    s_and_b32 s59, s3, 3
    s_mov_b32 s55, 0xffff0000
    s_mov_b32 s100, 0
    v_and_b32 v1, 63, v0
    v_and_b32 v4, 15, v1
    v_lshrrev_b32 v5, 4, v1
    v_mov_b32 v19, 163584
    v_add_u32 v18, s3, v19
    s_cbranch_vccz L_W0a
    s_waitcnt vmcnt(10)
    s_branch L_W0b
L_W0a:
    s_waitcnt vmcnt(9)
L_W0b:
    s_barrier
    s_lshr_b32 s64, 139585, s67
    s_and_b32 s64, s64, 15
    s_cmp_ge_u32 s64, 3
    s_cselect_b32 s65, s68, 0
    s_add_u32 s64, s64, s65
    s_cmp_ge_u32 s64, 10
    s_cselect_b32 s65, 7, 0
    s_sub_u32 s64, s64, s65
    s_mul_i32 s65, s64, 245760
    s_lshl_b32 s64, s64, 7
    s_add_u32 s64, s64, s57
    s_add_u32 m0, s69, 38912
    s_mov_b32 exec_lo, s70
    buffer_load_dwordx4 v196, s[24:27], s64 offen lds
    s_add_u32 m0, s69, 43008
    s_mov_b32 exec_lo, -1
    buffer_load_dwordx4 v197, s[24:27], s64 offen lds
    s_add_u32 m0, s69, 47104
    s_add_u32 s65, s65, s58
    buffer_load_dwordx4 v198, s[24:27], s64 offen lds
    s_cbranch_vccz L_SK2
    s_add_u32 m0, s69, 51200
    s_nop 0
    buffer_load_dwordx4 v199, s[24:27], s64 offen lds
L_SK2:
    s_add_u32 m0, s69, 53248
    s_add_u32 s66, s65, 122880
    buffer_load_dwordx4 v200, s[32:35], s65 offen offset:0 lds
    v_lshlrev_b32 v6, 4, v1
    v_mov_b32 v28, 0x3f803f80
    v_mov_b32 v29, 0x3f803f80
    v_mov_b32 v30, 0x3f803f80
    v_mov_b32 v31, 0x3f803f80
    s_add_u32 m0, s69, 60160
    s_nop 0
    buffer_load_dwordx4 v200, s[32:35], s65 offen offset:1280 lds
    v_lshlrev_b32 v2, 2, v5
    v_sub_u32 v3, v4, v2
    v_add_u32 v3, 12, v3
    s_mov_b32 s60, 267390975
    v_bfe_i32 v32, s60, v3, 1
    s_add_u32 m0, s69, 67072
    s_nop 0
    buffer_load_dwordx4 v200, s[32:35], s65 offen offset:2560 lds
    v_and_b32 v32, 0xff800000, v32
    s_mov_b32 s60, 268435440
    v_bfe_i32 v36, s60, v3, 1
    v_and_b32 v36, 0xff800000, v36
    s_mov_b32 s60, 266346495
    s_add_u32 m0, s69, 57344
    s_nop 0
    buffer_load_dwordx4 v200, s[32:35], s66 offen offset:0 lds
    v_bfe_i32 v33, s60, v3, 1
    v_and_b32 v33, 0xff800000, v33
    s_mov_b32 s60, 268435424
    v_bfe_i32 v37, s60, v3, 1
    v_and_b32 v37, 0xff800000, v37
    s_add_u32 m0, s69, 64256
    s_nop 0
    buffer_load_dwordx4 v200, s[32:35], s66 offen offset:1280 lds
    s_mov_b32 s60, 264257535
    v_bfe_i32 v34, s60, v3, 1
    v_and_b32 v34, 0xff800000, v34
    s_mov_b32 s60, 268435392
    v_bfe_i32 v38, s60, v3, 1
    s_add_u32 m0, s69, 71168
    s_nop 0
    buffer_load_dwordx4 v200, s[32:35], s66 offen offset:2560 lds
    v_and_b32 v38, 0xff800000, v38
    s_mov_b32 s60, 260079615
    v_bfe_i32 v35, s60, v3, 1
    v_and_b32 v35, 0xff800000, v35
    s_waitcnt vmcnt(9)
    s_barrier
    s_lshr_b32 s64, 217890, s67
    s_and_b32 s64, s64, 15
    s_cmp_ge_u32 s64, 3
    s_cselect_b32 s65, s68, 0
    s_add_u32 s64, s64, s65
    s_cmp_ge_u32 s64, 10
    s_cselect_b32 s65, 7, 0
    s_sub_u32 s64, s64, s65
    s_mul_i32 s65, s64, 245760
    s_lshl_b32 s64, s64, 7
    s_add_u32 s64, s64, s57
    s_add_u32 m0, s69, 77824
    s_mov_b32 exec_lo, s70
    buffer_load_dwordx4 v196, s[24:27], s64 offen lds
    s_add_u32 m0, s69, 81920
    s_mov_b32 exec_lo, -1
    buffer_load_dwordx4 v197, s[24:27], s64 offen lds
    s_add_u32 m0, s69, 86016
    s_add_u32 s65, s65, s58
    buffer_load_dwordx4 v198, s[24:27], s64 offen lds
    s_cbranch_vccz L_SK3
    s_add_u32 m0, s69, 90112
    s_nop 0
    buffer_load_dwordx4 v199, s[24:27], s64 offen lds
L_SK3:
    s_add_u32 m0, s69, 92160
    s_add_u32 s66, s65, 122880
    buffer_load_dwordx4 v200, s[32:35], s65 offen offset:0 lds
    s_mov_b32 s60, 268435328
    v_bfe_i32 v39, s60, v3, 1
    v_and_b32 v39, 0xff800000, v39
    v_sub_u32 v2, 13, v3
    v_med3_i32 v2, v2, 0, 2
    s_add_u32 m0, s69, 99072
    s_nop 0
    buffer_load_dwordx4 v200, s[32:35], s65 offen offset:1280 lds
    v_lshlrev_b32 v2, 3, v2
    v_mov_b32 v40, -1
    v_lshrrev_b32 v40, v2, v40
    v_lshrrev_b32 v40, v2, v40
    v_sub_u32 v2, 15, v3
    s_add_u32 m0, s69, 105984
    s_nop 0
    buffer_load_dwordx4 v200, s[32:35], s65 offen offset:2560 lds
    v_med3_i32 v2, v2, 0, 2
    v_lshlrev_b32 v2, 3, v2
    v_mov_b32 v41, -1
    v_lshrrev_b32 v41, v2, v41
    v_lshrrev_b32 v41, v2, v41
    s_add_u32 m0, s69, 96256
    s_nop 0
    buffer_load_dwordx4 v200, s[32:35], s66 offen offset:0 lds
    s_ashr_i32 s60, s56, 31
    s_and_b32 s60, s60, 0xff800000
    v_lshrrev_b32 v2, 3, v1
    v_bfe_i32 v2, 10, v2, 1
    v_and_b32 v2, s60, v2
    s_add_u32 m0, s69, 103168
    s_nop 0
    buffer_load_dwordx4 v200, s[32:35], s66 offen offset:1280 lds
    v_or_b32 v42, v32, v2
    v_or_b32 v43, v33, v2
    v_or_b32 v44, v34, v2
    v_or_b32 v45, v35, v2
    v_mul_u32_u24 v25, 20224, v5
    s_add_u32 m0, s69, 110080
    s_nop 0
    buffer_load_dwordx4 v200, s[32:35], s66 offen offset:2560 lds
    v_add_u32 v25, v25, v6
    v_lshrrev_b32 v24, 5, v1
    v_mul_u32_u24 v24, 19968, v24
    v_add_u32 v24, v24, v6
    v_lshlrev_b32 v26, 4, v4
    s_waitcnt vmcnt(9)
    s_barrier
    s_lshr_b32 s64, 406580, s67
    s_and_b32 s64, s64, 15
    s_add_u32 s64, s64, s68
    s_cmp_ge_u32 s64, 10
    s_cselect_b32 s65, 7, 0
    s_sub_u32 s64, s64, s65
    s_mul_i32 s65, s64, 245760
    s_lshl_b32 s64, s64, 7
    s_add_u32 s64, s64, s57
    s_add_u32 m0, s69, 0
    s_mov_b32 exec_lo, s70
    buffer_load_dwordx4 v196, s[24:27], s64 offen lds
    s_add_u32 m0, s69, 4096
    s_mov_b32 exec_lo, -1
    buffer_load_dwordx4 v197, s[24:27], s64 offen lds
    s_add_u32 m0, s69, 8192
    s_add_u32 s65, s65, s58
    buffer_load_dwordx4 v198, s[24:27], s64 offen lds
    s_cbranch_vccz L_SK4
    s_add_u32 m0, s69, 12288
    s_nop 0
    buffer_load_dwordx4 v199, s[24:27], s64 offen lds
L_SK4:
    s_add_u32 m0, s69, 14336
    s_add_u32 s66, s65, 122880
    buffer_load_dwordx4 v200, s[32:35], s65 offen offset:0 lds
    v_add_u32 v26, 161544, v26
    v_bfe_u32 v2, v1, 2, 2
    v_lshlrev_b32 v2, 7, v2
    v_and_b32 v3, 8, v1
    v_lshl_add_u32 v2, v3, 2, v2
    s_add_u32 m0, s69, 21248
    s_nop 0
    buffer_load_dwordx4 v200, s[32:35], s65 offen offset:1280 lds
    v_and_b32 v3, 3, v1
    v_lshl_add_u32 v2, v3, 3, v2
    v_and_b32 v3, 48, v1
    s_mov_b32 s62, 0xffff
    s_mov_b32 s60, 201329216
    s_add_u32 m0, s69, 28160
    s_nop 0
    buffer_load_dwordx4 v200, s[32:35], s65 offen offset:2560 lds
    s_mov_b32 s61, 373298176
    v_lshrrev_b64 v[46:47], v3, s[60:61]
    v_and_or_b32 v9, v46, s62, v2
    s_mov_b32 s60, 37748736
    s_mov_b32 s61, 2550175296
    s_add_u32 m0, s69, 18432
    s_nop 0
    buffer_load_dwordx4 v200, s[32:35], s66 offen offset:0 lds
    v_lshrrev_b64 v[46:47], v3, s[60:61]
    v_and_or_b32 v10, v46, s62, v2
    s_mov_b32 s60, 469766720
    s_mov_b32 s61, 977285120
    v_lshrrev_b64 v[46:47], v3, s[60:61]
    s_add_u32 m0, s69, 25344
    s_nop 0
    buffer_load_dwordx4 v200, s[32:35], s66 offen offset:1280 lds
    v_and_or_b32 v11, v46, s62, v2
    s_mov_b32 s60, 2483063360
    s_mov_b32 s61, 2654996480
    v_lshrrev_b64 v[46:47], v3, s[60:61]
    v_and_or_b32 v12, v46, s62, v2
    s_add_u32 m0, s69, 32256
    s_nop 0
    buffer_load_dwordx4 v200, s[32:35], s66 offen offset:2560 lds
    s_mov_b32 s60, 574627840
    s_mov_b32 s61, 2051045376
    v_lshrrev_b64 v[46:47], v3, s[60:61]
    v_and_or_b32 v13, v46, s62, v2
    s_mov_b32 s60, 1073757184
    s_add_u32 m0, s69, 147200
    s_add_u32 s64, s58, s57
    buffer_load_dwordx4 v196, s[24:27], s64 offen lds
    s_waitcnt vmcnt(10)
    s_barrier
    s_lshr_b32 s64, 280405, s67
    s_and_b32 s64, s64, 15
    s_add_u32 s64, s64, s68
    s_cmp_ge_u32 s64, 10
    s_cselect_b32 s65, 7, 0
    s_sub_u32 s64, s64, s65
    s_mul_i32 s65, s64, 245760
    s_lshl_b32 s64, s64, 7
    s_add_u32 s64, s64, s57
    s_add_u32 m0, s69, 38912
    s_mov_b32 exec_lo, s70
    buffer_load_dwordx4 v196, s[24:27], s64 offen lds
    s_add_u32 m0, s69, 43008
    s_mov_b32 exec_lo, -1
    buffer_load_dwordx4 v197, s[24:27], s64 offen lds
    s_add_u32 m0, s69, 47104
    s_add_u32 s65, s65, s58
    buffer_load_dwordx4 v198, s[24:27], s64 offen lds
    s_cbranch_vccz L_SK5
    s_add_u32 m0, s69, 51200
    s_nop 0
    buffer_load_dwordx4 v199, s[24:27], s64 offen lds
L_SK5:
    s_add_u32 m0, s69, 53248
    s_add_u32 s66, s65, 122880
    buffer_load_dwordx4 v200, s[32:35], s65 offen offset:0 lds
    s_mov_b32 s61, 1610635840
    v_lshrrev_b64 v[46:47], v3, s[60:61]
    v_and_or_b32 v14, v46, s62, v2
    s_mov_b32 s60, 1140858432
    s_mov_b32 s61, 2147507776
    s_add_u32 m0, s69, 60160
    s_nop 0
    buffer_load_dwordx4 v200, s[32:35], s65 offen offset:1280 lds
    v_lshrrev_b64 v[46:47], v3, s[60:61]
    v_and_or_b32 v15, v46, s62, v2
    v_lshrrev_b32 v2, 3, v1
    v_bitop3_b32 v3, v1, v2, 7 bitop3:0x28
    v_mul_u32_u24 v7, 2560, v2
    s_add_u32 m0, s69, 67072
    s_nop 0
    buffer_load_dwordx4 v200, s[32:35], s65 offen offset:2560 lds
    v_lshl_add_u32 v7, v3, 4, v7
    v_lshrrev_b32 v2, 5, v1
    v_bitop3_b32 v2, v2, v4, 7 bitop3:0x28
    v_lshlrev_b32 v8, 7, v4
    v_lshl_add_u32 v8, v2, 4, v8
    s_add_u32 m0, s69, 57344
    s_nop 0
    buffer_load_dwordx4 v200, s[32:35], s66 offen offset:0 lds
    v_and_b32 v2, 1, v5
    v_lshl_add_u32 v8, v2, 3, v8
    v_bfe_u32 v2, v0, 3, 5
    v_and_b32 v3, 6, v2
    v_bitop3_b32 v3, v0, v3, 7 bitop3:0x28
    s_add_u32 m0, s69, 64256
    s_nop 0
    buffer_load_dwordx4 v200, s[32:35], s66 offen offset:1280 lds
    v_mul_u32_u24 v16, 1280, v2
    v_lshl_add_u32 v16, v3, 4, v16
    s_lshl_b32 s98, s56, 4
    s_mul_i32 s60, s57, 13
    s_add_u32 s98, s98, s60
    s_add_u32 m0, s69, 71168
    s_nop 0
    buffer_load_dwordx4 v200, s[32:35], s66 offen offset:2560 lds
    s_add_u32 s98, s98, 458880
    s_add_u32 s96, s56, 8
    s_mulk_i32 s96, 1408
    s_mul_i32 s60, s57, 1144
    s_add_u32 s96, s96, s60
    s_add_u32 m0, s69, 151296
    s_add_u32 s64, s58, s57
    buffer_load_dwordx4 v197, s[24:27], s64 offen lds
    s_waitcnt vmcnt(10)
    s_barrier
    s_lshr_b32 s64, 550246, s67
    s_and_b32 s64, s64, 15
    s_add_u32 s64, s64, s68
    s_cmp_ge_u32 s64, 10
    s_cselect_b32 s65, 7, 0
    s_sub_u32 s64, s64, s65
    s_mul_i32 s65, s64, 245760
    s_lshl_b32 s64, s64, 7
    s_add_u32 s64, s64, s57
    s_add_u32 m0, s69, 77824
    s_mov_b32 exec_lo, s70
    buffer_load_dwordx4 v196, s[24:27], s64 offen lds
    s_add_u32 m0, s69, 81920
    s_mov_b32 exec_lo, -1
    buffer_load_dwordx4 v197, s[24:27], s64 offen lds
    s_add_u32 m0, s69, 86016
    s_add_u32 s65, s65, s58
    buffer_load_dwordx4 v198, s[24:27], s64 offen lds
    s_cbranch_vccz L_SK6
    s_add_u32 m0, s69, 90112
    s_nop 0
    buffer_load_dwordx4 v199, s[24:27], s64 offen lds
L_SK6:
    s_add_u32 m0, s69, 92160
    s_add_u32 s66, s65, 122880
    buffer_load_dwordx4 v200, s[32:35], s65 offen offset:0 lds
    s_add_u32 s96, s96, 1048576
    s_and_b32 s62, s2, 1
    s_mulk_i32 s62, 10240
    s_add_u32 s62, s62, s96
    s_sub_u32 s63, s54, s53
    s_add_u32 m0, s69, 99072
    s_nop 0
    buffer_load_dwordx4 v200, s[32:35], s65 offen offset:1280 lds
    s_and_b32 s60, s2, 7
    s_mul_i32 s60, s60, 25
    s_add_u32 s63, s63, s60
    s_mulk_i32 s63, 11520
    s_add_u32 s63, s63, 4194304
    s_add_u32 m0, s69, 105984
    s_nop 0
    buffer_load_dwordx4 v200, s[32:35], s65 offen offset:2560 lds
    v_mul_u32_u24 v2, 272, v4
    v_add_u32 v2, 112384, v2
    v_lshlrev_b32 v3, 3, v5
    s_waitcnt lgkmcnt(0)
    v_bfe_u32 v20, s4, v3, 8
    s_add_u32 m0, s69, 96256
    s_nop 0
    buffer_load_dwordx4 v200, s[32:35], s66 offen offset:0 lds
    v_bfe_u32 v21, s5, v3, 8
    v_add_u32 v20, v20, v2
    v_add_u32 v21, v21, v2
    v_lshrrev_b32 v2, 2, v1
    v_mul_u32_u24 v2, 136, v2
    s_add_u32 m0, s69, 103168
    s_nop 0
    buffer_load_dwordx4 v200, s[32:35], s66 offen offset:1280 lds
    v_add_u32 v2, 79744, v2
    v_add_u32 v23, s7, v2
    v_lshlrev_b32 v3, 3, v1
    v_bfe_u32 v22, s6, v3, 8
    v_add_u32 v22, v22, v2
    s_add_u32 m0, s69, 110080
    s_nop 0
    buffer_load_dwordx4 v200, s[32:35], s66 offen offset:2560 lds
    s_add_u32 s9, s9, s62
    s_add_u32 s10, s10, s62
    s_add_u32 s11, s11, s63
    s_add_u32 s12, s12, s63
    s_add_u32 s5, s9, 40960
    s_add_u32 m0, s69, 155392
    s_add_u32 s64, s58, s57
    buffer_load_dwordx4 v198, s[24:27], s64 offen lds
    s_waitcnt vmcnt(10)
    s_barrier
    s_lshr_b32 s64, 358775, s67
    s_and_b32 s64, s64, 15
    s_add_u32 s64, s64, s68
    s_cmp_ge_u32 s64, 10
    s_cselect_b32 s65, 7, 0
    s_sub_u32 s64, s64, s65
    s_mul_i32 s65, s64, 245760
    s_lshl_b32 s64, s64, 7
    s_add_u32 s64, s64, s57
    s_add_u32 m0, s69, 0
    s_mov_b32 exec_lo, s70
    buffer_load_dwordx4 v196, s[24:27], s64 offen lds
    s_add_u32 m0, s69, 4096
    s_mov_b32 exec_lo, -1
    buffer_load_dwordx4 v197, s[24:27], s64 offen lds
    s_add_u32 m0, s69, 8192
    s_add_u32 s65, s65, s58
    buffer_load_dwordx4 v198, s[24:27], s64 offen lds
    s_cbranch_vccz L_SK7
    s_add_u32 m0, s69, 12288
    s_nop 0
    buffer_load_dwordx4 v199, s[24:27], s64 offen lds
L_SK7:
    s_add_u32 m0, s69, 14336
    s_add_u32 s66, s65, 122880
    buffer_load_dwordx4 v200, s[32:35], s65 offen offset:0 lds
    s_mul_i32 s60, s8, 20480
    s_add_u32 s96, s96, s60
    s_lshl4_add_u32 s95, s8, s56
    s_cmp_eq_u32 s8, 6
    s_cselect_b32 s101, 1, 2
    s_add_u32 m0, s69, 21248
    s_nop 0
    buffer_load_dwordx4 v200, s[32:35], s65 offen offset:1280 lds
    s_cmpk_ge_i32 s95, 1024
    s_cselect_b32 s101, 0, s101
    s_mul_i32 s97, s95, 2560
    s_add_u32 s97, s97, s57
    s_add_u32 s97, s97, s58
    s_add_u32 m0, s69, 28160
    s_nop 0
    buffer_load_dwordx4 v200, s[32:35], s65 offen offset:2560 lds
    s_add_u32 s94, s97, 20480
    s_cmp_eq_u32 s8, 0
    s_cselect_b32 s97, 2146435072, s97
    s_cselect_b32 s61, 2146435072, 0
    s_and_b32 s60, s53, 2
    s_add_u32 m0, s69, 18432
    s_nop 0
    buffer_load_dwordx4 v200, s[32:35], s66 offen offset:0 lds
    s_mul_i32 s22, s60, 204800
    s_sub_u32 s23, 409600, s22
    s_add_u32 s22, s22, s58
    s_add_u32 s23, s23, s58
    s_mulk_i32 s60, 5120
    s_add_u32 m0, s69, 25344
    s_nop 0
    buffer_load_dwordx4 v200, s[32:35], s66 offen offset:1280 lds
    s_sub_u32 s4, s96, s60
    s_add_u32 s4, s4, 10240
    s_add_u32 s96, s96, s60
    s_add_u32 s92, s96, 4096
    s_add_u32 s93, s92, 4096
    s_add_u32 m0, s69, 32256
    s_nop 0
    buffer_load_dwordx4 v200, s[32:35], s66 offen offset:2560 lds
    s_add_u32 s6, s4, 4096
    s_add_u32 s7, s6, 4096
    v_bfe_i32 v2, v1, 3, 1
    v_bfi_b32 v2, v2, 0, s61
    v_or_b32 v27, v2, v6
    s_cbranch_vccz L_SKX
    s_add_u32 m0, s69, 159488
    s_add_u32 s64, s58, s57
    buffer_load_dwordx4 v199, s[24:27], s64 offen lds
L_SKX:
    s_waitcnt vmcnt(9)
    s_barrier
    s_lshr_b32 s64, 493192, s67
    s_and_b32 s64, s64, 15
    s_add_u32 s64, s64, s68
    s_cmp_ge_u32 s64, 10
    s_cselect_b32 s65, 7, 0
    s_sub_u32 s64, s64, s65
    s_mul_i32 s65, s64, 245760
    s_lshl_b32 s64, s64, 7
    s_add_u32 s64, s64, s57
    s_add_u32 m0, s69, 38912
    s_mov_b32 exec_lo, s70
    buffer_load_dwordx4 v196, s[24:27], s64 offen lds
    s_add_u32 m0, s69, 43008
    s_mov_b32 exec_lo, -1
    buffer_load_dwordx4 v197, s[24:27], s64 offen lds
    s_add_u32 m0, s69, 47104
    s_add_u32 s65, s65, s58
    buffer_load_dwordx4 v198, s[24:27], s64 offen lds
    s_cbranch_vccz L_SK8
    s_add_u32 m0, s69, 51200
    s_nop 0
    buffer_load_dwordx4 v199, s[24:27], s64 offen lds
L_SK8:
    s_add_u32 m0, s69, 53248
    s_add_u32 s66, s65, 122880
    buffer_load_dwordx4 v200, s[32:35], s65 offen offset:0 lds
    s_and_b32 s60, s2, 4
    s_lshl_b32 s60, s60, 8
    s_add_u32 s95, s95, s60
    s_lshl_b32 s60, s8, 11
    s_add_u32 s60, s60, 147200
    s_add_u32 m0, s69, 60160
    s_nop 0
    buffer_load_dwordx4 v200, s[32:35], s65 offen offset:1280 lds
    v_add_u32 v8, s60, v8
    s_lshl_b32 s60, s8, 8
    s_add_u32 s60, s60, 161536
    v_lshl_add_u32 v17, v4, 4, s60
    ds_read_b32 v109, v19 offset:32
    s_add_u32 m0, s69, 67072
    s_nop 0
    buffer_load_dwordx4 v200, s[32:35], s65 offen offset:2560 lds
    s_mul_i32 s60, s59, 28
    v_min_u32 v2, 27, v1
    v_add_u32 v2, s60, v2
    v_lshlrev_b32 v82, 4, v2
    v_add_u32 v82, 161536, v82
    s_add_u32 m0, s69, 57344
    s_nop 0
    buffer_load_dwordx4 v200, s[32:35], s66 offen offset:0 lds
    v_add_u32 v2, s56, v2
    v_max_i32 v2, 0, v2
    v_min_u32 v2, 1023, v2
    s_and_b32 s60, s2, 4
    s_lshl_b32 s60, s60, 12
    s_add_u32 m0, s69, 64256
    s_nop 0
    buffer_load_dwordx4 v200, s[32:35], s66 offen offset:1280 lds
    s_add_u32 s60, s60, 16384
    v_lshl_add_u32 v81, v2, 4, s60
    s_lshr_b32 s60, s58, 7
    s_movk_i32 s99, 0x3ff
    v_lshlrev_b32 v108, 7, v1
    s_add_u32 m0, s69, 71168
    s_nop 0
    buffer_load_dwordx4 v200, s[32:35], s66 offen offset:2560 lds
    s_mul_i32 s71, s54, 52
    s_lshr_b32 s71, s71, 8
    s_lshl_b32 s71, s71, 13
    s_waitcnt lgkmcnt(0)
    v_readfirstlane_b32 s52, v109
    s_mul_i32 s60, s59, 448
    s_add_u32 m0, s60, 161536
    s_mov_b64 exec, 0xfffffff
    buffer_load_dwordx4 v81, s[28:31], 0 offen  lds
    s_mov_b64 exec, -1
    s_waitcnt vmcnt(10)
    s_barrier
    s_lshr_b32 s64, 628889, s67
    s_and_b32 s64, s64, 15
    s_add_u32 s64, s64, s68
    s_cmp_ge_u32 s64, 10
    s_cselect_b32 s65, 7, 0
    s_sub_u32 s64, s64, s65
    s_mul_i32 s65, s64, 245760
    s_lshl_b32 s64, s64, 7
    s_add_u32 s64, s64, s57
    s_add_u32 m0, s69, 77824
    s_mov_b32 exec_lo, s70
    buffer_load_dwordx4 v196, s[24:27], s64 offen lds
    s_add_u32 m0, s69, 81920
    s_mov_b32 exec_lo, -1
    buffer_load_dwordx4 v197, s[24:27], s64 offen lds
    s_add_u32 m0, s69, 86016
    s_add_u32 s65, s65, s58
    buffer_load_dwordx4 v198, s[24:27], s64 offen lds
    s_cbranch_vccz L_SK9
    s_add_u32 m0, s69, 90112
    s_nop 0
    buffer_load_dwordx4 v199, s[24:27], s64 offen lds
L_SK9:
    s_add_u32 m0, s69, 92160
    s_add_u32 s66, s65, 122880
    buffer_load_dwordx4 v200, s[32:35], s65 offen offset:0 lds
    s_add_u32 m0, s69, 99072
    s_nop 0
    buffer_load_dwordx4 v200, s[32:35], s65 offen offset:1280 lds
    s_add_u32 m0, s69, 105984
    s_nop 0
    buffer_load_dwordx4 v200, s[32:35], s65 offen offset:2560 lds
    s_add_u32 m0, s69, 96256
    s_nop 0
    buffer_load_dwordx4 v200, s[32:35], s66 offen offset:0 lds
    s_add_u32 m0, s69, 103168
    s_nop 0
    buffer_load_dwordx4 v200, s[32:35], s66 offen offset:1280 lds
    s_add_u32 m0, s69, 110080
    s_nop 0
    buffer_load_dwordx4 v200, s[32:35], s66 offen offset:2560 lds
    s_waitcnt vmcnt(9)
    s_barrier
    ds_read_b128 v[84:87], v82
    s_mov_b32 s64, s71
    s_add_u32 s65, s69, 0
    s_add_u32 m0, s64, s65
    s_mul_i32 s61, s64, 10
    s_add_u32 s61, s61, s22
    buffer_load_dwordx4 v16, s[40:43], s61 offen lds
    s_add_u32 s64, s64, 4096
    s_cmp_eq_u32 s64, 36864
    s_cselect_b32 s64, 0, s64
    s_add_u32 m0, s64, s65
    s_mul_i32 s61, s64, 10
    s_add_u32 s61, s61, s22
    buffer_load_dwordx4 v16, s[40:43], s61 offen lds
    s_add_u32 s64, s64, 4096
    s_add_u32 m0, s64, s65
    s_mul_i32 s61, s64, 10
    s_add_u32 s61, s61, s22
    buffer_load_dwordx4 v16, s[40:43], s61 offen lds
    s_add_u32 s64, s64, 4096
    s_cmp_eq_u32 s64, 36864
    s_cselect_b32 s64, 0, s64
    s_add_u32 m0, s64, s65
    s_mul_i32 s61, s64, 10
    s_add_u32 s61, s61, s22
    buffer_load_dwordx4 v16, s[40:43], s61 offen lds
    s_add_u32 s64, s64, 4096
    s_add_u32 m0, s64, s65
    s_mul_i32 s61, s64, 10
    s_add_u32 s61, s61, s22
    buffer_load_dwordx4 v16, s[40:43], s61 offen lds
    s_add_u32 s64, s64, 4096
    s_cmp_eq_u32 s64, 36864
    s_cselect_b32 s64, 0, s64
    s_add_u32 m0, s64, s65
    s_mul_i32 s61, s64, 10
    s_add_u32 s61, s61, s22
    buffer_load_dwordx4 v16, s[40:43], s61 offen lds
    s_add_u32 s64, s64, 4096
    s_add_u32 m0, s64, s65
    s_mul_i32 s61, s64, 10
    s_add_u32 s61, s61, s22
    buffer_load_dwordx4 v16, s[40:43], s61 offen lds
    s_add_u32 s64, s64, 4096
    s_cmp_eq_u32 s64, 36864
    s_cselect_b32 s64, 0, s64
    s_add_u32 m0, s64, s65
    s_mul_i32 s61, s64, 10
    s_add_u32 s61, s61, s22
    buffer_load_dwordx4 v16, s[40:43], s61 offen lds
    s_add_u32 s64, s64, 4096
    s_add_u32 m0, s64, s65
    s_mul_i32 s61, s64, 10
    s_add_u32 s61, s61, s22
    buffer_load_dwordx4 v16, s[40:43], s61 offen lds
    s_waitcnt lgkmcnt(0)
L_RC_CHK:
    v_xor_b32 v2, s52, v85
    v_bitop3_b32 v2, v87, s52, v2 bitop3:0xbe
    v_cmp_ne_u32 vcc, 0, v2
    s_cbranch_vccnz L_RC_RETRY
L_RC_OK:
    s_waitcnt vmcnt(9)
    s_barrier
    s_lshl_b32 s60, s59, 10
    s_add_u32 m0, s60, 36864
    s_add_u32 s60, s22, 368640
    buffer_load_dwordx4 v16, s[40:43], s60 offen lds
    s_mov_b64 exec, 1
    buffer_load_dwordx4 v[112:115], v6, s[28:31], 0 offen offset:256
    s_mov_b64 exec, -1
    s_mul_i32 s64, s71, 10
    s_add_u32 s61, s64, s23
    buffer_load_dwordx4 v[216:219], v16, s[40:43], s61 offen
    s_add_u32 s64, s64, 40960
    s_add_u32 s61, s64, s23
    buffer_load_dwordx4 v[220:223], v16, s[40:43], s61 offen
    s_add_u32 s64, s64, 40960
    s_cmp_eq_u32 s64, 409600
    s_cselect_b32 s64, 0, s64
    s_add_u32 s61, s64, s23
    buffer_load_dwordx4 v[224:227], v16, s[40:43], s61 offen
    s_add_u32 s64, s64, 40960
    s_add_u32 s61, s64, s23
    buffer_load_dwordx4 v[228:231], v16, s[40:43], s61 offen
    s_add_u32 s64, s64, 40960
    s_cmp_eq_u32 s64, 409600
    s_cselect_b32 s64, 0, s64
    s_add_u32 s61, s64, s23
    buffer_load_dwordx4 v[232:235], v16, s[40:43], s61 offen
    s_add_u32 s64, s64, 40960
    s_add_u32 s61, s64, s23
    buffer_load_dwordx4 v[236:239], v16, s[40:43], s61 offen
    s_add_u32 s64, s64, 40960
    s_cmp_eq_u32 s64, 409600
    s_cselect_b32 s64, 0, s64
    s_add_u32 s61, s64, s23
    buffer_load_dwordx4 v[240:243], v16, s[40:43], s61 offen
    s_add_u32 s64, s64, 40960
    s_add_u32 s61, s64, s23
    buffer_load_dwordx4 v[244:247], v16, s[40:43], s61 offen
    s_add_u32 s64, s64, 40960
    s_cmp_eq_u32 s64, 409600
    s_cselect_b32 s64, 0, s64
    s_add_u32 s61, s64, s23
    buffer_load_dwordx4 v[248:251], v16, s[40:43], s61 offen
    s_add_u32 s64, s64, 40960
    s_add_u32 s61, s64, s23
    buffer_load_dwordx4 v[252:255], v16, s[40:43], s61 offen
    s_mov_b64 exec, 0
    s_bitcmp1_b32 s3, 0
    s_cbranch_scc1 TC4
    s_branch TC0
TC_END:
    s_mov_b64 exec, -1
    s_barrier
    s_setprio 1
    s_cmp_eq_u32 s13, 1
    s_cbranch_scc1 AL_S
    ds_read_b64 v[64:65], v20 offset:4480
    ds_read_b64 v[66:67], v21 offset:4480
    ds_read_b64 v[84:85], v20 offset:4352
    ds_read_b64 v[86:87], v21 offset:4352
    ds_read_b64 v[68:69], v20 offset:8832
    ds_read_b64 v[70:71], v21 offset:8832
    ds_read_b64 v[88:89], v20 offset:8704
    ds_read_b64 v[90:91], v21 offset:8704
    ds_read_b64 v[72:73], v20 offset:13184
    ds_read_b64 v[74:75], v21 offset:13184
    ds_read_b64 v[92:93], v20 offset:13056
    ds_read_b64 v[94:95], v21 offset:13056
    ds_read_b64 v[76:77], v20 offset:17536
    ds_read_b64 v[78:79], v21 offset:17536
    ds_read_b64 v[96:97], v20 offset:17408
    ds_read_b64 v[98:99], v21 offset:17408
    v_lshl_add_u32 v3, v5, 8, v26
    v_mov_b32 v0, v27
    s_waitcnt lgkmcnt(12)
    v_mfma_f32_16x16x32_bf16 v[168:171], v[84:87], v[64:67], v[42:45]
    s_waitcnt lgkmcnt(8)
    v_mfma_f32_16x16x32_bf16 v[172:175], v[88:91], v[68:71], v[32:35]
    v_mfma_f32_16x16x32_bf16 v[52:55], v[84:87], v[68:71], v[36:39]
    s_waitcnt lgkmcnt(4)
    v_mfma_f32_16x16x32_bf16 v[176:179], v[92:95], v[72:75], v[32:35]
    v_mfma_f32_16x16x32_bf16 v[56:59], v[88:91], v[72:75], v[36:39]
    s_waitcnt lgkmcnt(0)
    v_mfma_f32_16x16x32_bf16 v[180:183], v[96:99], v[76:79], v[32:35]
    v_mfma_f32_16x16x32_bf16 v[60:63], v[92:95], v[76:79], v[36:39]
    s_branch AL_J
AL_S:
    ds_read_b64 v[64:65], v20 offset:4480
    ds_read_b64 v[84:85], v20 offset:4352
    ds_read_b64 v[68:69], v20 offset:8832
    ds_read_b64 v[88:89], v20 offset:8704
    ds_read_b64 v[72:73], v20 offset:13184
    ds_read_b64 v[92:93], v20 offset:13056
    ds_read_b64 v[76:77], v20 offset:17536
    ds_read_b64 v[96:97], v20 offset:17408
    s_cmp_lg_u32 s8, 6
    s_cbranch_scc1 AL_NOR0
    s_mov_b32 exec_lo, s99
    s_mov_b32 exec_hi, 0
    buffer_load_dword v109, v108, s[28:31], s98 offen sc1
    s_mov_b64 exec, -1
AL_NOR0:
    v_lshl_add_u32 v3, v5, 8, v26
    v_mov_b32 v0, v27
    s_waitcnt lgkmcnt(6)
    v_mfma_f32_16x16x16_bf16 v[168:171], v[84:85], v[64:65], v[42:45]
    s_waitcnt lgkmcnt(4)
    v_mfma_f32_16x16x16_bf16 v[172:175], v[88:89], v[68:69], v[32:35]
    v_mfma_f32_16x16x16_bf16 v[52:55], v[84:85], v[68:69], v[36:39]
    s_waitcnt lgkmcnt(2)
    v_mfma_f32_16x16x16_bf16 v[176:179], v[92:93], v[72:73], v[32:35]
    v_mfma_f32_16x16x16_bf16 v[56:59], v[88:89], v[72:73], v[36:39]
    s_waitcnt lgkmcnt(0)
    v_mfma_f32_16x16x16_bf16 v[180:183], v[96:97], v[76:77], v[32:35]
    v_mfma_f32_16x16x16_bf16 v[60:63], v[92:93], v[76:77], v[36:39]
AL_J:
    ds_read_b32 v27, v3
    ds_read2st64_b32 v[36:37], v26 offset1:1
    ds_read2st64_b32 v[38:39], v26 offset0:2 offset1:3
    v_max_f32 v172, v172, v52
    v_max_f32 v173, v173, v53
    v_max_f32 v174, v174, v54
    v_max_f32 v175, v175, v55
    v_max_f32 v176, v176, v56
    v_max_f32 v177, v177, v57
    v_max_f32 v178, v178, v58
    v_max_f32 v179, v179, v59
    v_max_f32 v180, v180, v60
    v_max_f32 v181, v181, v61
    v_max_f32 v182, v182, v62
    v_max_f32 v183, v183, v63
    s_mov_b64 exec, 1
    s_waitcnt vmcnt(0)
L_FL_CHK:
    v_xor_b32 v2, s52, v113
    v_bitop3_b32 v2, v115, s52, v2 bitop3:0xbe
    v_cmp_ne_u32 vcc, 0, v2
    s_cbranch_vccnz L_FL_RETRY
L_FL_OK:
    ds_write2_b32 v19, v112, v114 offset0:10 offset1:11
    s_mov_b64 exec, -1
    s_cmp_lg_u32 s8, 6
    s_cbranch_scc1 AL_NOR1
    s_mov_b32 exec_lo, s99
    s_mov_b32 exec_hi, 0
    s_waitcnt vmcnt(0)
AL_RD_CHK:
    v_xor_b32 v2, s52, v109
    v_cmp_ne_u32 vcc, 0, v2
    s_cbranch_vccz AL_RD_OK
AL_RD_RETRY:
    s_add_u32 s100, s100, 1
    s_cmp_gt_u32 s100, 20000
    s_cbranch_scc1 AL_RD_OK
    s_sleep 1
    buffer_load_dword v109, v108, s[28:31], s98 offen sc1
    s_waitcnt vmcnt(0)
    s_branch AL_RD_CHK
AL_RD_OK:
    s_mov_b64 exec, -1
AL_NOR1:
    s_cmp_lg_u32 s13, 1
    s_cbranch_scc1 AL_SM
    v_cvt_pk_bf16_f32 v64, v168, v169
    v_mov_b32 v65, s52
    v_cvt_pk_bf16_f32 v66, v170, v171
    v_mov_b32 v67, s52
    buffer_store_dwordx4 v[64:67], v6, s[28:31], s11 offen offset:0 sc1
    v_cvt_pk_bf16_f32 v68, v172, v173
    v_mov_b32 v69, s52
    v_cvt_pk_bf16_f32 v70, v174, v175
    v_mov_b32 v71, s52
    buffer_store_dwordx4 v[68:71], v6, s[28:31], s11 offen offset:1024 sc1
    v_cvt_pk_bf16_f32 v72, v176, v177
    v_mov_b32 v73, s52
    v_cvt_pk_bf16_f32 v74, v178, v179
    v_mov_b32 v75, s52
    buffer_store_dwordx4 v[72:75], v6, s[28:31], s11 offen offset:2048 sc1
    v_cvt_pk_bf16_f32 v76, v180, v181
    v_mov_b32 v77, s52
    v_cvt_pk_bf16_f32 v78, v182, v183
    v_mov_b32 v79, s52
    buffer_store_dwordx4 v[76:79], v6, s[28:31], s11 offen offset:3072 sc1
    s_branch AL_X
AL_SM:
    v_max3_f32 v136, v168, v169, v170
    v_max3_f32 v138, v172, v173, v174
    v_max3_f32 v140, v176, v177, v178
    v_max3_f32 v142, v180, v181, v182
    v_max_f32 v136, v136, v171
    v_max_f32 v138, v138, v175
    v_max_f32 v140, v140, v179
    v_max_f32 v142, v142, v183
    s_nop 0
    v_permlane32_swap_b32 v136, v140
    v_permlane32_swap_b32 v138, v142
    v_max_f32 v136, v136, v140
    v_max_f32 v138, v138, v142
    s_waitcnt lgkmcnt(0)
    v_mul_f32 v27, 0x3ea52b5c, v27
    v_permlane16_swap_b32 v136, v138
    v_max_f32 v136, v136, v138
    v_mul_f32 v138, v136, v27
    v_mul_f32 v136, v136, v27
    v_mul_f32 v32, 0x3ea52b5c, v36
    v_mul_f32 v34, 0x3ea52b5c, v37
    v_permlane16_swap_b32 v136, v138
    v_mov_b32 v140, v136
    v_mov_b32 v142, v138
    v_mul_f32 v36, 0x3ea52b5c, v38
    v_mul_f32 v38, 0x3ea52b5c, v39
    v_permlane32_swap_b32 v136, v140
    v_permlane32_swap_b32 v138, v142
    v_pk_fma_f32 v[168:169], v[168:169], v[32:33], v[136:137] op_sel_hi:[1,0,0] neg_lo:[0,0,1] neg_hi:[0,0,1]
    v_pk_fma_f32 v[170:171], v[170:171], v[32:33], v[136:137] op_sel_hi:[1,0,0] neg_lo:[0,0,1] neg_hi:[0,0,1]
    v_pk_fma_f32 v[172:173], v[172:173], v[34:35], v[138:139] op_sel_hi:[1,0,0] neg_lo:[0,0,1] neg_hi:[0,0,1]
    v_pk_fma_f32 v[174:175], v[174:175], v[34:35], v[138:139] op_sel_hi:[1,0,0] neg_lo:[0,0,1] neg_hi:[0,0,1]
    v_pk_fma_f32 v[176:177], v[176:177], v[36:37], v[140:141] op_sel_hi:[1,0,0] neg_lo:[0,0,1] neg_hi:[0,0,1]
    v_pk_fma_f32 v[178:179], v[178:179], v[36:37], v[140:141] op_sel_hi:[1,0,0] neg_lo:[0,0,1] neg_hi:[0,0,1]
    v_pk_fma_f32 v[180:181], v[180:181], v[38:39], v[142:143] op_sel_hi:[1,0,0] neg_lo:[0,0,1] neg_hi:[0,0,1]
    v_pk_fma_f32 v[182:183], v[182:183], v[38:39], v[142:143] op_sel_hi:[1,0,0] neg_lo:[0,0,1] neg_hi:[0,0,1]
    s_cmp_eq_u32 s13, 1
    s_cbranch_scc1 AL_NOY
    s_barrier
    ds_read_b64_tr_b16 v[184:185], v22 offset:2176
    ds_read_b64_tr_b16 v[194:195], v23 offset:2176
    ds_read_b64_tr_b16 v[186:187], v22 offset:2176
    ds_read_b64_tr_b16 v[196:197], v23 offset:2176
    ds_read_b64_tr_b16 v[188:189], v22 offset:4352
    ds_read_b64_tr_b16 v[198:199], v23 offset:4352
    ds_read_b64_tr_b16 v[190:191], v22 offset:6528
    ds_read_b64_tr_b16 v[200:201], v23 offset:6528
    ds_read_b64_tr_b16 v[192:193], v22 offset:8704
    ds_read_b64_tr_b16 v[202:203], v23 offset:8704
AL_NOY:
    v_exp_f32 v168, v168
    v_exp_f32 v169, v169
    v_exp_f32 v170, v170
    v_exp_f32 v171, v171
    v_cvt_pk_bf16_f32 v2, v168, v169
    v_cvt_pk_bf16_f32 v3, v170, v171
    v_bfi_b32 v168, v40, 0, v2
    v_bfi_b32 v169, v41, 0, v3
    v_and_b32 v170, v40, v2
    v_and_b32 v171, v41, v3
    s_waitcnt lgkmcnt(0)
    v_exp_f32 v172, v172
    v_mfma_f32_16x16x32_bf16 v[116:119], v[28:31], v[168:171], 0
    v_exp_f32 v173, v173
    v_mfma_f32_16x16x32_bf16 v[136:139], v[184:187], v[168:171], 0
    v_exp_f32 v174, v174
    v_mfma_f32_16x16x32_bf16 v[152:155], v[194:197], v[168:171], 0
    v_exp_f32 v175, v175
    v_cvt_pk_bf16_f32 v2, v172, v173
    v_cvt_pk_bf16_f32 v3, v174, v175
    v_bfi_b32 v172, v40, 0, v2
    v_bfi_b32 v173, v41, 0, v3
    v_and_b32 v174, v40, v2
    v_and_b32 v175, v41, v3
    v_rcp_f32 v32, v116
    v_exp_f32 v176, v176
    v_mfma_f32_16x16x32_bf16 v[120:123], v[28:31], v[172:175], 0
    v_exp_f32 v177, v177
    v_mfma_f32_16x16x32_bf16 v[140:143], v[186:189], v[172:175], 0
    v_exp_f32 v178, v178
    v_mfma_f32_16x16x32_bf16 v[156:159], v[196:199], v[172:175], 0
    v_exp_f32 v179, v179
    v_cvt_pk_bf16_f32 v2, v176, v177
    v_cvt_pk_bf16_f32 v3, v178, v179
    v_bfi_b32 v176, v40, 0, v2
    v_bfi_b32 v177, v41, 0, v3
    v_and_b32 v178, v40, v2
    v_and_b32 v179, v41, v3
    v_rcp_f32 v34, v120
    v_exp_f32 v180, v180
    v_mfma_f32_16x16x32_bf16 v[116:119], v[28:31], v[176:179], 0
    v_exp_f32 v181, v181
    v_mfma_f32_16x16x32_bf16 v[144:147], v[188:191], v[176:179], 0
    v_exp_f32 v182, v182
    v_mfma_f32_16x16x32_bf16 v[160:163], v[198:201], v[176:179], 0
    v_exp_f32 v183, v183
    v_cvt_pk_bf16_f32 v2, v180, v181
    v_cvt_pk_bf16_f32 v3, v182, v183
    v_bfi_b32 v180, v40, 0, v2
    v_bfi_b32 v181, v41, 0, v3
    v_and_b32 v182, v40, v2
    v_and_b32 v183, v41, v3
    v_rcp_f32 v36, v116
    v_mul_f32 v136, v136, v32
    v_mfma_f32_16x16x32_bf16 v[120:123], v[28:31], v[180:183], 0
    v_mul_f32 v137, v137, v32
    v_mfma_f32_16x16x32_bf16 v[148:151], v[190:193], v[180:183], 0
    v_mul_f32 v138, v138, v32
    v_mfma_f32_16x16x32_bf16 v[164:167], v[200:203], v[180:183], 0
    v_mul_f32 v139, v139, v32
    v_cvt_pk_bf16_f32 v136, v136, v137
    v_cvt_pk_bf16_f32 v137, v138, v139
    v_mul_f32 v140, v140, v34
    v_mul_f32 v141, v141, v34
    v_mul_f32 v142, v142, v34
    v_mul_f32 v143, v143, v34
    v_cvt_pk_bf16_f32 v138, v140, v141
    v_cvt_pk_bf16_f32 v139, v142, v143
    v_rcp_f32 v38, v120
    v_pk_mul_f32 v[144:145], v[144:145], v[36:37] op_sel_hi:[1,0]
    v_pk_mul_f32 v[146:147], v[146:147], v[36:37] op_sel_hi:[1,0]
    v_permlane32_swap_b32 v136, v138
    v_permlane32_swap_b32 v137, v139
    v_pk_mul_f32 v[148:149], v[148:149], v[38:39] op_sel_hi:[1,0]
    v_pk_mul_f32 v[150:151], v[150:151], v[38:39] op_sel_hi:[1,0]
    v_cvt_pk_bf16_f32 v144, v144, v145
    v_cvt_pk_bf16_f32 v145, v146, v147
    v_cvt_pk_bf16_f32 v146, v148, v149
    v_cvt_pk_bf16_f32 v147, v150, v151
    s_mov_b64 exec, s[14:15]
    buffer_store_dwordx4 v[136:139], v24, s[28:31], s9 offen sc1
    s_mov_b64 exec, -1
    v_permlane32_swap_b32 v144, v146
    v_permlane32_swap_b32 v145, v147
    v_pk_mul_f32 v[152:153], v[152:153], v[32:33] op_sel_hi:[1,0]
    v_pk_mul_f32 v[154:155], v[154:155], v[32:33] op_sel_hi:[1,0]
    s_mov_b64 exec, s[16:17]
    buffer_store_dwordx4 v[144:147], v24, s[28:31], s5 offen sc1
    s_lshl_b64 exec, -1, 16
    v_pk_mul_f32 v[152:153], v[156:157], v[34:35] op_sel_hi:[1,0]
    v_pk_mul_f32 v[154:155], v[158:159], v[34:35] op_sel_hi:[1,0]
    s_lshl_b64 exec, -1, 32
    v_pk_mul_f32 v[152:153], v[160:161], v[36:37] op_sel_hi:[1,0]
    v_pk_mul_f32 v[154:155], v[162:163], v[36:37] op_sel_hi:[1,0]
    s_lshl_b64 exec, -1, 48
    v_pk_mul_f32 v[152:153], v[164:165], v[38:39] op_sel_hi:[1,0]
    v_pk_mul_f32 v[154:155], v[166:167], v[38:39] op_sel_hi:[1,0]
    s_mov_b64 exec, s[18:19]
    v_cvt_pk_bf16_f32 v152, v152, v153
    v_cvt_pk_bf16_f32 v153, v154, v155
    buffer_store_dwordx2 v[152:153], v25, s[28:31], s10 offen sc1
    s_mov_b64 exec, -1
    s_cmp_eq_u32 s13, 1
    s_cbranch_scc1 P_TAIL
    s_mov_b32 s64, s71
    s_add_u32 s65, s69, 40960
    s_add_u32 s61, s64, s65
    v_add_u32 v3, s61, v6
    ds_write_b128 v3, v[216:219] offset:0
    ds_write_b128 v3, v[220:223] offset:4096
    s_add_u32 s64, s64, 8192
    s_cmp_eq_u32 s64, 40960
    s_cselect_b32 s64, 0, s64
    s_add_u32 s61, s64, s65
    v_add_u32 v3, s61, v6
    ds_write_b128 v3, v[224:227] offset:0
    ds_write_b128 v3, v[228:231] offset:4096
    s_add_u32 s64, s64, 8192
    s_cmp_eq_u32 s64, 40960
    s_cselect_b32 s64, 0, s64
    s_add_u32 s61, s64, s65
    v_add_u32 v3, s61, v6
    ds_write_b128 v3, v[232:235] offset:0
    ds_write_b128 v3, v[236:239] offset:4096
    s_add_u32 s64, s64, 8192
    s_cmp_eq_u32 s64, 40960
    s_cselect_b32 s64, 0, s64
    s_add_u32 s61, s64, s65
    v_add_u32 v3, s61, v6
    ds_write_b128 v3, v[240:243] offset:0
    ds_write_b128 v3, v[244:247] offset:4096
    s_add_u32 s64, s64, 8192
    s_cmp_eq_u32 s64, 40960
    s_cselect_b32 s64, 0, s64
    s_add_u32 s61, s64, s65
    v_add_u32 v3, s61, v6
    ds_write_b128 v3, v[248:251] offset:0
    ds_write_b128 v3, v[252:255] offset:4096
    v_mov_b32 v2, 1
    ds_write_b8 v18, v2 offset:16
    s_branch A_DONE
AC_X:
TC0:
    s_cbranch_execz TC1
    s_setprio 0
    s_sleep 12
    s_setprio 2
    buffer_load_dwordx4 v[136:139], v6, s[28:31], s12 offen offset:0 sc1
    buffer_load_dwordx4 v[140:143], v6, s[28:31], s12 offen offset:1024 sc1
    buffer_load_dwordx4 v[144:147], v6, s[28:31], s12 offen offset:2048 sc1
    s_setprio 0
    s_call_b64 s[20:21], K_P1
    s_call_b64 s[20:21], K_P2
    s_setprio 2
    s_waitcnt vmcnt(0)
AC_MB_CHK:
    v_xor_b32 v2, s52, v137
    v_bitop3_b32 v2, v139, s52, v2 bitop3:0xbe
    v_bitop3_b32 v2, v141, s52, v2 bitop3:0xbe
    v_bitop3_b32 v2, v143, s52, v2 bitop3:0xbe
    v_bitop3_b32 v2, v145, s52, v2 bitop3:0xbe
    v_bitop3_b32 v2, v147, s52, v2 bitop3:0xbe
    v_cmp_ne_u32 vcc, 0, v2
    s_cbranch_vccnz AC_MB_RETRY
AC_MB_OK:
    v_lshlrev_b32 v137, 16, v136
    v_and_b32 v136, s55, v136
    v_lshlrev_b32 v139, 16, v138
    v_and_b32 v138, s55, v138
    v_add_f32 v168, v168, v137
    v_add_f32 v169, v169, v136
    v_add_f32 v170, v170, v139
    v_add_f32 v171, v171, v138
    v_lshlrev_b32 v141, 16, v140
    v_and_b32 v140, s55, v140
    v_lshlrev_b32 v143, 16, v142
    v_and_b32 v142, s55, v142
    v_add_f32 v172, v172, v141
    v_add_f32 v173, v173, v140
    v_add_f32 v174, v174, v143
    v_add_f32 v175, v175, v142
    v_lshlrev_b32 v145, 16, v144
    v_and_b32 v144, s55, v144
    v_lshlrev_b32 v147, 16, v146
    v_and_b32 v146, s55, v146
    v_add_f32 v176, v176, v145
    v_add_f32 v177, v177, v144
    v_add_f32 v178, v178, v147
    v_add_f32 v179, v179, v146
    s_branch AC_SM
AL_X:
TC7:
    s_cbranch_execz TC_END
    s_setprio 0
    s_waitcnt lgkmcnt(0)
    s_barrier
    ds_read_b64_tr_b16 v[184:185], v22 offset:2176
    ds_read_b64_tr_b16 v[194:195], v23 offset:2176
    ds_read_b64_tr_b16 v[186:187], v22 offset:2176
    ds_read_b64_tr_b16 v[196:197], v23 offset:2176
    ds_read_b64_tr_b16 v[188:189], v22 offset:4352
    ds_read_b64_tr_b16 v[198:199], v23 offset:4352
    ds_read_b64_tr_b16 v[190:191], v22 offset:6528
    ds_read_b64_tr_b16 v[200:201], v23 offset:6528
    ds_read_b64_tr_b16 v[192:193], v22 offset:8704
    ds_read_b64_tr_b16 v[202:203], v23 offset:8704
    s_mov_b32 s64, s71
    s_add_u32 s65, s69, 40960
    s_add_u32 s61, s64, s65
    v_add_u32 v3, s61, v6
    ds_write_b128 v3, v[216:219] offset:0
    ds_write_b128 v3, v[220:223] offset:4096
    s_add_u32 s64, s64, 8192
    s_cmp_eq_u32 s64, 40960
    s_cselect_b32 s64, 0, s64
    s_add_u32 s61, s64, s65
    v_add_u32 v3, s61, v6
    ds_write_b128 v3, v[224:227] offset:0
    ds_write_b128 v3, v[228:231] offset:4096
    s_add_u32 s64, s64, 8192
    s_cmp_eq_u32 s64, 40960
    s_cselect_b32 s64, 0, s64
    s_add_u32 s61, s64, s65
    v_add_u32 v3, s61, v6
    ds_write_b128 v3, v[232:235] offset:0
    ds_write_b128 v3, v[236:239] offset:4096
    s_add_u32 s64, s64, 8192
    s_cmp_eq_u32 s64, 40960
    s_cselect_b32 s64, 0, s64
    s_add_u32 s61, s64, s65
    v_add_u32 v3, s61, v6
    ds_write_b128 v3, v[240:243] offset:0
    ds_write_b128 v3, v[244:247] offset:4096
    s_add_u32 s64, s64, 8192
    s_cmp_eq_u32 s64, 40960
    s_cselect_b32 s64, 0, s64
    s_add_u32 s61, s64, s65
    v_add_u32 v3, s61, v6
    ds_write_b128 v3, v[248:251] offset:0
    ds_write_b128 v3, v[252:255] offset:4096
    v_mov_b32 v2, 1
    ds_write_b8 v18, v2 offset:16
    s_sleep 6
    s_setprio 2
    buffer_load_dwordx4 v[136:139], v6, s[28:31], s12 offen offset:0 sc1
    buffer_load_dwordx4 v[140:143], v6, s[28:31], s12 offen offset:1024 sc1
    buffer_load_dwordx4 v[144:147], v6, s[28:31], s12 offen offset:2048 sc1
    buffer_load_dwordx4 v[148:151], v6, s[28:31], s12 offen offset:3072 sc1
    s_setprio 0
    s_call_b64 s[20:21], K_P1
    s_call_b64 s[20:21], K_P2
    s_setprio 2
    s_waitcnt vmcnt(0)
AL_MB_CHK:
    v_xor_b32 v2, s52, v137
    v_bitop3_b32 v2, v139, s52, v2 bitop3:0xbe
    v_bitop3_b32 v2, v141, s52, v2 bitop3:0xbe
    v_bitop3_b32 v2, v143, s52, v2 bitop3:0xbe
    v_bitop3_b32 v2, v145, s52, v2 bitop3:0xbe
    v_bitop3_b32 v2, v147, s52, v2 bitop3:0xbe
    v_bitop3_b32 v2, v149, s52, v2 bitop3:0xbe
    v_bitop3_b32 v2, v151, s52, v2 bitop3:0xbe
    v_cmp_ne_u32 vcc, 0, v2
    s_cbranch_vccnz AL_MB_RETRY
AL_MB_OK:
    v_lshlrev_b32 v137, 16, v136
    v_and_b32 v136, s55, v136
    v_lshlrev_b32 v139, 16, v138
    v_and_b32 v138, s55, v138
    v_add_f32 v168, v168, v137
    v_add_f32 v169, v169, v136
    v_add_f32 v170, v170, v139
    v_add_f32 v171, v171, v138
    v_lshlrev_b32 v141, 16, v140
    v_and_b32 v140, s55, v140
    v_lshlrev_b32 v143, 16, v142
    v_and_b32 v142, s55, v142
    v_add_f32 v172, v172, v141
    v_add_f32 v173, v173, v140
    v_add_f32 v174, v174, v143
    v_add_f32 v175, v175, v142
    v_lshlrev_b32 v145, 16, v144
    v_and_b32 v144, s55, v144
    v_lshlrev_b32 v147, 16, v146
    v_and_b32 v146, s55, v146
    v_add_f32 v176, v176, v145
    v_add_f32 v177, v177, v144
    v_add_f32 v178, v178, v147
    v_add_f32 v179, v179, v146
    v_lshlrev_b32 v149, 16, v148
    v_and_b32 v148, s55, v148
    v_lshlrev_b32 v151, 16, v150
    v_and_b32 v150, s55, v150
    v_add_f32 v180, v180, v149
    v_add_f32 v181, v181, v148
    v_add_f32 v182, v182, v151
    v_add_f32 v183, v183, v150
    s_branch AL_SM
AC_MB_RETRY:
    s_add_u32 s100, s100, 1
    s_cmp_gt_u32 s100, 20000
    s_cbranch_scc1 AC_MB_OK
    s_sleep 6
    buffer_load_dwordx4 v[136:139], v6, s[28:31], s12 offen offset:0 sc1
    buffer_load_dwordx4 v[140:143], v6, s[28:31], s12 offen offset:1024 sc1
    buffer_load_dwordx4 v[144:147], v6, s[28:31], s12 offen offset:2048 sc1
    s_waitcnt vmcnt(0)
    s_branch AC_MB_CHK
G2_R0:
TC2:
    s_cbranch_execz TC3
    s_sleep 3
    buffer_load_dwordx4 v[96:99], v0, s[28:31], s96 offen offset:0 sc1
    buffer_load_dwordx4 v[100:103], v31, s[28:31], s96 offen offset:0 sc1
    buffer_load_dwordx4 v[104:107], v0, s[28:31], s96 offen offset:1024 sc1
    buffer_load_dwordx4 v[108:111], v31, s[28:31], s96 offen offset:1024 sc1
    buffer_load_dwordx4 v[112:115], v0, s[28:31], s96 offen offset:2048 sc1
    buffer_load_dwordx4 v[116:119], v31, s[28:31], s96 offen offset:2048 sc1
    buffer_load_dwordx4 v[120:123], v0, s[28:31], s96 offen offset:3072 sc1
    buffer_load_dwordx4 v[124:127], v31, s[28:31], s96 offen offset:3072 sc1
    s_add_u32 s100, s100, 1
    s_cmp_gt_u32 s100, 20000
    s_waitcnt vmcnt(0)
    s_cbranch_scc1 G2_OK0
    v_max3_u32 v2, v96, v98, v100
    v_max_u32 v2, v2, v102
    v_cmp_eq_u32 vcc, -1, v2
    s_cbranch_vccnz G2_R0
    s_branch G2_OK0
G2_R1:
    s_sleep 3
    buffer_load_dwordx4 v[104:107], v0, s[28:31], s96 offen offset:1024 sc1
    buffer_load_dwordx4 v[108:111], v31, s[28:31], s96 offen offset:1024 sc1
    buffer_load_dwordx4 v[112:115], v0, s[28:31], s96 offen offset:2048 sc1
    buffer_load_dwordx4 v[116:119], v31, s[28:31], s96 offen offset:2048 sc1
    buffer_load_dwordx4 v[120:123], v0, s[28:31], s96 offen offset:3072 sc1
    buffer_load_dwordx4 v[124:127], v31, s[28:31], s96 offen offset:3072 sc1
    buffer_load_dwordx4 v[128:131], v0, s[28:31], s92 offen offset:0 sc1
    buffer_load_dwordx4 v[132:135], v31, s[28:31], s92 offen offset:0 sc1
    s_add_u32 s100, s100, 1
    s_cmp_gt_u32 s100, 20000
    s_waitcnt vmcnt(0)
    s_cbranch_scc1 G2_OK1
    v_max3_u32 v2, v104, v106, v108
    v_max_u32 v2, v2, v110
    v_cmp_eq_u32 vcc, -1, v2
    s_cbranch_vccnz G2_R1
    s_branch G2_OK1
G2_R2:
    s_sleep 3
    buffer_load_dwordx4 v[112:115], v0, s[28:31], s96 offen offset:2048 sc1
    buffer_load_dwordx4 v[116:119], v31, s[28:31], s96 offen offset:2048 sc1
    buffer_load_dwordx4 v[120:123], v0, s[28:31], s96 offen offset:3072 sc1
    buffer_load_dwordx4 v[124:127], v31, s[28:31], s96 offen offset:3072 sc1
    buffer_load_dwordx4 v[128:131], v0, s[28:31], s92 offen offset:0 sc1
    buffer_load_dwordx4 v[132:135], v31, s[28:31], s92 offen offset:0 sc1
    buffer_load_dwordx4 v[136:139], v0, s[28:31], s92 offen offset:1024 sc1
    buffer_load_dwordx4 v[140:143], v31, s[28:31], s92 offen offset:1024 sc1
    s_add_u32 s100, s100, 1
    s_cmp_gt_u32 s100, 20000
    s_waitcnt vmcnt(0)
    s_cbranch_scc1 G2_OK2
    v_max3_u32 v2, v112, v114, v116
    v_max_u32 v2, v2, v118
    v_cmp_eq_u32 vcc, -1, v2
    s_cbranch_vccnz G2_R2
    s_branch G2_OK2
G2_ZA:
    s_waitcnt lgkmcnt(0)
    v_and_b32 v2, v2, v3
    v_cmp_ne_u32 vcc, 0x01010101, v2
    s_cbranch_vccz G2_ZAOK
G2_ZAR:
    s_add_u32 s100, s100, 1
    s_cmp_gt_u32 s100, 200000
    s_cbranch_scc1 G2_ZAOK
    s_sleep 1
    ds_read_b64 v[2:3], v19 offset:16
    s_branch G2_ZA
G2_R3:
    s_sleep 3
    buffer_load_dwordx4 v[120:123], v0, s[28:31], s96 offen offset:3072 sc1
    buffer_load_dwordx4 v[124:127], v31, s[28:31], s96 offen offset:3072 sc1
    buffer_load_dwordx4 v[128:131], v0, s[28:31], s92 offen offset:0 sc1
    buffer_load_dwordx4 v[132:135], v31, s[28:31], s92 offen offset:0 sc1
    buffer_load_dwordx4 v[136:139], v0, s[28:31], s92 offen offset:1024 sc1
    buffer_load_dwordx4 v[140:143], v31, s[28:31], s92 offen offset:1024 sc1
    buffer_load_dwordx4 v[144:147], v0, s[28:31], s92 offen offset:2048 sc1
    buffer_load_dwordx4 v[148:151], v31, s[28:31], s92 offen offset:2048 sc1
    s_add_u32 s100, s100, 1
    s_cmp_gt_u32 s100, 20000
    s_waitcnt vmcnt(0)
    s_cbranch_scc1 G2_OK3
    v_max3_u32 v2, v120, v122, v124
    v_max_u32 v2, v2, v126
    v_cmp_eq_u32 vcc, -1, v2
    s_cbranch_vccnz G2_R3
    s_branch G2_OK3
G2_R4:
    s_sleep 3
    buffer_load_dwordx4 v[128:131], v0, s[28:31], s92 offen offset:0 sc1
    buffer_load_dwordx4 v[132:135], v31, s[28:31], s92 offen offset:0 sc1
    buffer_load_dwordx4 v[136:139], v0, s[28:31], s92 offen offset:1024 sc1
    buffer_load_dwordx4 v[140:143], v31, s[28:31], s92 offen offset:1024 sc1
    buffer_load_dwordx4 v[144:147], v0, s[28:31], s92 offen offset:2048 sc1
    buffer_load_dwordx4 v[148:151], v31, s[28:31], s92 offen offset:2048 sc1
    buffer_load_dwordx4 v[152:155], v0, s[28:31], s4 offen offset:0 sc1
    buffer_load_dwordx4 v[156:159], v31, s[28:31], s4 offen offset:0 sc1
    s_add_u32 s100, s100, 1
    s_cmp_gt_u32 s100, 20000
    s_waitcnt vmcnt(0)
    s_cbranch_scc1 G2_OK4
    v_max3_u32 v2, v128, v130, v132
    v_max_u32 v2, v2, v134
    v_cmp_eq_u32 vcc, -1, v2
    s_cbranch_vccnz G2_R4
    s_branch G2_OK4
G2_R5:
    s_sleep 3
    buffer_load_dwordx4 v[136:139], v0, s[28:31], s92 offen offset:1024 sc1
    buffer_load_dwordx4 v[140:143], v31, s[28:31], s92 offen offset:1024 sc1
    buffer_load_dwordx4 v[144:147], v0, s[28:31], s92 offen offset:2048 sc1
    buffer_load_dwordx4 v[148:151], v31, s[28:31], s92 offen offset:2048 sc1
    buffer_load_dwordx4 v[152:155], v0, s[28:31], s4 offen offset:0 sc1
    buffer_load_dwordx4 v[156:159], v31, s[28:31], s4 offen offset:0 sc1
    buffer_load_dwordx4 v[96:99], v0, s[28:31], s4 offen offset:1024 sc1
    buffer_load_dwordx4 v[100:103], v31, s[28:31], s4 offen offset:1024 sc1
    s_add_u32 s100, s100, 1
    s_cmp_gt_u32 s100, 20000
    s_waitcnt vmcnt(0)
    s_cbranch_scc1 G2_OK5
    v_max3_u32 v2, v136, v138, v140
    v_max_u32 v2, v2, v142
    v_cmp_eq_u32 vcc, -1, v2
    s_cbranch_vccnz G2_R5
    s_branch G2_OK5
G2_R6:
    s_sleep 3
    buffer_load_dwordx4 v[144:147], v0, s[28:31], s92 offen offset:2048 sc1
    buffer_load_dwordx4 v[148:151], v31, s[28:31], s92 offen offset:2048 sc1
    buffer_load_dwordx4 v[152:155], v0, s[28:31], s4 offen offset:0 sc1
    buffer_load_dwordx4 v[156:159], v31, s[28:31], s4 offen offset:0 sc1
    buffer_load_dwordx4 v[96:99], v0, s[28:31], s4 offen offset:1024 sc1
    buffer_load_dwordx4 v[100:103], v31, s[28:31], s4 offen offset:1024 sc1
    buffer_load_dwordx4 v[104:107], v0, s[28:31], s4 offen offset:2048 sc1
    buffer_load_dwordx4 v[108:111], v31, s[28:31], s4 offen offset:2048 sc1
    s_add_u32 s100, s100, 1
    s_cmp_gt_u32 s100, 20000
    s_waitcnt vmcnt(0)
    s_cbranch_scc1 G2_OK6
    v_max3_u32 v2, v144, v146, v148
    v_max_u32 v2, v2, v150
    v_cmp_eq_u32 vcc, -1, v2
    s_cbranch_vccnz G2_R6
    s_branch G2_OK6
G2_R7:
TC3:
    s_cbranch_execz TC_END
    s_sleep 3
    buffer_load_dwordx4 v[152:155], v0, s[28:31], s4 offen offset:0 sc1
    buffer_load_dwordx4 v[156:159], v31, s[28:31], s4 offen offset:0 sc1
    buffer_load_dwordx4 v[96:99], v0, s[28:31], s4 offen offset:1024 sc1
    buffer_load_dwordx4 v[100:103], v31, s[28:31], s4 offen offset:1024 sc1
    buffer_load_dwordx4 v[104:107], v0, s[28:31], s4 offen offset:2048 sc1
    buffer_load_dwordx4 v[108:111], v31, s[28:31], s4 offen offset:2048 sc1
    buffer_load_dwordx4 v[112:115], v0, s[28:31], s4 offen offset:3072 sc1
    buffer_load_dwordx4 v[116:119], v31, s[28:31], s4 offen offset:3072 sc1
    s_add_u32 s100, s100, 1
    s_cmp_gt_u32 s100, 20000
    s_waitcnt vmcnt(0)
    s_cbranch_scc1 G2_OK7
    v_max3_u32 v2, v152, v154, v156
    v_max_u32 v2, v2, v158
    v_cmp_eq_u32 vcc, -1, v2
    s_cbranch_vccnz G2_R7
    s_branch G2_OK7
G2_R8:
    s_sleep 3
    buffer_load_dwordx4 v[96:99], v0, s[28:31], s4 offen offset:1024 sc1
    buffer_load_dwordx4 v[100:103], v31, s[28:31], s4 offen offset:1024 sc1
    buffer_load_dwordx4 v[104:107], v0, s[28:31], s4 offen offset:2048 sc1
    buffer_load_dwordx4 v[108:111], v31, s[28:31], s4 offen offset:2048 sc1
    buffer_load_dwordx4 v[112:115], v0, s[28:31], s4 offen offset:3072 sc1
    buffer_load_dwordx4 v[116:119], v31, s[28:31], s4 offen offset:3072 sc1
    buffer_load_dwordx4 v[120:123], v0, s[28:31], s6 offen offset:0 sc1
    buffer_load_dwordx4 v[124:127], v31, s[28:31], s6 offen offset:0 sc1
    s_add_u32 s100, s100, 1
    s_cmp_gt_u32 s100, 20000
    s_waitcnt vmcnt(0)
    s_cbranch_scc1 G2_OK8
    v_max3_u32 v2, v96, v98, v100
    v_max_u32 v2, v2, v102
    v_cmp_eq_u32 vcc, -1, v2
    s_cbranch_vccnz G2_R8
    s_branch G2_OK8
G2_ZL:
    s_waitcnt lgkmcnt(0)
    v_and_b32 v2, v2, v3
    v_cmp_ne_u32 vcc, 0x01010101, v2
    s_cbranch_vccz G2_ZLOK
G2_ZLR:
    s_add_u32 s100, s100, 1
    s_cmp_gt_u32 s100, 200000
    s_cbranch_scc1 G2_ZLOK
    s_sleep 1
    ds_read_b64 v[2:3], v19 offset:0
    s_branch G2_ZL
G2_R9:
    s_sleep 3
    buffer_load_dwordx4 v[104:107], v0, s[28:31], s4 offen offset:2048 sc1
    buffer_load_dwordx4 v[108:111], v31, s[28:31], s4 offen offset:2048 sc1
    buffer_load_dwordx4 v[112:115], v0, s[28:31], s4 offen offset:3072 sc1
    buffer_load_dwordx4 v[116:119], v31, s[28:31], s4 offen offset:3072 sc1
    buffer_load_dwordx4 v[120:123], v0, s[28:31], s6 offen offset:0 sc1
    buffer_load_dwordx4 v[124:127], v31, s[28:31], s6 offen offset:0 sc1
    buffer_load_dwordx4 v[128:131], v0, s[28:31], s6 offen offset:1024 sc1
    buffer_load_dwordx4 v[132:135], v31, s[28:31], s6 offen offset:1024 sc1
    s_add_u32 s100, s100, 1
    s_cmp_gt_u32 s100, 20000
    s_waitcnt vmcnt(0)
    s_cbranch_scc1 G2_OK9
    v_max3_u32 v2, v104, v106, v108
    v_max_u32 v2, v2, v110
    v_cmp_eq_u32 vcc, -1, v2
    s_cbranch_vccnz G2_R9
    s_branch G2_OK9
G2_R10:
    s_sleep 3
    buffer_load_dwordx4 v[112:115], v0, s[28:31], s4 offen offset:3072 sc1
    buffer_load_dwordx4 v[116:119], v31, s[28:31], s4 offen offset:3072 sc1
    buffer_load_dwordx4 v[120:123], v0, s[28:31], s6 offen offset:0 sc1
    buffer_load_dwordx4 v[124:127], v31, s[28:31], s6 offen offset:0 sc1
    buffer_load_dwordx4 v[128:131], v0, s[28:31], s6 offen offset:1024 sc1
    buffer_load_dwordx4 v[132:135], v31, s[28:31], s6 offen offset:1024 sc1
    buffer_load_dwordx4 v[136:139], v0, s[28:31], s6 offen offset:2048 sc1
    buffer_load_dwordx4 v[140:143], v31, s[28:31], s6 offen offset:2048 sc1
    s_add_u32 s100, s100, 1
    s_cmp_gt_u32 s100, 20000
    s_waitcnt vmcnt(0)
    s_cbranch_scc1 G2_OK10
    v_max3_u32 v2, v112, v114, v116
    v_max_u32 v2, v2, v118
    v_cmp_eq_u32 vcc, -1, v2
    s_cbranch_vccnz G2_R10
    s_branch G2_OK10
G2_R11:
    s_sleep 3
    buffer_load_dwordx4 v[120:123], v0, s[28:31], s6 offen offset:0 sc1
    buffer_load_dwordx4 v[124:127], v31, s[28:31], s6 offen offset:0 sc1
    buffer_load_dwordx4 v[128:131], v0, s[28:31], s6 offen offset:1024 sc1
    buffer_load_dwordx4 v[132:135], v31, s[28:31], s6 offen offset:1024 sc1
    buffer_load_dwordx4 v[136:139], v0, s[28:31], s6 offen offset:2048 sc1
    buffer_load_dwordx4 v[140:143], v31, s[28:31], s6 offen offset:2048 sc1
    buffer_load_dwordx4 v[144:147], v0, s[28:31], s93 offen offset:0 sc1
    buffer_load_dwordx4 v[148:151], v31, s[28:31], s93 offen offset:0 sc1
    s_add_u32 s100, s100, 1
    s_cmp_gt_u32 s100, 20000
    s_waitcnt vmcnt(0)
    s_cbranch_scc1 G2_OK11
    v_max3_u32 v2, v120, v122, v124
    v_max_u32 v2, v2, v126
    v_cmp_eq_u32 vcc, -1, v2
    s_cbranch_vccnz G2_R11
    s_branch G2_OK11
G2_R12:
    s_sleep 3
    buffer_load_dwordx4 v[128:131], v0, s[28:31], s6 offen offset:1024 sc1
    buffer_load_dwordx4 v[132:135], v31, s[28:31], s6 offen offset:1024 sc1
    buffer_load_dwordx4 v[136:139], v0, s[28:31], s6 offen offset:2048 sc1
    buffer_load_dwordx4 v[140:143], v31, s[28:31], s6 offen offset:2048 sc1
    buffer_load_dwordx4 v[144:147], v0, s[28:31], s93 offen offset:0 sc1
    buffer_load_dwordx4 v[148:151], v31, s[28:31], s93 offen offset:0 sc1
    buffer_load_dwordx4 v[152:155], v0, s[28:31], s7 offen offset:0 sc1
    buffer_load_dwordx4 v[156:159], v31, s[28:31], s7 offen offset:0 sc1
    s_add_u32 s100, s100, 1
    s_cmp_gt_u32 s100, 20000
    s_waitcnt vmcnt(0)
    s_cbranch_scc1 G2_OK12
    v_max3_u32 v2, v128, v130, v132
    v_max_u32 v2, v2, v134
    v_cmp_eq_u32 vcc, -1, v2
    s_cbranch_vccnz G2_R12
    s_branch G2_OK12
G2_R13:
    s_sleep 3
    buffer_load_dwordx4 v[136:139], v0, s[28:31], s6 offen offset:2048 sc1
    buffer_load_dwordx4 v[140:143], v31, s[28:31], s6 offen offset:2048 sc1
    buffer_load_dwordx4 v[144:147], v0, s[28:31], s93 offen offset:0 sc1
    buffer_load_dwordx4 v[148:151], v31, s[28:31], s93 offen offset:0 sc1
    buffer_load_dwordx4 v[152:155], v0, s[28:31], s7 offen offset:0 sc1
    buffer_load_dwordx4 v[156:159], v31, s[28:31], s7 offen offset:0 sc1
    buffer_load_dwordx4 v[96:99], v0, s[28:31], s93 offen offset:1024 sc1
    buffer_load_dwordx4 v[100:103], v31, s[28:31], s93 offen offset:1024 sc1
    s_add_u32 s100, s100, 1
    s_cmp_gt_u32 s100, 20000
    s_waitcnt vmcnt(0)
    s_cbranch_scc1 G2_OK13
    v_max3_u32 v2, v136, v138, v140
    v_max_u32 v2, v2, v142
    v_cmp_eq_u32 vcc, -1, v2
    s_cbranch_vccnz G2_R13
    s_branch G2_OK13
G2_R14:
TC4:
    s_cbranch_execz TC5
    s_sleep 3
    buffer_load_dwordx4 v[144:147], v0, s[28:31], s93 offen offset:0 sc1
    buffer_load_dwordx4 v[148:151], v31, s[28:31], s93 offen offset:0 sc1
    buffer_load_dwordx4 v[152:155], v0, s[28:31], s7 offen offset:0 sc1
    buffer_load_dwordx4 v[156:159], v31, s[28:31], s7 offen offset:0 sc1
    buffer_load_dwordx4 v[96:99], v0, s[28:31], s93 offen offset:1024 sc1
    buffer_load_dwordx4 v[100:103], v31, s[28:31], s93 offen offset:1024 sc1
    buffer_load_dwordx4 v[104:107], v0, s[28:31], s7 offen offset:1024 sc1
    buffer_load_dwordx4 v[108:111], v31, s[28:31], s7 offen offset:1024 sc1
    s_add_u32 s100, s100, 1
    s_cmp_gt_u32 s100, 20000
    s_waitcnt vmcnt(0)
    s_cbranch_scc1 G2_OK14
    v_max3_u32 v2, v144, v146, v148
    v_max_u32 v2, v2, v150
    v_cmp_eq_u32 vcc, -1, v2
    s_cbranch_vccnz G2_R14
    s_branch G2_OK14
G2_R15:
    s_sleep 3
    buffer_load_dwordx4 v[152:155], v0, s[28:31], s7 offen offset:0 sc1
    buffer_load_dwordx4 v[156:159], v31, s[28:31], s7 offen offset:0 sc1
    buffer_load_dwordx4 v[96:99], v0, s[28:31], s93 offen offset:1024 sc1
    buffer_load_dwordx4 v[100:103], v31, s[28:31], s93 offen offset:1024 sc1
    buffer_load_dwordx4 v[104:107], v0, s[28:31], s7 offen offset:1024 sc1
    buffer_load_dwordx4 v[108:111], v31, s[28:31], s7 offen offset:1024 sc1
    buffer_load_dwordx4 v[112:115], v0, s[28:31], s92 offen offset:3072 sc1
    buffer_load_dwordx4 v[116:119], v31, s[28:31], s92 offen offset:3072 sc1
    s_add_u32 s100, s100, 1
    s_cmp_gt_u32 s100, 20000
    s_waitcnt vmcnt(0)
    s_cbranch_scc1 G2_OK15
    v_max3_u32 v2, v152, v154, v156
    v_max_u32 v2, v2, v158
    v_cmp_eq_u32 vcc, -1, v2
    s_cbranch_vccnz G2_R15
    s_branch G2_OK15
G2_R16:
    s_sleep 3
    buffer_load_dwordx4 v[96:99], v0, s[28:31], s93 offen offset:1024 sc1
    buffer_load_dwordx4 v[100:103], v31, s[28:31], s93 offen offset:1024 sc1
    buffer_load_dwordx4 v[104:107], v0, s[28:31], s7 offen offset:1024 sc1
    buffer_load_dwordx4 v[108:111], v31, s[28:31], s7 offen offset:1024 sc1
    buffer_load_dwordx4 v[112:115], v0, s[28:31], s92 offen offset:3072 sc1
    buffer_load_dwordx4 v[116:119], v31, s[28:31], s92 offen offset:3072 sc1
    buffer_load_dwordx4 v[120:123], v0, s[28:31], s6 offen offset:3072 sc1
    buffer_load_dwordx4 v[124:127], v31, s[28:31], s6 offen offset:3072 sc1
    s_add_u32 s100, s100, 1
    s_cmp_gt_u32 s100, 20000
    s_waitcnt vmcnt(0)
    s_cbranch_scc1 G2_OK16
    v_max3_u32 v2, v96, v98, v100
    v_max_u32 v2, v2, v102
    v_cmp_eq_u32 vcc, -1, v2
    s_cbranch_vccnz G2_R16
    s_branch G2_OK16
G2_R17:
    s_sleep 3
    buffer_load_dwordx4 v[104:107], v0, s[28:31], s7 offen offset:1024 sc1
    buffer_load_dwordx4 v[108:111], v31, s[28:31], s7 offen offset:1024 sc1
    buffer_load_dwordx4 v[112:115], v0, s[28:31], s92 offen offset:3072 sc1
    buffer_load_dwordx4 v[116:119], v31, s[28:31], s92 offen offset:3072 sc1
    buffer_load_dwordx4 v[120:123], v0, s[28:31], s6 offen offset:3072 sc1
    buffer_load_dwordx4 v[124:127], v31, s[28:31], s6 offen offset:3072 sc1
    s_add_u32 s100, s100, 1
    s_cmp_gt_u32 s100, 20000
    s_waitcnt vmcnt(0)
    s_cbranch_scc1 G2_OK17
    v_max3_u32 v2, v104, v106, v108
    v_max_u32 v2, v2, v110
    v_cmp_eq_u32 vcc, -1, v2
    s_cbranch_vccnz G2_R17
    s_branch G2_OK17
G2_R18:
    s_sleep 3
    buffer_load_dwordx4 v[112:115], v0, s[28:31], s92 offen offset:3072 sc1
    buffer_load_dwordx4 v[116:119], v31, s[28:31], s92 offen offset:3072 sc1
    buffer_load_dwordx4 v[120:123], v0, s[28:31], s6 offen offset:3072 sc1
    buffer_load_dwordx4 v[124:127], v31, s[28:31], s6 offen offset:3072 sc1
    s_add_u32 s100, s100, 1
    s_cmp_gt_u32 s100, 20000
    s_waitcnt vmcnt(0)
    s_cbranch_scc1 G2_OK18
    v_max3_u32 v2, v112, v114, v116
    v_max_u32 v2, v2, v118
    v_cmp_eq_u32 vcc, -1, v2
    s_cbranch_vccnz G2_R18
    s_branch G2_OK18
G2_R19:
    s_sleep 3
    buffer_load_dwordx4 v[120:123], v0, s[28:31], s6 offen offset:3072 sc1
    buffer_load_dwordx4 v[124:127], v31, s[28:31], s6 offen offset:3072 sc1
    s_add_u32 s100, s100, 1
    s_cmp_gt_u32 s100, 20000
    s_waitcnt vmcnt(0)
    s_cbranch_scc1 G2_OK19
    v_max3_u32 v2, v120, v122, v124
    v_max_u32 v2, v2, v126
    v_cmp_eq_u32 vcc, -1, v2
    s_cbranch_vccnz G2_R19
    s_branch G2_OK19
G2_ZG:
    s_waitcnt lgkmcnt(0)
    v_and_b32 v2, v2, v3
    v_cmp_ne_u32 vcc, 0x01010101, v2
    s_cbranch_vccz G2_ZGOK
G2_ZGR:
    s_add_u32 s100, s100, 1
    s_cmp_gt_u32 s100, 200000
    s_cbranch_scc1 G2_ZGOK
    s_sleep 1
    ds_read_b64 v[2:3], v19 offset:8
    s_branch G2_ZG
P_ZR:
    s_add_u32 s100, s100, 1
    s_cmp_gt_u32 s100, 200000
    s_cbranch_scc1 P_ZOK
    s_sleep 1
    ds_read_b64 v[2:3], v19 offset:0
    s_branch P_Z
L_RC_RETRY:
    s_add_u32 s100, s100, 1
    s_cmp_gt_u32 s100, 20000
    s_cbranch_scc1 L_RC_OK
    s_sleep 4
    s_mul_i32 s60, s59, 448
    s_add_u32 m0, s60, 161536
    s_mov_b64 exec, 0xfffffff
    buffer_load_dwordx4 v81, s[28:31], 0 offen sc1 lds
    s_mov_b64 exec, -1
    s_waitcnt vmcnt(0)
    ds_read_b128 v[84:87], v82
    s_waitcnt lgkmcnt(0)
    s_waitcnt vmcnt(0)
    s_branch L_RC_CHK
L_FL_RETRY:
    s_add_u32 s100, s100, 1
    s_cmp_gt_u32 s100, 20000
    s_cbranch_scc1 L_FL_OK
    s_sleep 8
    s_mov_b64 exec, 1
    buffer_load_dwordx4 v[112:115], v6, s[28:31], 0 offen offset:256 sc1
    s_waitcnt vmcnt(0)
    s_branch L_FL_CHK
AL_MB_RETRY:
    s_add_u32 s100, s100, 1
    s_cmp_gt_u32 s100, 20000
    s_cbranch_scc1 AL_MB_OK
    s_sleep 6
    buffer_load_dwordx4 v[136:139], v6, s[28:31], s12 offen offset:0 sc1
    buffer_load_dwordx4 v[140:143], v6, s[28:31], s12 offen offset:1024 sc1
    buffer_load_dwordx4 v[144:147], v6, s[28:31], s12 offen offset:2048 sc1
    buffer_load_dwordx4 v[148:151], v6, s[28:31], s12 offen offset:3072 sc1
    s_waitcnt vmcnt(0)
    s_branch AL_MB_CHK
K_AUX0:
    s_sub_u32 s56, s2, 200
K_AUX:
    s_lshr_b32 s3, s3, 6
    s_and_b32 s59, s3, 3
    s_mov_b32 s55, 0xffff0000
    s_mov_b32 s100, 0
    v_and_b32 v1, 63, v0
    v_and_b32 v4, 15, v1
    v_lshrrev_b32 v5, 4, v1
    v_mov_b32 v19, 163584
    v_add_u32 v18, s3, v19
    s_mov_b32 s30, 7077888
    s_mov_b32 s31, 0x20000
    s_cmp_ge_u32 s3, 4
    s_cbranch_scc1 K_FC
    s_cmp_lg_u32 s101, 5
    s_cbranch_scc1 FL_SPARE
    s_waitcnt vmcnt(16)
    s_barrier
    s_mov_b32 s70, 4
FL_GU1b:
    s_mov_b32 m0, s69
    s_sub_u32 s70, s70, 1
    buffer_load_dwordx4 v30, s[48:51], s68 offen nt lds
    s_add_u32 m0, s69, 16384
    s_add_u32 s69, s69, 4096
    buffer_load_dwordx4 v30, s[36:39], s68 offen nt lds
    s_add_u32 s68, s68, 110592
    s_and_b32 s60, s70, 3
    s_cselect_b32 s60, 0, 16384
    s_add_u32 s69, s69, s60
    s_cmp_lg_u32 s70, 0
    s_cbranch_scc1 FL_GU1b
    s_barrier
    s_lshl_b32 s69, s59, 10
    s_add_u32 m0, s69, 0
    s_nop 0
    buffer_load_dwordx4 v30, s[48:51], s68 offen nt lds
    s_add_u32 m0, s69, 16384
    s_nop 0
    buffer_load_dwordx4 v30, s[36:39], s68 offen nt lds
    s_add_u32 s68, s68, 110592
    s_add_u32 m0, s69, 4096
    s_nop 0
    buffer_load_dwordx4 v30, s[48:51], s68 offen nt lds
    s_add_u32 m0, s69, 20480
    s_nop 0
    buffer_load_dwordx4 v30, s[36:39], s68 offen nt lds
    s_add_u32 s68, s68, 110592
    s_add_u32 m0, s69, 8192
    s_nop 0
    buffer_load_dwordx4 v30, s[48:51], s68 offen nt lds
    s_add_u32 m0, s69, 24576
    s_nop 0
    buffer_load_dwordx4 v30, s[36:39], s68 offen nt lds
    s_add_u32 s68, s68, 110592
    s_waitcnt vmcnt(14)
    s_barrier
    s_add_u32 m0, s69, 12288
    s_nop 0
    buffer_load_dwordx4 v30, s[48:51], s68 offen nt lds
    s_add_u32 m0, s69, 28672
    s_nop 0
    buffer_load_dwordx4 v30, s[36:39], s68 offen nt lds
    s_add_u32 s68, s68, 110592
    s_waitcnt vmcnt(0)
    s_barrier
    s_branch K_END
FL_SPARE:
    s_waitcnt lgkmcnt(0)
    s_load_dwordx2 s[48:49], s[0:1], 56
    s_load_dwordx2 s[40:41], s[0:1], 16
    s_mov_b32 s42, 819200
    s_mov_b32 s43, 0x20000
    s_and_b32 s60, s59, 2
    s_lshl_b32 s60, s60, 2
    v_lshl_or_b32 v2, v5, 1, s60
    v_xor_b32 v2, v2, v1
    v_and_b32 v2, 15, v2
    v_lshrrev_b32 v31, 4, v0
    v_mul_u32_u24 v31, 1280, v31
    v_lshl_add_u32 v31, v2, 4, v31
    s_sub_u32 s61, s56, 27
    s_mul_i32 s61, s61, 81920
    v_add_u32 v31, s61, v31
    s_lshl_b32 s63, s59, 10
    s_mov_b32 s50, 2211840
    s_mov_b32 s51, 0x20000
    s_waitcnt lgkmcnt(0)
    s_sleep 30
    s_lshl3_add_u32 s60, s56, s3
    s_lshl_b32 s60, s60, 10
    s_add_u32 s60, s60, 827392
    v_mov_b32 v108, -1
    v_mov_b32 v109, -1
    v_mov_b32 v110, -1
    v_mov_b32 v111, -1
    v_lshlrev_b32 v15, 4, v1
FL_CLR:
    buffer_store_dwordx4 v[108:111], v15, s[28:31], s60 offen sc1
    s_add_u32 s60, s60, 237568
    s_cmp_lt_u32 s60, 3977216
    s_cbranch_scc1 FL_CLR
    s_waitcnt vmcnt(0)
    s_barrier
    s_add_u32 m0, s63, 0
    s_mov_b32 s60, 0
    buffer_load_dwordx4 v31, s[48:51], s60 offen nt lds
    s_add_u32 m0, s63, 4096
    s_mov_b32 s60, 20480
    buffer_load_dwordx4 v31, s[48:51], s60 offen nt lds
    s_add_u32 m0, s63, 8192
    s_mov_b32 s60, 40960
    buffer_load_dwordx4 v31, s[48:51], s60 offen nt lds
    s_add_u32 m0, s63, 12288
    s_mov_b32 s60, 61440
    buffer_load_dwordx4 v31, s[48:51], s60 offen nt lds
    s_add_u32 m0, s63, 16384
    s_mov_b32 s60, 256
    buffer_load_dwordx4 v31, s[48:51], s60 offen nt lds
    s_add_u32 m0, s63, 20480
    s_mov_b32 s60, 20736
    buffer_load_dwordx4 v31, s[48:51], s60 offen nt lds
    s_add_u32 m0, s63, 24576
    s_mov_b32 s60, 41216
    buffer_load_dwordx4 v31, s[48:51], s60 offen nt lds
    s_add_u32 m0, s63, 28672
    s_mov_b32 s60, 61696
    buffer_load_dwordx4 v31, s[48:51], s60 offen nt lds
    s_add_u32 m0, s63, 32768
    s_mov_b32 s60, 512
    buffer_load_dwordx4 v31, s[48:51], s60 offen nt lds
    s_add_u32 m0, s63, 36864
    s_mov_b32 s60, 20992
    buffer_load_dwordx4 v31, s[48:51], s60 offen nt lds
    s_add_u32 m0, s63, 40960
    s_mov_b32 s60, 41472
    buffer_load_dwordx4 v31, s[48:51], s60 offen nt lds
    s_add_u32 m0, s63, 45056
    s_mov_b32 s60, 61952
    buffer_load_dwordx4 v31, s[48:51], s60 offen nt lds
    s_add_u32 m0, s63, 49152
    s_mov_b32 s60, 768
    buffer_load_dwordx4 v31, s[48:51], s60 offen nt lds
    s_add_u32 m0, s63, 53248
    s_mov_b32 s60, 21248
    buffer_load_dwordx4 v31, s[48:51], s60 offen nt lds
    s_add_u32 m0, s63, 57344
    s_mov_b32 s60, 41728
    buffer_load_dwordx4 v31, s[48:51], s60 offen nt lds
    s_add_u32 m0, s63, 61440
    s_mov_b32 s60, 62208
    buffer_load_dwordx4 v31, s[48:51], s60 offen nt lds
    s_add_u32 m0, s63, 65536
    s_mov_b32 s60, 1024
    buffer_load_dwordx4 v31, s[48:51], s60 offen nt lds
    s_add_u32 m0, s63, 69632
    s_mov_b32 s60, 21504
    buffer_load_dwordx4 v31, s[48:51], s60 offen nt lds
    s_add_u32 m0, s63, 73728
    s_mov_b32 s60, 41984
    buffer_load_dwordx4 v31, s[48:51], s60 offen nt lds
    s_add_u32 m0, s63, 77824
    s_mov_b32 s60, 62464
    buffer_load_dwordx4 v31, s[48:51], s60 offen nt lds
    s_sub_u32 s60, s56, 27
    s_mul_i32 s60, s60, 28672
    v_lshlrev_b32 v30, 4, v0
    s_add_u32 m0, s63, 81920
    s_nop 0
    buffer_load_dwordx4 v30, s[40:43], s60 offen lds
    s_add_u32 s60, s60, 4096
    buffer_load_dwordx4 v30, s[40:43], s60 offen lds
    s_add_u32 s60, s60, 4096
    buffer_load_dwordx4 v30, s[40:43], s60 offen lds
    s_add_u32 s60, s60, 4096
    buffer_load_dwordx4 v30, s[40:43], s60 offen lds
    s_add_u32 s60, s60, 4096
    buffer_load_dwordx4 v30, s[40:43], s60 offen lds
    s_add_u32 s60, s60, 4096
    buffer_load_dwordx4 v30, s[40:43], s60 offen lds
    s_add_u32 s60, s60, 4096
    buffer_load_dwordx4 v30, s[40:43], s60 offen lds
    s_add_u32 s60, s60, 4096
    s_waitcnt vmcnt(7)
    s_barrier
    s_branch K_END
K_FC:
    s_waitcnt lgkmcnt(0)
    v_mov_b32 v241, 0x3f803f80
    s_mul_i32 s52, s52, 0x9E3779B1
    s_add_u32 s52, s52, 0x7F4A7C15
    s_or_b32 s52, s52, 1
    v_mov_b32 v245, s52
    v_mov_b32 v247, s52
    s_bfe_u32 s60, s2, 0x10002
    s_lshl4_add_u32 s60, s68, s60
    s_sub_u32 s60, 0xffff, s60
    v_lshlrev_b32 v239, 1, v232
    v_sub_u32 v239, s60, v239
    v_lshlrev_b32 v243, 3, v232
    v_lshlrev_b32 v232, 4, v232
    v_mov_b32 v249, s52
    s_setprio 3
    s_waitcnt vmcnt(3)
    v_dot2_f32_bf16 v233, v212, v241, 0
    v_dot2_f32_bf16 v234, v212, v212, 0
    v_dot2_f32_bf16 v233, v213, v241, v233
    v_dot2_f32_bf16 v234, v213, v213, v234
    v_dot2_f32_bf16 v233, v214, v241, v233
    v_dot2_f32_bf16 v234, v214, v214, v234
    v_dot2_f32_bf16 v233, v215, v241, v233
    v_dot2_f32_bf16 v234, v215, v215, v234
    v_dot2_f32_bf16 v233, v216, v241, v233
    v_dot2_f32_bf16 v234, v216, v216, v234
    v_dot2_f32_bf16 v233, v217, v241, v233
    v_dot2_f32_bf16 v234, v217, v217, v234
    v_dot2_f32_bf16 v233, v218, v241, v233
    v_dot2_f32_bf16 v234, v218, v218, v234
    v_dot2_f32_bf16 v233, v219, v241, v233
    v_dot2_f32_bf16 v234, v219, v219, v234
    v_dot2_f32_bf16 v233, v220, v241, v233
    v_dot2_f32_bf16 v234, v220, v220, v234
    v_dot2_f32_bf16 v233, v221, v241, v233
    v_dot2_f32_bf16 v234, v221, v221, v234
    s_waitcnt vmcnt(0)
    v_dot2_f32_bf16 v235, v212, v222, 0
    v_dot2_f32_bf16 v236, v222, v241, 0
    v_dot2_f32_bf16 v235, v213, v223, v235
    v_dot2_f32_bf16 v236, v223, v241, v236
    v_dot2_f32_bf16 v235, v214, v224, v235
    v_dot2_f32_bf16 v236, v224, v241, v236
    v_dot2_f32_bf16 v235, v215, v225, v235
    v_dot2_f32_bf16 v236, v225, v241, v236
    v_dot2_f32_bf16 v235, v216, v226, v235
    v_dot2_f32_bf16 v236, v226, v241, v236
    v_dot2_f32_bf16 v235, v217, v227, v235
    v_dot2_f32_bf16 v236, v227, v241, v236
    v_dot2_f32_bf16 v235, v218, v228, v235
    v_dot2_f32_bf16 v236, v228, v241, v236
    v_dot2_f32_bf16 v235, v219, v229, v235
    v_dot2_f32_bf16 v236, v229, v241, v236
    v_dot2_f32_bf16 v235, v220, v230, v235
    v_dot2_f32_bf16 v236, v230, v241, v236
    v_dot2_f32_bf16 v235, v221, v231, v235
    v_dot2_f32_bf16 v236, v231, v241, v236
    v_permlane16_swap_b32 v233, v234
    v_add_f32 v233, v233, v234
    s_nop 0
    v_permlane16_swap_b32 v235, v236
    v_add_f32 v235, v235, v236
    v_add_f32_dpp v233, v233, v233 row_ror:8 row_mask:0xf bank_mask:0xf
    s_nop 0
    v_add_f32_dpp v235, v235, v235 row_ror:8 row_mask:0xf bank_mask:0xf
    v_add_f32_dpp v233, v233, v233 row_ror:4 row_mask:0xf bank_mask:0xf
    s_nop 0
    v_add_f32_dpp v235, v235, v235 row_ror:4 row_mask:0xf bank_mask:0xf
    v_add_f32_dpp v233, v233, v233 row_ror:2 row_mask:0xf bank_mask:0xf
    s_nop 0
    v_add_f32_dpp v235, v235, v235 row_ror:2 row_mask:0xf bank_mask:0xf
    v_add_f32_dpp v233, v233, v233 row_ror:1 row_mask:0xf bank_mask:0xf
    s_nop 0
    v_add_f32_dpp v235, v235, v235 row_ror:1 row_mask:0xf bank_mask:0xf
    v_mul_f32 v233, 0x3acccccd, v233
    v_mov_b32 v236, v235
    v_mov_b32 v234, v233
    s_nop 0
    v_permlane16_swap_b32 v235, v236
    v_permlane16_swap_b32 v233, v234
    v_fma_f32 v234, -v233, v233, v234
    v_max_f32 v234, 0, v234
    v_cvt_pk_bf16_f32 v237, v233, v234
    v_lshlrev_b32 v233, 16, v237
    v_and_b32 v234, 0xffff0000, v237
    v_add_f32 v234, 0x3727c5ac, v234
    v_cvt_pk_bf16_f32 v234, v234, v234
    v_lshlrev_b32 v234, 16, v234
    v_sqrt_f32 v234, v234
    v_fma_f32 v235, -v233, v236, v235
    v_cvt_pk_bf16_f32 v234, v234, v234
    v_lshlrev_b32 v234, 16, v234
    v_rcp_f32 v246, v234
    s_mov_b32 exec_lo, 1
    s_mov_b32 exec_hi, 1
    v_mul_f32 v235, v235, v246
    v_xor_b32 v244, 0x80000000, v233
    v_cvt_pk_bf16_f32 v235, v235, v235
    buffer_store_dwordx4 v[244:247], v232, s[28:31], s70 offen sc1
    v_ashrrev_i32 v237, 31, v235
    v_or_b32 v237, 0x80000000, v237
    v_xor_b32 v235, v235, v237
    v_bfi_b32 v248, s55, v235, v239
    buffer_store_dwordx2 v[248:249], v243, s[28:31], s71 offen sc1
    s_mov_b64 exec, -1
    s_cmp_ge_u32 s56, 27
    s_cbranch_scc1 FC_SPARE
    v_bfe_u32 v7, v1, 2, 2
    v_and_b32 v8, 3, v1
    v_lshl_add_u32 v6, v5, 3, v7
    v_bfe_u32 v2, v1, 3, 2
    v_xor_b32 v2, s59, v2
    v_lshlrev_b32 v9, 5, v2
    v_lshl_add_u32 v9, v8, 3, v9
    v_lshl_add_u32 v9, v6, 7, v9
    v_add_u32 v8, 65536, v9
    v_mov_b32 v176, 0x3f803f80
    v_mov_b32 v177, 0x3f803f80
    v_mov_b32 v178, 0x3f803f80
    v_mov_b32 v179, 0x3f803f80
    v_mov_b32 v180, 0x3f803f80
    v_mov_b32 v181, 0x3f803f80
    v_mov_b32 v182, 0x3f803f80
    v_mov_b32 v183, 0x3f803f80
    v_mov_b32 v184, 0x3f803f80
    v_mov_b32 v185, 0x3f803f80
    v_mov_b32 v186, 0x3f803f80
    v_mov_b32 v187, 0x3f803f80
    v_mov_b32 v188, 0x3f803f80
    v_mov_b32 v189, 0x3f803f80
    v_mov_b32 v190, 0x3f803f80
    v_mov_b32 v191, 0x3f803f80
    v_mov_b32 v192, 0x3f803f80
    v_mov_b32 v193, 0x3f803f80
    v_mov_b32 v194, 0x3f803f80
    v_mov_b32 v195, 0x3f803f80
    v_mov_b32 v196, 0x3f803f80
    v_mov_b32 v197, 0x3f803f80
    v_mov_b32 v198, 0x3f803f80
    v_mov_b32 v199, 0x3f803f80
    v_mov_b32 v200, 0x3f803f80
    v_mov_b32 v201, 0x3f803f80
    v_mov_b32 v202, 0x3f803f80
    v_mov_b32 v203, 0x3f803f80
    v_mov_b32 v204, 0x3f803f80
    v_mov_b32 v205, 0x3f803f80
    v_mov_b32 v206, 0x3f803f80
    v_mov_b32 v207, 0x3f803f80
    v_mov_b32 v208, 0x3f803f80
    v_mov_b32 v209, 0x3f803f80
    v_mov_b32 v210, 0x3f803f80
    v_mov_b32 v211, 0x3f803f80
    v_mov_b32 v212, 0x3f803f80
    v_mov_b32 v213, 0x3f803f80
    v_mov_b32 v214, 0x3f803f80
    v_mov_b32 v215, 0x3f803f80
    v_mov_b32 v216, 0x3f803f80
    v_mov_b32 v217, 0x3f803f80
    v_mov_b32 v218, 0x3f803f80
    v_mov_b32 v219, 0x3f803f80
    v_mov_b32 v220, 0x3f803f80
    v_mov_b32 v221, 0x3f803f80
    v_mov_b32 v222, 0x3f803f80
    v_mov_b32 v223, 0x3f803f80
    v_mov_b32 v224, 0x3f803f80
    v_mov_b32 v225, 0x3f803f80
    v_mov_b32 v226, 0x3f803f80
    v_mov_b32 v227, 0x3f803f80
    v_mov_b32 v228, 0x3f803f80
    v_mov_b32 v229, 0x3f803f80
    v_mov_b32 v230, 0x3f803f80
    v_mov_b32 v231, 0x3f803f80
    v_mov_b32 v232, 0x3f803f80
    v_mov_b32 v233, 0x3f803f80
    v_mov_b32 v234, 0x3f803f80
    v_mov_b32 v235, 0x3f803f80
    v_mov_b32 v236, 0x3f803f80
    v_mov_b32 v237, 0x3f803f80
    v_mov_b32 v238, 0x3f803f80
    v_mov_b32 v239, 0x3f803f80
    v_mov_b32 v240, 0x3f803f80
    v_mov_b32 v241, 0x3f803f80
    v_mov_b32 v242, 0x3f803f80
    v_mov_b32 v243, 0x3f803f80
    v_mov_b32 v244, 0x3f803f80
    v_mov_b32 v245, 0x3f803f80
    v_mov_b32 v246, 0x3f803f80
    v_mov_b32 v247, 0x3f803f80
    v_mov_b32 v248, 0x3f803f80
    v_mov_b32 v249, 0x3f803f80
    v_mov_b32 v250, 0x3f803f80
    v_mov_b32 v251, 0x3f803f80
    v_mov_b32 v252, 0x3f803f80
    v_mov_b32 v253, 0x3f803f80
    v_mov_b32 v254, 0x3f803f80
    v_mov_b32 v255, 0x3f803f80
    s_lshl2_add_u32 s65, s56, s59
    v_bfe_i32 v17, v1, 0, 1
    v_bfe_u32 v6, v0, 4, 4
    v_lshlrev_b32 v6, 3, v6
    v_add_u32 v6, 157952, v6
    v_lshlrev_b32 v7, 3, v4
    v_add_u32 v7, 157952, v7
    s_barrier
    v_lshlrev_b32 v12, 4, v1
    s_lshl_b32 s62, s59, 12
    s_add_u32 s60, s62, 49152
    buffer_load_dwordx4 v[120:123], v12, s[28:31], s60 offen offset:0 sc1
    buffer_load_dwordx4 v[124:127], v12, s[28:31], s60 offen offset:1024 sc1
    buffer_load_dwordx4 v[128:131], v12, s[28:31], s60 offen offset:2048 sc1
    buffer_load_dwordx4 v[132:135], v12, s[28:31], s60 offen offset:3072 sc1
    ds_read_b64_tr_b16 v[24:25], v9 offset:0
    ds_read_b64_tr_b16 v[26:27], v9 offset:512
    ds_read_b64_tr_b16 v[72:73], v9 offset:16384
    ds_read_b64_tr_b16 v[74:75], v9 offset:16896
    ds_read_b64_tr_b16 v[28:29], v9 offset:4096
    ds_read_b64_tr_b16 v[30:31], v9 offset:4608
    ds_read_b64_tr_b16 v[76:77], v9 offset:20480
    ds_read_b64_tr_b16 v[78:79], v9 offset:20992
    ds_read_b64_tr_b16 v[32:33], v9 offset:8192
    ds_read_b64_tr_b16 v[34:35], v9 offset:8704
    ds_read_b64_tr_b16 v[80:81], v9 offset:24576
    ds_read_b64_tr_b16 v[82:83], v9 offset:25088
    ds_read_b64_tr_b16 v[36:37], v9 offset:12288
    ds_read_b64_tr_b16 v[38:39], v9 offset:12800
    ds_read_b64_tr_b16 v[84:85], v9 offset:28672
    ds_read_b64_tr_b16 v[86:87], v9 offset:29184
    s_waitcnt lgkmcnt(0)
    s_barrier
    s_waitcnt vmcnt(0)
FC_KY_CHK:
    v_xor_b32 v2, s52, v121
    v_bitop3_b32 v2, v123, s52, v2 bitop3:0xbe
    v_bitop3_b32 v2, v125, s52, v2 bitop3:0xbe
    v_bitop3_b32 v2, v127, s52, v2 bitop3:0xbe
    v_bitop3_b32 v2, v129, s52, v2 bitop3:0xbe
    v_bitop3_b32 v2, v131, s52, v2 bitop3:0xbe
    v_bitop3_b32 v2, v133, s52, v2 bitop3:0xbe
    v_bitop3_b32 v2, v135, s52, v2 bitop3:0xbe
    v_cmp_ne_u32 vcc, 0, v2
    s_cbranch_vccz FC_KY_OK
FC_KY_RETRY:
    s_add_u32 s100, s100, 1
    s_cmp_gt_u32 s100, 20000
    s_cbranch_scc1 FC_KY_OK
    s_sleep 16
    s_add_u32 s60, s62, 49152
    buffer_load_dwordx4 v[120:123], v12, s[28:31], s60 offen offset:0 sc1
    buffer_load_dwordx4 v[124:127], v12, s[28:31], s60 offen offset:1024 sc1
    buffer_load_dwordx4 v[128:131], v12, s[28:31], s60 offen offset:2048 sc1
    buffer_load_dwordx4 v[132:135], v12, s[28:31], s60 offen offset:3072 sc1
    s_waitcnt vmcnt(0)
    s_branch FC_KY_CHK
FC_KY_OK:
    v_max_u32 v20, v120, v122
    v_min_u32 v21, v120, v122
    v_med3_u32 v21, v20, v21, v124
    v_max_u32 v20, v20, v124
    v_med3_u32 v21, v20, v21, v126
    v_max_u32 v20, v20, v126
    v_med3_u32 v21, v20, v21, v128
    v_max_u32 v20, v20, v128
    v_med3_u32 v21, v20, v21, v130
    v_max_u32 v20, v20, v130
    v_med3_u32 v21, v20, v21, v132
    v_max_u32 v20, v20, v132
    v_med3_u32 v21, v20, v21, v134
    v_max_u32 v20, v20, v134
    s_nop 1
    v_mov_b32_dpp v22, v20 row_ror:8 row_mask:0xf bank_mask:0xf
    v_mov_b32_dpp v23, v21 row_ror:8 row_mask:0xf bank_mask:0xf
    v_min_u32 v2, v20, v22
    v_max_u32 v20, v20, v22
    v_max3_u32 v21, v21, v23, v2
    s_nop 0
    v_mov_b32_dpp v22, v20 row_ror:4 row_mask:0xf bank_mask:0xf
    v_mov_b32_dpp v23, v21 row_ror:4 row_mask:0xf bank_mask:0xf
    v_min_u32 v2, v20, v22
    v_max_u32 v20, v20, v22
    v_max3_u32 v21, v21, v23, v2
    s_nop 0
    v_mov_b32_dpp v22, v20 row_ror:2 row_mask:0xf bank_mask:0xf
    v_mov_b32_dpp v23, v21 row_ror:2 row_mask:0xf bank_mask:0xf
    v_min_u32 v2, v20, v22
    v_max_u32 v20, v20, v22
    v_max3_u32 v21, v21, v23, v2
    s_nop 0
    v_mov_b32_dpp v22, v20 row_ror:1 row_mask:0xf bank_mask:0xf
    v_mov_b32_dpp v23, v21 row_ror:1 row_mask:0xf bank_mask:0xf
    v_min_u32 v2, v20, v22
    v_max_u32 v20, v20, v22
    v_max3_u32 v21, v21, v23, v2
    ds_write_b64 v6, v[20:21]
    s_waitcnt lgkmcnt(0)
    s_barrier
    ds_read_b64 v[20:21], v7
    s_waitcnt lgkmcnt(0)
    v_mov_b32_dpp v22, v20 row_ror:8 row_mask:0xf bank_mask:0xf
    v_mov_b32_dpp v23, v21 row_ror:8 row_mask:0xf bank_mask:0xf
    v_min_u32 v2, v20, v22
    v_max_u32 v20, v20, v22
    v_max3_u32 v21, v21, v23, v2
    s_nop 0
    v_mov_b32_dpp v22, v20 row_ror:4 row_mask:0xf bank_mask:0xf
    v_mov_b32_dpp v23, v21 row_ror:4 row_mask:0xf bank_mask:0xf
    v_min_u32 v2, v20, v22
    v_max_u32 v20, v20, v22
    v_max3_u32 v21, v21, v23, v2
    s_nop 0
    v_mov_b32_dpp v22, v20 row_ror:2 row_mask:0xf bank_mask:0xf
    v_mov_b32_dpp v23, v21 row_ror:2 row_mask:0xf bank_mask:0xf
    v_min_u32 v2, v20, v22
    v_max_u32 v20, v20, v22
    v_max3_u32 v21, v21, v23, v2
    s_nop 0
    v_mov_b32_dpp v22, v20 row_ror:1 row_mask:0xf bank_mask:0xf
    v_mov_b32_dpp v23, v21 row_ror:1 row_mask:0xf bank_mask:0xf
    v_min_u32 v2, v20, v22
    v_max_u32 v20, v20, v22
    v_max3_u32 v21, v21, v23, v2
    v_bfi_b32 v10, v17, v21, v20
    v_not_b32 v2, v10
    v_and_b32 v2, 2047, v2
    v_mul_u32_u24 v17, 1280, v2
    v_lshrrev_b32 v16, 1, v2
    v_and_b32 v3, 1, v2
    v_lshl_add_u32 v16, v3, 10, v16
    v_readlane_b32 s60, v17, 0
    v_readlane_b32 s61, v17, 1
    v_lshlrev_b32 v16, 4, v16
    v_add_u32 v16, 16384, v16
    s_mul_i32 s62, s59, 2624
    s_add_u32 s62, s62, 147456
    s_add_u32 m0, s62, 0
    s_nop 0
    buffer_load_dwordx4 v12, s[24:27], s60 offen lds
    s_add_u32 m0, s62, 1344
    s_nop 0
    buffer_load_dwordx4 v12, s[24:27], s61 offen lds
    s_mov_b64 exec, 0xffff
    s_add_u32 m0, s62, 0
    s_nop 0
    buffer_load_dwordx4 v12, s[24:27], s60 offen offset:1024 lds
    s_add_u32 m0, s62, 1344
    s_nop 0
    buffer_load_dwordx4 v12, s[24:27], s61 offen offset:1024 lds
    s_mov_b32 exec_lo, 0x00030003
    s_mov_b32 exec_hi, 0x00030003
    buffer_load_dwordx4 v[20:23], v16, s[28:31], 0 offen
    s_mov_b64 exec, -1
    v_and_b32 v17, 1, v1
    v_mul_u32_u24 v17, 1344, v17
    v_lshl_add_u32 v17, v5, 4, v17
    v_add_u32 v17, s62, v17
    ds_read_b64_tr_b16 v[40:41], v9 offset:32768
    ds_read_b64_tr_b16 v[42:43], v9 offset:33280
    ds_read_b64_tr_b16 v[88:89], v9 offset:49152
    ds_read_b64_tr_b16 v[90:91], v9 offset:49664
    ds_read_b64_tr_b16 v[44:45], v9 offset:36864
    ds_read_b64_tr_b16 v[46:47], v9 offset:37376
    ds_read_b64_tr_b16 v[92:93], v9 offset:53248
    ds_read_b64_tr_b16 v[94:95], v9 offset:53760
    ds_read_b64_tr_b16 v[48:49], v9 offset:40960
    ds_read_b64_tr_b16 v[50:51], v9 offset:41472
    ds_read_b64_tr_b16 v[96:97], v9 offset:57344
    ds_read_b64_tr_b16 v[98:99], v9 offset:57856
    ds_read_b64_tr_b16 v[52:53], v9 offset:45056
    ds_read_b64_tr_b16 v[54:55], v9 offset:45568
    ds_read_b64_tr_b16 v[100:101], v9 offset:61440
    ds_read_b64_tr_b16 v[102:103], v9 offset:61952
    ds_read_b64_tr_b16 v[56:57], v8 offset:0
    ds_read_b64_tr_b16 v[58:59], v8 offset:512
    ds_read_b64_tr_b16 v[104:105], v8 offset:16384
    ds_read_b64_tr_b16 v[106:107], v8 offset:16896
    ds_read_b64_tr_b16 v[60:61], v8 offset:4096
    ds_read_b64_tr_b16 v[62:63], v8 offset:4608
    ds_read_b64_tr_b16 v[108:109], v8 offset:20480
    ds_read_b64_tr_b16 v[110:111], v8 offset:20992
    ds_read_b64_tr_b16 v[64:65], v8 offset:8192
    ds_read_b64_tr_b16 v[66:67], v8 offset:8704
    ds_read_b64_tr_b16 v[112:113], v8 offset:24576
    ds_read_b64_tr_b16 v[114:115], v8 offset:25088
    ds_read_b64_tr_b16 v[68:69], v8 offset:12288
    ds_read_b64_tr_b16 v[70:71], v8 offset:12800
    ds_read_b64_tr_b16 v[116:117], v8 offset:28672
    ds_read_b64_tr_b16 v[118:119], v8 offset:29184
    s_waitcnt vmcnt(0)
    s_mov_b32 exec_lo, 0x00030003
    s_mov_b32 exec_hi, 0x00030003
    ds_read_b128 v[176:179], v17 offset:0
    ds_read_b128 v[180:183], v17 offset:64
    ds_read_b128 v[184:187], v17 offset:128
    ds_read_b128 v[188:191], v17 offset:192
    ds_read_b128 v[192:195], v17 offset:256
    ds_read_b128 v[196:199], v17 offset:320
    ds_read_b128 v[200:203], v17 offset:384
    ds_read_b128 v[204:207], v17 offset:448
    ds_read_b128 v[208:211], v17 offset:512
    ds_read_b128 v[212:215], v17 offset:576
    ds_read_b128 v[216:219], v17 offset:640
    ds_read_b128 v[220:223], v17 offset:704
    ds_read_b128 v[224:227], v17 offset:768
    ds_read_b128 v[228:231], v17 offset:832
    ds_read_b128 v[232:235], v17 offset:896
    ds_read_b128 v[236:239], v17 offset:960
    ds_read_b128 v[240:243], v17 offset:1024
    ds_read_b128 v[244:247], v17 offset:1088
    ds_read_b128 v[248:251], v17 offset:1152
    ds_read_b128 v[252:255], v17 offset:1216
    s_mov_b64 exec, -1
    s_waitcnt lgkmcnt(15)
    v_mfma_f32_16x16x32_bf16 v[152:155], v[24:27], v[176:179], 0
    v_mfma_f32_16x16x32_bf16 v[156:159], v[72:75], v[176:179], 0
    v_mfma_f32_16x16x32_bf16 v[152:155], v[28:31], v[180:183], v[152:155]
    v_mfma_f32_16x16x32_bf16 v[156:159], v[76:79], v[180:183], v[156:159]
    v_mfma_f32_16x16x32_bf16 v[152:155], v[32:35], v[184:187], v[152:155]
    v_mfma_f32_16x16x32_bf16 v[156:159], v[80:83], v[184:187], v[156:159]
    v_mfma_f32_16x16x32_bf16 v[152:155], v[36:39], v[188:191], v[152:155]
    v_mfma_f32_16x16x32_bf16 v[156:159], v[84:87], v[188:191], v[156:159]
    s_waitcnt lgkmcnt(12)
    v_mfma_f32_16x16x32_bf16 v[152:155], v[40:43], v[192:195], v[152:155]
    v_mfma_f32_16x16x32_bf16 v[156:159], v[88:91], v[192:195], v[156:159]
    v_mfma_f32_16x16x32_bf16 v[152:155], v[44:47], v[196:199], v[152:155]
    v_mfma_f32_16x16x32_bf16 v[156:159], v[92:95], v[196:199], v[156:159]
    v_mfma_f32_16x16x32_bf16 v[152:155], v[48:51], v[200:203], v[152:155]
    v_mfma_f32_16x16x32_bf16 v[156:159], v[96:99], v[200:203], v[156:159]
    v_mfma_f32_16x16x32_bf16 v[152:155], v[52:55], v[204:207], v[152:155]
    v_mfma_f32_16x16x32_bf16 v[156:159], v[100:103], v[204:207], v[156:159]
    s_waitcnt lgkmcnt(8)
    v_mfma_f32_16x16x32_bf16 v[152:155], v[56:59], v[208:211], v[152:155]
    v_mfma_f32_16x16x32_bf16 v[156:159], v[104:107], v[208:211], v[156:159]
    v_mfma_f32_16x16x32_bf16 v[152:155], v[60:63], v[212:215], v[152:155]
    v_mfma_f32_16x16x32_bf16 v[156:159], v[108:111], v[212:215], v[156:159]
    v_mfma_f32_16x16x32_bf16 v[152:155], v[64:67], v[216:219], v[152:155]
    v_mfma_f32_16x16x32_bf16 v[156:159], v[112:115], v[216:219], v[156:159]
    v_mfma_f32_16x16x32_bf16 v[152:155], v[68:71], v[220:223], v[152:155]
    v_mfma_f32_16x16x32_bf16 v[156:159], v[116:119], v[220:223], v[156:159]
    s_barrier
    ds_read_b64_tr_b16 v[120:121], v8 offset:32768
    ds_read_b64_tr_b16 v[122:123], v8 offset:33280
    ds_read_b64_tr_b16 v[136:137], v8 offset:49152
    ds_read_b64_tr_b16 v[138:139], v8 offset:49664
    ds_read_b64_tr_b16 v[124:125], v8 offset:36864
    ds_read_b64_tr_b16 v[126:127], v8 offset:37376
    ds_read_b64_tr_b16 v[140:141], v8 offset:53248
    ds_read_b64_tr_b16 v[142:143], v8 offset:53760
    ds_read_b64_tr_b16 v[128:129], v8 offset:40960
    ds_read_b64_tr_b16 v[130:131], v8 offset:41472
    ds_read_b64_tr_b16 v[144:145], v8 offset:57344
    ds_read_b64_tr_b16 v[146:147], v8 offset:57856
    ds_read_b64_tr_b16 v[132:133], v8 offset:45056
    ds_read_b64_tr_b16 v[134:135], v8 offset:45568
    ds_read_b64_tr_b16 v[148:149], v8 offset:61440
    ds_read_b64_tr_b16 v[150:151], v8 offset:61952
    ds_read_b64_tr_b16 v[24:25], v9 offset:0
    ds_read_b64_tr_b16 v[26:27], v9 offset:512
    ds_read_b64_tr_b16 v[72:73], v9 offset:16384
    ds_read_b64_tr_b16 v[74:75], v9 offset:16896
    ds_read_b64_tr_b16 v[28:29], v9 offset:4096
    ds_read_b64_tr_b16 v[30:31], v9 offset:4608
    ds_read_b64_tr_b16 v[76:77], v9 offset:20480
    ds_read_b64_tr_b16 v[78:79], v9 offset:20992
    ds_read_b64_tr_b16 v[32:33], v9 offset:8192
    ds_read_b64_tr_b16 v[34:35], v9 offset:8704
    ds_read_b64_tr_b16 v[80:81], v9 offset:24576
    ds_read_b64_tr_b16 v[82:83], v9 offset:25088
    ds_read_b64_tr_b16 v[36:37], v9 offset:12288
    ds_read_b64_tr_b16 v[38:39], v9 offset:12800
    ds_read_b64_tr_b16 v[84:85], v9 offset:28672
    ds_read_b64_tr_b16 v[86:87], v9 offset:29184
    s_waitcnt lgkmcnt(15)
    v_mfma_f32_16x16x32_bf16 v[152:155], v[120:123], v[224:227], v[152:155]
    v_mfma_f32_16x16x32_bf16 v[156:159], v[136:139], v[224:227], v[156:159]
    v_mfma_f32_16x16x32_bf16 v[152:155], v[124:127], v[228:231], v[152:155]
    v_mfma_f32_16x16x32_bf16 v[156:159], v[140:143], v[228:231], v[156:159]
    v_mfma_f32_16x16x32_bf16 v[152:155], v[128:131], v[232:235], v[152:155]
    v_mfma_f32_16x16x32_bf16 v[156:159], v[144:147], v[232:235], v[156:159]
    v_mfma_f32_16x16x32_bf16 v[152:155], v[132:135], v[236:239], v[152:155]
    v_mfma_f32_16x16x32_bf16 v[156:159], v[148:151], v[236:239], v[156:159]
    s_waitcnt lgkmcnt(0)
    v_mfma_f32_16x16x32_bf16 v[152:155], v[24:27], v[240:243], v[152:155]
    v_mfma_f32_16x16x32_bf16 v[156:159], v[72:75], v[240:243], v[156:159]
    v_mfma_f32_16x16x32_bf16 v[152:155], v[28:31], v[244:247], v[152:155]
    v_mfma_f32_16x16x32_bf16 v[156:159], v[76:79], v[244:247], v[156:159]
    v_mfma_f32_16x16x32_bf16 v[152:155], v[32:35], v[248:251], v[152:155]
    v_mfma_f32_16x16x32_bf16 v[156:159], v[80:83], v[248:251], v[156:159]
    v_mfma_f32_16x16x32_bf16 v[152:155], v[36:39], v[252:255], v[152:155]
    v_mfma_f32_16x16x32_bf16 v[156:159], v[84:87], v[252:255], v[156:159]
    s_mov_b32 exec_lo, 0x00030003
    s_mov_b32 exec_hi, 0x00030003
    s_waitcnt vmcnt(0)
FC_RC_CHK:
    v_xor_b32 v2, s52, v21
    v_bitop3_b32 v2, v23, s52, v2 bitop3:0xbe
    v_cmp_ne_u32 vcc, 0, v2
    s_cbranch_vccz FC_RC_OK
FC_RC_RETRY:
    s_add_u32 s100, s100, 1
    s_cmp_gt_u32 s100, 20000
    s_cbranch_scc1 FC_RC_OK
    s_sleep 2
    buffer_load_dwordx4 v[20:23], v16, s[28:31], 0 offen sc1
    s_waitcnt vmcnt(0)
    s_branch FC_RC_CHK
FC_RC_OK:
    s_mov_b64 exec, -1
    v_mov_b32_dpp v160, v152 row_newbcast:2 row_mask:0xf bank_mask:0xf
    v_mov_b32_dpp v164, v156 row_newbcast:2 row_mask:0xf bank_mask:0xf
    v_mov_b32_dpp v161, v153 row_newbcast:2 row_mask:0xf bank_mask:0xf
    v_mov_b32_dpp v165, v157 row_newbcast:2 row_mask:0xf bank_mask:0xf
    v_mov_b32_dpp v162, v154 row_newbcast:2 row_mask:0xf bank_mask:0xf
    v_mov_b32_dpp v166, v158 row_newbcast:2 row_mask:0xf bank_mask:0xf
    v_mov_b32_dpp v163, v155 row_newbcast:2 row_mask:0xf bank_mask:0xf
    v_mov_b32_dpp v167, v159 row_newbcast:2 row_mask:0xf bank_mask:0xf
    v_fma_f32 v152, v20, v160, v152
    v_fma_f32 v156, v20, v164, v156
    v_fma_f32 v153, v20, v161, v153
    v_fma_f32 v157, v20, v165, v157
    v_fma_f32 v154, v20, v162, v154
    v_fma_f32 v158, v20, v166, v158
    v_fma_f32 v155, v20, v163, v155
    v_fma_f32 v159, v20, v167, v159
    v_mul_f32 v152, v152, v22
    v_mul_f32 v156, v156, v22
    v_mul_f32 v153, v153, v22
    v_mul_f32 v157, v157, v22
    v_mul_f32 v154, v154, v22
    v_mul_f32 v158, v158, v22
    v_mul_f32 v155, v155, v22
    v_mul_f32 v159, v159, v22
    v_cvt_pk_bf16_f32 v152, v152, v156
    v_cvt_pk_bf16_f32 v153, v153, v157
    v_cvt_pk_bf16_f32 v154, v154, v158
    v_cvt_pk_bf16_f32 v155, v155, v159
    v_and_b32 v156, s55, v152
    v_lshlrev_b32 v152, 16, v152
    v_and_b32 v157, s55, v153
    v_lshlrev_b32 v153, 16, v153
    v_and_b32 v158, s55, v154
    v_lshlrev_b32 v154, 16, v154
    v_and_b32 v159, s55, v155
    v_lshlrev_b32 v155, 16, v155
    v_mul_f32 v160, 0xbfb8aa3b, v152
    v_mul_f32 v161, 0xbfb8aa3b, v153
    v_mul_f32 v162, 0xbfb8aa3b, v154
    v_mul_f32 v163, 0xbfb8aa3b, v155
    v_exp_f32 v160, v160
    v_exp_f32 v161, v161
    v_exp_f32 v162, v162
    v_exp_f32 v163, v163
    v_add_f32 v160, 1.0, v160
    v_add_f32 v161, 1.0, v161
    v_add_f32 v162, 1.0, v162
    v_add_f32 v163, 1.0, v163
    v_rcp_f32 v160, v160
    v_rcp_f32 v161, v161
    v_rcp_f32 v162, v162
    v_rcp_f32 v163, v163
    v_mul_f32 v152, v152, v160
    v_mul_f32 v153, v153, v161
    v_mul_f32 v154, v154, v162
    v_mul_f32 v155, v155, v163
    v_cvt_pk_bf16_f32 v152, v152, v152
    v_cvt_pk_bf16_f32 v153, v153, v153
    v_cvt_pk_bf16_f32 v154, v154, v154
    v_cvt_pk_bf16_f32 v155, v155, v155
    v_lshlrev_b32 v152, 16, v152
    v_lshlrev_b32 v153, 16, v153
    v_lshlrev_b32 v154, 16, v154
    v_lshlrev_b32 v155, 16, v155
    v_mul_f32 v152, v152, v156
    v_mul_f32 v153, v153, v157
    v_mul_f32 v154, v154, v158
    v_mul_f32 v155, v155, v159
    v_cvt_pk_bf16_f32 v152, v152, v153
    v_cvt_pk_bf16_f32 v154, v154, v155
    v_mov_b32 v153, s52
    v_mov_b32 v155, s52
    v_lshlrev_b32 v3, 6, v4
    v_lshl_add_u32 v3, v5, 4, v3
    s_lshl_b32 s60, s65, 7
    s_add_u32 s60, s60, 425984
    s_mov_b32 exec_lo, 0x00030003
    s_mov_b32 exec_hi, 0x00030003
    buffer_store_dwordx4 v[152:155], v3, s[28:31], s60 offen sc1
    s_mov_b64 exec, -1
    s_branch K_END
FC_SPARE:
    v_bfe_u32 v7, v1, 2, 2
    v_and_b32 v8, 3, v1
    v_and_b32 v3, 1, v5
    v_lshl_or_b32 v12, v3, 2, v7
    v_lshl_add_u32 v6, v5, 3, v7
    v_lshlrev_b32 v13, 8, v6
    v_lshl_add_u32 v13, v8, 3, v13
    s_lshl3_add_u32 s60, s56, s3
    s_lshl_b32 s60, s60, 10
    s_add_u32 s60, s60, 827392
    v_mov_b32 v108, -1
    v_mov_b32 v109, -1
    v_mov_b32 v110, -1
    v_mov_b32 v111, -1
    v_lshlrev_b32 v15, 4, v1
FC_CLR:
    buffer_store_dwordx4 v[108:111], v15, s[28:31], s60 offen sc1
    s_add_u32 s60, s60, 237568
    s_cmp_lt_u32 s60, 3977216
    s_cbranch_scc1 FC_CLR
    s_lshl_b32 s64, s56, 7
    s_add_u32 s64, s64, 4736
    v_mov_b32 v104, s52
    v_mov_b32 v105, s52
    v_mov_b32 v106, s52
    v_mov_b32 v107, s52
    s_waitcnt vmcnt(0)
    s_barrier
    s_cmp_lg_u32 s59, 0
    s_cbranch_scc1 FC_NOFL
    s_mov_b64 exec, 0xff
    buffer_store_dwordx4 v[104:107], v15, s[28:31], s64 offen sc1
    s_mov_b64 exec, -1
FC_NOFL:
    s_lshl2_add_u32 s60, s56, s59
    s_cmp_eq_u32 s60, 221
    s_cbranch_scc1 FC_TOP
    s_cmp_lg_u32 s54, 30
    s_cbranch_scc1 FC_NOWR
    s_and_b32 s60, s2, 4
    s_add_u32 s60, s60, s59
    s_lshl_b32 s60, s60, 12
    s_add_u32 s60, s60, 16384
    buffer_load_dwordx4 v[168:171], v15, s[28:31], s60 offen offset:0
    buffer_load_dwordx4 v[168:171], v15, s[28:31], s60 offen offset:1024
    buffer_load_dwordx4 v[168:171], v15, s[28:31], s60 offen offset:2048
    buffer_load_dwordx4 v[168:171], v15, s[28:31], s60 offen offset:3072
FC_NOWR:
    s_barrier
    s_mul_i32 s60, s59, 10
    s_add_u32 s60, s60, 0
    s_and_b32 s61, s60, 7
    s_lshr_b32 s60, s60, 3
    s_lshl_b32 s60, s60, 14
    v_xor_b32 v2, s61, v12
    v_lshl_add_u32 v2, v2, 5, v13
    v_add_u32 v2, s60, v2
    ds_read_b64_tr_b16 v[24:25], v2 offset:0
    ds_read_b64_tr_b16 v[26:27], v2 offset:1024
    ds_read_b64_tr_b16 v[28:29], v2 offset:8192
    ds_read_b64_tr_b16 v[30:31], v2 offset:9216
    s_mul_i32 s60, s59, 10
    s_add_u32 s60, s60, 1
    s_and_b32 s61, s60, 7
    s_lshr_b32 s60, s60, 3
    s_lshl_b32 s60, s60, 14
    v_xor_b32 v2, s61, v12
    v_lshl_add_u32 v2, v2, 5, v13
    v_add_u32 v2, s60, v2
    ds_read_b64_tr_b16 v[32:33], v2 offset:0
    ds_read_b64_tr_b16 v[34:35], v2 offset:1024
    ds_read_b64_tr_b16 v[36:37], v2 offset:8192
    ds_read_b64_tr_b16 v[38:39], v2 offset:9216
    s_mul_i32 s60, s59, 10
    s_add_u32 s60, s60, 2
    s_and_b32 s61, s60, 7
    s_lshr_b32 s60, s60, 3
    s_lshl_b32 s60, s60, 14
    v_xor_b32 v2, s61, v12
    v_lshl_add_u32 v2, v2, 5, v13
    v_add_u32 v2, s60, v2
    ds_read_b64_tr_b16 v[40:41], v2 offset:0
    ds_read_b64_tr_b16 v[42:43], v2 offset:1024
    ds_read_b64_tr_b16 v[44:45], v2 offset:8192
    ds_read_b64_tr_b16 v[46:47], v2 offset:9216
    s_mul_i32 s60, s59, 10
    s_add_u32 s60, s60, 3
    s_and_b32 s61, s60, 7
    s_lshr_b32 s60, s60, 3
    s_lshl_b32 s60, s60, 14
    v_xor_b32 v2, s61, v12
    v_lshl_add_u32 v2, v2, 5, v13
    v_add_u32 v2, s60, v2
    ds_read_b64_tr_b16 v[48:49], v2 offset:0
    ds_read_b64_tr_b16 v[50:51], v2 offset:1024
    ds_read_b64_tr_b16 v[52:53], v2 offset:8192
    ds_read_b64_tr_b16 v[54:55], v2 offset:9216
    s_mul_i32 s60, s59, 10
    s_add_u32 s60, s60, 4
    s_and_b32 s61, s60, 7
    s_lshr_b32 s60, s60, 3
    s_lshl_b32 s60, s60, 14
    v_xor_b32 v2, s61, v12
    v_lshl_add_u32 v2, v2, 5, v13
    v_add_u32 v2, s60, v2
    ds_read_b64_tr_b16 v[56:57], v2 offset:0
    ds_read_b64_tr_b16 v[58:59], v2 offset:1024
    ds_read_b64_tr_b16 v[60:61], v2 offset:8192
    ds_read_b64_tr_b16 v[62:63], v2 offset:9216
    s_mul_i32 s60, s59, 10
    s_add_u32 s60, s60, 5
    s_and_b32 s61, s60, 7
    s_lshr_b32 s60, s60, 3
    s_lshl_b32 s60, s60, 14
    v_xor_b32 v2, s61, v12
    v_lshl_add_u32 v2, v2, 5, v13
    v_add_u32 v2, s60, v2
    ds_read_b64_tr_b16 v[64:65], v2 offset:0
    ds_read_b64_tr_b16 v[66:67], v2 offset:1024
    ds_read_b64_tr_b16 v[68:69], v2 offset:8192
    ds_read_b64_tr_b16 v[70:71], v2 offset:9216
    s_mul_i32 s60, s59, 10
    s_add_u32 s60, s60, 6
    s_and_b32 s61, s60, 7
    s_lshr_b32 s60, s60, 3
    s_lshl_b32 s60, s60, 14
    v_xor_b32 v2, s61, v12
    v_lshl_add_u32 v2, v2, 5, v13
    v_add_u32 v2, s60, v2
    ds_read_b64_tr_b16 v[72:73], v2 offset:0
    ds_read_b64_tr_b16 v[74:75], v2 offset:1024
    ds_read_b64_tr_b16 v[76:77], v2 offset:8192
    ds_read_b64_tr_b16 v[78:79], v2 offset:9216
    s_mul_i32 s60, s59, 10
    s_add_u32 s60, s60, 7
    s_and_b32 s61, s60, 7
    s_lshr_b32 s60, s60, 3
    s_lshl_b32 s60, s60, 14
    v_xor_b32 v2, s61, v12
    v_lshl_add_u32 v2, v2, 5, v13
    v_add_u32 v2, s60, v2
    ds_read_b64_tr_b16 v[80:81], v2 offset:0
    ds_read_b64_tr_b16 v[82:83], v2 offset:1024
    ds_read_b64_tr_b16 v[84:85], v2 offset:8192
    ds_read_b64_tr_b16 v[86:87], v2 offset:9216
    s_mul_i32 s60, s59, 10
    s_add_u32 s60, s60, 8
    s_and_b32 s61, s60, 7
    s_lshr_b32 s60, s60, 3
    s_lshl_b32 s60, s60, 14
    v_xor_b32 v2, s61, v12
    v_lshl_add_u32 v2, v2, 5, v13
    v_add_u32 v2, s60, v2
    ds_read_b64_tr_b16 v[88:89], v2 offset:0
    ds_read_b64_tr_b16 v[90:91], v2 offset:1024
    ds_read_b64_tr_b16 v[92:93], v2 offset:8192
    ds_read_b64_tr_b16 v[94:95], v2 offset:9216
    s_mul_i32 s60, s59, 10
    s_add_u32 s60, s60, 9
    s_and_b32 s61, s60, 7
    s_lshr_b32 s60, s60, 3
    s_lshl_b32 s60, s60, 14
    v_xor_b32 v2, s61, v12
    v_lshl_add_u32 v2, v2, 5, v13
    v_add_u32 v2, s60, v2
    ds_read_b64_tr_b16 v[96:97], v2 offset:0
    ds_read_b64_tr_b16 v[98:99], v2 offset:1024
    ds_read_b64_tr_b16 v[100:101], v2 offset:8192
    ds_read_b64_tr_b16 v[102:103], v2 offset:9216
    v_lshrrev_b32 v14, 1, v5
    v_lshlrev_b32 v14, 7, v14
    v_and_b32 v2, 1, v1
    v_lshl_add_u32 v14, v2, 6, v14
    v_lshl_add_u32 v14, v3, 5, v14
    s_sub_u32 s63, s56, 27
    s_waitcnt lgkmcnt(0)
    s_cmp_ge_u32 s63, 27
    s_cbranch_scc1 K_END
    s_lshl_b32 s65, s63, 9
    s_add_u32 s65, s65, 425984
    s_mov_b32 exec_lo, 0x33333333
    s_mov_b32 exec_hi, 0x33333333
    buffer_load_dwordx4 v[112:115], v14, s[28:31], s65 offen offset:0 sc1
    buffer_load_dwordx4 v[116:119], v14, s[28:31], s65 offen offset:16 sc1
    buffer_load_dwordx4 v[120:123], v14, s[28:31], s65 offen offset:256 sc1
    buffer_load_dwordx4 v[124:127], v14, s[28:31], s65 offen offset:272 sc1
    s_waitcnt vmcnt(0)
D_H_CHK:
    v_xor_b32 v2, s52, v113
    v_bitop3_b32 v2, v115, s52, v2 bitop3:0xbe
    v_bitop3_b32 v2, v117, s52, v2 bitop3:0xbe
    v_bitop3_b32 v2, v119, s52, v2 bitop3:0xbe
    v_bitop3_b32 v2, v121, s52, v2 bitop3:0xbe
    v_bitop3_b32 v2, v123, s52, v2 bitop3:0xbe
    v_bitop3_b32 v2, v125, s52, v2 bitop3:0xbe
    v_bitop3_b32 v2, v127, s52, v2 bitop3:0xbe
    v_cmp_ne_u32 vcc, 0, v2
    s_cbranch_vccz D_H_OK
D_H_RETRY:
    s_add_u32 s100, s100, 1
    s_cmp_gt_u32 s100, 20000
    s_cbranch_scc1 D_H_OK
    s_sleep 6
    buffer_load_dwordx4 v[112:115], v14, s[28:31], s65 offen offset:0 sc1
    buffer_load_dwordx4 v[116:119], v14, s[28:31], s65 offen offset:16 sc1
    buffer_load_dwordx4 v[120:123], v14, s[28:31], s65 offen offset:256 sc1
    buffer_load_dwordx4 v[124:127], v14, s[28:31], s65 offen offset:272 sc1
    s_waitcnt vmcnt(0)
    s_branch D_H_CHK
D_H_OK:
    s_mov_b64 exec, -1
    v_mov_b32 v132, v112
    v_mov_b32 v133, v114
    v_mov_b32 v134, v116
    v_mov_b32 v135, v118
    v_mov_b32 v136, v120
    v_mov_b32 v137, v122
    v_mov_b32 v138, v124
    v_mov_b32 v139, v126
    v_mfma_f32_16x16x32_bf16 v[176:179], v[132:135], v[24:27], 0
    v_mfma_f32_16x16x32_bf16 v[180:183], v[132:135], v[32:35], 0
    v_mfma_f32_16x16x32_bf16 v[184:187], v[132:135], v[40:43], 0
    v_mfma_f32_16x16x32_bf16 v[188:191], v[132:135], v[48:51], 0
    v_mfma_f32_16x16x32_bf16 v[192:195], v[132:135], v[56:59], 0
    v_mfma_f32_16x16x32_bf16 v[196:199], v[132:135], v[64:67], 0
    v_mfma_f32_16x16x32_bf16 v[200:203], v[132:135], v[72:75], 0
    v_mfma_f32_16x16x32_bf16 v[204:207], v[132:135], v[80:83], 0
    v_mfma_f32_16x16x32_bf16 v[208:211], v[132:135], v[88:91], 0
    v_mfma_f32_16x16x32_bf16 v[212:215], v[132:135], v[96:99], 0
    v_mfma_f32_16x16x32_bf16 v[176:179], v[136:139], v[28:31], v[176:179]
    v_mfma_f32_16x16x32_bf16 v[180:183], v[136:139], v[36:39], v[180:183]
    v_mfma_f32_16x16x32_bf16 v[184:187], v[136:139], v[44:47], v[184:187]
    v_mfma_f32_16x16x32_bf16 v[188:191], v[136:139], v[52:55], v[188:191]
    v_mfma_f32_16x16x32_bf16 v[192:195], v[136:139], v[60:63], v[192:195]
    v_mfma_f32_16x16x32_bf16 v[196:199], v[136:139], v[68:71], v[196:199]
    v_mfma_f32_16x16x32_bf16 v[200:203], v[136:139], v[76:79], v[200:203]
    v_mfma_f32_16x16x32_bf16 v[204:207], v[136:139], v[84:87], v[204:207]
    v_mfma_f32_16x16x32_bf16 v[208:211], v[136:139], v[92:95], v[208:211]
    v_mfma_f32_16x16x32_bf16 v[212:215], v[136:139], v[100:103], v[212:215]
    v_lshlrev_b32 v2, 3, v1
    s_mul_i32 s60, s59, 1280
    s_mul_i32 s61, s63, 5120
    s_add_u32 s60, s60, s61
    s_add_u32 s60, s60, 131072
    s_add_u32 s61, s60, 138240
    v_mov_b32 v141, s52
    v_mov_b32 v143, s52
    v_mov_b32 v145, s52
    v_mov_b32 v147, s52
    v_mov_b32 v149, s52
    v_mov_b32 v151, s52
    s_mov_b32 exec_lo, 0xffff
    s_mov_b32 exec_hi, 0
    v_mov_b32 v140, v176
    v_mov_b32 v142, v177
    v_mov_b32 v144, v192
    v_mov_b32 v146, v193
    v_mov_b32 v148, v208
    v_mov_b32 v150, v209
    s_mov_b32 exec_lo, 0xffff0000
    s_mov_b32 exec_hi, 0
    v_mov_b32 v140, v180
    v_mov_b32 v142, v181
    v_mov_b32 v144, v196
    v_mov_b32 v146, v197
    v_mov_b32 v148, v212
    v_mov_b32 v150, v213
    s_mov_b32 exec_lo, 0
    s_mov_b32 exec_hi, 0xffff
    v_mov_b32 v140, v184
    v_mov_b32 v142, v185
    v_mov_b32 v144, v200
    v_mov_b32 v146, v201
    s_mov_b32 exec_lo, 0
    s_mov_b32 exec_hi, 0xffff0000
    v_mov_b32 v140, v188
    v_mov_b32 v142, v189
    v_mov_b32 v144, v204
    v_mov_b32 v146, v205
    s_mov_b64 exec, -1
    buffer_store_dwordx2 v[140:141], v2, s[28:31], s60 offen offset:0 sc1
    buffer_store_dwordx2 v[142:143], v2, s[28:31], s61 offen offset:0 sc1
    buffer_store_dwordx2 v[144:145], v2, s[28:31], s60 offen offset:512 sc1
    buffer_store_dwordx2 v[146:147], v2, s[28:31], s61 offen offset:512 sc1
    s_mov_b32 exec_hi, 0
    buffer_store_dwordx2 v[148:149], v2, s[28:31], s60 offen offset:1024 sc1
    buffer_store_dwordx2 v[150:151], v2, s[28:31], s61 offen offset:1024 sc1
    s_mov_b64 exec, -1
    s_branch K_END
FC_TOP:
    v_lshlrev_b32 v12, 4, v1
    s_mov_b32 s62, 0
    s_add_u32 s60, s62, 49152
    buffer_load_dwordx4 v[88:91], v12, s[28:31], s60 offen offset:0 sc1
    buffer_load_dwordx4 v[92:95], v12, s[28:31], s60 offen offset:1024 sc1
    buffer_load_dwordx4 v[96:99], v12, s[28:31], s60 offen offset:2048 sc1
    buffer_load_dwordx4 v[100:103], v12, s[28:31], s60 offen offset:3072 sc1
    s_add_u32 s60, s62, 53248
    buffer_load_dwordx4 v[104:107], v12, s[28:31], s60 offen offset:0 sc1
    buffer_load_dwordx4 v[108:111], v12, s[28:31], s60 offen offset:1024 sc1
    buffer_load_dwordx4 v[112:115], v12, s[28:31], s60 offen offset:2048 sc1
    buffer_load_dwordx4 v[116:119], v12, s[28:31], s60 offen offset:3072 sc1
    s_add_u32 s60, s62, 57344
    buffer_load_dwordx4 v[120:123], v12, s[28:31], s60 offen offset:0 sc1
    buffer_load_dwordx4 v[124:127], v12, s[28:31], s60 offen offset:1024 sc1
    buffer_load_dwordx4 v[128:131], v12, s[28:31], s60 offen offset:2048 sc1
    buffer_load_dwordx4 v[132:135], v12, s[28:31], s60 offen offset:3072 sc1
    s_add_u32 s60, s62, 61440
    buffer_load_dwordx4 v[136:139], v12, s[28:31], s60 offen offset:0 sc1
    buffer_load_dwordx4 v[140:143], v12, s[28:31], s60 offen offset:1024 sc1
    buffer_load_dwordx4 v[144:147], v12, s[28:31], s60 offen offset:2048 sc1
    buffer_load_dwordx4 v[148:151], v12, s[28:31], s60 offen offset:3072 sc1
    s_waitcnt vmcnt(0)
T_KY_CHK:
    v_xor_b32 v2, s52, v89
    v_bitop3_b32 v2, v91, s52, v2 bitop3:0xbe
    v_bitop3_b32 v2, v93, s52, v2 bitop3:0xbe
    v_bitop3_b32 v2, v95, s52, v2 bitop3:0xbe
    v_bitop3_b32 v2, v97, s52, v2 bitop3:0xbe
    v_bitop3_b32 v2, v99, s52, v2 bitop3:0xbe
    v_bitop3_b32 v2, v101, s52, v2 bitop3:0xbe
    v_bitop3_b32 v2, v103, s52, v2 bitop3:0xbe
    v_bitop3_b32 v2, v105, s52, v2 bitop3:0xbe
    v_bitop3_b32 v2, v107, s52, v2 bitop3:0xbe
    v_bitop3_b32 v2, v109, s52, v2 bitop3:0xbe
    v_bitop3_b32 v2, v111, s52, v2 bitop3:0xbe
    v_bitop3_b32 v2, v113, s52, v2 bitop3:0xbe
    v_bitop3_b32 v2, v115, s52, v2 bitop3:0xbe
    v_bitop3_b32 v2, v117, s52, v2 bitop3:0xbe
    v_bitop3_b32 v2, v119, s52, v2 bitop3:0xbe
    v_bitop3_b32 v2, v121, s52, v2 bitop3:0xbe
    v_bitop3_b32 v2, v123, s52, v2 bitop3:0xbe
    v_bitop3_b32 v2, v125, s52, v2 bitop3:0xbe
    v_bitop3_b32 v2, v127, s52, v2 bitop3:0xbe
    v_bitop3_b32 v2, v129, s52, v2 bitop3:0xbe
    v_bitop3_b32 v2, v131, s52, v2 bitop3:0xbe
    v_bitop3_b32 v2, v133, s52, v2 bitop3:0xbe
    v_bitop3_b32 v2, v135, s52, v2 bitop3:0xbe
    v_bitop3_b32 v2, v137, s52, v2 bitop3:0xbe
    v_bitop3_b32 v2, v139, s52, v2 bitop3:0xbe
    v_bitop3_b32 v2, v141, s52, v2 bitop3:0xbe
    v_bitop3_b32 v2, v143, s52, v2 bitop3:0xbe
    v_bitop3_b32 v2, v145, s52, v2 bitop3:0xbe
    v_bitop3_b32 v2, v147, s52, v2 bitop3:0xbe
    v_bitop3_b32 v2, v149, s52, v2 bitop3:0xbe
    v_bitop3_b32 v2, v151, s52, v2 bitop3:0xbe
    v_cmp_ne_u32 vcc, 0, v2
    s_cbranch_vccz T_KY_OK
T_KY_RETRY:
    s_add_u32 s100, s100, 1
    s_cmp_gt_u32 s100, 20000
    s_cbranch_scc1 T_KY_OK
    s_sleep 16
    s_add_u32 s60, s62, 49152
    buffer_load_dwordx4 v[88:91], v12, s[28:31], s60 offen offset:0 sc1
    buffer_load_dwordx4 v[92:95], v12, s[28:31], s60 offen offset:1024 sc1
    buffer_load_dwordx4 v[96:99], v12, s[28:31], s60 offen offset:2048 sc1
    buffer_load_dwordx4 v[100:103], v12, s[28:31], s60 offen offset:3072 sc1
    s_add_u32 s60, s62, 53248
    buffer_load_dwordx4 v[104:107], v12, s[28:31], s60 offen offset:0 sc1
    buffer_load_dwordx4 v[108:111], v12, s[28:31], s60 offen offset:1024 sc1
    buffer_load_dwordx4 v[112:115], v12, s[28:31], s60 offen offset:2048 sc1
    buffer_load_dwordx4 v[116:119], v12, s[28:31], s60 offen offset:3072 sc1
    s_add_u32 s60, s62, 57344
    buffer_load_dwordx4 v[120:123], v12, s[28:31], s60 offen offset:0 sc1
    buffer_load_dwordx4 v[124:127], v12, s[28:31], s60 offen offset:1024 sc1
    buffer_load_dwordx4 v[128:131], v12, s[28:31], s60 offen offset:2048 sc1
    buffer_load_dwordx4 v[132:135], v12, s[28:31], s60 offen offset:3072 sc1
    s_add_u32 s60, s62, 61440
    buffer_load_dwordx4 v[136:139], v12, s[28:31], s60 offen offset:0 sc1
    buffer_load_dwordx4 v[140:143], v12, s[28:31], s60 offen offset:1024 sc1
    buffer_load_dwordx4 v[144:147], v12, s[28:31], s60 offen offset:2048 sc1
    buffer_load_dwordx4 v[148:151], v12, s[28:31], s60 offen offset:3072 sc1
    s_waitcnt vmcnt(0)
    s_branch T_KY_CHK
T_KY_OK:
    v_max_u32 v20, v88, v90
    v_min_u32 v21, v88, v90
    v_med3_u32 v21, v20, v21, v92
    v_max_u32 v20, v20, v92
    v_med3_u32 v21, v20, v21, v94
    v_max_u32 v20, v20, v94
    v_med3_u32 v21, v20, v21, v96
    v_max_u32 v20, v20, v96
    v_med3_u32 v21, v20, v21, v98
    v_max_u32 v20, v20, v98
    v_med3_u32 v21, v20, v21, v100
    v_max_u32 v20, v20, v100
    v_med3_u32 v21, v20, v21, v102
    v_max_u32 v20, v20, v102
    v_med3_u32 v21, v20, v21, v104
    v_max_u32 v20, v20, v104
    v_med3_u32 v21, v20, v21, v106
    v_max_u32 v20, v20, v106
    v_med3_u32 v21, v20, v21, v108
    v_max_u32 v20, v20, v108
    v_med3_u32 v21, v20, v21, v110
    v_max_u32 v20, v20, v110
    v_med3_u32 v21, v20, v21, v112
    v_max_u32 v20, v20, v112
    v_med3_u32 v21, v20, v21, v114
    v_max_u32 v20, v20, v114
    v_med3_u32 v21, v20, v21, v116
    v_max_u32 v20, v20, v116
    v_med3_u32 v21, v20, v21, v118
    v_max_u32 v20, v20, v118
    v_med3_u32 v21, v20, v21, v120
    v_max_u32 v20, v20, v120
    v_med3_u32 v21, v20, v21, v122
    v_max_u32 v20, v20, v122
    v_med3_u32 v21, v20, v21, v124
    v_max_u32 v20, v20, v124
    v_med3_u32 v21, v20, v21, v126
    v_max_u32 v20, v20, v126
    v_med3_u32 v21, v20, v21, v128
    v_max_u32 v20, v20, v128
    v_med3_u32 v21, v20, v21, v130
    v_max_u32 v20, v20, v130
    v_med3_u32 v21, v20, v21, v132
    v_max_u32 v20, v20, v132
    v_med3_u32 v21, v20, v21, v134
    v_max_u32 v20, v20, v134
    v_med3_u32 v21, v20, v21, v136
    v_max_u32 v20, v20, v136
    v_med3_u32 v21, v20, v21, v138
    v_max_u32 v20, v20, v138
    v_med3_u32 v21, v20, v21, v140
    v_max_u32 v20, v20, v140
    v_med3_u32 v21, v20, v21, v142
    v_max_u32 v20, v20, v142
    v_med3_u32 v21, v20, v21, v144
    v_max_u32 v20, v20, v144
    v_med3_u32 v21, v20, v21, v146
    v_max_u32 v20, v20, v146
    v_med3_u32 v21, v20, v21, v148
    v_max_u32 v20, v20, v148
    v_med3_u32 v21, v20, v21, v150
    v_max_u32 v20, v20, v150
    s_nop 1
    v_mov_b32_dpp v22, v20 row_ror:8 row_mask:0xf bank_mask:0xf
    v_mov_b32_dpp v23, v21 row_ror:8 row_mask:0xf bank_mask:0xf
    v_min_u32 v2, v20, v22
    v_max_u32 v20, v20, v22
    v_max3_u32 v21, v21, v23, v2
    s_nop 0
    v_mov_b32_dpp v22, v20 row_ror:4 row_mask:0xf bank_mask:0xf
    v_mov_b32_dpp v23, v21 row_ror:4 row_mask:0xf bank_mask:0xf
    v_min_u32 v2, v20, v22
    v_max_u32 v20, v20, v22
    v_max3_u32 v21, v21, v23, v2
    s_nop 0
    v_mov_b32_dpp v22, v20 row_ror:2 row_mask:0xf bank_mask:0xf
    v_mov_b32_dpp v23, v21 row_ror:2 row_mask:0xf bank_mask:0xf
    v_min_u32 v2, v20, v22
    v_max_u32 v20, v20, v22
    v_max3_u32 v21, v21, v23, v2
    s_nop 0
    v_mov_b32_dpp v22, v20 row_ror:1 row_mask:0xf bank_mask:0xf
    v_mov_b32_dpp v23, v21 row_ror:1 row_mask:0xf bank_mask:0xf
    v_min_u32 v2, v20, v22
    v_max_u32 v20, v20, v22
    v_max3_u32 v21, v21, v23, v2
    v_mov_b32 v22, v20
    v_mov_b32 v23, v21
    s_nop 0
    v_permlane16_swap_b32 v20, v22
    v_permlane16_swap_b32 v21, v23
    v_min_u32 v2, v20, v22
    v_max_u32 v20, v20, v22
    v_max3_u32 v21, v21, v23, v2
    v_mov_b32 v22, v20
    v_mov_b32 v23, v21
    s_nop 0
    v_permlane32_swap_b32 v20, v22
    v_permlane32_swap_b32 v21, v23
    v_min_u32 v2, v20, v22
    v_max_u32 v20, v20, v22
    v_max3_u32 v21, v21, v23, v2
    s_mov_b64 exec, 0x1fffffff
    v_lshlrev_b32 v11, 7, v1
    s_movk_i32 s63, 8192
    buffer_load_dword v16, v11, s[28:31], s63 offen sc1
    v_mov_b32 v104, v20
    v_mov_b32 v106, v21
    s_waitcnt vmcnt(0)
T_FL_CHK:
    v_xor_b32 v2, s52, v16
    v_cmp_ne_u32 vcc, 0, v2
    s_cbranch_vccz T_FL_OK
T_FL_RETRY:
    s_add_u32 s100, s100, 1
    s_cmp_gt_u32 s100, 20000
    s_cbranch_scc1 T_FL_OK
    s_sleep 8
    s_movk_i32 s63, 8192
    buffer_load_dword v16, v11, s[28:31], s63 offen sc1
    s_waitcnt vmcnt(0)
    s_branch T_FL_CHK
T_FL_OK:
    s_mov_b64 exec, 0xff
    buffer_store_dwordx4 v[104:107], v15, s[28:31], 0 offen offset:256 sc1
    s_mov_b64 exec, 1
    buffer_store_dword v105, v15, s[28:31], 0 offen offset:0 sc1
    s_mov_b64 exec, -1
    s_branch K_END
K_END:
K_EXIT:
    s_endpgm
    .p2align 6
    .type K_TAB,@object
K_TAB:
    .long 0x18100800, 0x80808020, 0x18100800, 0x20, 0x0, 0x1400, 0x1e00, 0x0
    .long 0x0, 0x2, 0xff00ff00, 0xffffffff, 0xffffffff, 0xffffffff, 0xffffff00, 0xffffffff
    .long 0x18100800, 0x80808080, 0x18100800, 0x18, 0x6, 0x2000, 0x7ff00000, 0x1c00
    .long 0x0, 0x1, 0xff00ff00, 0xffffffff, 0xffffffff, 0xffffffff, 0xffffff00, 0xffffffff
    .long 0x80100800, 0x80808080, 0x8080000, 0x10, 0x6, 0x2500, 0x1d08, 0x5400
    .long 0x3800, 0x1, 0xff00, 0xffff, 0xffff, 0xffff, 0xffffff00, 0xffffffff
    .long 0x80800800, 0x80808080, 0x8080000, 0x8, 0x6, 0x2700, 0x7ff00000, 0x8c00
    .long 0x7000, 0x1, 0xff00, 0xffff, 0xffff, 0xffff, 0xffffff00, 0xffffffff
    .long 0x80808000, 0x80808080, 0x8080000, 0x0, 0x6, 0x7ff00000, 0x1f08, 0xc400
    .long 0xa800, 0x1, 0xff00, 0xffff, 0xffff, 0xffff, 0xffffff00, 0xffffffff
    .long 0x40383028, 0x80808048, 0x40383028, 0x48, 0x2, 0x0, 0x1800, 0x0
    .long 0x0, 0x0, 0xff00ff00, 0xffffffff, 0xffffffff, 0xffffffff, 0xffffff00, 0xffffffff
    .long 0x38302820, 0x80808040, 0x38302820, 0x40, 0x0, 0x400, 0x1a00, 0x0
    .long 0x0, 0x0, 0xff00ff00, 0xffffffff, 0xffffffff, 0xffffffff, 0xffffff00, 0xffffffff
    .long 0x30282018, 0x80808038, 0x30282018, 0x38, 0x0, 0x800, 0x1808, 0x0
    .long 0x0, 0x0, 0xff00ff00, 0xffffffff, 0xffffffff, 0xffffffff, 0xffffff00, 0xffffffff
    .long 0x28201810, 0x80808030, 0x28201810, 0x30, 0x0, 0xc00, 0x1a08, 0x0
    .long 0x0, 0x0, 0xff00ff00, 0xffffffff, 0xffffffff, 0xffffffff, 0xffffff00, 0xffffffff
    .long 0x20181008, 0x80808028, 0x20181008, 0x28, 0x0, 0x1000, 0x1c00, 0x0
    .long 0x0, 0x0, 0xff00ff00, 0xffffffff, 0xffffffff, 0xffffffff, 0xffffff00, 0xffffffff
    .long 0x68605850, 0x80808070, 0x68605850, 0x70, 0x4, 0x200, 0x1900, 0x0
    .long 0x0, 0x0, 0xff00ff00, 0xffffffff, 0xffffffff, 0xffffffff, 0xffffff00, 0xffffffff
    .long 0x60585048, 0x80808068, 0x60585048, 0x68, 0x2, 0x600, 0x1b00, 0x0
    .long 0x0, 0x0, 0xff00ff00, 0xffffffff, 0xffffffff, 0xffffffff, 0xffffff00, 0xffffffff
    .long 0x58504840, 0x80808060, 0x58504840, 0x60, 0x2, 0xa00, 0x1908, 0x0
    .long 0x0, 0x0, 0xff00ff00, 0xffffffff, 0xffffffff, 0xffffffff, 0xffffff00, 0xffffffff
    .long 0x50484038, 0x80808058, 0x50484038, 0x58, 0x2, 0xe00, 0x1b08, 0x0
    .long 0x0, 0x0, 0xff00ff00, 0xffffffff, 0xffffffff, 0xffffffff, 0xffffff00, 0xffffffff
    .long 0x48403830, 0x80808050, 0x48403830, 0x50, 0x2, 0x1200, 0x1d00, 0x0
    .long 0x0, 0x0, 0xff00ff00, 0xffffffff, 0xffffffff, 0xffffffff, 0xffffff00, 0xffffffff
    .long 0x80808078, 0x80808080, 0x80807878, 0x78, 0x6, 0x7ff00000, 0x1c08, 0x0
    .long 0x1c00, 0x1, 0xff00, 0xffff, 0xffff, 0xffff, 0xffffff00, 0xffffffff
    .long 0x80807870, 0x80808080, 0x78787070, 0x78, 0x4, 0x2400, 0x7ff00000, 0x3800
    .long 0x5400, 0x1, 0xff00, 0xffff, 0xffff, 0xffff, 0xffffff00, 0xffffffff
    .long 0x80787068, 0x80808080, 0x70706868, 0x78, 0x4, 0x2600, 0x1e08, 0x7000
    .long 0x8c00, 0x1, 0xff00, 0xffff, 0xffff, 0xffff, 0xffffff00, 0xffffffff
    .long 0x78706860, 0x80808080, 0x78706860, 0x78, 0x4, 0x2200, 0x7ff00000, 0xa800
    .long 0xc400, 0x1, 0xff00ff00, 0xffffffff, 0xffffffff, 0xffffffff, 0xffffff00, 0xffffffff
    .long 0x70686058, 0x80808078, 0x70686058, 0x78, 0x4, 0x1600, 0x1f00, 0x0
    .long 0x0, 0x2, 0xff00ff00, 0xffffffff, 0xffffffff, 0xffffffff, 0xffffff00, 0xffffffff
    .long 0x40383028, 0x80808048, 0x40383028, 0x48, 0x0, 0x14000, 0x15800, 0x0
    .long 0x0, 0x0, 0xffffffff, 0xffffffff, 0xffffffff, 0x0, 0xffffffff, 0xffff
    .long 0x38302820, 0x80808040, 0x38302820, 0x40, 0x6, 0x14400, 0x15a00, 0x0
    .long 0x0, 0x0, 0xffffffff, 0xffffffff, 0xffffffff, 0x0, 0xffffffff, 0xffff
    .long 0x30282018, 0x80808038, 0x30282018, 0x38, 0x6, 0x14800, 0x15808, 0x0
    .long 0x0, 0x0, 0xffffffff, 0xffffffff, 0xffffffff, 0x0, 0xffffffff, 0xffff
    .long 0x28201810, 0x80808030, 0x28201810, 0x30, 0x6, 0x14c00, 0x15a08, 0x0
    .long 0x0, 0x0, 0xffffffff, 0xffffffff, 0xffffffff, 0x0, 0xffffffff, 0xffff
    .long 0x20181008, 0x80808028, 0x20181008, 0x28, 0x6, 0x15000, 0x15c00, 0x0
    .long 0x0, 0x0, 0xffffffff, 0xffffffff, 0xffffffff, 0x0, 0xffffffff, 0xffff
    .long 0x18100800, 0x80808020, 0x18100800, 0x20, 0x2, 0x15400, 0x15e00, 0x0
    .long 0x0, 0x2, 0xffffffff, 0xffffffff, 0xffffffff, 0x0, 0xffffffff, 0xffff
    .long 0x18100800, 0x80808080, 0x18100800, 0x18, 0x0, 0x16000, 0x7ff00000, 0x2c00
    .long 0x1000, 0x1, 0xffffffff, 0xffffffff, 0xffffffff, 0x0, 0xffffffff, 0xffff
    .long 0x80100800, 0x80808080, 0x8080000, 0x10, 0x0, 0x16500, 0x15d08, 0x6400
    .long 0x4800, 0x1, 0xffff, 0xffff, 0xffff, 0x0, 0xffffffff, 0xffff
    .long 0x80800800, 0x80808080, 0x8080000, 0x8, 0x0, 0x16700, 0x7ff00000, 0x9c00
    .long 0x8000, 0x1, 0xffff, 0xffff, 0xffff, 0x0, 0xffffffff, 0xffff
    .long 0x80808000, 0x80808080, 0x8080000, 0x0, 0x0, 0x7ff00000, 0x15f08, 0xd400
    .long 0xb800, 0x1, 0xffff, 0xffff, 0xffff, 0x0, 0xffffffff, 0xffff
    .long 0x80808078, 0x80808080, 0x80807878, 0x78, 0x4, 0x7ff00000, 0x15c08, 0x1000
    .long 0x2c00, 0x1, 0xffff, 0xffff, 0xffff, 0x0, 0xffffffff, 0xffff
    .long 0x80807870, 0x80808080, 0x78787070, 0x78, 0x2, 0x16400, 0x7ff00000, 0x4800
    .long 0x6400, 0x1, 0xffff, 0xffff, 0xffff, 0x0, 0xffffffff, 0xffff
    .long 0x80787068, 0x80808080, 0x70706868, 0x78, 0x2, 0x16600, 0x15e08, 0x8000
    .long 0x9c00, 0x1, 0xffff, 0xffff, 0xffff, 0x0, 0xffffffff, 0xffff
    .long 0x78706860, 0x80808080, 0x78706860, 0x78, 0x2, 0x16200, 0x7ff00000, 0xb800
    .long 0xd400, 0x1, 0xffffffff, 0xffffffff, 0xffffffff, 0x0, 0xffffffff, 0xffff
    .long 0x70686058, 0x80808078, 0x70686058, 0x78, 0x2, 0x15600, 0x15f00, 0x0
    .long 0x0, 0x2, 0xffffffff, 0xffffffff, 0xffffffff, 0x0, 0xffffffff, 0xffff
    .long 0x68605850, 0x80808070, 0x68605850, 0x70, 0x6, 0x14200, 0x15900, 0x0
    .long 0x0, 0x0, 0xffffffff, 0xffffffff, 0xffffffff, 0x0, 0xffffffff, 0xffff
    .long 0x60585048, 0x80808068, 0x60585048, 0x68, 0x4, 0x14600, 0x15b00, 0x0
    .long 0x0, 0x0, 0xffffffff, 0xffffffff, 0xffffffff, 0x0, 0xffffffff, 0xffff
    .long 0x58504840, 0x80808060, 0x58504840, 0x60, 0x4, 0x14a00, 0x15908, 0x0
    .long 0x0, 0x0, 0xffffffff, 0xffffffff, 0xffffffff, 0x0, 0xffffffff, 0xffff
    .long 0x50484038, 0x80808058, 0x50484038, 0x58, 0x4, 0x14e00, 0x15b08, 0x0
    .long 0x0, 0x0, 0xffffffff, 0xffffffff, 0xffffffff, 0x0, 0xffffffff, 0xffff
    .long 0x48403830, 0x80808050, 0x48403830, 0x50, 0x4, 0x15200, 0x15d00, 0x0
    .long 0x0, 0x0, 0xffffffff, 0xffffffff, 0xffffffff, 0x0, 0xffffffff, 0xffff
    .fill (40960 - (. - recurrent_scan__sliding_local_dilated__moe_arch_mod__prompt_kernel)) / 4, 4, 0xbf810000
.section .rodata,"a"
.p2align 6
.amdhsa_kernel recurrent_scan__sliding_local_dilated__moe_arch_mod__prompt_kernel
  .amdhsa_next_free_vgpr 256
  .amdhsa_next_free_sgpr 102
  .amdhsa_accum_offset 256
  .amdhsa_group_segment_fixed_size 0
  .amdhsa_kernarg_size 88
  .amdhsa_user_sgpr_count 2
  .amdhsa_user_sgpr_kernarg_segment_ptr 1
  .amdhsa_system_sgpr_workgroup_id_x 1
.end_amdhsa_kernel
```

```asm
; @launch grid=(256,1,1) block=(512,1,1) lds=163840
.amdgcn_target "amdgcn-amd-amdhsa--gfx950"
.text
.globl recurrent_scan__sliding_local_dilated__moe_arch_mod__prompt_kernel
.p2align 8
.type recurrent_scan__sliding_local_dilated__moe_arch_mod__prompt_kernel,@function
recurrent_scan__sliding_local_dilated__moe_arch_mod__prompt_kernel:
    s_load_dwordx2 s[24:25], s[0:1], 0
    s_load_dwordx2 s[32:33], s[0:1], 8
    s_load_dwordx2 s[28:29], s[0:1], 80
    s_cmpk_ge_u32 s2, 256
    s_cbranch_scc1 K_EXIT
    v_readfirstlane_b32 s3, v0
    s_getpc_b64 s[20:21]
K_PC:
    s_lshr_b32 s54, s2, 3
    s_lshl_b32 s60, s54, 10
    v_lshl_add_u32 v2, v0, 1, s60
    global_load_ushort v255, v2, s[20:21]
    s_mul_i32 s60, s54, 52
    s_lshr_b32 s60, s60, 8
    s_mul_i32 s53, s60, 5
    s_sub_u32 s53, s54, s53
    s_add_u32 s67, s60, s53
    s_bitcmp1_b32 s2, 1
    s_cselect_b32 s61, 5, 0
    s_add_u32 s56, s60, s61
    s_mulk_i32 s56, 104
    s_sub_u32 s56, s56, 8
    s_and_b32 s57, s2, 4
    s_mulk_i32 s57, 320
    s_bitcmp1_b32 s2, 0
    s_cselect_b32 s61, 5, 0
    s_add_u32 s58, s53, s61
    s_lshl_b32 s58, s58, 7
    s_mov_b32 s26, 2621440
    s_mov_b32 s27, 0x20000
    s_lshr_b32 s60, s3, 3
    s_max_u32 s60, s60, s54
    s_cmp_ge_u32 s60, 25
    s_cbranch_scc1 K_NL
    v_lshrrev_b32 v2, 3, v0
    v_add_u32 v3, s56, v2
    v_mul_i32_i24 v3, 2560, v3
    v_bitop3_b32 v1, v0, v2, 7 bitop3:0x28
    v_lshl_add_u32 v196, v1, 4, v3
    v_and_b32 v3, 2, v2
    v_lshrrev_b32 v1, 1, v2
    v_and_or_b32 v3, v1, 4, v3
    v_bitop3_b32 v3, v0, v3, 7 bitop3:0x28
    v_mul_u32_u24 v200, 3840, v2
    v_lshl_add_u32 v200, v3, 4, v200
    s_cmp_ge_u32 s67, 5
    s_cselect_b32 s61, 5, 0
    s_sub_u32 s67, s67, s61
    s_lshl_b32 s67, s67, 2
    s_and_b32 s68, s2, 6
    s_mul_i32 s68, s68, 5
    s_lshr_b32 s68, s68, 2
    s_lshl_b32 s69, s3, 4
    s_mov_b32 s34, 2457600
    s_mov_b32 s35, s27
    s_cmp_eq_u32 s3, 0
    s_cselect_b32 s70, 0xffffff00, -1
    s_cmpk_lt_u32 s69, 2048
    s_cselect_b64 vcc, -1, 0
    s_lshr_b32 s64, 66064, s67
    s_and_b32 s64, s64, 15
    s_add_u32 s64, s64, s68
    s_cmp_ge_u32 s64, 10
    s_cselect_b32 s65, 10, 0
    s_sub_u32 s64, s64, s65
    s_mul_i32 s65, s64, 245760
    s_lshl_b32 s64, s64, 7
    s_add_u32 s64, s64, s57
    s_add_u32 m0, s69, 77824
    s_mov_b32 exec_lo, s70
    s_waitcnt lgkmcnt(0)
    buffer_load_dwordx4 v196, s[24:27], s64 offen lds
    s_add_u32 m0, s69, 81920
    s_mov_b32 exec_lo, -1
    v_add_u32 v197, 81920, v196
    buffer_load_dwordx4 v197, s[24:27], s64 offen lds
    s_add_u32 m0, s69, 86016
    s_add_u32 s65, s65, s58
    v_add_u32 v198, 163840, v196
    buffer_load_dwordx4 v198, s[24:27], s64 offen lds
    v_add_u32 v199, 245760, v196
    s_cbranch_vccz L_SK0
    s_add_u32 m0, s69, 90112
    s_nop 0
    buffer_load_dwordx4 v199, s[24:27], s64 offen lds
L_SK0:
    s_add_u32 m0, s69, 92160
    s_add_u32 s66, s65, 122880
    buffer_load_dwordx4 v200, s[32:35], s65 offen offset:0 lds
    s_add_u32 m0, s69, 99072
    s_nop 0
    buffer_load_dwordx4 v200, s[32:35], s65 offen offset:1280 lds
    s_add_u32 m0, s69, 105984
    s_nop 0
    buffer_load_dwordx4 v200, s[32:35], s65 offen offset:2560 lds
    s_add_u32 m0, s69, 96256
    s_nop 0
    buffer_load_dwordx4 v200, s[32:35], s66 offen offset:0 lds
    s_add_u32 m0, s69, 103168
    s_nop 0
    buffer_load_dwordx4 v200, s[32:35], s66 offen offset:1280 lds
    s_add_u32 m0, s69, 110080
    s_nop 0
    buffer_load_dwordx4 v200, s[32:35], s66 offen offset:2560 lds
    s_branch L_CONT
K_NL:
    s_cmpk_ge_u32 s3, 256
    s_cbranch_scc1 K_ER
    s_sub_u32 s56, s2, 200
    s_mov_b32 s101, 1
    s_cmp_ge_u32 s56, 27
    s_cbranch_scc1 K_AUX
    s_load_dwordx2 s[48:49], s[0:1], 40
    s_load_dwordx2 s[36:37], s[0:1], 48
    v_lshrrev_b32 v2, 3, v0
    v_and_b32 v3, 2, v2
    v_lshrrev_b32 v1, 1, v2
    v_and_or_b32 v3, v1, 4, v3
    v_bitop3_b32 v3, v0, v3, 7 bitop3:0x28
    v_mul_u32_u24 v30, 3456, v2
    v_lshl_add_u32 v30, v3, 4, v30
    s_lshl_b32 s68, s56, 7
    s_lshl_b32 s69, s3, 4
    s_mov_b32 s70, 12
    s_mov_b32 s50, 2211840
    s_mov_b32 s51, 0x20000
    s_mov_b32 s38, 2211840
    s_mov_b32 s39, 0x20000
    s_waitcnt lgkmcnt(0)
FL_GU1:
    s_mov_b32 m0, s69
    s_sub_u32 s70, s70, 1
    buffer_load_dwordx4 v30, s[48:51], s68 offen nt lds
    s_add_u32 m0, s69, 16384
    s_add_u32 s69, s69, 4096
    buffer_load_dwordx4 v30, s[36:39], s68 offen nt lds
    s_add_u32 s68, s68, 110592
    s_and_b32 s60, s70, 3
    s_cselect_b32 s60, 0, 16384
    s_add_u32 s69, s69, s60
    s_cmp_lg_u32 s70, 0
    s_cbranch_scc1 FL_GU1
    s_mov_b32 s101, 5
    s_branch K_AUX
K_ER:
    s_setprio 3
    s_load_dwordx2 s[22:23], s[0:1], 32
    v_bfe_u32 v232, v0, 5, 3
    v_and_b32 v4, 31, v0
    v_mul_u32_u24 v7, 2560, v232
    v_lshlrev_b32 v5, 4, v4
    v_lshlrev_b32 v6, 3, v4
    v_add_u32 v8, v7, v6
    v_add_u32 v7, v7, v5
    s_and_b32 s68, s2, 3
    s_lshl_b32 s68, s68, 5
    s_add_u32 s68, s68, s54
    s_mul_i32 s69, s68, 20480
    s_add_u32 s69, s69, s57
    s_waitcnt lgkmcnt(0)
    buffer_load_dwordx4 v[212:215], v7, s[24:27], s69 offen
    buffer_load_dwordx4 v[216:219], v7, s[24:27], s69 offen offset:512
    buffer_load_dwordx2 v[220:221], v8, s[24:27], s69 offen offset:1024
    global_load_dwordx4 v[222:225], v5, s[22:23]
    global_load_dwordx4 v[226:229], v5, s[22:23] offset:512
    global_load_dwordx2 v[230:231], v6, s[22:23] offset:1024
    s_load_dword s52, s[28:29], 0
    s_mov_b32 s30, 7077888
    s_mov_b32 s31, 0x20000
    s_and_b32 s70, s2, 4
    s_lshl_b32 s70, s70, 5
    s_add_u32 s70, s70, s68
    s_lshl_b32 s71, s70, 6
    s_lshl_b32 s70, s70, 7
    s_add_u32 s70, s70, 16384
    s_add_u32 s71, s71, 49152
    s_setprio 0
    s_mov_b32 s101, 1
    s_cmp_ge_u32 s54, 25
    s_cbranch_scc1 K_AUX0
    s_mul_i32 s60, s3, 5
    s_lshl_b32 s61, s53, 6
    s_add_u32 s60, s60, s61
    s_add_u32 s60, s60, K_TAB-K_PC
    s_load_dwordx16 s[4:19], s[20:21], s60
    s_load_dwordx2 s[44:45], s[0:1], 64
    s_load_dwordx2 s[40:41], s[0:1], 16
    s_mov_b32 s46, 2621440
    s_mov_b32 s47, 0x20000
    s_mov_b32 s30, 7077888
    s_mov_b32 s31, 0x20000
    s_mov_b32 s42, 819200
    s_mov_b32 s43, 0x20000
    s_lshr_b32 s3, s3, 6
    s_and_b32 s59, s3, 3
    s_mov_b32 s55, 0xffff0000
    s_mov_b32 s100, 0
    v_and_b32 v1, 63, v0
    v_and_b32 v4, 15, v1
    v_lshrrev_b32 v5, 4, v1
    v_mov_b32 v19, 163584
    v_add_u32 v18, s3, v19
    v_mov_b32 v2, 0
    v_mov_b32 v3, 0
    v_mov_b32 v46, 0x00010100
    v_mov_b32 v47, 0x01000001
    ds_write2_b64 v19, v[2:3], v[46:47] offset1:1
    v_mov_b32 v45, 0x01010101
    ds_write2_b32 v19, v2, v45 offset0:4 offset1:5
    v_bfe_u32 v46, v0, 1, 7
    v_min_u32 v46, 111, v46
    v_mul_u32_u24 v46, 272, v46
    v_add_u32 v46, 116992, v46
    ds_write_b64 v46, v[2:3]
    s_min_u32 s60, s59, 2
    s_mul_i32 s60, s60, 38912
    v_and_b32 v46, 31, v0
    v_lshl_add_u32 v46, v46, 2, s60
    v_mov_b32 v47, 0x3f803f80
    ds_write_b32 v46, v47
    v_lshlrev_b32 v6, 4, v1
    v_mov_b32 v28, 0x3f803f80
    v_mov_b32 v29, 0x3f803f80
    v_mov_b32 v30, 0x3f803f80
    v_mov_b32 v31, 0x3f803f80
    v_lshlrev_b32 v2, 2, v5
    v_sub_u32 v3, v4, v2
    v_add_u32 v3, 12, v3
    s_mov_b32 s60, 267390975
    v_bfe_i32 v32, s60, v3, 1
    v_and_b32 v32, 0xff800000, v32
    s_mov_b32 s60, 268435440
    v_bfe_i32 v36, s60, v3, 1
    v_and_b32 v36, 0xff800000, v36
    s_mov_b32 s60, 266346495
    v_bfe_i32 v33, s60, v3, 1
    v_and_b32 v33, 0xff800000, v33
    s_mov_b32 s60, 268435424
    v_bfe_i32 v37, s60, v3, 1
    v_and_b32 v37, 0xff800000, v37
    s_mov_b32 s60, 264257535
    v_bfe_i32 v34, s60, v3, 1
    v_and_b32 v34, 0xff800000, v34
    s_mov_b32 s60, 268435392
    v_bfe_i32 v38, s60, v3, 1
    v_and_b32 v38, 0xff800000, v38
    s_mov_b32 s60, 260079615
    v_bfe_i32 v35, s60, v3, 1
    v_and_b32 v35, 0xff800000, v35
    s_mov_b32 s60, 268435328
    v_bfe_i32 v39, s60, v3, 1
    v_and_b32 v39, 0xff800000, v39
    v_sub_u32 v2, 13, v3
    v_med3_i32 v2, v2, 0, 2
    v_lshlrev_b32 v2, 3, v2
    v_mov_b32 v40, -1
    v_lshrrev_b32 v40, v2, v40
    v_lshrrev_b32 v40, v2, v40
    v_sub_u32 v2, 15, v3
    v_med3_i32 v2, v2, 0, 2
    v_lshlrev_b32 v2, 3, v2
    v_mov_b32 v41, -1
    v_lshrrev_b32 v41, v2, v41
    v_lshrrev_b32 v41, v2, v41
    v_mul_u32_u24 v25, 20224, v5
    v_add_u32 v25, v25, v6
    v_lshrrev_b32 v24, 5, v1
    v_mul_u32_u24 v24, 19968, v24
    v_add_u32 v24, v24, v6
    v_lshlrev_b32 v26, 4, v4
    v_add_u32 v26, 162568, v26
    v_bfe_u32 v2, v1, 2, 2
    v_lshlrev_b32 v2, 7, v2
    v_and_b32 v3, 8, v1
    v_lshl_add_u32 v2, v3, 2, v2
    v_and_b32 v3, 3, v1
    v_lshl_add_u32 v2, v3, 3, v2
    v_and_b32 v3, 48, v1
    s_mov_b32 s62, 0xffff
    s_mov_b32 s60, 201329216
    s_mov_b32 s61, 373298176
    v_lshrrev_b64 v[46:47], v3, s[60:61]
    v_and_or_b32 v9, v46, s62, v2
    s_mov_b32 s60, 37748736
    s_mov_b32 s61, 2550175296
    v_lshrrev_b64 v[46:47], v3, s[60:61]
    v_and_or_b32 v10, v46, s62, v2
    s_mov_b32 s60, 469766720
    s_mov_b32 s61, 977285120
    v_lshrrev_b64 v[46:47], v3, s[60:61]
    v_and_or_b32 v11, v46, s62, v2
    s_mov_b32 s60, 2483063360
    s_mov_b32 s61, 2654996480
    v_lshrrev_b64 v[46:47], v3, s[60:61]
    v_and_or_b32 v12, v46, s62, v2
    s_mov_b32 s60, 574627840
    s_mov_b32 s61, 2051045376
    v_lshrrev_b64 v[46:47], v3, s[60:61]
    v_and_or_b32 v13, v46, s62, v2
    s_mov_b32 s60, 1073757184
    s_mov_b32 s61, 1610635840
    v_lshrrev_b64 v[46:47], v3, s[60:61]
    v_and_or_b32 v14, v46, s62, v2
    s_mov_b32 s60, 1140858432
    s_mov_b32 s61, 2147507776
    v_lshrrev_b64 v[46:47], v3, s[60:61]
    v_and_or_b32 v15, v46, s62, v2
    v_lshrrev_b32 v2, 3, v1
    v_bitop3_b32 v3, v1, v2, 7 bitop3:0x28
    v_mul_u32_u24 v7, 2560, v2
    v_lshl_add_u32 v7, v3, 4, v7
    v_lshrrev_b32 v2, 5, v1
    v_bitop3_b32 v2, v2, v4, 7 bitop3:0x28
    v_lshlrev_b32 v8, 7, v4
    v_lshl_add_u32 v8, v2, 4, v8
    v_and_b32 v2, 1, v5
    v_lshl_add_u32 v8, v2, 3, v8
    v_bfe_u32 v2, v0, 3, 5
    v_and_b32 v3, 6, v2
    v_bitop3_b32 v3, v0, v3, 7 bitop3:0x28
    v_mul_u32_u24 v16, 1280, v2
    v_lshl_add_u32 v16, v3, 4, v16
    s_lshl_b32 s98, s56, 4
    s_mul_i32 s60, s57, 13
    s_add_u32 s98, s98, s60
    s_add_u32 s98, s98, 458880
    s_add_u32 s98, s98, s58
    s_cmp_eq_u32 s59, 0
    s_cselect_b32 s98, s98, 2146435072
    s_add_u32 s96, s56, 8
    s_mulk_i32 s96, 1408
    s_mul_i32 s60, s57, 1144
    s_add_u32 s96, s96, s60
    s_add_u32 s96, s96, 1048576
    s_and_b32 s62, s2, 1
    s_mulk_i32 s62, 10240
    s_add_u32 s62, s62, s96
    s_sub_u32 s63, s54, s53
    s_and_b32 s60, s2, 7
    s_mul_i32 s60, s60, 25
    s_add_u32 s63, s63, s60
    s_mulk_i32 s63, 11520
    s_add_u32 s63, s63, 4194304
    v_mul_u32_u24 v2, 272, v4
    v_add_u32 v2, 129792, v2
    v_lshlrev_b32 v3, 3, v5
    s_waitcnt lgkmcnt(0)
    s_mul_i32 s52, s52, 0x9E3779B1
    s_add_u32 s52, s52, 0x7F4A7C15
    s_or_b32 s52, s52, 1
    v_mov_b32 v46, s52
    ds_write_b32 v19, v46 offset:32
    v_bfe_u32 v20, s4, v3, 8
    v_bfe_u32 v21, s5, v3, 8
    v_add_u32 v20, v20, v2
    v_add_u32 v21, v21, v2
    v_lshrrev_b32 v2, 2, v1
    v_mul_u32_u24 v2, 136, v2
    v_add_u32 v2, 88448, v2
    v_add_u32 v23, s7, v2
    v_lshlrev_b32 v3, 3, v1
    v_bfe_u32 v22, s6, v3, 8
    v_add_u32 v22, v22, v2
    s_add_u32 s9, s9, s62
    s_add_u32 s10, s10, s62
    s_add_u32 s11, s11, s63
    s_add_u32 s12, s12, s63
    s_add_u32 s5, s9, 40960
    s_mul_i32 s60, s8, 20480
    s_add_u32 s96, s96, s60
    s_lshl4_add_u32 s95, s8, s56
    s_cmp_eq_u32 s8, 6
    s_cselect_b32 s101, 1, 2
    s_cmpk_ge_i32 s95, 1024
    s_cselect_b32 s101, 0, s101
    s_mul_i32 s97, s95, 2560
    s_add_u32 s97, s97, s57
    s_add_u32 s97, s97, s58
    s_add_u32 s94, s97, 20480
    s_cmp_eq_u32 s8, 0
    s_cselect_b32 s97, 2146435072, s97
    s_cselect_b32 s61, 2146435072, 0
    s_and_b32 s60, s53, 2
    s_mul_i32 s22, s60, 204800
    s_sub_u32 s23, 409600, s22
    s_add_u32 s22, s22, s58
    s_add_u32 s23, s23, s58
    s_mulk_i32 s60, 5120
    s_sub_u32 s4, s96, s60
    s_add_u32 s4, s4, 10240
    s_add_u32 s96, s96, s60
    s_add_u32 s92, s96, 4096
    s_add_u32 s93, s92, 4096
    s_add_u32 s6, s4, 4096
    s_add_u32 s7, s6, 4096
    v_bfe_i32 v2, v1, 3, 1
    v_bfi_b32 v2, v2, 0, s61
    v_or_b32 v27, v2, v6
    s_and_b32 s60, s2, 4
    s_lshl_b32 s60, s60, 8
    s_add_u32 s95, s95, s60
    s_lshl_b32 s60, s8, 11
    s_add_u32 s60, s60, 147200
    v_add_u32 v8, s60, v8
    s_lshl_b32 s60, s8, 8
    s_add_u32 s60, s60, 161536
    v_lshl_add_u32 v17, v4, 4, s60
    v_bitop3_b32 v2, v5, v4, 7 bitop3:0x28
    v_lshlrev_b32 v2, 4, v2
    v_lshl_add_u32 v42, v4, 7, v2
    v_add_u32 v42, 77824, v42
    v_xor_b32 v43, 64, v42
    v_bfe_u32 v2, v1, 3, 2
    v_xor_b32 v2, s59, v2
    v_lshlrev_b32 v2, 5, v2
    v_lshl_add_u32 v2, v5, 10, v2
    v_bfe_u32 v3, v1, 2, 2
    v_lshl_add_u32 v2, v3, 7, v2
    v_and_b32 v3, 3, v1
    v_lshl_add_u32 v2, v3, 3, v2
    v_add_u32 v44, 92160, v2
    s_lshl_b32 s60, s59, 5
    s_add_u32 s60, s60, 116736
    v_mul_u32_u24 v46, 272, v4
    v_lshl_add_u32 v2, v5, 3, s60
    v_add_u32 v46, v46, v2
    v_mul_u32_u24 v47, 136, v4
    v_add_u32 v47, v47, v2
    v_subrev_u32 v47, 34816, v47
    v_lshlrev_b32 v45, 4, v4
    v_add_u32 v45, 161536, v45
    s_mov_b64 exec, 0
    s_branch TL0
TL0_END:
    s_mov_b64 exec, -1
    v_mov_b32 v241, 0x3f803f80
    v_mov_b32 v245, s52
    v_mov_b32 v247, s52
    s_bfe_u32 s60, s2, 0x10002
    s_lshl4_add_u32 s60, s68, s60
    s_sub_u32 s60, 0xffff, s60
    v_lshlrev_b32 v239, 1, v232
    v_sub_u32 v239, s60, v239
    v_lshlrev_b32 v243, 3, v232
    v_lshlrev_b32 v232, 4, v232
    v_mov_b32 v249, s52
    s_setprio 3
    s_waitcnt vmcnt(3)
    v_dot2_f32_bf16 v233, v212, v241, 0
    v_dot2_f32_bf16 v234, v212, v212, 0
    v_dot2_f32_bf16 v233, v213, v241, v233
    v_dot2_f32_bf16 v234, v213, v213, v234
    v_dot2_f32_bf16 v233, v214, v241, v233
    v_dot2_f32_bf16 v234, v214, v214, v234
    v_dot2_f32_bf16 v233, v215, v241, v233
    v_dot2_f32_bf16 v234, v215, v215, v234
    v_dot2_f32_bf16 v233, v216, v241, v233
    v_dot2_f32_bf16 v234, v216, v216, v234
    v_dot2_f32_bf16 v233, v217, v241, v233
    v_dot2_f32_bf16 v234, v217, v217, v234
    v_dot2_f32_bf16 v233, v218, v241, v233
    v_dot2_f32_bf16 v234, v218, v218, v234
    v_dot2_f32_bf16 v233, v219, v241, v233
    v_dot2_f32_bf16 v234, v219, v219, v234
    v_dot2_f32_bf16 v233, v220, v241, v233
    v_dot2_f32_bf16 v234, v220, v220, v234
    v_dot2_f32_bf16 v233, v221, v241, v233
    v_dot2_f32_bf16 v234, v221, v221, v234
    s_waitcnt vmcnt(0)
    v_dot2_f32_bf16 v235, v212, v222, 0
    v_dot2_f32_bf16 v236, v222, v241, 0
    v_dot2_f32_bf16 v235, v213, v223, v235
    v_dot2_f32_bf16 v236, v223, v241, v236
    v_dot2_f32_bf16 v235, v214, v224, v235
    v_dot2_f32_bf16 v236, v224, v241, v236
    v_dot2_f32_bf16 v235, v215, v225, v235
    v_dot2_f32_bf16 v236, v225, v241, v236
    v_dot2_f32_bf16 v235, v216, v226, v235
    v_dot2_f32_bf16 v236, v226, v241, v236
    v_dot2_f32_bf16 v235, v217, v227, v235
    v_dot2_f32_bf16 v236, v227, v241, v236
    v_dot2_f32_bf16 v235, v218, v228, v235
    v_dot2_f32_bf16 v236, v228, v241, v236
    v_dot2_f32_bf16 v235, v219, v229, v235
    v_dot2_f32_bf16 v236, v229, v241, v236
    v_dot2_f32_bf16 v235, v220, v230, v235
    v_dot2_f32_bf16 v236, v230, v241, v236
    v_dot2_f32_bf16 v235, v221, v231, v235
    v_dot2_f32_bf16 v236, v231, v241, v236
    v_permlane16_swap_b32 v233, v234
    v_add_f32 v233, v233, v234
    s_nop 0
    v_permlane16_swap_b32 v235, v236
    v_add_f32 v235, v235, v236
    v_add_f32_dpp v233, v233, v233 row_ror:8 row_mask:0xf bank_mask:0xf
    s_nop 0
    v_add_f32_dpp v235, v235, v235 row_ror:8 row_mask:0xf bank_mask:0xf
    v_add_f32_dpp v233, v233, v233 row_ror:4 row_mask:0xf bank_mask:0xf
    s_nop 0
    v_add_f32_dpp v235, v235, v235 row_ror:4 row_mask:0xf bank_mask:0xf
    v_add_f32_dpp v233, v233, v233 row_ror:2 row_mask:0xf bank_mask:0xf
    s_nop 0
    v_add_f32_dpp v235, v235, v235 row_ror:2 row_mask:0xf bank_mask:0xf
    v_add_f32_dpp v233, v233, v233 row_ror:1 row_mask:0xf bank_mask:0xf
    s_nop 0
    v_add_f32_dpp v235, v235, v235 row_ror:1 row_mask:0xf bank_mask:0xf
    v_mul_f32 v233, 0x3acccccd, v233
    v_mov_b32 v236, v235
    v_mov_b32 v234, v233
    s_nop 0
    v_permlane16_swap_b32 v235, v236
    v_permlane16_swap_b32 v233, v234
    v_fma_f32 v234, -v233, v233, v234
    v_max_f32 v234, 0, v234
    v_cvt_pk_bf16_f32 v237, v233, v234
    v_lshlrev_b32 v233, 16, v237
    v_and_b32 v234, 0xffff0000, v237
    v_add_f32 v234, 0x3727c5ac, v234
    v_cvt_pk_bf16_f32 v234, v234, v234
    v_lshlrev_b32 v234, 16, v234
    v_sqrt_f32 v234, v234
    v_fma_f32 v235, -v233, v236, v235
    v_cvt_pk_bf16_f32 v234, v234, v234
    v_lshlrev_b32 v234, 16, v234
    v_rcp_f32 v246, v234
    s_mov_b32 exec_lo, 1
    s_mov_b32 exec_hi, 1
    v_mul_f32 v235, v235, v246
    v_xor_b32 v244, 0x80000000, v233
    v_cvt_pk_bf16_f32 v235, v235, v235
    buffer_store_dwordx4 v[244:247], v232, s[28:31], s70 offen sc1
    v_ashrrev_i32 v237, 31, v235
    v_or_b32 v237, 0x80000000, v237
    v_xor_b32 v235, v235, v237
    v_bfi_b32 v248, s55, v235, v239
    buffer_store_dwordx2 v[248:249], v243, s[28:31], s71 offen sc1
    s_mov_b64 exec, -1
    s_setprio 0
    s_mov_b32 s63, 0
    s_mov_b32 s64, 77824
    s_mov_b32 s67, 38912
    s_waitcnt lgkmcnt(0)
    s_barrier
    ds_read_b64_tr_b16 v[132:133], v44 offset:0
    ds_read_b64_tr_b16 v[134:135], v44 offset:512
    ds_read_b128 v[156:159], v42 offset:0
    ds_read_b64_tr_b16 v[136:137], v44 offset:8192
    ds_read_b64_tr_b16 v[138:139], v44 offset:8704
    ds_read_b128 v[160:163], v42 offset:2048
    ds_read_b64_tr_b16 v[140:141], v44 offset:16384
    ds_read_b64_tr_b16 v[142:143], v44 offset:16896
    ds_read_b128 v[164:167], v42 offset:4096
    ds_read_b128 v[168:171], v42 offset:6144
    ds_read_b128 v[172:175], v42 offset:8192
    ds_read_b128 v[176:179], v42 offset:10240
    ds_read_b128 v[180:183], v42 offset:12288
    s_waitcnt lgkmcnt(10)
    v_mfma_f32_16x16x32_bf16 v[48:51], v[132:135], v[156:159], 0
    ds_read_b64_tr_b16 v[144:145], v44 offset:4096
    s_waitcnt lgkmcnt(9)
    v_mfma_f32_16x16x32_bf16 v[76:79], v[136:139], v[156:159], 0
    ds_read_b64_tr_b16 v[146:147], v44 offset:4608
    s_waitcnt lgkmcnt(9)
    v_mfma_f32_16x16x32_bf16 v[52:55], v[132:135], v[160:163], 0
    ds_read_b128 v[184:187], v43 offset:0
    v_mfma_f32_16x16x32_bf16 v[80:83], v[136:139], v[160:163], 0
    ds_read_b64_tr_b16 v[148:149], v44 offset:12288
    s_waitcnt lgkmcnt(9)
    v_mfma_f32_16x16x32_bf16 v[104:107], v[140:143], v[156:159], 0
    ds_read_b64_tr_b16 v[150:151], v44 offset:12800
    v_mfma_f32_16x16x32_bf16 v[108:111], v[140:143], v[160:163], 0
    ds_read_b128 v[188:191], v43 offset:2048
    s_waitcnt lgkmcnt(10)
    v_mfma_f32_16x16x32_bf16 v[56:59], v[132:135], v[164:167], 0
    ds_read_b64_tr_b16 v[152:153], v44 offset:20480
    v_mfma_f32_16x16x32_bf16 v[84:87], v[136:139], v[164:167], 0
    ds_read_b64_tr_b16 v[154:155], v44 offset:20992
    v_mfma_f32_16x16x32_bf16 v[112:115], v[140:143], v[164:167], 0
    ds_read_b128 v[192:195], v43 offset:4096
    s_waitcnt lgkmcnt(12)
    v_mfma_f32_16x16x32_bf16 v[60:63], v[132:135], v[168:171], 0
    ds_read_b128 v[196:199], v43 offset:6144
    v_mfma_f32_16x16x32_bf16 v[88:91], v[136:139], v[168:171], 0
    ds_read_b128 v[200:203], v43 offset:8192
    v_mfma_f32_16x16x32_bf16 v[116:119], v[140:143], v[168:171], 0
    ds_read_b128 v[204:207], v43 offset:10240
    s_waitcnt lgkmcnt(14)
    v_mfma_f32_16x16x32_bf16 v[64:67], v[132:135], v[172:175], 0
    ds_read_b128 v[208:211], v43 offset:12288
    v_mfma_f32_16x16x32_bf16 v[92:95], v[136:139], v[172:175], 0
    v_mfma_f32_16x16x32_bf16 v[120:123], v[140:143], v[172:175], 0
    s_cmp_eq_u32 s64, 77824
    s_cselect_b32 s66, 4294889472, s67
    s_waitcnt lgkmcnt(14)
    v_mfma_f32_16x16x32_bf16 v[68:71], v[132:135], v[176:179], 0
    s_add_u32 s64, s64, s66
    s_add_u32 s63, s63, 1
    v_mfma_f32_16x16x32_bf16 v[96:99], v[136:139], v[176:179], 0
    v_add_u32 v44, s66, v44
    v_mfma_f32_16x16x32_bf16 v[124:127], v[140:143], v[176:179], 0
    v_add_u32 v42, s66, v42
    s_waitcnt lgkmcnt(13)
    v_mfma_f32_16x16x32_bf16 v[72:75], v[132:135], v[180:183], 0
    v_add_u32 v43, s66, v43
    v_mfma_f32_16x16x32_bf16 v[100:103], v[136:139], v[180:183], 0
    s_cmp_lt_u32 s63, 9
    v_mfma_f32_16x16x32_bf16 v[128:131], v[140:143], v[180:183], 0
    s_branch C_MID
C_LOOP:
    s_waitcnt lgkmcnt(10)
    v_mfma_f32_16x16x32_bf16 v[48:51], v[132:135], v[156:159], v[48:51]
    ds_read_b64_tr_b16 v[144:145], v44 offset:4096
    s_waitcnt lgkmcnt(9)
    v_mfma_f32_16x16x32_bf16 v[76:79], v[136:139], v[156:159], v[76:79]
    ds_read_b64_tr_b16 v[146:147], v44 offset:4608
    s_waitcnt lgkmcnt(9)
    v_mfma_f32_16x16x32_bf16 v[52:55], v[132:135], v[160:163], v[52:55]
    ds_read_b128 v[184:187], v43 offset:0
    v_mfma_f32_16x16x32_bf16 v[80:83], v[136:139], v[160:163], v[80:83]
    ds_read_b64_tr_b16 v[148:149], v44 offset:12288
    s_waitcnt lgkmcnt(9)
    v_mfma_f32_16x16x32_bf16 v[104:107], v[140:143], v[156:159], v[104:107]
    ds_read_b64_tr_b16 v[150:151], v44 offset:12800
    v_mfma_f32_16x16x32_bf16 v[108:111], v[140:143], v[160:163], v[108:111]
    ds_read_b128 v[188:191], v43 offset:2048
    s_waitcnt lgkmcnt(10)
    v_mfma_f32_16x16x32_bf16 v[56:59], v[132:135], v[164:167], v[56:59]
    ds_read_b64_tr_b16 v[152:153], v44 offset:20480
    v_mfma_f32_16x16x32_bf16 v[84:87], v[136:139], v[164:167], v[84:87]
    ds_read_b64_tr_b16 v[154:155], v44 offset:20992
    v_mfma_f32_16x16x32_bf16 v[112:115], v[140:143], v[164:167], v[112:115]
    ds_read_b128 v[192:195], v43 offset:4096
    s_waitcnt lgkmcnt(12)
    v_mfma_f32_16x16x32_bf16 v[60:63], v[132:135], v[168:171], v[60:63]
    ds_read_b128 v[196:199], v43 offset:6144
    v_mfma_f32_16x16x32_bf16 v[88:91], v[136:139], v[168:171], v[88:91]
    ds_read_b128 v[200:203], v43 offset:8192
    v_mfma_f32_16x16x32_bf16 v[116:119], v[140:143], v[168:171], v[116:119]
    ds_read_b128 v[204:207], v43 offset:10240
    s_waitcnt lgkmcnt(14)
    v_mfma_f32_16x16x32_bf16 v[64:67], v[132:135], v[172:175], v[64:67]
    ds_read_b128 v[208:211], v43 offset:12288
    v_mfma_f32_16x16x32_bf16 v[92:95], v[136:139], v[172:175], v[92:95]
    v_mfma_f32_16x16x32_bf16 v[120:123], v[140:143], v[172:175], v[120:123]
    s_cmp_eq_u32 s64, 77824
    s_cselect_b32 s66, 4294889472, s67
    s_waitcnt lgkmcnt(14)
    v_mfma_f32_16x16x32_bf16 v[68:71], v[132:135], v[176:179], v[68:71]
    s_add_u32 s64, s64, s66
    s_add_u32 s63, s63, 1
    v_mfma_f32_16x16x32_bf16 v[96:99], v[136:139], v[176:179], v[96:99]
    v_add_u32 v44, s66, v44
    v_mfma_f32_16x16x32_bf16 v[124:127], v[140:143], v[176:179], v[124:127]
    v_add_u32 v42, s66, v42
    s_waitcnt lgkmcnt(13)
    v_mfma_f32_16x16x32_bf16 v[72:75], v[132:135], v[180:183], v[72:75]
    v_add_u32 v43, s66, v43
    v_mfma_f32_16x16x32_bf16 v[100:103], v[136:139], v[180:183], v[100:103]
    s_cmp_lt_u32 s63, 9
    v_mfma_f32_16x16x32_bf16 v[128:131], v[140:143], v[180:183], v[128:131]
C_MID:
    s_waitcnt lgkmcnt(0)
    v_mfma_f32_16x16x32_bf16 v[48:51], v[144:147], v[184:187], v[48:51]
    v_mfma_f32_16x16x32_bf16 v[76:79], v[148:151], v[184:187], v[76:79]
    v_mfma_f32_16x16x32_bf16 v[104:107], v[152:155], v[184:187], v[104:107]
    v_mfma_f32_16x16x32_bf16 v[52:55], v[144:147], v[188:191], v[52:55]
    v_mfma_f32_16x16x32_bf16 v[80:83], v[148:151], v[188:191], v[80:83]
    v_mfma_f32_16x16x32_bf16 v[108:111], v[152:155], v[188:191], v[108:111]
    s_barrier
    ds_read_b64_tr_b16 v[132:133], v44 offset:0
    v_mfma_f32_16x16x32_bf16 v[56:59], v[144:147], v[192:195], v[56:59]
    ds_read_b64_tr_b16 v[134:135], v44 offset:512
    v_mfma_f32_16x16x32_bf16 v[84:87], v[148:151], v[192:195], v[84:87]
    ds_read_b128 v[156:159], v42 offset:0
    v_mfma_f32_16x16x32_bf16 v[112:115], v[152:155], v[192:195], v[112:115]
    ds_read_b64_tr_b16 v[136:137], v44 offset:8192
    v_mfma_f32_16x16x32_bf16 v[60:63], v[144:147], v[196:199], v[60:63]
    ds_read_b64_tr_b16 v[138:139], v44 offset:8704
    v_mfma_f32_16x16x32_bf16 v[88:91], v[148:151], v[196:199], v[88:91]
    ds_read_b128 v[160:163], v42 offset:2048
    v_mfma_f32_16x16x32_bf16 v[116:119], v[152:155], v[196:199], v[116:119]
    ds_read_b64_tr_b16 v[140:141], v44 offset:16384
    v_mfma_f32_16x16x32_bf16 v[64:67], v[144:147], v[200:203], v[64:67]
    ds_read_b64_tr_b16 v[142:143], v44 offset:16896
    v_mfma_f32_16x16x32_bf16 v[92:95], v[148:151], v[200:203], v[92:95]
    ds_read_b128 v[164:167], v42 offset:4096
    v_mfma_f32_16x16x32_bf16 v[120:123], v[152:155], v[200:203], v[120:123]
    ds_read_b128 v[168:171], v42 offset:6144
    v_mfma_f32_16x16x32_bf16 v[68:71], v[144:147], v[204:207], v[68:71]
    ds_read_b128 v[172:175], v42 offset:8192
    v_mfma_f32_16x16x32_bf16 v[96:99], v[148:151], v[204:207], v[96:99]
    ds_read_b128 v[176:179], v42 offset:10240
    v_mfma_f32_16x16x32_bf16 v[124:127], v[152:155], v[204:207], v[124:127]
    ds_read_b128 v[180:183], v42 offset:12288
    v_mfma_f32_16x16x32_bf16 v[72:75], v[144:147], v[208:211], v[72:75]
    v_mfma_f32_16x16x32_bf16 v[100:103], v[148:151], v[208:211], v[100:103]
    v_mfma_f32_16x16x32_bf16 v[128:131], v[152:155], v[208:211], v[128:131]
    s_cbranch_scc1 C_LOOP
TL0:
    s_cbranch_execz TL0_END
    s_setprio 2
    s_waitcnt lgkmcnt(10)
    v_mfma_f32_16x16x32_bf16 v[48:51], v[132:135], v[156:159], v[48:51]
    ds_read_b64_tr_b16 v[144:145], v44 offset:4096
    s_waitcnt lgkmcnt(9)
    v_mfma_f32_16x16x32_bf16 v[76:79], v[136:139], v[156:159], v[76:79]
    ds_read_b64_tr_b16 v[146:147], v44 offset:4608
    s_waitcnt lgkmcnt(9)
    v_mfma_f32_16x16x32_bf16 v[52:55], v[132:135], v[160:163], v[52:55]
    ds_read_b64_tr_b16 v[148:149], v44 offset:12288
    v_mfma_f32_16x16x32_bf16 v[80:83], v[136:139], v[160:163], v[80:83]
    ds_read_b64_tr_b16 v[150:151], v44 offset:12800
    s_waitcnt lgkmcnt(8)
    v_mfma_f32_16x16x32_bf16 v[56:59], v[132:135], v[164:167], v[56:59]
    ds_read_b128 v[184:187], v43 offset:0
    v_mfma_f32_16x16x32_bf16 v[84:87], v[136:139], v[164:167], v[84:87]
    ds_read_b128 v[188:191], v43 offset:2048
    s_waitcnt lgkmcnt(9)
    v_mfma_f32_16x16x32_bf16 v[60:63], v[132:135], v[168:171], v[60:63]
    ds_read_b128 v[192:195], v43 offset:4096
    v_mfma_f32_16x16x32_bf16 v[88:91], v[136:139], v[168:171], v[88:91]
    ds_read_b128 v[196:199], v43 offset:6144
    s_waitcnt lgkmcnt(10)
    v_mfma_f32_16x16x32_bf16 v[64:67], v[132:135], v[172:175], v[64:67]
    ds_read_b128 v[200:203], v43 offset:8192
    v_mfma_f32_16x16x32_bf16 v[92:95], v[136:139], v[172:175], v[92:95]
    ds_read_b128 v[204:207], v43 offset:10240
    s_waitcnt lgkmcnt(11)
    v_mfma_f32_16x16x32_bf16 v[68:71], v[132:135], v[176:179], v[68:71]
    ds_read_b128 v[208:211], v43 offset:12288
    v_mfma_f32_16x16x32_bf16 v[96:99], v[136:139], v[176:179], v[96:99]
    ds_read_b128 v[212:215], v45 offset:0
    s_waitcnt lgkmcnt(12)
    v_mfma_f32_16x16x32_bf16 v[72:75], v[132:135], v[180:183], v[72:75]
    ds_read_b128 v[216:219], v45 offset:256
    v_mfma_f32_16x16x32_bf16 v[100:103], v[136:139], v[180:183], v[100:103]
    ds_read_b128 v[220:223], v45 offset:512
    s_waitcnt lgkmcnt(7)
    v_mfma_f32_16x16x32_bf16 v[48:51], v[144:147], v[184:187], v[48:51]
    ds_read_b64_tr_b16 v[152:153], v44 offset:20480
    v_mfma_f32_16x16x32_bf16 v[76:79], v[148:151], v[184:187], v[76:79]
    ds_read_b64_tr_b16 v[154:155], v44 offset:20992
    v_mfma_f32_16x16x32_bf16 v[52:55], v[144:147], v[188:191], v[52:55]
    ds_read_b128 v[224:227], v45 offset:768
    s_waitcnt lgkmcnt(3)
    v_mfma_f32_16x16x32_bf16 v[80:83], v[148:151], v[188:191], v[80:83]
    ds_read_b128 v[228:231], v45 offset:1024
    v_mov_b32_dpp v240, v48 row_newbcast:0 row_mask:0xf bank_mask:0xf
    v_mov_b32_dpp v241, v49 row_newbcast:0 row_mask:0xf bank_mask:0xf
    v_mfma_f32_16x16x32_bf16 v[56:59], v[144:147], v[192:195], v[56:59]
    ds_read_b128 v[232:235], v45 offset:1280
    v_mov_b32_dpp v242, v50 row_newbcast:0 row_mask:0xf bank_mask:0xf
    v_mov_b32_dpp v243, v51 row_newbcast:0 row_mask:0xf bank_mask:0xf
    v_mfma_f32_16x16x32_bf16 v[84:87], v[148:151], v[192:195], v[84:87]
    ds_read_b128 v[236:239], v45 offset:1536
    v_mov_b32_dpp v244, v76 row_newbcast:0 row_mask:0xf bank_mask:0xf
    v_mov_b32_dpp v245, v77 row_newbcast:0 row_mask:0xf bank_mask:0xf
    v_mfma_f32_16x16x32_bf16 v[60:63], v[144:147], v[196:199], v[60:63]
    v_mov_b32_dpp v246, v78 row_newbcast:0 row_mask:0xf bank_mask:0xf
    v_mov_b32_dpp v247, v79 row_newbcast:0 row_mask:0xf bank_mask:0xf
    v_mfma_f32_16x16x32_bf16 v[88:91], v[148:151], v[196:199], v[88:91]
    v_fmac_f32 v48, v212, v240
    v_fmac_f32 v49, v212, v241
    v_mfma_f32_16x16x32_bf16 v[64:67], v[144:147], v[200:203], v[64:67]
    v_fmac_f32 v50, v212, v242
    v_fmac_f32 v51, v212, v243
    s_waitcnt lgkmcnt(0)
    v_mfma_f32_16x16x32_bf16 v[92:95], v[148:151], v[200:203], v[92:95]
    v_cvt_pk_bf16_f32 v48, v48, v49
    v_cvt_pk_bf16_f32 v49, v50, v51
    v_mfma_f32_16x16x32_bf16 v[68:71], v[144:147], v[204:207], v[68:71]
    ds_write_b64 v46, v[48:49] offset:128
    v_fmac_f32 v76, v212, v244
    v_mfma_f32_16x16x32_bf16 v[96:99], v[148:151], v[204:207], v[96:99]
    v_fmac_f32 v77, v212, v245
    v_fmac_f32 v78, v212, v246
    v_mfma_f32_16x16x32_bf16 v[72:75], v[144:147], v[208:211], v[72:75]
    v_fmac_f32 v79, v212, v247
    v_mul_f32 v76, v76, v214
    v_mfma_f32_16x16x32_bf16 v[100:103], v[148:151], v[208:211], v[100:103]
    v_mul_f32 v77, v77, v214
    v_mul_f32 v78, v78, v214
    v_mfma_f32_16x16x32_bf16 v[104:107], v[140:143], v[156:159], v[104:107]
    v_mul_f32 v79, v79, v214
    v_cvt_pk_bf16_f32 v76, v76, v77
    v_mfma_f32_16x16x32_bf16 v[108:111], v[140:143], v[160:163], v[108:111]
    v_cvt_pk_bf16_f32 v77, v78, v79
    ds_write_b64 v46, v[76:77] offset:0
    v_mfma_f32_16x16x32_bf16 v[104:107], v[152:155], v[184:187], v[104:107]
    v_fmac_f32 v52, v216, v240
    v_fmac_f32 v53, v216, v241
    v_mfma_f32_16x16x32_bf16 v[108:111], v[152:155], v[188:191], v[108:111]
    v_fmac_f32 v54, v216, v242
    v_fmac_f32 v55, v216, v243
    v_mfma_f32_16x16x32_bf16 v[112:115], v[140:143], v[164:167], v[112:115]
    v_cvt_pk_bf16_f32 v52, v52, v53
    v_cvt_pk_bf16_f32 v53, v54, v55
    v_mfma_f32_16x16x32_bf16 v[116:119], v[140:143], v[168:171], v[116:119]
    ds_write_b64 v46, v[52:53] offset:4480
    v_fmac_f32 v80, v216, v244
    v_mfma_f32_16x16x32_bf16 v[112:115], v[152:155], v[192:195], v[112:115]
    v_fmac_f32 v81, v216, v245
    v_fmac_f32 v82, v216, v246
    v_mfma_f32_16x16x32_bf16 v[116:119], v[152:155], v[196:199], v[116:119]
    v_fmac_f32 v83, v216, v247
    v_mul_f32 v80, v80, v218
    v_mfma_f32_16x16x32_bf16 v[120:123], v[140:143], v[172:175], v[120:123]
    v_mul_f32 v81, v81, v218
    v_mul_f32 v82, v82, v218
    v_mfma_f32_16x16x32_bf16 v[124:127], v[140:143], v[176:179], v[124:127]
    v_mul_f32 v83, v83, v218
    v_cvt_pk_bf16_f32 v80, v80, v81
    v_mfma_f32_16x16x32_bf16 v[120:123], v[152:155], v[200:203], v[120:123]
    v_cvt_pk_bf16_f32 v81, v82, v83
    ds_write_b64 v46, v[80:81] offset:4352
    v_mfma_f32_16x16x32_bf16 v[124:127], v[152:155], v[204:207], v[124:127]
    v_fmac_f32 v56, v220, v240
    v_fmac_f32 v57, v220, v241
    v_mfma_f32_16x16x32_bf16 v[128:131], v[140:143], v[180:183], v[128:131]
    v_fmac_f32 v58, v220, v242
    v_fmac_f32 v59, v220, v243
    v_mfma_f32_16x16x32_bf16 v[128:131], v[152:155], v[208:211], v[128:131]
    v_cvt_pk_bf16_f32 v56, v56, v57
    v_cvt_pk_bf16_f32 v57, v58, v59
    ds_write_b64 v46, v[56:57] offset:8832
    v_fmac_f32 v84, v220, v244
    v_fmac_f32 v85, v220, v245
    v_fmac_f32 v86, v220, v246
    v_fmac_f32 v87, v220, v247
    v_mul_f32 v84, v84, v222
    v_mul_f32 v85, v85, v222
    v_mul_f32 v86, v86, v222
    v_mul_f32 v87, v87, v222
    v_cvt_pk_bf16_f32 v84, v84, v85
    v_cvt_pk_bf16_f32 v85, v86, v87
    ds_write_b64 v46, v[84:85] offset:8704
    v_pk_fma_f32 v[88:89], v[224:225], v[244:245], v[88:89] op_sel_hi:[0,1,1]
    v_pk_fma_f32 v[90:91], v[224:225], v[246:247], v[90:91] op_sel_hi:[0,1,1]
    v_pk_fma_f32 v[60:61], v[224:225], v[240:241], v[60:61] op_sel_hi:[0,1,1]
    v_pk_fma_f32 v[62:63], v[224:225], v[242:243], v[62:63] op_sel_hi:[0,1,1]
    v_pk_mul_f32 v[88:89], v[88:89], v[226:227] op_sel_hi:[1,0]
    v_pk_mul_f32 v[90:91], v[90:91], v[226:227] op_sel_hi:[1,0]
    v_cvt_pk_bf16_f32 v60, v60, v61
    v_cvt_pk_bf16_f32 v61, v62, v63
    ds_write_b64 v46, v[60:61] offset:13184
    v_cvt_pk_bf16_f32 v88, v88, v89
    v_cvt_pk_bf16_f32 v89, v90, v91
    ds_write_b64 v46, v[88:89] offset:13056
    v_pk_fma_f32 v[92:93], v[228:229], v[244:245], v[92:93] op_sel_hi:[0,1,1]
    v_pk_fma_f32 v[94:95], v[228:229], v[246:247], v[94:95] op_sel_hi:[0,1,1]
    v_pk_fma_f32 v[64:65], v[228:229], v[240:241], v[64:65] op_sel_hi:[0,1,1]
    v_pk_fma_f32 v[66:67], v[228:229], v[242:243], v[66:67] op_sel_hi:[0,1,1]
    v_pk_mul_f32 v[92:93], v[92:93], v[230:231] op_sel_hi:[1,0]
    v_pk_mul_f32 v[94:95], v[94:95], v[230:231] op_sel_hi:[1,0]
    v_cvt_pk_bf16_f32 v64, v64, v65
    v_cvt_pk_bf16_f32 v65, v66, v67
    ds_write_b64 v46, v[64:65] offset:17536
    v_cvt_pk_bf16_f32 v92, v92, v93
    v_cvt_pk_bf16_f32 v93, v94, v95
    ds_write_b64 v46, v[92:93] offset:17408
    v_pk_fma_f32 v[96:97], v[232:233], v[244:245], v[96:97] op_sel_hi:[0,1,1]
    v_pk_fma_f32 v[98:99], v[232:233], v[246:247], v[98:99] op_sel_hi:[0,1,1]
    v_pk_fma_f32 v[68:69], v[232:233], v[240:241], v[68:69] op_sel_hi:[0,1,1]
    v_pk_fma_f32 v[70:71], v[232:233], v[242:243], v[70:71] op_sel_hi:[0,1,1]
    v_pk_mul_f32 v[96:97], v[96:97], v[234:235] op_sel_hi:[1,0]
    v_pk_mul_f32 v[98:99], v[98:99], v[234:235] op_sel_hi:[1,0]
    v_cvt_pk_bf16_f32 v68, v68, v69
    v_cvt_pk_bf16_f32 v69, v70, v71
    ds_write_b64 v46, v[68:69] offset:21888
    v_cvt_pk_bf16_f32 v96, v96, v97
    v_cvt_pk_bf16_f32 v97, v98, v99
    ds_write_b64 v46, v[96:97] offset:21760
    v_pk_fma_f32 v[100:101], v[236:237], v[244:245], v[100:101] op_sel_hi:[0,1,1]
    v_pk_fma_f32 v[102:103], v[236:237], v[246:247], v[102:103] op_sel_hi:[0,1,1]
    v_pk_fma_f32 v[72:73], v[236:237], v[240:241], v[72:73] op_sel_hi:[0,1,1]
    v_pk_fma_f32 v[74:75], v[236:237], v[242:243], v[74:75] op_sel_hi:[0,1,1]
    v_pk_mul_f32 v[100:101], v[100:101], v[238:239] op_sel_hi:[1,0]
    v_pk_mul_f32 v[102:103], v[102:103], v[238:239] op_sel_hi:[1,0]
    v_cvt_pk_bf16_f32 v72, v72, v73
    v_cvt_pk_bf16_f32 v73, v74, v75
    ds_write_b64 v46, v[72:73] offset:26240
    v_cvt_pk_bf16_f32 v100, v100, v101
    v_cvt_pk_bf16_f32 v101, v102, v103
    ds_write_b64 v46, v[100:101] offset:26112
    s_waitcnt lgkmcnt(0)
    s_barrier
    s_cmp_eq_u32 s13, 1
    s_cbranch_scc1 AC_S
    ds_read_b64 v[80:81], v20 offset:0
    ds_read_b64 v[82:83], v21 offset:0
    ds_read_b64 v[64:65], v20 offset:4480
    ds_read_b64 v[66:67], v21 offset:4480
    ds_read_b64 v[84:85], v20 offset:4352
    ds_read_b64 v[86:87], v21 offset:4352
    ds_read_b64 v[68:69], v20 offset:8832
    ds_read_b64 v[70:71], v21 offset:8832
    ds_read_b64 v[88:89], v20 offset:8704
    ds_read_b64 v[90:91], v21 offset:8704
    ds_read_b64 v[72:73], v20 offset:13184
    ds_read_b64 v[74:75], v21 offset:13184
    ds_read_b64 v[92:93], v20 offset:13056
    ds_read_b64 v[94:95], v21 offset:13056
    v_lshl_add_u32 v3, v5, 8, v26
    v_mov_b32 v0, v27
    v_mov_b32_dpp v248, v104 row_newbcast:0 row_mask:0xf bank_mask:0xf
    v_mov_b32_dpp v249, v105 row_newbcast:0 row_mask:0xf bank_mask:0xf
    v_mov_b32_dpp v250, v106 row_newbcast:0 row_mask:0xf bank_mask:0xf
    v_mov_b32_dpp v251, v107 row_newbcast:0 row_mask:0xf bank_mask:0xf
    v_pk_fma_f32 v[104:105], v[212:213], v[248:249], v[104:105] op_sel_hi:[0,1,1]
    v_pk_fma_f32 v[106:107], v[212:213], v[250:251], v[106:107] op_sel_hi:[0,1,1]
    v_pk_fma_f32 v[108:109], v[216:217], v[248:249], v[108:109] op_sel_hi:[0,1,1]
    v_pk_fma_f32 v[110:111], v[216:217], v[250:251], v[110:111] op_sel_hi:[0,1,1]
    v_pk_mul_f32 v[104:105], v[104:105], v[214:215] op_sel_hi:[1,0]
    v_pk_mul_f32 v[106:107], v[106:107], v[214:215] op_sel_hi:[1,0]
    v_pk_mul_f32 v[108:109], v[108:109], v[218:219] op_sel_hi:[1,0]
    v_pk_mul_f32 v[110:111], v[110:111], v[218:219] op_sel_hi:[1,0]
    v_cvt_pk_bf16_f32 v104, v104, v105
    v_cvt_pk_bf16_f32 v105, v106, v107
    ds_write_b64 v47, v[104:105] offset:0
    v_cvt_pk_bf16_f32 v108, v108, v109
    v_cvt_pk_bf16_f32 v109, v110, v111
    ds_write_b64 v47, v[108:109] offset:2176
    s_waitcnt lgkmcnt(10)
    v_mfma_f32_16x16x32_bf16 v[168:171], v[84:87], v[64:67], v[32:35]
    v_mfma_f32_16x16x32_bf16 v[48:51], v[80:83], v[64:67], v[36:39]
    s_waitcnt lgkmcnt(6)
    v_mfma_f32_16x16x32_bf16 v[172:175], v[88:91], v[68:71], v[32:35]
    v_mfma_f32_16x16x32_bf16 v[52:55], v[84:87], v[68:71], v[36:39]
    s_waitcnt lgkmcnt(2)
    v_mfma_f32_16x16x32_bf16 v[176:179], v[92:95], v[72:75], v[32:35]
    v_mfma_f32_16x16x32_bf16 v[56:59], v[88:91], v[72:75], v[36:39]
    s_branch AC_J
AC_S:
    ds_read_b64 v[80:81], v20 offset:0
    ds_read_b64 v[64:65], v20 offset:4480
    ds_read_b64 v[84:85], v20 offset:4352
    ds_read_b64 v[68:69], v20 offset:8832
    ds_read_b64 v[88:89], v20 offset:8704
    ds_read_b64 v[72:73], v20 offset:13184
    ds_read_b64 v[92:93], v20 offset:13056
    v_lshl_add_u32 v3, v5, 8, v26
    v_mov_b32 v0, v27
    v_mov_b32_dpp v248, v104 row_newbcast:0 row_mask:0xf bank_mask:0xf
    v_mov_b32_dpp v249, v105 row_newbcast:0 row_mask:0xf bank_mask:0xf
    v_mov_b32_dpp v250, v106 row_newbcast:0 row_mask:0xf bank_mask:0xf
    v_mov_b32_dpp v251, v107 row_newbcast:0 row_mask:0xf bank_mask:0xf
    v_pk_fma_f32 v[104:105], v[212:213], v[248:249], v[104:105] op_sel_hi:[0,1,1]
    v_pk_fma_f32 v[106:107], v[212:213], v[250:251], v[106:107] op_sel_hi:[0,1,1]
    v_pk_fma_f32 v[108:109], v[216:217], v[248:249], v[108:109] op_sel_hi:[0,1,1]
    v_pk_fma_f32 v[110:111], v[216:217], v[250:251], v[110:111] op_sel_hi:[0,1,1]
    v_pk_mul_f32 v[104:105], v[104:105], v[214:215] op_sel_hi:[1,0]
    v_pk_mul_f32 v[106:107], v[106:107], v[214:215] op_sel_hi:[1,0]
    v_pk_mul_f32 v[108:109], v[108:109], v[218:219] op_sel_hi:[1,0]
    v_pk_mul_f32 v[110:111], v[110:111], v[218:219] op_sel_hi:[1,0]
    v_cvt_pk_bf16_f32 v104, v104, v105
    v_cvt_pk_bf16_f32 v105, v106, v107
    ds_write_b64 v47, v[104:105] offset:0
    v_cvt_pk_bf16_f32 v108, v108, v109
    v_cvt_pk_bf16_f32 v109, v110, v111
    ds_write_b64 v47, v[108:109] offset:2176
    s_waitcnt lgkmcnt(6)
    v_mfma_f32_16x16x16_bf16 v[168:171], v[84:85], v[64:65], v[32:35]
    v_mfma_f32_16x16x16_bf16 v[48:51], v[80:81], v[64:65], v[36:39]
    s_waitcnt lgkmcnt(4)
    v_mfma_f32_16x16x16_bf16 v[172:175], v[88:89], v[68:69], v[32:35]
    v_mfma_f32_16x16x16_bf16 v[52:55], v[84:85], v[68:69], v[36:39]
    s_waitcnt lgkmcnt(2)
    v_mfma_f32_16x16x16_bf16 v[176:179], v[92:93], v[72:73], v[32:35]
    v_mfma_f32_16x16x16_bf16 v[56:59], v[88:89], v[72:73], v[36:39]
AC_J:
    ds_read_b32 v27, v3
    ds_read2st64_b32 v[36:37], v26 offset1:1
    ds_read2st64_b32 v[38:39], v26 offset0:2 offset1:3
    v_max_f32 v168, v168, v48
    v_max_f32 v169, v169, v49
    v_max_f32 v170, v170, v50
    v_max_f32 v171, v171, v51
    v_max_f32 v172, v172, v52
    v_max_f32 v173, v173, v53
    v_max_f32 v174, v174, v54
    v_max_f32 v175, v175, v55
    v_max_f32 v176, v176, v56
    v_max_f32 v177, v177, v57
    v_max_f32 v178, v178, v58
    v_max_f32 v179, v179, v59
    s_cmp_lg_u32 s13, 1
    s_cbranch_scc1 AC_NS
    v_cvt_pk_bf16_f32 v64, v168, v169
    v_mov_b32 v65, s52
    v_cvt_pk_bf16_f32 v66, v170, v171
    v_mov_b32 v67, s52
    buffer_store_dwordx4 v[64:67], v6, s[28:31], s11 offen offset:0 sc1
    v_cvt_pk_bf16_f32 v68, v172, v173
    v_mov_b32 v69, s52
    v_cvt_pk_bf16_f32 v70, v174, v175
    v_mov_b32 v71, s52
    buffer_store_dwordx4 v[68:71], v6, s[28:31], s11 offen offset:1024 sc1
    v_cvt_pk_bf16_f32 v72, v176, v177
    v_mov_b32 v73, s52
    v_cvt_pk_bf16_f32 v74, v178, v179
    v_mov_b32 v75, s52
    buffer_store_dwordx4 v[72:75], v6, s[28:31], s11 offen offset:2048 sc1
AC_NS:
    v_pk_fma_f32 v[112:113], v[220:221], v[248:249], v[112:113] op_sel_hi:[0,1,1]
    v_pk_fma_f32 v[114:115], v[220:221], v[250:251], v[114:115] op_sel_hi:[0,1,1]
    v_pk_fma_f32 v[116:117], v[224:225], v[248:249], v[116:117] op_sel_hi:[0,1,1]
    v_pk_fma_f32 v[118:119], v[224:225], v[250:251], v[118:119] op_sel_hi:[0,1,1]
    v_pk_mul_f32 v[112:113], v[112:113], v[222:223] op_sel_hi:[1,0]
    v_pk_mul_f32 v[114:115], v[114:115], v[222:223] op_sel_hi:[1,0]
    v_pk_mul_f32 v[116:117], v[116:117], v[226:227] op_sel_hi:[1,0]
    v_pk_mul_f32 v[118:119], v[118:119], v[226:227] op_sel_hi:[1,0]
    v_cvt_pk_bf16_f32 v112, v112, v113
    v_cvt_pk_bf16_f32 v113, v114, v115
    ds_write_b64 v47, v[112:113] offset:4352
    v_cvt_pk_bf16_f32 v116, v116, v117
    v_cvt_pk_bf16_f32 v117, v118, v119
    ds_write_b64 v47, v[116:117] offset:6528
    v_pk_fma_f32 v[120:121], v[228:229], v[248:249], v[120:121] op_sel_hi:[0,1,1]
    v_pk_fma_f32 v[122:123], v[228:229], v[250:251], v[122:123] op_sel_hi:[0,1,1]
    v_pk_fma_f32 v[124:125], v[232:233], v[248:249], v[124:125] op_sel_hi:[0,1,1]
    v_pk_fma_f32 v[126:127], v[232:233], v[250:251], v[126:127] op_sel_hi:[0,1,1]
    v_pk_mul_f32 v[120:121], v[120:121], v[230:231] op_sel_hi:[1,0]
    v_pk_mul_f32 v[122:123], v[122:123], v[230:231] op_sel_hi:[1,0]
    v_pk_mul_f32 v[124:125], v[124:125], v[234:235] op_sel_hi:[1,0]
    v_pk_mul_f32 v[126:127], v[126:127], v[234:235] op_sel_hi:[1,0]
    v_cvt_pk_bf16_f32 v120, v120, v121
    v_cvt_pk_bf16_f32 v121, v122, v123
    ds_write_b64 v47, v[120:121] offset:8704
    v_cvt_pk_bf16_f32 v124, v124, v125
    v_cvt_pk_bf16_f32 v125, v126, v127
    ds_write_b64 v47, v[124:125] offset:10880
    v_pk_fma_f32 v[128:129], v[236:237], v[248:249], v[128:129] op_sel_hi:[0,1,1]
    v_pk_fma_f32 v[130:131], v[236:237], v[250:251], v[130:131] op_sel_hi:[0,1,1]
    v_pk_mul_f32 v[128:129], v[128:129], v[238:239] op_sel_hi:[1,0]
    v_pk_mul_f32 v[130:131], v[130:131], v[238:239] op_sel_hi:[1,0]
    v_cvt_pk_bf16_f32 v128, v128, v129
    v_cvt_pk_bf16_f32 v129, v130, v131
    ds_write_b64 v47, v[128:129] offset:13056
    s_waitcnt lgkmcnt(0)
    s_barrier
    ds_read_b64_tr_b16 v[184:185], v22 offset:0
    ds_read_b64_tr_b16 v[194:195], v23 offset:0
    ds_read_b64_tr_b16 v[186:187], v22 offset:2176
    ds_read_b64_tr_b16 v[196:197], v23 offset:2176
    ds_read_b64_tr_b16 v[188:189], v22 offset:4352
    ds_read_b64_tr_b16 v[198:199], v23 offset:4352
    ds_read_b64_tr_b16 v[190:191], v22 offset:6528
    ds_read_b64_tr_b16 v[200:201], v23 offset:6528
    s_cbranch_scc0 AC_X
AC_SM:
    v_max3_f32 v136, v168, v169, v170
    v_max3_f32 v138, v172, v173, v174
    v_max3_f32 v140, v176, v177, v178
    v_max_f32 v136, v136, v171
    v_max_f32 v138, v138, v175
    v_max_f32 v140, v140, v179
    s_nop 1
    v_permlane32_swap_b32 v136, v140
    v_permlane32_swap_b32 v138, v142
    v_max_f32 v136, v136, v140
    v_max_f32 v138, v138, v142
    v_mul_f32 v27, 0x3ea52b5c, v27
    s_nop 0
    v_permlane16_swap_b32 v136, v138
    v_max_f32 v136, v136, v138
    v_mul_f32 v138, v136, v27
    v_mul_f32 v136, v136, v27
    v_mul_f32 v32, 0x3ea52b5c, v36
    v_mul_f32 v34, 0x3ea52b5c, v37
    v_permlane16_swap_b32 v136, v138
    v_mov_b32 v140, v136
    v_mov_b32 v142, v138
    v_mul_f32 v36, 0x3ea52b5c, v38
    v_permlane32_swap_b32 v136, v140
    v_permlane32_swap_b32 v138, v142
    v_pk_fma_f32 v[168:169], v[168:169], v[32:33], v[136:137] op_sel_hi:[1,0,0] neg_lo:[0,0,1] neg_hi:[0,0,1]
    v_pk_fma_f32 v[170:171], v[170:171], v[32:33], v[136:137] op_sel_hi:[1,0,0] neg_lo:[0,0,1] neg_hi:[0,0,1]
    v_pk_fma_f32 v[172:173], v[172:173], v[34:35], v[138:139] op_sel_hi:[1,0,0] neg_lo:[0,0,1] neg_hi:[0,0,1]
    v_pk_fma_f32 v[174:175], v[174:175], v[34:35], v[138:139] op_sel_hi:[1,0,0] neg_lo:[0,0,1] neg_hi:[0,0,1]
    v_pk_fma_f32 v[176:177], v[176:177], v[36:37], v[140:141] op_sel_hi:[1,0,0] neg_lo:[0,0,1] neg_hi:[0,0,1]
    v_pk_fma_f32 v[178:179], v[178:179], v[36:37], v[140:141] op_sel_hi:[1,0,0] neg_lo:[0,0,1] neg_hi:[0,0,1]
    v_exp_f32 v168, v168
    v_exp_f32 v169, v169
    v_exp_f32 v170, v170
    v_exp_f32 v171, v171
    v_cvt_pk_bf16_f32 v2, v168, v169
    v_cvt_pk_bf16_f32 v3, v170, v171
    v_bfi_b32 v168, v40, 0, v2
    v_bfi_b32 v169, v41, 0, v3
    v_and_b32 v170, v40, v2
    v_and_b32 v171, v41, v3
    s_waitcnt lgkmcnt(0)
    v_exp_f32 v172, v172
    v_mfma_f32_16x16x32_bf16 v[116:119], v[28:31], v[168:171], 0
    v_exp_f32 v173, v173
    v_mfma_f32_16x16x32_bf16 v[136:139], v[184:187], v[168:171], 0
    v_exp_f32 v174, v174
    v_mfma_f32_16x16x32_bf16 v[152:155], v[194:197], v[168:171], 0
    v_exp_f32 v175, v175
    v_cvt_pk_bf16_f32 v2, v172, v173
    v_cvt_pk_bf16_f32 v3, v174, v175
    v_bfi_b32 v172, v40, 0, v2
    v_bfi_b32 v173, v41, 0, v3
    v_and_b32 v174, v40, v2
    v_and_b32 v175, v41, v3
    v_rcp_f32 v32, v116
    v_exp_f32 v176, v176
    v_mfma_f32_16x16x32_bf16 v[120:123], v[28:31], v[172:175], 0
    v_exp_f32 v177, v177
    v_mfma_f32_16x16x32_bf16 v[140:143], v[186:189], v[172:175], 0
    v_exp_f32 v178, v178
    v_mfma_f32_16x16x32_bf16 v[156:159], v[196:199], v[172:175], 0
    v_exp_f32 v179, v179
    v_cvt_pk_bf16_f32 v2, v176, v177
    v_cvt_pk_bf16_f32 v3, v178, v179
    v_bfi_b32 v176, v40, 0, v2
    v_bfi_b32 v177, v41, 0, v3
    v_and_b32 v178, v40, v2
    v_and_b32 v179, v41, v3
    v_rcp_f32 v34, v120
    v_mul_f32 v136, v136, v32
    v_mfma_f32_16x16x32_bf16 v[116:119], v[28:31], v[176:179], 0
    v_mul_f32 v137, v137, v32
    v_mfma_f32_16x16x32_bf16 v[144:147], v[188:191], v[176:179], 0
    v_mul_f32 v138, v138, v32
    v_mfma_f32_16x16x32_bf16 v[160:163], v[198:201], v[176:179], 0
    v_mul_f32 v139, v139, v32
    v_cvt_pk_bf16_f32 v136, v136, v137
    v_cvt_pk_bf16_f32 v137, v138, v139
    v_mul_f32 v140, v140, v34
    v_mul_f32 v141, v141, v34
    v_mul_f32 v142, v142, v34
    v_mul_f32 v143, v143, v34
    v_cvt_pk_bf16_f32 v138, v140, v141
    v_cvt_pk_bf16_f32 v139, v142, v143
    v_rcp_f32 v36, v116
    v_permlane32_swap_b32 v136, v138
    v_permlane32_swap_b32 v137, v139
    v_pk_mul_f32 v[144:145], v[144:145], v[36:37] op_sel_hi:[1,0]
    v_pk_mul_f32 v[146:147], v[146:147], v[36:37] op_sel_hi:[1,0]
    v_cvt_pk_bf16_f32 v144, v144, v145
    v_cvt_pk_bf16_f32 v145, v146, v147
    s_mov_b64 exec, s[14:15]
    buffer_store_dwordx4 v[136:139], v24, s[28:31], s9 offen sc1
    s_mov_b64 exec, -1
    v_permlane32_swap_b32 v144, v146
    v_permlane32_swap_b32 v145, v147
    v_pk_mul_f32 v[152:153], v[152:153], v[32:33] op_sel_hi:[1,0]
    v_pk_mul_f32 v[154:155], v[154:155], v[32:33] op_sel_hi:[1,0]
    s_mov_b64 exec, s[16:17]
    buffer_store_dwordx4 v[144:147], v24, s[28:31], s5 offen sc1
    s_lshl_b64 exec, -1, 16
    v_pk_mul_f32 v[152:153], v[156:157], v[34:35] op_sel_hi:[1,0]
    v_pk_mul_f32 v[154:155], v[158:159], v[34:35] op_sel_hi:[1,0]
    s_lshl_b64 exec, -1, 32
    v_pk_mul_f32 v[152:153], v[160:161], v[36:37] op_sel_hi:[1,0]
    v_pk_mul_f32 v[154:155], v[162:163], v[36:37] op_sel_hi:[1,0]
    s_mov_b64 exec, s[18:19]
    v_cvt_pk_bf16_f32 v152, v152, v153
    v_cvt_pk_bf16_f32 v153, v154, v155
    buffer_store_dwordx2 v[152:153], v25, s[28:31], s10 offen sc1
    s_mov_b64 exec, -1
A_DONE:
TC1:
    s_cbranch_execz TC2
    s_cmp_lg_u32 s13, 0
    s_cbranch_scc1 P_TAIL
    s_setprio 1
    v_mov_b32 v2, 1
    ds_write_b8 v18, v2 offset:0
    s_cmp_eq_u32 s101, 0
    s_cbranch_scc1 K_END
    v_xor_b32 v28, 32, v8
    v_xor_b32 v29, 64, v8
    v_xor_b32 v30, 96, v8
    ds_read_b64 v[48:49], v8 offset:0
    ds_read_b64 v[50:51], v28 offset:0
    ds_read_b64 v[52:53], v29 offset:0
    ds_read_b64 v[54:55], v30 offset:0
    ds_read_b64 v[56:57], v8 offset:2048
    ds_read_b64 v[58:59], v28 offset:2048
    ds_read_b64 v[60:61], v29 offset:2048
    ds_read_b64 v[62:63], v30 offset:2048
    s_cmp_eq_u32 s101, 2
    s_cselect_b32 s60, 0, 2146435072
    s_add_u32 s60, s60, 20480
    v_add_u32 v31, s60, v6
    s_mov_b32 s100, 0
    v_xor_b32 v28, 32, v9
    v_xor_b32 v29, 64, v9
    v_xor_b32 v30, 96, v9
    ds_read_b64_tr_b16 v[160:161], v9 offset:0
    ds_read_b64_tr_b16 v[164:165], v28 offset:0
    ds_read_b64_tr_b16 v[168:169], v29 offset:0
    ds_read_b64_tr_b16 v[172:173], v30 offset:0
    ds_read_b64_tr_b16 v[162:163], v9 offset:1024
    ds_read_b64_tr_b16 v[166:167], v28 offset:1024
    ds_read_b64_tr_b16 v[170:171], v29 offset:1024
    ds_read_b64_tr_b16 v[174:175], v30 offset:1024
    s_waitcnt lgkmcnt(8)
    v_lshlrev_b32 v64, 16, v48
    ds_read_b64_tr_b16 v[176:177], v29 offset:7680
    v_and_b32 v65, 0xffff0000, v48
    ds_read_b64_tr_b16 v[180:181], v30 offset:7680
    v_lshlrev_b32 v66, 16, v49
    ds_read_b64_tr_b16 v[184:185], v9 offset:7680
    v_and_b32 v67, 0xffff0000, v49
    ds_read_b64_tr_b16 v[188:189], v28 offset:7680
    v_lshlrev_b32 v68, 16, v50
    ds_read_b64_tr_b16 v[178:179], v29 offset:8704
    v_and_b32 v69, 0xffff0000, v50
    ds_read_b64_tr_b16 v[182:183], v30 offset:8704
    v_lshlrev_b32 v70, 16, v51
    ds_read_b64_tr_b16 v[186:187], v9 offset:8704
    v_and_b32 v71, 0xffff0000, v51
    ds_read_b64_tr_b16 v[190:191], v28 offset:8704
    v_lshlrev_b32 v72, 16, v52
    ds_read_b64_tr_b16 v[192:193], v9 offset:15360
    v_and_b32 v73, 0xffff0000, v52
    ds_read_b64_tr_b16 v[196:197], v28 offset:15360
    v_lshlrev_b32 v74, 16, v53
    ds_read_b64_tr_b16 v[200:201], v29 offset:15360
    v_and_b32 v75, 0xffff0000, v53
    ds_read_b64_tr_b16 v[204:205], v30 offset:15360
    v_lshlrev_b32 v76, 16, v54
    ds_read_b64_tr_b16 v[194:195], v9 offset:16384
    v_and_b32 v77, 0xffff0000, v54
    ds_read_b64_tr_b16 v[198:199], v28 offset:16384
    v_lshlrev_b32 v78, 16, v55
    ds_read_b64_tr_b16 v[202:203], v29 offset:16384
    v_and_b32 v79, 0xffff0000, v55
    ds_read_b64_tr_b16 v[206:207], v30 offset:16384
    v_lshlrev_b32 v80, 16, v56
    ds_read_b64_tr_b16 v[208:209], v29 offset:23040
    v_and_b32 v81, 0xffff0000, v56
    ds_read_b64_tr_b16 v[212:213], v30 offset:23040
    v_lshlrev_b32 v82, 16, v57
    ds_read_b64_tr_b16 v[216:217], v9 offset:23040
    v_and_b32 v83, 0xffff0000, v57
    ds_read_b64_tr_b16 v[220:221], v28 offset:23040
    v_lshlrev_b32 v84, 16, v58
    ds_read_b64_tr_b16 v[210:211], v29 offset:24064
    v_and_b32 v85, 0xffff0000, v58
    ds_read_b64_tr_b16 v[214:215], v30 offset:24064
    v_lshlrev_b32 v86, 16, v59
    ds_read_b64_tr_b16 v[218:219], v9 offset:24064
    v_and_b32 v87, 0xffff0000, v59
    ds_read_b64_tr_b16 v[222:223], v28 offset:24064
    v_lshlrev_b32 v88, 16, v60
    ds_read_b64_tr_b16 v[224:225], v9 offset:30720
    v_and_b32 v89, 0xffff0000, v60
    ds_read_b64_tr_b16 v[228:229], v28 offset:30720
    v_lshlrev_b32 v90, 16, v61
    ds_read_b64_tr_b16 v[232:233], v29 offset:30720
    v_and_b32 v91, 0xffff0000, v61
    ds_read_b64_tr_b16 v[236:237], v30 offset:30720
    v_lshlrev_b32 v92, 16, v62
    ds_read_b64_tr_b16 v[226:227], v9 offset:31744
    v_and_b32 v93, 0xffff0000, v62
    ds_read_b64_tr_b16 v[230:231], v28 offset:31744
    v_lshlrev_b32 v94, 16, v63
    ds_read_b64_tr_b16 v[234:235], v29 offset:31744
    v_and_b32 v95, 0xffff0000, v63
    ds_read_b64_tr_b16 v[238:239], v30 offset:31744
    v_xor_b32 v28, 32, v10
    v_xor_b32 v29, 64, v10
    v_xor_b32 v30, 96, v10
    ds_read_b64_tr_b16 v[240:241], v10 offset:0
    ds_read_b64_tr_b16 v[244:245], v28 offset:0
    ds_read_b64_tr_b16 v[248:249], v29 offset:0
    ds_read_b64_tr_b16 v[252:253], v30 offset:0
    ds_read_b64_tr_b16 v[242:243], v10 offset:1024
    ds_read_b64_tr_b16 v[246:247], v28 offset:1024
    ds_read_b64_tr_b16 v[250:251], v29 offset:1024
    ds_read_b64_tr_b16 v[254:255], v30 offset:1024
    s_cmp_lt_u32 s3, 4
    s_cbranch_scc1 G_NOS
    s_sleep 6
G_NOS:
    s_sleep 6
    buffer_load_dwordx4 v[96:99], v0, s[28:31], s96 offen offset:0 sc1
    buffer_load_dwordx4 v[100:103], v31, s[28:31], s96 offen offset:0 sc1
    buffer_load_dwordx4 v[104:107], v0, s[28:31], s96 offen offset:1024 sc1
    buffer_load_dwordx4 v[108:111], v31, s[28:31], s96 offen offset:1024 sc1
    buffer_load_dwordx4 v[112:115], v0, s[28:31], s96 offen offset:2048 sc1
    buffer_load_dwordx4 v[116:119], v31, s[28:31], s96 offen offset:2048 sc1
    buffer_load_dwordx4 v[120:123], v0, s[28:31], s96 offen offset:3072 sc1
    buffer_load_dwordx4 v[124:127], v31, s[28:31], s96 offen offset:3072 sc1
    buffer_load_dwordx4 v[128:131], v0, s[28:31], s92 offen offset:0 sc1
    buffer_load_dwordx4 v[132:135], v31, s[28:31], s92 offen offset:0 sc1
    s_waitcnt vmcnt(8)
    v_max3_u32 v2, v96, v98, v100
    v_max_u32 v2, v2, v102
    v_cmp_eq_u32 vcc, -1, v2
    s_waitcnt lgkmcnt(15)
    s_cbranch_vccnz G2_R0
G2_OK0:
    v_mfma_f32_16x16x32_bf16 v[32:35], v[160:163], v[96:99], 0
    ds_read_b64 v[24:25], v19 offset:16
    buffer_load_dwordx4 v[136:139], v0, s[28:31], s92 offen offset:1024 sc1
    v_mfma_f32_16x16x32_bf16 v[48:51], v[160:163], v[100:103], 0
    buffer_load_dwordx4 v[140:143], v31, s[28:31], s92 offen offset:1024 sc1
    v_mfma_f32_16x16x32_bf16 v[36:39], v[164:167], v[96:99], 0
    v_mfma_f32_16x16x32_bf16 v[52:55], v[164:167], v[100:103], 0
    s_waitcnt vmcnt(8)
    v_max3_u32 v2, v104, v106, v108
    v_mfma_f32_16x16x32_bf16 v[40:43], v[168:171], v[96:99], 0
    v_max_u32 v2, v2, v110
    v_mfma_f32_16x16x32_bf16 v[56:59], v[168:171], v[100:103], 0
    v_cmp_eq_u32 vcc, -1, v2
    v_mfma_f32_16x16x32_bf16 v[44:47], v[172:175], v[96:99], 0
    s_waitcnt lgkmcnt(0)
    v_mfma_f32_16x16x32_bf16 v[60:63], v[172:175], v[100:103], 0
    s_cbranch_vccnz G2_R1
G2_OK1:
    v_mfma_f32_16x16x32_bf16 v[32:35], v[176:179], v[104:107], v[32:35]
    v_xor_b32 v28, 32, v11
    v_xor_b32 v29, 64, v11
    v_and_b32 v3, v24, v25
    v_cmp_ne_u32 vcc, 0x01010101, v3
    v_mfma_f32_16x16x32_bf16 v[48:51], v[176:179], v[108:111], v[48:51]
    v_xor_b32 v30, 96, v11
    s_cbranch_vccnz G2_ZAR
G2_ZAOK:
    v_mfma_f32_16x16x32_bf16 v[36:39], v[180:183], v[104:107], v[36:39]
    ds_read_b64_tr_b16 v[160:161], v11 offset:0
    ds_read_b64_tr_b16 v[164:165], v28 offset:0
    buffer_load_dwordx4 v[144:147], v0, s[28:31], s92 offen offset:2048 sc1
    v_mfma_f32_16x16x32_bf16 v[52:55], v[180:183], v[108:111], v[52:55]
    ds_read_b64_tr_b16 v[168:169], v29 offset:0
    buffer_load_dwordx4 v[148:151], v31, s[28:31], s92 offen offset:2048 sc1
    s_waitcnt vmcnt(8)
    v_max3_u32 v2, v112, v114, v116
    v_mfma_f32_16x16x32_bf16 v[40:43], v[184:187], v[104:107], v[40:43]
    ds_read_b64_tr_b16 v[172:173], v30 offset:0
    v_max_u32 v2, v2, v118
    v_mfma_f32_16x16x32_bf16 v[56:59], v[184:187], v[108:111], v[56:59]
    ds_read_b64_tr_b16 v[162:163], v11 offset:15360
    ds_read_b64_tr_b16 v[166:167], v28 offset:15360
    v_cmp_eq_u32 vcc, -1, v2
    v_mfma_f32_16x16x32_bf16 v[44:47], v[188:191], v[104:107], v[44:47]
    ds_read_b64_tr_b16 v[170:171], v29 offset:15360
    v_mfma_f32_16x16x32_bf16 v[60:63], v[188:191], v[108:111], v[60:63]
    ds_read_b64_tr_b16 v[174:175], v30 offset:15360
    s_cbranch_vccnz G2_R2
G2_OK2:
    v_mfma_f32_16x16x32_bf16 v[32:35], v[192:195], v[112:115], v[32:35]
    v_add_u32 v9, 40960, v9
    v_xor_b32 v28, 32, v9
    buffer_load_dwordx4 v[152:155], v0, s[28:31], s4 offen offset:0 sc1
    v_mfma_f32_16x16x32_bf16 v[48:51], v[192:195], v[116:119], v[48:51]
    v_xor_b32 v29, 64, v9
    buffer_load_dwordx4 v[156:159], v31, s[28:31], s4 offen offset:0 sc1
    v_mfma_f32_16x16x32_bf16 v[36:39], v[196:199], v[112:115], v[36:39]
    v_xor_b32 v30, 96, v9
    ds_read_b64_tr_b16 v[176:177], v9 offset:0
    v_mfma_f32_16x16x32_bf16 v[52:55], v[196:199], v[116:119], v[52:55]
    ds_read_b64_tr_b16 v[180:181], v28 offset:0
    s_waitcnt vmcnt(8)
    v_max3_u32 v2, v120, v122, v124
    v_mfma_f32_16x16x32_bf16 v[40:43], v[200:203], v[112:115], v[40:43]
    ds_read_b64_tr_b16 v[184:185], v29 offset:0
    ds_read_b64_tr_b16 v[188:189], v30 offset:0
    v_max_u32 v2, v2, v126
    v_mfma_f32_16x16x32_bf16 v[56:59], v[200:203], v[116:119], v[56:59]
    ds_read_b64_tr_b16 v[178:179], v9 offset:1024
    v_cmp_eq_u32 vcc, -1, v2
    v_mfma_f32_16x16x32_bf16 v[44:47], v[204:207], v[112:115], v[44:47]
    ds_read_b64_tr_b16 v[182:183], v28 offset:1024
    ds_read_b64_tr_b16 v[186:187], v29 offset:1024
    v_mfma_f32_16x16x32_bf16 v[60:63], v[204:207], v[116:119], v[60:63]
    ds_read_b64_tr_b16 v[190:191], v30 offset:1024
    s_cbranch_vccnz G2_R3
G2_OK3:
    v_mfma_f32_16x16x32_bf16 v[32:35], v[208:211], v[120:123], v[32:35]
    ds_read_b64_tr_b16 v[192:193], v29 offset:7680
    buffer_load_dwordx4 v[96:99], v0, s[28:31], s4 offen offset:1024 sc1
    v_mfma_f32_16x16x32_bf16 v[48:51], v[208:211], v[124:127], v[48:51]
    ds_read_b64_tr_b16 v[196:197], v30 offset:7680
    buffer_load_dwordx4 v[100:103], v31, s[28:31], s4 offen offset:1024 sc1
    v_mfma_f32_16x16x32_bf16 v[36:39], v[212:215], v[120:123], v[36:39]
    ds_read_b64_tr_b16 v[200:201], v9 offset:7680
    v_mfma_f32_16x16x32_bf16 v[52:55], v[212:215], v[124:127], v[52:55]
    ds_read_b64_tr_b16 v[204:205], v28 offset:7680
    s_waitcnt vmcnt(8)
    v_max3_u32 v2, v128, v130, v132
    v_mfma_f32_16x16x32_bf16 v[40:43], v[216:219], v[120:123], v[40:43]
    ds_read_b64_tr_b16 v[194:195], v29 offset:8704
    v_max_u32 v2, v2, v134
    v_mfma_f32_16x16x32_bf16 v[56:59], v[216:219], v[124:127], v[56:59]
    ds_read_b64_tr_b16 v[198:199], v30 offset:8704
    v_cmp_eq_u32 vcc, -1, v2
    v_mfma_f32_16x16x32_bf16 v[44:47], v[220:223], v[120:123], v[44:47]
    ds_read_b64_tr_b16 v[202:203], v9 offset:8704
    v_mfma_f32_16x16x32_bf16 v[60:63], v[220:223], v[124:127], v[60:63]
    ds_read_b64_tr_b16 v[206:207], v28 offset:8704
    s_cbranch_vccnz G2_R4
G2_OK4:
    v_mfma_f32_16x16x32_bf16 v[32:35], v[224:227], v[128:131], v[32:35]
    ds_read_b64_tr_b16 v[208:209], v9 offset:15360
    buffer_load_dwordx4 v[104:107], v0, s[28:31], s4 offen offset:2048 sc1
    v_mfma_f32_16x16x32_bf16 v[48:51], v[224:227], v[132:135], v[48:51]
    ds_read_b64_tr_b16 v[212:213], v28 offset:15360
    buffer_load_dwordx4 v[108:111], v31, s[28:31], s4 offen offset:2048 sc1
    v_mfma_f32_16x16x32_bf16 v[36:39], v[228:231], v[128:131], v[36:39]
    ds_read_b64_tr_b16 v[216:217], v29 offset:15360
    v_mfma_f32_16x16x32_bf16 v[52:55], v[228:231], v[132:135], v[52:55]
    ds_read_b64_tr_b16 v[220:221], v30 offset:15360
    s_waitcnt vmcnt(8)
    v_max3_u32 v2, v136, v138, v140
    v_mfma_f32_16x16x32_bf16 v[40:43], v[232:235], v[128:131], v[40:43]
    ds_read_b64_tr_b16 v[210:211], v9 offset:16384
    v_max_u32 v2, v2, v142
    v_mfma_f32_16x16x32_bf16 v[56:59], v[232:235], v[132:135], v[56:59]
    ds_read_b64_tr_b16 v[214:215], v28 offset:16384
    v_cmp_eq_u32 vcc, -1, v2
    v_mfma_f32_16x16x32_bf16 v[44:47], v[236:239], v[128:131], v[44:47]
    ds_read_b64_tr_b16 v[218:219], v29 offset:16384
    v_mfma_f32_16x16x32_bf16 v[60:63], v[236:239], v[132:135], v[60:63]
    ds_read_b64_tr_b16 v[222:223], v30 offset:16384
    s_cbranch_vccnz G2_R5
G2_OK5:
    v_mfma_f32_16x16x32_bf16 v[32:35], v[240:243], v[136:139], v[32:35]
    ds_read_b64_tr_b16 v[224:225], v29 offset:23040
    buffer_load_dwordx4 v[112:115], v0, s[28:31], s4 offen offset:3072 sc1
    v_mfma_f32_16x16x32_bf16 v[48:51], v[240:243], v[140:143], v[48:51]
    ds_read_b64_tr_b16 v[228:229], v30 offset:23040
    buffer_load_dwordx4 v[116:119], v31, s[28:31], s4 offen offset:3072 sc1
    v_mfma_f32_16x16x32_bf16 v[36:39], v[244:247], v[136:139], v[36:39]
    ds_read_b64_tr_b16 v[232:233], v9 offset:23040
    v_mfma_f32_16x16x32_bf16 v[52:55], v[244:247], v[140:143], v[52:55]
    ds_read_b64_tr_b16 v[236:237], v28 offset:23040
    s_waitcnt vmcnt(8)
    v_max3_u32 v2, v144, v146, v148
    v_mfma_f32_16x16x32_bf16 v[40:43], v[248:251], v[136:139], v[40:43]
    ds_read_b64_tr_b16 v[226:227], v29 offset:24064
    v_max_u32 v2, v2, v150
    v_mfma_f32_16x16x32_bf16 v[56:59], v[248:251], v[140:143], v[56:59]
    ds_read_b64_tr_b16 v[230:231], v30 offset:24064
    v_cmp_eq_u32 vcc, -1, v2
    v_mfma_f32_16x16x32_bf16 v[44:47], v[252:255], v[136:139], v[44:47]
    ds_read_b64_tr_b16 v[234:235], v9 offset:24064
    s_waitcnt lgkmcnt(15)
    v_mfma_f32_16x16x32_bf16 v[60:63], v[252:255], v[140:143], v[60:63]
    ds_read_b64_tr_b16 v[238:239], v28 offset:24064
    s_cbranch_vccnz G2_R6
G2_OK6:
    v_mfma_f32_16x16x32_bf16 v[32:35], v[160:163], v[144:147], v[32:35]
    ds_read_b64_tr_b16 v[240:241], v9 offset:30720
    buffer_load_dwordx4 v[120:123], v0, s[28:31], s6 offen offset:0 sc1
    v_mfma_f32_16x16x32_bf16 v[48:51], v[160:163], v[148:151], v[48:51]
    ds_read_b64_tr_b16 v[244:245], v28 offset:30720
    buffer_load_dwordx4 v[124:127], v31, s[28:31], s6 offen offset:0 sc1
    v_mfma_f32_16x16x32_bf16 v[36:39], v[164:167], v[144:147], v[36:39]
    ds_read_b64_tr_b16 v[248:249], v29 offset:30720
    v_mfma_f32_16x16x32_bf16 v[52:55], v[164:167], v[148:151], v[52:55]
    ds_read_b64_tr_b16 v[252:253], v30 offset:30720
    s_waitcnt vmcnt(8)
    v_max3_u32 v2, v152, v154, v156
    v_mfma_f32_16x16x32_bf16 v[40:43], v[168:171], v[144:147], v[40:43]
    ds_read_b64_tr_b16 v[242:243], v9 offset:31744
    v_max_u32 v2, v2, v158
    v_mfma_f32_16x16x32_bf16 v[56:59], v[168:171], v[148:151], v[56:59]
    ds_read_b64_tr_b16 v[246:247], v28 offset:31744
    v_cmp_eq_u32 vcc, -1, v2
    v_mfma_f32_16x16x32_bf16 v[44:47], v[172:175], v[144:147], v[44:47]
    ds_read_b64_tr_b16 v[250:251], v29 offset:31744
    s_waitcnt lgkmcnt(15)
    v_mfma_f32_16x16x32_bf16 v[60:63], v[172:175], v[148:151], v[60:63]
    ds_read_b64_tr_b16 v[254:255], v30 offset:31744
    s_cbranch_vccnz G2_R7
G2_OK7:
    v_mfma_f32_16x16x32_bf16 v[32:35], v[176:179], v[152:155], v[32:35]
    ds_read_b64 v[24:25], v19 offset:0
    v_xor_b32 v28, 32, v10
    buffer_load_dwordx4 v[128:131], v0, s[28:31], s6 offen offset:1024 sc1
    v_mfma_f32_16x16x32_bf16 v[48:51], v[176:179], v[156:159], v[48:51]
    v_xor_b32 v29, 64, v10
    buffer_load_dwordx4 v[132:135], v31, s[28:31], s6 offen offset:1024 sc1
    v_mfma_f32_16x16x32_bf16 v[36:39], v[180:183], v[152:155], v[36:39]
    v_xor_b32 v30, 96, v10
    ds_read_b64_tr_b16 v[160:161], v10 offset:40960
    v_mfma_f32_16x16x32_bf16 v[52:55], v[180:183], v[156:159], v[52:55]
    ds_read_b64_tr_b16 v[164:165], v28 offset:40960
    s_waitcnt vmcnt(8)
    v_max3_u32 v2, v96, v98, v100
    v_mfma_f32_16x16x32_bf16 v[40:43], v[184:187], v[152:155], v[40:43]
    ds_read_b64_tr_b16 v[168:169], v29 offset:40960
    ds_read_b64_tr_b16 v[172:173], v30 offset:40960
    v_max_u32 v2, v2, v102
    v_mfma_f32_16x16x32_bf16 v[56:59], v[184:187], v[156:159], v[56:59]
    ds_read_b64_tr_b16 v[162:163], v10 offset:41984
    v_cmp_eq_u32 vcc, -1, v2
    v_mfma_f32_16x16x32_bf16 v[44:47], v[188:191], v[152:155], v[44:47]
    ds_read_b64_tr_b16 v[166:167], v28 offset:41984
    ds_read_b64_tr_b16 v[170:171], v29 offset:41984
    s_waitcnt lgkmcnt(7)
    v_mfma_f32_16x16x32_bf16 v[60:63], v[188:191], v[156:159], v[60:63]
    ds_read_b64_tr_b16 v[174:175], v30 offset:41984
    s_cbranch_vccnz G2_R8
G2_OK8:
    v_mfma_f32_16x16x32_bf16 v[32:35], v[192:195], v[96:99], v[32:35]
    v_xor_b32 v28, 32, v11
    v_xor_b32 v29, 64, v11
    v_and_b32 v3, v24, v25
    v_cmp_ne_u32 vcc, 0x01010101, v3
    v_mfma_f32_16x16x32_bf16 v[48:51], v[192:195], v[100:103], v[48:51]
    v_xor_b32 v30, 96, v11
    s_cbranch_vccnz G2_ZLR
G2_ZLOK:
    v_mfma_f32_16x16x32_bf16 v[36:39], v[196:199], v[96:99], v[36:39]
    ds_read_b64_tr_b16 v[176:177], v11 offset:40960
    ds_read_b64_tr_b16 v[180:181], v28 offset:40960
    buffer_load_dwordx4 v[136:139], v0, s[28:31], s6 offen offset:2048 sc1
    v_mfma_f32_16x16x32_bf16 v[52:55], v[196:199], v[100:103], v[52:55]
    ds_read_b64_tr_b16 v[184:185], v29 offset:40960
    buffer_load_dwordx4 v[140:143], v31, s[28:31], s6 offen offset:2048 sc1
    s_waitcnt vmcnt(8)
    v_max3_u32 v2, v104, v106, v108
    v_mfma_f32_16x16x32_bf16 v[40:43], v[200:203], v[96:99], v[40:43]
    ds_read_b64_tr_b16 v[188:189], v30 offset:40960
    v_max_u32 v2, v2, v110
    v_mfma_f32_16x16x32_bf16 v[56:59], v[200:203], v[100:103], v[56:59]
    ds_read_b64_tr_b16 v[178:179], v11 offset:56320
    ds_read_b64_tr_b16 v[182:183], v28 offset:56320
    v_cmp_eq_u32 vcc, -1, v2
    v_mfma_f32_16x16x32_bf16 v[44:47], v[204:207], v[96:99], v[44:47]
    ds_read_b64_tr_b16 v[186:187], v29 offset:56320
    v_mfma_f32_16x16x32_bf16 v[60:63], v[204:207], v[100:103], v[60:63]
    ds_read_b64_tr_b16 v[190:191], v30 offset:56320
    s_cbranch_vccnz G2_R9
G2_OK9:
    v_mfma_f32_16x16x32_bf16 v[32:35], v[208:211], v[104:107], v[32:35]
    v_xor_b32 v28, 32, v13
    v_xor_b32 v29, 64, v13
    v_mfma_f32_16x16x32_bf16 v[48:51], v[208:211], v[108:111], v[48:51]
    v_xor_b32 v30, 96, v13
    v_mfma_f32_16x16x32_bf16 v[36:39], v[212:215], v[104:107], v[36:39]
    ds_read_b64_tr_b16 v[192:193], v13 offset:0
    ds_read_b64_tr_b16 v[196:197], v28 offset:0
    v_mfma_f32_16x16x32_bf16 v[52:55], v[212:215], v[108:111], v[52:55]
    ds_read_b64_tr_b16 v[200:201], v29 offset:0
    s_waitcnt vmcnt(6)
    v_max3_u32 v2, v112, v114, v116
    v_mfma_f32_16x16x32_bf16 v[40:43], v[216:219], v[104:107], v[40:43]
    ds_read_b64_tr_b16 v[204:205], v30 offset:0
    v_max_u32 v2, v2, v118
    v_mfma_f32_16x16x32_bf16 v[56:59], v[216:219], v[108:111], v[56:59]
    ds_read_b64_tr_b16 v[194:195], v13 offset:1024
    ds_read_b64_tr_b16 v[198:199], v28 offset:1024
    v_cmp_eq_u32 vcc, -1, v2
    v_mfma_f32_16x16x32_bf16 v[44:47], v[220:223], v[104:107], v[44:47]
    ds_read_b64_tr_b16 v[202:203], v29 offset:1024
    v_mfma_f32_16x16x32_bf16 v[60:63], v[220:223], v[108:111], v[60:63]
    ds_read_b64_tr_b16 v[206:207], v30 offset:1024
    s_cbranch_vccnz G2_R10
G2_OK10:
    v_mfma_f32_16x16x32_bf16 v[32:35], v[224:227], v[112:115], v[32:35]
    ds_read_b64_tr_b16 v[208:209], v13 offset:40960
    v_mfma_f32_16x16x32_bf16 v[48:51], v[224:227], v[116:119], v[48:51]
    ds_read_b64_tr_b16 v[212:213], v28 offset:40960
    v_mfma_f32_16x16x32_bf16 v[36:39], v[228:231], v[112:115], v[36:39]
    ds_read_b64_tr_b16 v[216:217], v29 offset:40960
    v_mfma_f32_16x16x32_bf16 v[52:55], v[228:231], v[116:119], v[52:55]
    ds_read_b64_tr_b16 v[220:221], v30 offset:40960
    s_waitcnt vmcnt(4)
    v_max3_u32 v2, v120, v122, v124
    v_mfma_f32_16x16x32_bf16 v[40:43], v[232:235], v[112:115], v[40:43]
    ds_read_b64_tr_b16 v[210:211], v13 offset:41984
    v_max_u32 v2, v2, v126
    v_mfma_f32_16x16x32_bf16 v[56:59], v[232:235], v[116:119], v[56:59]
    ds_read_b64_tr_b16 v[214:215], v28 offset:41984
    v_cmp_eq_u32 vcc, -1, v2
    v_mfma_f32_16x16x32_bf16 v[44:47], v[236:239], v[112:115], v[44:47]
    ds_read_b64_tr_b16 v[218:219], v29 offset:41984
    v_mfma_f32_16x16x32_bf16 v[60:63], v[236:239], v[116:119], v[60:63]
    ds_read_b64_tr_b16 v[222:223], v30 offset:41984
    s_cbranch_vccnz G2_R11
G2_OK11:
    v_mfma_f32_16x16x32_bf16 v[32:35], v[240:243], v[120:123], v[32:35]
    v_xor_b32 v28, 32, v14
    v_xor_b32 v29, 64, v14
    buffer_load_dwordx4 v[144:147], v0, s[28:31], s93 offen offset:0 sc1
    buffer_load_dwordx4 v[148:151], v31, s[28:31], s93 offen offset:0 sc1
    v_mfma_f32_16x16x32_bf16 v[48:51], v[240:243], v[124:127], v[48:51]
    v_xor_b32 v30, 96, v14
    buffer_load_dwordx4 v[152:155], v0, s[28:31], s7 offen offset:0 sc1
    buffer_load_dwordx4 v[156:159], v31, s[28:31], s7 offen offset:0 sc1
    v_mfma_f32_16x16x32_bf16 v[36:39], v[244:247], v[120:123], v[36:39]
    ds_read_b64_tr_b16 v[224:225], v14 offset:0
    ds_read_b64_tr_b16 v[228:229], v28 offset:0
    v_mfma_f32_16x16x32_bf16 v[52:55], v[244:247], v[124:127], v[52:55]
    ds_read_b64_tr_b16 v[232:233], v29 offset:0
    s_waitcnt vmcnt(6)
    v_max3_u32 v2, v128, v130, v132
    v_mfma_f32_16x16x32_bf16 v[40:43], v[248:251], v[120:123], v[40:43]
    ds_read_b64_tr_b16 v[236:237], v30 offset:0
    v_max_u32 v2, v2, v134
    v_mfma_f32_16x16x32_bf16 v[56:59], v[248:251], v[124:127], v[56:59]
    ds_read_b64_tr_b16 v[226:227], v29 offset:512
    ds_read_b64_tr_b16 v[230:231], v30 offset:512
    v_cmp_eq_u32 vcc, -1, v2
    v_mfma_f32_16x16x32_bf16 v[44:47], v[252:255], v[120:123], v[44:47]
    ds_read_b64_tr_b16 v[234:235], v14 offset:512
    s_waitcnt lgkmcnt(15)
    v_mfma_f32_16x16x32_bf16 v[60:63], v[252:255], v[124:127], v[60:63]
    ds_read_b64_tr_b16 v[238:239], v28 offset:512
    s_cbranch_vccnz G2_R12
G2_OK12:
    v_mfma_f32_16x16x32_bf16 v[32:35], v[160:163], v[128:131], v[32:35]
    ds_read_b64_tr_b16 v[240:241], v14 offset:40960
    buffer_load_dwordx4 v[96:99], v0, s[28:31], s93 offen offset:1024 sc1
    buffer_load_dwordx4 v[100:103], v31, s[28:31], s93 offen offset:1024 sc1
    v_mfma_f32_16x16x32_bf16 v[48:51], v[160:163], v[132:135], v[48:51]
    ds_read_b64_tr_b16 v[244:245], v28 offset:40960
    buffer_load_dwordx4 v[104:107], v0, s[28:31], s7 offen offset:1024 sc1
    buffer_load_dwordx4 v[108:111], v31, s[28:31], s7 offen offset:1024 sc1
    v_mfma_f32_16x16x32_bf16 v[36:39], v[164:167], v[128:131], v[36:39]
    ds_read_b64_tr_b16 v[248:249], v29 offset:40960
    v_mfma_f32_16x16x32_bf16 v[52:55], v[164:167], v[132:135], v[52:55]
    ds_read_b64_tr_b16 v[252:253], v30 offset:40960
    s_waitcnt vmcnt(8)
    v_max3_u32 v2, v136, v138, v140
    v_mfma_f32_16x16x32_bf16 v[40:43], v[168:171], v[128:131], v[40:43]
    ds_read_b64_tr_b16 v[242:243], v29 offset:41472
    v_max_u32 v2, v2, v142
    v_mfma_f32_16x16x32_bf16 v[56:59], v[168:171], v[132:135], v[56:59]
    ds_read_b64_tr_b16 v[246:247], v30 offset:41472
    v_cmp_eq_u32 vcc, -1, v2
    v_mfma_f32_16x16x32_bf16 v[44:47], v[172:175], v[128:131], v[44:47]
    ds_read_b64_tr_b16 v[250:251], v14 offset:41472
    s_waitcnt lgkmcnt(15)
    v_mfma_f32_16x16x32_bf16 v[60:63], v[172:175], v[132:135], v[60:63]
    ds_read_b64_tr_b16 v[254:255], v28 offset:41472
    s_cbranch_vccnz G2_R13
G2_OK13:
    v_mfma_f32_16x16x32_bf16 v[32:35], v[176:179], v[136:139], v[32:35]
    v_xor_b32 v28, 32, v12
    v_xor_b32 v29, 64, v12
    buffer_load_dwordx4 v[112:115], v0, s[28:31], s92 offen offset:3072 sc1
    v_mfma_f32_16x16x32_bf16 v[48:51], v[176:179], v[140:143], v[48:51]
    v_xor_b32 v30, 96, v12
    ds_read_b64_tr_b16 v[160:161], v12 offset:0
    buffer_load_dwordx4 v[116:119], v31, s[28:31], s92 offen offset:3072 sc1
    v_mfma_f32_16x16x32_bf16 v[36:39], v[180:183], v[136:139], v[36:39]
    ds_read_b64_tr_b16 v[164:165], v28 offset:0
    ds_read_b64_tr_b16 v[168:169], v29 offset:0
    v_mfma_f32_16x16x32_bf16 v[52:55], v[180:183], v[140:143], v[52:55]
    ds_read_b64_tr_b16 v[172:173], v30 offset:0
    s_waitcnt vmcnt(8)
    v_max3_u32 v2, v144, v146, v148
    v_mfma_f32_16x16x32_bf16 v[40:43], v[184:187], v[136:139], v[40:43]
    v_xor_b32 v28, 32, v15
    v_xor_b32 v29, 64, v15
    v_max_u32 v2, v2, v150
    v_mfma_f32_16x16x32_bf16 v[56:59], v[184:187], v[140:143], v[56:59]
    v_xor_b32 v30, 96, v15
    ds_read_b64_tr_b16 v[162:163], v15 offset:0
    v_cmp_eq_u32 vcc, -1, v2
    v_mfma_f32_16x16x32_bf16 v[44:47], v[188:191], v[136:139], v[44:47]
    ds_read_b64_tr_b16 v[166:167], v28 offset:0
    ds_read_b64_tr_b16 v[170:171], v29 offset:0
    s_waitcnt lgkmcnt(15)
    v_mfma_f32_16x16x32_bf16 v[60:63], v[188:191], v[140:143], v[60:63]
    ds_read_b64_tr_b16 v[174:175], v30 offset:0
    s_cbranch_vccnz G2_R14
G2_OK14:
    v_mfma_f32_16x16x32_bf16 v[32:35], v[192:195], v[144:147], v[32:35]
    v_xor_b32 v28, 32, v12
    v_xor_b32 v29, 64, v12
    buffer_load_dwordx4 v[120:123], v0, s[28:31], s6 offen offset:3072 sc1
    v_mfma_f32_16x16x32_bf16 v[48:51], v[192:195], v[148:151], v[48:51]
    v_xor_b32 v30, 96, v12
    ds_read_b64_tr_b16 v[176:177], v12 offset:40960
    buffer_load_dwordx4 v[124:127], v31, s[28:31], s6 offen offset:3072 sc1
    v_mfma_f32_16x16x32_bf16 v[36:39], v[196:199], v[144:147], v[36:39]
    ds_read_b64_tr_b16 v[180:181], v28 offset:40960
    ds_read_b64_tr_b16 v[184:185], v29 offset:40960
    v_mfma_f32_16x16x32_bf16 v[52:55], v[196:199], v[148:151], v[52:55]
    ds_read_b64_tr_b16 v[188:189], v30 offset:40960
    s_waitcnt vmcnt(8)
    v_max3_u32 v2, v152, v154, v156
    v_mfma_f32_16x16x32_bf16 v[40:43], v[200:203], v[144:147], v[40:43]
    v_xor_b32 v28, 32, v15
    v_xor_b32 v29, 64, v15
    v_max_u32 v2, v2, v158
    v_mfma_f32_16x16x32_bf16 v[56:59], v[200:203], v[148:151], v[56:59]
    v_xor_b32 v30, 96, v15
    ds_read_b64_tr_b16 v[178:179], v15 offset:40960
    v_cmp_eq_u32 vcc, -1, v2
    v_mfma_f32_16x16x32_bf16 v[44:47], v[204:207], v[144:147], v[44:47]
    ds_read_b64_tr_b16 v[182:183], v28 offset:40960
    ds_read_b64_tr_b16 v[186:187], v29 offset:40960
    s_waitcnt lgkmcnt(15)
    v_mfma_f32_16x16x32_bf16 v[60:63], v[204:207], v[148:151], v[60:63]
    ds_read_b64_tr_b16 v[190:191], v30 offset:40960
    s_cbranch_vccnz G2_R15
G2_OK15:
    v_mfma_f32_16x16x32_bf16 v[32:35], v[208:211], v[152:155], v[32:35]
    v_mfma_f32_16x16x32_bf16 v[48:51], v[208:211], v[156:159], v[48:51]
    v_mfma_f32_16x16x32_bf16 v[36:39], v[212:215], v[152:155], v[36:39]
    v_mfma_f32_16x16x32_bf16 v[52:55], v[212:215], v[156:159], v[52:55]
    s_waitcnt vmcnt(6)
    v_max3_u32 v2, v96, v98, v100
    v_mfma_f32_16x16x32_bf16 v[40:43], v[216:219], v[152:155], v[40:43]
    v_max_u32 v2, v2, v102
    v_mfma_f32_16x16x32_bf16 v[56:59], v[216:219], v[156:159], v[56:59]
    v_cmp_eq_u32 vcc, -1, v2
    v_mfma_f32_16x16x32_bf16 v[44:47], v[220:223], v[152:155], v[44:47]
    s_waitcnt lgkmcnt(15)
    v_mfma_f32_16x16x32_bf16 v[60:63], v[220:223], v[156:159], v[60:63]
    s_cbranch_vccnz G2_R16
G2_OK16:
    v_mfma_f32_16x16x32_bf16 v[32:35], v[224:227], v[96:99], v[32:35]
    v_mfma_f32_16x16x32_bf16 v[48:51], v[224:227], v[100:103], v[48:51]
    v_mfma_f32_16x16x32_bf16 v[36:39], v[228:231], v[96:99], v[36:39]
    v_mfma_f32_16x16x32_bf16 v[52:55], v[228:231], v[100:103], v[52:55]
    s_waitcnt vmcnt(4)
    v_max3_u32 v2, v104, v106, v108
    v_mfma_f32_16x16x32_bf16 v[40:43], v[232:235], v[96:99], v[40:43]
    v_max_u32 v2, v2, v110
    v_mfma_f32_16x16x32_bf16 v[56:59], v[232:235], v[100:103], v[56:59]
    v_cmp_eq_u32 vcc, -1, v2
    v_mfma_f32_16x16x32_bf16 v[44:47], v[236:239], v[96:99], v[44:47]
    s_waitcnt lgkmcnt(15)
    v_mfma_f32_16x16x32_bf16 v[60:63], v[236:239], v[100:103], v[60:63]
    s_cbranch_vccnz G2_R17
G2_OK17:
    v_mfma_f32_16x16x32_bf16 v[32:35], v[240:243], v[104:107], v[32:35]
    v_mfma_f32_16x16x32_bf16 v[48:51], v[240:243], v[108:111], v[48:51]
    v_mfma_f32_16x16x32_bf16 v[36:39], v[244:247], v[104:107], v[36:39]
    v_mfma_f32_16x16x32_bf16 v[52:55], v[244:247], v[108:111], v[52:55]
    s_waitcnt vmcnt(2)
    v_max3_u32 v2, v112, v114, v116
    v_mfma_f32_16x16x32_bf16 v[40:43], v[248:251], v[104:107], v[40:43]
    v_max_u32 v2, v2, v118
    v_mfma_f32_16x16x32_bf16 v[56:59], v[248:251], v[108:111], v[56:59]
    v_cmp_eq_u32 vcc, -1, v2
    v_mfma_f32_16x16x32_bf16 v[44:47], v[252:255], v[104:107], v[44:47]
    s_waitcnt lgkmcnt(8)
    v_mfma_f32_16x16x32_bf16 v[60:63], v[252:255], v[108:111], v[60:63]
    s_cbranch_vccnz G2_R18
G2_OK18:
    v_mfma_f32_16x16x32_bf16 v[32:35], v[160:163], v[112:115], v[32:35]
    ds_read_b64 v[24:25], v19 offset:8
    v_xor_b32 v28, 32, v8
    v_mfma_f32_16x16x32_bf16 v[48:51], v[160:163], v[116:119], v[48:51]
    v_xor_b32 v29, 64, v8
    v_mfma_f32_16x16x32_bf16 v[36:39], v[164:167], v[112:115], v[36:39]
    v_xor_b32 v30, 96, v8
    v_mfma_f32_16x16x32_bf16 v[52:55], v[164:167], v[116:119], v[52:55]
    s_lshl_b32 s60, s8, 11
    s_waitcnt vmcnt(0)
    v_max3_u32 v2, v120, v122, v124
    v_mfma_f32_16x16x32_bf16 v[40:43], v[168:171], v[112:115], v[40:43]
    s_add_u32 s61, s60, 147200
    v_max_u32 v2, v2, v126
    v_mfma_f32_16x16x32_bf16 v[56:59], v[168:171], v[116:119], v[56:59]
    v_add_u32 v17, s61, v6
    v_cmp_eq_u32 vcc, -1, v2
    v_mfma_f32_16x16x32_bf16 v[44:47], v[172:175], v[112:115], v[44:47]
    s_lshl1_add_u32 s60, s60, 81920
    s_waitcnt lgkmcnt(0)
    v_mfma_f32_16x16x32_bf16 v[60:63], v[172:175], v[116:119], v[60:63]
    v_add_u32 v20, s60, v6
    s_cbranch_vccnz G2_R19
G2_OK19:
    v_mfma_f32_16x16x32_bf16 v[32:35], v[176:179], v[120:123], v[32:35]
    v_and_b32 v3, v24, v25
    v_cmp_ne_u32 vcc, 0x01010101, v3
    v_mfma_f32_16x16x32_bf16 v[36:39], v[180:183], v[120:123], v[36:39]
    s_cbranch_vccnz G2_ZGR
G2_ZGOK:
    v_mfma_f32_16x16x32_bf16 v[40:43], v[184:187], v[120:123], v[40:43]
    ds_read_b128 v[192:195], v20 offset:0
    ds_read_b128 v[196:199], v20 offset:1024
    v_mfma_f32_16x16x32_bf16 v[44:47], v[188:191], v[120:123], v[44:47]
    ds_read_b128 v[200:203], v20 offset:2048
    ds_read_b128 v[204:207], v20 offset:3072
    v_mfma_f32_16x16x32_bf16 v[48:51], v[176:179], v[124:127], v[48:51]
    ds_read_b128 v[208:211], v20 offset:4096
    ds_read_b128 v[212:215], v20 offset:5120
    v_mfma_f32_16x16x32_bf16 v[52:55], v[180:183], v[124:127], v[52:55]
    ds_read_b128 v[216:219], v20 offset:6144
    ds_read_b128 v[220:223], v20 offset:7168
    v_mfma_f32_16x16x32_bf16 v[56:59], v[184:187], v[124:127], v[56:59]
    v_mfma_f32_16x16x32_bf16 v[60:63], v[188:191], v[124:127], v[60:63]
    s_waitcnt lgkmcnt(4)
    v_pk_fma_f32 v[64:65], v[32:33], v[192:193], v[64:65]
    v_pk_fma_f32 v[66:67], v[34:35], v[194:195], v[66:67]
    v_pk_fma_f32 v[68:69], v[36:37], v[196:197], v[68:69]
    v_pk_fma_f32 v[70:71], v[38:39], v[198:199], v[70:71]
    v_pk_fma_f32 v[72:73], v[40:41], v[200:201], v[72:73]
    v_pk_fma_f32 v[74:75], v[42:43], v[202:203], v[74:75]
    v_pk_fma_f32 v[76:77], v[44:45], v[204:205], v[76:77]
    v_pk_fma_f32 v[78:79], v[46:47], v[206:207], v[78:79]
    v_cvt_pk_bf16_f32 v96, v64, v65
    v_cvt_pk_bf16_f32 v97, v66, v67
    ds_write_b64 v8, v[96:97] offset:0
    v_cvt_pk_bf16_f32 v98, v68, v69
    v_cvt_pk_bf16_f32 v99, v70, v71
    ds_write_b64 v28, v[98:99] offset:0
    v_cvt_pk_bf16_f32 v100, v72, v73
    v_cvt_pk_bf16_f32 v101, v74, v75
    ds_write_b64 v29, v[100:101] offset:0
    v_cvt_pk_bf16_f32 v102, v76, v77
    v_cvt_pk_bf16_f32 v103, v78, v79
    ds_write_b64 v30, v[102:103] offset:0
    ds_read_b128 v[224:227], v17 offset:0
    ds_read_b128 v[228:231], v17 offset:1024
    s_cmp_eq_u32 s101, 1
    s_cbranch_scc1 G2_ONE
    s_waitcnt lgkmcnt(6)
    v_pk_fma_f32 v[80:81], v[48:49], v[208:209], v[80:81]
    v_pk_fma_f32 v[82:83], v[50:51], v[210:211], v[82:83]
    v_pk_fma_f32 v[84:85], v[52:53], v[212:213], v[84:85]
    v_pk_fma_f32 v[86:87], v[54:55], v[214:215], v[86:87]
    v_pk_fma_f32 v[88:89], v[56:57], v[216:217], v[88:89]
    v_pk_fma_f32 v[90:91], v[58:59], v[218:219], v[90:91]
    v_pk_fma_f32 v[92:93], v[60:61], v[220:221], v[92:93]
    v_pk_fma_f32 v[94:95], v[62:63], v[222:223], v[94:95]
    v_cvt_pk_bf16_f32 v104, v80, v81
    v_cvt_pk_bf16_f32 v105, v82, v83
    ds_write_b64 v8, v[104:105] offset:2048
    v_cvt_pk_bf16_f32 v106, v84, v85
    v_cvt_pk_bf16_f32 v107, v86, v87
    ds_write_b64 v28, v[106:107] offset:2048
    v_cvt_pk_bf16_f32 v108, v88, v89
    v_cvt_pk_bf16_f32 v109, v90, v91
    ds_write_b64 v29, v[108:109] offset:2048
    v_cvt_pk_bf16_f32 v110, v92, v93
    v_cvt_pk_bf16_f32 v111, v94, v95
    ds_write_b64 v30, v[110:111] offset:2048
    ds_read_b128 v[232:235], v17 offset:2048
    ds_read_b128 v[236:239], v17 offset:3072
    s_waitcnt lgkmcnt(7)
    buffer_store_dwordx4 v[224:227], v7, s[44:47], s97 offen sc1
    s_waitcnt lgkmcnt(6)
    buffer_store_dwordx4 v[228:231], v7, s[44:47], s94 offen sc1
    s_add_u32 s94, s94, 20480
    s_waitcnt lgkmcnt(1)
    buffer_store_dwordx4 v[232:235], v7, s[44:47], s94 offen sc1
    s_add_u32 s94, s94, 20480
    s_waitcnt lgkmcnt(0)
    buffer_store_dwordx4 v[236:239], v7, s[44:47], s94 offen sc1
    s_endpgm
G2_ONE:
    s_waitcnt lgkmcnt(1)
    buffer_store_dwordx4 v[224:227], v7, s[44:47], s97 offen sc1
    s_waitcnt lgkmcnt(0)
    buffer_store_dwordx4 v[228:231], v7, s[44:47], s94 offen sc1
    s_endpgm
K_P1:
TC5:
    s_cbranch_execz TC6
    ds_read_b128 v[240:243], v17 offset:0
    ds_read_b128 v[248:251], v17 offset:256
    ds_read_b64 v[48:49], v8 offset:0
    ds_read_b64 v[56:57], v8 offset:2048
    v_xor_b32 v100, 32, v8
    ds_read_b64 v[50:51], v100 offset:0
    ds_read_b64 v[58:59], v100 offset:2048
    v_xor_b32 v100, 64, v8
    ds_read_b64 v[52:53], v100 offset:0
    ds_read_b64 v[60:61], v100 offset:2048
    v_xor_b32 v100, 96, v8
    ds_read_b64 v[54:55], v100 offset:0
    ds_read_b64 v[62:63], v100 offset:2048
    s_waitcnt lgkmcnt(0)
    v_mul_f32 v240, v240, v242
    v_mul_f32 v244, 0xbfb8aa3b, v242
    v_mul_f32 v246, 0xbfb8aa3b, v240
    v_lshlrev_b32 v208, 16, v48
    v_and_b32 v209, 0xffff0000, v48
    v_lshlrev_b32 v210, 16, v49
    v_and_b32 v211, 0xffff0000, v49
    v_lshlrev_b32 v212, 16, v50
    v_and_b32 v213, 0xffff0000, v50
    v_lshlrev_b32 v214, 16, v51
    v_and_b32 v215, 0xffff0000, v51
    v_pk_fma_f32 v[100:101], v[208:209], v[244:245], v[246:247] op_sel_hi:[1,0,0]
    v_pk_fma_f32 v[102:103], v[210:211], v[244:245], v[246:247] op_sel_hi:[1,0,0]
    v_pk_fma_f32 v[104:105], v[212:213], v[244:245], v[246:247] op_sel_hi:[1,0,0]
    v_pk_fma_f32 v[106:107], v[214:215], v[244:245], v[246:247] op_sel_hi:[1,0,0]
    v_pk_fma_f32 v[208:209], v[208:209], v[242:243], v[240:241] op_sel_hi:[1,0,0]
    v_pk_fma_f32 v[210:211], v[210:211], v[242:243], v[240:241] op_sel_hi:[1,0,0]
    v_pk_fma_f32 v[212:213], v[212:213], v[242:243], v[240:241] op_sel_hi:[1,0,0]
    v_pk_fma_f32 v[214:215], v[214:215], v[242:243], v[240:241] op_sel_hi:[1,0,0]
    v_exp_f32 v100, v100
    v_exp_f32 v101, v101
    v_exp_f32 v102, v102
    v_exp_f32 v103, v103
    v_exp_f32 v104, v104
    v_exp_f32 v105, v105
    v_exp_f32 v106, v106
    v_exp_f32 v107, v107
    v_pk_add_f32 v[100:101], v[100:101], 1.0 op_sel_hi:[1,0]
    v_pk_add_f32 v[102:103], v[102:103], 1.0 op_sel_hi:[1,0]
    v_pk_add_f32 v[104:105], v[104:105], 1.0 op_sel_hi:[1,0]
    v_pk_add_f32 v[106:107], v[106:107], 1.0 op_sel_hi:[1,0]
    v_rcp_f32 v100, v100
    v_rcp_f32 v101, v101
    v_rcp_f32 v102, v102
    v_rcp_f32 v103, v103
    v_rcp_f32 v104, v104
    v_rcp_f32 v105, v105
    v_rcp_f32 v106, v106
    v_rcp_f32 v107, v107
    v_pk_mul_f32 v[208:209], v[208:209], v[100:101]
    v_pk_mul_f32 v[210:211], v[210:211], v[102:103]
    v_pk_mul_f32 v[212:213], v[212:213], v[104:105]
    v_pk_mul_f32 v[214:215], v[214:215], v[106:107]
    s_setpc_b64 s[20:21]
K_P2:
    v_lshlrev_b32 v216, 16, v52
    v_and_b32 v217, 0xffff0000, v52
    v_lshlrev_b32 v218, 16, v53
    v_and_b32 v219, 0xffff0000, v53
    v_lshlrev_b32 v220, 16, v54
    v_and_b32 v221, 0xffff0000, v54
    v_lshlrev_b32 v222, 16, v55
    v_and_b32 v223, 0xffff0000, v55
    v_pk_fma_f32 v[100:101], v[216:217], v[244:245], v[246:247] op_sel_hi:[1,0,0]
    v_pk_fma_f32 v[102:103], v[218:219], v[244:245], v[246:247] op_sel_hi:[1,0,0]
    v_pk_fma_f32 v[104:105], v[220:221], v[244:245], v[246:247] op_sel_hi:[1,0,0]
    v_pk_fma_f32 v[106:107], v[222:223], v[244:245], v[246:247] op_sel_hi:[1,0,0]
    v_pk_fma_f32 v[216:217], v[216:217], v[242:243], v[240:241] op_sel_hi:[1,0,0]
    v_pk_fma_f32 v[218:219], v[218:219], v[242:243], v[240:241] op_sel_hi:[1,0,0]
    v_pk_fma_f32 v[220:221], v[220:221], v[242:243], v[240:241] op_sel_hi:[1,0,0]
    v_pk_fma_f32 v[222:223], v[222:223], v[242:243], v[240:241] op_sel_hi:[1,0,0]
    v_exp_f32 v100, v100
    v_exp_f32 v101, v101
    v_exp_f32 v102, v102
    v_exp_f32 v103, v103
    v_exp_f32 v104, v104
    v_exp_f32 v105, v105
    v_exp_f32 v106, v106
    v_exp_f32 v107, v107
    v_pk_add_f32 v[100:101], v[100:101], 1.0 op_sel_hi:[1,0]
    v_pk_add_f32 v[102:103], v[102:103], 1.0 op_sel_hi:[1,0]
    v_pk_add_f32 v[104:105], v[104:105], 1.0 op_sel_hi:[1,0]
    v_pk_add_f32 v[106:107], v[106:107], 1.0 op_sel_hi:[1,0]
    v_rcp_f32 v100, v100
    v_rcp_f32 v101, v101
    v_rcp_f32 v102, v102
    v_rcp_f32 v103, v103
    v_rcp_f32 v104, v104
    v_rcp_f32 v105, v105
    v_rcp_f32 v106, v106
    v_rcp_f32 v107, v107
    v_pk_mul_f32 v[216:217], v[216:217], v[100:101]
    v_pk_mul_f32 v[218:219], v[218:219], v[102:103]
    v_pk_mul_f32 v[220:221], v[220:221], v[104:105]
    v_pk_mul_f32 v[222:223], v[222:223], v[106:107]
    s_setpc_b64 s[20:21]
P_TAIL:
TC6:
    s_cbranch_execz TC7
    s_setprio 0
    v_mov_b32 v2, 1
    ds_write_b8 v18, v2 offset:0
    s_cmp_eq_u32 s13, 1
    s_cbranch_scc1 P_ST
    s_call_b64 s[20:21], K_P1
    s_call_b64 s[20:21], K_P2
P_ST:
    ds_read_b64 v[22:23], v19 offset:40
    s_lshl_b32 s60, s8, 12
    s_add_u32 s60, s60, 81920
    v_add_u32 v20, s60, v6
    s_lshl_b32 s62, s101, 4
    s_mov_b32 s100, 0
    s_waitcnt lgkmcnt(0)
    v_readfirstlane_b32 s90, v22
    v_readfirstlane_b32 s91, v23
    s_lshl_b32 s67, s58, 2
    s_add_u32 s67, s67, 131072
    s_mov_b32 s68, 2
FIX_L:
    v_mov_b32 v45, v49
    v_mov_b32 v46, v50
    v_mov_b32 v47, v51
    v_mov_b32 v49, 114688
    s_not_b32 s60, s90
    s_bfe_u32 s61, s60, 655361
    s_and_b32 s60, s60, 1
    s_lshl_b32 s60, s60, 10
    s_add_u32 s60, s60, s61
    s_sub_u32 s63, s60, s95
    s_cmp_lt_u32 s63, s62
    s_cbranch_scc1 FIX_RUN
FIX_N:
    s_mov_b32 s90, s91
    s_add_u32 s67, s67, 138240
    s_sub_u32 s68, s68, 1
    s_cmp_lg_u32 s68, 0
    s_cbranch_scc1 FIX_L
    s_setprio 0
    s_cmp_lt_u32 s101, 2
    s_cbranch_scc1 P_NOB
    v_mul_f32 v248, v248, v250
    v_mul_f32 v252, 0xbfb8aa3b, v250
    v_mul_f32 v254, 0xbfb8aa3b, v248
    v_lshlrev_b32 v224, 16, v56
    v_and_b32 v225, 0xffff0000, v56
    v_lshlrev_b32 v226, 16, v57
    v_and_b32 v227, 0xffff0000, v57
    v_lshlrev_b32 v228, 16, v58
    v_and_b32 v229, 0xffff0000, v58
    v_lshlrev_b32 v230, 16, v59
    v_and_b32 v231, 0xffff0000, v59
    v_fma_f32 v100, v224, v252, v254
    v_fma_f32 v101, v225, v252, v254
    v_fma_f32 v102, v226, v252, v254
    v_fma_f32 v103, v227, v252, v254
    v_fma_f32 v104, v228, v252, v254
    v_fma_f32 v105, v229, v252, v254
    v_fma_f32 v106, v230, v252, v254
    v_fma_f32 v107, v231, v252, v254
    v_exp_f32 v100, v100
    v_fma_f32 v224, v224, v250, v248
    v_exp_f32 v101, v101
    v_fma_f32 v225, v225, v250, v248
    v_exp_f32 v102, v102
    v_fma_f32 v226, v226, v250, v248
    v_exp_f32 v103, v103
    v_fma_f32 v227, v227, v250, v248
    v_exp_f32 v104, v104
    v_fma_f32 v228, v228, v250, v248
    v_exp_f32 v105, v105
    v_fma_f32 v229, v229, v250, v248
    v_exp_f32 v106, v106
    v_fma_f32 v230, v230, v250, v248
    v_exp_f32 v107, v107
    v_fma_f32 v231, v231, v250, v248
    v_add_f32 v100, 1.0, v100
    v_add_f32 v101, 1.0, v101
    v_add_f32 v102, 1.0, v102
    v_add_f32 v103, 1.0, v103
    v_add_f32 v104, 1.0, v104
    v_add_f32 v105, 1.0, v105
    v_add_f32 v106, 1.0, v106
    v_add_f32 v107, 1.0, v107
    v_rcp_f32 v100, v100
    v_rcp_f32 v101, v101
    v_rcp_f32 v102, v102
    v_rcp_f32 v103, v103
    v_rcp_f32 v104, v104
    v_rcp_f32 v105, v105
    v_rcp_f32 v106, v106
    v_rcp_f32 v107, v107
    v_mul_f32 v224, v224, v100
    v_mul_f32 v225, v225, v101
    v_mul_f32 v226, v226, v102
    v_mul_f32 v227, v227, v103
    v_mul_f32 v228, v228, v104
    v_mul_f32 v229, v229, v105
    v_mul_f32 v230, v230, v106
    v_mul_f32 v231, v231, v107
    v_lshlrev_b32 v232, 16, v60
    v_and_b32 v233, 0xffff0000, v60
    v_lshlrev_b32 v234, 16, v61
    v_and_b32 v235, 0xffff0000, v61
    v_lshlrev_b32 v236, 16, v62
    v_and_b32 v237, 0xffff0000, v62
    v_lshlrev_b32 v238, 16, v63
    v_and_b32 v239, 0xffff0000, v63
    v_fma_f32 v100, v232, v252, v254
    v_fma_f32 v101, v233, v252, v254
    v_fma_f32 v102, v234, v252, v254
    v_fma_f32 v103, v235, v252, v254
    v_fma_f32 v104, v236, v252, v254
    v_fma_f32 v105, v237, v252, v254
    v_fma_f32 v106, v238, v252, v254
    v_fma_f32 v107, v239, v252, v254
    v_exp_f32 v100, v100
    v_fma_f32 v232, v232, v250, v248
    v_exp_f32 v101, v101
    v_fma_f32 v233, v233, v250, v248
    v_exp_f32 v102, v102
    v_fma_f32 v234, v234, v250, v248
    v_exp_f32 v103, v103
    v_fma_f32 v235, v235, v250, v248
    v_exp_f32 v104, v104
    v_fma_f32 v236, v236, v250, v248
    v_exp_f32 v105, v105
    v_fma_f32 v237, v237, v250, v248
    v_exp_f32 v106, v106
    v_fma_f32 v238, v238, v250, v248
    v_exp_f32 v107, v107
    v_fma_f32 v239, v239, v250, v248
    v_add_f32 v100, 1.0, v100
    v_add_f32 v101, 1.0, v101
    v_add_f32 v102, 1.0, v102
    v_add_f32 v103, 1.0, v103
    v_add_f32 v104, 1.0, v104
    v_add_f32 v105, 1.0, v105
    v_add_f32 v106, 1.0, v106
    v_add_f32 v107, 1.0, v107
    v_rcp_f32 v100, v100
    v_rcp_f32 v101, v101
    v_rcp_f32 v102, v102
    v_rcp_f32 v103, v103
    v_rcp_f32 v104, v104
    v_rcp_f32 v105, v105
    v_rcp_f32 v106, v106
    v_rcp_f32 v107, v107
    v_mul_f32 v232, v232, v100
    v_mul_f32 v233, v233, v101
    v_mul_f32 v234, v234, v102
    v_mul_f32 v235, v235, v103
    v_mul_f32 v236, v236, v104
    v_mul_f32 v237, v237, v105
    v_mul_f32 v238, v238, v106
    v_mul_f32 v239, v239, v107
P_NOB:
    s_mov_b32 s100, 0
    ds_read_b64 v[2:3], v19 offset:0
P_Z:
    s_waitcnt lgkmcnt(0)
    v_and_b32 v2, v2, v3
    v_cmp_ne_u32 vcc, 0x01010101, v2
    s_cbranch_vccnz P_ZR
P_ZOK:
    ds_write_b128 v20, v[208:211] offset:0
    ds_write_b128 v20, v[212:215] offset:1024
    ds_write_b128 v20, v[216:219] offset:2048
    ds_write_b128 v20, v[220:223] offset:3072
    ds_write_b128 v20, v[224:227] offset:4096
    ds_write_b128 v20, v[228:231] offset:5120
    ds_write_b128 v20, v[232:235] offset:6144
    ds_write_b128 v20, v[236:239] offset:7168
    s_mov_b32 exec_hi, 0
    ds_write_b64 v49, v[50:51]
    ds_write_b64 v45, v[46:47]
    v_mov_b32 v2, 1
    ds_write_b8 v18, v2 offset:8
    s_endpgm
FIX_RUN:
    s_setprio 3
    v_lshrrev_b32 v48, 5, v1
    v_mul_u32_u24 v48, 4608, v48
    v_add_u32 v48, v48, v6
    v_mov_b32 v116, 0
    v_mov_b32 v117, s52
    v_mov_b32 v118, 0
    v_mov_b32 v119, s52
    s_add_u32 s60, s67, 0
    buffer_load_dwordx4 v[64:67], v48, s[28:31], s60 offen sc1
    s_add_u32 s60, s67, 10240
    buffer_load_dwordx4 v[68:71], v48, s[28:31], s60 offen sc1
    s_add_u32 s60, s67, 20480
    buffer_load_dwordx4 v[72:75], v48, s[28:31], s60 offen sc1
    s_add_u32 s60, s67, 30720
    buffer_load_dwordx4 v[76:79], v48, s[28:31], s60 offen sc1
    s_add_u32 s60, s67, 40960
    buffer_load_dwordx4 v[80:83], v48, s[28:31], s60 offen sc1
    s_add_u32 s60, s67, 51200
    buffer_load_dwordx4 v[84:87], v48, s[28:31], s60 offen sc1
    s_add_u32 s60, s67, 61440
    buffer_load_dwordx4 v[88:91], v48, s[28:31], s60 offen sc1
    s_add_u32 s60, s67, 71680
    buffer_load_dwordx4 v[92:95], v48, s[28:31], s60 offen sc1
    s_add_u32 s60, s67, 81920
    buffer_load_dwordx4 v[96:99], v48, s[28:31], s60 offen sc1
    s_add_u32 s60, s67, 92160
    buffer_load_dwordx4 v[100:103], v48, s[28:31], s60 offen sc1
    s_add_u32 s60, s67, 102400
    buffer_load_dwordx4 v[104:107], v48, s[28:31], s60 offen sc1
    s_add_u32 s60, s67, 112640
    buffer_load_dwordx4 v[108:111], v48, s[28:31], s60 offen sc1
    s_add_u32 s60, s67, 122880
    buffer_load_dwordx4 v[112:115], v48, s[28:31], s60 offen sc1
    s_add_u32 s60, s67, 133120
    s_mov_b32 exec_hi, 0
    buffer_load_dwordx4 v[116:119], v48, s[28:31], s60 offen sc1
    s_mov_b32 exec_hi, -1
    s_lshl4_add_u32 s64, s8, s63
    s_lshl_b32 s60, s64, 4
    s_add_u32 s60, s60, 161536
    v_mov_b32 v2, s60
    ds_read_b96 v[52:54], v2
    v_bfe_u32 v2, v1, 2, 3
    s_and_b32 s60, s64, 7
    v_xor_b32 v2, s60, v2
    v_and_b32 v3, 3, v1
    v_lshl_add_u32 v2, v2, 2, v3
    s_lshl_b32 s60, s64, 7
    s_add_u32 s60, s60, 147200
    v_lshl_add_u32 v2, v2, 2, s60
    ds_read_b32 v50, v2
    s_ashr_i32 s60, s90, 31
    s_orn2_b32 s60, 0x80000000, s60
    s_xor_b32 s60, s60, s90
    s_and_b32 s60, s60, s55
    v_mov_b32 v55, 0xbfb8aa3b
    v_mul_f32 v55, s60, v55
    v_exp_f32 v55, v55
    s_nop 0
    v_add_f32 v55, 1.0, v55
    v_rcp_f32 v55, v55
    s_nop 0
    v_cvt_pk_bf16_f32 v55, v55, v55
    v_lshlrev_b32 v55, 16, v55
    s_lshr_b32 s60, s64, 4
    s_lshl_b32 s60, s60, 12
    s_and_b32 s61, s64, 15
    s_lshl4_add_u32 s60, s61, s60
    s_add_u32 s60, s60, 81920
    v_lshrrev_b32 v49, 1, v1
    v_lshl_add_u32 v49, v49, 8, s60
    v_and_b32 v3, 1, v1
    v_lshl_add_u32 v49, v3, 3, v49
    s_waitcnt lgkmcnt(0)
    v_and_b32 v51, 0xffff0000, v50
    v_lshlrev_b32 v50, 16, v50
    v_add_f32 v50, v50, v52
    v_add_f32 v51, v51, v52
    v_cvt_pk_bf16_f32 v3, v50, v51
    v_lshlrev_b32 v50, 16, v3
    v_and_b32 v51, s55, v3
    v_mul_f32 v50, v50, v54
    v_mul_f32 v51, v51, v54
    v_cvt_pk_bf16_f32 v3, v50, v51
    v_lshlrev_b32 v50, 16, v3
    v_and_b32 v51, s55, v3
    s_waitcnt vmcnt(0)
FIX_Y_CHK:
    v_xor_b32 v2, s52, v65
    v_bitop3_b32 v2, v67, s52, v2 bitop3:0xbe
    v_bitop3_b32 v2, v69, s52, v2 bitop3:0xbe
    v_bitop3_b32 v2, v71, s52, v2 bitop3:0xbe
    v_bitop3_b32 v2, v73, s52, v2 bitop3:0xbe
    v_bitop3_b32 v2, v75, s52, v2 bitop3:0xbe
    v_bitop3_b32 v2, v77, s52, v2 bitop3:0xbe
    v_bitop3_b32 v2, v79, s52, v2 bitop3:0xbe
    v_bitop3_b32 v2, v81, s52, v2 bitop3:0xbe
    v_bitop3_b32 v2, v83, s52, v2 bitop3:0xbe
    v_bitop3_b32 v2, v85, s52, v2 bitop3:0xbe
    v_bitop3_b32 v2, v87, s52, v2 bitop3:0xbe
    v_bitop3_b32 v2, v89, s52, v2 bitop3:0xbe
    v_bitop3_b32 v2, v91, s52, v2 bitop3:0xbe
    v_bitop3_b32 v2, v93, s52, v2 bitop3:0xbe
    v_bitop3_b32 v2, v95, s52, v2 bitop3:0xbe
    v_bitop3_b32 v2, v97, s52, v2 bitop3:0xbe
    v_bitop3_b32 v2, v99, s52, v2 bitop3:0xbe
    v_bitop3_b32 v2, v101, s52, v2 bitop3:0xbe
    v_bitop3_b32 v2, v103, s52, v2 bitop3:0xbe
    v_bitop3_b32 v2, v105, s52, v2 bitop3:0xbe
    v_bitop3_b32 v2, v107, s52, v2 bitop3:0xbe
    v_bitop3_b32 v2, v109, s52, v2 bitop3:0xbe
    v_bitop3_b32 v2, v111, s52, v2 bitop3:0xbe
    v_bitop3_b32 v2, v113, s52, v2 bitop3:0xbe
    v_bitop3_b32 v2, v115, s52, v2 bitop3:0xbe
    v_bitop3_b32 v2, v117, s52, v2 bitop3:0xbe
    v_bitop3_b32 v2, v119, s52, v2 bitop3:0xbe
    v_cmp_ne_u32 vcc, 0, v2
    s_cbranch_vccz FIX_Y_OK
FIX_Y_RETRY:
    s_add_u32 s100, s100, 1
    s_cmp_gt_u32 s100, 20000
    s_cbranch_scc1 FIX_Y_OK
    s_sleep 8
    s_add_u32 s60, s67, 0
    buffer_load_dwordx4 v[64:67], v48, s[28:31], s60 offen sc1
    s_add_u32 s60, s67, 10240
    buffer_load_dwordx4 v[68:71], v48, s[28:31], s60 offen sc1
    s_add_u32 s60, s67, 20480
    buffer_load_dwordx4 v[72:75], v48, s[28:31], s60 offen sc1
    s_add_u32 s60, s67, 30720
    buffer_load_dwordx4 v[76:79], v48, s[28:31], s60 offen sc1
    s_add_u32 s60, s67, 40960
    buffer_load_dwordx4 v[80:83], v48, s[28:31], s60 offen sc1
    s_add_u32 s60, s67, 51200
    buffer_load_dwordx4 v[84:87], v48, s[28:31], s60 offen sc1
    s_add_u32 s60, s67, 61440
    buffer_load_dwordx4 v[88:91], v48, s[28:31], s60 offen sc1
    s_add_u32 s60, s67, 71680
    buffer_load_dwordx4 v[92:95], v48, s[28:31], s60 offen sc1
    s_add_u32 s60, s67, 81920
    buffer_load_dwordx4 v[96:99], v48, s[28:31], s60 offen sc1
    s_add_u32 s60, s67, 92160
    buffer_load_dwordx4 v[100:103], v48, s[28:31], s60 offen sc1
    s_add_u32 s60, s67, 102400
    buffer_load_dwordx4 v[104:107], v48, s[28:31], s60 offen sc1
    s_add_u32 s60, s67, 112640
    buffer_load_dwordx4 v[108:111], v48, s[28:31], s60 offen sc1
    s_add_u32 s60, s67, 122880
    buffer_load_dwordx4 v[112:115], v48, s[28:31], s60 offen sc1
    s_add_u32 s60, s67, 133120
    s_mov_b32 exec_hi, 0
    buffer_load_dwordx4 v[116:119], v48, s[28:31], s60 offen sc1
    s_mov_b32 exec_hi, -1
    s_waitcnt vmcnt(0)
    s_branch FIX_Y_CHK
FIX_Y_OK:
    v_add_f32 v64, v64, v68
    v_add_f32 v66, v66, v70
    v_add_f32 v64, v64, v72
    v_add_f32 v66, v66, v74
    v_add_f32 v64, v64, v76
    v_add_f32 v66, v66, v78
    v_add_f32 v64, v64, v80
    v_add_f32 v66, v66, v82
    v_add_f32 v64, v64, v84
    v_add_f32 v66, v66, v86
    v_add_f32 v64, v64, v88
    v_add_f32 v66, v66, v90
    v_add_f32 v64, v64, v92
    v_add_f32 v66, v66, v94
    v_add_f32 v64, v64, v96
    v_add_f32 v66, v66, v98
    v_add_f32 v64, v64, v100
    v_add_f32 v66, v66, v102
    v_add_f32 v64, v64, v104
    v_add_f32 v66, v66, v106
    v_add_f32 v64, v64, v108
    v_add_f32 v66, v66, v110
    v_add_f32 v64, v64, v112
    v_add_f32 v66, v66, v114
    v_add_f32 v64, v64, v116
    v_add_f32 v66, v66, v118
    v_mov_b32 v65, v66
    v_mov_b32 v66, v64
    v_mov_b32 v67, v65
    s_nop 0
    v_permlane32_swap_b32 v64, v66
    v_permlane32_swap_b32 v65, v67
    v_add_f32 v64, v64, v66
    v_add_f32 v65, v65, v67
    v_cvt_pk_bf16_f32 v3, v64, v65
    v_lshlrev_b32 v64, 16, v3
    v_and_b32 v65, s55, v3
    v_mul_f32 v64, v64, v55
    v_mul_f32 v65, v65, v55
    v_cvt_pk_bf16_f32 v3, v64, v65
    v_lshlrev_b32 v64, 16, v3
    v_and_b32 v65, s55, v3
    v_add_f32 v50, v50, v64
    v_add_f32 v51, v51, v65
    v_cvt_pk_bf16_f32 v3, v50, v51
    v_lshlrev_b32 v50, 16, v3
    v_and_b32 v51, s55, v3
    v_mul_f32 v64, 0xbfb8aa3b, v50
    v_mul_f32 v65, 0xbfb8aa3b, v51
    v_exp_f32 v64, v64
    v_exp_f32 v65, v65
    v_add_f32 v64, 1.0, v64
    v_add_f32 v65, 1.0, v65
    v_rcp_f32 v64, v64
    v_rcp_f32 v65, v65
    v_mul_f32 v50, v50, v64
    v_mul_f32 v51, v51, v65
    s_branch FIX_N
L_CONT:
    s_mul_i32 s60, s3, 5
    s_lshl_b32 s61, s53, 6
    s_add_u32 s60, s60, s61
    s_add_u32 s60, s60, K_TAB-K_PC
    s_load_dwordx16 s[4:19], s[20:21], s60
    s_load_dwordx2 s[44:45], s[0:1], 64
    s_load_dwordx2 s[40:41], s[0:1], 16
    s_mov_b32 s46, 2621440
    s_mov_b32 s47, 0x20000
    s_mov_b32 s30, 7077888
    s_mov_b32 s31, 0x20000
    s_mov_b32 s42, 819200
    s_mov_b32 s43, 0x20000
    s_lshr_b32 s3, s3, 6
    s_and_b32 s59, s3, 3
    s_mov_b32 s55, 0xffff0000
    s_mov_b32 s100, 0
    v_and_b32 v1, 63, v0
    v_and_b32 v4, 15, v1
    v_lshrrev_b32 v5, 4, v1
    v_mov_b32 v19, 163584
    v_add_u32 v18, s3, v19
    v_lshlrev_b32 v6, 4, v1
    v_mov_b32 v28, 0x3f803f80
    v_mov_b32 v29, 0x3f803f80
    v_mov_b32 v30, 0x3f803f80
    v_mov_b32 v31, 0x3f803f80
    v_lshlrev_b32 v2, 2, v5
    v_sub_u32 v3, v4, v2
    v_add_u32 v3, 12, v3
    s_mov_b32 s60, 267390975
    v_bfe_i32 v32, s60, v3, 1
    v_and_b32 v32, 0xff800000, v32
    s_mov_b32 s60, 268435440
    v_bfe_i32 v36, s60, v3, 1
    v_and_b32 v36, 0xff800000, v36
    s_mov_b32 s60, 266346495
    v_bfe_i32 v33, s60, v3, 1
    v_and_b32 v33, 0xff800000, v33
    s_mov_b32 s60, 268435424
    v_bfe_i32 v37, s60, v3, 1
    v_and_b32 v37, 0xff800000, v37
    s_mov_b32 s60, 264257535
    v_bfe_i32 v34, s60, v3, 1
    v_and_b32 v34, 0xff800000, v34
    s_mov_b32 s60, 268435392
    v_bfe_i32 v38, s60, v3, 1
    v_and_b32 v38, 0xff800000, v38
    s_mov_b32 s60, 260079615
    v_bfe_i32 v35, s60, v3, 1
    v_and_b32 v35, 0xff800000, v35
    s_mov_b32 s60, 268435328
    v_bfe_i32 v39, s60, v3, 1
    v_and_b32 v39, 0xff800000, v39
    v_sub_u32 v2, 13, v3
    v_med3_i32 v2, v2, 0, 2
    v_lshlrev_b32 v2, 3, v2
    v_mov_b32 v40, -1
    v_lshrrev_b32 v40, v2, v40
    v_lshrrev_b32 v40, v2, v40
    v_sub_u32 v2, 15, v3
    v_med3_i32 v2, v2, 0, 2
    v_lshlrev_b32 v2, 3, v2
    v_mov_b32 v41, -1
    v_lshrrev_b32 v41, v2, v41
    v_lshrrev_b32 v41, v2, v41
    s_ashr_i32 s60, s56, 31
    s_and_b32 s60, s60, 0xff800000
    v_lshrrev_b32 v2, 3, v1
    v_bfe_i32 v2, 10, v2, 1
    v_and_b32 v2, s60, v2
    v_or_b32 v42, v32, v2
    v_or_b32 v43, v33, v2
    v_or_b32 v44, v34, v2
    v_or_b32 v45, v35, v2
    v_mul_u32_u24 v25, 20224, v5
    v_add_u32 v25, v25, v6
    v_lshrrev_b32 v24, 5, v1
    v_mul_u32_u24 v24, 19968, v24
    v_add_u32 v24, v24, v6
    v_lshlrev_b32 v26, 4, v4
    v_add_u32 v26, 161544, v26
    v_bfe_u32 v2, v1, 2, 2
    v_lshlrev_b32 v2, 7, v2
    v_and_b32 v3, 8, v1
    v_lshl_add_u32 v2, v3, 2, v2
    v_and_b32 v3, 3, v1
    v_lshl_add_u32 v2, v3, 3, v2
    v_and_b32 v3, 48, v1
    s_mov_b32 s62, 0xffff
    s_mov_b32 s60, 201329216
    s_mov_b32 s61, 373298176
    v_lshrrev_b64 v[46:47], v3, s[60:61]
    v_and_or_b32 v9, v46, s62, v2
    s_mov_b32 s60, 37748736
    s_mov_b32 s61, 2550175296
    v_lshrrev_b64 v[46:47], v3, s[60:61]
    v_and_or_b32 v10, v46, s62, v2
    s_mov_b32 s60, 469766720
    s_mov_b32 s61, 977285120
    v_lshrrev_b64 v[46:47], v3, s[60:61]
    v_and_or_b32 v11, v46, s62, v2
    s_mov_b32 s60, 2483063360
    s_mov_b32 s61, 2654996480
    v_lshrrev_b64 v[46:47], v3, s[60:61]
    v_and_or_b32 v12, v46, s62, v2
    s_mov_b32 s60, 574627840
    s_mov_b32 s61, 2051045376
    v_lshrrev_b64 v[46:47], v3, s[60:61]
    v_and_or_b32 v13, v46, s62, v2
    s_mov_b32 s60, 1073757184
    s_mov_b32 s61, 1610635840
    v_lshrrev_b64 v[46:47], v3, s[60:61]
    v_and_or_b32 v14, v46, s62, v2
    s_mov_b32 s60, 1140858432
    s_mov_b32 s61, 2147507776
    v_lshrrev_b64 v[46:47], v3, s[60:61]
    v_and_or_b32 v15, v46, s62, v2
    v_lshrrev_b32 v2, 3, v1
    v_bitop3_b32 v3, v1, v2, 7 bitop3:0x28
    v_mul_u32_u24 v7, 2560, v2
    v_lshl_add_u32 v7, v3, 4, v7
    v_lshrrev_b32 v2, 5, v1
    v_bitop3_b32 v2, v2, v4, 7 bitop3:0x28
    v_lshlrev_b32 v8, 7, v4
    v_lshl_add_u32 v8, v2, 4, v8
    v_and_b32 v2, 1, v5
    v_lshl_add_u32 v8, v2, 3, v8
    v_bfe_u32 v2, v0, 3, 5
    v_and_b32 v3, 6, v2
    v_bitop3_b32 v3, v0, v3, 7 bitop3:0x28
    v_mul_u32_u24 v16, 1280, v2
    v_lshl_add_u32 v16, v3, 4, v16
    s_lshl_b32 s98, s56, 4
    s_mul_i32 s60, s57, 13
    s_add_u32 s98, s98, s60
    s_add_u32 s98, s98, 458880
    s_add_u32 s96, s56, 8
    s_mulk_i32 s96, 1408
    s_mul_i32 s60, s57, 1144
    s_add_u32 s96, s96, s60
    s_add_u32 s96, s96, 1048576
    s_and_b32 s62, s2, 1
    s_mulk_i32 s62, 10240
    s_add_u32 s62, s62, s96
    s_sub_u32 s63, s54, s53
    s_and_b32 s60, s2, 7
    s_mul_i32 s60, s60, 25
    s_add_u32 s63, s63, s60
    s_mulk_i32 s63, 11520
    s_add_u32 s63, s63, 4194304
    v_mul_u32_u24 v2, 272, v4
    v_add_u32 v2, 112384, v2
    v_lshlrev_b32 v3, 3, v5
    s_waitcnt lgkmcnt(0)
    v_bfe_u32 v20, s4, v3, 8
    v_bfe_u32 v21, s5, v3, 8
    v_add_u32 v20, v20, v2
    v_add_u32 v21, v21, v2
    v_lshrrev_b32 v2, 2, v1
    v_mul_u32_u24 v2, 136, v2
    v_add_u32 v2, 79744, v2
    v_add_u32 v23, s7, v2
    v_lshlrev_b32 v3, 3, v1
    v_bfe_u32 v22, s6, v3, 8
    v_add_u32 v22, v22, v2
    s_add_u32 s9, s9, s62
    s_add_u32 s10, s10, s62
    s_add_u32 s11, s11, s63
    s_add_u32 s12, s12, s63
    s_add_u32 s5, s9, 40960
    s_mul_i32 s60, s8, 20480
    s_add_u32 s96, s96, s60
    s_lshl4_add_u32 s95, s8, s56
    s_cmp_eq_u32 s8, 6
    s_cselect_b32 s101, 1, 2
    s_cmpk_ge_i32 s95, 1024
    s_cselect_b32 s101, 0, s101
    s_mul_i32 s97, s95, 2560
    s_add_u32 s97, s97, s57
    s_add_u32 s97, s97, s58
    s_add_u32 s94, s97, 20480
    s_cmp_eq_u32 s8, 0
    s_cselect_b32 s97, 2146435072, s97
    s_cselect_b32 s61, 2146435072, 0
    s_and_b32 s60, s53, 2
    s_mul_i32 s22, s60, 204800
    s_sub_u32 s23, 409600, s22
    s_add_u32 s22, s22, s58
    s_add_u32 s23, s23, s58
    s_mulk_i32 s60, 5120
    s_sub_u32 s4, s96, s60
    s_add_u32 s4, s4, 10240
    s_add_u32 s96, s96, s60
    s_add_u32 s92, s96, 4096
    s_add_u32 s93, s92, 4096
    s_add_u32 s6, s4, 4096
    s_add_u32 s7, s6, 4096
    v_bfe_i32 v2, v1, 3, 1
    v_bfi_b32 v2, v2, 0, s61
    v_or_b32 v27, v2, v6
    s_and_b32 s60, s2, 4
    s_lshl_b32 s60, s60, 8
    s_add_u32 s95, s95, s60
    s_lshl_b32 s60, s8, 11
    s_add_u32 s60, s60, 147200
    v_add_u32 v8, s60, v8
    s_lshl_b32 s60, s8, 8
    s_add_u32 s60, s60, 161536
    v_lshl_add_u32 v17, v4, 4, s60
    s_mul_i32 s60, s59, 28
    v_min_u32 v2, 27, v1
    v_add_u32 v2, s60, v2
    v_lshlrev_b32 v82, 4, v2
    v_add_u32 v82, 161536, v82
    v_add_u32 v2, s56, v2
    v_max_i32 v2, 0, v2
    v_min_u32 v2, 1023, v2
    s_and_b32 s60, s2, 4
    s_lshl_b32 s60, s60, 12
    s_add_u32 s60, s60, 16384
    v_lshl_add_u32 v81, v2, 4, s60
    s_lshr_b32 s60, s58, 7
    s_movk_i32 s99, 0x3ff
    s_bitset0_b32 s99, s60
    v_lshlrev_b32 v108, 7, v1
    s_mul_i32 s71, s54, 52
    s_lshr_b32 s71, s71, 8
    s_lshl_b32 s71, s71, 13
L_GAP:
    s_lshr_b32 s64, 4099, s67
    s_and_b32 s64, s64, 15
    s_add_u32 s64, s64, s68
    s_cmp_ge_u32 s64, 10
    s_cselect_b32 s65, 10, 0
    s_sub_u32 s64, s64, s65
    s_mul_i32 s65, s64, 245760
    s_lshl_b32 s64, s64, 7
    s_add_u32 s64, s64, s57
    s_add_u32 m0, s69, 0
    s_mov_b32 exec_lo, s70
    buffer_load_dwordx4 v196, s[24:27], s64 offen lds
    s_add_u32 m0, s69, 4096
    s_mov_b32 exec_lo, -1
    buffer_load_dwordx4 v197, s[24:27], s64 offen lds
    s_add_u32 m0, s69, 8192
    s_add_u32 s65, s65, s58
    buffer_load_dwordx4 v198, s[24:27], s64 offen lds
    s_cbranch_vccz L_SK1
    s_add_u32 m0, s69, 12288
    s_nop 0
    buffer_load_dwordx4 v199, s[24:27], s64 offen lds
L_SK1:
    s_add_u32 m0, s69, 14336
    s_add_u32 s66, s65, 122880
    buffer_load_dwordx4 v200, s[32:35], s65 offen offset:0 lds
    s_add_u32 m0, s69, 21248
    s_nop 0
    buffer_load_dwordx4 v200, s[32:35], s65 offen offset:1280 lds
    s_add_u32 m0, s69, 28160
    s_nop 0
    buffer_load_dwordx4 v200, s[32:35], s65 offen offset:2560 lds
    s_add_u32 m0, s69, 18432
    s_nop 0
    buffer_load_dwordx4 v200, s[32:35], s66 offen offset:0 lds
    s_add_u32 m0, s69, 25344
    s_nop 0
    buffer_load_dwordx4 v200, s[32:35], s66 offen offset:1280 lds
    s_add_u32 m0, s69, 32256
    s_nop 0
    buffer_load_dwordx4 v200, s[32:35], s66 offen offset:2560 lds
    s_cbranch_vccz L_W0a
    s_waitcnt vmcnt(10)
    s_branch L_W0b
L_W0a:
    s_waitcnt vmcnt(9)
L_W0b:
    s_barrier
    s_lshr_b32 s64, 139585, s67
    s_and_b32 s64, s64, 15
    s_add_u32 s64, s64, s68
    s_cmp_ge_u32 s64, 10
    s_cselect_b32 s65, 10, 0
    s_sub_u32 s64, s64, s65
    s_mul_i32 s65, s64, 245760
    s_lshl_b32 s64, s64, 7
    s_add_u32 s64, s64, s57
    s_add_u32 m0, s69, 38912
    s_mov_b32 exec_lo, s70
    buffer_load_dwordx4 v196, s[24:27], s64 offen lds
    s_add_u32 m0, s69, 43008
    s_mov_b32 exec_lo, -1
    buffer_load_dwordx4 v197, s[24:27], s64 offen lds
    s_add_u32 m0, s69, 47104
    s_add_u32 s65, s65, s58
    buffer_load_dwordx4 v198, s[24:27], s64 offen lds
    s_cbranch_vccz L_SK2
    s_add_u32 m0, s69, 51200
    s_nop 0
    buffer_load_dwordx4 v199, s[24:27], s64 offen lds
L_SK2:
    s_add_u32 m0, s69, 53248
    s_add_u32 s66, s65, 122880
    buffer_load_dwordx4 v200, s[32:35], s65 offen offset:0 lds
    s_add_u32 m0, s69, 60160
    s_nop 0
    buffer_load_dwordx4 v200, s[32:35], s65 offen offset:1280 lds
    s_add_u32 m0, s69, 67072
    s_nop 0
    buffer_load_dwordx4 v200, s[32:35], s65 offen offset:2560 lds
    s_add_u32 m0, s69, 57344
    s_nop 0
    buffer_load_dwordx4 v200, s[32:35], s66 offen offset:0 lds
    s_add_u32 m0, s69, 64256
    s_nop 0
    buffer_load_dwordx4 v200, s[32:35], s66 offen offset:1280 lds
    s_add_u32 m0, s69, 71168
    s_nop 0
    buffer_load_dwordx4 v200, s[32:35], s66 offen offset:2560 lds
    s_waitcnt vmcnt(9)
    s_barrier
    s_lshr_b32 s64, 217890, s67
    s_and_b32 s64, s64, 15
    s_add_u32 s64, s64, s68
    s_cmp_ge_u32 s64, 10
    s_cselect_b32 s65, 10, 0
    s_sub_u32 s64, s64, s65
    s_mul_i32 s65, s64, 245760
    s_lshl_b32 s64, s64, 7
    s_add_u32 s64, s64, s57
    s_add_u32 m0, s69, 77824
    s_mov_b32 exec_lo, s70
    buffer_load_dwordx4 v196, s[24:27], s64 offen lds
    s_add_u32 m0, s69, 81920
    s_mov_b32 exec_lo, -1
    buffer_load_dwordx4 v197, s[24:27], s64 offen lds
    s_add_u32 m0, s69, 86016
    s_add_u32 s65, s65, s58
    buffer_load_dwordx4 v198, s[24:27], s64 offen lds
    s_cbranch_vccz L_SK3
    s_add_u32 m0, s69, 90112
    s_nop 0
    buffer_load_dwordx4 v199, s[24:27], s64 offen lds
L_SK3:
    s_add_u32 m0, s69, 92160
    s_add_u32 s66, s65, 122880
    buffer_load_dwordx4 v200, s[32:35], s65 offen offset:0 lds
    s_add_u32 m0, s69, 99072
    s_nop 0
    buffer_load_dwordx4 v200, s[32:35], s65 offen offset:1280 lds
    s_add_u32 m0, s69, 105984
    s_nop 0
    buffer_load_dwordx4 v200, s[32:35], s65 offen offset:2560 lds
    s_add_u32 m0, s69, 96256
    s_nop 0
    buffer_load_dwordx4 v200, s[32:35], s66 offen offset:0 lds
    s_add_u32 m0, s69, 103168
    s_nop 0
    buffer_load_dwordx4 v200, s[32:35], s66 offen offset:1280 lds
    s_add_u32 m0, s69, 110080
    s_nop 0
    buffer_load_dwordx4 v200, s[32:35], s66 offen offset:2560 lds
    s_waitcnt vmcnt(9)
    s_barrier
    s_lshr_b32 s64, 406580, s67
    s_and_b32 s64, s64, 15
    s_add_u32 s64, s64, s68
    s_cmp_ge_u32 s64, 10
    s_cselect_b32 s65, 10, 0
    s_sub_u32 s64, s64, s65
    s_mul_i32 s65, s64, 245760
    s_lshl_b32 s64, s64, 7
    s_add_u32 s64, s64, s57
    s_add_u32 m0, s69, 0
    s_mov_b32 exec_lo, s70
    buffer_load_dwordx4 v196, s[24:27], s64 offen lds
    s_add_u32 m0, s69, 4096
    s_mov_b32 exec_lo, -1
    buffer_load_dwordx4 v197, s[24:27], s64 offen lds
    s_add_u32 m0, s69, 8192
    s_add_u32 s65, s65, s58
    buffer_load_dwordx4 v198, s[24:27], s64 offen lds
    s_cbranch_vccz L_SK4
    s_add_u32 m0, s69, 12288
    s_nop 0
    buffer_load_dwordx4 v199, s[24:27], s64 offen lds
L_SK4:
    s_add_u32 m0, s69, 14336
    s_add_u32 s66, s65, 122880
    buffer_load_dwordx4 v200, s[32:35], s65 offen offset:0 lds
    ds_read_b32 v109, v19 offset:32
    s_add_u32 m0, s69, 21248
    s_nop 0
    buffer_load_dwordx4 v200, s[32:35], s65 offen offset:1280 lds
    s_add_u32 m0, s69, 28160
    s_nop 0
    buffer_load_dwordx4 v200, s[32:35], s65 offen offset:2560 lds
    s_add_u32 m0, s69, 18432
    s_nop 0
    buffer_load_dwordx4 v200, s[32:35], s66 offen offset:0 lds
    s_add_u32 m0, s69, 25344
    s_nop 0
    buffer_load_dwordx4 v200, s[32:35], s66 offen offset:1280 lds
    s_add_u32 m0, s69, 32256
    s_nop 0
    buffer_load_dwordx4 v200, s[32:35], s66 offen offset:2560 lds
    s_add_u32 m0, s69, 147200
    s_add_u32 s64, s58, s57
    buffer_load_dwordx4 v196, s[24:27], s64 offen lds
    s_waitcnt vmcnt(10)
    s_barrier
    s_lshr_b32 s64, 280405, s67
    s_and_b32 s64, s64, 15
    s_add_u32 s64, s64, s68
    s_cmp_ge_u32 s64, 10
    s_cselect_b32 s65, 10, 0
    s_sub_u32 s64, s64, s65
    s_mul_i32 s65, s64, 245760
    s_lshl_b32 s64, s64, 7
    s_add_u32 s64, s64, s57
    s_add_u32 m0, s69, 38912
    s_mov_b32 exec_lo, s70
    buffer_load_dwordx4 v196, s[24:27], s64 offen lds
    s_add_u32 m0, s69, 43008
    s_mov_b32 exec_lo, -1
    buffer_load_dwordx4 v197, s[24:27], s64 offen lds
    s_add_u32 m0, s69, 47104
    s_add_u32 s65, s65, s58
    buffer_load_dwordx4 v198, s[24:27], s64 offen lds
    s_cbranch_vccz L_SK5
    s_add_u32 m0, s69, 51200
    s_nop 0
    buffer_load_dwordx4 v199, s[24:27], s64 offen lds
L_SK5:
    s_add_u32 m0, s69, 53248
    s_add_u32 s66, s65, 122880
    buffer_load_dwordx4 v200, s[32:35], s65 offen offset:0 lds
    s_add_u32 m0, s69, 60160
    s_nop 0
    buffer_load_dwordx4 v200, s[32:35], s65 offen offset:1280 lds
    s_add_u32 m0, s69, 67072
    s_nop 0
    buffer_load_dwordx4 v200, s[32:35], s65 offen offset:2560 lds
    s_add_u32 m0, s69, 57344
    s_nop 0
    buffer_load_dwordx4 v200, s[32:35], s66 offen offset:0 lds
    s_add_u32 m0, s69, 64256
    s_nop 0
    buffer_load_dwordx4 v200, s[32:35], s66 offen offset:1280 lds
    s_add_u32 m0, s69, 71168
    s_nop 0
    buffer_load_dwordx4 v200, s[32:35], s66 offen offset:2560 lds
    s_add_u32 m0, s69, 151296
    s_add_u32 s64, s58, s57
    buffer_load_dwordx4 v197, s[24:27], s64 offen lds
    s_waitcnt vmcnt(10)
    s_barrier
    s_lshr_b32 s64, 353640, s67
    s_and_b32 s64, s64, 15
    s_add_u32 s64, s64, s68
    s_cmp_ge_u32 s64, 10
    s_cselect_b32 s65, 10, 0
    s_sub_u32 s64, s64, s65
    s_mul_i32 s65, s64, 245760
    s_lshl_b32 s64, s64, 7
    s_add_u32 s64, s64, s57
    s_add_u32 m0, s69, 77824
    s_mov_b32 exec_lo, s70
    buffer_load_dwordx4 v196, s[24:27], s64 offen lds
    s_add_u32 m0, s69, 81920
    s_mov_b32 exec_lo, -1
    buffer_load_dwordx4 v197, s[24:27], s64 offen lds
    s_add_u32 m0, s69, 86016
    s_add_u32 s65, s65, s58
    buffer_load_dwordx4 v198, s[24:27], s64 offen lds
    s_cbranch_vccz L_SK6
    s_add_u32 m0, s69, 90112
    s_nop 0
    buffer_load_dwordx4 v199, s[24:27], s64 offen lds
L_SK6:
    s_add_u32 m0, s69, 92160
    s_add_u32 s66, s65, 122880
    buffer_load_dwordx4 v200, s[32:35], s65 offen offset:0 lds
    s_waitcnt lgkmcnt(0)
    s_add_u32 m0, s69, 99072
    s_nop 0
    buffer_load_dwordx4 v200, s[32:35], s65 offen offset:1280 lds
    s_add_u32 m0, s69, 105984
    s_nop 0
    buffer_load_dwordx4 v200, s[32:35], s65 offen offset:2560 lds
    s_add_u32 m0, s69, 96256
    s_nop 0
    buffer_load_dwordx4 v200, s[32:35], s66 offen offset:0 lds
    s_add_u32 m0, s69, 103168
    s_nop 0
    buffer_load_dwordx4 v200, s[32:35], s66 offen offset:1280 lds
    s_add_u32 m0, s69, 110080
    s_nop 0
    buffer_load_dwordx4 v200, s[32:35], s66 offen offset:2560 lds
    s_add_u32 m0, s69, 155392
    s_add_u32 s64, s58, s57
    buffer_load_dwordx4 v198, s[24:27], s64 offen lds
    s_waitcnt vmcnt(10)
    s_barrier
    s_lshr_b32 s64, 489110, s67
    s_and_b32 s64, s64, 15
    s_add_u32 s64, s64, s68
    s_cmp_ge_u32 s64, 10
    s_cselect_b32 s65, 10, 0
    s_sub_u32 s64, s64, s65
    s_mul_i32 s65, s64, 245760
    s_lshl_b32 s64, s64, 7
    s_add_u32 s64, s64, s57
    s_add_u32 m0, s69, 0
    s_mov_b32 exec_lo, s70
    buffer_load_dwordx4 v196, s[24:27], s64 offen lds
    s_add_u32 m0, s69, 4096
    s_mov_b32 exec_lo, -1
    buffer_load_dwordx4 v197, s[24:27], s64 offen lds
    s_add_u32 m0, s69, 8192
    s_add_u32 s65, s65, s58
    buffer_load_dwordx4 v198, s[24:27], s64 offen lds
    s_cbranch_vccz L_SK7
    s_add_u32 m0, s69, 12288
    s_nop 0
    buffer_load_dwordx4 v199, s[24:27], s64 offen lds
L_SK7:
    s_add_u32 m0, s69, 14336
    s_add_u32 s66, s65, 122880
    buffer_load_dwordx4 v200, s[32:35], s65 offen offset:0 lds
    s_add_u32 m0, s69, 21248
    s_nop 0
    buffer_load_dwordx4 v200, s[32:35], s65 offen offset:1280 lds
    s_add_u32 m0, s69, 28160
    s_nop 0
    buffer_load_dwordx4 v200, s[32:35], s65 offen offset:2560 lds
    s_add_u32 m0, s69, 18432
    s_nop 0
    buffer_load_dwordx4 v200, s[32:35], s66 offen offset:0 lds
    s_add_u32 m0, s69, 25344
    s_nop 0
    buffer_load_dwordx4 v200, s[32:35], s66 offen offset:1280 lds
    s_add_u32 m0, s69, 32256
    s_nop 0
    buffer_load_dwordx4 v200, s[32:35], s66 offen offset:2560 lds
    s_cbranch_vccz L_SKX
    s_add_u32 m0, s69, 159488
    s_add_u32 s64, s58, s57
    buffer_load_dwordx4 v199, s[24:27], s64 offen lds
L_SKX:
    s_waitcnt vmcnt(9)
    s_barrier
    s_lshr_b32 s64, 559223, s67
    s_and_b32 s64, s64, 15
    s_add_u32 s64, s64, s68
    s_cmp_ge_u32 s64, 10
    s_cselect_b32 s65, 10, 0
    s_sub_u32 s64, s64, s65
    s_mul_i32 s65, s64, 245760
    s_lshl_b32 s64, s64, 7
    s_add_u32 s64, s64, s57
    s_add_u32 m0, s69, 38912
    s_mov_b32 exec_lo, s70
    buffer_load_dwordx4 v196, s[24:27], s64 offen lds
    s_add_u32 m0, s69, 43008
    s_mov_b32 exec_lo, -1
    buffer_load_dwordx4 v197, s[24:27], s64 offen lds
    s_add_u32 m0, s69, 47104
    s_add_u32 s65, s65, s58
    buffer_load_dwordx4 v198, s[24:27], s64 offen lds
    s_cbranch_vccz L_SK8
    s_add_u32 m0, s69, 51200
    s_nop 0
    buffer_load_dwordx4 v199, s[24:27], s64 offen lds
L_SK8:
    s_add_u32 m0, s69, 53248
    s_add_u32 s66, s65, 122880
    buffer_load_dwordx4 v200, s[32:35], s65 offen offset:0 lds
    v_readfirstlane_b32 s52, v109
    s_add_u32 m0, s69, 60160
    s_nop 0
    buffer_load_dwordx4 v200, s[32:35], s65 offen offset:1280 lds
    s_add_u32 m0, s69, 67072
    s_nop 0
    buffer_load_dwordx4 v200, s[32:35], s65 offen offset:2560 lds
    s_add_u32 m0, s69, 57344
    s_nop 0
    buffer_load_dwordx4 v200, s[32:35], s66 offen offset:0 lds
    s_add_u32 m0, s69, 64256
    s_nop 0
    buffer_load_dwordx4 v200, s[32:35], s66 offen offset:1280 lds
    s_add_u32 m0, s69, 71168
    s_nop 0
    buffer_load_dwordx4 v200, s[32:35], s66 offen offset:2560 lds
    s_mul_i32 s60, s59, 448
    s_add_u32 m0, s60, 161536
    s_mov_b64 exec, 0xfffffff
    buffer_load_dwordx4 v81, s[28:31], 0 offen  lds
    s_mov_b64 exec, -1
    s_waitcnt vmcnt(10)
    s_barrier
    s_lshr_b32 s64, 629129, s67
    s_and_b32 s64, s64, 15
    s_add_u32 s64, s64, s68
    s_cmp_ge_u32 s64, 10
    s_cselect_b32 s65, 10, 0
    s_sub_u32 s64, s64, s65
    s_mul_i32 s65, s64, 245760
    s_lshl_b32 s64, s64, 7
    s_add_u32 s64, s64, s57
    s_add_u32 m0, s69, 77824
    s_mov_b32 exec_lo, s70
    buffer_load_dwordx4 v196, s[24:27], s64 offen lds
    s_add_u32 m0, s69, 81920
    s_mov_b32 exec_lo, -1
    buffer_load_dwordx4 v197, s[24:27], s64 offen lds
    s_add_u32 m0, s69, 86016
    s_add_u32 s65, s65, s58
    buffer_load_dwordx4 v198, s[24:27], s64 offen lds
    s_cbranch_vccz L_SK9
    s_add_u32 m0, s69, 90112
    s_nop 0
    buffer_load_dwordx4 v199, s[24:27], s64 offen lds
L_SK9:
    s_add_u32 m0, s69, 92160
    s_add_u32 s66, s65, 122880
    buffer_load_dwordx4 v200, s[32:35], s65 offen offset:0 lds
    s_add_u32 m0, s69, 99072
    s_nop 0
    buffer_load_dwordx4 v200, s[32:35], s65 offen offset:1280 lds
    s_add_u32 m0, s69, 105984
    s_nop 0
    buffer_load_dwordx4 v200, s[32:35], s65 offen offset:2560 lds
    s_add_u32 m0, s69, 96256
    s_nop 0
    buffer_load_dwordx4 v200, s[32:35], s66 offen offset:0 lds
    s_add_u32 m0, s69, 103168
    s_nop 0
    buffer_load_dwordx4 v200, s[32:35], s66 offen offset:1280 lds
    s_add_u32 m0, s69, 110080
    s_nop 0
    buffer_load_dwordx4 v200, s[32:35], s66 offen offset:2560 lds
    s_waitcnt vmcnt(9)
    s_barrier
    ds_read_b128 v[84:87], v82
    s_mov_b32 s64, s71
    s_add_u32 s65, s69, 0
    s_add_u32 m0, s64, s65
    s_mul_i32 s61, s64, 10
    s_add_u32 s61, s61, s22
    buffer_load_dwordx4 v16, s[40:43], s61 offen lds
    s_add_u32 s64, s64, 4096
    s_cmp_eq_u32 s64, 36864
    s_cselect_b32 s64, 0, s64
    s_add_u32 m0, s64, s65
    s_mul_i32 s61, s64, 10
    s_add_u32 s61, s61, s22
    buffer_load_dwordx4 v16, s[40:43], s61 offen lds
    s_add_u32 s64, s64, 4096
    s_add_u32 m0, s64, s65
    s_mul_i32 s61, s64, 10
    s_add_u32 s61, s61, s22
    buffer_load_dwordx4 v16, s[40:43], s61 offen lds
    s_add_u32 s64, s64, 4096
    s_cmp_eq_u32 s64, 36864
    s_cselect_b32 s64, 0, s64
    s_add_u32 m0, s64, s65
    s_mul_i32 s61, s64, 10
    s_add_u32 s61, s61, s22
    buffer_load_dwordx4 v16, s[40:43], s61 offen lds
    s_add_u32 s64, s64, 4096
    s_add_u32 m0, s64, s65
    s_mul_i32 s61, s64, 10
    s_add_u32 s61, s61, s22
    buffer_load_dwordx4 v16, s[40:43], s61 offen lds
    s_add_u32 s64, s64, 4096
    s_cmp_eq_u32 s64, 36864
    s_cselect_b32 s64, 0, s64
    s_add_u32 m0, s64, s65
    s_mul_i32 s61, s64, 10
    s_add_u32 s61, s61, s22
    buffer_load_dwordx4 v16, s[40:43], s61 offen lds
    s_add_u32 s64, s64, 4096
    s_add_u32 m0, s64, s65
    s_mul_i32 s61, s64, 10
    s_add_u32 s61, s61, s22
    buffer_load_dwordx4 v16, s[40:43], s61 offen lds
    s_add_u32 s64, s64, 4096
    s_cmp_eq_u32 s64, 36864
    s_cselect_b32 s64, 0, s64
    s_add_u32 m0, s64, s65
    s_mul_i32 s61, s64, 10
    s_add_u32 s61, s61, s22
    buffer_load_dwordx4 v16, s[40:43], s61 offen lds
    s_add_u32 s64, s64, 4096
    s_add_u32 m0, s64, s65
    s_mul_i32 s61, s64, 10
    s_add_u32 s61, s61, s22
    buffer_load_dwordx4 v16, s[40:43], s61 offen lds
    s_waitcnt lgkmcnt(0)
L_RC_CHK:
    v_xor_b32 v2, s52, v85
    v_bitop3_b32 v2, v87, s52, v2 bitop3:0xbe
    v_cmp_ne_u32 vcc, 0, v2
    s_cbranch_vccnz L_RC_RETRY
L_RC_OK:
    s_waitcnt vmcnt(9)
    s_barrier
    s_cmp_lg_u32 s3, 1
    s_cbranch_scc1 L_NORS
    v_mov_b32 v124, s52
    v_mov_b32 v125, s52
    v_mov_b32 v126, s52
    v_mov_b32 v127, s52
    s_add_u32 s60, s98, s58
    s_mov_b64 exec, 0xff
    buffer_store_dwordx4 v[124:127], v6, s[28:31], s60 offen sc1
    s_mov_b64 exec, -1
L_NORS:
    s_lshl_b32 s60, s59, 10
    s_add_u32 m0, s60, 36864
    s_add_u32 s60, s22, 368640
    buffer_load_dwordx4 v16, s[40:43], s60 offen lds
    s_mov_b64 exec, 1
    buffer_load_dwordx4 v[112:115], v6, s[28:31], 0 offen offset:256
    s_mov_b64 exec, -1
    s_mul_i32 s64, s71, 10
    s_add_u32 s61, s64, s23
    buffer_load_dwordx4 v[216:219], v16, s[40:43], s61 offen
    s_add_u32 s64, s64, 40960
    s_add_u32 s61, s64, s23
    buffer_load_dwordx4 v[220:223], v16, s[40:43], s61 offen
    s_add_u32 s64, s64, 40960
    s_cmp_eq_u32 s64, 409600
    s_cselect_b32 s64, 0, s64
    s_add_u32 s61, s64, s23
    buffer_load_dwordx4 v[224:227], v16, s[40:43], s61 offen
    s_add_u32 s64, s64, 40960
    s_add_u32 s61, s64, s23
    buffer_load_dwordx4 v[228:231], v16, s[40:43], s61 offen
    s_add_u32 s64, s64, 40960
    s_cmp_eq_u32 s64, 409600
    s_cselect_b32 s64, 0, s64
    s_add_u32 s61, s64, s23
    buffer_load_dwordx4 v[232:235], v16, s[40:43], s61 offen
    s_add_u32 s64, s64, 40960
    s_add_u32 s61, s64, s23
    buffer_load_dwordx4 v[236:239], v16, s[40:43], s61 offen
    s_add_u32 s64, s64, 40960
    s_cmp_eq_u32 s64, 409600
    s_cselect_b32 s64, 0, s64
    s_add_u32 s61, s64, s23
    buffer_load_dwordx4 v[240:243], v16, s[40:43], s61 offen
    s_add_u32 s64, s64, 40960
    s_add_u32 s61, s64, s23
    buffer_load_dwordx4 v[244:247], v16, s[40:43], s61 offen
    s_add_u32 s64, s64, 40960
    s_cmp_eq_u32 s64, 409600
    s_cselect_b32 s64, 0, s64
    s_add_u32 s61, s64, s23
    buffer_load_dwordx4 v[248:251], v16, s[40:43], s61 offen
    s_add_u32 s64, s64, 40960
    s_add_u32 s61, s64, s23
    buffer_load_dwordx4 v[252:255], v16, s[40:43], s61 offen
    s_mov_b64 exec, 0
    s_bitcmp1_b32 s3, 0
    s_cbranch_scc1 TC4
    s_branch TC0
TC_END:
    s_mov_b64 exec, -1
    s_barrier
    s_setprio 1
    s_cmp_eq_u32 s13, 1
    s_cbranch_scc1 AL_S
    ds_read_b64 v[64:65], v20 offset:4480
    ds_read_b64 v[66:67], v21 offset:4480
    ds_read_b64 v[84:85], v20 offset:4352
    ds_read_b64 v[86:87], v21 offset:4352
    ds_read_b64 v[68:69], v20 offset:8832
    ds_read_b64 v[70:71], v21 offset:8832
    ds_read_b64 v[88:89], v20 offset:8704
    ds_read_b64 v[90:91], v21 offset:8704
    ds_read_b64 v[72:73], v20 offset:13184
    ds_read_b64 v[74:75], v21 offset:13184
    ds_read_b64 v[92:93], v20 offset:13056
    ds_read_b64 v[94:95], v21 offset:13056
    ds_read_b64 v[76:77], v20 offset:17536
    ds_read_b64 v[78:79], v21 offset:17536
    ds_read_b64 v[96:97], v20 offset:17408
    ds_read_b64 v[98:99], v21 offset:17408
    s_cmp_lg_u32 s3, 2
    s_cbranch_scc1 AL_NOR0
    s_mov_b32 exec_lo, s99
    s_mov_b32 exec_hi, 0
    buffer_load_dword v109, v108, s[28:31], s98 offen sc1
    s_mov_b64 exec, -1
AL_NOR0:
    v_lshl_add_u32 v3, v5, 8, v26
    v_mov_b32 v0, v27
    s_waitcnt lgkmcnt(12)
    v_mfma_f32_16x16x32_bf16 v[168:171], v[84:87], v[64:67], v[42:45]
    s_waitcnt lgkmcnt(8)
    v_mfma_f32_16x16x32_bf16 v[172:175], v[88:91], v[68:71], v[32:35]
    v_mfma_f32_16x16x32_bf16 v[52:55], v[84:87], v[68:71], v[36:39]
    s_waitcnt lgkmcnt(4)
    v_mfma_f32_16x16x32_bf16 v[176:179], v[92:95], v[72:75], v[32:35]
    v_mfma_f32_16x16x32_bf16 v[56:59], v[88:91], v[72:75], v[36:39]
    s_waitcnt lgkmcnt(0)
    v_mfma_f32_16x16x32_bf16 v[180:183], v[96:99], v[76:79], v[32:35]
    v_mfma_f32_16x16x32_bf16 v[60:63], v[92:95], v[76:79], v[36:39]
    s_branch AL_J
AL_S:
    ds_read_b64 v[64:65], v20 offset:4480
    ds_read_b64 v[84:85], v20 offset:4352
    ds_read_b64 v[68:69], v20 offset:8832
    ds_read_b64 v[88:89], v20 offset:8704
    ds_read_b64 v[72:73], v20 offset:13184
    ds_read_b64 v[92:93], v20 offset:13056
    ds_read_b64 v[76:77], v20 offset:17536
    ds_read_b64 v[96:97], v20 offset:17408
    v_lshl_add_u32 v3, v5, 8, v26
    v_mov_b32 v0, v27
    s_waitcnt lgkmcnt(6)
    v_mfma_f32_16x16x16_bf16 v[168:171], v[84:85], v[64:65], v[42:45]
    s_waitcnt lgkmcnt(4)
    v_mfma_f32_16x16x16_bf16 v[172:175], v[88:89], v[68:69], v[32:35]
    v_mfma_f32_16x16x16_bf16 v[52:55], v[84:85], v[68:69], v[36:39]
    s_waitcnt lgkmcnt(2)
    v_mfma_f32_16x16x16_bf16 v[176:179], v[92:93], v[72:73], v[32:35]
    v_mfma_f32_16x16x16_bf16 v[56:59], v[88:89], v[72:73], v[36:39]
    s_waitcnt lgkmcnt(0)
    v_mfma_f32_16x16x16_bf16 v[180:183], v[96:97], v[76:77], v[32:35]
    v_mfma_f32_16x16x16_bf16 v[60:63], v[92:93], v[76:77], v[36:39]
AL_J:
    ds_read_b32 v27, v3
    ds_read2st64_b32 v[36:37], v26 offset1:1
    ds_read2st64_b32 v[38:39], v26 offset0:2 offset1:3
    v_max_f32 v172, v172, v52
    v_max_f32 v173, v173, v53
    v_max_f32 v174, v174, v54
    v_max_f32 v175, v175, v55
    v_max_f32 v176, v176, v56
    v_max_f32 v177, v177, v57
    v_max_f32 v178, v178, v58
    v_max_f32 v179, v179, v59
    v_max_f32 v180, v180, v60
    v_max_f32 v181, v181, v61
    v_max_f32 v182, v182, v62
    v_max_f32 v183, v183, v63
    s_cmp_lg_u32 s13, 1
    s_cbranch_scc1 AL_SM
    v_cvt_pk_bf16_f32 v64, v168, v169
    v_mov_b32 v65, s52
    v_cvt_pk_bf16_f32 v66, v170, v171
    v_mov_b32 v67, s52
    buffer_store_dwordx4 v[64:67], v6, s[28:31], s11 offen offset:0 sc1
    v_cvt_pk_bf16_f32 v68, v172, v173
    v_mov_b32 v69, s52
    v_cvt_pk_bf16_f32 v70, v174, v175
    v_mov_b32 v71, s52
    buffer_store_dwordx4 v[68:71], v6, s[28:31], s11 offen offset:1024 sc1
    v_cvt_pk_bf16_f32 v72, v176, v177
    v_mov_b32 v73, s52
    v_cvt_pk_bf16_f32 v74, v178, v179
    v_mov_b32 v75, s52
    buffer_store_dwordx4 v[72:75], v6, s[28:31], s11 offen offset:2048 sc1
    v_cvt_pk_bf16_f32 v76, v180, v181
    v_mov_b32 v77, s52
    v_cvt_pk_bf16_f32 v78, v182, v183
    v_mov_b32 v79, s52
    buffer_store_dwordx4 v[76:79], v6, s[28:31], s11 offen offset:3072 sc1
    s_branch AL_X
AL_SM:
    v_max3_f32 v136, v168, v169, v170
    v_max3_f32 v138, v172, v173, v174
    v_max3_f32 v140, v176, v177, v178
    v_max3_f32 v142, v180, v181, v182
    v_max_f32 v136, v136, v171
    v_max_f32 v138, v138, v175
    v_max_f32 v140, v140, v179
    v_max_f32 v142, v142, v183
    s_nop 0
    v_permlane32_swap_b32 v136, v140
    v_permlane32_swap_b32 v138, v142
    v_max_f32 v136, v136, v140
    v_max_f32 v138, v138, v142
    s_waitcnt lgkmcnt(0)
    v_mul_f32 v27, 0x3ea52b5c, v27
    v_permlane16_swap_b32 v136, v138
    v_max_f32 v136, v136, v138
    v_mul_f32 v138, v136, v27
    v_mul_f32 v136, v136, v27
    v_mul_f32 v32, 0x3ea52b5c, v36
    v_mul_f32 v34, 0x3ea52b5c, v37
    v_permlane16_swap_b32 v136, v138
    v_mov_b32 v140, v136
    v_mov_b32 v142, v138
    v_mul_f32 v36, 0x3ea52b5c, v38
    v_mul_f32 v38, 0x3ea52b5c, v39
    v_permlane32_swap_b32 v136, v140
    v_permlane32_swap_b32 v138, v142
    v_pk_fma_f32 v[168:169], v[168:169], v[32:33], v[136:137] op_sel_hi:[1,0,0] neg_lo:[0,0,1] neg_hi:[0,0,1]
    v_pk_fma_f32 v[170:171], v[170:171], v[32:33], v[136:137] op_sel_hi:[1,0,0] neg_lo:[0,0,1] neg_hi:[0,0,1]
    v_pk_fma_f32 v[172:173], v[172:173], v[34:35], v[138:139] op_sel_hi:[1,0,0] neg_lo:[0,0,1] neg_hi:[0,0,1]
    v_pk_fma_f32 v[174:175], v[174:175], v[34:35], v[138:139] op_sel_hi:[1,0,0] neg_lo:[0,0,1] neg_hi:[0,0,1]
    v_pk_fma_f32 v[176:177], v[176:177], v[36:37], v[140:141] op_sel_hi:[1,0,0] neg_lo:[0,0,1] neg_hi:[0,0,1]
    v_pk_fma_f32 v[178:179], v[178:179], v[36:37], v[140:141] op_sel_hi:[1,0,0] neg_lo:[0,0,1] neg_hi:[0,0,1]
    v_pk_fma_f32 v[180:181], v[180:181], v[38:39], v[142:143] op_sel_hi:[1,0,0] neg_lo:[0,0,1] neg_hi:[0,0,1]
    v_pk_fma_f32 v[182:183], v[182:183], v[38:39], v[142:143] op_sel_hi:[1,0,0] neg_lo:[0,0,1] neg_hi:[0,0,1]
    s_cmp_eq_u32 s13, 1
    s_cbranch_scc1 AL_NOY
    s_cmp_lg_u32 s3, 2
    s_cbranch_scc1 AL_NOR1
    s_mov_b32 exec_lo, s99
    s_mov_b32 exec_hi, 0
    s_waitcnt vmcnt(0)
AL_RD_CHK:
    v_xor_b32 v2, s52, v109
    v_cmp_ne_u32 vcc, 0, v2
    s_cbranch_vccz AL_RD_OK
AL_RD_RETRY:
    s_add_u32 s100, s100, 1
    s_cmp_gt_u32 s100, 20000
    s_cbranch_scc1 AL_RD_OK
    s_sleep 1
    buffer_load_dword v109, v108, s[28:31], s98 offen sc1
    s_waitcnt vmcnt(0)
    s_branch AL_RD_CHK
AL_RD_OK:
    s_mov_b64 exec, -1
AL_NOR1:
    s_waitcnt vmcnt(0)
    s_barrier
    ds_read_b64_tr_b16 v[184:185], v22 offset:2176
    ds_read_b64_tr_b16 v[194:195], v23 offset:2176
    ds_read_b64_tr_b16 v[186:187], v22 offset:2176
    ds_read_b64_tr_b16 v[196:197], v23 offset:2176
    ds_read_b64_tr_b16 v[188:189], v22 offset:4352
    ds_read_b64_tr_b16 v[198:199], v23 offset:4352
    ds_read_b64_tr_b16 v[190:191], v22 offset:6528
    ds_read_b64_tr_b16 v[200:201], v23 offset:6528
    ds_read_b64_tr_b16 v[192:193], v22 offset:8704
    ds_read_b64_tr_b16 v[202:203], v23 offset:8704
AL_NOY:
    v_exp_f32 v168, v168
    v_exp_f32 v169, v169
    v_exp_f32 v170, v170
    v_exp_f32 v171, v171
    v_cvt_pk_bf16_f32 v2, v168, v169
    v_cvt_pk_bf16_f32 v3, v170, v171
    v_bfi_b32 v168, v40, 0, v2
    v_bfi_b32 v169, v41, 0, v3
    v_and_b32 v170, v40, v2
    v_and_b32 v171, v41, v3
    s_waitcnt lgkmcnt(0)
    v_exp_f32 v172, v172
    v_mfma_f32_16x16x32_bf16 v[116:119], v[28:31], v[168:171], 0
    v_exp_f32 v173, v173
    v_mfma_f32_16x16x32_bf16 v[136:139], v[184:187], v[168:171], 0
    v_exp_f32 v174, v174
    v_mfma_f32_16x16x32_bf16 v[152:155], v[194:197], v[168:171], 0
    v_exp_f32 v175, v175
    v_cvt_pk_bf16_f32 v2, v172, v173
    v_cvt_pk_bf16_f32 v3, v174, v175
    v_bfi_b32 v172, v40, 0, v2
    v_bfi_b32 v173, v41, 0, v3
    v_and_b32 v174, v40, v2
    v_and_b32 v175, v41, v3
    v_rcp_f32 v32, v116
    v_exp_f32 v176, v176
    v_mfma_f32_16x16x32_bf16 v[120:123], v[28:31], v[172:175], 0
    v_exp_f32 v177, v177
    v_mfma_f32_16x16x32_bf16 v[140:143], v[186:189], v[172:175], 0
    v_exp_f32 v178, v178
    v_mfma_f32_16x16x32_bf16 v[156:159], v[196:199], v[172:175], 0
    v_exp_f32 v179, v179
    v_cvt_pk_bf16_f32 v2, v176, v177
    v_cvt_pk_bf16_f32 v3, v178, v179
    v_bfi_b32 v176, v40, 0, v2
    v_bfi_b32 v177, v41, 0, v3
    v_and_b32 v178, v40, v2
    v_and_b32 v179, v41, v3
    v_rcp_f32 v34, v120
    v_exp_f32 v180, v180
    v_mfma_f32_16x16x32_bf16 v[116:119], v[28:31], v[176:179], 0
    v_exp_f32 v181, v181
    v_mfma_f32_16x16x32_bf16 v[144:147], v[188:191], v[176:179], 0
    v_exp_f32 v182, v182
    v_mfma_f32_16x16x32_bf16 v[160:163], v[198:201], v[176:179], 0
    v_exp_f32 v183, v183
    v_cvt_pk_bf16_f32 v2, v180, v181
    v_cvt_pk_bf16_f32 v3, v182, v183
    v_bfi_b32 v180, v40, 0, v2
    v_bfi_b32 v181, v41, 0, v3
    v_and_b32 v182, v40, v2
    v_and_b32 v183, v41, v3
    v_rcp_f32 v36, v116
    v_mul_f32 v136, v136, v32
    v_mfma_f32_16x16x32_bf16 v[120:123], v[28:31], v[180:183], 0
    v_mul_f32 v137, v137, v32
    v_mfma_f32_16x16x32_bf16 v[148:151], v[190:193], v[180:183], 0
    v_mul_f32 v138, v138, v32
    v_mfma_f32_16x16x32_bf16 v[164:167], v[200:203], v[180:183], 0
    v_mul_f32 v139, v139, v32
    v_cvt_pk_bf16_f32 v136, v136, v137
    v_cvt_pk_bf16_f32 v137, v138, v139
    v_mul_f32 v140, v140, v34
    v_mul_f32 v141, v141, v34
    v_mul_f32 v142, v142, v34
    v_mul_f32 v143, v143, v34
    v_cvt_pk_bf16_f32 v138, v140, v141
    v_cvt_pk_bf16_f32 v139, v142, v143
    v_rcp_f32 v38, v120
    v_pk_mul_f32 v[144:145], v[144:145], v[36:37] op_sel_hi:[1,0]
    v_pk_mul_f32 v[146:147], v[146:147], v[36:37] op_sel_hi:[1,0]
    v_permlane32_swap_b32 v136, v138
    v_permlane32_swap_b32 v137, v139
    v_pk_mul_f32 v[148:149], v[148:149], v[38:39] op_sel_hi:[1,0]
    v_pk_mul_f32 v[150:151], v[150:151], v[38:39] op_sel_hi:[1,0]
    v_cvt_pk_bf16_f32 v144, v144, v145
    v_cvt_pk_bf16_f32 v145, v146, v147
    v_cvt_pk_bf16_f32 v146, v148, v149
    v_cvt_pk_bf16_f32 v147, v150, v151
    s_mov_b64 exec, s[14:15]
    buffer_store_dwordx4 v[136:139], v24, s[28:31], s9 offen sc1
    s_mov_b64 exec, -1
    v_permlane32_swap_b32 v144, v146
    v_permlane32_swap_b32 v145, v147
    v_pk_mul_f32 v[152:153], v[152:153], v[32:33] op_sel_hi:[1,0]
    v_pk_mul_f32 v[154:155], v[154:155], v[32:33] op_sel_hi:[1,0]
    s_mov_b64 exec, s[16:17]
    buffer_store_dwordx4 v[144:147], v24, s[28:31], s5 offen sc1
    s_lshl_b64 exec, -1, 16
    v_pk_mul_f32 v[152:153], v[156:157], v[34:35] op_sel_hi:[1,0]
    v_pk_mul_f32 v[154:155], v[158:159], v[34:35] op_sel_hi:[1,0]
    s_lshl_b64 exec, -1, 32
    v_pk_mul_f32 v[152:153], v[160:161], v[36:37] op_sel_hi:[1,0]
    v_pk_mul_f32 v[154:155], v[162:163], v[36:37] op_sel_hi:[1,0]
    s_lshl_b64 exec, -1, 48
    v_pk_mul_f32 v[152:153], v[164:165], v[38:39] op_sel_hi:[1,0]
    v_pk_mul_f32 v[154:155], v[166:167], v[38:39] op_sel_hi:[1,0]
    s_mov_b64 exec, s[18:19]
    v_cvt_pk_bf16_f32 v152, v152, v153
    v_cvt_pk_bf16_f32 v153, v154, v155
    buffer_store_dwordx2 v[152:153], v25, s[28:31], s10 offen sc1
    s_mov_b64 exec, -1
    s_cmp_eq_u32 s13, 1
    s_cbranch_scc1 P_TAIL
    s_mov_b32 s64, s71
    s_add_u32 s65, s69, 40960
    s_add_u32 s61, s64, s65
    v_add_u32 v3, s61, v6
    ds_write_b128 v3, v[216:219] offset:0
    ds_write_b128 v3, v[220:223] offset:4096
    s_add_u32 s64, s64, 8192
    s_cmp_eq_u32 s64, 40960
    s_cselect_b32 s64, 0, s64
    s_add_u32 s61, s64, s65
    v_add_u32 v3, s61, v6
    ds_write_b128 v3, v[224:227] offset:0
    ds_write_b128 v3, v[228:231] offset:4096
    s_add_u32 s64, s64, 8192
    s_cmp_eq_u32 s64, 40960
    s_cselect_b32 s64, 0, s64
    s_add_u32 s61, s64, s65
    v_add_u32 v3, s61, v6
    ds_write_b128 v3, v[232:235] offset:0
    ds_write_b128 v3, v[236:239] offset:4096
    s_add_u32 s64, s64, 8192
    s_cmp_eq_u32 s64, 40960
    s_cselect_b32 s64, 0, s64
    s_add_u32 s61, s64, s65
    v_add_u32 v3, s61, v6
    ds_write_b128 v3, v[240:243] offset:0
    ds_write_b128 v3, v[244:247] offset:4096
    s_add_u32 s64, s64, 8192
    s_cmp_eq_u32 s64, 40960
    s_cselect_b32 s64, 0, s64
    s_add_u32 s61, s64, s65
    v_add_u32 v3, s61, v6
    ds_write_b128 v3, v[248:251] offset:0
    ds_write_b128 v3, v[252:255] offset:4096
    v_mov_b32 v2, 1
    ds_write_b8 v18, v2 offset:16
    s_branch A_DONE
AC_X:
TC0:
    s_cbranch_execz TC1
    s_setprio 0
    s_sleep 16
    s_setprio 2
    buffer_load_dwordx4 v[136:139], v6, s[28:31], s12 offen offset:0 sc1
    buffer_load_dwordx4 v[140:143], v6, s[28:31], s12 offen offset:1024 sc1
    buffer_load_dwordx4 v[144:147], v6, s[28:31], s12 offen offset:2048 sc1
    s_setprio 0
    s_call_b64 s[20:21], K_P1
    s_call_b64 s[20:21], K_P2
    s_setprio 2
    s_waitcnt vmcnt(0)
AC_MB_CHK:
    v_xor_b32 v2, s52, v137
    v_bitop3_b32 v2, v139, s52, v2 bitop3:0xbe
    v_bitop3_b32 v2, v141, s52, v2 bitop3:0xbe
    v_bitop3_b32 v2, v143, s52, v2 bitop3:0xbe
    v_bitop3_b32 v2, v145, s52, v2 bitop3:0xbe
    v_bitop3_b32 v2, v147, s52, v2 bitop3:0xbe
    v_cmp_ne_u32 vcc, 0, v2
    s_cbranch_vccnz AC_MB_RETRY
AC_MB_OK:
    v_lshlrev_b32 v137, 16, v136
    v_and_b32 v136, s55, v136
    v_lshlrev_b32 v139, 16, v138
    v_and_b32 v138, s55, v138
    v_add_f32 v168, v168, v137
    v_add_f32 v169, v169, v136
    v_add_f32 v170, v170, v139
    v_add_f32 v171, v171, v138
    v_lshlrev_b32 v141, 16, v140
    v_and_b32 v140, s55, v140
    v_lshlrev_b32 v143, 16, v142
    v_and_b32 v142, s55, v142
    v_add_f32 v172, v172, v141
    v_add_f32 v173, v173, v140
    v_add_f32 v174, v174, v143
    v_add_f32 v175, v175, v142
    v_lshlrev_b32 v145, 16, v144
    v_and_b32 v144, s55, v144
    v_lshlrev_b32 v147, 16, v146
    v_and_b32 v146, s55, v146
    v_add_f32 v176, v176, v145
    v_add_f32 v177, v177, v144
    v_add_f32 v178, v178, v147
    v_add_f32 v179, v179, v146
    s_branch AC_SM
AL_X:
TC7:
    s_cbranch_execz TC_END
    s_setprio 0
    s_mov_b64 exec, 1
    s_waitcnt vmcnt(4)
L_FL_CHK:
    v_xor_b32 v2, s52, v113
    v_bitop3_b32 v2, v115, s52, v2 bitop3:0xbe
    v_cmp_ne_u32 vcc, 0, v2
    s_cbranch_vccnz L_FL_RETRY
L_FL_OK:
    ds_write2_b32 v19, v112, v114 offset0:10 offset1:11
    s_mov_b64 exec, -1
    s_waitcnt lgkmcnt(0)
    s_barrier
    ds_read_b64_tr_b16 v[184:185], v22 offset:2176
    ds_read_b64_tr_b16 v[194:195], v23 offset:2176
    ds_read_b64_tr_b16 v[186:187], v22 offset:2176
    ds_read_b64_tr_b16 v[196:197], v23 offset:2176
    ds_read_b64_tr_b16 v[188:189], v22 offset:4352
    ds_read_b64_tr_b16 v[198:199], v23 offset:4352
    ds_read_b64_tr_b16 v[190:191], v22 offset:6528
    ds_read_b64_tr_b16 v[200:201], v23 offset:6528
    ds_read_b64_tr_b16 v[192:193], v22 offset:8704
    ds_read_b64_tr_b16 v[202:203], v23 offset:8704
    s_mov_b32 s64, s71
    s_add_u32 s65, s69, 40960
    s_add_u32 s61, s64, s65
    v_add_u32 v3, s61, v6
    ds_write_b128 v3, v[216:219] offset:0
    ds_write_b128 v3, v[220:223] offset:4096
    s_add_u32 s64, s64, 8192
    s_cmp_eq_u32 s64, 40960
    s_cselect_b32 s64, 0, s64
    s_add_u32 s61, s64, s65
    v_add_u32 v3, s61, v6
    ds_write_b128 v3, v[224:227] offset:0
    ds_write_b128 v3, v[228:231] offset:4096
    s_add_u32 s64, s64, 8192
    s_cmp_eq_u32 s64, 40960
    s_cselect_b32 s64, 0, s64
    s_add_u32 s61, s64, s65
    v_add_u32 v3, s61, v6
    ds_write_b128 v3, v[232:235] offset:0
    ds_write_b128 v3, v[236:239] offset:4096
    s_add_u32 s64, s64, 8192
    s_cmp_eq_u32 s64, 40960
    s_cselect_b32 s64, 0, s64
    s_add_u32 s61, s64, s65
    v_add_u32 v3, s61, v6
    ds_write_b128 v3, v[240:243] offset:0
    ds_write_b128 v3, v[244:247] offset:4096
    s_add_u32 s64, s64, 8192
    s_cmp_eq_u32 s64, 40960
    s_cselect_b32 s64, 0, s64
    s_add_u32 s61, s64, s65
    v_add_u32 v3, s61, v6
    ds_write_b128 v3, v[248:251] offset:0
    ds_write_b128 v3, v[252:255] offset:4096
    v_mov_b32 v2, 1
    ds_write_b8 v18, v2 offset:16
    s_sleep 10
    s_setprio 2
    buffer_load_dwordx4 v[136:139], v6, s[28:31], s12 offen offset:0 sc1
    buffer_load_dwordx4 v[140:143], v6, s[28:31], s12 offen offset:1024 sc1
    buffer_load_dwordx4 v[144:147], v6, s[28:31], s12 offen offset:2048 sc1
    buffer_load_dwordx4 v[148:151], v6, s[28:31], s12 offen offset:3072 sc1
    s_setprio 0
    s_call_b64 s[20:21], K_P1
    s_call_b64 s[20:21], K_P2
    s_setprio 2
    s_waitcnt vmcnt(0)
AL_MB_CHK:
    v_xor_b32 v2, s52, v137
    v_bitop3_b32 v2, v139, s52, v2 bitop3:0xbe
    v_bitop3_b32 v2, v141, s52, v2 bitop3:0xbe
    v_bitop3_b32 v2, v143, s52, v2 bitop3:0xbe
    v_bitop3_b32 v2, v145, s52, v2 bitop3:0xbe
    v_bitop3_b32 v2, v147, s52, v2 bitop3:0xbe
    v_bitop3_b32 v2, v149, s52, v2 bitop3:0xbe
    v_bitop3_b32 v2, v151, s52, v2 bitop3:0xbe
    v_cmp_ne_u32 vcc, 0, v2
    s_cbranch_vccnz AL_MB_RETRY
AL_MB_OK:
    v_lshlrev_b32 v137, 16, v136
    v_and_b32 v136, s55, v136
    v_lshlrev_b32 v139, 16, v138
    v_and_b32 v138, s55, v138
    v_add_f32 v168, v168, v137
    v_add_f32 v169, v169, v136
    v_add_f32 v170, v170, v139
    v_add_f32 v171, v171, v138
    v_lshlrev_b32 v141, 16, v140
    v_and_b32 v140, s55, v140
    v_lshlrev_b32 v143, 16, v142
    v_and_b32 v142, s55, v142
    v_add_f32 v172, v172, v141
    v_add_f32 v173, v173, v140
    v_add_f32 v174, v174, v143
    v_add_f32 v175, v175, v142
    v_lshlrev_b32 v145, 16, v144
    v_and_b32 v144, s55, v144
    v_lshlrev_b32 v147, 16, v146
    v_and_b32 v146, s55, v146
    v_add_f32 v176, v176, v145
    v_add_f32 v177, v177, v144
    v_add_f32 v178, v178, v147
    v_add_f32 v179, v179, v146
    v_lshlrev_b32 v149, 16, v148
    v_and_b32 v148, s55, v148
    v_lshlrev_b32 v151, 16, v150
    v_and_b32 v150, s55, v150
    v_add_f32 v180, v180, v149
    v_add_f32 v181, v181, v148
    v_add_f32 v182, v182, v151
    v_add_f32 v183, v183, v150
    s_branch AL_SM
AC_MB_RETRY:
    s_add_u32 s100, s100, 1
    s_cmp_gt_u32 s100, 20000
    s_cbranch_scc1 AC_MB_OK
    s_sleep 6
    buffer_load_dwordx4 v[136:139], v6, s[28:31], s12 offen offset:0 sc1
    buffer_load_dwordx4 v[140:143], v6, s[28:31], s12 offen offset:1024 sc1
    buffer_load_dwordx4 v[144:147], v6, s[28:31], s12 offen offset:2048 sc1
    s_waitcnt vmcnt(0)
    s_branch AC_MB_CHK
G2_R0:
TC2:
    s_cbranch_execz TC3
    s_sleep 3
    buffer_load_dwordx4 v[96:99], v0, s[28:31], s96 offen offset:0 sc1
    buffer_load_dwordx4 v[100:103], v31, s[28:31], s96 offen offset:0 sc1
    buffer_load_dwordx4 v[104:107], v0, s[28:31], s96 offen offset:1024 sc1
    buffer_load_dwordx4 v[108:111], v31, s[28:31], s96 offen offset:1024 sc1
    buffer_load_dwordx4 v[112:115], v0, s[28:31], s96 offen offset:2048 sc1
    buffer_load_dwordx4 v[116:119], v31, s[28:31], s96 offen offset:2048 sc1
    buffer_load_dwordx4 v[120:123], v0, s[28:31], s96 offen offset:3072 sc1
    buffer_load_dwordx4 v[124:127], v31, s[28:31], s96 offen offset:3072 sc1
    buffer_load_dwordx4 v[128:131], v0, s[28:31], s92 offen offset:0 sc1
    buffer_load_dwordx4 v[132:135], v31, s[28:31], s92 offen offset:0 sc1
    s_add_u32 s100, s100, 1
    s_cmp_gt_u32 s100, 20000
    s_waitcnt vmcnt(0)
    s_cbranch_scc1 G2_OK0
    v_max3_u32 v2, v96, v98, v100
    v_max_u32 v2, v2, v102
    v_cmp_eq_u32 vcc, -1, v2
    s_cbranch_vccnz G2_R0
    s_branch G2_OK0
G2_R1:
    s_sleep 3
    buffer_load_dwordx4 v[104:107], v0, s[28:31], s96 offen offset:1024 sc1
    buffer_load_dwordx4 v[108:111], v31, s[28:31], s96 offen offset:1024 sc1
    buffer_load_dwordx4 v[112:115], v0, s[28:31], s96 offen offset:2048 sc1
    buffer_load_dwordx4 v[116:119], v31, s[28:31], s96 offen offset:2048 sc1
    buffer_load_dwordx4 v[120:123], v0, s[28:31], s96 offen offset:3072 sc1
    buffer_load_dwordx4 v[124:127], v31, s[28:31], s96 offen offset:3072 sc1
    buffer_load_dwordx4 v[128:131], v0, s[28:31], s92 offen offset:0 sc1
    buffer_load_dwordx4 v[132:135], v31, s[28:31], s92 offen offset:0 sc1
    buffer_load_dwordx4 v[136:139], v0, s[28:31], s92 offen offset:1024 sc1
    buffer_load_dwordx4 v[140:143], v31, s[28:31], s92 offen offset:1024 sc1
    s_add_u32 s100, s100, 1
    s_cmp_gt_u32 s100, 20000
    s_waitcnt vmcnt(0)
    s_cbranch_scc1 G2_OK1
    v_max3_u32 v2, v104, v106, v108
    v_max_u32 v2, v2, v110
    v_cmp_eq_u32 vcc, -1, v2
    s_cbranch_vccnz G2_R1
    s_branch G2_OK1
G2_R2:
    s_sleep 3
    buffer_load_dwordx4 v[112:115], v0, s[28:31], s96 offen offset:2048 sc1
    buffer_load_dwordx4 v[116:119], v31, s[28:31], s96 offen offset:2048 sc1
    buffer_load_dwordx4 v[120:123], v0, s[28:31], s96 offen offset:3072 sc1
    buffer_load_dwordx4 v[124:127], v31, s[28:31], s96 offen offset:3072 sc1
    buffer_load_dwordx4 v[128:131], v0, s[28:31], s92 offen offset:0 sc1
    buffer_load_dwordx4 v[132:135], v31, s[28:31], s92 offen offset:0 sc1
    buffer_load_dwordx4 v[136:139], v0, s[28:31], s92 offen offset:1024 sc1
    buffer_load_dwordx4 v[140:143], v31, s[28:31], s92 offen offset:1024 sc1
    buffer_load_dwordx4 v[144:147], v0, s[28:31], s92 offen offset:2048 sc1
    buffer_load_dwordx4 v[148:151], v31, s[28:31], s92 offen offset:2048 sc1
    s_add_u32 s100, s100, 1
    s_cmp_gt_u32 s100, 20000
    s_waitcnt vmcnt(0)
    s_cbranch_scc1 G2_OK2
    v_max3_u32 v2, v112, v114, v116
    v_max_u32 v2, v2, v118
    v_cmp_eq_u32 vcc, -1, v2
    s_cbranch_vccnz G2_R2
    s_branch G2_OK2
G2_ZA:
    s_waitcnt lgkmcnt(0)
    v_and_b32 v2, v2, v3
    v_cmp_ne_u32 vcc, 0x01010101, v2
    s_cbranch_vccz G2_ZAOK
G2_ZAR:
    s_add_u32 s100, s100, 1
    s_cmp_gt_u32 s100, 200000
    s_cbranch_scc1 G2_ZAOK
    s_sleep 1
    ds_read_b64 v[2:3], v19 offset:16
    s_branch G2_ZA
G2_R3:
    s_sleep 3
    buffer_load_dwordx4 v[120:123], v0, s[28:31], s96 offen offset:3072 sc1
    buffer_load_dwordx4 v[124:127], v31, s[28:31], s96 offen offset:3072 sc1
    buffer_load_dwordx4 v[128:131], v0, s[28:31], s92 offen offset:0 sc1
    buffer_load_dwordx4 v[132:135], v31, s[28:31], s92 offen offset:0 sc1
    buffer_load_dwordx4 v[136:139], v0, s[28:31], s92 offen offset:1024 sc1
    buffer_load_dwordx4 v[140:143], v31, s[28:31], s92 offen offset:1024 sc1
    buffer_load_dwordx4 v[144:147], v0, s[28:31], s92 offen offset:2048 sc1
    buffer_load_dwordx4 v[148:151], v31, s[28:31], s92 offen offset:2048 sc1
    buffer_load_dwordx4 v[152:155], v0, s[28:31], s4 offen offset:0 sc1
    buffer_load_dwordx4 v[156:159], v31, s[28:31], s4 offen offset:0 sc1
    s_add_u32 s100, s100, 1
    s_cmp_gt_u32 s100, 20000
    s_waitcnt vmcnt(0)
    s_cbranch_scc1 G2_OK3
    v_max3_u32 v2, v120, v122, v124
    v_max_u32 v2, v2, v126
    v_cmp_eq_u32 vcc, -1, v2
    s_cbranch_vccnz G2_R3
    s_branch G2_OK3
G2_R4:
    s_sleep 3
    buffer_load_dwordx4 v[128:131], v0, s[28:31], s92 offen offset:0 sc1
    buffer_load_dwordx4 v[132:135], v31, s[28:31], s92 offen offset:0 sc1
    buffer_load_dwordx4 v[136:139], v0, s[28:31], s92 offen offset:1024 sc1
    buffer_load_dwordx4 v[140:143], v31, s[28:31], s92 offen offset:1024 sc1
    buffer_load_dwordx4 v[144:147], v0, s[28:31], s92 offen offset:2048 sc1
    buffer_load_dwordx4 v[148:151], v31, s[28:31], s92 offen offset:2048 sc1
    buffer_load_dwordx4 v[152:155], v0, s[28:31], s4 offen offset:0 sc1
    buffer_load_dwordx4 v[156:159], v31, s[28:31], s4 offen offset:0 sc1
    buffer_load_dwordx4 v[96:99], v0, s[28:31], s4 offen offset:1024 sc1
    buffer_load_dwordx4 v[100:103], v31, s[28:31], s4 offen offset:1024 sc1
    s_add_u32 s100, s100, 1
    s_cmp_gt_u32 s100, 20000
    s_waitcnt vmcnt(0)
    s_cbranch_scc1 G2_OK4
    v_max3_u32 v2, v128, v130, v132
    v_max_u32 v2, v2, v134
    v_cmp_eq_u32 vcc, -1, v2
    s_cbranch_vccnz G2_R4
    s_branch G2_OK4
G2_R5:
    s_sleep 3
    buffer_load_dwordx4 v[136:139], v0, s[28:31], s92 offen offset:1024 sc1
    buffer_load_dwordx4 v[140:143], v31, s[28:31], s92 offen offset:1024 sc1
    buffer_load_dwordx4 v[144:147], v0, s[28:31], s92 offen offset:2048 sc1
    buffer_load_dwordx4 v[148:151], v31, s[28:31], s92 offen offset:2048 sc1
    buffer_load_dwordx4 v[152:155], v0, s[28:31], s4 offen offset:0 sc1
    buffer_load_dwordx4 v[156:159], v31, s[28:31], s4 offen offset:0 sc1
    buffer_load_dwordx4 v[96:99], v0, s[28:31], s4 offen offset:1024 sc1
    buffer_load_dwordx4 v[100:103], v31, s[28:31], s4 offen offset:1024 sc1
    buffer_load_dwordx4 v[104:107], v0, s[28:31], s4 offen offset:2048 sc1
    buffer_load_dwordx4 v[108:111], v31, s[28:31], s4 offen offset:2048 sc1
    s_add_u32 s100, s100, 1
    s_cmp_gt_u32 s100, 20000
    s_waitcnt vmcnt(0)
    s_cbranch_scc1 G2_OK5
    v_max3_u32 v2, v136, v138, v140
    v_max_u32 v2, v2, v142
    v_cmp_eq_u32 vcc, -1, v2
    s_cbranch_vccnz G2_R5
    s_branch G2_OK5
G2_R6:
    s_sleep 3
    buffer_load_dwordx4 v[144:147], v0, s[28:31], s92 offen offset:2048 sc1
    buffer_load_dwordx4 v[148:151], v31, s[28:31], s92 offen offset:2048 sc1
    buffer_load_dwordx4 v[152:155], v0, s[28:31], s4 offen offset:0 sc1
    buffer_load_dwordx4 v[156:159], v31, s[28:31], s4 offen offset:0 sc1
    buffer_load_dwordx4 v[96:99], v0, s[28:31], s4 offen offset:1024 sc1
    buffer_load_dwordx4 v[100:103], v31, s[28:31], s4 offen offset:1024 sc1
    buffer_load_dwordx4 v[104:107], v0, s[28:31], s4 offen offset:2048 sc1
    buffer_load_dwordx4 v[108:111], v31, s[28:31], s4 offen offset:2048 sc1
    buffer_load_dwordx4 v[112:115], v0, s[28:31], s4 offen offset:3072 sc1
    buffer_load_dwordx4 v[116:119], v31, s[28:31], s4 offen offset:3072 sc1
    s_add_u32 s100, s100, 1
    s_cmp_gt_u32 s100, 20000
    s_waitcnt vmcnt(0)
    s_cbranch_scc1 G2_OK6
    v_max3_u32 v2, v144, v146, v148
    v_max_u32 v2, v2, v150
    v_cmp_eq_u32 vcc, -1, v2
    s_cbranch_vccnz G2_R6
    s_branch G2_OK6
G2_R7:
TC3:
    s_cbranch_execz TC_END
    s_sleep 3
    buffer_load_dwordx4 v[152:155], v0, s[28:31], s4 offen offset:0 sc1
    buffer_load_dwordx4 v[156:159], v31, s[28:31], s4 offen offset:0 sc1
    buffer_load_dwordx4 v[96:99], v0, s[28:31], s4 offen offset:1024 sc1
    buffer_load_dwordx4 v[100:103], v31, s[28:31], s4 offen offset:1024 sc1
    buffer_load_dwordx4 v[104:107], v0, s[28:31], s4 offen offset:2048 sc1
    buffer_load_dwordx4 v[108:111], v31, s[28:31], s4 offen offset:2048 sc1
    buffer_load_dwordx4 v[112:115], v0, s[28:31], s4 offen offset:3072 sc1
    buffer_load_dwordx4 v[116:119], v31, s[28:31], s4 offen offset:3072 sc1
    buffer_load_dwordx4 v[120:123], v0, s[28:31], s6 offen offset:0 sc1
    buffer_load_dwordx4 v[124:127], v31, s[28:31], s6 offen offset:0 sc1
    s_add_u32 s100, s100, 1
    s_cmp_gt_u32 s100, 20000
    s_waitcnt vmcnt(0)
    s_cbranch_scc1 G2_OK7
    v_max3_u32 v2, v152, v154, v156
    v_max_u32 v2, v2, v158
    v_cmp_eq_u32 vcc, -1, v2
    s_cbranch_vccnz G2_R7
    s_branch G2_OK7
G2_R8:
    s_sleep 3
    buffer_load_dwordx4 v[96:99], v0, s[28:31], s4 offen offset:1024 sc1
    buffer_load_dwordx4 v[100:103], v31, s[28:31], s4 offen offset:1024 sc1
    buffer_load_dwordx4 v[104:107], v0, s[28:31], s4 offen offset:2048 sc1
    buffer_load_dwordx4 v[108:111], v31, s[28:31], s4 offen offset:2048 sc1
    buffer_load_dwordx4 v[112:115], v0, s[28:31], s4 offen offset:3072 sc1
    buffer_load_dwordx4 v[116:119], v31, s[28:31], s4 offen offset:3072 sc1
    buffer_load_dwordx4 v[120:123], v0, s[28:31], s6 offen offset:0 sc1
    buffer_load_dwordx4 v[124:127], v31, s[28:31], s6 offen offset:0 sc1
    buffer_load_dwordx4 v[128:131], v0, s[28:31], s6 offen offset:1024 sc1
    buffer_load_dwordx4 v[132:135], v31, s[28:31], s6 offen offset:1024 sc1
    s_add_u32 s100, s100, 1
    s_cmp_gt_u32 s100, 20000
    s_waitcnt vmcnt(0)
    s_cbranch_scc1 G2_OK8
    v_max3_u32 v2, v96, v98, v100
    v_max_u32 v2, v2, v102
    v_cmp_eq_u32 vcc, -1, v2
    s_cbranch_vccnz G2_R8
    s_branch G2_OK8
G2_R9:
    s_sleep 3
    buffer_load_dwordx4 v[104:107], v0, s[28:31], s4 offen offset:2048 sc1
    buffer_load_dwordx4 v[108:111], v31, s[28:31], s4 offen offset:2048 sc1
    buffer_load_dwordx4 v[112:115], v0, s[28:31], s4 offen offset:3072 sc1
    buffer_load_dwordx4 v[116:119], v31, s[28:31], s4 offen offset:3072 sc1
    buffer_load_dwordx4 v[120:123], v0, s[28:31], s6 offen offset:0 sc1
    buffer_load_dwordx4 v[124:127], v31, s[28:31], s6 offen offset:0 sc1
    buffer_load_dwordx4 v[128:131], v0, s[28:31], s6 offen offset:1024 sc1
    buffer_load_dwordx4 v[132:135], v31, s[28:31], s6 offen offset:1024 sc1
    buffer_load_dwordx4 v[136:139], v0, s[28:31], s6 offen offset:2048 sc1
    buffer_load_dwordx4 v[140:143], v31, s[28:31], s6 offen offset:2048 sc1
    s_add_u32 s100, s100, 1
    s_cmp_gt_u32 s100, 20000
    s_waitcnt vmcnt(0)
    s_cbranch_scc1 G2_OK9
    v_max3_u32 v2, v104, v106, v108
    v_max_u32 v2, v2, v110
    v_cmp_eq_u32 vcc, -1, v2
    s_cbranch_vccnz G2_R9
    s_branch G2_OK9
G2_ZL:
    s_waitcnt lgkmcnt(0)
    v_and_b32 v2, v2, v3
    v_cmp_ne_u32 vcc, 0x01010101, v2
    s_cbranch_vccz G2_ZLOK
G2_ZLR:
    s_add_u32 s100, s100, 1
    s_cmp_gt_u32 s100, 200000
    s_cbranch_scc1 G2_ZLOK
    s_sleep 1
    ds_read_b64 v[2:3], v19 offset:0
    s_branch G2_ZL
G2_R10:
    s_sleep 3
    buffer_load_dwordx4 v[112:115], v0, s[28:31], s4 offen offset:3072 sc1
    buffer_load_dwordx4 v[116:119], v31, s[28:31], s4 offen offset:3072 sc1
    buffer_load_dwordx4 v[120:123], v0, s[28:31], s6 offen offset:0 sc1
    buffer_load_dwordx4 v[124:127], v31, s[28:31], s6 offen offset:0 sc1
    buffer_load_dwordx4 v[128:131], v0, s[28:31], s6 offen offset:1024 sc1
    buffer_load_dwordx4 v[132:135], v31, s[28:31], s6 offen offset:1024 sc1
    buffer_load_dwordx4 v[136:139], v0, s[28:31], s6 offen offset:2048 sc1
    buffer_load_dwordx4 v[140:143], v31, s[28:31], s6 offen offset:2048 sc1
    s_add_u32 s100, s100, 1
    s_cmp_gt_u32 s100, 20000
    s_waitcnt vmcnt(0)
    s_cbranch_scc1 G2_OK10
    v_max3_u32 v2, v112, v114, v116
    v_max_u32 v2, v2, v118
    v_cmp_eq_u32 vcc, -1, v2
    s_cbranch_vccnz G2_R10
    s_branch G2_OK10
G2_R11:
    s_sleep 3
    buffer_load_dwordx4 v[120:123], v0, s[28:31], s6 offen offset:0 sc1
    buffer_load_dwordx4 v[124:127], v31, s[28:31], s6 offen offset:0 sc1
    buffer_load_dwordx4 v[128:131], v0, s[28:31], s6 offen offset:1024 sc1
    buffer_load_dwordx4 v[132:135], v31, s[28:31], s6 offen offset:1024 sc1
    buffer_load_dwordx4 v[136:139], v0, s[28:31], s6 offen offset:2048 sc1
    buffer_load_dwordx4 v[140:143], v31, s[28:31], s6 offen offset:2048 sc1
    s_add_u32 s100, s100, 1
    s_cmp_gt_u32 s100, 20000
    s_waitcnt vmcnt(0)
    s_cbranch_scc1 G2_OK11
    v_max3_u32 v2, v120, v122, v124
    v_max_u32 v2, v2, v126
    v_cmp_eq_u32 vcc, -1, v2
    s_cbranch_vccnz G2_R11
    s_branch G2_OK11
G2_R12:
    s_sleep 3
    buffer_load_dwordx4 v[128:131], v0, s[28:31], s6 offen offset:1024 sc1
    buffer_load_dwordx4 v[132:135], v31, s[28:31], s6 offen offset:1024 sc1
    buffer_load_dwordx4 v[136:139], v0, s[28:31], s6 offen offset:2048 sc1
    buffer_load_dwordx4 v[140:143], v31, s[28:31], s6 offen offset:2048 sc1
    buffer_load_dwordx4 v[144:147], v0, s[28:31], s93 offen offset:0 sc1
    buffer_load_dwordx4 v[148:151], v31, s[28:31], s93 offen offset:0 sc1
    buffer_load_dwordx4 v[152:155], v0, s[28:31], s7 offen offset:0 sc1
    buffer_load_dwordx4 v[156:159], v31, s[28:31], s7 offen offset:0 sc1
    s_add_u32 s100, s100, 1
    s_cmp_gt_u32 s100, 20000
    s_waitcnt vmcnt(0)
    s_cbranch_scc1 G2_OK12
    v_max3_u32 v2, v128, v130, v132
    v_max_u32 v2, v2, v134
    v_cmp_eq_u32 vcc, -1, v2
    s_cbranch_vccnz G2_R12
    s_branch G2_OK12
G2_R13:
    s_sleep 3
    buffer_load_dwordx4 v[136:139], v0, s[28:31], s6 offen offset:2048 sc1
    buffer_load_dwordx4 v[140:143], v31, s[28:31], s6 offen offset:2048 sc1
    buffer_load_dwordx4 v[144:147], v0, s[28:31], s93 offen offset:0 sc1
    buffer_load_dwordx4 v[148:151], v31, s[28:31], s93 offen offset:0 sc1
    buffer_load_dwordx4 v[152:155], v0, s[28:31], s7 offen offset:0 sc1
    buffer_load_dwordx4 v[156:159], v31, s[28:31], s7 offen offset:0 sc1
    buffer_load_dwordx4 v[96:99], v0, s[28:31], s93 offen offset:1024 sc1
    buffer_load_dwordx4 v[100:103], v31, s[28:31], s93 offen offset:1024 sc1
    buffer_load_dwordx4 v[104:107], v0, s[28:31], s7 offen offset:1024 sc1
    buffer_load_dwordx4 v[108:111], v31, s[28:31], s7 offen offset:1024 sc1
    s_add_u32 s100, s100, 1
    s_cmp_gt_u32 s100, 20000
    s_waitcnt vmcnt(0)
    s_cbranch_scc1 G2_OK13
    v_max3_u32 v2, v136, v138, v140
    v_max_u32 v2, v2, v142
    v_cmp_eq_u32 vcc, -1, v2
    s_cbranch_vccnz G2_R13
    s_branch G2_OK13
G2_R14:
TC4:
    s_cbranch_execz TC5
    s_sleep 3
    buffer_load_dwordx4 v[144:147], v0, s[28:31], s93 offen offset:0 sc1
    buffer_load_dwordx4 v[148:151], v31, s[28:31], s93 offen offset:0 sc1
    buffer_load_dwordx4 v[152:155], v0, s[28:31], s7 offen offset:0 sc1
    buffer_load_dwordx4 v[156:159], v31, s[28:31], s7 offen offset:0 sc1
    buffer_load_dwordx4 v[96:99], v0, s[28:31], s93 offen offset:1024 sc1
    buffer_load_dwordx4 v[100:103], v31, s[28:31], s93 offen offset:1024 sc1
    buffer_load_dwordx4 v[104:107], v0, s[28:31], s7 offen offset:1024 sc1
    buffer_load_dwordx4 v[108:111], v31, s[28:31], s7 offen offset:1024 sc1
    buffer_load_dwordx4 v[112:115], v0, s[28:31], s92 offen offset:3072 sc1
    buffer_load_dwordx4 v[116:119], v31, s[28:31], s92 offen offset:3072 sc1
    s_add_u32 s100, s100, 1
    s_cmp_gt_u32 s100, 20000
    s_waitcnt vmcnt(0)
    s_cbranch_scc1 G2_OK14
    v_max3_u32 v2, v144, v146, v148
    v_max_u32 v2, v2, v150
    v_cmp_eq_u32 vcc, -1, v2
    s_cbranch_vccnz G2_R14
    s_branch G2_OK14
G2_R15:
    s_sleep 3
    buffer_load_dwordx4 v[152:155], v0, s[28:31], s7 offen offset:0 sc1
    buffer_load_dwordx4 v[156:159], v31, s[28:31], s7 offen offset:0 sc1
    buffer_load_dwordx4 v[96:99], v0, s[28:31], s93 offen offset:1024 sc1
    buffer_load_dwordx4 v[100:103], v31, s[28:31], s93 offen offset:1024 sc1
    buffer_load_dwordx4 v[104:107], v0, s[28:31], s7 offen offset:1024 sc1
    buffer_load_dwordx4 v[108:111], v31, s[28:31], s7 offen offset:1024 sc1
    buffer_load_dwordx4 v[112:115], v0, s[28:31], s92 offen offset:3072 sc1
    buffer_load_dwordx4 v[116:119], v31, s[28:31], s92 offen offset:3072 sc1
    buffer_load_dwordx4 v[120:123], v0, s[28:31], s6 offen offset:3072 sc1
    buffer_load_dwordx4 v[124:127], v31, s[28:31], s6 offen offset:3072 sc1
    s_add_u32 s100, s100, 1
    s_cmp_gt_u32 s100, 20000
    s_waitcnt vmcnt(0)
    s_cbranch_scc1 G2_OK15
    v_max3_u32 v2, v152, v154, v156
    v_max_u32 v2, v2, v158
    v_cmp_eq_u32 vcc, -1, v2
    s_cbranch_vccnz G2_R15
    s_branch G2_OK15
G2_R16:
    s_sleep 3
    buffer_load_dwordx4 v[96:99], v0, s[28:31], s93 offen offset:1024 sc1
    buffer_load_dwordx4 v[100:103], v31, s[28:31], s93 offen offset:1024 sc1
    buffer_load_dwordx4 v[104:107], v0, s[28:31], s7 offen offset:1024 sc1
    buffer_load_dwordx4 v[108:111], v31, s[28:31], s7 offen offset:1024 sc1
    buffer_load_dwordx4 v[112:115], v0, s[28:31], s92 offen offset:3072 sc1
    buffer_load_dwordx4 v[116:119], v31, s[28:31], s92 offen offset:3072 sc1
    buffer_load_dwordx4 v[120:123], v0, s[28:31], s6 offen offset:3072 sc1
    buffer_load_dwordx4 v[124:127], v31, s[28:31], s6 offen offset:3072 sc1
    s_add_u32 s100, s100, 1
    s_cmp_gt_u32 s100, 20000
    s_waitcnt vmcnt(0)
    s_cbranch_scc1 G2_OK16
    v_max3_u32 v2, v96, v98, v100
    v_max_u32 v2, v2, v102
    v_cmp_eq_u32 vcc, -1, v2
    s_cbranch_vccnz G2_R16
    s_branch G2_OK16
G2_R17:
    s_sleep 3
    buffer_load_dwordx4 v[104:107], v0, s[28:31], s7 offen offset:1024 sc1
    buffer_load_dwordx4 v[108:111], v31, s[28:31], s7 offen offset:1024 sc1
    buffer_load_dwordx4 v[112:115], v0, s[28:31], s92 offen offset:3072 sc1
    buffer_load_dwordx4 v[116:119], v31, s[28:31], s92 offen offset:3072 sc1
    buffer_load_dwordx4 v[120:123], v0, s[28:31], s6 offen offset:3072 sc1
    buffer_load_dwordx4 v[124:127], v31, s[28:31], s6 offen offset:3072 sc1
    s_add_u32 s100, s100, 1
    s_cmp_gt_u32 s100, 20000
    s_waitcnt vmcnt(0)
    s_cbranch_scc1 G2_OK17
    v_max3_u32 v2, v104, v106, v108
    v_max_u32 v2, v2, v110
    v_cmp_eq_u32 vcc, -1, v2
    s_cbranch_vccnz G2_R17
    s_branch G2_OK17
G2_R18:
    s_sleep 3
    buffer_load_dwordx4 v[112:115], v0, s[28:31], s92 offen offset:3072 sc1
    buffer_load_dwordx4 v[116:119], v31, s[28:31], s92 offen offset:3072 sc1
    buffer_load_dwordx4 v[120:123], v0, s[28:31], s6 offen offset:3072 sc1
    buffer_load_dwordx4 v[124:127], v31, s[28:31], s6 offen offset:3072 sc1
    s_add_u32 s100, s100, 1
    s_cmp_gt_u32 s100, 20000
    s_waitcnt vmcnt(0)
    s_cbranch_scc1 G2_OK18
    v_max3_u32 v2, v112, v114, v116
    v_max_u32 v2, v2, v118
    v_cmp_eq_u32 vcc, -1, v2
    s_cbranch_vccnz G2_R18
    s_branch G2_OK18
G2_R19:
    s_sleep 3
    buffer_load_dwordx4 v[120:123], v0, s[28:31], s6 offen offset:3072 sc1
    buffer_load_dwordx4 v[124:127], v31, s[28:31], s6 offen offset:3072 sc1
    s_add_u32 s100, s100, 1
    s_cmp_gt_u32 s100, 20000
    s_waitcnt vmcnt(0)
    s_cbranch_scc1 G2_OK19
    v_max3_u32 v2, v120, v122, v124
    v_max_u32 v2, v2, v126
    v_cmp_eq_u32 vcc, -1, v2
    s_cbranch_vccnz G2_R19
    s_branch G2_OK19
G2_ZG:
    s_waitcnt lgkmcnt(0)
    v_and_b32 v2, v2, v3
    v_cmp_ne_u32 vcc, 0x01010101, v2
    s_cbranch_vccz G2_ZGOK
G2_ZGR:
    s_add_u32 s100, s100, 1
    s_cmp_gt_u32 s100, 200000
    s_cbranch_scc1 G2_ZGOK
    s_sleep 1
    ds_read_b64 v[2:3], v19 offset:8
    s_branch G2_ZG
P_ZR:
    s_add_u32 s100, s100, 1
    s_cmp_gt_u32 s100, 200000
    s_cbranch_scc1 P_ZOK
    s_sleep 1
    ds_read_b64 v[2:3], v19 offset:0
    s_branch P_Z
L_RC_RETRY:
    s_add_u32 s100, s100, 1
    s_cmp_gt_u32 s100, 20000
    s_cbranch_scc1 L_RC_OK
    s_sleep 4
    s_mul_i32 s60, s59, 448
    s_add_u32 m0, s60, 161536
    s_mov_b64 exec, 0xfffffff
    buffer_load_dwordx4 v81, s[28:31], 0 offen sc1 lds
    s_mov_b64 exec, -1
    s_waitcnt vmcnt(0)
    ds_read_b128 v[84:87], v82
    s_waitcnt lgkmcnt(0)
    s_waitcnt vmcnt(0)
    s_branch L_RC_CHK
L_FL_RETRY:
    s_add_u32 s100, s100, 1
    s_cmp_gt_u32 s100, 20000
    s_cbranch_scc1 L_FL_OK
    s_sleep 8
    s_mov_b64 exec, 1
    buffer_load_dwordx4 v[112:115], v6, s[28:31], 0 offen offset:256 sc1
    s_waitcnt vmcnt(0)
    s_branch L_FL_CHK
AL_MB_RETRY:
    s_add_u32 s100, s100, 1
    s_cmp_gt_u32 s100, 20000
    s_cbranch_scc1 AL_MB_OK
    s_sleep 6
    buffer_load_dwordx4 v[136:139], v6, s[28:31], s12 offen offset:0 sc1
    buffer_load_dwordx4 v[140:143], v6, s[28:31], s12 offen offset:1024 sc1
    buffer_load_dwordx4 v[144:147], v6, s[28:31], s12 offen offset:2048 sc1
    buffer_load_dwordx4 v[148:151], v6, s[28:31], s12 offen offset:3072 sc1
    s_waitcnt vmcnt(0)
    s_branch AL_MB_CHK
K_AUX0:
    s_sub_u32 s56, s2, 200
K_AUX:
    s_lshr_b32 s3, s3, 6
    s_and_b32 s59, s3, 3
    s_mov_b32 s55, 0xffff0000
    s_mov_b32 s100, 0
    v_and_b32 v1, 63, v0
    v_and_b32 v4, 15, v1
    v_lshrrev_b32 v5, 4, v1
    v_mov_b32 v19, 163584
    v_add_u32 v18, s3, v19
    s_mov_b32 s30, 7077888
    s_mov_b32 s31, 0x20000
    s_cmp_ge_u32 s3, 4
    s_cbranch_scc1 K_FC
    s_cmp_lg_u32 s101, 5
    s_cbranch_scc1 FL_SPARE
    s_waitcnt vmcnt(16)
    s_barrier
    s_mov_b32 s70, 4
FL_GU1b:
    s_mov_b32 m0, s69
    s_sub_u32 s70, s70, 1
    buffer_load_dwordx4 v30, s[48:51], s68 offen nt lds
    s_add_u32 m0, s69, 16384
    s_add_u32 s69, s69, 4096
    buffer_load_dwordx4 v30, s[36:39], s68 offen nt lds
    s_add_u32 s68, s68, 110592
    s_and_b32 s60, s70, 3
    s_cselect_b32 s60, 0, 16384
    s_add_u32 s69, s69, s60
    s_cmp_lg_u32 s70, 0
    s_cbranch_scc1 FL_GU1b
    s_barrier
    s_lshl_b32 s69, s59, 10
    s_add_u32 m0, s69, 0
    s_nop 0
    buffer_load_dwordx4 v30, s[48:51], s68 offen nt lds
    s_add_u32 m0, s69, 16384
    s_nop 0
    buffer_load_dwordx4 v30, s[36:39], s68 offen nt lds
    s_add_u32 s68, s68, 110592
    s_add_u32 m0, s69, 4096
    s_nop 0
    buffer_load_dwordx4 v30, s[48:51], s68 offen nt lds
    s_add_u32 m0, s69, 20480
    s_nop 0
    buffer_load_dwordx4 v30, s[36:39], s68 offen nt lds
    s_add_u32 s68, s68, 110592
    s_add_u32 m0, s69, 8192
    s_nop 0
    buffer_load_dwordx4 v30, s[48:51], s68 offen nt lds
    s_add_u32 m0, s69, 24576
    s_nop 0
    buffer_load_dwordx4 v30, s[36:39], s68 offen nt lds
    s_add_u32 s68, s68, 110592
    s_waitcnt vmcnt(14)
    s_barrier
    s_add_u32 m0, s69, 12288
    s_nop 0
    buffer_load_dwordx4 v30, s[48:51], s68 offen nt lds
    s_add_u32 m0, s69, 28672
    s_nop 0
    buffer_load_dwordx4 v30, s[36:39], s68 offen nt lds
    s_add_u32 s68, s68, 110592
    s_waitcnt vmcnt(0)
    s_barrier
    s_branch K_END
FL_SPARE:
    s_waitcnt lgkmcnt(0)
    s_load_dwordx2 s[48:49], s[0:1], 56
    s_load_dwordx2 s[40:41], s[0:1], 16
    s_mov_b32 s42, 819200
    s_mov_b32 s43, 0x20000
    s_and_b32 s60, s59, 2
    s_lshl_b32 s60, s60, 2
    v_lshl_or_b32 v2, v5, 1, s60
    v_xor_b32 v2, v2, v1
    v_and_b32 v2, 15, v2
    v_lshrrev_b32 v31, 4, v0
    v_mul_u32_u24 v31, 1280, v31
    v_lshl_add_u32 v31, v2, 4, v31
    s_sub_u32 s61, s56, 27
    s_mul_i32 s61, s61, 81920
    v_add_u32 v31, s61, v31
    s_lshl_b32 s63, s59, 10
    s_mov_b32 s50, 2211840
    s_mov_b32 s51, 0x20000
    s_waitcnt lgkmcnt(0)
    s_sleep 30
    s_lshl3_add_u32 s60, s56, s3
    s_lshl_b32 s60, s60, 10
    s_add_u32 s60, s60, 827392
    v_mov_b32 v108, -1
    v_mov_b32 v109, -1
    v_mov_b32 v110, -1
    v_mov_b32 v111, -1
    v_lshlrev_b32 v15, 4, v1
FL_CLR:
    buffer_store_dwordx4 v[108:111], v15, s[28:31], s60 offen sc1
    s_add_u32 s60, s60, 237568
    s_cmp_lt_u32 s60, 3977216
    s_cbranch_scc1 FL_CLR
    s_waitcnt vmcnt(0)
    s_barrier
    s_add_u32 m0, s63, 0
    s_mov_b32 s60, 0
    buffer_load_dwordx4 v31, s[48:51], s60 offen nt lds
    s_add_u32 m0, s63, 4096
    s_mov_b32 s60, 20480
    buffer_load_dwordx4 v31, s[48:51], s60 offen nt lds
    s_add_u32 m0, s63, 8192
    s_mov_b32 s60, 40960
    buffer_load_dwordx4 v31, s[48:51], s60 offen nt lds
    s_add_u32 m0, s63, 12288
    s_mov_b32 s60, 61440
    buffer_load_dwordx4 v31, s[48:51], s60 offen nt lds
    s_add_u32 m0, s63, 16384
    s_mov_b32 s60, 256
    buffer_load_dwordx4 v31, s[48:51], s60 offen nt lds
    s_add_u32 m0, s63, 20480
    s_mov_b32 s60, 20736
    buffer_load_dwordx4 v31, s[48:51], s60 offen nt lds
    s_add_u32 m0, s63, 24576
    s_mov_b32 s60, 41216
    buffer_load_dwordx4 v31, s[48:51], s60 offen nt lds
    s_add_u32 m0, s63, 28672
    s_mov_b32 s60, 61696
    buffer_load_dwordx4 v31, s[48:51], s60 offen nt lds
    s_add_u32 m0, s63, 32768
    s_mov_b32 s60, 512
    buffer_load_dwordx4 v31, s[48:51], s60 offen nt lds
    s_add_u32 m0, s63, 36864
    s_mov_b32 s60, 20992
    buffer_load_dwordx4 v31, s[48:51], s60 offen nt lds
    s_add_u32 m0, s63, 40960
    s_mov_b32 s60, 41472
    buffer_load_dwordx4 v31, s[48:51], s60 offen nt lds
    s_add_u32 m0, s63, 45056
    s_mov_b32 s60, 61952
    buffer_load_dwordx4 v31, s[48:51], s60 offen nt lds
    s_add_u32 m0, s63, 49152
    s_mov_b32 s60, 768
    buffer_load_dwordx4 v31, s[48:51], s60 offen nt lds
    s_add_u32 m0, s63, 53248
    s_mov_b32 s60, 21248
    buffer_load_dwordx4 v31, s[48:51], s60 offen nt lds
    s_add_u32 m0, s63, 57344
    s_mov_b32 s60, 41728
    buffer_load_dwordx4 v31, s[48:51], s60 offen nt lds
    s_add_u32 m0, s63, 61440
    s_mov_b32 s60, 62208
    buffer_load_dwordx4 v31, s[48:51], s60 offen nt lds
    s_add_u32 m0, s63, 65536
    s_mov_b32 s60, 1024
    buffer_load_dwordx4 v31, s[48:51], s60 offen nt lds
    s_add_u32 m0, s63, 69632
    s_mov_b32 s60, 21504
    buffer_load_dwordx4 v31, s[48:51], s60 offen nt lds
    s_add_u32 m0, s63, 73728
    s_mov_b32 s60, 41984
    buffer_load_dwordx4 v31, s[48:51], s60 offen nt lds
    s_add_u32 m0, s63, 77824
    s_mov_b32 s60, 62464
    buffer_load_dwordx4 v31, s[48:51], s60 offen nt lds
    s_sub_u32 s60, s56, 27
    s_mul_i32 s60, s60, 28672
    v_lshlrev_b32 v30, 4, v0
    s_add_u32 m0, s63, 81920
    s_nop 0
    buffer_load_dwordx4 v30, s[40:43], s60 offen lds
    s_add_u32 s60, s60, 4096
    buffer_load_dwordx4 v30, s[40:43], s60 offen lds
    s_add_u32 s60, s60, 4096
    buffer_load_dwordx4 v30, s[40:43], s60 offen lds
    s_add_u32 s60, s60, 4096
    buffer_load_dwordx4 v30, s[40:43], s60 offen lds
    s_add_u32 s60, s60, 4096
    buffer_load_dwordx4 v30, s[40:43], s60 offen lds
    s_add_u32 s60, s60, 4096
    buffer_load_dwordx4 v30, s[40:43], s60 offen lds
    s_add_u32 s60, s60, 4096
    buffer_load_dwordx4 v30, s[40:43], s60 offen lds
    s_add_u32 s60, s60, 4096
    s_waitcnt vmcnt(7)
    s_barrier
    s_branch K_END
K_FC:
    s_waitcnt lgkmcnt(0)
    v_mov_b32 v241, 0x3f803f80
    s_mul_i32 s52, s52, 0x9E3779B1
    s_add_u32 s52, s52, 0x7F4A7C15
    s_or_b32 s52, s52, 1
    v_mov_b32 v245, s52
    v_mov_b32 v247, s52
    s_bfe_u32 s60, s2, 0x10002
    s_lshl4_add_u32 s60, s68, s60
    s_sub_u32 s60, 0xffff, s60
    v_lshlrev_b32 v239, 1, v232
    v_sub_u32 v239, s60, v239
    v_lshlrev_b32 v243, 3, v232
    v_lshlrev_b32 v232, 4, v232
    v_mov_b32 v249, s52
    s_setprio 3
    s_waitcnt vmcnt(3)
    v_dot2_f32_bf16 v233, v212, v241, 0
    v_dot2_f32_bf16 v234, v212, v212, 0
    v_dot2_f32_bf16 v233, v213, v241, v233
    v_dot2_f32_bf16 v234, v213, v213, v234
    v_dot2_f32_bf16 v233, v214, v241, v233
    v_dot2_f32_bf16 v234, v214, v214, v234
    v_dot2_f32_bf16 v233, v215, v241, v233
    v_dot2_f32_bf16 v234, v215, v215, v234
    v_dot2_f32_bf16 v233, v216, v241, v233
    v_dot2_f32_bf16 v234, v216, v216, v234
    v_dot2_f32_bf16 v233, v217, v241, v233
    v_dot2_f32_bf16 v234, v217, v217, v234
    v_dot2_f32_bf16 v233, v218, v241, v233
    v_dot2_f32_bf16 v234, v218, v218, v234
    v_dot2_f32_bf16 v233, v219, v241, v233
    v_dot2_f32_bf16 v234, v219, v219, v234
    v_dot2_f32_bf16 v233, v220, v241, v233
    v_dot2_f32_bf16 v234, v220, v220, v234
    v_dot2_f32_bf16 v233, v221, v241, v233
    v_dot2_f32_bf16 v234, v221, v221, v234
    s_waitcnt vmcnt(0)
    v_dot2_f32_bf16 v235, v212, v222, 0
    v_dot2_f32_bf16 v236, v222, v241, 0
    v_dot2_f32_bf16 v235, v213, v223, v235
    v_dot2_f32_bf16 v236, v223, v241, v236
    v_dot2_f32_bf16 v235, v214, v224, v235
    v_dot2_f32_bf16 v236, v224, v241, v236
    v_dot2_f32_bf16 v235, v215, v225, v235
    v_dot2_f32_bf16 v236, v225, v241, v236
    v_dot2_f32_bf16 v235, v216, v226, v235
    v_dot2_f32_bf16 v236, v226, v241, v236
    v_dot2_f32_bf16 v235, v217, v227, v235
    v_dot2_f32_bf16 v236, v227, v241, v236
    v_dot2_f32_bf16 v235, v218, v228, v235
    v_dot2_f32_bf16 v236, v228, v241, v236
    v_dot2_f32_bf16 v235, v219, v229, v235
    v_dot2_f32_bf16 v236, v229, v241, v236
    v_dot2_f32_bf16 v235, v220, v230, v235
    v_dot2_f32_bf16 v236, v230, v241, v236
    v_dot2_f32_bf16 v235, v221, v231, v235
    v_dot2_f32_bf16 v236, v231, v241, v236
    v_permlane16_swap_b32 v233, v234
    v_add_f32 v233, v233, v234
    s_nop 0
    v_permlane16_swap_b32 v235, v236
    v_add_f32 v235, v235, v236
    v_add_f32_dpp v233, v233, v233 row_ror:8 row_mask:0xf bank_mask:0xf
    s_nop 0
    v_add_f32_dpp v235, v235, v235 row_ror:8 row_mask:0xf bank_mask:0xf
    v_add_f32_dpp v233, v233, v233 row_ror:4 row_mask:0xf bank_mask:0xf
    s_nop 0
    v_add_f32_dpp v235, v235, v235 row_ror:4 row_mask:0xf bank_mask:0xf
    v_add_f32_dpp v233, v233, v233 row_ror:2 row_mask:0xf bank_mask:0xf
    s_nop 0
    v_add_f32_dpp v235, v235, v235 row_ror:2 row_mask:0xf bank_mask:0xf
    v_add_f32_dpp v233, v233, v233 row_ror:1 row_mask:0xf bank_mask:0xf
    s_nop 0
    v_add_f32_dpp v235, v235, v235 row_ror:1 row_mask:0xf bank_mask:0xf
    v_mul_f32 v233, 0x3acccccd, v233
    v_mov_b32 v236, v235
    v_mov_b32 v234, v233
    s_nop 0
    v_permlane16_swap_b32 v235, v236
    v_permlane16_swap_b32 v233, v234
    v_fma_f32 v234, -v233, v233, v234
    v_max_f32 v234, 0, v234
    v_cvt_pk_bf16_f32 v237, v233, v234
    v_lshlrev_b32 v233, 16, v237
    v_and_b32 v234, 0xffff0000, v237
    v_add_f32 v234, 0x3727c5ac, v234
    v_cvt_pk_bf16_f32 v234, v234, v234
    v_lshlrev_b32 v234, 16, v234
    v_sqrt_f32 v234, v234
    v_fma_f32 v235, -v233, v236, v235
    v_cvt_pk_bf16_f32 v234, v234, v234
    v_lshlrev_b32 v234, 16, v234
    v_rcp_f32 v246, v234
    s_mov_b32 exec_lo, 1
    s_mov_b32 exec_hi, 1
    v_mul_f32 v235, v235, v246
    v_xor_b32 v244, 0x80000000, v233
    v_cvt_pk_bf16_f32 v235, v235, v235
    buffer_store_dwordx4 v[244:247], v232, s[28:31], s70 offen sc1
    v_ashrrev_i32 v237, 31, v235
    v_or_b32 v237, 0x80000000, v237
    v_xor_b32 v235, v235, v237
    v_bfi_b32 v248, s55, v235, v239
    buffer_store_dwordx2 v[248:249], v243, s[28:31], s71 offen sc1
    s_mov_b64 exec, -1
    s_cmp_ge_u32 s56, 27
    s_cbranch_scc1 FC_SPARE
    v_bfe_u32 v7, v1, 2, 2
    v_and_b32 v8, 3, v1
    v_lshl_add_u32 v6, v5, 3, v7
    v_bfe_u32 v2, v1, 3, 2
    v_xor_b32 v2, s59, v2
    v_lshlrev_b32 v9, 5, v2
    v_lshl_add_u32 v9, v8, 3, v9
    v_lshl_add_u32 v9, v6, 7, v9
    v_add_u32 v8, 65536, v9
    v_mov_b32 v176, 0x3f803f80
    v_mov_b32 v177, 0x3f803f80
    v_mov_b32 v178, 0x3f803f80
    v_mov_b32 v179, 0x3f803f80
    v_mov_b32 v180, 0x3f803f80
    v_mov_b32 v181, 0x3f803f80
    v_mov_b32 v182, 0x3f803f80
    v_mov_b32 v183, 0x3f803f80
    v_mov_b32 v184, 0x3f803f80
    v_mov_b32 v185, 0x3f803f80
    v_mov_b32 v186, 0x3f803f80
    v_mov_b32 v187, 0x3f803f80
    v_mov_b32 v188, 0x3f803f80
    v_mov_b32 v189, 0x3f803f80
    v_mov_b32 v190, 0x3f803f80
    v_mov_b32 v191, 0x3f803f80
    v_mov_b32 v192, 0x3f803f80
    v_mov_b32 v193, 0x3f803f80
    v_mov_b32 v194, 0x3f803f80
    v_mov_b32 v195, 0x3f803f80
    v_mov_b32 v196, 0x3f803f80
    v_mov_b32 v197, 0x3f803f80
    v_mov_b32 v198, 0x3f803f80
    v_mov_b32 v199, 0x3f803f80
    v_mov_b32 v200, 0x3f803f80
    v_mov_b32 v201, 0x3f803f80
    v_mov_b32 v202, 0x3f803f80
    v_mov_b32 v203, 0x3f803f80
    v_mov_b32 v204, 0x3f803f80
    v_mov_b32 v205, 0x3f803f80
    v_mov_b32 v206, 0x3f803f80
    v_mov_b32 v207, 0x3f803f80
    v_mov_b32 v208, 0x3f803f80
    v_mov_b32 v209, 0x3f803f80
    v_mov_b32 v210, 0x3f803f80
    v_mov_b32 v211, 0x3f803f80
    v_mov_b32 v212, 0x3f803f80
    v_mov_b32 v213, 0x3f803f80
    v_mov_b32 v214, 0x3f803f80
    v_mov_b32 v215, 0x3f803f80
    v_mov_b32 v216, 0x3f803f80
    v_mov_b32 v217, 0x3f803f80
    v_mov_b32 v218, 0x3f803f80
    v_mov_b32 v219, 0x3f803f80
    v_mov_b32 v220, 0x3f803f80
    v_mov_b32 v221, 0x3f803f80
    v_mov_b32 v222, 0x3f803f80
    v_mov_b32 v223, 0x3f803f80
    v_mov_b32 v224, 0x3f803f80
    v_mov_b32 v225, 0x3f803f80
    v_mov_b32 v226, 0x3f803f80
    v_mov_b32 v227, 0x3f803f80
    v_mov_b32 v228, 0x3f803f80
    v_mov_b32 v229, 0x3f803f80
    v_mov_b32 v230, 0x3f803f80
    v_mov_b32 v231, 0x3f803f80
    v_mov_b32 v232, 0x3f803f80
    v_mov_b32 v233, 0x3f803f80
    v_mov_b32 v234, 0x3f803f80
    v_mov_b32 v235, 0x3f803f80
    v_mov_b32 v236, 0x3f803f80
    v_mov_b32 v237, 0x3f803f80
    v_mov_b32 v238, 0x3f803f80
    v_mov_b32 v239, 0x3f803f80
    v_mov_b32 v240, 0x3f803f80
    v_mov_b32 v241, 0x3f803f80
    v_mov_b32 v242, 0x3f803f80
    v_mov_b32 v243, 0x3f803f80
    v_mov_b32 v244, 0x3f803f80
    v_mov_b32 v245, 0x3f803f80
    v_mov_b32 v246, 0x3f803f80
    v_mov_b32 v247, 0x3f803f80
    v_mov_b32 v248, 0x3f803f80
    v_mov_b32 v249, 0x3f803f80
    v_mov_b32 v250, 0x3f803f80
    v_mov_b32 v251, 0x3f803f80
    v_mov_b32 v252, 0x3f803f80
    v_mov_b32 v253, 0x3f803f80
    v_mov_b32 v254, 0x3f803f80
    v_mov_b32 v255, 0x3f803f80
    s_lshl2_add_u32 s65, s56, s59
    v_bfe_i32 v17, v1, 0, 1
    v_bfe_u32 v6, v0, 4, 4
    v_lshlrev_b32 v6, 3, v6
    v_add_u32 v6, 157952, v6
    v_lshlrev_b32 v7, 3, v4
    v_add_u32 v7, 157952, v7
    s_barrier
    v_lshlrev_b32 v12, 4, v1
    s_lshl_b32 s62, s59, 12
    s_add_u32 s60, s62, 49152
    buffer_load_dwordx4 v[120:123], v12, s[28:31], s60 offen offset:0 sc1
    buffer_load_dwordx4 v[124:127], v12, s[28:31], s60 offen offset:1024 sc1
    buffer_load_dwordx4 v[128:131], v12, s[28:31], s60 offen offset:2048 sc1
    buffer_load_dwordx4 v[132:135], v12, s[28:31], s60 offen offset:3072 sc1
    ds_read_b64_tr_b16 v[24:25], v9 offset:0
    ds_read_b64_tr_b16 v[26:27], v9 offset:512
    ds_read_b64_tr_b16 v[72:73], v9 offset:16384
    ds_read_b64_tr_b16 v[74:75], v9 offset:16896
    ds_read_b64_tr_b16 v[28:29], v9 offset:4096
    ds_read_b64_tr_b16 v[30:31], v9 offset:4608
    ds_read_b64_tr_b16 v[76:77], v9 offset:20480
    ds_read_b64_tr_b16 v[78:79], v9 offset:20992
    ds_read_b64_tr_b16 v[32:33], v9 offset:8192
    ds_read_b64_tr_b16 v[34:35], v9 offset:8704
    ds_read_b64_tr_b16 v[80:81], v9 offset:24576
    ds_read_b64_tr_b16 v[82:83], v9 offset:25088
    ds_read_b64_tr_b16 v[36:37], v9 offset:12288
    ds_read_b64_tr_b16 v[38:39], v9 offset:12800
    ds_read_b64_tr_b16 v[84:85], v9 offset:28672
    ds_read_b64_tr_b16 v[86:87], v9 offset:29184
    s_waitcnt lgkmcnt(0)
    s_barrier
    s_waitcnt vmcnt(0)
FC_KY_CHK:
    v_xor_b32 v2, s52, v121
    v_bitop3_b32 v2, v123, s52, v2 bitop3:0xbe
    v_bitop3_b32 v2, v125, s52, v2 bitop3:0xbe
    v_bitop3_b32 v2, v127, s52, v2 bitop3:0xbe
    v_bitop3_b32 v2, v129, s52, v2 bitop3:0xbe
    v_bitop3_b32 v2, v131, s52, v2 bitop3:0xbe
    v_bitop3_b32 v2, v133, s52, v2 bitop3:0xbe
    v_bitop3_b32 v2, v135, s52, v2 bitop3:0xbe
    v_cmp_ne_u32 vcc, 0, v2
    s_cbranch_vccz FC_KY_OK
FC_KY_RETRY:
    s_add_u32 s100, s100, 1
    s_cmp_gt_u32 s100, 20000
    s_cbranch_scc1 FC_KY_OK
    s_sleep 16
    s_add_u32 s60, s62, 49152
    buffer_load_dwordx4 v[120:123], v12, s[28:31], s60 offen offset:0 sc1
    buffer_load_dwordx4 v[124:127], v12, s[28:31], s60 offen offset:1024 sc1
    buffer_load_dwordx4 v[128:131], v12, s[28:31], s60 offen offset:2048 sc1
    buffer_load_dwordx4 v[132:135], v12, s[28:31], s60 offen offset:3072 sc1
    s_waitcnt vmcnt(0)
    s_branch FC_KY_CHK
FC_KY_OK:
    v_max_u32 v20, v120, v122
    v_min_u32 v21, v120, v122
    v_med3_u32 v21, v20, v21, v124
    v_max_u32 v20, v20, v124
    v_med3_u32 v21, v20, v21, v126
    v_max_u32 v20, v20, v126
    v_med3_u32 v21, v20, v21, v128
    v_max_u32 v20, v20, v128
    v_med3_u32 v21, v20, v21, v130
    v_max_u32 v20, v20, v130
    v_med3_u32 v21, v20, v21, v132
    v_max_u32 v20, v20, v132
    v_med3_u32 v21, v20, v21, v134
    v_max_u32 v20, v20, v134
    s_nop 1
    v_mov_b32_dpp v22, v20 row_ror:8 row_mask:0xf bank_mask:0xf
    v_mov_b32_dpp v23, v21 row_ror:8 row_mask:0xf bank_mask:0xf
    v_min_u32 v2, v20, v22
    v_max_u32 v20, v20, v22
    v_max3_u32 v21, v21, v23, v2
    s_nop 0
    v_mov_b32_dpp v22, v20 row_ror:4 row_mask:0xf bank_mask:0xf
    v_mov_b32_dpp v23, v21 row_ror:4 row_mask:0xf bank_mask:0xf
    v_min_u32 v2, v20, v22
    v_max_u32 v20, v20, v22
    v_max3_u32 v21, v21, v23, v2
    s_nop 0
    v_mov_b32_dpp v22, v20 row_ror:2 row_mask:0xf bank_mask:0xf
    v_mov_b32_dpp v23, v21 row_ror:2 row_mask:0xf bank_mask:0xf
    v_min_u32 v2, v20, v22
    v_max_u32 v20, v20, v22
    v_max3_u32 v21, v21, v23, v2
    s_nop 0
    v_mov_b32_dpp v22, v20 row_ror:1 row_mask:0xf bank_mask:0xf
    v_mov_b32_dpp v23, v21 row_ror:1 row_mask:0xf bank_mask:0xf
    v_min_u32 v2, v20, v22
    v_max_u32 v20, v20, v22
    v_max3_u32 v21, v21, v23, v2
    ds_write_b64 v6, v[20:21]
    s_waitcnt lgkmcnt(0)
    s_barrier
    ds_read_b64 v[20:21], v7
    s_waitcnt lgkmcnt(0)
    v_mov_b32_dpp v22, v20 row_ror:8 row_mask:0xf bank_mask:0xf
    v_mov_b32_dpp v23, v21 row_ror:8 row_mask:0xf bank_mask:0xf
    v_min_u32 v2, v20, v22
    v_max_u32 v20, v20, v22
    v_max3_u32 v21, v21, v23, v2
    s_nop 0
    v_mov_b32_dpp v22, v20 row_ror:4 row_mask:0xf bank_mask:0xf
    v_mov_b32_dpp v23, v21 row_ror:4 row_mask:0xf bank_mask:0xf
    v_min_u32 v2, v20, v22
    v_max_u32 v20, v20, v22
    v_max3_u32 v21, v21, v23, v2
    s_nop 0
    v_mov_b32_dpp v22, v20 row_ror:2 row_mask:0xf bank_mask:0xf
    v_mov_b32_dpp v23, v21 row_ror:2 row_mask:0xf bank_mask:0xf
    v_min_u32 v2, v20, v22
    v_max_u32 v20, v20, v22
    v_max3_u32 v21, v21, v23, v2
    s_nop 0
    v_mov_b32_dpp v22, v20 row_ror:1 row_mask:0xf bank_mask:0xf
    v_mov_b32_dpp v23, v21 row_ror:1 row_mask:0xf bank_mask:0xf
    v_min_u32 v2, v20, v22
    v_max_u32 v20, v20, v22
    v_max3_u32 v21, v21, v23, v2
    v_bfi_b32 v10, v17, v21, v20
    v_not_b32 v2, v10
    v_and_b32 v2, 2047, v2
    v_mul_u32_u24 v17, 1280, v2
    v_lshrrev_b32 v16, 1, v2
    v_and_b32 v3, 1, v2
    v_lshl_add_u32 v16, v3, 10, v16
    v_readlane_b32 s60, v17, 0
    v_readlane_b32 s61, v17, 1
    v_lshlrev_b32 v16, 4, v16
    v_add_u32 v16, 16384, v16
    s_mul_i32 s62, s59, 2624
    s_add_u32 s62, s62, 147456
    s_add_u32 m0, s62, 0
    s_nop 0
    buffer_load_dwordx4 v12, s[24:27], s60 offen lds
    s_add_u32 m0, s62, 1344
    s_nop 0
    buffer_load_dwordx4 v12, s[24:27], s61 offen lds
    s_mov_b64 exec, 0xffff
    s_add_u32 m0, s62, 0
    s_nop 0
    buffer_load_dwordx4 v12, s[24:27], s60 offen offset:1024 lds
    s_add_u32 m0, s62, 1344
    s_nop 0
    buffer_load_dwordx4 v12, s[24:27], s61 offen offset:1024 lds
    s_mov_b32 exec_lo, 0x00030003
    s_mov_b32 exec_hi, 0x00030003
    buffer_load_dwordx4 v[20:23], v16, s[28:31], 0 offen
    s_mov_b64 exec, -1
    v_and_b32 v17, 1, v1
    v_mul_u32_u24 v17, 1344, v17
    v_lshl_add_u32 v17, v5, 4, v17
    v_add_u32 v17, s62, v17
    ds_read_b64_tr_b16 v[40:41], v9 offset:32768
    ds_read_b64_tr_b16 v[42:43], v9 offset:33280
    ds_read_b64_tr_b16 v[88:89], v9 offset:49152
    ds_read_b64_tr_b16 v[90:91], v9 offset:49664
    ds_read_b64_tr_b16 v[44:45], v9 offset:36864
    ds_read_b64_tr_b16 v[46:47], v9 offset:37376
    ds_read_b64_tr_b16 v[92:93], v9 offset:53248
    ds_read_b64_tr_b16 v[94:95], v9 offset:53760
    ds_read_b64_tr_b16 v[48:49], v9 offset:40960
    ds_read_b64_tr_b16 v[50:51], v9 offset:41472
    ds_read_b64_tr_b16 v[96:97], v9 offset:57344
    ds_read_b64_tr_b16 v[98:99], v9 offset:57856
    ds_read_b64_tr_b16 v[52:53], v9 offset:45056
    ds_read_b64_tr_b16 v[54:55], v9 offset:45568
    ds_read_b64_tr_b16 v[100:101], v9 offset:61440
    ds_read_b64_tr_b16 v[102:103], v9 offset:61952
    ds_read_b64_tr_b16 v[56:57], v8 offset:0
    ds_read_b64_tr_b16 v[58:59], v8 offset:512
    ds_read_b64_tr_b16 v[104:105], v8 offset:16384
    ds_read_b64_tr_b16 v[106:107], v8 offset:16896
    ds_read_b64_tr_b16 v[60:61], v8 offset:4096
    ds_read_b64_tr_b16 v[62:63], v8 offset:4608
    ds_read_b64_tr_b16 v[108:109], v8 offset:20480
    ds_read_b64_tr_b16 v[110:111], v8 offset:20992
    ds_read_b64_tr_b16 v[64:65], v8 offset:8192
    ds_read_b64_tr_b16 v[66:67], v8 offset:8704
    ds_read_b64_tr_b16 v[112:113], v8 offset:24576
    ds_read_b64_tr_b16 v[114:115], v8 offset:25088
    ds_read_b64_tr_b16 v[68:69], v8 offset:12288
    ds_read_b64_tr_b16 v[70:71], v8 offset:12800
    ds_read_b64_tr_b16 v[116:117], v8 offset:28672
    ds_read_b64_tr_b16 v[118:119], v8 offset:29184
    s_waitcnt vmcnt(0)
    s_mov_b32 exec_lo, 0x00030003
    s_mov_b32 exec_hi, 0x00030003
    ds_read_b128 v[176:179], v17 offset:0
    ds_read_b128 v[180:183], v17 offset:64
    ds_read_b128 v[184:187], v17 offset:128
    ds_read_b128 v[188:191], v17 offset:192
    ds_read_b128 v[192:195], v17 offset:256
    ds_read_b128 v[196:199], v17 offset:320
    ds_read_b128 v[200:203], v17 offset:384
    ds_read_b128 v[204:207], v17 offset:448
    ds_read_b128 v[208:211], v17 offset:512
    ds_read_b128 v[212:215], v17 offset:576
    ds_read_b128 v[216:219], v17 offset:640
    ds_read_b128 v[220:223], v17 offset:704
    ds_read_b128 v[224:227], v17 offset:768
    ds_read_b128 v[228:231], v17 offset:832
    ds_read_b128 v[232:235], v17 offset:896
    ds_read_b128 v[236:239], v17 offset:960
    ds_read_b128 v[240:243], v17 offset:1024
    ds_read_b128 v[244:247], v17 offset:1088
    ds_read_b128 v[248:251], v17 offset:1152
    ds_read_b128 v[252:255], v17 offset:1216
    s_mov_b64 exec, -1
    s_waitcnt lgkmcnt(15)
    v_mfma_f32_16x16x32_bf16 v[152:155], v[24:27], v[176:179], 0
    v_mfma_f32_16x16x32_bf16 v[156:159], v[72:75], v[176:179], 0
    v_mfma_f32_16x16x32_bf16 v[152:155], v[28:31], v[180:183], v[152:155]
    v_mfma_f32_16x16x32_bf16 v[156:159], v[76:79], v[180:183], v[156:159]
    v_mfma_f32_16x16x32_bf16 v[152:155], v[32:35], v[184:187], v[152:155]
    v_mfma_f32_16x16x32_bf16 v[156:159], v[80:83], v[184:187], v[156:159]
    v_mfma_f32_16x16x32_bf16 v[152:155], v[36:39], v[188:191], v[152:155]
    v_mfma_f32_16x16x32_bf16 v[156:159], v[84:87], v[188:191], v[156:159]
    s_waitcnt lgkmcnt(12)
    v_mfma_f32_16x16x32_bf16 v[152:155], v[40:43], v[192:195], v[152:155]
    v_mfma_f32_16x16x32_bf16 v[156:159], v[88:91], v[192:195], v[156:159]
    v_mfma_f32_16x16x32_bf16 v[152:155], v[44:47], v[196:199], v[152:155]
    v_mfma_f32_16x16x32_bf16 v[156:159], v[92:95], v[196:199], v[156:159]
    v_mfma_f32_16x16x32_bf16 v[152:155], v[48:51], v[200:203], v[152:155]
    v_mfma_f32_16x16x32_bf16 v[156:159], v[96:99], v[200:203], v[156:159]
    v_mfma_f32_16x16x32_bf16 v[152:155], v[52:55], v[204:207], v[152:155]
    v_mfma_f32_16x16x32_bf16 v[156:159], v[100:103], v[204:207], v[156:159]
    s_waitcnt lgkmcnt(8)
    v_mfma_f32_16x16x32_bf16 v[152:155], v[56:59], v[208:211], v[152:155]
    v_mfma_f32_16x16x32_bf16 v[156:159], v[104:107], v[208:211], v[156:159]
    v_mfma_f32_16x16x32_bf16 v[152:155], v[60:63], v[212:215], v[152:155]
    v_mfma_f32_16x16x32_bf16 v[156:159], v[108:111], v[212:215], v[156:159]
    v_mfma_f32_16x16x32_bf16 v[152:155], v[64:67], v[216:219], v[152:155]
    v_mfma_f32_16x16x32_bf16 v[156:159], v[112:115], v[216:219], v[156:159]
    v_mfma_f32_16x16x32_bf16 v[152:155], v[68:71], v[220:223], v[152:155]
    v_mfma_f32_16x16x32_bf16 v[156:159], v[116:119], v[220:223], v[156:159]
    s_barrier
    ds_read_b64_tr_b16 v[120:121], v8 offset:32768
    ds_read_b64_tr_b16 v[122:123], v8 offset:33280
    ds_read_b64_tr_b16 v[136:137], v8 offset:49152
    ds_read_b64_tr_b16 v[138:139], v8 offset:49664
    ds_read_b64_tr_b16 v[124:125], v8 offset:36864
    ds_read_b64_tr_b16 v[126:127], v8 offset:37376
    ds_read_b64_tr_b16 v[140:141], v8 offset:53248
    ds_read_b64_tr_b16 v[142:143], v8 offset:53760
    ds_read_b64_tr_b16 v[128:129], v8 offset:40960
    ds_read_b64_tr_b16 v[130:131], v8 offset:41472
    ds_read_b64_tr_b16 v[144:145], v8 offset:57344
    ds_read_b64_tr_b16 v[146:147], v8 offset:57856
    ds_read_b64_tr_b16 v[132:133], v8 offset:45056
    ds_read_b64_tr_b16 v[134:135], v8 offset:45568
    ds_read_b64_tr_b16 v[148:149], v8 offset:61440
    ds_read_b64_tr_b16 v[150:151], v8 offset:61952
    ds_read_b64_tr_b16 v[24:25], v9 offset:0
    ds_read_b64_tr_b16 v[26:27], v9 offset:512
    ds_read_b64_tr_b16 v[72:73], v9 offset:16384
    ds_read_b64_tr_b16 v[74:75], v9 offset:16896
    ds_read_b64_tr_b16 v[28:29], v9 offset:4096
    ds_read_b64_tr_b16 v[30:31], v9 offset:4608
    ds_read_b64_tr_b16 v[76:77], v9 offset:20480
    ds_read_b64_tr_b16 v[78:79], v9 offset:20992
    ds_read_b64_tr_b16 v[32:33], v9 offset:8192
    ds_read_b64_tr_b16 v[34:35], v9 offset:8704
    ds_read_b64_tr_b16 v[80:81], v9 offset:24576
    ds_read_b64_tr_b16 v[82:83], v9 offset:25088
    ds_read_b64_tr_b16 v[36:37], v9 offset:12288
    ds_read_b64_tr_b16 v[38:39], v9 offset:12800
    ds_read_b64_tr_b16 v[84:85], v9 offset:28672
    ds_read_b64_tr_b16 v[86:87], v9 offset:29184
    s_waitcnt lgkmcnt(15)
    v_mfma_f32_16x16x32_bf16 v[152:155], v[120:123], v[224:227], v[152:155]
    v_mfma_f32_16x16x32_bf16 v[156:159], v[136:139], v[224:227], v[156:159]
    v_mfma_f32_16x16x32_bf16 v[152:155], v[124:127], v[228:231], v[152:155]
    v_mfma_f32_16x16x32_bf16 v[156:159], v[140:143], v[228:231], v[156:159]
    v_mfma_f32_16x16x32_bf16 v[152:155], v[128:131], v[232:235], v[152:155]
    v_mfma_f32_16x16x32_bf16 v[156:159], v[144:147], v[232:235], v[156:159]
    v_mfma_f32_16x16x32_bf16 v[152:155], v[132:135], v[236:239], v[152:155]
    v_mfma_f32_16x16x32_bf16 v[156:159], v[148:151], v[236:239], v[156:159]
    s_waitcnt lgkmcnt(0)
    v_mfma_f32_16x16x32_bf16 v[152:155], v[24:27], v[240:243], v[152:155]
    v_mfma_f32_16x16x32_bf16 v[156:159], v[72:75], v[240:243], v[156:159]
    v_mfma_f32_16x16x32_bf16 v[152:155], v[28:31], v[244:247], v[152:155]
    v_mfma_f32_16x16x32_bf16 v[156:159], v[76:79], v[244:247], v[156:159]
    v_mfma_f32_16x16x32_bf16 v[152:155], v[32:35], v[248:251], v[152:155]
    v_mfma_f32_16x16x32_bf16 v[156:159], v[80:83], v[248:251], v[156:159]
    v_mfma_f32_16x16x32_bf16 v[152:155], v[36:39], v[252:255], v[152:155]
    v_mfma_f32_16x16x32_bf16 v[156:159], v[84:87], v[252:255], v[156:159]
    s_mov_b32 exec_lo, 0x00030003
    s_mov_b32 exec_hi, 0x00030003
    s_waitcnt vmcnt(0)
FC_RC_CHK:
    v_xor_b32 v2, s52, v21
    v_bitop3_b32 v2, v23, s52, v2 bitop3:0xbe
    v_cmp_ne_u32 vcc, 0, v2
    s_cbranch_vccz FC_RC_OK
FC_RC_RETRY:
    s_add_u32 s100, s100, 1
    s_cmp_gt_u32 s100, 20000
    s_cbranch_scc1 FC_RC_OK
    s_sleep 2
    buffer_load_dwordx4 v[20:23], v16, s[28:31], 0 offen sc1
    s_waitcnt vmcnt(0)
    s_branch FC_RC_CHK
FC_RC_OK:
    s_mov_b64 exec, -1
    v_mov_b32_dpp v160, v152 row_newbcast:2 row_mask:0xf bank_mask:0xf
    v_mov_b32_dpp v164, v156 row_newbcast:2 row_mask:0xf bank_mask:0xf
    v_mov_b32_dpp v161, v153 row_newbcast:2 row_mask:0xf bank_mask:0xf
    v_mov_b32_dpp v165, v157 row_newbcast:2 row_mask:0xf bank_mask:0xf
    v_mov_b32_dpp v162, v154 row_newbcast:2 row_mask:0xf bank_mask:0xf
    v_mov_b32_dpp v166, v158 row_newbcast:2 row_mask:0xf bank_mask:0xf
    v_mov_b32_dpp v163, v155 row_newbcast:2 row_mask:0xf bank_mask:0xf
    v_mov_b32_dpp v167, v159 row_newbcast:2 row_mask:0xf bank_mask:0xf
    v_fma_f32 v152, v20, v160, v152
    v_fma_f32 v156, v20, v164, v156
    v_fma_f32 v153, v20, v161, v153
    v_fma_f32 v157, v20, v165, v157
    v_fma_f32 v154, v20, v162, v154
    v_fma_f32 v158, v20, v166, v158
    v_fma_f32 v155, v20, v163, v155
    v_fma_f32 v159, v20, v167, v159
    v_mul_f32 v152, v152, v22
    v_mul_f32 v156, v156, v22
    v_mul_f32 v153, v153, v22
    v_mul_f32 v157, v157, v22
    v_mul_f32 v154, v154, v22
    v_mul_f32 v158, v158, v22
    v_mul_f32 v155, v155, v22
    v_mul_f32 v159, v159, v22
    v_cvt_pk_bf16_f32 v152, v152, v156
    v_cvt_pk_bf16_f32 v153, v153, v157
    v_cvt_pk_bf16_f32 v154, v154, v158
    v_cvt_pk_bf16_f32 v155, v155, v159
    v_and_b32 v156, s55, v152
    v_lshlrev_b32 v152, 16, v152
    v_and_b32 v157, s55, v153
    v_lshlrev_b32 v153, 16, v153
    v_and_b32 v158, s55, v154
    v_lshlrev_b32 v154, 16, v154
    v_and_b32 v159, s55, v155
    v_lshlrev_b32 v155, 16, v155
    v_mul_f32 v160, 0xbfb8aa3b, v152
    v_mul_f32 v161, 0xbfb8aa3b, v153
    v_mul_f32 v162, 0xbfb8aa3b, v154
    v_mul_f32 v163, 0xbfb8aa3b, v155
    v_exp_f32 v160, v160
    v_exp_f32 v161, v161
    v_exp_f32 v162, v162
    v_exp_f32 v163, v163
    v_add_f32 v160, 1.0, v160
    v_add_f32 v161, 1.0, v161
    v_add_f32 v162, 1.0, v162
    v_add_f32 v163, 1.0, v163
    v_rcp_f32 v160, v160
    v_rcp_f32 v161, v161
    v_rcp_f32 v162, v162
    v_rcp_f32 v163, v163
    v_mul_f32 v152, v152, v160
    v_mul_f32 v153, v153, v161
    v_mul_f32 v154, v154, v162
    v_mul_f32 v155, v155, v163
    v_cvt_pk_bf16_f32 v152, v152, v152
    v_cvt_pk_bf16_f32 v153, v153, v153
    v_cvt_pk_bf16_f32 v154, v154, v154
    v_cvt_pk_bf16_f32 v155, v155, v155
    v_lshlrev_b32 v152, 16, v152
    v_lshlrev_b32 v153, 16, v153
    v_lshlrev_b32 v154, 16, v154
    v_lshlrev_b32 v155, 16, v155
    v_mul_f32 v152, v152, v156
    v_mul_f32 v153, v153, v157
    v_mul_f32 v154, v154, v158
    v_mul_f32 v155, v155, v159
    v_cvt_pk_bf16_f32 v152, v152, v153
    v_cvt_pk_bf16_f32 v154, v154, v155
    v_mov_b32 v153, s52
    v_mov_b32 v155, s52
    v_lshlrev_b32 v3, 6, v4
    v_lshl_add_u32 v3, v5, 4, v3
    s_lshl_b32 s60, s65, 7
    s_add_u32 s60, s60, 425984
    s_mov_b32 exec_lo, 0x00030003
    s_mov_b32 exec_hi, 0x00030003
    buffer_store_dwordx4 v[152:155], v3, s[28:31], s60 offen sc1
    s_mov_b64 exec, -1
    s_branch K_END
FC_SPARE:
    v_bfe_u32 v7, v1, 2, 2
    v_and_b32 v8, 3, v1
    v_and_b32 v3, 1, v5
    v_lshl_or_b32 v12, v3, 2, v7
    v_lshl_add_u32 v6, v5, 3, v7
    v_lshlrev_b32 v13, 8, v6
    v_lshl_add_u32 v13, v8, 3, v13
    s_lshl3_add_u32 s60, s56, s3
    s_lshl_b32 s60, s60, 10
    s_add_u32 s60, s60, 827392
    v_mov_b32 v108, -1
    v_mov_b32 v109, -1
    v_mov_b32 v110, -1
    v_mov_b32 v111, -1
    v_lshlrev_b32 v15, 4, v1
FC_CLR:
    buffer_store_dwordx4 v[108:111], v15, s[28:31], s60 offen sc1
    s_add_u32 s60, s60, 237568
    s_cmp_lt_u32 s60, 3977216
    s_cbranch_scc1 FC_CLR
    s_lshl_b32 s64, s56, 7
    s_add_u32 s64, s64, 4736
    v_mov_b32 v104, s52
    v_mov_b32 v105, s52
    v_mov_b32 v106, s52
    v_mov_b32 v107, s52
    s_waitcnt vmcnt(0)
    s_barrier
    s_cmp_lg_u32 s59, 0
    s_cbranch_scc1 FC_NOFL
    s_mov_b64 exec, 0xff
    buffer_store_dwordx4 v[104:107], v15, s[28:31], s64 offen sc1
    s_mov_b64 exec, -1
FC_NOFL:
    s_lshl2_add_u32 s60, s56, s59
    s_cmp_eq_u32 s60, 221
    s_cbranch_scc1 FC_TOP
    s_cmp_lg_u32 s54, 30
    s_cbranch_scc1 FC_NOWR
    s_and_b32 s60, s2, 4
    s_add_u32 s60, s60, s59
    s_lshl_b32 s60, s60, 12
    s_add_u32 s60, s60, 16384
    buffer_load_dwordx4 v[168:171], v15, s[28:31], s60 offen offset:0
    buffer_load_dwordx4 v[168:171], v15, s[28:31], s60 offen offset:1024
    buffer_load_dwordx4 v[168:171], v15, s[28:31], s60 offen offset:2048
    buffer_load_dwordx4 v[168:171], v15, s[28:31], s60 offen offset:3072
FC_NOWR:
    s_barrier
    s_mul_i32 s60, s59, 10
    s_add_u32 s60, s60, 0
    s_and_b32 s61, s60, 7
    s_lshr_b32 s60, s60, 3
    s_lshl_b32 s60, s60, 14
    v_xor_b32 v2, s61, v12
    v_lshl_add_u32 v2, v2, 5, v13
    v_add_u32 v2, s60, v2
    ds_read_b64_tr_b16 v[24:25], v2 offset:0
    ds_read_b64_tr_b16 v[26:27], v2 offset:1024
    ds_read_b64_tr_b16 v[28:29], v2 offset:8192
    ds_read_b64_tr_b16 v[30:31], v2 offset:9216
    s_mul_i32 s60, s59, 10
    s_add_u32 s60, s60, 1
    s_and_b32 s61, s60, 7
    s_lshr_b32 s60, s60, 3
    s_lshl_b32 s60, s60, 14
    v_xor_b32 v2, s61, v12
    v_lshl_add_u32 v2, v2, 5, v13
    v_add_u32 v2, s60, v2
    ds_read_b64_tr_b16 v[32:33], v2 offset:0
    ds_read_b64_tr_b16 v[34:35], v2 offset:1024
    ds_read_b64_tr_b16 v[36:37], v2 offset:8192
    ds_read_b64_tr_b16 v[38:39], v2 offset:9216
    s_mul_i32 s60, s59, 10
    s_add_u32 s60, s60, 2
    s_and_b32 s61, s60, 7
    s_lshr_b32 s60, s60, 3
    s_lshl_b32 s60, s60, 14
    v_xor_b32 v2, s61, v12
    v_lshl_add_u32 v2, v2, 5, v13
    v_add_u32 v2, s60, v2
    ds_read_b64_tr_b16 v[40:41], v2 offset:0
    ds_read_b64_tr_b16 v[42:43], v2 offset:1024
    ds_read_b64_tr_b16 v[44:45], v2 offset:8192
    ds_read_b64_tr_b16 v[46:47], v2 offset:9216
    s_mul_i32 s60, s59, 10
    s_add_u32 s60, s60, 3
    s_and_b32 s61, s60, 7
    s_lshr_b32 s60, s60, 3
    s_lshl_b32 s60, s60, 14
    v_xor_b32 v2, s61, v12
    v_lshl_add_u32 v2, v2, 5, v13
    v_add_u32 v2, s60, v2
    ds_read_b64_tr_b16 v[48:49], v2 offset:0
    ds_read_b64_tr_b16 v[50:51], v2 offset:1024
    ds_read_b64_tr_b16 v[52:53], v2 offset:8192
    ds_read_b64_tr_b16 v[54:55], v2 offset:9216
    s_mul_i32 s60, s59, 10
    s_add_u32 s60, s60, 4
    s_and_b32 s61, s60, 7
    s_lshr_b32 s60, s60, 3
    s_lshl_b32 s60, s60, 14
    v_xor_b32 v2, s61, v12
    v_lshl_add_u32 v2, v2, 5, v13
    v_add_u32 v2, s60, v2
    ds_read_b64_tr_b16 v[56:57], v2 offset:0
    ds_read_b64_tr_b16 v[58:59], v2 offset:1024
    ds_read_b64_tr_b16 v[60:61], v2 offset:8192
    ds_read_b64_tr_b16 v[62:63], v2 offset:9216
    s_mul_i32 s60, s59, 10
    s_add_u32 s60, s60, 5
    s_and_b32 s61, s60, 7
    s_lshr_b32 s60, s60, 3
    s_lshl_b32 s60, s60, 14
    v_xor_b32 v2, s61, v12
    v_lshl_add_u32 v2, v2, 5, v13
    v_add_u32 v2, s60, v2
    ds_read_b64_tr_b16 v[64:65], v2 offset:0
    ds_read_b64_tr_b16 v[66:67], v2 offset:1024
    ds_read_b64_tr_b16 v[68:69], v2 offset:8192
    ds_read_b64_tr_b16 v[70:71], v2 offset:9216
    s_mul_i32 s60, s59, 10
    s_add_u32 s60, s60, 6
    s_and_b32 s61, s60, 7
    s_lshr_b32 s60, s60, 3
    s_lshl_b32 s60, s60, 14
    v_xor_b32 v2, s61, v12
    v_lshl_add_u32 v2, v2, 5, v13
    v_add_u32 v2, s60, v2
    ds_read_b64_tr_b16 v[72:73], v2 offset:0
    ds_read_b64_tr_b16 v[74:75], v2 offset:1024
    ds_read_b64_tr_b16 v[76:77], v2 offset:8192
    ds_read_b64_tr_b16 v[78:79], v2 offset:9216
    s_mul_i32 s60, s59, 10
    s_add_u32 s60, s60, 7
    s_and_b32 s61, s60, 7
    s_lshr_b32 s60, s60, 3
    s_lshl_b32 s60, s60, 14
    v_xor_b32 v2, s61, v12
    v_lshl_add_u32 v2, v2, 5, v13
    v_add_u32 v2, s60, v2
    ds_read_b64_tr_b16 v[80:81], v2 offset:0
    ds_read_b64_tr_b16 v[82:83], v2 offset:1024
    ds_read_b64_tr_b16 v[84:85], v2 offset:8192
    ds_read_b64_tr_b16 v[86:87], v2 offset:9216
    s_mul_i32 s60, s59, 10
    s_add_u32 s60, s60, 8
    s_and_b32 s61, s60, 7
    s_lshr_b32 s60, s60, 3
    s_lshl_b32 s60, s60, 14
    v_xor_b32 v2, s61, v12
    v_lshl_add_u32 v2, v2, 5, v13
    v_add_u32 v2, s60, v2
    ds_read_b64_tr_b16 v[88:89], v2 offset:0
    ds_read_b64_tr_b16 v[90:91], v2 offset:1024
    ds_read_b64_tr_b16 v[92:93], v2 offset:8192
    ds_read_b64_tr_b16 v[94:95], v2 offset:9216
    s_mul_i32 s60, s59, 10
    s_add_u32 s60, s60, 9
    s_and_b32 s61, s60, 7
    s_lshr_b32 s60, s60, 3
    s_lshl_b32 s60, s60, 14
    v_xor_b32 v2, s61, v12
    v_lshl_add_u32 v2, v2, 5, v13
    v_add_u32 v2, s60, v2
    ds_read_b64_tr_b16 v[96:97], v2 offset:0
    ds_read_b64_tr_b16 v[98:99], v2 offset:1024
    ds_read_b64_tr_b16 v[100:101], v2 offset:8192
    ds_read_b64_tr_b16 v[102:103], v2 offset:9216
    v_lshrrev_b32 v14, 1, v5
    v_lshlrev_b32 v14, 7, v14
    v_and_b32 v2, 1, v1
    v_lshl_add_u32 v14, v2, 6, v14
    v_lshl_add_u32 v14, v3, 5, v14
    s_sub_u32 s63, s56, 27
    s_waitcnt lgkmcnt(0)
    s_cmp_ge_u32 s63, 27
    s_cbranch_scc1 K_END
    s_lshl_b32 s65, s63, 9
    s_add_u32 s65, s65, 425984
    s_mov_b32 exec_lo, 0x33333333
    s_mov_b32 exec_hi, 0x33333333
    buffer_load_dwordx4 v[112:115], v14, s[28:31], s65 offen offset:0 sc1
    buffer_load_dwordx4 v[116:119], v14, s[28:31], s65 offen offset:16 sc1
    buffer_load_dwordx4 v[120:123], v14, s[28:31], s65 offen offset:256 sc1
    buffer_load_dwordx4 v[124:127], v14, s[28:31], s65 offen offset:272 sc1
    s_waitcnt vmcnt(0)
D_H_CHK:
    v_xor_b32 v2, s52, v113
    v_bitop3_b32 v2, v115, s52, v2 bitop3:0xbe
    v_bitop3_b32 v2, v117, s52, v2 bitop3:0xbe
    v_bitop3_b32 v2, v119, s52, v2 bitop3:0xbe
    v_bitop3_b32 v2, v121, s52, v2 bitop3:0xbe
    v_bitop3_b32 v2, v123, s52, v2 bitop3:0xbe
    v_bitop3_b32 v2, v125, s52, v2 bitop3:0xbe
    v_bitop3_b32 v2, v127, s52, v2 bitop3:0xbe
    v_cmp_ne_u32 vcc, 0, v2
    s_cbranch_vccz D_H_OK
D_H_RETRY:
    s_add_u32 s100, s100, 1
    s_cmp_gt_u32 s100, 20000
    s_cbranch_scc1 D_H_OK
    s_sleep 6
    buffer_load_dwordx4 v[112:115], v14, s[28:31], s65 offen offset:0 sc1
    buffer_load_dwordx4 v[116:119], v14, s[28:31], s65 offen offset:16 sc1
    buffer_load_dwordx4 v[120:123], v14, s[28:31], s65 offen offset:256 sc1
    buffer_load_dwordx4 v[124:127], v14, s[28:31], s65 offen offset:272 sc1
    s_waitcnt vmcnt(0)
    s_branch D_H_CHK
D_H_OK:
    s_mov_b64 exec, -1
    v_mov_b32 v132, v112
    v_mov_b32 v133, v114
    v_mov_b32 v134, v116
    v_mov_b32 v135, v118
    v_mov_b32 v136, v120
    v_mov_b32 v137, v122
    v_mov_b32 v138, v124
    v_mov_b32 v139, v126
    v_mfma_f32_16x16x32_bf16 v[176:179], v[132:135], v[24:27], 0
    v_mfma_f32_16x16x32_bf16 v[180:183], v[132:135], v[32:35], 0
    v_mfma_f32_16x16x32_bf16 v[184:187], v[132:135], v[40:43], 0
    v_mfma_f32_16x16x32_bf16 v[188:191], v[132:135], v[48:51], 0
    v_mfma_f32_16x16x32_bf16 v[192:195], v[132:135], v[56:59], 0
    v_mfma_f32_16x16x32_bf16 v[196:199], v[132:135], v[64:67], 0
    v_mfma_f32_16x16x32_bf16 v[200:203], v[132:135], v[72:75], 0
    v_mfma_f32_16x16x32_bf16 v[204:207], v[132:135], v[80:83], 0
    v_mfma_f32_16x16x32_bf16 v[208:211], v[132:135], v[88:91], 0
    v_mfma_f32_16x16x32_bf16 v[212:215], v[132:135], v[96:99], 0
    v_mfma_f32_16x16x32_bf16 v[176:179], v[136:139], v[28:31], v[176:179]
    v_mfma_f32_16x16x32_bf16 v[180:183], v[136:139], v[36:39], v[180:183]
    v_mfma_f32_16x16x32_bf16 v[184:187], v[136:139], v[44:47], v[184:187]
    v_mfma_f32_16x16x32_bf16 v[188:191], v[136:139], v[52:55], v[188:191]
    v_mfma_f32_16x16x32_bf16 v[192:195], v[136:139], v[60:63], v[192:195]
    v_mfma_f32_16x16x32_bf16 v[196:199], v[136:139], v[68:71], v[196:199]
    v_mfma_f32_16x16x32_bf16 v[200:203], v[136:139], v[76:79], v[200:203]
    v_mfma_f32_16x16x32_bf16 v[204:207], v[136:139], v[84:87], v[204:207]
    v_mfma_f32_16x16x32_bf16 v[208:211], v[136:139], v[92:95], v[208:211]
    v_mfma_f32_16x16x32_bf16 v[212:215], v[136:139], v[100:103], v[212:215]
    v_lshlrev_b32 v2, 3, v1
    s_mul_i32 s60, s59, 1280
    s_mul_i32 s61, s63, 5120
    s_add_u32 s60, s60, s61
    s_add_u32 s60, s60, 131072
    s_add_u32 s61, s60, 138240
    v_mov_b32 v141, s52
    v_mov_b32 v143, s52
    v_mov_b32 v145, s52
    v_mov_b32 v147, s52
    v_mov_b32 v149, s52
    v_mov_b32 v151, s52
    s_mov_b32 exec_lo, 0xffff
    s_mov_b32 exec_hi, 0
    v_mov_b32 v140, v176
    v_mov_b32 v142, v177
    v_mov_b32 v144, v192
    v_mov_b32 v146, v193
    v_mov_b32 v148, v208
    v_mov_b32 v150, v209
    s_mov_b32 exec_lo, 0xffff0000
    s_mov_b32 exec_hi, 0
    v_mov_b32 v140, v180
    v_mov_b32 v142, v181
    v_mov_b32 v144, v196
    v_mov_b32 v146, v197
    v_mov_b32 v148, v212
    v_mov_b32 v150, v213
    s_mov_b32 exec_lo, 0
    s_mov_b32 exec_hi, 0xffff
    v_mov_b32 v140, v184
    v_mov_b32 v142, v185
    v_mov_b32 v144, v200
    v_mov_b32 v146, v201
    s_mov_b32 exec_lo, 0
    s_mov_b32 exec_hi, 0xffff0000
    v_mov_b32 v140, v188
    v_mov_b32 v142, v189
    v_mov_b32 v144, v204
    v_mov_b32 v146, v205
    s_mov_b64 exec, -1
    buffer_store_dwordx2 v[140:141], v2, s[28:31], s60 offen offset:0 sc1
    buffer_store_dwordx2 v[142:143], v2, s[28:31], s61 offen offset:0 sc1
    buffer_store_dwordx2 v[144:145], v2, s[28:31], s60 offen offset:512 sc1
    buffer_store_dwordx2 v[146:147], v2, s[28:31], s61 offen offset:512 sc1
    s_mov_b32 exec_hi, 0
    buffer_store_dwordx2 v[148:149], v2, s[28:31], s60 offen offset:1024 sc1
    buffer_store_dwordx2 v[150:151], v2, s[28:31], s61 offen offset:1024 sc1
    s_mov_b64 exec, -1
    s_branch K_END
FC_TOP:
    v_lshlrev_b32 v12, 4, v1
    s_mov_b32 s62, 0
    s_add_u32 s60, s62, 49152
    buffer_load_dwordx4 v[88:91], v12, s[28:31], s60 offen offset:0 sc1
    buffer_load_dwordx4 v[92:95], v12, s[28:31], s60 offen offset:1024 sc1
    buffer_load_dwordx4 v[96:99], v12, s[28:31], s60 offen offset:2048 sc1
    buffer_load_dwordx4 v[100:103], v12, s[28:31], s60 offen offset:3072 sc1
    s_add_u32 s60, s62, 53248
    buffer_load_dwordx4 v[104:107], v12, s[28:31], s60 offen offset:0 sc1
    buffer_load_dwordx4 v[108:111], v12, s[28:31], s60 offen offset:1024 sc1
    buffer_load_dwordx4 v[112:115], v12, s[28:31], s60 offen offset:2048 sc1
    buffer_load_dwordx4 v[116:119], v12, s[28:31], s60 offen offset:3072 sc1
    s_add_u32 s60, s62, 57344
    buffer_load_dwordx4 v[120:123], v12, s[28:31], s60 offen offset:0 sc1
    buffer_load_dwordx4 v[124:127], v12, s[28:31], s60 offen offset:1024 sc1
    buffer_load_dwordx4 v[128:131], v12, s[28:31], s60 offen offset:2048 sc1
    buffer_load_dwordx4 v[132:135], v12, s[28:31], s60 offen offset:3072 sc1
    s_add_u32 s60, s62, 61440
    buffer_load_dwordx4 v[136:139], v12, s[28:31], s60 offen offset:0 sc1
    buffer_load_dwordx4 v[140:143], v12, s[28:31], s60 offen offset:1024 sc1
    buffer_load_dwordx4 v[144:147], v12, s[28:31], s60 offen offset:2048 sc1
    buffer_load_dwordx4 v[148:151], v12, s[28:31], s60 offen offset:3072 sc1
    s_waitcnt vmcnt(0)
T_KY_CHK:
    v_xor_b32 v2, s52, v89
    v_bitop3_b32 v2, v91, s52, v2 bitop3:0xbe
    v_bitop3_b32 v2, v93, s52, v2 bitop3:0xbe
    v_bitop3_b32 v2, v95, s52, v2 bitop3:0xbe
    v_bitop3_b32 v2, v97, s52, v2 bitop3:0xbe
    v_bitop3_b32 v2, v99, s52, v2 bitop3:0xbe
    v_bitop3_b32 v2, v101, s52, v2 bitop3:0xbe
    v_bitop3_b32 v2, v103, s52, v2 bitop3:0xbe
    v_bitop3_b32 v2, v105, s52, v2 bitop3:0xbe
    v_bitop3_b32 v2, v107, s52, v2 bitop3:0xbe
    v_bitop3_b32 v2, v109, s52, v2 bitop3:0xbe
    v_bitop3_b32 v2, v111, s52, v2 bitop3:0xbe
    v_bitop3_b32 v2, v113, s52, v2 bitop3:0xbe
    v_bitop3_b32 v2, v115, s52, v2 bitop3:0xbe
    v_bitop3_b32 v2, v117, s52, v2 bitop3:0xbe
    v_bitop3_b32 v2, v119, s52, v2 bitop3:0xbe
    v_bitop3_b32 v2, v121, s52, v2 bitop3:0xbe
    v_bitop3_b32 v2, v123, s52, v2 bitop3:0xbe
    v_bitop3_b32 v2, v125, s52, v2 bitop3:0xbe
    v_bitop3_b32 v2, v127, s52, v2 bitop3:0xbe
    v_bitop3_b32 v2, v129, s52, v2 bitop3:0xbe
    v_bitop3_b32 v2, v131, s52, v2 bitop3:0xbe
    v_bitop3_b32 v2, v133, s52, v2 bitop3:0xbe
    v_bitop3_b32 v2, v135, s52, v2 bitop3:0xbe
    v_bitop3_b32 v2, v137, s52, v2 bitop3:0xbe
    v_bitop3_b32 v2, v139, s52, v2 bitop3:0xbe
    v_bitop3_b32 v2, v141, s52, v2 bitop3:0xbe
    v_bitop3_b32 v2, v143, s52, v2 bitop3:0xbe
    v_bitop3_b32 v2, v145, s52, v2 bitop3:0xbe
    v_bitop3_b32 v2, v147, s52, v2 bitop3:0xbe
    v_bitop3_b32 v2, v149, s52, v2 bitop3:0xbe
    v_bitop3_b32 v2, v151, s52, v2 bitop3:0xbe
    v_cmp_ne_u32 vcc, 0, v2
    s_cbranch_vccz T_KY_OK
T_KY_RETRY:
    s_add_u32 s100, s100, 1
    s_cmp_gt_u32 s100, 20000
    s_cbranch_scc1 T_KY_OK
    s_sleep 16
    s_add_u32 s60, s62, 49152
    buffer_load_dwordx4 v[88:91], v12, s[28:31], s60 offen offset:0 sc1
    buffer_load_dwordx4 v[92:95], v12, s[28:31], s60 offen offset:1024 sc1
    buffer_load_dwordx4 v[96:99], v12, s[28:31], s60 offen offset:2048 sc1
    buffer_load_dwordx4 v[100:103], v12, s[28:31], s60 offen offset:3072 sc1
    s_add_u32 s60, s62, 53248
    buffer_load_dwordx4 v[104:107], v12, s[28:31], s60 offen offset:0 sc1
    buffer_load_dwordx4 v[108:111], v12, s[28:31], s60 offen offset:1024 sc1
    buffer_load_dwordx4 v[112:115], v12, s[28:31], s60 offen offset:2048 sc1
    buffer_load_dwordx4 v[116:119], v12, s[28:31], s60 offen offset:3072 sc1
    s_add_u32 s60, s62, 57344
    buffer_load_dwordx4 v[120:123], v12, s[28:31], s60 offen offset:0 sc1
    buffer_load_dwordx4 v[124:127], v12, s[28:31], s60 offen offset:1024 sc1
    buffer_load_dwordx4 v[128:131], v12, s[28:31], s60 offen offset:2048 sc1
    buffer_load_dwordx4 v[132:135], v12, s[28:31], s60 offen offset:3072 sc1
    s_add_u32 s60, s62, 61440
    buffer_load_dwordx4 v[136:139], v12, s[28:31], s60 offen offset:0 sc1
    buffer_load_dwordx4 v[140:143], v12, s[28:31], s60 offen offset:1024 sc1
    buffer_load_dwordx4 v[144:147], v12, s[28:31], s60 offen offset:2048 sc1
    buffer_load_dwordx4 v[148:151], v12, s[28:31], s60 offen offset:3072 sc1
    s_waitcnt vmcnt(0)
    s_branch T_KY_CHK
T_KY_OK:
    v_max_u32 v20, v88, v90
    v_min_u32 v21, v88, v90
    v_med3_u32 v21, v20, v21, v92
    v_max_u32 v20, v20, v92
    v_med3_u32 v21, v20, v21, v94
    v_max_u32 v20, v20, v94
    v_med3_u32 v21, v20, v21, v96
    v_max_u32 v20, v20, v96
    v_med3_u32 v21, v20, v21, v98
    v_max_u32 v20, v20, v98
    v_med3_u32 v21, v20, v21, v100
    v_max_u32 v20, v20, v100
    v_med3_u32 v21, v20, v21, v102
    v_max_u32 v20, v20, v102
    v_med3_u32 v21, v20, v21, v104
    v_max_u32 v20, v20, v104
    v_med3_u32 v21, v20, v21, v106
    v_max_u32 v20, v20, v106
    v_med3_u32 v21, v20, v21, v108
    v_max_u32 v20, v20, v108
    v_med3_u32 v21, v20, v21, v110
    v_max_u32 v20, v20, v110
    v_med3_u32 v21, v20, v21, v112
    v_max_u32 v20, v20, v112
    v_med3_u32 v21, v20, v21, v114
    v_max_u32 v20, v20, v114
    v_med3_u32 v21, v20, v21, v116
    v_max_u32 v20, v20, v116
    v_med3_u32 v21, v20, v21, v118
    v_max_u32 v20, v20, v118
    v_med3_u32 v21, v20, v21, v120
    v_max_u32 v20, v20, v120
    v_med3_u32 v21, v20, v21, v122
    v_max_u32 v20, v20, v122
    v_med3_u32 v21, v20, v21, v124
    v_max_u32 v20, v20, v124
    v_med3_u32 v21, v20, v21, v126
    v_max_u32 v20, v20, v126
    v_med3_u32 v21, v20, v21, v128
    v_max_u32 v20, v20, v128
    v_med3_u32 v21, v20, v21, v130
    v_max_u32 v20, v20, v130
    v_med3_u32 v21, v20, v21, v132
    v_max_u32 v20, v20, v132
    v_med3_u32 v21, v20, v21, v134
    v_max_u32 v20, v20, v134
    v_med3_u32 v21, v20, v21, v136
    v_max_u32 v20, v20, v136
    v_med3_u32 v21, v20, v21, v138
    v_max_u32 v20, v20, v138
    v_med3_u32 v21, v20, v21, v140
    v_max_u32 v20, v20, v140
    v_med3_u32 v21, v20, v21, v142
    v_max_u32 v20, v20, v142
    v_med3_u32 v21, v20, v21, v144
    v_max_u32 v20, v20, v144
    v_med3_u32 v21, v20, v21, v146
    v_max_u32 v20, v20, v146
    v_med3_u32 v21, v20, v21, v148
    v_max_u32 v20, v20, v148
    v_med3_u32 v21, v20, v21, v150
    v_max_u32 v20, v20, v150
    s_nop 1
    v_mov_b32_dpp v22, v20 row_ror:8 row_mask:0xf bank_mask:0xf
    v_mov_b32_dpp v23, v21 row_ror:8 row_mask:0xf bank_mask:0xf
    v_min_u32 v2, v20, v22
    v_max_u32 v20, v20, v22
    v_max3_u32 v21, v21, v23, v2
    s_nop 0
    v_mov_b32_dpp v22, v20 row_ror:4 row_mask:0xf bank_mask:0xf
    v_mov_b32_dpp v23, v21 row_ror:4 row_mask:0xf bank_mask:0xf
    v_min_u32 v2, v20, v22
    v_max_u32 v20, v20, v22
    v_max3_u32 v21, v21, v23, v2
    s_nop 0
    v_mov_b32_dpp v22, v20 row_ror:2 row_mask:0xf bank_mask:0xf
    v_mov_b32_dpp v23, v21 row_ror:2 row_mask:0xf bank_mask:0xf
    v_min_u32 v2, v20, v22
    v_max_u32 v20, v20, v22
    v_max3_u32 v21, v21, v23, v2
    s_nop 0
    v_mov_b32_dpp v22, v20 row_ror:1 row_mask:0xf bank_mask:0xf
    v_mov_b32_dpp v23, v21 row_ror:1 row_mask:0xf bank_mask:0xf
    v_min_u32 v2, v20, v22
    v_max_u32 v20, v20, v22
    v_max3_u32 v21, v21, v23, v2
    v_mov_b32 v22, v20
    v_mov_b32 v23, v21
    s_nop 0
    v_permlane16_swap_b32 v20, v22
    v_permlane16_swap_b32 v21, v23
    v_min_u32 v2, v20, v22
    v_max_u32 v20, v20, v22
    v_max3_u32 v21, v21, v23, v2
    v_mov_b32 v22, v20
    v_mov_b32 v23, v21
    s_nop 0
    v_permlane32_swap_b32 v20, v22
    v_permlane32_swap_b32 v21, v23
    v_min_u32 v2, v20, v22
    v_max_u32 v20, v20, v22
    v_max3_u32 v21, v21, v23, v2
    s_mov_b64 exec, 0x1fffffff
    v_lshlrev_b32 v11, 7, v1
    s_movk_i32 s63, 8192
    buffer_load_dword v16, v11, s[28:31], s63 offen sc1
    v_mov_b32 v104, v20
    v_mov_b32 v106, v21
    s_waitcnt vmcnt(0)
T_FL_CHK:
    v_xor_b32 v2, s52, v16
    v_cmp_ne_u32 vcc, 0, v2
    s_cbranch_vccz T_FL_OK
T_FL_RETRY:
    s_add_u32 s100, s100, 1
    s_cmp_gt_u32 s100, 20000
    s_cbranch_scc1 T_FL_OK
    s_sleep 8
    s_movk_i32 s63, 8192
    buffer_load_dword v16, v11, s[28:31], s63 offen sc1
    s_waitcnt vmcnt(0)
    s_branch T_FL_CHK
T_FL_OK:
    s_mov_b64 exec, 0xff
    buffer_store_dwordx4 v[104:107], v15, s[28:31], 0 offen offset:256 sc1
    s_mov_b64 exec, 1
    buffer_store_dword v105, v15, s[28:31], 0 offen offset:0 sc1
    s_mov_b64 exec, -1
    s_branch K_END
K_END:
K_EXIT:
    s_endpgm
    .p2align 6
    .type K_TAB,@object
K_TAB:
    .long 0x18100800, 0x80808020, 0x18100800, 0x20, 0x0, 0x1400, 0x1e00, 0x0
    .long 0x0, 0x2, 0xff00ff00, 0xffffffff, 0xffffffff, 0xffffffff, 0xffffff00, 0xffffffff
    .long 0x18100800, 0x80808080, 0x18100800, 0x18, 0x6, 0x2000, 0x7ff00000, 0x1c00
    .long 0x0, 0x1, 0xff00ff00, 0xffffffff, 0xffffffff, 0xffffffff, 0xffffff00, 0xffffffff
    .long 0x80100800, 0x80808080, 0x8080000, 0x10, 0x6, 0x2500, 0x1d08, 0x5400
    .long 0x3800, 0x1, 0xff00, 0xffff, 0xffff, 0xffff, 0xffffff00, 0xffffffff
    .long 0x80800800, 0x80808080, 0x8080000, 0x8, 0x6, 0x2700, 0x7ff00000, 0x8c00
    .long 0x7000, 0x1, 0xff00, 0xffff, 0xffff, 0xffff, 0xffffff00, 0xffffffff
    .long 0x80808000, 0x80808080, 0x8080000, 0x0, 0x6, 0x7ff00000, 0x1f08, 0xc400
    .long 0xa800, 0x1, 0xff00, 0xffff, 0xffff, 0xffff, 0xffffff00, 0xffffffff
    .long 0x40383028, 0x80808048, 0x40383028, 0x48, 0x2, 0x0, 0x1800, 0x0
    .long 0x0, 0x0, 0xff00ff00, 0xffffffff, 0xffffffff, 0xffffffff, 0xffffff00, 0xffffffff
    .long 0x38302820, 0x80808040, 0x38302820, 0x40, 0x0, 0x400, 0x1a00, 0x0
    .long 0x0, 0x0, 0xff00ff00, 0xffffffff, 0xffffffff, 0xffffffff, 0xffffff00, 0xffffffff
    .long 0x30282018, 0x80808038, 0x30282018, 0x38, 0x0, 0x800, 0x1808, 0x0
    .long 0x0, 0x0, 0xff00ff00, 0xffffffff, 0xffffffff, 0xffffffff, 0xffffff00, 0xffffffff
    .long 0x28201810, 0x80808030, 0x28201810, 0x30, 0x0, 0xc00, 0x1a08, 0x0
    .long 0x0, 0x0, 0xff00ff00, 0xffffffff, 0xffffffff, 0xffffffff, 0xffffff00, 0xffffffff
    .long 0x20181008, 0x80808028, 0x20181008, 0x28, 0x0, 0x1000, 0x1c00, 0x0
    .long 0x0, 0x0, 0xff00ff00, 0xffffffff, 0xffffffff, 0xffffffff, 0xffffff00, 0xffffffff
    .long 0x68605850, 0x80808070, 0x68605850, 0x70, 0x4, 0x200, 0x1900, 0x0
    .long 0x0, 0x0, 0xff00ff00, 0xffffffff, 0xffffffff, 0xffffffff, 0xffffff00, 0xffffffff
    .long 0x60585048, 0x80808068, 0x60585048, 0x68, 0x2, 0x600, 0x1b00, 0x0
    .long 0x0, 0x0, 0xff00ff00, 0xffffffff, 0xffffffff, 0xffffffff, 0xffffff00, 0xffffffff
    .long 0x58504840, 0x80808060, 0x58504840, 0x60, 0x2, 0xa00, 0x1908, 0x0
    .long 0x0, 0x0, 0xff00ff00, 0xffffffff, 0xffffffff, 0xffffffff, 0xffffff00, 0xffffffff
    .long 0x50484038, 0x80808058, 0x50484038, 0x58, 0x2, 0xe00, 0x1b08, 0x0
    .long 0x0, 0x0, 0xff00ff00, 0xffffffff, 0xffffffff, 0xffffffff, 0xffffff00, 0xffffffff
    .long 0x48403830, 0x80808050, 0x48403830, 0x50, 0x2, 0x1200, 0x1d00, 0x0
    .long 0x0, 0x0, 0xff00ff00, 0xffffffff, 0xffffffff, 0xffffffff, 0xffffff00, 0xffffffff
    .long 0x80808078, 0x80808080, 0x80807878, 0x78, 0x6, 0x7ff00000, 0x1c08, 0x0
    .long 0x1c00, 0x1, 0xff00, 0xffff, 0xffff, 0xffff, 0xffffff00, 0xffffffff
    .long 0x80807870, 0x80808080, 0x78787070, 0x78, 0x4, 0x2400, 0x7ff00000, 0x3800
    .long 0x5400, 0x1, 0xff00, 0xffff, 0xffff, 0xffff, 0xffffff00, 0xffffffff
    .long 0x80787068, 0x80808080, 0x70706868, 0x78, 0x4, 0x2600, 0x1e08, 0x7000
    .long 0x8c00, 0x1, 0xff00, 0xffff, 0xffff, 0xffff, 0xffffff00, 0xffffffff
    .long 0x78706860, 0x80808080, 0x78706860, 0x78, 0x4, 0x2200, 0x7ff00000, 0xa800
    .long 0xc400, 0x1, 0xff00ff00, 0xffffffff, 0xffffffff, 0xffffffff, 0xffffff00, 0xffffffff
    .long 0x70686058, 0x80808078, 0x70686058, 0x78, 0x4, 0x1600, 0x1f00, 0x0
    .long 0x0, 0x2, 0xff00ff00, 0xffffffff, 0xffffffff, 0xffffffff, 0xffffff00, 0xffffffff
    .long 0x40383028, 0x80808048, 0x40383028, 0x48, 0x0, 0x14000, 0x15800, 0x0
    .long 0x0, 0x0, 0xffffffff, 0xffffffff, 0xffffffff, 0x0, 0xffffffff, 0xffff
    .long 0x38302820, 0x80808040, 0x38302820, 0x40, 0x6, 0x14400, 0x15a00, 0x0
    .long 0x0, 0x0, 0xffffffff, 0xffffffff, 0xffffffff, 0x0, 0xffffffff, 0xffff
    .long 0x30282018, 0x80808038, 0x30282018, 0x38, 0x6, 0x14800, 0x15808, 0x0
    .long 0x0, 0x0, 0xffffffff, 0xffffffff, 0xffffffff, 0x0, 0xffffffff, 0xffff
    .long 0x28201810, 0x80808030, 0x28201810, 0x30, 0x6, 0x14c00, 0x15a08, 0x0
    .long 0x0, 0x0, 0xffffffff, 0xffffffff, 0xffffffff, 0x0, 0xffffffff, 0xffff
    .long 0x20181008, 0x80808028, 0x20181008, 0x28, 0x6, 0x15000, 0x15c00, 0x0
    .long 0x0, 0x0, 0xffffffff, 0xffffffff, 0xffffffff, 0x0, 0xffffffff, 0xffff
    .long 0x18100800, 0x80808020, 0x18100800, 0x20, 0x2, 0x15400, 0x15e00, 0x0
    .long 0x0, 0x2, 0xffffffff, 0xffffffff, 0xffffffff, 0x0, 0xffffffff, 0xffff
    .long 0x18100800, 0x80808080, 0x18100800, 0x18, 0x0, 0x16000, 0x7ff00000, 0x2c00
    .long 0x1000, 0x1, 0xffffffff, 0xffffffff, 0xffffffff, 0x0, 0xffffffff, 0xffff
    .long 0x80100800, 0x80808080, 0x8080000, 0x10, 0x0, 0x16500, 0x15d08, 0x6400
    .long 0x4800, 0x1, 0xffff, 0xffff, 0xffff, 0x0, 0xffffffff, 0xffff
    .long 0x80800800, 0x80808080, 0x8080000, 0x8, 0x0, 0x16700, 0x7ff00000, 0x9c00
    .long 0x8000, 0x1, 0xffff, 0xffff, 0xffff, 0x0, 0xffffffff, 0xffff
    .long 0x80808000, 0x80808080, 0x8080000, 0x0, 0x0, 0x7ff00000, 0x15f08, 0xd400
    .long 0xb800, 0x1, 0xffff, 0xffff, 0xffff, 0x0, 0xffffffff, 0xffff
    .long 0x80808078, 0x80808080, 0x80807878, 0x78, 0x4, 0x7ff00000, 0x15c08, 0x1000
    .long 0x2c00, 0x1, 0xffff, 0xffff, 0xffff, 0x0, 0xffffffff, 0xffff
    .long 0x80807870, 0x80808080, 0x78787070, 0x78, 0x2, 0x16400, 0x7ff00000, 0x4800
    .long 0x6400, 0x1, 0xffff, 0xffff, 0xffff, 0x0, 0xffffffff, 0xffff
    .long 0x80787068, 0x80808080, 0x70706868, 0x78, 0x2, 0x16600, 0x15e08, 0x8000
    .long 0x9c00, 0x1, 0xffff, 0xffff, 0xffff, 0x0, 0xffffffff, 0xffff
    .long 0x78706860, 0x80808080, 0x78706860, 0x78, 0x2, 0x16200, 0x7ff00000, 0xb800
    .long 0xd400, 0x1, 0xffffffff, 0xffffffff, 0xffffffff, 0x0, 0xffffffff, 0xffff
    .long 0x70686058, 0x80808078, 0x70686058, 0x78, 0x2, 0x15600, 0x15f00, 0x0
    .long 0x0, 0x2, 0xffffffff, 0xffffffff, 0xffffffff, 0x0, 0xffffffff, 0xffff
    .long 0x68605850, 0x80808070, 0x68605850, 0x70, 0x6, 0x14200, 0x15900, 0x0
    .long 0x0, 0x0, 0xffffffff, 0xffffffff, 0xffffffff, 0x0, 0xffffffff, 0xffff
    .long 0x60585048, 0x80808068, 0x60585048, 0x68, 0x4, 0x14600, 0x15b00, 0x0
    .long 0x0, 0x0, 0xffffffff, 0xffffffff, 0xffffffff, 0x0, 0xffffffff, 0xffff
    .long 0x58504840, 0x80808060, 0x58504840, 0x60, 0x4, 0x14a00, 0x15908, 0x0
    .long 0x0, 0x0, 0xffffffff, 0xffffffff, 0xffffffff, 0x0, 0xffffffff, 0xffff
    .long 0x50484038, 0x80808058, 0x50484038, 0x58, 0x4, 0x14e00, 0x15b08, 0x0
    .long 0x0, 0x0, 0xffffffff, 0xffffffff, 0xffffffff, 0x0, 0xffffffff, 0xffff
    .long 0x48403830, 0x80808050, 0x48403830, 0x50, 0x4, 0x15200, 0x15d00, 0x0
    .long 0x0, 0x0, 0xffffffff, 0xffffffff, 0xffffffff, 0x0, 0xffffffff, 0xffff
    .fill (40960 - (. - recurrent_scan__sliding_local_dilated__moe_arch_mod__prompt_kernel)) / 4, 4, 0xbf810000
.section .rodata,"a"
.p2align 6
.amdhsa_kernel recurrent_scan__sliding_local_dilated__moe_arch_mod__prompt_kernel
  .amdhsa_next_free_vgpr 256
  .amdhsa_next_free_sgpr 102
  .amdhsa_accum_offset 256
  .amdhsa_group_segment_fixed_size 0
  .amdhsa_kernarg_size 88
  .amdhsa_user_sgpr_count 2
  .amdhsa_user_sgpr_kernarg_segment_ptr 1
  .amdhsa_system_sgpr_workgroup_id_x 1
.end_amdhsa_kernel
```

```asm
; @launch grid=(256,1,1) block=(512,1,1) lds=163840
.amdgcn_target "amdgcn-amd-amdhsa--gfx950"
.text
.globl recurrent_scan__sliding_local_dilated__moe_arch_mod__prompt_kernel
.p2align 8
.type recurrent_scan__sliding_local_dilated__moe_arch_mod__prompt_kernel,@function
recurrent_scan__sliding_local_dilated__moe_arch_mod__prompt_kernel:
    s_load_dwordx2 s[24:25], s[0:1], 0
    s_load_dwordx2 s[32:33], s[0:1], 8
    s_load_dwordx2 s[28:29], s[0:1], 80
    s_cmpk_ge_u32 s2, 256
    s_cbranch_scc1 K_EXIT
    v_readfirstlane_b32 s3, v0
    s_getpc_b64 s[20:21]
K_PC:
    s_lshr_b32 s54, s2, 3
    s_lshl_b32 s60, s54, 10
    v_lshl_add_u32 v2, v0, 1, s60
    global_load_ushort v255, v2, s[20:21]
    s_mul_i32 s60, s54, 52
    s_lshr_b32 s60, s60, 8
    s_mul_i32 s53, s60, 5
    s_sub_u32 s53, s54, s53
    s_add_u32 s67, s60, s53
    s_bitcmp1_b32 s2, 1
    s_cselect_b32 s61, 5, 0
    s_add_u32 s56, s60, s61
    s_mulk_i32 s56, 104
    s_sub_u32 s56, s56, 8
    s_and_b32 s57, s2, 4
    s_mulk_i32 s57, 320
    s_bitcmp1_b32 s2, 0
    s_cselect_b32 s61, 5, 0
    s_add_u32 s58, s53, s61
    s_lshl_b32 s58, s58, 7
    s_mov_b32 s26, 2621440
    s_mov_b32 s27, 0x20000
    s_lshr_b32 s60, s3, 3
    s_max_u32 s60, s60, s54
    s_cmp_ge_u32 s60, 25
    s_cbranch_scc1 K_NL
    v_lshrrev_b32 v2, 3, v0
    v_add_u32 v3, s56, v2
    v_mul_i32_i24 v3, 2560, v3
    v_bitop3_b32 v1, v0, v2, 7 bitop3:0x28
    v_lshl_add_u32 v196, v1, 4, v3
    v_and_b32 v3, 2, v2
    v_lshrrev_b32 v1, 1, v2
    v_and_or_b32 v3, v1, 4, v3
    v_bitop3_b32 v3, v0, v3, 7 bitop3:0x28
    v_mul_u32_u24 v200, 3840, v2
    v_lshl_add_u32 v200, v3, 4, v200
    s_cmp_ge_u32 s67, 5
    s_cselect_b32 s61, 5, 0
    s_sub_u32 s67, s67, s61
    s_lshl_b32 s67, s67, 2
    s_and_b32 s68, s2, 6
    s_mul_i32 s68, s68, 5
    s_lshr_b32 s68, s68, 2
    s_lshl_b32 s69, s3, 4
    s_mov_b32 s34, 2457600
    s_mov_b32 s35, s27
    s_cmp_eq_u32 s3, 0
    s_cselect_b32 s70, 0xffffff00, -1
    s_cmpk_lt_u32 s69, 2048
    s_cselect_b64 vcc, -1, 0
    s_lshr_b32 s64, 66064, s67
    s_and_b32 s64, s64, 15
    s_add_u32 s64, s64, s68
    s_cmp_ge_u32 s64, 10
    s_cselect_b32 s65, 10, 0
    s_sub_u32 s64, s64, s65
    s_mul_i32 s65, s64, 245760
    s_lshl_b32 s64, s64, 7
    s_add_u32 s64, s64, s57
    s_add_u32 m0, s69, 77824
    s_mov_b32 exec_lo, s70
    s_waitcnt lgkmcnt(0)
    buffer_load_dwordx4 v196, s[24:27], s64 offen lds
    s_add_u32 m0, s69, 81920
    s_mov_b32 exec_lo, -1
    v_add_u32 v197, 81920, v196
    buffer_load_dwordx4 v197, s[24:27], s64 offen lds
    s_add_u32 m0, s69, 86016
    s_add_u32 s65, s65, s58
    v_add_u32 v198, 163840, v196
    buffer_load_dwordx4 v198, s[24:27], s64 offen lds
    v_add_u32 v199, 245760, v196
    s_cbranch_vccz L_SK0
    s_add_u32 m0, s69, 90112
    s_nop 0
    buffer_load_dwordx4 v199, s[24:27], s64 offen lds
L_SK0:
    s_add_u32 m0, s69, 92160
    s_add_u32 s66, s65, 122880
    buffer_load_dwordx4 v200, s[32:35], s65 offen offset:0 lds
    s_add_u32 m0, s69, 99072
    s_nop 0
    buffer_load_dwordx4 v200, s[32:35], s65 offen offset:1280 lds
    s_add_u32 m0, s69, 105984
    s_nop 0
    buffer_load_dwordx4 v200, s[32:35], s65 offen offset:2560 lds
    s_add_u32 m0, s69, 96256
    s_nop 0
    buffer_load_dwordx4 v200, s[32:35], s66 offen offset:0 lds
    s_add_u32 m0, s69, 103168
    s_nop 0
    buffer_load_dwordx4 v200, s[32:35], s66 offen offset:1280 lds
    s_add_u32 m0, s69, 110080
    s_nop 0
    buffer_load_dwordx4 v200, s[32:35], s66 offen offset:2560 lds
    s_branch L_CONT
K_NL:
    s_cmpk_ge_u32 s3, 256
    s_cbranch_scc1 K_ER
    s_sub_u32 s56, s2, 200
    s_mov_b32 s101, 1
    s_cmp_ge_u32 s56, 27
    s_cbranch_scc1 K_AUX
    s_load_dwordx2 s[48:49], s[0:1], 40
    s_load_dwordx2 s[36:37], s[0:1], 48
    v_lshrrev_b32 v2, 3, v0
    v_and_b32 v3, 2, v2
    v_lshrrev_b32 v1, 1, v2
    v_and_or_b32 v3, v1, 4, v3
    v_bitop3_b32 v3, v0, v3, 7 bitop3:0x28
    v_mul_u32_u24 v30, 3456, v2
    v_lshl_add_u32 v30, v3, 4, v30
    s_lshl_b32 s68, s56, 7
    s_lshl_b32 s69, s3, 4
    s_mov_b32 s70, 12
    s_mov_b32 s50, 2211840
    s_mov_b32 s51, 0x20000
    s_mov_b32 s38, 2211840
    s_mov_b32 s39, 0x20000
    s_waitcnt lgkmcnt(0)
FL_GU1:
    s_mov_b32 m0, s69
    s_sub_u32 s70, s70, 1
    buffer_load_dwordx4 v30, s[48:51], s68 offen nt lds
    s_add_u32 m0, s69, 16384
    s_add_u32 s69, s69, 4096
    buffer_load_dwordx4 v30, s[36:39], s68 offen nt lds
    s_add_u32 s68, s68, 110592
    s_and_b32 s60, s70, 3
    s_cselect_b32 s60, 0, 16384
    s_add_u32 s69, s69, s60
    s_cmp_lg_u32 s70, 0
    s_cbranch_scc1 FL_GU1
    s_mov_b32 s101, 5
    s_branch K_AUX
K_ER:
    s_setprio 3
    s_load_dwordx2 s[22:23], s[0:1], 32
    v_bfe_u32 v232, v0, 5, 3
    v_and_b32 v4, 31, v0
    v_mul_u32_u24 v7, 2560, v232
    v_lshlrev_b32 v5, 4, v4
    v_lshlrev_b32 v6, 3, v4
    v_add_u32 v8, v7, v6
    v_add_u32 v7, v7, v5
    s_and_b32 s68, s2, 3
    s_lshl_b32 s68, s68, 5
    s_add_u32 s68, s68, s54
    s_mul_i32 s69, s68, 20480
    s_add_u32 s69, s69, s57
    s_waitcnt lgkmcnt(0)
    buffer_load_dwordx4 v[212:215], v7, s[24:27], s69 offen
    buffer_load_dwordx4 v[216:219], v7, s[24:27], s69 offen offset:512
    buffer_load_dwordx2 v[220:221], v8, s[24:27], s69 offen offset:1024
    global_load_dwordx4 v[222:225], v5, s[22:23]
    global_load_dwordx4 v[226:229], v5, s[22:23] offset:512
    global_load_dwordx2 v[230:231], v6, s[22:23] offset:1024
    s_load_dword s52, s[28:29], 0
    s_mov_b32 s30, 7077888
    s_mov_b32 s31, 0x20000
    s_and_b32 s70, s2, 4
    s_lshl_b32 s70, s70, 5
    s_add_u32 s70, s70, s68
    s_lshl_b32 s71, s70, 6
    s_lshl_b32 s70, s70, 7
    s_add_u32 s70, s70, 16384
    s_add_u32 s71, s71, 49152
    s_setprio 0
    s_mov_b32 s101, 1
    s_cmp_ge_u32 s54, 25
    s_cbranch_scc1 K_AUX0
    s_mul_i32 s60, s3, 5
    s_lshl_b32 s61, s53, 6
    s_add_u32 s60, s60, s61
    s_add_u32 s60, s60, K_TAB-K_PC
    s_load_dwordx16 s[4:19], s[20:21], s60
    s_load_dwordx2 s[44:45], s[0:1], 64
    s_load_dwordx2 s[40:41], s[0:1], 16
    s_mov_b32 s46, 2621440
    s_mov_b32 s47, 0x20000
    s_mov_b32 s30, 7077888
    s_mov_b32 s31, 0x20000
    s_mov_b32 s42, 819200
    s_mov_b32 s43, 0x20000
    s_lshr_b32 s3, s3, 6
    s_and_b32 s59, s3, 3
    s_mov_b32 s55, 0xffff0000
    s_mov_b32 s100, 0
    v_and_b32 v1, 63, v0
    v_and_b32 v4, 15, v1
    v_lshrrev_b32 v5, 4, v1
    v_mov_b32 v19, 163584
    v_add_u32 v18, s3, v19
    v_mov_b32 v2, 0
    v_mov_b32 v3, 0
    v_mov_b32 v46, 0x00010100
    v_mov_b32 v47, 0x01000001
    ds_write2_b64 v19, v[2:3], v[46:47] offset1:1
    v_mov_b32 v45, 0x01010101
    ds_write2_b32 v19, v2, v45 offset0:4 offset1:5
    v_bfe_u32 v46, v0, 1, 7
    v_min_u32 v46, 111, v46
    v_mul_u32_u24 v46, 272, v46
    v_add_u32 v46, 116992, v46
    ds_write_b64 v46, v[2:3]
    s_min_u32 s60, s59, 2
    s_mul_i32 s60, s60, 38912
    v_and_b32 v46, 31, v0
    v_lshl_add_u32 v46, v46, 2, s60
    v_mov_b32 v47, 0x3f803f80
    ds_write_b32 v46, v47
    v_lshlrev_b32 v6, 4, v1
    v_mov_b32 v28, 0x3f803f80
    v_mov_b32 v29, 0x3f803f80
    v_mov_b32 v30, 0x3f803f80
    v_mov_b32 v31, 0x3f803f80
    v_lshlrev_b32 v2, 2, v5
    v_sub_u32 v3, v4, v2
    v_add_u32 v3, 12, v3
    s_mov_b32 s60, 267390975
    v_bfe_i32 v32, s60, v3, 1
    v_and_b32 v32, 0xff800000, v32
    s_mov_b32 s60, 268435440
    v_bfe_i32 v36, s60, v3, 1
    v_and_b32 v36, 0xff800000, v36
    s_mov_b32 s60, 266346495
    v_bfe_i32 v33, s60, v3, 1
    v_and_b32 v33, 0xff800000, v33
    s_mov_b32 s60, 268435424
    v_bfe_i32 v37, s60, v3, 1
    v_and_b32 v37, 0xff800000, v37
    s_mov_b32 s60, 264257535
    v_bfe_i32 v34, s60, v3, 1
    v_and_b32 v34, 0xff800000, v34
    s_mov_b32 s60, 268435392
    v_bfe_i32 v38, s60, v3, 1
    v_and_b32 v38, 0xff800000, v38
    s_mov_b32 s60, 260079615
    v_bfe_i32 v35, s60, v3, 1
    v_and_b32 v35, 0xff800000, v35
    s_mov_b32 s60, 268435328
    v_bfe_i32 v39, s60, v3, 1
    v_and_b32 v39, 0xff800000, v39
    v_sub_u32 v2, 13, v3
    v_med3_i32 v2, v2, 0, 2
    v_lshlrev_b32 v2, 3, v2
    v_mov_b32 v40, -1
    v_lshrrev_b32 v40, v2, v40
    v_lshrrev_b32 v40, v2, v40
    v_sub_u32 v2, 15, v3
    v_med3_i32 v2, v2, 0, 2
    v_lshlrev_b32 v2, 3, v2
    v_mov_b32 v41, -1
    v_lshrrev_b32 v41, v2, v41
    v_lshrrev_b32 v41, v2, v41
    v_mul_u32_u24 v25, 20224, v5
    v_add_u32 v25, v25, v6
    v_lshrrev_b32 v24, 5, v1
    v_mul_u32_u24 v24, 19968, v24
    v_add_u32 v24, v24, v6
    v_lshlrev_b32 v26, 4, v4
    v_add_u32 v26, 162568, v26
    v_bfe_u32 v2, v1, 2, 2
    v_lshlrev_b32 v2, 7, v2
    v_and_b32 v3, 8, v1
    v_lshl_add_u32 v2, v3, 2, v2
    v_and_b32 v3, 3, v1
    v_lshl_add_u32 v2, v3, 3, v2
    v_and_b32 v3, 48, v1
    s_mov_b32 s62, 0xffff
    s_mov_b32 s60, 201329216
    s_mov_b32 s61, 373298176
    v_lshrrev_b64 v[46:47], v3, s[60:61]
    v_and_or_b32 v9, v46, s62, v2
    s_mov_b32 s60, 37748736
    s_mov_b32 s61, 2550175296
    v_lshrrev_b64 v[46:47], v3, s[60:61]
    v_and_or_b32 v10, v46, s62, v2
    s_mov_b32 s60, 469766720
    s_mov_b32 s61, 977285120
    v_lshrrev_b64 v[46:47], v3, s[60:61]
    v_and_or_b32 v11, v46, s62, v2
    s_mov_b32 s60, 2483063360
    s_mov_b32 s61, 2654996480
    v_lshrrev_b64 v[46:47], v3, s[60:61]
    v_and_or_b32 v12, v46, s62, v2
    s_mov_b32 s60, 574627840
    s_mov_b32 s61, 2051045376
    v_lshrrev_b64 v[46:47], v3, s[60:61]
    v_and_or_b32 v13, v46, s62, v2
    s_mov_b32 s60, 1073757184
    s_mov_b32 s61, 1610635840
    v_lshrrev_b64 v[46:47], v3, s[60:61]
    v_and_or_b32 v14, v46, s62, v2
    s_mov_b32 s60, 1140858432
    s_mov_b32 s61, 2147507776
    v_lshrrev_b64 v[46:47], v3, s[60:61]
    v_and_or_b32 v15, v46, s62, v2
    v_lshrrev_b32 v2, 3, v1
    v_bitop3_b32 v3, v1, v2, 7 bitop3:0x28
    v_mul_u32_u24 v7, 2560, v2
    v_lshl_add_u32 v7, v3, 4, v7
    v_lshrrev_b32 v2, 5, v1
    v_bitop3_b32 v2, v2, v4, 7 bitop3:0x28
    v_lshlrev_b32 v8, 7, v4
    v_lshl_add_u32 v8, v2, 4, v8
    v_and_b32 v2, 1, v5
    v_lshl_add_u32 v8, v2, 3, v8
    v_bfe_u32 v2, v0, 3, 5
    v_and_b32 v3, 6, v2
    v_bitop3_b32 v3, v0, v3, 7 bitop3:0x28
    v_mul_u32_u24 v16, 1280, v2
    v_lshl_add_u32 v16, v3, 4, v16
    s_lshl_b32 s98, s56, 4
    s_mul_i32 s60, s57, 13
    s_add_u32 s98, s98, s60
    s_add_u32 s98, s98, 458880
    s_add_u32 s98, s98, s58
    s_cmp_eq_u32 s59, 0
    s_cselect_b32 s98, s98, 2146435072
    s_add_u32 s96, s56, 8
    s_mulk_i32 s96, 1408
    s_mul_i32 s60, s57, 1144
    s_add_u32 s96, s96, s60
    s_add_u32 s96, s96, 1048576
    s_and_b32 s62, s2, 1
    s_mulk_i32 s62, 10240
    s_add_u32 s62, s62, s96
    s_sub_u32 s63, s54, s53
    s_and_b32 s60, s2, 7
    s_mul_i32 s60, s60, 25
    s_add_u32 s63, s63, s60
    s_mulk_i32 s63, 11520
    s_add_u32 s63, s63, 4194304
    v_mul_u32_u24 v2, 272, v4
    v_add_u32 v2, 129792, v2
    v_lshlrev_b32 v3, 3, v5
    s_waitcnt lgkmcnt(0)
    s_mul_i32 s52, s52, 0x9E3779B1
    s_add_u32 s52, s52, 0x7F4A7C15
    s_or_b32 s52, s52, 1
    v_mov_b32 v46, s52
    ds_write_b32 v19, v46 offset:32
    v_bfe_u32 v20, s4, v3, 8
    v_bfe_u32 v21, s5, v3, 8
    v_add_u32 v20, v20, v2
    v_add_u32 v21, v21, v2
    v_lshrrev_b32 v2, 2, v1
    v_mul_u32_u24 v2, 136, v2
    v_add_u32 v2, 88448, v2
    v_add_u32 v23, s7, v2
    v_lshlrev_b32 v3, 3, v1
    v_bfe_u32 v22, s6, v3, 8
    v_add_u32 v22, v22, v2
    s_add_u32 s9, s9, s62
    s_add_u32 s10, s10, s62
    s_add_u32 s11, s11, s63
    s_add_u32 s12, s12, s63
    s_add_u32 s5, s9, 40960
    s_mul_i32 s60, s8, 20480
    s_add_u32 s96, s96, s60
    s_lshl4_add_u32 s95, s8, s56
    s_cmp_eq_u32 s8, 6
    s_cselect_b32 s101, 1, 2
    s_cmpk_ge_i32 s95, 1024
    s_cselect_b32 s101, 0, s101
    s_mul_i32 s97, s95, 2560
    s_add_u32 s97, s97, s57
    s_add_u32 s97, s97, s58
    s_add_u32 s94, s97, 20480
    s_cmp_eq_u32 s8, 0
    s_cselect_b32 s97, 2146435072, s97
    s_cselect_b32 s61, 2146435072, 0
    s_and_b32 s60, s53, 2
    s_mul_i32 s22, s60, 204800
    s_sub_u32 s23, 409600, s22
    s_add_u32 s22, s22, s58
    s_add_u32 s23, s23, s58
    s_mulk_i32 s60, 5120
    s_sub_u32 s4, s96, s60
    s_add_u32 s4, s4, 10240
    s_add_u32 s96, s96, s60
    s_add_u32 s92, s96, 4096
    s_add_u32 s93, s92, 4096
    s_add_u32 s6, s4, 4096
    s_add_u32 s7, s6, 4096
    v_bfe_i32 v2, v1, 3, 1
    v_bfi_b32 v2, v2, 0, s61
    v_or_b32 v27, v2, v6
    s_and_b32 s60, s2, 4
    s_lshl_b32 s60, s60, 8
    s_add_u32 s95, s95, s60
    s_lshl_b32 s60, s8, 11
    s_add_u32 s60, s60, 147200
    v_add_u32 v8, s60, v8
    s_lshl_b32 s60, s8, 8
    s_add_u32 s60, s60, 161536
    v_lshl_add_u32 v17, v4, 4, s60
    v_bitop3_b32 v2, v5, v4, 7 bitop3:0x28
    v_lshlrev_b32 v2, 4, v2
    v_lshl_add_u32 v42, v4, 7, v2
    v_add_u32 v42, 77824, v42
    v_xor_b32 v43, 64, v42
    v_bfe_u32 v2, v1, 3, 2
    v_xor_b32 v2, s59, v2
    v_lshlrev_b32 v2, 5, v2
    v_lshl_add_u32 v2, v5, 10, v2
    v_bfe_u32 v3, v1, 2, 2
    v_lshl_add_u32 v2, v3, 7, v2
    v_and_b32 v3, 3, v1
    v_lshl_add_u32 v2, v3, 3, v2
    v_add_u32 v44, 92160, v2
    s_lshl_b32 s60, s59, 5
    s_add_u32 s60, s60, 116736
    v_mul_u32_u24 v46, 272, v4
    v_lshl_add_u32 v2, v5, 3, s60
    v_add_u32 v46, v46, v2
    v_mul_u32_u24 v47, 136, v4
    v_add_u32 v47, v47, v2
    v_subrev_u32 v47, 34816, v47
    v_lshlrev_b32 v45, 4, v4
    v_add_u32 v45, 161536, v45
    s_mov_b64 exec, 0
    s_branch TL0
TL0_END:
    s_mov_b64 exec, -1
    v_mov_b32 v241, 0x3f803f80
    v_mov_b32 v245, s52
    v_mov_b32 v247, s52
    s_bfe_u32 s60, s2, 0x10002
    s_lshl4_add_u32 s60, s68, s60
    s_sub_u32 s60, 0xffff, s60
    v_lshlrev_b32 v239, 1, v232
    v_sub_u32 v239, s60, v239
    v_lshlrev_b32 v243, 3, v232
    v_lshlrev_b32 v232, 4, v232
    v_mov_b32 v249, s52
    s_setprio 3
    s_waitcnt vmcnt(3)
    v_dot2_f32_bf16 v233, v212, v241, 0
    v_dot2_f32_bf16 v234, v212, v212, 0
    v_dot2_f32_bf16 v233, v213, v241, v233
    v_dot2_f32_bf16 v234, v213, v213, v234
    v_dot2_f32_bf16 v233, v214, v241, v233
    v_dot2_f32_bf16 v234, v214, v214, v234
    v_dot2_f32_bf16 v233, v215, v241, v233
    v_dot2_f32_bf16 v234, v215, v215, v234
    v_dot2_f32_bf16 v233, v216, v241, v233
    v_dot2_f32_bf16 v234, v216, v216, v234
    v_dot2_f32_bf16 v233, v217, v241, v233
    v_dot2_f32_bf16 v234, v217, v217, v234
    v_dot2_f32_bf16 v233, v218, v241, v233
    v_dot2_f32_bf16 v234, v218, v218, v234
    v_dot2_f32_bf16 v233, v219, v241, v233
    v_dot2_f32_bf16 v234, v219, v219, v234
    v_dot2_f32_bf16 v233, v220, v241, v233
    v_dot2_f32_bf16 v234, v220, v220, v234
    v_dot2_f32_bf16 v233, v221, v241, v233
    v_dot2_f32_bf16 v234, v221, v221, v234
    s_waitcnt vmcnt(0)
    v_dot2_f32_bf16 v235, v212, v222, 0
    v_dot2_f32_bf16 v236, v222, v241, 0
    v_dot2_f32_bf16 v235, v213, v223, v235
    v_dot2_f32_bf16 v236, v223, v241, v236
    v_dot2_f32_bf16 v235, v214, v224, v235
    v_dot2_f32_bf16 v236, v224, v241, v236
    v_dot2_f32_bf16 v235, v215, v225, v235
    v_dot2_f32_bf16 v236, v225, v241, v236
    v_dot2_f32_bf16 v235, v216, v226, v235
    v_dot2_f32_bf16 v236, v226, v241, v236
    v_dot2_f32_bf16 v235, v217, v227, v235
    v_dot2_f32_bf16 v236, v227, v241, v236
    v_dot2_f32_bf16 v235, v218, v228, v235
    v_dot2_f32_bf16 v236, v228, v241, v236
    v_dot2_f32_bf16 v235, v219, v229, v235
    v_dot2_f32_bf16 v236, v229, v241, v236
    v_dot2_f32_bf16 v235, v220, v230, v235
    v_dot2_f32_bf16 v236, v230, v241, v236
    v_dot2_f32_bf16 v235, v221, v231, v235
    v_dot2_f32_bf16 v236, v231, v241, v236
    v_permlane16_swap_b32 v233, v234
    v_add_f32 v233, v233, v234
    s_nop 0
    v_permlane16_swap_b32 v235, v236
    v_add_f32 v235, v235, v236
    v_add_f32_dpp v233, v233, v233 row_ror:8 row_mask:0xf bank_mask:0xf
    s_nop 0
    v_add_f32_dpp v235, v235, v235 row_ror:8 row_mask:0xf bank_mask:0xf
    v_add_f32_dpp v233, v233, v233 row_ror:4 row_mask:0xf bank_mask:0xf
    s_nop 0
    v_add_f32_dpp v235, v235, v235 row_ror:4 row_mask:0xf bank_mask:0xf
    v_add_f32_dpp v233, v233, v233 row_ror:2 row_mask:0xf bank_mask:0xf
    s_nop 0
    v_add_f32_dpp v235, v235, v235 row_ror:2 row_mask:0xf bank_mask:0xf
    v_add_f32_dpp v233, v233, v233 row_ror:1 row_mask:0xf bank_mask:0xf
    s_nop 0
    v_add_f32_dpp v235, v235, v235 row_ror:1 row_mask:0xf bank_mask:0xf
    v_mul_f32 v233, 0x3acccccd, v233
    v_mov_b32 v236, v235
    v_mov_b32 v234, v233
    s_nop 0
    v_permlane16_swap_b32 v235, v236
    v_permlane16_swap_b32 v233, v234
    v_fma_f32 v234, -v233, v233, v234
    v_max_f32 v234, 0, v234
    v_cvt_pk_bf16_f32 v237, v233, v234
    v_lshlrev_b32 v233, 16, v237
    v_and_b32 v234, 0xffff0000, v237
    v_add_f32 v234, 0x3727c5ac, v234
    v_cvt_pk_bf16_f32 v234, v234, v234
    v_lshlrev_b32 v234, 16, v234
    v_sqrt_f32 v234, v234
    v_fma_f32 v235, -v233, v236, v235
    v_cvt_pk_bf16_f32 v234, v234, v234
    v_lshlrev_b32 v234, 16, v234
    v_rcp_f32 v246, v234
    s_mov_b32 exec_lo, 1
    s_mov_b32 exec_hi, 1
    v_mul_f32 v235, v235, v246
    v_xor_b32 v244, 0x80000000, v233
    v_cvt_pk_bf16_f32 v235, v235, v235
    buffer_store_dwordx4 v[244:247], v232, s[28:31], s70 offen sc1
    v_ashrrev_i32 v237, 31, v235
    v_or_b32 v237, 0x80000000, v237
    v_xor_b32 v235, v235, v237
    v_bfi_b32 v248, s55, v235, v239
    buffer_store_dwordx2 v[248:249], v243, s[28:31], s71 offen sc1
    s_mov_b64 exec, -1
    s_setprio 0
    s_mov_b32 s63, 0
    s_mov_b32 s64, 77824
    s_mov_b32 s67, 38912
    s_waitcnt lgkmcnt(0)
    s_barrier
    ds_read_b64_tr_b16 v[132:133], v44 offset:0
    ds_read_b64_tr_b16 v[134:135], v44 offset:512
    ds_read_b128 v[156:159], v42 offset:0
    ds_read_b64_tr_b16 v[136:137], v44 offset:8192
    ds_read_b64_tr_b16 v[138:139], v44 offset:8704
    ds_read_b128 v[160:163], v42 offset:2048
    ds_read_b64_tr_b16 v[140:141], v44 offset:16384
    ds_read_b64_tr_b16 v[142:143], v44 offset:16896
    ds_read_b128 v[164:167], v42 offset:4096
    ds_read_b128 v[168:171], v42 offset:6144
    ds_read_b128 v[172:175], v42 offset:8192
    ds_read_b128 v[176:179], v42 offset:10240
    ds_read_b128 v[180:183], v42 offset:12288
    s_waitcnt lgkmcnt(10)
    v_mfma_f32_16x16x32_bf16 v[48:51], v[132:135], v[156:159], 0
    ds_read_b64_tr_b16 v[144:145], v44 offset:4096
    s_waitcnt lgkmcnt(9)
    v_mfma_f32_16x16x32_bf16 v[76:79], v[136:139], v[156:159], 0
    ds_read_b64_tr_b16 v[146:147], v44 offset:4608
    s_waitcnt lgkmcnt(9)
    v_mfma_f32_16x16x32_bf16 v[52:55], v[132:135], v[160:163], 0
    ds_read_b128 v[184:187], v43 offset:0
    v_mfma_f32_16x16x32_bf16 v[80:83], v[136:139], v[160:163], 0
    ds_read_b64_tr_b16 v[148:149], v44 offset:12288
    s_waitcnt lgkmcnt(9)
    v_mfma_f32_16x16x32_bf16 v[104:107], v[140:143], v[156:159], 0
    ds_read_b64_tr_b16 v[150:151], v44 offset:12800
    v_mfma_f32_16x16x32_bf16 v[108:111], v[140:143], v[160:163], 0
    ds_read_b128 v[188:191], v43 offset:2048
    s_waitcnt lgkmcnt(10)
    v_mfma_f32_16x16x32_bf16 v[56:59], v[132:135], v[164:167], 0
    ds_read_b64_tr_b16 v[152:153], v44 offset:20480
    v_mfma_f32_16x16x32_bf16 v[84:87], v[136:139], v[164:167], 0
    ds_read_b64_tr_b16 v[154:155], v44 offset:20992
    v_mfma_f32_16x16x32_bf16 v[112:115], v[140:143], v[164:167], 0
    ds_read_b128 v[192:195], v43 offset:4096
    s_waitcnt lgkmcnt(12)
    v_mfma_f32_16x16x32_bf16 v[60:63], v[132:135], v[168:171], 0
    ds_read_b128 v[196:199], v43 offset:6144
    v_mfma_f32_16x16x32_bf16 v[88:91], v[136:139], v[168:171], 0
    ds_read_b128 v[200:203], v43 offset:8192
    v_mfma_f32_16x16x32_bf16 v[116:119], v[140:143], v[168:171], 0
    ds_read_b128 v[204:207], v43 offset:10240
    s_waitcnt lgkmcnt(14)
    v_mfma_f32_16x16x32_bf16 v[64:67], v[132:135], v[172:175], 0
    ds_read_b128 v[208:211], v43 offset:12288
    v_mfma_f32_16x16x32_bf16 v[92:95], v[136:139], v[172:175], 0
    v_mfma_f32_16x16x32_bf16 v[120:123], v[140:143], v[172:175], 0
    s_cmp_eq_u32 s64, 77824
    s_cselect_b32 s66, 4294889472, s67
    s_waitcnt lgkmcnt(14)
    v_mfma_f32_16x16x32_bf16 v[68:71], v[132:135], v[176:179], 0
    s_add_u32 s64, s64, s66
    s_add_u32 s63, s63, 1
    v_mfma_f32_16x16x32_bf16 v[96:99], v[136:139], v[176:179], 0
    v_add_u32 v44, s66, v44
    v_mfma_f32_16x16x32_bf16 v[124:127], v[140:143], v[176:179], 0
    v_add_u32 v42, s66, v42
    s_waitcnt lgkmcnt(13)
    v_mfma_f32_16x16x32_bf16 v[72:75], v[132:135], v[180:183], 0
    v_add_u32 v43, s66, v43
    v_mfma_f32_16x16x32_bf16 v[100:103], v[136:139], v[180:183], 0
    s_cmp_lt_u32 s63, 9
    v_mfma_f32_16x16x32_bf16 v[128:131], v[140:143], v[180:183], 0
    s_branch C_MID
C_LOOP:
    s_waitcnt lgkmcnt(10)
    v_mfma_f32_16x16x32_bf16 v[48:51], v[132:135], v[156:159], v[48:51]
    ds_read_b64_tr_b16 v[144:145], v44 offset:4096
    s_waitcnt lgkmcnt(9)
    v_mfma_f32_16x16x32_bf16 v[76:79], v[136:139], v[156:159], v[76:79]
    ds_read_b64_tr_b16 v[146:147], v44 offset:4608
    s_waitcnt lgkmcnt(9)
    v_mfma_f32_16x16x32_bf16 v[52:55], v[132:135], v[160:163], v[52:55]
    ds_read_b128 v[184:187], v43 offset:0
    v_mfma_f32_16x16x32_bf16 v[80:83], v[136:139], v[160:163], v[80:83]
    ds_read_b64_tr_b16 v[148:149], v44 offset:12288
    s_waitcnt lgkmcnt(9)
    v_mfma_f32_16x16x32_bf16 v[104:107], v[140:143], v[156:159], v[104:107]
    ds_read_b64_tr_b16 v[150:151], v44 offset:12800
    v_mfma_f32_16x16x32_bf16 v[108:111], v[140:143], v[160:163], v[108:111]
    ds_read_b128 v[188:191], v43 offset:2048
    s_waitcnt lgkmcnt(10)
    v_mfma_f32_16x16x32_bf16 v[56:59], v[132:135], v[164:167], v[56:59]
    ds_read_b64_tr_b16 v[152:153], v44 offset:20480
    v_mfma_f32_16x16x32_bf16 v[84:87], v[136:139], v[164:167], v[84:87]
    ds_read_b64_tr_b16 v[154:155], v44 offset:20992
    v_mfma_f32_16x16x32_bf16 v[112:115], v[140:143], v[164:167], v[112:115]
    ds_read_b128 v[192:195], v43 offset:4096
    s_waitcnt lgkmcnt(12)
    v_mfma_f32_16x16x32_bf16 v[60:63], v[132:135], v[168:171], v[60:63]
    ds_read_b128 v[196:199], v43 offset:6144
    v_mfma_f32_16x16x32_bf16 v[88:91], v[136:139], v[168:171], v[88:91]
    ds_read_b128 v[200:203], v43 offset:8192
    v_mfma_f32_16x16x32_bf16 v[116:119], v[140:143], v[168:171], v[116:119]
    ds_read_b128 v[204:207], v43 offset:10240
    s_waitcnt lgkmcnt(14)
    v_mfma_f32_16x16x32_bf16 v[64:67], v[132:135], v[172:175], v[64:67]
    ds_read_b128 v[208:211], v43 offset:12288
    v_mfma_f32_16x16x32_bf16 v[92:95], v[136:139], v[172:175], v[92:95]
    v_mfma_f32_16x16x32_bf16 v[120:123], v[140:143], v[172:175], v[120:123]
    s_cmp_eq_u32 s64, 77824
    s_cselect_b32 s66, 4294889472, s67
    s_waitcnt lgkmcnt(14)
    v_mfma_f32_16x16x32_bf16 v[68:71], v[132:135], v[176:179], v[68:71]
    s_add_u32 s64, s64, s66
    s_add_u32 s63, s63, 1
    v_mfma_f32_16x16x32_bf16 v[96:99], v[136:139], v[176:179], v[96:99]
    v_add_u32 v44, s66, v44
    v_mfma_f32_16x16x32_bf16 v[124:127], v[140:143], v[176:179], v[124:127]
    v_add_u32 v42, s66, v42
    s_waitcnt lgkmcnt(13)
    v_mfma_f32_16x16x32_bf16 v[72:75], v[132:135], v[180:183], v[72:75]
    v_add_u32 v43, s66, v43
    v_mfma_f32_16x16x32_bf16 v[100:103], v[136:139], v[180:183], v[100:103]
    s_cmp_lt_u32 s63, 9
    v_mfma_f32_16x16x32_bf16 v[128:131], v[140:143], v[180:183], v[128:131]
C_MID:
    s_waitcnt lgkmcnt(0)
    v_mfma_f32_16x16x32_bf16 v[48:51], v[144:147], v[184:187], v[48:51]
    v_mfma_f32_16x16x32_bf16 v[76:79], v[148:151], v[184:187], v[76:79]
    v_mfma_f32_16x16x32_bf16 v[104:107], v[152:155], v[184:187], v[104:107]
    v_mfma_f32_16x16x32_bf16 v[108:111], v[152:155], v[188:191], v[108:111]
    v_mfma_f32_16x16x32_bf16 v[80:83], v[148:151], v[188:191], v[80:83]
    v_mfma_f32_16x16x32_bf16 v[52:55], v[144:147], v[188:191], v[52:55]
    s_barrier
    ds_read_b64_tr_b16 v[132:133], v44 offset:0
    v_mfma_f32_16x16x32_bf16 v[56:59], v[144:147], v[192:195], v[56:59]
    ds_read_b64_tr_b16 v[134:135], v44 offset:512
    v_mfma_f32_16x16x32_bf16 v[84:87], v[148:151], v[192:195], v[84:87]
    ds_read_b128 v[156:159], v42 offset:0
    v_mfma_f32_16x16x32_bf16 v[112:115], v[152:155], v[192:195], v[112:115]
    ds_read_b64_tr_b16 v[136:137], v44 offset:8192
    v_mfma_f32_16x16x32_bf16 v[116:119], v[152:155], v[196:199], v[116:119]
    ds_read_b64_tr_b16 v[138:139], v44 offset:8704
    v_mfma_f32_16x16x32_bf16 v[88:91], v[148:151], v[196:199], v[88:91]
    ds_read_b128 v[160:163], v42 offset:2048
    v_mfma_f32_16x16x32_bf16 v[60:63], v[144:147], v[196:199], v[60:63]
    ds_read_b64_tr_b16 v[140:141], v44 offset:16384
    v_mfma_f32_16x16x32_bf16 v[64:67], v[144:147], v[200:203], v[64:67]
    ds_read_b64_tr_b16 v[142:143], v44 offset:16896
    v_mfma_f32_16x16x32_bf16 v[92:95], v[148:151], v[200:203], v[92:95]
    ds_read_b128 v[164:167], v42 offset:4096
    v_mfma_f32_16x16x32_bf16 v[120:123], v[152:155], v[200:203], v[120:123]
    ds_read_b128 v[168:171], v42 offset:6144
    v_mfma_f32_16x16x32_bf16 v[124:127], v[152:155], v[204:207], v[124:127]
    ds_read_b128 v[172:175], v42 offset:8192
    v_mfma_f32_16x16x32_bf16 v[96:99], v[148:151], v[204:207], v[96:99]
    ds_read_b128 v[176:179], v42 offset:10240
    v_mfma_f32_16x16x32_bf16 v[68:71], v[144:147], v[204:207], v[68:71]
    ds_read_b128 v[180:183], v42 offset:12288
    v_mfma_f32_16x16x32_bf16 v[72:75], v[144:147], v[208:211], v[72:75]
    v_mfma_f32_16x16x32_bf16 v[100:103], v[148:151], v[208:211], v[100:103]
    v_mfma_f32_16x16x32_bf16 v[128:131], v[152:155], v[208:211], v[128:131]
    s_cbranch_scc1 C_LOOP
TL0:
    s_cbranch_execz TL0_END
    s_setprio 2
    s_waitcnt lgkmcnt(10)
    v_mfma_f32_16x16x32_bf16 v[48:51], v[132:135], v[156:159], v[48:51]
    ds_read_b64_tr_b16 v[144:145], v44 offset:4096
    s_waitcnt lgkmcnt(9)
    v_mfma_f32_16x16x32_bf16 v[76:79], v[136:139], v[156:159], v[76:79]
    ds_read_b64_tr_b16 v[146:147], v44 offset:4608
    s_waitcnt lgkmcnt(9)
    v_mfma_f32_16x16x32_bf16 v[52:55], v[132:135], v[160:163], v[52:55]
    ds_read_b64_tr_b16 v[148:149], v44 offset:12288
    v_mfma_f32_16x16x32_bf16 v[80:83], v[136:139], v[160:163], v[80:83]
    ds_read_b64_tr_b16 v[150:151], v44 offset:12800
    s_waitcnt lgkmcnt(8)
    v_mfma_f32_16x16x32_bf16 v[56:59], v[132:135], v[164:167], v[56:59]
    ds_read_b128 v[184:187], v43 offset:0
    v_mfma_f32_16x16x32_bf16 v[84:87], v[136:139], v[164:167], v[84:87]
    ds_read_b128 v[188:191], v43 offset:2048
    s_waitcnt lgkmcnt(9)
    v_mfma_f32_16x16x32_bf16 v[60:63], v[132:135], v[168:171], v[60:63]
    ds_read_b128 v[192:195], v43 offset:4096
    v_mfma_f32_16x16x32_bf16 v[88:91], v[136:139], v[168:171], v[88:91]
    ds_read_b128 v[196:199], v43 offset:6144
    s_waitcnt lgkmcnt(10)
    v_mfma_f32_16x16x32_bf16 v[64:67], v[132:135], v[172:175], v[64:67]
    ds_read_b128 v[200:203], v43 offset:8192
    v_mfma_f32_16x16x32_bf16 v[92:95], v[136:139], v[172:175], v[92:95]
    ds_read_b128 v[204:207], v43 offset:10240
    s_waitcnt lgkmcnt(11)
    v_mfma_f32_16x16x32_bf16 v[68:71], v[132:135], v[176:179], v[68:71]
    ds_read_b128 v[208:211], v43 offset:12288
    v_mfma_f32_16x16x32_bf16 v[96:99], v[136:139], v[176:179], v[96:99]
    ds_read_b128 v[212:215], v45 offset:0
    s_waitcnt lgkmcnt(12)
    v_mfma_f32_16x16x32_bf16 v[72:75], v[132:135], v[180:183], v[72:75]
    ds_read_b128 v[216:219], v45 offset:256
    v_mfma_f32_16x16x32_bf16 v[100:103], v[136:139], v[180:183], v[100:103]
    ds_read_b128 v[220:223], v45 offset:512
    s_waitcnt lgkmcnt(7)
    v_mfma_f32_16x16x32_bf16 v[48:51], v[144:147], v[184:187], v[48:51]
    ds_read_b64_tr_b16 v[152:153], v44 offset:20480
    v_mfma_f32_16x16x32_bf16 v[76:79], v[148:151], v[184:187], v[76:79]
    ds_read_b64_tr_b16 v[154:155], v44 offset:20992
    v_mfma_f32_16x16x32_bf16 v[52:55], v[144:147], v[188:191], v[52:55]
    ds_read_b128 v[224:227], v45 offset:768
    s_waitcnt lgkmcnt(3)
    v_mfma_f32_16x16x32_bf16 v[80:83], v[148:151], v[188:191], v[80:83]
    ds_read_b128 v[228:231], v45 offset:1024
    v_mov_b32_dpp v240, v48 row_newbcast:0 row_mask:0xf bank_mask:0xf
    v_mov_b32_dpp v241, v49 row_newbcast:0 row_mask:0xf bank_mask:0xf
    v_mfma_f32_16x16x32_bf16 v[56:59], v[144:147], v[192:195], v[56:59]
    ds_read_b128 v[232:235], v45 offset:1280
    v_mov_b32_dpp v242, v50 row_newbcast:0 row_mask:0xf bank_mask:0xf
    v_mov_b32_dpp v243, v51 row_newbcast:0 row_mask:0xf bank_mask:0xf
    v_mfma_f32_16x16x32_bf16 v[84:87], v[148:151], v[192:195], v[84:87]
    ds_read_b128 v[236:239], v45 offset:1536
    v_mov_b32_dpp v244, v76 row_newbcast:0 row_mask:0xf bank_mask:0xf
    v_mov_b32_dpp v245, v77 row_newbcast:0 row_mask:0xf bank_mask:0xf
    v_mfma_f32_16x16x32_bf16 v[60:63], v[144:147], v[196:199], v[60:63]
    v_mov_b32_dpp v246, v78 row_newbcast:0 row_mask:0xf bank_mask:0xf
    v_mov_b32_dpp v247, v79 row_newbcast:0 row_mask:0xf bank_mask:0xf
    v_mfma_f32_16x16x32_bf16 v[88:91], v[148:151], v[196:199], v[88:91]
    v_fmac_f32 v48, v212, v240
    v_fmac_f32 v49, v212, v241
    v_mfma_f32_16x16x32_bf16 v[64:67], v[144:147], v[200:203], v[64:67]
    v_fmac_f32 v50, v212, v242
    v_fmac_f32 v51, v212, v243
    s_waitcnt lgkmcnt(0)
    v_mfma_f32_16x16x32_bf16 v[92:95], v[148:151], v[200:203], v[92:95]
    v_cvt_pk_bf16_f32 v48, v48, v49
    v_cvt_pk_bf16_f32 v49, v50, v51
    v_mfma_f32_16x16x32_bf16 v[68:71], v[144:147], v[204:207], v[68:71]
    ds_write_b64 v46, v[48:49] offset:128
    v_fmac_f32 v76, v212, v244
    v_mfma_f32_16x16x32_bf16 v[96:99], v[148:151], v[204:207], v[96:99]
    v_fmac_f32 v77, v212, v245
    v_fmac_f32 v78, v212, v246
    v_mfma_f32_16x16x32_bf16 v[72:75], v[144:147], v[208:211], v[72:75]
    v_fmac_f32 v79, v212, v247
    v_mul_f32 v76, v76, v214
    v_mfma_f32_16x16x32_bf16 v[100:103], v[148:151], v[208:211], v[100:103]
    v_mul_f32 v77, v77, v214
    v_mul_f32 v78, v78, v214
    v_mfma_f32_16x16x32_bf16 v[104:107], v[140:143], v[156:159], v[104:107]
    v_mul_f32 v79, v79, v214
    v_cvt_pk_bf16_f32 v76, v76, v77
    v_mfma_f32_16x16x32_bf16 v[108:111], v[140:143], v[160:163], v[108:111]
    v_cvt_pk_bf16_f32 v77, v78, v79
    ds_write_b64 v46, v[76:77] offset:0
    v_mfma_f32_16x16x32_bf16 v[104:107], v[152:155], v[184:187], v[104:107]
    v_fmac_f32 v52, v216, v240
    v_fmac_f32 v53, v216, v241
    v_mfma_f32_16x16x32_bf16 v[108:111], v[152:155], v[188:191], v[108:111]
    v_fmac_f32 v54, v216, v242
    v_fmac_f32 v55, v216, v243
    v_mfma_f32_16x16x32_bf16 v[112:115], v[140:143], v[164:167], v[112:115]
    v_cvt_pk_bf16_f32 v52, v52, v53
    v_cvt_pk_bf16_f32 v53, v54, v55
    v_mfma_f32_16x16x32_bf16 v[116:119], v[140:143], v[168:171], v[116:119]
    ds_write_b64 v46, v[52:53] offset:4480
    v_fmac_f32 v80, v216, v244
    v_mfma_f32_16x16x32_bf16 v[112:115], v[152:155], v[192:195], v[112:115]
    v_fmac_f32 v81, v216, v245
    v_fmac_f32 v82, v216, v246
    v_mfma_f32_16x16x32_bf16 v[116:119], v[152:155], v[196:199], v[116:119]
    v_fmac_f32 v83, v216, v247
    v_mul_f32 v80, v80, v218
    v_mfma_f32_16x16x32_bf16 v[120:123], v[140:143], v[172:175], v[120:123]
    v_mul_f32 v81, v81, v218
    v_mul_f32 v82, v82, v218
    v_mfma_f32_16x16x32_bf16 v[124:127], v[140:143], v[176:179], v[124:127]
    v_mul_f32 v83, v83, v218
    v_cvt_pk_bf16_f32 v80, v80, v81
    v_mfma_f32_16x16x32_bf16 v[120:123], v[152:155], v[200:203], v[120:123]
    v_cvt_pk_bf16_f32 v81, v82, v83
    ds_write_b64 v46, v[80:81] offset:4352
    v_mfma_f32_16x16x32_bf16 v[124:127], v[152:155], v[204:207], v[124:127]
    v_fmac_f32 v56, v220, v240
    v_fmac_f32 v57, v220, v241
    v_mfma_f32_16x16x32_bf16 v[128:131], v[140:143], v[180:183], v[128:131]
    v_fmac_f32 v58, v220, v242
    v_fmac_f32 v59, v220, v243
    v_mfma_f32_16x16x32_bf16 v[128:131], v[152:155], v[208:211], v[128:131]
    v_cvt_pk_bf16_f32 v56, v56, v57
    v_cvt_pk_bf16_f32 v57, v58, v59
    ds_write_b64 v46, v[56:57] offset:8832
    v_fmac_f32 v84, v220, v244
    v_fmac_f32 v85, v220, v245
    v_fmac_f32 v86, v220, v246
    v_fmac_f32 v87, v220, v247
    v_mul_f32 v84, v84, v222
    v_mul_f32 v85, v85, v222
    v_mul_f32 v86, v86, v222
    v_mul_f32 v87, v87, v222
    v_cvt_pk_bf16_f32 v84, v84, v85
    v_cvt_pk_bf16_f32 v85, v86, v87
    ds_write_b64 v46, v[84:85] offset:8704
    v_pk_fma_f32 v[88:89], v[224:225], v[244:245], v[88:89] op_sel_hi:[0,1,1]
    v_pk_fma_f32 v[90:91], v[224:225], v[246:247], v[90:91] op_sel_hi:[0,1,1]
    v_pk_fma_f32 v[60:61], v[224:225], v[240:241], v[60:61] op_sel_hi:[0,1,1]
    v_pk_fma_f32 v[62:63], v[224:225], v[242:243], v[62:63] op_sel_hi:[0,1,1]
    v_pk_mul_f32 v[88:89], v[88:89], v[226:227] op_sel_hi:[1,0]
    v_pk_mul_f32 v[90:91], v[90:91], v[226:227] op_sel_hi:[1,0]
    v_cvt_pk_bf16_f32 v60, v60, v61
    v_cvt_pk_bf16_f32 v61, v62, v63
    ds_write_b64 v46, v[60:61] offset:13184
    v_cvt_pk_bf16_f32 v88, v88, v89
    v_cvt_pk_bf16_f32 v89, v90, v91
    ds_write_b64 v46, v[88:89] offset:13056
    v_pk_fma_f32 v[92:93], v[228:229], v[244:245], v[92:93] op_sel_hi:[0,1,1]
    v_pk_fma_f32 v[94:95], v[228:229], v[246:247], v[94:95] op_sel_hi:[0,1,1]
    v_pk_fma_f32 v[64:65], v[228:229], v[240:241], v[64:65] op_sel_hi:[0,1,1]
    v_pk_fma_f32 v[66:67], v[228:229], v[242:243], v[66:67] op_sel_hi:[0,1,1]
    v_pk_mul_f32 v[92:93], v[92:93], v[230:231] op_sel_hi:[1,0]
    v_pk_mul_f32 v[94:95], v[94:95], v[230:231] op_sel_hi:[1,0]
    v_cvt_pk_bf16_f32 v64, v64, v65
    v_cvt_pk_bf16_f32 v65, v66, v67
    ds_write_b64 v46, v[64:65] offset:17536
    v_cvt_pk_bf16_f32 v92, v92, v93
    v_cvt_pk_bf16_f32 v93, v94, v95
    ds_write_b64 v46, v[92:93] offset:17408
    v_pk_fma_f32 v[96:97], v[232:233], v[244:245], v[96:97] op_sel_hi:[0,1,1]
    v_pk_fma_f32 v[98:99], v[232:233], v[246:247], v[98:99] op_sel_hi:[0,1,1]
    v_pk_fma_f32 v[68:69], v[232:233], v[240:241], v[68:69] op_sel_hi:[0,1,1]
    v_pk_fma_f32 v[70:71], v[232:233], v[242:243], v[70:71] op_sel_hi:[0,1,1]
    v_pk_mul_f32 v[96:97], v[96:97], v[234:235] op_sel_hi:[1,0]
    v_pk_mul_f32 v[98:99], v[98:99], v[234:235] op_sel_hi:[1,0]
    v_cvt_pk_bf16_f32 v68, v68, v69
    v_cvt_pk_bf16_f32 v69, v70, v71
    ds_write_b64 v46, v[68:69] offset:21888
    v_cvt_pk_bf16_f32 v96, v96, v97
    v_cvt_pk_bf16_f32 v97, v98, v99
    ds_write_b64 v46, v[96:97] offset:21760
    v_pk_fma_f32 v[100:101], v[236:237], v[244:245], v[100:101] op_sel_hi:[0,1,1]
    v_pk_fma_f32 v[102:103], v[236:237], v[246:247], v[102:103] op_sel_hi:[0,1,1]
    v_pk_fma_f32 v[72:73], v[236:237], v[240:241], v[72:73] op_sel_hi:[0,1,1]
    v_pk_fma_f32 v[74:75], v[236:237], v[242:243], v[74:75] op_sel_hi:[0,1,1]
    v_pk_mul_f32 v[100:101], v[100:101], v[238:239] op_sel_hi:[1,0]
    v_pk_mul_f32 v[102:103], v[102:103], v[238:239] op_sel_hi:[1,0]
    v_cvt_pk_bf16_f32 v72, v72, v73
    v_cvt_pk_bf16_f32 v73, v74, v75
    ds_write_b64 v46, v[72:73] offset:26240
    v_cvt_pk_bf16_f32 v100, v100, v101
    v_cvt_pk_bf16_f32 v101, v102, v103
    ds_write_b64 v46, v[100:101] offset:26112
    s_waitcnt lgkmcnt(0)
    s_barrier
    s_cmp_eq_u32 s13, 1
    s_cbranch_scc1 AC_S
    ds_read_b64 v[80:81], v20 offset:0
    ds_read_b64 v[82:83], v21 offset:0
    ds_read_b64 v[64:65], v20 offset:4480
    ds_read_b64 v[66:67], v21 offset:4480
    ds_read_b64 v[84:85], v20 offset:4352
    ds_read_b64 v[86:87], v21 offset:4352
    ds_read_b64 v[68:69], v20 offset:8832
    ds_read_b64 v[70:71], v21 offset:8832
    ds_read_b64 v[88:89], v20 offset:8704
    ds_read_b64 v[90:91], v21 offset:8704
    ds_read_b64 v[72:73], v20 offset:13184
    ds_read_b64 v[74:75], v21 offset:13184
    ds_read_b64 v[92:93], v20 offset:13056
    ds_read_b64 v[94:95], v21 offset:13056
    v_lshl_add_u32 v3, v5, 8, v26
    v_mov_b32 v0, v27
    v_mov_b32_dpp v248, v104 row_newbcast:0 row_mask:0xf bank_mask:0xf
    v_mov_b32_dpp v249, v105 row_newbcast:0 row_mask:0xf bank_mask:0xf
    v_mov_b32_dpp v250, v106 row_newbcast:0 row_mask:0xf bank_mask:0xf
    v_mov_b32_dpp v251, v107 row_newbcast:0 row_mask:0xf bank_mask:0xf
    v_pk_fma_f32 v[104:105], v[212:213], v[248:249], v[104:105] op_sel_hi:[0,1,1]
    v_pk_fma_f32 v[106:107], v[212:213], v[250:251], v[106:107] op_sel_hi:[0,1,1]
    v_pk_fma_f32 v[108:109], v[216:217], v[248:249], v[108:109] op_sel_hi:[0,1,1]
    v_pk_fma_f32 v[110:111], v[216:217], v[250:251], v[110:111] op_sel_hi:[0,1,1]
    v_pk_mul_f32 v[104:105], v[104:105], v[214:215] op_sel_hi:[1,0]
    v_pk_mul_f32 v[106:107], v[106:107], v[214:215] op_sel_hi:[1,0]
    v_pk_mul_f32 v[108:109], v[108:109], v[218:219] op_sel_hi:[1,0]
    v_pk_mul_f32 v[110:111], v[110:111], v[218:219] op_sel_hi:[1,0]
    v_cvt_pk_bf16_f32 v104, v104, v105
    v_cvt_pk_bf16_f32 v105, v106, v107
    ds_write_b64 v47, v[104:105] offset:0
    v_cvt_pk_bf16_f32 v108, v108, v109
    v_cvt_pk_bf16_f32 v109, v110, v111
    ds_write_b64 v47, v[108:109] offset:2176
    s_waitcnt lgkmcnt(10)
    v_mfma_f32_16x16x32_bf16 v[168:171], v[84:87], v[64:67], v[32:35]
    v_mfma_f32_16x16x32_bf16 v[48:51], v[80:83], v[64:67], v[36:39]
    s_waitcnt lgkmcnt(6)
    v_mfma_f32_16x16x32_bf16 v[172:175], v[88:91], v[68:71], v[32:35]
    v_mfma_f32_16x16x32_bf16 v[52:55], v[84:87], v[68:71], v[36:39]
    s_waitcnt lgkmcnt(2)
    v_mfma_f32_16x16x32_bf16 v[176:179], v[92:95], v[72:75], v[32:35]
    v_mfma_f32_16x16x32_bf16 v[56:59], v[88:91], v[72:75], v[36:39]
    s_branch AC_J
AC_S:
    ds_read_b64 v[80:81], v20 offset:0
    ds_read_b64 v[64:65], v20 offset:4480
    ds_read_b64 v[84:85], v20 offset:4352
    ds_read_b64 v[68:69], v20 offset:8832
    ds_read_b64 v[88:89], v20 offset:8704
    ds_read_b64 v[72:73], v20 offset:13184
    ds_read_b64 v[92:93], v20 offset:13056
    v_lshl_add_u32 v3, v5, 8, v26
    v_mov_b32 v0, v27
    v_mov_b32_dpp v248, v104 row_newbcast:0 row_mask:0xf bank_mask:0xf
    v_mov_b32_dpp v249, v105 row_newbcast:0 row_mask:0xf bank_mask:0xf
    v_mov_b32_dpp v250, v106 row_newbcast:0 row_mask:0xf bank_mask:0xf
    v_mov_b32_dpp v251, v107 row_newbcast:0 row_mask:0xf bank_mask:0xf
    v_pk_fma_f32 v[104:105], v[212:213], v[248:249], v[104:105] op_sel_hi:[0,1,1]
    v_pk_fma_f32 v[106:107], v[212:213], v[250:251], v[106:107] op_sel_hi:[0,1,1]
    v_pk_fma_f32 v[108:109], v[216:217], v[248:249], v[108:109] op_sel_hi:[0,1,1]
    v_pk_fma_f32 v[110:111], v[216:217], v[250:251], v[110:111] op_sel_hi:[0,1,1]
    v_pk_mul_f32 v[104:105], v[104:105], v[214:215] op_sel_hi:[1,0]
    v_pk_mul_f32 v[106:107], v[106:107], v[214:215] op_sel_hi:[1,0]
    v_pk_mul_f32 v[108:109], v[108:109], v[218:219] op_sel_hi:[1,0]
    v_pk_mul_f32 v[110:111], v[110:111], v[218:219] op_sel_hi:[1,0]
    v_cvt_pk_bf16_f32 v104, v104, v105
    v_cvt_pk_bf16_f32 v105, v106, v107
    ds_write_b64 v47, v[104:105] offset:0
    v_cvt_pk_bf16_f32 v108, v108, v109
    v_cvt_pk_bf16_f32 v109, v110, v111
    ds_write_b64 v47, v[108:109] offset:2176
    s_waitcnt lgkmcnt(6)
    v_mfma_f32_16x16x16_bf16 v[168:171], v[84:85], v[64:65], v[32:35]
    v_mfma_f32_16x16x16_bf16 v[48:51], v[80:81], v[64:65], v[36:39]
    s_waitcnt lgkmcnt(4)
    v_mfma_f32_16x16x16_bf16 v[172:175], v[88:89], v[68:69], v[32:35]
    v_mfma_f32_16x16x16_bf16 v[52:55], v[84:85], v[68:69], v[36:39]
    s_waitcnt lgkmcnt(2)
    v_mfma_f32_16x16x16_bf16 v[176:179], v[92:93], v[72:73], v[32:35]
    v_mfma_f32_16x16x16_bf16 v[56:59], v[88:89], v[72:73], v[36:39]
AC_J:
    ds_read_b32 v27, v3
    ds_read2st64_b32 v[36:37], v26 offset1:1
    ds_read2st64_b32 v[38:39], v26 offset0:2 offset1:3
    v_max_f32 v168, v168, v48
    v_max_f32 v169, v169, v49
    v_max_f32 v170, v170, v50
    v_max_f32 v171, v171, v51
    v_max_f32 v172, v172, v52
    v_max_f32 v173, v173, v53
    v_max_f32 v174, v174, v54
    v_max_f32 v175, v175, v55
    v_max_f32 v176, v176, v56
    v_max_f32 v177, v177, v57
    v_max_f32 v178, v178, v58
    v_max_f32 v179, v179, v59
    s_cmp_lg_u32 s13, 1
    s_cbranch_scc1 AC_NS
    v_cvt_pk_bf16_f32 v64, v168, v169
    v_mov_b32 v65, s52
    v_cvt_pk_bf16_f32 v66, v170, v171
    v_mov_b32 v67, s52
    buffer_store_dwordx4 v[64:67], v6, s[28:31], s11 offen offset:0 sc1
    v_cvt_pk_bf16_f32 v68, v172, v173
    v_mov_b32 v69, s52
    v_cvt_pk_bf16_f32 v70, v174, v175
    v_mov_b32 v71, s52
    buffer_store_dwordx4 v[68:71], v6, s[28:31], s11 offen offset:1024 sc1
    v_cvt_pk_bf16_f32 v72, v176, v177
    v_mov_b32 v73, s52
    v_cvt_pk_bf16_f32 v74, v178, v179
    v_mov_b32 v75, s52
    buffer_store_dwordx4 v[72:75], v6, s[28:31], s11 offen offset:2048 sc1
AC_NS:
    v_pk_fma_f32 v[112:113], v[220:221], v[248:249], v[112:113] op_sel_hi:[0,1,1]
    v_pk_fma_f32 v[114:115], v[220:221], v[250:251], v[114:115] op_sel_hi:[0,1,1]
    v_pk_fma_f32 v[116:117], v[224:225], v[248:249], v[116:117] op_sel_hi:[0,1,1]
    v_pk_fma_f32 v[118:119], v[224:225], v[250:251], v[118:119] op_sel_hi:[0,1,1]
    v_pk_mul_f32 v[112:113], v[112:113], v[222:223] op_sel_hi:[1,0]
    v_pk_mul_f32 v[114:115], v[114:115], v[222:223] op_sel_hi:[1,0]
    v_pk_mul_f32 v[116:117], v[116:117], v[226:227] op_sel_hi:[1,0]
    v_pk_mul_f32 v[118:119], v[118:119], v[226:227] op_sel_hi:[1,0]
    v_cvt_pk_bf16_f32 v112, v112, v113
    v_cvt_pk_bf16_f32 v113, v114, v115
    ds_write_b64 v47, v[112:113] offset:4352
    v_cvt_pk_bf16_f32 v116, v116, v117
    v_cvt_pk_bf16_f32 v117, v118, v119
    ds_write_b64 v47, v[116:117] offset:6528
    v_pk_fma_f32 v[120:121], v[228:229], v[248:249], v[120:121] op_sel_hi:[0,1,1]
    v_pk_fma_f32 v[122:123], v[228:229], v[250:251], v[122:123] op_sel_hi:[0,1,1]
    v_pk_fma_f32 v[124:125], v[232:233], v[248:249], v[124:125] op_sel_hi:[0,1,1]
    v_pk_fma_f32 v[126:127], v[232:233], v[250:251], v[126:127] op_sel_hi:[0,1,1]
    v_pk_mul_f32 v[120:121], v[120:121], v[230:231] op_sel_hi:[1,0]
    v_pk_mul_f32 v[122:123], v[122:123], v[230:231] op_sel_hi:[1,0]
    v_pk_mul_f32 v[124:125], v[124:125], v[234:235] op_sel_hi:[1,0]
    v_pk_mul_f32 v[126:127], v[126:127], v[234:235] op_sel_hi:[1,0]
    v_cvt_pk_bf16_f32 v120, v120, v121
    v_cvt_pk_bf16_f32 v121, v122, v123
    ds_write_b64 v47, v[120:121] offset:8704
    v_cvt_pk_bf16_f32 v124, v124, v125
    v_cvt_pk_bf16_f32 v125, v126, v127
    ds_write_b64 v47, v[124:125] offset:10880
    v_pk_fma_f32 v[128:129], v[236:237], v[248:249], v[128:129] op_sel_hi:[0,1,1]
    v_pk_fma_f32 v[130:131], v[236:237], v[250:251], v[130:131] op_sel_hi:[0,1,1]
    v_pk_mul_f32 v[128:129], v[128:129], v[238:239] op_sel_hi:[1,0]
    v_pk_mul_f32 v[130:131], v[130:131], v[238:239] op_sel_hi:[1,0]
    v_cvt_pk_bf16_f32 v128, v128, v129
    v_cvt_pk_bf16_f32 v129, v130, v131
    ds_write_b64 v47, v[128:129] offset:13056
    s_waitcnt lgkmcnt(0)
    s_barrier
    ds_read_b64_tr_b16 v[184:185], v22 offset:0
    ds_read_b64_tr_b16 v[194:195], v23 offset:0
    ds_read_b64_tr_b16 v[186:187], v22 offset:2176
    ds_read_b64_tr_b16 v[196:197], v23 offset:2176
    ds_read_b64_tr_b16 v[188:189], v22 offset:4352
    ds_read_b64_tr_b16 v[198:199], v23 offset:4352
    ds_read_b64_tr_b16 v[190:191], v22 offset:6528
    ds_read_b64_tr_b16 v[200:201], v23 offset:6528
    s_cbranch_scc0 AC_X
AC_SM:
    v_max3_f32 v136, v168, v169, v170
    v_max3_f32 v138, v172, v173, v174
    v_max3_f32 v140, v176, v177, v178
    v_max_f32 v136, v136, v171
    v_max_f32 v138, v138, v175
    v_max_f32 v140, v140, v179
    s_nop 1
    v_permlane32_swap_b32 v136, v140
    v_permlane32_swap_b32 v138, v142
    v_max_f32 v136, v136, v140
    v_max_f32 v138, v138, v142
    v_mul_f32 v27, 0x3ea52b5c, v27
    s_nop 0
    v_permlane16_swap_b32 v136, v138
    v_max_f32 v136, v136, v138
    v_mul_f32 v138, v136, v27
    v_mul_f32 v136, v136, v27
    v_mul_f32 v32, 0x3ea52b5c, v36
    v_mul_f32 v34, 0x3ea52b5c, v37
    v_permlane16_swap_b32 v136, v138
    v_mov_b32 v140, v136
    v_mov_b32 v142, v138
    v_mul_f32 v36, 0x3ea52b5c, v38
    v_permlane32_swap_b32 v136, v140
    v_permlane32_swap_b32 v138, v142
    v_pk_fma_f32 v[168:169], v[168:169], v[32:33], v[136:137] op_sel_hi:[1,0,0] neg_lo:[0,0,1] neg_hi:[0,0,1]
    v_pk_fma_f32 v[170:171], v[170:171], v[32:33], v[136:137] op_sel_hi:[1,0,0] neg_lo:[0,0,1] neg_hi:[0,0,1]
    v_pk_fma_f32 v[172:173], v[172:173], v[34:35], v[138:139] op_sel_hi:[1,0,0] neg_lo:[0,0,1] neg_hi:[0,0,1]
    v_pk_fma_f32 v[174:175], v[174:175], v[34:35], v[138:139] op_sel_hi:[1,0,0] neg_lo:[0,0,1] neg_hi:[0,0,1]
    v_pk_fma_f32 v[176:177], v[176:177], v[36:37], v[140:141] op_sel_hi:[1,0,0] neg_lo:[0,0,1] neg_hi:[0,0,1]
    v_pk_fma_f32 v[178:179], v[178:179], v[36:37], v[140:141] op_sel_hi:[1,0,0] neg_lo:[0,0,1] neg_hi:[0,0,1]
    v_exp_f32 v168, v168
    v_exp_f32 v169, v169
    v_exp_f32 v170, v170
    v_exp_f32 v171, v171
    v_cvt_pk_bf16_f32 v2, v168, v169
    v_cvt_pk_bf16_f32 v3, v170, v171
    v_bfi_b32 v168, v40, 0, v2
    v_bfi_b32 v169, v41, 0, v3
    v_and_b32 v170, v40, v2
    v_and_b32 v171, v41, v3
    s_waitcnt lgkmcnt(0)
    v_exp_f32 v172, v172
    v_mfma_f32_16x16x32_bf16 v[116:119], v[28:31], v[168:171], 0
    v_exp_f32 v173, v173
    v_mfma_f32_16x16x32_bf16 v[136:139], v[184:187], v[168:171], 0
    v_exp_f32 v174, v174
    v_mfma_f32_16x16x32_bf16 v[152:155], v[194:197], v[168:171], 0
    v_exp_f32 v175, v175
    v_cvt_pk_bf16_f32 v2, v172, v173
    v_cvt_pk_bf16_f32 v3, v174, v175
    v_bfi_b32 v172, v40, 0, v2
    v_bfi_b32 v173, v41, 0, v3
    v_and_b32 v174, v40, v2
    v_and_b32 v175, v41, v3
    v_rcp_f32 v32, v116
    v_exp_f32 v176, v176
    v_mfma_f32_16x16x32_bf16 v[120:123], v[28:31], v[172:175], 0
    v_exp_f32 v177, v177
    v_mfma_f32_16x16x32_bf16 v[140:143], v[186:189], v[172:175], 0
    v_exp_f32 v178, v178
    v_mfma_f32_16x16x32_bf16 v[156:159], v[196:199], v[172:175], 0
    v_exp_f32 v179, v179
    v_cvt_pk_bf16_f32 v2, v176, v177
    v_cvt_pk_bf16_f32 v3, v178, v179
    v_bfi_b32 v176, v40, 0, v2
    v_bfi_b32 v177, v41, 0, v3
    v_and_b32 v178, v40, v2
    v_and_b32 v179, v41, v3
    v_rcp_f32 v34, v120
    v_mul_f32 v136, v136, v32
    v_mfma_f32_16x16x32_bf16 v[116:119], v[28:31], v[176:179], 0
    v_mul_f32 v137, v137, v32
    v_mfma_f32_16x16x32_bf16 v[144:147], v[188:191], v[176:179], 0
    v_mul_f32 v138, v138, v32
    v_mfma_f32_16x16x32_bf16 v[160:163], v[198:201], v[176:179], 0
    v_mul_f32 v139, v139, v32
    v_cvt_pk_bf16_f32 v136, v136, v137
    v_cvt_pk_bf16_f32 v137, v138, v139
    v_mul_f32 v140, v140, v34
    v_mul_f32 v141, v141, v34
    v_mul_f32 v142, v142, v34
    v_mul_f32 v143, v143, v34
    v_cvt_pk_bf16_f32 v138, v140, v141
    v_cvt_pk_bf16_f32 v139, v142, v143
    v_rcp_f32 v36, v116
    v_permlane32_swap_b32 v136, v138
    v_permlane32_swap_b32 v137, v139
    v_pk_mul_f32 v[144:145], v[144:145], v[36:37] op_sel_hi:[1,0]
    v_pk_mul_f32 v[146:147], v[146:147], v[36:37] op_sel_hi:[1,0]
    v_cvt_pk_bf16_f32 v144, v144, v145
    v_cvt_pk_bf16_f32 v145, v146, v147
    s_mov_b64 exec, s[14:15]
    buffer_store_dwordx4 v[136:139], v24, s[28:31], s9 offen sc1
    s_mov_b64 exec, -1
    v_permlane32_swap_b32 v144, v146
    v_permlane32_swap_b32 v145, v147
    v_pk_mul_f32 v[152:153], v[152:153], v[32:33] op_sel_hi:[1,0]
    v_pk_mul_f32 v[154:155], v[154:155], v[32:33] op_sel_hi:[1,0]
    s_mov_b64 exec, s[16:17]
    buffer_store_dwordx4 v[144:147], v24, s[28:31], s5 offen sc1
    s_lshl_b64 exec, -1, 16
    v_pk_mul_f32 v[152:153], v[156:157], v[34:35] op_sel_hi:[1,0]
    v_pk_mul_f32 v[154:155], v[158:159], v[34:35] op_sel_hi:[1,0]
    s_lshl_b64 exec, -1, 32
    v_pk_mul_f32 v[152:153], v[160:161], v[36:37] op_sel_hi:[1,0]
    v_pk_mul_f32 v[154:155], v[162:163], v[36:37] op_sel_hi:[1,0]
    s_mov_b64 exec, s[18:19]
    v_cvt_pk_bf16_f32 v152, v152, v153
    v_cvt_pk_bf16_f32 v153, v154, v155
    buffer_store_dwordx2 v[152:153], v25, s[28:31], s10 offen sc1
    s_mov_b64 exec, -1
A_DONE:
TC1:
    s_cbranch_execz TC2
    s_cmp_lg_u32 s13, 0
    s_cbranch_scc1 P_TAIL
    s_setprio 1
    v_mov_b32 v2, 1
    ds_write_b8 v18, v2 offset:0
    s_cmp_eq_u32 s101, 0
    s_cbranch_scc1 K_END
    v_xor_b32 v28, 32, v8
    v_xor_b32 v29, 64, v8
    v_xor_b32 v30, 96, v8
    ds_read_b64 v[48:49], v8 offset:0
    ds_read_b64 v[50:51], v28 offset:0
    ds_read_b64 v[52:53], v29 offset:0
    ds_read_b64 v[54:55], v30 offset:0
    ds_read_b64 v[56:57], v8 offset:2048
    ds_read_b64 v[58:59], v28 offset:2048
    ds_read_b64 v[60:61], v29 offset:2048
    ds_read_b64 v[62:63], v30 offset:2048
    s_cmp_eq_u32 s101, 2
    s_cselect_b32 s60, 0, 2146435072
    s_add_u32 s60, s60, 20480
    v_add_u32 v31, s60, v6
    s_mov_b32 s100, 0
    v_xor_b32 v28, 32, v9
    v_xor_b32 v29, 64, v9
    v_xor_b32 v30, 96, v9
    ds_read_b64_tr_b16 v[160:161], v9 offset:0
    ds_read_b64_tr_b16 v[164:165], v28 offset:0
    ds_read_b64_tr_b16 v[168:169], v29 offset:0
    ds_read_b64_tr_b16 v[172:173], v30 offset:0
    ds_read_b64_tr_b16 v[162:163], v9 offset:1024
    ds_read_b64_tr_b16 v[166:167], v28 offset:1024
    ds_read_b64_tr_b16 v[170:171], v29 offset:1024
    ds_read_b64_tr_b16 v[174:175], v30 offset:1024
    s_waitcnt lgkmcnt(8)
    v_lshlrev_b32 v64, 16, v48
    ds_read_b64_tr_b16 v[176:177], v29 offset:7680
    v_and_b32 v65, 0xffff0000, v48
    ds_read_b64_tr_b16 v[180:181], v30 offset:7680
    v_lshlrev_b32 v66, 16, v49
    ds_read_b64_tr_b16 v[184:185], v9 offset:7680
    v_and_b32 v67, 0xffff0000, v49
    ds_read_b64_tr_b16 v[188:189], v28 offset:7680
    v_lshlrev_b32 v68, 16, v50
    ds_read_b64_tr_b16 v[178:179], v29 offset:8704
    v_and_b32 v69, 0xffff0000, v50
    ds_read_b64_tr_b16 v[182:183], v30 offset:8704
    v_lshlrev_b32 v70, 16, v51
    ds_read_b64_tr_b16 v[186:187], v9 offset:8704
    v_and_b32 v71, 0xffff0000, v51
    ds_read_b64_tr_b16 v[190:191], v28 offset:8704
    v_lshlrev_b32 v72, 16, v52
    ds_read_b64_tr_b16 v[192:193], v9 offset:15360
    v_and_b32 v73, 0xffff0000, v52
    ds_read_b64_tr_b16 v[196:197], v28 offset:15360
    v_lshlrev_b32 v74, 16, v53
    ds_read_b64_tr_b16 v[200:201], v29 offset:15360
    v_and_b32 v75, 0xffff0000, v53
    ds_read_b64_tr_b16 v[204:205], v30 offset:15360
    v_lshlrev_b32 v76, 16, v54
    ds_read_b64_tr_b16 v[194:195], v9 offset:16384
    v_and_b32 v77, 0xffff0000, v54
    ds_read_b64_tr_b16 v[198:199], v28 offset:16384
    v_lshlrev_b32 v78, 16, v55
    ds_read_b64_tr_b16 v[202:203], v29 offset:16384
    v_and_b32 v79, 0xffff0000, v55
    ds_read_b64_tr_b16 v[206:207], v30 offset:16384
    v_lshlrev_b32 v80, 16, v56
    ds_read_b64_tr_b16 v[208:209], v29 offset:23040
    v_and_b32 v81, 0xffff0000, v56
    ds_read_b64_tr_b16 v[212:213], v30 offset:23040
    v_lshlrev_b32 v82, 16, v57
    ds_read_b64_tr_b16 v[216:217], v9 offset:23040
    v_and_b32 v83, 0xffff0000, v57
    ds_read_b64_tr_b16 v[220:221], v28 offset:23040
    v_lshlrev_b32 v84, 16, v58
    ds_read_b64_tr_b16 v[210:211], v29 offset:24064
    v_and_b32 v85, 0xffff0000, v58
    ds_read_b64_tr_b16 v[214:215], v30 offset:24064
    v_lshlrev_b32 v86, 16, v59
    ds_read_b64_tr_b16 v[218:219], v9 offset:24064
    v_and_b32 v87, 0xffff0000, v59
    ds_read_b64_tr_b16 v[222:223], v28 offset:24064
    v_lshlrev_b32 v88, 16, v60
    ds_read_b64_tr_b16 v[224:225], v9 offset:30720
    s_cmp_lt_u32 s3, 4
    s_cbranch_scc1 G_NOS
    s_sleep 6
G_NOS:
    buffer_load_dwordx4 v[96:99], v0, s[28:31], s96 offen offset:0 sc1
    buffer_load_dwordx4 v[100:103], v31, s[28:31], s96 offen offset:0 sc1
    buffer_load_dwordx4 v[104:107], v0, s[28:31], s96 offen offset:1024 sc1
    buffer_load_dwordx4 v[108:111], v31, s[28:31], s96 offen offset:1024 sc1
    buffer_load_dwordx4 v[112:115], v0, s[28:31], s96 offen offset:2048 sc1
    buffer_load_dwordx4 v[116:119], v31, s[28:31], s96 offen offset:2048 sc1
    buffer_load_dwordx4 v[120:123], v0, s[28:31], s96 offen offset:3072 sc1
    buffer_load_dwordx4 v[124:127], v31, s[28:31], s96 offen offset:3072 sc1
    buffer_load_dwordx4 v[128:131], v0, s[28:31], s92 offen offset:0 sc1
    buffer_load_dwordx4 v[132:135], v31, s[28:31], s92 offen offset:0 sc1
    v_and_b32 v89, 0xffff0000, v60
    ds_read_b64_tr_b16 v[228:229], v28 offset:30720
    v_lshlrev_b32 v90, 16, v61
    ds_read_b64_tr_b16 v[232:233], v29 offset:30720
    v_and_b32 v91, 0xffff0000, v61
    ds_read_b64_tr_b16 v[236:237], v30 offset:30720
    v_lshlrev_b32 v92, 16, v62
    ds_read_b64_tr_b16 v[226:227], v9 offset:31744
    v_and_b32 v93, 0xffff0000, v62
    ds_read_b64_tr_b16 v[230:231], v28 offset:31744
    v_lshlrev_b32 v94, 16, v63
    ds_read_b64_tr_b16 v[234:235], v29 offset:31744
    v_and_b32 v95, 0xffff0000, v63
    ds_read_b64_tr_b16 v[238:239], v30 offset:31744
    v_xor_b32 v28, 32, v10
    v_xor_b32 v29, 64, v10
    v_xor_b32 v30, 96, v10
    ds_read_b64_tr_b16 v[240:241], v10 offset:0
    ds_read_b64_tr_b16 v[244:245], v28 offset:0
    ds_read_b64_tr_b16 v[248:249], v29 offset:0
    ds_read_b64_tr_b16 v[252:253], v30 offset:0
    ds_read_b64_tr_b16 v[242:243], v10 offset:1024
    ds_read_b64_tr_b16 v[246:247], v28 offset:1024
    ds_read_b64_tr_b16 v[250:251], v29 offset:1024
    ds_read_b64_tr_b16 v[254:255], v30 offset:1024
    s_waitcnt vmcnt(8)
    v_max3_u32 v2, v96, v98, v100
    v_max_u32 v2, v2, v102
    v_cmp_eq_u32 vcc, -1, v2
    s_waitcnt lgkmcnt(15)
    s_cbranch_vccnz G2_R0
G2_OK0:
    v_mfma_f32_16x16x32_bf16 v[32:35], v[160:163], v[96:99], 0
    ds_read_b64 v[24:25], v19 offset:16
    buffer_load_dwordx4 v[136:139], v0, s[28:31], s92 offen offset:1024 sc1
    v_mfma_f32_16x16x32_bf16 v[48:51], v[160:163], v[100:103], 0
    s_waitcnt vmcnt(7)
    v_mfma_f32_16x16x32_bf16 v[36:39], v[164:167], v[96:99], 0
    v_max3_u32 v2, v104, v106, v108
    v_mfma_f32_16x16x32_bf16 v[52:55], v[164:167], v[100:103], 0
    v_max_u32 v2, v2, v110
    v_mfma_f32_16x16x32_bf16 v[40:43], v[168:171], v[96:99], 0
    buffer_load_dwordx4 v[140:143], v31, s[28:31], s92 offen offset:1024 sc1
    v_mfma_f32_16x16x32_bf16 v[56:59], v[168:171], v[100:103], 0
    v_cmp_eq_u32 vcc, -1, v2
    v_mfma_f32_16x16x32_bf16 v[44:47], v[172:175], v[96:99], 0
    s_waitcnt lgkmcnt(0)
    v_mfma_f32_16x16x32_bf16 v[60:63], v[172:175], v[100:103], 0
    s_cbranch_vccnz G2_R1
G2_OK1:
    v_mfma_f32_16x16x32_bf16 v[32:35], v[176:179], v[104:107], v[32:35]
    v_xor_b32 v28, 32, v11
    v_xor_b32 v29, 64, v11
    v_and_b32 v3, v24, v25
    v_cmp_ne_u32 vcc, 0x01010101, v3
    v_mfma_f32_16x16x32_bf16 v[48:51], v[176:179], v[108:111], v[48:51]
    v_xor_b32 v30, 96, v11
    buffer_load_dwordx4 v[144:147], v0, s[28:31], s92 offen offset:2048 sc1
    s_waitcnt vmcnt(7)
    v_mfma_f32_16x16x32_bf16 v[36:39], v[180:183], v[104:107], v[36:39]
    ds_read_b64_tr_b16 v[160:161], v11 offset:0
    ds_read_b64_tr_b16 v[164:165], v28 offset:0
    s_cbranch_vccnz G2_ZAR
G2_ZAOK:
    v_mfma_f32_16x16x32_bf16 v[52:55], v[180:183], v[108:111], v[52:55]
    ds_read_b64_tr_b16 v[168:169], v29 offset:0
    v_max3_u32 v2, v112, v114, v116
    v_max_u32 v2, v2, v118
    v_mfma_f32_16x16x32_bf16 v[40:43], v[184:187], v[104:107], v[40:43]
    ds_read_b64_tr_b16 v[172:173], v30 offset:0
    buffer_load_dwordx4 v[148:151], v31, s[28:31], s92 offen offset:2048 sc1
    v_mfma_f32_16x16x32_bf16 v[56:59], v[184:187], v[108:111], v[56:59]
    ds_read_b64_tr_b16 v[162:163], v11 offset:15360
    ds_read_b64_tr_b16 v[166:167], v28 offset:15360
    v_cmp_eq_u32 vcc, -1, v2
    v_mfma_f32_16x16x32_bf16 v[44:47], v[188:191], v[104:107], v[44:47]
    ds_read_b64_tr_b16 v[170:171], v29 offset:15360
    v_mfma_f32_16x16x32_bf16 v[60:63], v[188:191], v[108:111], v[60:63]
    ds_read_b64_tr_b16 v[174:175], v30 offset:15360
    s_cbranch_vccnz G2_R2
G2_OK2:
    v_mfma_f32_16x16x32_bf16 v[32:35], v[192:195], v[112:115], v[32:35]
    v_add_u32 v9, 40960, v9
    v_xor_b32 v28, 32, v9
    buffer_load_dwordx4 v[152:155], v0, s[28:31], s4 offen offset:0 sc1
    v_mfma_f32_16x16x32_bf16 v[48:51], v[192:195], v[116:119], v[48:51]
    v_xor_b32 v29, 64, v9
    s_waitcnt vmcnt(7)
    v_mfma_f32_16x16x32_bf16 v[36:39], v[196:199], v[112:115], v[36:39]
    v_xor_b32 v30, 96, v9
    ds_read_b64_tr_b16 v[176:177], v9 offset:0
    v_max3_u32 v2, v120, v122, v124
    v_mfma_f32_16x16x32_bf16 v[52:55], v[196:199], v[116:119], v[52:55]
    ds_read_b64_tr_b16 v[180:181], v28 offset:0
    v_max_u32 v2, v2, v126
    v_mfma_f32_16x16x32_bf16 v[40:43], v[200:203], v[112:115], v[40:43]
    ds_read_b64_tr_b16 v[184:185], v29 offset:0
    ds_read_b64_tr_b16 v[188:189], v30 offset:0
    buffer_load_dwordx4 v[156:159], v31, s[28:31], s4 offen offset:0 sc1
    v_mfma_f32_16x16x32_bf16 v[56:59], v[200:203], v[116:119], v[56:59]
    ds_read_b64_tr_b16 v[178:179], v9 offset:1024
    v_cmp_eq_u32 vcc, -1, v2
    v_mfma_f32_16x16x32_bf16 v[44:47], v[204:207], v[112:115], v[44:47]
    ds_read_b64_tr_b16 v[182:183], v28 offset:1024
    ds_read_b64_tr_b16 v[186:187], v29 offset:1024
    v_mfma_f32_16x16x32_bf16 v[60:63], v[204:207], v[116:119], v[60:63]
    ds_read_b64_tr_b16 v[190:191], v30 offset:1024
    s_cbranch_vccnz G2_R3
G2_OK3:
    v_mfma_f32_16x16x32_bf16 v[32:35], v[208:211], v[120:123], v[32:35]
    ds_read_b64_tr_b16 v[192:193], v29 offset:7680
    buffer_load_dwordx4 v[96:99], v0, s[28:31], s4 offen offset:1024 sc1
    v_mfma_f32_16x16x32_bf16 v[48:51], v[208:211], v[124:127], v[48:51]
    ds_read_b64_tr_b16 v[196:197], v30 offset:7680
    s_waitcnt vmcnt(7)
    v_mfma_f32_16x16x32_bf16 v[36:39], v[212:215], v[120:123], v[36:39]
    ds_read_b64_tr_b16 v[200:201], v9 offset:7680
    v_max3_u32 v2, v128, v130, v132
    v_mfma_f32_16x16x32_bf16 v[52:55], v[212:215], v[124:127], v[52:55]
    ds_read_b64_tr_b16 v[204:205], v28 offset:7680
    v_max_u32 v2, v2, v134
    v_mfma_f32_16x16x32_bf16 v[40:43], v[216:219], v[120:123], v[40:43]
    ds_read_b64_tr_b16 v[194:195], v29 offset:8704
    buffer_load_dwordx4 v[100:103], v31, s[28:31], s4 offen offset:1024 sc1
    v_mfma_f32_16x16x32_bf16 v[56:59], v[216:219], v[124:127], v[56:59]
    ds_read_b64_tr_b16 v[198:199], v30 offset:8704
    v_cmp_eq_u32 vcc, -1, v2
    v_mfma_f32_16x16x32_bf16 v[44:47], v[220:223], v[120:123], v[44:47]
    ds_read_b64_tr_b16 v[202:203], v9 offset:8704
    v_mfma_f32_16x16x32_bf16 v[60:63], v[220:223], v[124:127], v[60:63]
    ds_read_b64_tr_b16 v[206:207], v28 offset:8704
    s_cbranch_vccnz G2_R4
G2_OK4:
    v_mfma_f32_16x16x32_bf16 v[32:35], v[224:227], v[128:131], v[32:35]
    ds_read_b64_tr_b16 v[208:209], v9 offset:15360
    buffer_load_dwordx4 v[104:107], v0, s[28:31], s4 offen offset:2048 sc1
    v_mfma_f32_16x16x32_bf16 v[48:51], v[224:227], v[132:135], v[48:51]
    ds_read_b64_tr_b16 v[212:213], v28 offset:15360
    s_waitcnt vmcnt(7)
    v_mfma_f32_16x16x32_bf16 v[36:39], v[228:231], v[128:131], v[36:39]
    ds_read_b64_tr_b16 v[216:217], v29 offset:15360
    v_max3_u32 v2, v136, v138, v140
    v_mfma_f32_16x16x32_bf16 v[52:55], v[228:231], v[132:135], v[52:55]
    ds_read_b64_tr_b16 v[220:221], v30 offset:15360
    v_max_u32 v2, v2, v142
    v_mfma_f32_16x16x32_bf16 v[40:43], v[232:235], v[128:131], v[40:43]
    ds_read_b64_tr_b16 v[210:211], v9 offset:16384
    buffer_load_dwordx4 v[108:111], v31, s[28:31], s4 offen offset:2048 sc1
    v_mfma_f32_16x16x32_bf16 v[56:59], v[232:235], v[132:135], v[56:59]
    ds_read_b64_tr_b16 v[214:215], v28 offset:16384
    v_cmp_eq_u32 vcc, -1, v2
    v_mfma_f32_16x16x32_bf16 v[44:47], v[236:239], v[128:131], v[44:47]
    ds_read_b64_tr_b16 v[218:219], v29 offset:16384
    v_mfma_f32_16x16x32_bf16 v[60:63], v[236:239], v[132:135], v[60:63]
    ds_read_b64_tr_b16 v[222:223], v30 offset:16384
    s_cbranch_vccnz G2_R5
G2_OK5:
    v_mfma_f32_16x16x32_bf16 v[32:35], v[240:243], v[136:139], v[32:35]
    ds_read_b64_tr_b16 v[224:225], v29 offset:23040
    buffer_load_dwordx4 v[112:115], v0, s[28:31], s4 offen offset:3072 sc1
    v_mfma_f32_16x16x32_bf16 v[48:51], v[240:243], v[140:143], v[48:51]
    ds_read_b64_tr_b16 v[228:229], v30 offset:23040
    s_waitcnt vmcnt(7)
    v_mfma_f32_16x16x32_bf16 v[36:39], v[244:247], v[136:139], v[36:39]
    ds_read_b64_tr_b16 v[232:233], v9 offset:23040
    v_max3_u32 v2, v144, v146, v148
    v_mfma_f32_16x16x32_bf16 v[52:55], v[244:247], v[140:143], v[52:55]
    ds_read_b64_tr_b16 v[236:237], v28 offset:23040
    v_max_u32 v2, v2, v150
    v_mfma_f32_16x16x32_bf16 v[40:43], v[248:251], v[136:139], v[40:43]
    ds_read_b64_tr_b16 v[226:227], v29 offset:24064
    buffer_load_dwordx4 v[116:119], v31, s[28:31], s4 offen offset:3072 sc1
    v_mfma_f32_16x16x32_bf16 v[56:59], v[248:251], v[140:143], v[56:59]
    ds_read_b64_tr_b16 v[230:231], v30 offset:24064
    v_cmp_eq_u32 vcc, -1, v2
    v_mfma_f32_16x16x32_bf16 v[44:47], v[252:255], v[136:139], v[44:47]
    ds_read_b64_tr_b16 v[234:235], v9 offset:24064
    s_waitcnt lgkmcnt(15)
    v_mfma_f32_16x16x32_bf16 v[60:63], v[252:255], v[140:143], v[60:63]
    ds_read_b64_tr_b16 v[238:239], v28 offset:24064
    s_cbranch_vccnz G2_R6
G2_OK6:
    v_mfma_f32_16x16x32_bf16 v[32:35], v[160:163], v[144:147], v[32:35]
    ds_read_b64_tr_b16 v[240:241], v9 offset:30720
    buffer_load_dwordx4 v[120:123], v0, s[28:31], s6 offen offset:0 sc1
    v_mfma_f32_16x16x32_bf16 v[48:51], v[160:163], v[148:151], v[48:51]
    ds_read_b64_tr_b16 v[244:245], v28 offset:30720
    s_waitcnt vmcnt(7)
    v_mfma_f32_16x16x32_bf16 v[36:39], v[164:167], v[144:147], v[36:39]
    ds_read_b64_tr_b16 v[248:249], v29 offset:30720
    v_max3_u32 v2, v152, v154, v156
    v_mfma_f32_16x16x32_bf16 v[52:55], v[164:167], v[148:151], v[52:55]
    ds_read_b64_tr_b16 v[252:253], v30 offset:30720
    v_max_u32 v2, v2, v158
    v_mfma_f32_16x16x32_bf16 v[40:43], v[168:171], v[144:147], v[40:43]
    ds_read_b64_tr_b16 v[242:243], v9 offset:31744
    buffer_load_dwordx4 v[124:127], v31, s[28:31], s6 offen offset:0 sc1
    v_mfma_f32_16x16x32_bf16 v[56:59], v[168:171], v[148:151], v[56:59]
    ds_read_b64_tr_b16 v[246:247], v28 offset:31744
    v_cmp_eq_u32 vcc, -1, v2
    v_mfma_f32_16x16x32_bf16 v[44:47], v[172:175], v[144:147], v[44:47]
    ds_read_b64_tr_b16 v[250:251], v29 offset:31744
    s_waitcnt lgkmcnt(15)
    v_mfma_f32_16x16x32_bf16 v[60:63], v[172:175], v[148:151], v[60:63]
    ds_read_b64_tr_b16 v[254:255], v30 offset:31744
    s_cbranch_vccnz G2_R7
G2_OK7:
    v_mfma_f32_16x16x32_bf16 v[32:35], v[176:179], v[152:155], v[32:35]
    ds_read_b64 v[24:25], v19 offset:0
    v_xor_b32 v28, 32, v10
    buffer_load_dwordx4 v[128:131], v0, s[28:31], s6 offen offset:1024 sc1
    v_mfma_f32_16x16x32_bf16 v[48:51], v[176:179], v[156:159], v[48:51]
    v_xor_b32 v29, 64, v10
    s_waitcnt vmcnt(7)
    v_mfma_f32_16x16x32_bf16 v[36:39], v[180:183], v[152:155], v[36:39]
    v_xor_b32 v30, 96, v10
    ds_read_b64_tr_b16 v[160:161], v10 offset:40960
    v_max3_u32 v2, v96, v98, v100
    v_mfma_f32_16x16x32_bf16 v[52:55], v[180:183], v[156:159], v[52:55]
    ds_read_b64_tr_b16 v[164:165], v28 offset:40960
    v_max_u32 v2, v2, v102
    v_mfma_f32_16x16x32_bf16 v[40:43], v[184:187], v[152:155], v[40:43]
    ds_read_b64_tr_b16 v[168:169], v29 offset:40960
    ds_read_b64_tr_b16 v[172:173], v30 offset:40960
    buffer_load_dwordx4 v[132:135], v31, s[28:31], s6 offen offset:1024 sc1
    v_mfma_f32_16x16x32_bf16 v[56:59], v[184:187], v[156:159], v[56:59]
    ds_read_b64_tr_b16 v[162:163], v10 offset:41984
    v_cmp_eq_u32 vcc, -1, v2
    v_mfma_f32_16x16x32_bf16 v[44:47], v[188:191], v[152:155], v[44:47]
    ds_read_b64_tr_b16 v[166:167], v28 offset:41984
    ds_read_b64_tr_b16 v[170:171], v29 offset:41984
    s_waitcnt lgkmcnt(7)
    v_mfma_f32_16x16x32_bf16 v[60:63], v[188:191], v[156:159], v[60:63]
    ds_read_b64_tr_b16 v[174:175], v30 offset:41984
    s_cbranch_vccnz G2_R8
G2_OK8:
    v_mfma_f32_16x16x32_bf16 v[32:35], v[192:195], v[96:99], v[32:35]
    v_xor_b32 v28, 32, v11
    v_xor_b32 v29, 64, v11
    v_and_b32 v3, v24, v25
    v_cmp_ne_u32 vcc, 0x01010101, v3
    v_mfma_f32_16x16x32_bf16 v[48:51], v[192:195], v[100:103], v[48:51]
    v_xor_b32 v30, 96, v11
    buffer_load_dwordx4 v[136:139], v0, s[28:31], s6 offen offset:2048 sc1
    s_waitcnt vmcnt(7)
    v_mfma_f32_16x16x32_bf16 v[36:39], v[196:199], v[96:99], v[36:39]
    ds_read_b64_tr_b16 v[176:177], v11 offset:40960
    ds_read_b64_tr_b16 v[180:181], v28 offset:40960
    s_cbranch_vccnz G2_ZLR
G2_ZLOK:
    v_mfma_f32_16x16x32_bf16 v[52:55], v[196:199], v[100:103], v[52:55]
    ds_read_b64_tr_b16 v[184:185], v29 offset:40960
    v_max3_u32 v2, v104, v106, v108
    v_max_u32 v2, v2, v110
    v_mfma_f32_16x16x32_bf16 v[40:43], v[200:203], v[96:99], v[40:43]
    ds_read_b64_tr_b16 v[188:189], v30 offset:40960
    buffer_load_dwordx4 v[140:143], v31, s[28:31], s6 offen offset:2048 sc1
    v_mfma_f32_16x16x32_bf16 v[56:59], v[200:203], v[100:103], v[56:59]
    ds_read_b64_tr_b16 v[178:179], v11 offset:56320
    ds_read_b64_tr_b16 v[182:183], v28 offset:56320
    v_cmp_eq_u32 vcc, -1, v2
    v_mfma_f32_16x16x32_bf16 v[44:47], v[204:207], v[96:99], v[44:47]
    ds_read_b64_tr_b16 v[186:187], v29 offset:56320
    v_mfma_f32_16x16x32_bf16 v[60:63], v[204:207], v[100:103], v[60:63]
    ds_read_b64_tr_b16 v[190:191], v30 offset:56320
    s_cbranch_vccnz G2_R9
G2_OK9:
    v_mfma_f32_16x16x32_bf16 v[32:35], v[208:211], v[104:107], v[32:35]
    v_xor_b32 v28, 32, v13
    v_xor_b32 v29, 64, v13
    v_mfma_f32_16x16x32_bf16 v[48:51], v[208:211], v[108:111], v[48:51]
    v_xor_b32 v30, 96, v13
    s_waitcnt vmcnt(6)
    v_mfma_f32_16x16x32_bf16 v[36:39], v[212:215], v[104:107], v[36:39]
    ds_read_b64_tr_b16 v[192:193], v13 offset:0
    ds_read_b64_tr_b16 v[196:197], v28 offset:0
    v_max3_u32 v2, v112, v114, v116
    v_mfma_f32_16x16x32_bf16 v[52:55], v[212:215], v[108:111], v[52:55]
    ds_read_b64_tr_b16 v[200:201], v29 offset:0
    v_max_u32 v2, v2, v118
    v_mfma_f32_16x16x32_bf16 v[40:43], v[216:219], v[104:107], v[40:43]
    ds_read_b64_tr_b16 v[204:205], v30 offset:0
    v_mfma_f32_16x16x32_bf16 v[56:59], v[216:219], v[108:111], v[56:59]
    ds_read_b64_tr_b16 v[194:195], v13 offset:1024
    ds_read_b64_tr_b16 v[198:199], v28 offset:1024
    v_cmp_eq_u32 vcc, -1, v2
    v_mfma_f32_16x16x32_bf16 v[44:47], v[220:223], v[104:107], v[44:47]
    ds_read_b64_tr_b16 v[202:203], v29 offset:1024
    v_mfma_f32_16x16x32_bf16 v[60:63], v[220:223], v[108:111], v[60:63]
    ds_read_b64_tr_b16 v[206:207], v30 offset:1024
    s_cbranch_vccnz G2_R10
G2_OK10:
    v_mfma_f32_16x16x32_bf16 v[32:35], v[224:227], v[112:115], v[32:35]
    ds_read_b64_tr_b16 v[208:209], v13 offset:40960
    v_mfma_f32_16x16x32_bf16 v[48:51], v[224:227], v[116:119], v[48:51]
    ds_read_b64_tr_b16 v[212:213], v28 offset:40960
    s_waitcnt vmcnt(4)
    v_mfma_f32_16x16x32_bf16 v[36:39], v[228:231], v[112:115], v[36:39]
    ds_read_b64_tr_b16 v[216:217], v29 offset:40960
    v_max3_u32 v2, v120, v122, v124
    v_mfma_f32_16x16x32_bf16 v[52:55], v[228:231], v[116:119], v[52:55]
    ds_read_b64_tr_b16 v[220:221], v30 offset:40960
    v_max_u32 v2, v2, v126
    v_mfma_f32_16x16x32_bf16 v[40:43], v[232:235], v[112:115], v[40:43]
    ds_read_b64_tr_b16 v[210:211], v13 offset:41984
    v_mfma_f32_16x16x32_bf16 v[56:59], v[232:235], v[116:119], v[56:59]
    ds_read_b64_tr_b16 v[214:215], v28 offset:41984
    v_cmp_eq_u32 vcc, -1, v2
    v_mfma_f32_16x16x32_bf16 v[44:47], v[236:239], v[112:115], v[44:47]
    ds_read_b64_tr_b16 v[218:219], v29 offset:41984
    v_mfma_f32_16x16x32_bf16 v[60:63], v[236:239], v[116:119], v[60:63]
    ds_read_b64_tr_b16 v[222:223], v30 offset:41984
    s_cbranch_vccnz G2_R11
G2_OK11:
    v_mfma_f32_16x16x32_bf16 v[32:35], v[240:243], v[120:123], v[32:35]
    v_xor_b32 v28, 32, v14
    v_xor_b32 v29, 64, v14
    buffer_load_dwordx4 v[144:147], v0, s[28:31], s93 offen offset:0 sc1
    buffer_load_dwordx4 v[148:151], v31, s[28:31], s93 offen offset:0 sc1
    v_mfma_f32_16x16x32_bf16 v[48:51], v[240:243], v[124:127], v[48:51]
    v_xor_b32 v30, 96, v14
    s_waitcnt vmcnt(4)
    v_mfma_f32_16x16x32_bf16 v[36:39], v[244:247], v[120:123], v[36:39]
    ds_read_b64_tr_b16 v[224:225], v14 offset:0
    ds_read_b64_tr_b16 v[228:229], v28 offset:0
    v_max3_u32 v2, v128, v130, v132
    v_mfma_f32_16x16x32_bf16 v[52:55], v[244:247], v[124:127], v[52:55]
    ds_read_b64_tr_b16 v[232:233], v29 offset:0
    v_max_u32 v2, v2, v134
    v_mfma_f32_16x16x32_bf16 v[40:43], v[248:251], v[120:123], v[40:43]
    ds_read_b64_tr_b16 v[236:237], v30 offset:0
    buffer_load_dwordx4 v[152:155], v0, s[28:31], s7 offen offset:0 sc1
    buffer_load_dwordx4 v[156:159], v31, s[28:31], s7 offen offset:0 sc1
    v_mfma_f32_16x16x32_bf16 v[56:59], v[248:251], v[124:127], v[56:59]
    ds_read_b64_tr_b16 v[226:227], v29 offset:512
    ds_read_b64_tr_b16 v[230:231], v30 offset:512
    v_cmp_eq_u32 vcc, -1, v2
    v_mfma_f32_16x16x32_bf16 v[44:47], v[252:255], v[120:123], v[44:47]
    ds_read_b64_tr_b16 v[234:235], v14 offset:512
    s_waitcnt lgkmcnt(15)
    v_mfma_f32_16x16x32_bf16 v[60:63], v[252:255], v[124:127], v[60:63]
    ds_read_b64_tr_b16 v[238:239], v28 offset:512
    s_cbranch_vccnz G2_R12
G2_OK12:
    v_mfma_f32_16x16x32_bf16 v[32:35], v[160:163], v[128:131], v[32:35]
    ds_read_b64_tr_b16 v[240:241], v14 offset:40960
    buffer_load_dwordx4 v[96:99], v0, s[28:31], s93 offen offset:1024 sc1
    buffer_load_dwordx4 v[100:103], v31, s[28:31], s93 offen offset:1024 sc1
    v_mfma_f32_16x16x32_bf16 v[48:51], v[160:163], v[132:135], v[48:51]
    ds_read_b64_tr_b16 v[244:245], v28 offset:40960
    s_waitcnt vmcnt(6)
    v_mfma_f32_16x16x32_bf16 v[36:39], v[164:167], v[128:131], v[36:39]
    ds_read_b64_tr_b16 v[248:249], v29 offset:40960
    v_max3_u32 v2, v136, v138, v140
    v_mfma_f32_16x16x32_bf16 v[52:55], v[164:167], v[132:135], v[52:55]
    ds_read_b64_tr_b16 v[252:253], v30 offset:40960
    v_max_u32 v2, v2, v142
    v_mfma_f32_16x16x32_bf16 v[40:43], v[168:171], v[128:131], v[40:43]
    ds_read_b64_tr_b16 v[242:243], v29 offset:41472
    buffer_load_dwordx4 v[104:107], v0, s[28:31], s7 offen offset:1024 sc1
    buffer_load_dwordx4 v[108:111], v31, s[28:31], s7 offen offset:1024 sc1
    v_mfma_f32_16x16x32_bf16 v[56:59], v[168:171], v[132:135], v[56:59]
    ds_read_b64_tr_b16 v[246:247], v30 offset:41472
    v_cmp_eq_u32 vcc, -1, v2
    v_mfma_f32_16x16x32_bf16 v[44:47], v[172:175], v[128:131], v[44:47]
    ds_read_b64_tr_b16 v[250:251], v14 offset:41472
    s_waitcnt lgkmcnt(15)
    v_mfma_f32_16x16x32_bf16 v[60:63], v[172:175], v[132:135], v[60:63]
    ds_read_b64_tr_b16 v[254:255], v28 offset:41472
    s_cbranch_vccnz G2_R13
G2_OK13:
    v_mfma_f32_16x16x32_bf16 v[32:35], v[176:179], v[136:139], v[32:35]
    v_xor_b32 v28, 32, v12
    v_xor_b32 v29, 64, v12
    buffer_load_dwordx4 v[112:115], v0, s[28:31], s92 offen offset:3072 sc1
    v_mfma_f32_16x16x32_bf16 v[48:51], v[176:179], v[140:143], v[48:51]
    v_xor_b32 v30, 96, v12
    ds_read_b64_tr_b16 v[160:161], v12 offset:0
    s_waitcnt vmcnt(7)
    v_mfma_f32_16x16x32_bf16 v[36:39], v[180:183], v[136:139], v[36:39]
    ds_read_b64_tr_b16 v[164:165], v28 offset:0
    ds_read_b64_tr_b16 v[168:169], v29 offset:0
    v_max3_u32 v2, v144, v146, v148
    v_mfma_f32_16x16x32_bf16 v[52:55], v[180:183], v[140:143], v[52:55]
    ds_read_b64_tr_b16 v[172:173], v30 offset:0
    v_max_u32 v2, v2, v150
    v_mfma_f32_16x16x32_bf16 v[40:43], v[184:187], v[136:139], v[40:43]
    v_xor_b32 v28, 32, v15
    v_xor_b32 v29, 64, v15
    buffer_load_dwordx4 v[116:119], v31, s[28:31], s92 offen offset:3072 sc1
    v_mfma_f32_16x16x32_bf16 v[56:59], v[184:187], v[140:143], v[56:59]
    v_xor_b32 v30, 96, v15
    ds_read_b64_tr_b16 v[162:163], v15 offset:0
    v_cmp_eq_u32 vcc, -1, v2
    v_mfma_f32_16x16x32_bf16 v[44:47], v[188:191], v[136:139], v[44:47]
    ds_read_b64_tr_b16 v[166:167], v28 offset:0
    ds_read_b64_tr_b16 v[170:171], v29 offset:0
    s_waitcnt lgkmcnt(15)
    v_mfma_f32_16x16x32_bf16 v[60:63], v[188:191], v[140:143], v[60:63]
    ds_read_b64_tr_b16 v[174:175], v30 offset:0
    s_cbranch_vccnz G2_R14
G2_OK14:
    v_mfma_f32_16x16x32_bf16 v[32:35], v[192:195], v[144:147], v[32:35]
    v_xor_b32 v28, 32, v12
    v_xor_b32 v29, 64, v12
    buffer_load_dwordx4 v[120:123], v0, s[28:31], s6 offen offset:3072 sc1
    v_mfma_f32_16x16x32_bf16 v[48:51], v[192:195], v[148:151], v[48:51]
    v_xor_b32 v30, 96, v12
    ds_read_b64_tr_b16 v[176:177], v12 offset:40960
    s_waitcnt vmcnt(7)
    v_mfma_f32_16x16x32_bf16 v[36:39], v[196:199], v[144:147], v[36:39]
    ds_read_b64_tr_b16 v[180:181], v28 offset:40960
    ds_read_b64_tr_b16 v[184:185], v29 offset:40960
    v_max3_u32 v2, v152, v154, v156
    v_mfma_f32_16x16x32_bf16 v[52:55], v[196:199], v[148:151], v[52:55]
    ds_read_b64_tr_b16 v[188:189], v30 offset:40960
    v_max_u32 v2, v2, v158
    v_mfma_f32_16x16x32_bf16 v[40:43], v[200:203], v[144:147], v[40:43]
    v_xor_b32 v28, 32, v15
    v_xor_b32 v29, 64, v15
    buffer_load_dwordx4 v[124:127], v31, s[28:31], s6 offen offset:3072 sc1
    v_mfma_f32_16x16x32_bf16 v[56:59], v[200:203], v[148:151], v[56:59]
    v_xor_b32 v30, 96, v15
    ds_read_b64_tr_b16 v[178:179], v15 offset:40960
    v_cmp_eq_u32 vcc, -1, v2
    v_mfma_f32_16x16x32_bf16 v[44:47], v[204:207], v[144:147], v[44:47]
    ds_read_b64_tr_b16 v[182:183], v28 offset:40960
    ds_read_b64_tr_b16 v[186:187], v29 offset:40960
    s_waitcnt lgkmcnt(15)
    v_mfma_f32_16x16x32_bf16 v[60:63], v[204:207], v[148:151], v[60:63]
    ds_read_b64_tr_b16 v[190:191], v30 offset:40960
    s_cbranch_vccnz G2_R15
G2_OK15:
    v_mfma_f32_16x16x32_bf16 v[32:35], v[208:211], v[152:155], v[32:35]
    v_mfma_f32_16x16x32_bf16 v[48:51], v[208:211], v[156:159], v[48:51]
    s_waitcnt vmcnt(6)
    v_mfma_f32_16x16x32_bf16 v[36:39], v[212:215], v[152:155], v[36:39]
    v_max3_u32 v2, v96, v98, v100
    v_mfma_f32_16x16x32_bf16 v[52:55], v[212:215], v[156:159], v[52:55]
    v_max_u32 v2, v2, v102
    v_mfma_f32_16x16x32_bf16 v[40:43], v[216:219], v[152:155], v[40:43]
    v_mfma_f32_16x16x32_bf16 v[56:59], v[216:219], v[156:159], v[56:59]
    v_cmp_eq_u32 vcc, -1, v2
    v_mfma_f32_16x16x32_bf16 v[44:47], v[220:223], v[152:155], v[44:47]
    s_waitcnt lgkmcnt(15)
    v_mfma_f32_16x16x32_bf16 v[60:63], v[220:223], v[156:159], v[60:63]
    s_cbranch_vccnz G2_R16
G2_OK16:
    v_mfma_f32_16x16x32_bf16 v[32:35], v[224:227], v[96:99], v[32:35]
    ds_read_b64 v[24:25], v19 offset:8
    v_xor_b32 v28, 32, v8
    v_mfma_f32_16x16x32_bf16 v[48:51], v[224:227], v[100:103], v[48:51]
    v_xor_b32 v29, 64, v8
    s_waitcnt vmcnt(4)
    v_mfma_f32_16x16x32_bf16 v[36:39], v[228:231], v[96:99], v[36:39]
    v_xor_b32 v30, 96, v8
    v_max3_u32 v2, v104, v106, v108
    v_mfma_f32_16x16x32_bf16 v[52:55], v[228:231], v[100:103], v[52:55]
    s_lshl_b32 s60, s8, 11
    v_max_u32 v2, v2, v110
    v_mfma_f32_16x16x32_bf16 v[40:43], v[232:235], v[96:99], v[40:43]
    s_add_u32 s61, s60, 147200
    v_mfma_f32_16x16x32_bf16 v[56:59], v[232:235], v[100:103], v[56:59]
    v_add_u32 v17, s61, v6
    v_cmp_eq_u32 vcc, -1, v2
    v_mfma_f32_16x16x32_bf16 v[44:47], v[236:239], v[96:99], v[44:47]
    s_lshl1_add_u32 s60, s60, 81920
    s_waitcnt lgkmcnt(0)
    v_mfma_f32_16x16x32_bf16 v[60:63], v[236:239], v[100:103], v[60:63]
    v_add_u32 v20, s60, v6
    s_cbranch_vccnz G2_R17
G2_OK17:
    v_mfma_f32_16x16x32_bf16 v[32:35], v[240:243], v[104:107], v[32:35]
    v_and_b32 v3, v24, v25
    v_cmp_ne_u32 vcc, 0x01010101, v3
    v_mfma_f32_16x16x32_bf16 v[48:51], v[240:243], v[108:111], v[48:51]
    s_waitcnt vmcnt(2)
    v_mfma_f32_16x16x32_bf16 v[36:39], v[244:247], v[104:107], v[36:39]
    s_cbranch_vccnz G2_ZGR
G2_ZGOK:
    v_mfma_f32_16x16x32_bf16 v[52:55], v[244:247], v[108:111], v[52:55]
    ds_read_b128 v[192:195], v20 offset:0
    ds_read_b128 v[196:199], v20 offset:1024
    v_max3_u32 v2, v112, v114, v116
    v_max_u32 v2, v2, v118
    v_mfma_f32_16x16x32_bf16 v[40:43], v[248:251], v[104:107], v[40:43]
    ds_read_b128 v[200:203], v20 offset:2048
    ds_read_b128 v[204:207], v20 offset:3072
    v_mfma_f32_16x16x32_bf16 v[56:59], v[248:251], v[108:111], v[56:59]
    ds_read_b128 v[208:211], v20 offset:4096
    v_cmp_eq_u32 vcc, -1, v2
    v_mfma_f32_16x16x32_bf16 v[44:47], v[252:255], v[104:107], v[44:47]
    ds_read_b128 v[212:215], v20 offset:5120
    ds_read_b128 v[216:219], v20 offset:6144
    v_mfma_f32_16x16x32_bf16 v[60:63], v[252:255], v[108:111], v[60:63]
    ds_read_b128 v[220:223], v20 offset:7168
    s_cbranch_vccnz G2_R18
G2_OK18:
    v_mfma_f32_16x16x32_bf16 v[32:35], v[160:163], v[112:115], v[32:35]
    s_waitcnt vmcnt(0)
    v_max3_u32 v2, v120, v122, v124
    v_mfma_f32_16x16x32_bf16 v[36:39], v[164:167], v[112:115], v[36:39]
    v_max_u32 v2, v2, v126
    v_cmp_eq_u32 vcc, -1, v2
    v_mfma_f32_16x16x32_bf16 v[40:43], v[168:171], v[112:115], v[40:43]
    v_mfma_f32_16x16x32_bf16 v[44:47], v[172:175], v[112:115], v[44:47]
    s_cbranch_vccnz G2_R19
G2_OK19:
    v_mfma_f32_16x16x32_bf16 v[32:35], v[176:179], v[120:123], v[32:35]
    v_mfma_f32_16x16x32_bf16 v[36:39], v[180:183], v[120:123], v[36:39]
    v_mfma_f32_16x16x32_bf16 v[40:43], v[184:187], v[120:123], v[40:43]
    v_mfma_f32_16x16x32_bf16 v[44:47], v[188:191], v[120:123], v[44:47]
    s_waitcnt lgkmcnt(0)
    s_cmp_eq_u32 s101, 1
    s_cbranch_scc1 G2_ONE
    v_mfma_f32_16x16x32_bf16 v[48:51], v[160:163], v[116:119], v[48:51]
    v_mfma_f32_16x16x32_bf16 v[52:55], v[164:167], v[116:119], v[52:55]
    v_fmac_f32 v64, v32, v192
    v_fmac_f32 v65, v33, v193
    v_fmac_f32 v66, v34, v194
    v_mfma_f32_16x16x32_bf16 v[56:59], v[168:171], v[116:119], v[56:59]
    v_fmac_f32 v67, v35, v195
    v_cvt_pk_bf16_f32 v96, v64, v65
    v_cvt_pk_bf16_f32 v97, v66, v67
    v_mfma_f32_16x16x32_bf16 v[60:63], v[172:175], v[116:119], v[60:63]
    ds_write_b64 v8, v[96:97] offset:0
    v_fmac_f32 v68, v36, v196
    v_fmac_f32 v69, v37, v197
    v_mfma_f32_16x16x32_bf16 v[48:51], v[176:179], v[124:127], v[48:51]
    v_fmac_f32 v70, v38, v198
    v_fmac_f32 v71, v39, v199
    v_cvt_pk_bf16_f32 v98, v68, v69
    v_mfma_f32_16x16x32_bf16 v[52:55], v[180:183], v[124:127], v[52:55]
    v_cvt_pk_bf16_f32 v99, v70, v71
    ds_write_b64 v28, v[98:99] offset:0
    v_fmac_f32 v72, v40, v200
    v_mfma_f32_16x16x32_bf16 v[56:59], v[184:187], v[124:127], v[56:59]
    v_fmac_f32 v73, v41, v201
    v_fmac_f32 v74, v42, v202
    v_fmac_f32 v75, v43, v203
    v_mfma_f32_16x16x32_bf16 v[60:63], v[188:191], v[124:127], v[60:63]
    v_cvt_pk_bf16_f32 v100, v72, v73
    v_cvt_pk_bf16_f32 v101, v74, v75
    ds_write_b64 v29, v[100:101] offset:0
    v_fmac_f32 v76, v44, v204
    v_fmac_f32 v77, v45, v205
    v_fmac_f32 v78, v46, v206
    v_fmac_f32 v79, v47, v207
    v_cvt_pk_bf16_f32 v102, v76, v77
    v_cvt_pk_bf16_f32 v103, v78, v79
    ds_write_b64 v30, v[102:103] offset:0
    ds_read_b128 v[224:227], v17 offset:0
    ds_read_b128 v[228:231], v17 offset:1024
    v_pk_fma_f32 v[80:81], v[48:49], v[208:209], v[80:81]
    v_pk_fma_f32 v[82:83], v[50:51], v[210:211], v[82:83]
    v_pk_fma_f32 v[84:85], v[52:53], v[212:213], v[84:85]
    v_pk_fma_f32 v[86:87], v[54:55], v[214:215], v[86:87]
    v_pk_fma_f32 v[88:89], v[56:57], v[216:217], v[88:89]
    v_pk_fma_f32 v[90:91], v[58:59], v[218:219], v[90:91]
    v_pk_fma_f32 v[92:93], v[60:61], v[220:221], v[92:93]
    v_pk_fma_f32 v[94:95], v[62:63], v[222:223], v[94:95]
    v_cvt_pk_bf16_f32 v104, v80, v81
    v_cvt_pk_bf16_f32 v105, v82, v83
    s_waitcnt lgkmcnt(1)
    buffer_store_dwordx4 v[224:227], v7, s[44:47], s97 offen sc1
    s_waitcnt lgkmcnt(0)
    buffer_store_dwordx4 v[228:231], v7, s[44:47], s94 offen sc1
    ds_write_b64 v8, v[104:105] offset:2048
    v_cvt_pk_bf16_f32 v106, v84, v85
    v_cvt_pk_bf16_f32 v107, v86, v87
    ds_write_b64 v28, v[106:107] offset:2048
    v_cvt_pk_bf16_f32 v108, v88, v89
    v_cvt_pk_bf16_f32 v109, v90, v91
    ds_write_b64 v29, v[108:109] offset:2048
    v_cvt_pk_bf16_f32 v110, v92, v93
    v_cvt_pk_bf16_f32 v111, v94, v95
    ds_write_b64 v30, v[110:111] offset:2048
    ds_read_b128 v[232:235], v17 offset:2048
    ds_read_b128 v[236:239], v17 offset:3072
    s_add_u32 s94, s94, 20480
    s_waitcnt lgkmcnt(1)
    buffer_store_dwordx4 v[232:235], v7, s[44:47], s94 offen sc1
    s_add_u32 s94, s94, 20480
    s_waitcnt lgkmcnt(0)
    buffer_store_dwordx4 v[236:239], v7, s[44:47], s94 offen sc1
    s_endpgm
G2_ONE:
    s_nop 7
    v_pk_fma_f32 v[64:65], v[32:33], v[192:193], v[64:65]
    v_pk_fma_f32 v[66:67], v[34:35], v[194:195], v[66:67]
    v_pk_fma_f32 v[68:69], v[36:37], v[196:197], v[68:69]
    v_pk_fma_f32 v[70:71], v[38:39], v[198:199], v[70:71]
    v_pk_fma_f32 v[72:73], v[40:41], v[200:201], v[72:73]
    v_pk_fma_f32 v[74:75], v[42:43], v[202:203], v[74:75]
    v_pk_fma_f32 v[76:77], v[44:45], v[204:205], v[76:77]
    v_pk_fma_f32 v[78:79], v[46:47], v[206:207], v[78:79]
    v_cvt_pk_bf16_f32 v96, v64, v65
    v_cvt_pk_bf16_f32 v97, v66, v67
    ds_write_b64 v8, v[96:97] offset:0
    v_cvt_pk_bf16_f32 v98, v68, v69
    v_cvt_pk_bf16_f32 v99, v70, v71
    ds_write_b64 v28, v[98:99] offset:0
    v_cvt_pk_bf16_f32 v100, v72, v73
    v_cvt_pk_bf16_f32 v101, v74, v75
    ds_write_b64 v29, v[100:101] offset:0
    v_cvt_pk_bf16_f32 v102, v76, v77
    v_cvt_pk_bf16_f32 v103, v78, v79
    ds_write_b64 v30, v[102:103] offset:0
    ds_read_b128 v[224:227], v17 offset:0
    ds_read_b128 v[228:231], v17 offset:1024
    s_waitcnt lgkmcnt(1)
    buffer_store_dwordx4 v[224:227], v7, s[44:47], s97 offen sc1
    s_waitcnt lgkmcnt(0)
    buffer_store_dwordx4 v[228:231], v7, s[44:47], s94 offen sc1
    s_endpgm
K_P1:
TC5:
    s_cbranch_execz TC6
    ds_read_b128 v[240:243], v17 offset:0
    ds_read_b128 v[248:251], v17 offset:256
    ds_read_b64 v[48:49], v8 offset:0
    ds_read_b64 v[56:57], v8 offset:2048
    v_xor_b32 v100, 32, v8
    ds_read_b64 v[50:51], v100 offset:0
    ds_read_b64 v[58:59], v100 offset:2048
    v_xor_b32 v100, 64, v8
    ds_read_b64 v[52:53], v100 offset:0
    ds_read_b64 v[60:61], v100 offset:2048
    v_xor_b32 v100, 96, v8
    ds_read_b64 v[54:55], v100 offset:0
    ds_read_b64 v[62:63], v100 offset:2048
    s_waitcnt lgkmcnt(0)
    v_mul_f32 v240, v240, v242
    v_mul_f32 v244, 0xbfb8aa3b, v242
    v_mul_f32 v246, 0xbfb8aa3b, v240
    v_lshlrev_b32 v208, 16, v48
    v_and_b32 v209, 0xffff0000, v48
    v_lshlrev_b32 v210, 16, v49
    v_and_b32 v211, 0xffff0000, v49
    v_lshlrev_b32 v212, 16, v50
    v_and_b32 v213, 0xffff0000, v50
    v_lshlrev_b32 v214, 16, v51
    v_and_b32 v215, 0xffff0000, v51
    v_pk_fma_f32 v[100:101], v[208:209], v[244:245], v[246:247] op_sel_hi:[1,0,0]
    v_pk_fma_f32 v[102:103], v[210:211], v[244:245], v[246:247] op_sel_hi:[1,0,0]
    v_pk_fma_f32 v[104:105], v[212:213], v[244:245], v[246:247] op_sel_hi:[1,0,0]
    v_pk_fma_f32 v[106:107], v[214:215], v[244:245], v[246:247] op_sel_hi:[1,0,0]
    v_pk_fma_f32 v[208:209], v[208:209], v[242:243], v[240:241] op_sel_hi:[1,0,0]
    v_pk_fma_f32 v[210:211], v[210:211], v[242:243], v[240:241] op_sel_hi:[1,0,0]
    v_pk_fma_f32 v[212:213], v[212:213], v[242:243], v[240:241] op_sel_hi:[1,0,0]
    v_pk_fma_f32 v[214:215], v[214:215], v[242:243], v[240:241] op_sel_hi:[1,0,0]
    v_exp_f32 v100, v100
    v_exp_f32 v101, v101
    v_exp_f32 v102, v102
    v_exp_f32 v103, v103
    v_exp_f32 v104, v104
    v_exp_f32 v105, v105
    v_exp_f32 v106, v106
    v_exp_f32 v107, v107
    v_pk_add_f32 v[100:101], v[100:101], 1.0 op_sel_hi:[1,0]
    v_pk_add_f32 v[102:103], v[102:103], 1.0 op_sel_hi:[1,0]
    v_pk_add_f32 v[104:105], v[104:105], 1.0 op_sel_hi:[1,0]
    v_pk_add_f32 v[106:107], v[106:107], 1.0 op_sel_hi:[1,0]
    v_rcp_f32 v100, v100
    v_rcp_f32 v101, v101
    v_rcp_f32 v102, v102
    v_rcp_f32 v103, v103
    v_rcp_f32 v104, v104
    v_rcp_f32 v105, v105
    v_rcp_f32 v106, v106
    v_rcp_f32 v107, v107
    v_pk_mul_f32 v[208:209], v[208:209], v[100:101]
    v_pk_mul_f32 v[210:211], v[210:211], v[102:103]
    v_pk_mul_f32 v[212:213], v[212:213], v[104:105]
    v_pk_mul_f32 v[214:215], v[214:215], v[106:107]
    s_setpc_b64 s[20:21]
K_P2:
    v_lshlrev_b32 v216, 16, v52
    v_and_b32 v217, 0xffff0000, v52
    v_lshlrev_b32 v218, 16, v53
    v_and_b32 v219, 0xffff0000, v53
    v_lshlrev_b32 v220, 16, v54
    v_and_b32 v221, 0xffff0000, v54
    v_lshlrev_b32 v222, 16, v55
    v_and_b32 v223, 0xffff0000, v55
    v_pk_fma_f32 v[100:101], v[216:217], v[244:245], v[246:247] op_sel_hi:[1,0,0]
    v_pk_fma_f32 v[102:103], v[218:219], v[244:245], v[246:247] op_sel_hi:[1,0,0]
    v_pk_fma_f32 v[104:105], v[220:221], v[244:245], v[246:247] op_sel_hi:[1,0,0]
    v_pk_fma_f32 v[106:107], v[222:223], v[244:245], v[246:247] op_sel_hi:[1,0,0]
    v_pk_fma_f32 v[216:217], v[216:217], v[242:243], v[240:241] op_sel_hi:[1,0,0]
    v_pk_fma_f32 v[218:219], v[218:219], v[242:243], v[240:241] op_sel_hi:[1,0,0]
    v_pk_fma_f32 v[220:221], v[220:221], v[242:243], v[240:241] op_sel_hi:[1,0,0]
    v_pk_fma_f32 v[222:223], v[222:223], v[242:243], v[240:241] op_sel_hi:[1,0,0]
    v_exp_f32 v100, v100
    v_exp_f32 v101, v101
    v_exp_f32 v102, v102
    v_exp_f32 v103, v103
    v_exp_f32 v104, v104
    v_exp_f32 v105, v105
    v_exp_f32 v106, v106
    v_exp_f32 v107, v107
    v_pk_add_f32 v[100:101], v[100:101], 1.0 op_sel_hi:[1,0]
    v_pk_add_f32 v[102:103], v[102:103], 1.0 op_sel_hi:[1,0]
    v_pk_add_f32 v[104:105], v[104:105], 1.0 op_sel_hi:[1,0]
    v_pk_add_f32 v[106:107], v[106:107], 1.0 op_sel_hi:[1,0]
    v_rcp_f32 v100, v100
    v_rcp_f32 v101, v101
    v_rcp_f32 v102, v102
    v_rcp_f32 v103, v103
    v_rcp_f32 v104, v104
    v_rcp_f32 v105, v105
    v_rcp_f32 v106, v106
    v_rcp_f32 v107, v107
    v_pk_mul_f32 v[216:217], v[216:217], v[100:101]
    v_pk_mul_f32 v[218:219], v[218:219], v[102:103]
    v_pk_mul_f32 v[220:221], v[220:221], v[104:105]
    v_pk_mul_f32 v[222:223], v[222:223], v[106:107]
    s_setpc_b64 s[20:21]
K_P3:
    s_cmp_lt_u32 s101, 2
    s_cbranch_scc1 K_P3R
    v_mul_f32 v248, v248, v250
    v_mul_f32 v252, 0xbfb8aa3b, v250
    v_mul_f32 v254, 0xbfb8aa3b, v248
    v_lshlrev_b32 v224, 16, v56
    v_and_b32 v225, 0xffff0000, v56
    v_lshlrev_b32 v226, 16, v57
    v_and_b32 v227, 0xffff0000, v57
    v_lshlrev_b32 v228, 16, v58
    v_and_b32 v229, 0xffff0000, v58
    v_lshlrev_b32 v230, 16, v59
    v_and_b32 v231, 0xffff0000, v59
    v_pk_fma_f32 v[100:101], v[224:225], v[252:253], v[254:255] op_sel_hi:[1,0,0]
    v_pk_fma_f32 v[102:103], v[226:227], v[252:253], v[254:255] op_sel_hi:[1,0,0]
    v_pk_fma_f32 v[104:105], v[228:229], v[252:253], v[254:255] op_sel_hi:[1,0,0]
    v_pk_fma_f32 v[106:107], v[230:231], v[252:253], v[254:255] op_sel_hi:[1,0,0]
    v_pk_fma_f32 v[224:225], v[224:225], v[250:251], v[248:249] op_sel_hi:[1,0,0]
    v_pk_fma_f32 v[226:227], v[226:227], v[250:251], v[248:249] op_sel_hi:[1,0,0]
    v_pk_fma_f32 v[228:229], v[228:229], v[250:251], v[248:249] op_sel_hi:[1,0,0]
    v_pk_fma_f32 v[230:231], v[230:231], v[250:251], v[248:249] op_sel_hi:[1,0,0]
    v_exp_f32 v100, v100
    v_exp_f32 v101, v101
    v_exp_f32 v102, v102
    v_exp_f32 v103, v103
    v_exp_f32 v104, v104
    v_exp_f32 v105, v105
    v_exp_f32 v106, v106
    v_exp_f32 v107, v107
    v_pk_add_f32 v[100:101], v[100:101], 1.0 op_sel_hi:[1,0]
    v_pk_add_f32 v[102:103], v[102:103], 1.0 op_sel_hi:[1,0]
    v_pk_add_f32 v[104:105], v[104:105], 1.0 op_sel_hi:[1,0]
    v_pk_add_f32 v[106:107], v[106:107], 1.0 op_sel_hi:[1,0]
    v_rcp_f32 v100, v100
    v_rcp_f32 v101, v101
    v_rcp_f32 v102, v102
    v_rcp_f32 v103, v103
    v_rcp_f32 v104, v104
    v_rcp_f32 v105, v105
    v_rcp_f32 v106, v106
    v_rcp_f32 v107, v107
    v_pk_mul_f32 v[224:225], v[224:225], v[100:101]
    v_pk_mul_f32 v[226:227], v[226:227], v[102:103]
    v_pk_mul_f32 v[228:229], v[228:229], v[104:105]
    v_pk_mul_f32 v[230:231], v[230:231], v[106:107]
    v_lshlrev_b32 v232, 16, v60
    v_and_b32 v233, 0xffff0000, v60
    v_lshlrev_b32 v234, 16, v61
    v_and_b32 v235, 0xffff0000, v61
    v_lshlrev_b32 v236, 16, v62
    v_and_b32 v237, 0xffff0000, v62
    v_lshlrev_b32 v238, 16, v63
    v_and_b32 v239, 0xffff0000, v63
    v_pk_fma_f32 v[100:101], v[232:233], v[252:253], v[254:255] op_sel_hi:[1,0,0]
    v_pk_fma_f32 v[102:103], v[234:235], v[252:253], v[254:255] op_sel_hi:[1,0,0]
    v_pk_fma_f32 v[104:105], v[236:237], v[252:253], v[254:255] op_sel_hi:[1,0,0]
    v_pk_fma_f32 v[106:107], v[238:239], v[252:253], v[254:255] op_sel_hi:[1,0,0]
    v_pk_fma_f32 v[232:233], v[232:233], v[250:251], v[248:249] op_sel_hi:[1,0,0]
    v_pk_fma_f32 v[234:235], v[234:235], v[250:251], v[248:249] op_sel_hi:[1,0,0]
    v_pk_fma_f32 v[236:237], v[236:237], v[250:251], v[248:249] op_sel_hi:[1,0,0]
    v_pk_fma_f32 v[238:239], v[238:239], v[250:251], v[248:249] op_sel_hi:[1,0,0]
    v_exp_f32 v100, v100
    v_exp_f32 v101, v101
    v_exp_f32 v102, v102
    v_exp_f32 v103, v103
    v_exp_f32 v104, v104
    v_exp_f32 v105, v105
    v_exp_f32 v106, v106
    v_exp_f32 v107, v107
    v_pk_add_f32 v[100:101], v[100:101], 1.0 op_sel_hi:[1,0]
    v_pk_add_f32 v[102:103], v[102:103], 1.0 op_sel_hi:[1,0]
    v_pk_add_f32 v[104:105], v[104:105], 1.0 op_sel_hi:[1,0]
    v_pk_add_f32 v[106:107], v[106:107], 1.0 op_sel_hi:[1,0]
    v_rcp_f32 v100, v100
    v_rcp_f32 v101, v101
    v_rcp_f32 v102, v102
    v_rcp_f32 v103, v103
    v_rcp_f32 v104, v104
    v_rcp_f32 v105, v105
    v_rcp_f32 v106, v106
    v_rcp_f32 v107, v107
    v_pk_mul_f32 v[232:233], v[232:233], v[100:101]
    v_pk_mul_f32 v[234:235], v[234:235], v[102:103]
    v_pk_mul_f32 v[236:237], v[236:237], v[104:105]
    v_pk_mul_f32 v[238:239], v[238:239], v[106:107]
K_P3R:
    s_setpc_b64 s[20:21]
P_TAIL:
TC6:
    s_cbranch_execz TC7
    s_setprio 0
    v_mov_b32 v2, 1
    ds_write_b8 v18, v2 offset:0
    s_cmp_eq_u32 s13, 1
    s_cbranch_scc1 P_ST
    s_call_b64 s[20:21], K_P1
    s_call_b64 s[20:21], K_P2
    s_call_b64 s[20:21], K_P3
P_ST:
    ds_read_b64 v[22:23], v19 offset:40
    s_lshl_b32 s60, s8, 12
    s_add_u32 s60, s60, 81920
    v_add_u32 v20, s60, v6
    s_lshl_b32 s62, s101, 4
    s_mov_b32 s100, 0
    s_waitcnt lgkmcnt(0)
    v_readfirstlane_b32 s90, v22
    v_readfirstlane_b32 s91, v23
    s_lshl_b32 s67, s58, 2
    s_add_u32 s67, s67, 131072
    s_mov_b32 s68, 2
FIX_L:
    v_mov_b32 v45, v49
    v_mov_b32 v46, v50
    v_mov_b32 v47, v51
    v_mov_b32 v49, 114688
    s_not_b32 s60, s90
    s_bfe_u32 s61, s60, 655361
    s_and_b32 s60, s60, 1
    s_lshl_b32 s60, s60, 10
    s_add_u32 s60, s60, s61
    s_sub_u32 s63, s60, s95
    s_cmp_lt_u32 s63, s62
    s_cbranch_scc1 FIX_RUN
FIX_N:
    s_mov_b32 s90, s91
    s_add_u32 s67, s67, 138240
    s_sub_u32 s68, s68, 1
    s_cmp_lg_u32 s68, 0
    s_cbranch_scc1 FIX_L
    s_setprio 0
    s_mov_b32 s100, 0
    ds_read_b64 v[2:3], v19 offset:0
P_Z:
    s_waitcnt lgkmcnt(0)
    v_and_b32 v2, v2, v3
    v_cmp_ne_u32 vcc, 0x01010101, v2
    s_cbranch_vccnz P_ZR
P_ZOK:
    ds_write_b128 v20, v[208:211] offset:0
    ds_write_b128 v20, v[212:215] offset:1024
    ds_write_b128 v20, v[216:219] offset:2048
    ds_write_b128 v20, v[220:223] offset:3072
    ds_write_b128 v20, v[224:227] offset:4096
    ds_write_b128 v20, v[228:231] offset:5120
    ds_write_b128 v20, v[232:235] offset:6144
    ds_write_b128 v20, v[236:239] offset:7168
    s_mov_b32 exec_hi, 0
    ds_write_b64 v49, v[50:51]
    ds_write_b64 v45, v[46:47]
    v_mov_b32 v2, 1
    ds_write_b8 v18, v2 offset:8
    s_endpgm
FIX_RUN:
    s_setprio 3
    v_lshrrev_b32 v48, 5, v1
    v_mul_u32_u24 v48, 4608, v48
    v_add_u32 v48, v48, v6
    v_mov_b32 v116, 0
    v_mov_b32 v117, s52
    v_mov_b32 v118, 0
    v_mov_b32 v119, s52
    s_add_u32 s60, s67, 0
    buffer_load_dwordx4 v[64:67], v48, s[28:31], s60 offen sc1
    s_add_u32 s60, s67, 10240
    buffer_load_dwordx4 v[68:71], v48, s[28:31], s60 offen sc1
    s_add_u32 s60, s67, 20480
    buffer_load_dwordx4 v[72:75], v48, s[28:31], s60 offen sc1
    s_add_u32 s60, s67, 30720
    buffer_load_dwordx4 v[76:79], v48, s[28:31], s60 offen sc1
    s_add_u32 s60, s67, 40960
    buffer_load_dwordx4 v[80:83], v48, s[28:31], s60 offen sc1
    s_add_u32 s60, s67, 51200
    buffer_load_dwordx4 v[84:87], v48, s[28:31], s60 offen sc1
    s_add_u32 s60, s67, 61440
    buffer_load_dwordx4 v[88:91], v48, s[28:31], s60 offen sc1
    s_add_u32 s60, s67, 71680
    buffer_load_dwordx4 v[92:95], v48, s[28:31], s60 offen sc1
    s_add_u32 s60, s67, 81920
    buffer_load_dwordx4 v[96:99], v48, s[28:31], s60 offen sc1
    s_add_u32 s60, s67, 92160
    buffer_load_dwordx4 v[100:103], v48, s[28:31], s60 offen sc1
    s_add_u32 s60, s67, 102400
    buffer_load_dwordx4 v[104:107], v48, s[28:31], s60 offen sc1
    s_add_u32 s60, s67, 112640
    buffer_load_dwordx4 v[108:111], v48, s[28:31], s60 offen sc1
    s_add_u32 s60, s67, 122880
    buffer_load_dwordx4 v[112:115], v48, s[28:31], s60 offen sc1
    s_add_u32 s60, s67, 133120
    s_mov_b32 exec_hi, 0
    buffer_load_dwordx4 v[116:119], v48, s[28:31], s60 offen sc1
    s_mov_b32 exec_hi, -1
    s_lshl4_add_u32 s64, s8, s63
    s_lshl_b32 s60, s64, 4
    s_add_u32 s60, s60, 161536
    v_mov_b32 v2, s60
    ds_read_b96 v[52:54], v2
    v_bfe_u32 v2, v1, 2, 3
    s_and_b32 s60, s64, 7
    v_xor_b32 v2, s60, v2
    v_and_b32 v3, 3, v1
    v_lshl_add_u32 v2, v2, 2, v3
    s_lshl_b32 s60, s64, 7
    s_add_u32 s60, s60, 147200
    v_lshl_add_u32 v2, v2, 2, s60
    ds_read_b32 v50, v2
    s_ashr_i32 s60, s90, 31
    s_orn2_b32 s60, 0x80000000, s60
    s_xor_b32 s60, s60, s90
    s_and_b32 s60, s60, s55
    v_mov_b32 v55, 0xbfb8aa3b
    v_mul_f32 v55, s60, v55
    v_exp_f32 v55, v55
    s_nop 0
    v_add_f32 v55, 1.0, v55
    v_rcp_f32 v55, v55
    s_nop 0
    v_cvt_pk_bf16_f32 v55, v55, v55
    v_lshlrev_b32 v55, 16, v55
    s_lshr_b32 s60, s64, 4
    s_lshl_b32 s60, s60, 12
    s_and_b32 s61, s64, 15
    s_lshl4_add_u32 s60, s61, s60
    s_add_u32 s60, s60, 81920
    v_lshrrev_b32 v49, 1, v1
    v_lshl_add_u32 v49, v49, 8, s60
    v_and_b32 v3, 1, v1
    v_lshl_add_u32 v49, v3, 3, v49
    s_waitcnt lgkmcnt(0)
    v_and_b32 v51, 0xffff0000, v50
    v_lshlrev_b32 v50, 16, v50
    v_add_f32 v50, v50, v52
    v_add_f32 v51, v51, v52
    v_cvt_pk_bf16_f32 v3, v50, v51
    v_lshlrev_b32 v50, 16, v3
    v_and_b32 v51, s55, v3
    v_mul_f32 v50, v50, v54
    v_mul_f32 v51, v51, v54
    v_cvt_pk_bf16_f32 v3, v50, v51
    v_lshlrev_b32 v50, 16, v3
    v_and_b32 v51, s55, v3
    s_waitcnt vmcnt(0)
FIX_Y_CHK:
    v_xor_b32 v2, s52, v65
    v_bitop3_b32 v2, v67, s52, v2 bitop3:0xbe
    v_bitop3_b32 v2, v69, s52, v2 bitop3:0xbe
    v_bitop3_b32 v2, v71, s52, v2 bitop3:0xbe
    v_bitop3_b32 v2, v73, s52, v2 bitop3:0xbe
    v_bitop3_b32 v2, v75, s52, v2 bitop3:0xbe
    v_bitop3_b32 v2, v77, s52, v2 bitop3:0xbe
    v_bitop3_b32 v2, v79, s52, v2 bitop3:0xbe
    v_bitop3_b32 v2, v81, s52, v2 bitop3:0xbe
    v_bitop3_b32 v2, v83, s52, v2 bitop3:0xbe
    v_bitop3_b32 v2, v85, s52, v2 bitop3:0xbe
    v_bitop3_b32 v2, v87, s52, v2 bitop3:0xbe
    v_bitop3_b32 v2, v89, s52, v2 bitop3:0xbe
    v_bitop3_b32 v2, v91, s52, v2 bitop3:0xbe
    v_bitop3_b32 v2, v93, s52, v2 bitop3:0xbe
    v_bitop3_b32 v2, v95, s52, v2 bitop3:0xbe
    v_bitop3_b32 v2, v97, s52, v2 bitop3:0xbe
    v_bitop3_b32 v2, v99, s52, v2 bitop3:0xbe
    v_bitop3_b32 v2, v101, s52, v2 bitop3:0xbe
    v_bitop3_b32 v2, v103, s52, v2 bitop3:0xbe
    v_bitop3_b32 v2, v105, s52, v2 bitop3:0xbe
    v_bitop3_b32 v2, v107, s52, v2 bitop3:0xbe
    v_bitop3_b32 v2, v109, s52, v2 bitop3:0xbe
    v_bitop3_b32 v2, v111, s52, v2 bitop3:0xbe
    v_bitop3_b32 v2, v113, s52, v2 bitop3:0xbe
    v_bitop3_b32 v2, v115, s52, v2 bitop3:0xbe
    v_bitop3_b32 v2, v117, s52, v2 bitop3:0xbe
    v_bitop3_b32 v2, v119, s52, v2 bitop3:0xbe
    v_cmp_ne_u32 vcc, 0, v2
    s_cbranch_vccz FIX_Y_OK
FIX_Y_RETRY:
    s_add_u32 s100, s100, 1
    s_cmp_gt_u32 s100, 20000
    s_cbranch_scc1 FIX_Y_OK
    s_sleep 8
    s_add_u32 s60, s67, 0
    buffer_load_dwordx4 v[64:67], v48, s[28:31], s60 offen sc1
    s_add_u32 s60, s67, 10240
    buffer_load_dwordx4 v[68:71], v48, s[28:31], s60 offen sc1
    s_add_u32 s60, s67, 20480
    buffer_load_dwordx4 v[72:75], v48, s[28:31], s60 offen sc1
    s_add_u32 s60, s67, 30720
    buffer_load_dwordx4 v[76:79], v48, s[28:31], s60 offen sc1
    s_add_u32 s60, s67, 40960
    buffer_load_dwordx4 v[80:83], v48, s[28:31], s60 offen sc1
    s_add_u32 s60, s67, 51200
    buffer_load_dwordx4 v[84:87], v48, s[28:31], s60 offen sc1
    s_add_u32 s60, s67, 61440
    buffer_load_dwordx4 v[88:91], v48, s[28:31], s60 offen sc1
    s_add_u32 s60, s67, 71680
    buffer_load_dwordx4 v[92:95], v48, s[28:31], s60 offen sc1
    s_add_u32 s60, s67, 81920
    buffer_load_dwordx4 v[96:99], v48, s[28:31], s60 offen sc1
    s_add_u32 s60, s67, 92160
    buffer_load_dwordx4 v[100:103], v48, s[28:31], s60 offen sc1
    s_add_u32 s60, s67, 102400
    buffer_load_dwordx4 v[104:107], v48, s[28:31], s60 offen sc1
    s_add_u32 s60, s67, 112640
    buffer_load_dwordx4 v[108:111], v48, s[28:31], s60 offen sc1
    s_add_u32 s60, s67, 122880
    buffer_load_dwordx4 v[112:115], v48, s[28:31], s60 offen sc1
    s_add_u32 s60, s67, 133120
    s_mov_b32 exec_hi, 0
    buffer_load_dwordx4 v[116:119], v48, s[28:31], s60 offen sc1
    s_mov_b32 exec_hi, -1
    s_waitcnt vmcnt(0)
    s_branch FIX_Y_CHK
FIX_Y_OK:
    v_add_f32 v64, v64, v68
    v_add_f32 v66, v66, v70
    v_add_f32 v64, v64, v72
    v_add_f32 v66, v66, v74
    v_add_f32 v64, v64, v76
    v_add_f32 v66, v66, v78
    v_add_f32 v64, v64, v80
    v_add_f32 v66, v66, v82
    v_add_f32 v64, v64, v84
    v_add_f32 v66, v66, v86
    v_add_f32 v64, v64, v88
    v_add_f32 v66, v66, v90
    v_add_f32 v64, v64, v92
    v_add_f32 v66, v66, v94
    v_add_f32 v64, v64, v96
    v_add_f32 v66, v66, v98
    v_add_f32 v64, v64, v100
    v_add_f32 v66, v66, v102
    v_add_f32 v64, v64, v104
    v_add_f32 v66, v66, v106
    v_add_f32 v64, v64, v108
    v_add_f32 v66, v66, v110
    v_add_f32 v64, v64, v112
    v_add_f32 v66, v66, v114
    v_add_f32 v64, v64, v116
    v_add_f32 v66, v66, v118
    v_mov_b32 v65, v66
    v_mov_b32 v66, v64
    v_mov_b32 v67, v65
    s_nop 0
    v_permlane32_swap_b32 v64, v66
    v_permlane32_swap_b32 v65, v67
    v_add_f32 v64, v64, v66
    v_add_f32 v65, v65, v67
    v_cvt_pk_bf16_f32 v3, v64, v65
    v_lshlrev_b32 v64, 16, v3
    v_and_b32 v65, s55, v3
    v_mul_f32 v64, v64, v55
    v_mul_f32 v65, v65, v55
    v_cvt_pk_bf16_f32 v3, v64, v65
    v_lshlrev_b32 v64, 16, v3
    v_and_b32 v65, s55, v3
    v_add_f32 v50, v50, v64
    v_add_f32 v51, v51, v65
    v_cvt_pk_bf16_f32 v3, v50, v51
    v_lshlrev_b32 v50, 16, v3
    v_and_b32 v51, s55, v3
    v_mul_f32 v64, 0xbfb8aa3b, v50
    v_mul_f32 v65, 0xbfb8aa3b, v51
    v_exp_f32 v64, v64
    v_exp_f32 v65, v65
    v_add_f32 v64, 1.0, v64
    v_add_f32 v65, 1.0, v65
    v_rcp_f32 v64, v64
    v_rcp_f32 v65, v65
    v_mul_f32 v50, v50, v64
    v_mul_f32 v51, v51, v65
    s_branch FIX_N
L_CONT:
    s_mul_i32 s60, s3, 5
    s_lshl_b32 s61, s53, 6
    s_add_u32 s60, s60, s61
    s_add_u32 s60, s60, K_TAB-K_PC
    s_load_dwordx16 s[4:19], s[20:21], s60
    s_load_dwordx2 s[44:45], s[0:1], 64
    s_load_dwordx2 s[40:41], s[0:1], 16
    s_mov_b32 s46, 2621440
    s_mov_b32 s47, 0x20000
    s_mov_b32 s30, 7077888
    s_mov_b32 s31, 0x20000
    s_mov_b32 s42, 819200
    s_mov_b32 s43, 0x20000
    s_lshr_b32 s3, s3, 6
    s_and_b32 s59, s3, 3
    s_mov_b32 s55, 0xffff0000
    s_mov_b32 s100, 0
    v_and_b32 v1, 63, v0
    v_and_b32 v4, 15, v1
    v_lshrrev_b32 v5, 4, v1
    v_mov_b32 v19, 163584
    v_add_u32 v18, s3, v19
    v_lshlrev_b32 v6, 4, v1
    v_mov_b32 v28, 0x3f803f80
    v_mov_b32 v29, 0x3f803f80
    v_mov_b32 v30, 0x3f803f80
    v_mov_b32 v31, 0x3f803f80
    v_lshlrev_b32 v2, 2, v5
    v_sub_u32 v3, v4, v2
    v_add_u32 v3, 12, v3
    s_mov_b32 s60, 267390975
    v_bfe_i32 v32, s60, v3, 1
    v_and_b32 v32, 0xff800000, v32
    s_mov_b32 s60, 268435440
    v_bfe_i32 v36, s60, v3, 1
    v_and_b32 v36, 0xff800000, v36
    s_mov_b32 s60, 266346495
    v_bfe_i32 v33, s60, v3, 1
    v_and_b32 v33, 0xff800000, v33
    s_mov_b32 s60, 268435424
    v_bfe_i32 v37, s60, v3, 1
    v_and_b32 v37, 0xff800000, v37
    s_mov_b32 s60, 264257535
    v_bfe_i32 v34, s60, v3, 1
    v_and_b32 v34, 0xff800000, v34
    s_mov_b32 s60, 268435392
    v_bfe_i32 v38, s60, v3, 1
    v_and_b32 v38, 0xff800000, v38
    s_mov_b32 s60, 260079615
    v_bfe_i32 v35, s60, v3, 1
    v_and_b32 v35, 0xff800000, v35
    s_mov_b32 s60, 268435328
    v_bfe_i32 v39, s60, v3, 1
    v_and_b32 v39, 0xff800000, v39
    v_sub_u32 v2, 13, v3
    v_med3_i32 v2, v2, 0, 2
    v_lshlrev_b32 v2, 3, v2
    v_mov_b32 v40, -1
    v_lshrrev_b32 v40, v2, v40
    v_lshrrev_b32 v40, v2, v40
    v_sub_u32 v2, 15, v3
    v_med3_i32 v2, v2, 0, 2
    v_lshlrev_b32 v2, 3, v2
    v_mov_b32 v41, -1
    v_lshrrev_b32 v41, v2, v41
    v_lshrrev_b32 v41, v2, v41
    s_ashr_i32 s60, s56, 31
    s_and_b32 s60, s60, 0xff800000
    v_lshrrev_b32 v2, 3, v1
    v_bfe_i32 v2, 10, v2, 1
    v_and_b32 v2, s60, v2
    v_or_b32 v42, v32, v2
    v_or_b32 v43, v33, v2
    v_or_b32 v44, v34, v2
    v_or_b32 v45, v35, v2
    v_mul_u32_u24 v25, 20224, v5
    v_add_u32 v25, v25, v6
    v_lshrrev_b32 v24, 5, v1
    v_mul_u32_u24 v24, 19968, v24
    v_add_u32 v24, v24, v6
    v_lshlrev_b32 v26, 4, v4
    v_add_u32 v26, 161544, v26
    v_bfe_u32 v2, v1, 2, 2
    v_lshlrev_b32 v2, 7, v2
    v_and_b32 v3, 8, v1
    v_lshl_add_u32 v2, v3, 2, v2
    v_and_b32 v3, 3, v1
    v_lshl_add_u32 v2, v3, 3, v2
    v_and_b32 v3, 48, v1
    s_mov_b32 s62, 0xffff
    s_mov_b32 s60, 201329216
    s_mov_b32 s61, 373298176
    v_lshrrev_b64 v[46:47], v3, s[60:61]
    v_and_or_b32 v9, v46, s62, v2
    s_mov_b32 s60, 37748736
    s_mov_b32 s61, 2550175296
    v_lshrrev_b64 v[46:47], v3, s[60:61]
    v_and_or_b32 v10, v46, s62, v2
    s_mov_b32 s60, 469766720
    s_mov_b32 s61, 977285120
    v_lshrrev_b64 v[46:47], v3, s[60:61]
    v_and_or_b32 v11, v46, s62, v2
    s_mov_b32 s60, 2483063360
    s_mov_b32 s61, 2654996480
    v_lshrrev_b64 v[46:47], v3, s[60:61]
    v_and_or_b32 v12, v46, s62, v2
    s_mov_b32 s60, 574627840
    s_mov_b32 s61, 2051045376
    v_lshrrev_b64 v[46:47], v3, s[60:61]
    v_and_or_b32 v13, v46, s62, v2
    s_mov_b32 s60, 1073757184
    s_mov_b32 s61, 1610635840
    v_lshrrev_b64 v[46:47], v3, s[60:61]
    v_and_or_b32 v14, v46, s62, v2
    s_mov_b32 s60, 1140858432
    s_mov_b32 s61, 2147507776
    v_lshrrev_b64 v[46:47], v3, s[60:61]
    v_and_or_b32 v15, v46, s62, v2
    v_lshrrev_b32 v2, 3, v1
    v_bitop3_b32 v3, v1, v2, 7 bitop3:0x28
    v_mul_u32_u24 v7, 2560, v2
    v_lshl_add_u32 v7, v3, 4, v7
    v_lshrrev_b32 v2, 5, v1
    v_bitop3_b32 v2, v2, v4, 7 bitop3:0x28
    v_lshlrev_b32 v8, 7, v4
    v_lshl_add_u32 v8, v2, 4, v8
    v_and_b32 v2, 1, v5
    v_lshl_add_u32 v8, v2, 3, v8
    v_bfe_u32 v2, v0, 3, 5
    v_and_b32 v3, 6, v2
    v_bitop3_b32 v3, v0, v3, 7 bitop3:0x28
    v_mul_u32_u24 v16, 1280, v2
    v_lshl_add_u32 v16, v3, 4, v16
    s_lshl_b32 s98, s56, 4
    s_mul_i32 s60, s57, 13
    s_add_u32 s98, s98, s60
    s_add_u32 s98, s98, 458880
    s_add_u32 s96, s56, 8
    s_mulk_i32 s96, 1408
    s_mul_i32 s60, s57, 1144
    s_add_u32 s96, s96, s60
    s_add_u32 s96, s96, 1048576
    s_and_b32 s62, s2, 1
    s_mulk_i32 s62, 10240
    s_add_u32 s62, s62, s96
    s_sub_u32 s63, s54, s53
    s_and_b32 s60, s2, 7
    s_mul_i32 s60, s60, 25
    s_add_u32 s63, s63, s60
    s_mulk_i32 s63, 11520
    s_add_u32 s63, s63, 4194304
    v_mul_u32_u24 v2, 272, v4
    v_add_u32 v2, 112384, v2
    v_lshlrev_b32 v3, 3, v5
    s_waitcnt lgkmcnt(0)
    v_bfe_u32 v20, s4, v3, 8
    v_bfe_u32 v21, s5, v3, 8
    v_add_u32 v20, v20, v2
    v_add_u32 v21, v21, v2
    v_lshrrev_b32 v2, 2, v1
    v_mul_u32_u24 v2, 136, v2
    v_add_u32 v2, 79744, v2
    v_add_u32 v23, s7, v2
    v_lshlrev_b32 v3, 3, v1
    v_bfe_u32 v22, s6, v3, 8
    v_add_u32 v22, v22, v2
    s_add_u32 s9, s9, s62
    s_add_u32 s10, s10, s62
    s_add_u32 s11, s11, s63
    s_add_u32 s12, s12, s63
    s_add_u32 s5, s9, 40960
    s_mul_i32 s60, s8, 20480
    s_add_u32 s96, s96, s60
    s_lshl4_add_u32 s95, s8, s56
    s_cmp_eq_u32 s8, 6
    s_cselect_b32 s101, 1, 2
    s_cmpk_ge_i32 s95, 1024
    s_cselect_b32 s101, 0, s101
    s_mul_i32 s97, s95, 2560
    s_add_u32 s97, s97, s57
    s_add_u32 s97, s97, s58
    s_add_u32 s94, s97, 20480
    s_cmp_eq_u32 s8, 0
    s_cselect_b32 s97, 2146435072, s97
    s_cselect_b32 s61, 2146435072, 0
    s_and_b32 s60, s53, 2
    s_mul_i32 s22, s60, 204800
    s_sub_u32 s23, 409600, s22
    s_add_u32 s22, s22, s58
    s_add_u32 s23, s23, s58
    s_mulk_i32 s60, 5120
    s_sub_u32 s4, s96, s60
    s_add_u32 s4, s4, 10240
    s_add_u32 s96, s96, s60
    s_add_u32 s92, s96, 4096
    s_add_u32 s93, s92, 4096
    s_add_u32 s6, s4, 4096
    s_add_u32 s7, s6, 4096
    v_bfe_i32 v2, v1, 3, 1
    v_bfi_b32 v2, v2, 0, s61
    v_or_b32 v27, v2, v6
    s_and_b32 s60, s2, 4
    s_lshl_b32 s60, s60, 8
    s_add_u32 s95, s95, s60
    s_lshl_b32 s60, s8, 11
    s_add_u32 s60, s60, 147200
    v_add_u32 v8, s60, v8
    s_lshl_b32 s60, s8, 8
    s_add_u32 s60, s60, 161536
    v_lshl_add_u32 v17, v4, 4, s60
    s_mul_i32 s60, s59, 28
    v_min_u32 v2, 27, v1
    v_add_u32 v2, s60, v2
    v_lshlrev_b32 v82, 4, v2
    v_add_u32 v82, 161536, v82
    v_add_u32 v2, s56, v2
    v_max_i32 v2, 0, v2
    v_min_u32 v2, 1023, v2
    s_and_b32 s60, s2, 4
    s_lshl_b32 s60, s60, 12
    s_add_u32 s60, s60, 16384
    v_lshl_add_u32 v81, v2, 4, s60
    s_lshr_b32 s60, s58, 7
    s_movk_i32 s99, 0x3ff
    s_bitset0_b32 s99, s60
    v_lshlrev_b32 v108, 7, v1
    s_mul_i32 s71, s54, 52
    s_lshr_b32 s71, s71, 8
    s_lshl_b32 s71, s71, 13
L_GAP:
    s_lshr_b32 s64, 4099, s67
    s_and_b32 s64, s64, 15
    s_add_u32 s64, s64, s68
    s_cmp_ge_u32 s64, 10
    s_cselect_b32 s65, 10, 0
    s_sub_u32 s64, s64, s65
    s_mul_i32 s65, s64, 245760
    s_lshl_b32 s64, s64, 7
    s_add_u32 s64, s64, s57
    s_add_u32 m0, s69, 0
    s_mov_b32 exec_lo, s70
    buffer_load_dwordx4 v196, s[24:27], s64 offen lds
    s_add_u32 m0, s69, 4096
    s_mov_b32 exec_lo, -1
    buffer_load_dwordx4 v197, s[24:27], s64 offen lds
    s_add_u32 m0, s69, 8192
    s_add_u32 s65, s65, s58
    buffer_load_dwordx4 v198, s[24:27], s64 offen lds
    s_cbranch_vccz L_SK1
    s_add_u32 m0, s69, 12288
    s_nop 0
    buffer_load_dwordx4 v199, s[24:27], s64 offen lds
L_SK1:
    s_add_u32 m0, s69, 14336
    s_add_u32 s66, s65, 122880
    buffer_load_dwordx4 v200, s[32:35], s65 offen offset:0 lds
    s_add_u32 m0, s69, 21248
    s_nop 0
    buffer_load_dwordx4 v200, s[32:35], s65 offen offset:1280 lds
    s_add_u32 m0, s69, 28160
    s_nop 0
    buffer_load_dwordx4 v200, s[32:35], s65 offen offset:2560 lds
    s_add_u32 m0, s69, 18432
    s_nop 0
    buffer_load_dwordx4 v200, s[32:35], s66 offen offset:0 lds
    s_add_u32 m0, s69, 25344
    s_nop 0
    buffer_load_dwordx4 v200, s[32:35], s66 offen offset:1280 lds
    s_add_u32 m0, s69, 32256
    s_nop 0
    buffer_load_dwordx4 v200, s[32:35], s66 offen offset:2560 lds
    s_waitcnt vmcnt(10)
    s_cbranch_vccnz L_W0b
    s_waitcnt vmcnt(9)
L_W0b:
    s_barrier
    s_lshr_b32 s64, 139585, s67
    s_and_b32 s64, s64, 15
    s_add_u32 s64, s64, s68
    s_cmp_ge_u32 s64, 10
    s_cselect_b32 s65, 10, 0
    s_sub_u32 s64, s64, s65
    s_mul_i32 s65, s64, 245760
    s_lshl_b32 s64, s64, 7
    s_add_u32 s64, s64, s57
    s_add_u32 m0, s69, 38912
    s_mov_b32 exec_lo, s70
    buffer_load_dwordx4 v196, s[24:27], s64 offen lds
    s_add_u32 m0, s69, 43008
    s_mov_b32 exec_lo, -1
    buffer_load_dwordx4 v197, s[24:27], s64 offen lds
    s_add_u32 m0, s69, 47104
    s_add_u32 s65, s65, s58
    buffer_load_dwordx4 v198, s[24:27], s64 offen lds
    s_cbranch_vccz L_SK2
    s_add_u32 m0, s69, 51200
    s_nop 0
    buffer_load_dwordx4 v199, s[24:27], s64 offen lds
L_SK2:
    s_add_u32 m0, s69, 53248
    s_add_u32 s66, s65, 122880
    buffer_load_dwordx4 v200, s[32:35], s65 offen offset:0 lds
    s_add_u32 m0, s69, 60160
    s_nop 0
    buffer_load_dwordx4 v200, s[32:35], s65 offen offset:1280 lds
    s_add_u32 m0, s69, 67072
    s_nop 0
    buffer_load_dwordx4 v200, s[32:35], s65 offen offset:2560 lds
    s_add_u32 m0, s69, 57344
    s_nop 0
    buffer_load_dwordx4 v200, s[32:35], s66 offen offset:0 lds
    s_add_u32 m0, s69, 64256
    s_nop 0
    buffer_load_dwordx4 v200, s[32:35], s66 offen offset:1280 lds
    s_add_u32 m0, s69, 71168
    s_nop 0
    buffer_load_dwordx4 v200, s[32:35], s66 offen offset:2560 lds
    s_waitcnt vmcnt(9)
    s_barrier
    s_lshr_b32 s64, 217890, s67
    s_and_b32 s64, s64, 15
    s_add_u32 s64, s64, s68
    s_cmp_ge_u32 s64, 10
    s_cselect_b32 s65, 10, 0
    s_sub_u32 s64, s64, s65
    s_mul_i32 s65, s64, 245760
    s_lshl_b32 s64, s64, 7
    s_add_u32 s64, s64, s57
    s_add_u32 m0, s69, 77824
    s_mov_b32 exec_lo, s70
    buffer_load_dwordx4 v196, s[24:27], s64 offen lds
    s_add_u32 m0, s69, 81920
    s_mov_b32 exec_lo, -1
    buffer_load_dwordx4 v197, s[24:27], s64 offen lds
    s_add_u32 m0, s69, 86016
    s_add_u32 s65, s65, s58
    buffer_load_dwordx4 v198, s[24:27], s64 offen lds
    s_cbranch_vccz L_SK3
    s_add_u32 m0, s69, 90112
    s_nop 0
    buffer_load_dwordx4 v199, s[24:27], s64 offen lds
L_SK3:
    s_add_u32 m0, s69, 92160
    s_add_u32 s66, s65, 122880
    buffer_load_dwordx4 v200, s[32:35], s65 offen offset:0 lds
    s_add_u32 m0, s69, 99072
    s_nop 0
    buffer_load_dwordx4 v200, s[32:35], s65 offen offset:1280 lds
    s_add_u32 m0, s69, 105984
    s_nop 0
    buffer_load_dwordx4 v200, s[32:35], s65 offen offset:2560 lds
    s_add_u32 m0, s69, 96256
    s_nop 0
    buffer_load_dwordx4 v200, s[32:35], s66 offen offset:0 lds
    s_add_u32 m0, s69, 103168
    s_nop 0
    buffer_load_dwordx4 v200, s[32:35], s66 offen offset:1280 lds
    s_add_u32 m0, s69, 110080
    s_nop 0
    buffer_load_dwordx4 v200, s[32:35], s66 offen offset:2560 lds
    s_waitcnt vmcnt(9)
    s_barrier
    s_lshr_b32 s64, 406580, s67
    s_and_b32 s64, s64, 15
    s_add_u32 s64, s64, s68
    s_cmp_ge_u32 s64, 10
    s_cselect_b32 s65, 10, 0
    s_sub_u32 s64, s64, s65
    s_mul_i32 s65, s64, 245760
    s_lshl_b32 s64, s64, 7
    s_add_u32 s64, s64, s57
    s_add_u32 m0, s69, 0
    s_mov_b32 exec_lo, s70
    buffer_load_dwordx4 v196, s[24:27], s64 offen lds
    s_add_u32 m0, s69, 4096
    s_mov_b32 exec_lo, -1
    buffer_load_dwordx4 v197, s[24:27], s64 offen lds
    s_add_u32 m0, s69, 8192
    s_add_u32 s65, s65, s58
    buffer_load_dwordx4 v198, s[24:27], s64 offen lds
    s_cbranch_vccz L_SK4
    s_add_u32 m0, s69, 12288
    s_nop 0
    buffer_load_dwordx4 v199, s[24:27], s64 offen lds
L_SK4:
    s_add_u32 m0, s69, 14336
    s_add_u32 s66, s65, 122880
    buffer_load_dwordx4 v200, s[32:35], s65 offen offset:0 lds
    ds_read_b32 v109, v19 offset:32
    s_add_u32 m0, s69, 21248
    s_nop 0
    buffer_load_dwordx4 v200, s[32:35], s65 offen offset:1280 lds
    s_add_u32 m0, s69, 28160
    s_nop 0
    buffer_load_dwordx4 v200, s[32:35], s65 offen offset:2560 lds
    s_add_u32 m0, s69, 18432
    s_nop 0
    buffer_load_dwordx4 v200, s[32:35], s66 offen offset:0 lds
    s_add_u32 m0, s69, 25344
    s_nop 0
    buffer_load_dwordx4 v200, s[32:35], s66 offen offset:1280 lds
    s_add_u32 m0, s69, 32256
    s_nop 0
    buffer_load_dwordx4 v200, s[32:35], s66 offen offset:2560 lds
    s_add_u32 m0, s69, 147200
    s_add_u32 s64, s58, s57
    buffer_load_dwordx4 v196, s[24:27], s64 offen lds
    s_waitcnt vmcnt(10)
    s_barrier
    s_lshr_b32 s64, 280405, s67
    s_and_b32 s64, s64, 15
    s_add_u32 s64, s64, s68
    s_cmp_ge_u32 s64, 10
    s_cselect_b32 s65, 10, 0
    s_sub_u32 s64, s64, s65
    s_mul_i32 s65, s64, 245760
    s_lshl_b32 s64, s64, 7
    s_add_u32 s64, s64, s57
    s_add_u32 m0, s69, 38912
    s_mov_b32 exec_lo, s70
    buffer_load_dwordx4 v196, s[24:27], s64 offen lds
    s_add_u32 m0, s69, 43008
    s_mov_b32 exec_lo, -1
    buffer_load_dwordx4 v197, s[24:27], s64 offen lds
    s_add_u32 m0, s69, 47104
    s_add_u32 s65, s65, s58
    buffer_load_dwordx4 v198, s[24:27], s64 offen lds
    s_cbranch_vccz L_SK5
    s_add_u32 m0, s69, 51200
    s_nop 0
    buffer_load_dwordx4 v199, s[24:27], s64 offen lds
L_SK5:
    s_add_u32 m0, s69, 53248
    s_add_u32 s66, s65, 122880
    buffer_load_dwordx4 v200, s[32:35], s65 offen offset:0 lds
    s_add_u32 m0, s69, 60160
    s_nop 0
    buffer_load_dwordx4 v200, s[32:35], s65 offen offset:1280 lds
    s_add_u32 m0, s69, 67072
    s_nop 0
    buffer_load_dwordx4 v200, s[32:35], s65 offen offset:2560 lds
    s_add_u32 m0, s69, 57344
    s_nop 0
    buffer_load_dwordx4 v200, s[32:35], s66 offen offset:0 lds
    s_add_u32 m0, s69, 64256
    s_nop 0
    buffer_load_dwordx4 v200, s[32:35], s66 offen offset:1280 lds
    s_add_u32 m0, s69, 71168
    s_nop 0
    buffer_load_dwordx4 v200, s[32:35], s66 offen offset:2560 lds
    s_add_u32 m0, s69, 151296
    s_add_u32 s64, s58, s57
    buffer_load_dwordx4 v197, s[24:27], s64 offen lds
    s_waitcnt vmcnt(10)
    s_barrier
    s_lshr_b32 s64, 353640, s67
    s_and_b32 s64, s64, 15
    s_add_u32 s64, s64, s68
    s_cmp_ge_u32 s64, 10
    s_cselect_b32 s65, 10, 0
    s_sub_u32 s64, s64, s65
    s_mul_i32 s65, s64, 245760
    s_lshl_b32 s64, s64, 7
    s_add_u32 s64, s64, s57
    s_add_u32 m0, s69, 77824
    s_mov_b32 exec_lo, s70
    buffer_load_dwordx4 v196, s[24:27], s64 offen lds
    s_add_u32 m0, s69, 81920
    s_mov_b32 exec_lo, -1
    buffer_load_dwordx4 v197, s[24:27], s64 offen lds
    s_add_u32 m0, s69, 86016
    s_add_u32 s65, s65, s58
    buffer_load_dwordx4 v198, s[24:27], s64 offen lds
    s_cbranch_vccz L_SK6
    s_add_u32 m0, s69, 90112
    s_nop 0
    buffer_load_dwordx4 v199, s[24:27], s64 offen lds
L_SK6:
    s_add_u32 m0, s69, 92160
    s_add_u32 s66, s65, 122880
    buffer_load_dwordx4 v200, s[32:35], s65 offen offset:0 lds
    s_waitcnt lgkmcnt(0)
    s_add_u32 m0, s69, 99072
    s_nop 0
    buffer_load_dwordx4 v200, s[32:35], s65 offen offset:1280 lds
    s_add_u32 m0, s69, 105984
    s_nop 0
    buffer_load_dwordx4 v200, s[32:35], s65 offen offset:2560 lds
    s_add_u32 m0, s69, 96256
    s_nop 0
    buffer_load_dwordx4 v200, s[32:35], s66 offen offset:0 lds
    s_add_u32 m0, s69, 103168
    s_nop 0
    buffer_load_dwordx4 v200, s[32:35], s66 offen offset:1280 lds
    s_add_u32 m0, s69, 110080
    s_nop 0
    buffer_load_dwordx4 v200, s[32:35], s66 offen offset:2560 lds
    s_add_u32 m0, s69, 155392
    s_add_u32 s64, s58, s57
    buffer_load_dwordx4 v198, s[24:27], s64 offen lds
    s_waitcnt vmcnt(10)
    s_barrier
    s_lshr_b32 s64, 489110, s67
    s_and_b32 s64, s64, 15
    s_add_u32 s64, s64, s68
    s_cmp_ge_u32 s64, 10
    s_cselect_b32 s65, 10, 0
    s_sub_u32 s64, s64, s65
    s_mul_i32 s65, s64, 245760
    s_lshl_b32 s64, s64, 7
    s_add_u32 s64, s64, s57
    s_add_u32 m0, s69, 0
    s_mov_b32 exec_lo, s70
    buffer_load_dwordx4 v196, s[24:27], s64 offen lds
    s_add_u32 m0, s69, 4096
    s_mov_b32 exec_lo, -1
    buffer_load_dwordx4 v197, s[24:27], s64 offen lds
    s_add_u32 m0, s69, 8192
    s_add_u32 s65, s65, s58
    buffer_load_dwordx4 v198, s[24:27], s64 offen lds
    s_cbranch_vccz L_SK7
    s_add_u32 m0, s69, 12288
    s_nop 0
    buffer_load_dwordx4 v199, s[24:27], s64 offen lds
L_SK7:
    s_add_u32 m0, s69, 14336
    s_add_u32 s66, s65, 122880
    buffer_load_dwordx4 v200, s[32:35], s65 offen offset:0 lds
    s_add_u32 m0, s69, 21248
    s_nop 0
    buffer_load_dwordx4 v200, s[32:35], s65 offen offset:1280 lds
    s_add_u32 m0, s69, 28160
    s_nop 0
    buffer_load_dwordx4 v200, s[32:35], s65 offen offset:2560 lds
    s_add_u32 m0, s69, 18432
    s_nop 0
    buffer_load_dwordx4 v200, s[32:35], s66 offen offset:0 lds
    s_add_u32 m0, s69, 25344
    s_nop 0
    buffer_load_dwordx4 v200, s[32:35], s66 offen offset:1280 lds
    s_add_u32 m0, s69, 32256
    s_nop 0
    buffer_load_dwordx4 v200, s[32:35], s66 offen offset:2560 lds
    s_cbranch_vccz L_SKX
    s_add_u32 m0, s69, 159488
    s_add_u32 s64, s58, s57
    buffer_load_dwordx4 v199, s[24:27], s64 offen lds
L_SKX:
    s_waitcnt vmcnt(9)
    s_barrier
    s_lshr_b32 s64, 559223, s67
    s_and_b32 s64, s64, 15
    s_add_u32 s64, s64, s68
    s_cmp_ge_u32 s64, 10
    s_cselect_b32 s65, 10, 0
    s_sub_u32 s64, s64, s65
    s_mul_i32 s65, s64, 245760
    s_lshl_b32 s64, s64, 7
    s_add_u32 s64, s64, s57
    s_add_u32 m0, s69, 38912
    s_mov_b32 exec_lo, s70
    buffer_load_dwordx4 v196, s[24:27], s64 offen lds
    s_add_u32 m0, s69, 43008
    s_mov_b32 exec_lo, -1
    buffer_load_dwordx4 v197, s[24:27], s64 offen lds
    s_add_u32 m0, s69, 47104
    s_add_u32 s65, s65, s58
    buffer_load_dwordx4 v198, s[24:27], s64 offen lds
    s_cbranch_vccz L_SK8
    s_add_u32 m0, s69, 51200
    s_nop 0
    buffer_load_dwordx4 v199, s[24:27], s64 offen lds
L_SK8:
    s_add_u32 m0, s69, 53248
    s_add_u32 s66, s65, 122880
    buffer_load_dwordx4 v200, s[32:35], s65 offen offset:0 lds
    v_readfirstlane_b32 s52, v109
    s_add_u32 m0, s69, 60160
    s_nop 0
    buffer_load_dwordx4 v200, s[32:35], s65 offen offset:1280 lds
    s_add_u32 m0, s69, 67072
    s_nop 0
    buffer_load_dwordx4 v200, s[32:35], s65 offen offset:2560 lds
    s_add_u32 m0, s69, 57344
    s_nop 0
    buffer_load_dwordx4 v200, s[32:35], s66 offen offset:0 lds
    s_add_u32 m0, s69, 64256
    s_nop 0
    buffer_load_dwordx4 v200, s[32:35], s66 offen offset:1280 lds
    s_add_u32 m0, s69, 71168
    s_nop 0
    buffer_load_dwordx4 v200, s[32:35], s66 offen offset:2560 lds
    s_mul_i32 s60, s59, 448
    s_add_u32 m0, s60, 161536
    s_mov_b64 exec, 0xfffffff
    buffer_load_dwordx4 v81, s[28:31], 0 offen  lds
    s_mov_b64 exec, -1
    s_waitcnt vmcnt(10)
    s_barrier
    s_lshr_b32 s64, 629129, s67
    s_and_b32 s64, s64, 15
    s_add_u32 s64, s64, s68
    s_cmp_ge_u32 s64, 10
    s_cselect_b32 s65, 10, 0
    s_sub_u32 s64, s64, s65
    s_mul_i32 s65, s64, 245760
    s_lshl_b32 s64, s64, 7
    s_add_u32 s64, s64, s57
    s_add_u32 m0, s69, 77824
    s_mov_b32 exec_lo, s70
    buffer_load_dwordx4 v196, s[24:27], s64 offen lds
    s_add_u32 m0, s69, 81920
    s_mov_b32 exec_lo, -1
    buffer_load_dwordx4 v197, s[24:27], s64 offen lds
    s_add_u32 m0, s69, 86016
    s_add_u32 s65, s65, s58
    buffer_load_dwordx4 v198, s[24:27], s64 offen lds
    s_cbranch_vccz L_SK9
    s_add_u32 m0, s69, 90112
    s_nop 0
    buffer_load_dwordx4 v199, s[24:27], s64 offen lds
L_SK9:
    s_add_u32 m0, s69, 92160
    s_add_u32 s66, s65, 122880
    buffer_load_dwordx4 v200, s[32:35], s65 offen offset:0 lds
    s_add_u32 m0, s69, 99072
    s_nop 0
    buffer_load_dwordx4 v200, s[32:35], s65 offen offset:1280 lds
    s_add_u32 m0, s69, 105984
    s_nop 0
    buffer_load_dwordx4 v200, s[32:35], s65 offen offset:2560 lds
    s_add_u32 m0, s69, 96256
    s_nop 0
    buffer_load_dwordx4 v200, s[32:35], s66 offen offset:0 lds
    s_add_u32 m0, s69, 103168
    s_nop 0
    buffer_load_dwordx4 v200, s[32:35], s66 offen offset:1280 lds
    s_add_u32 m0, s69, 110080
    s_nop 0
    buffer_load_dwordx4 v200, s[32:35], s66 offen offset:2560 lds
    s_waitcnt vmcnt(9)
    s_barrier
    ds_read_b128 v[84:87], v82
    s_mov_b32 s64, s71
    s_add_u32 s65, s69, 0
    s_add_u32 m0, s64, s65
    s_mul_i32 s61, s64, 10
    s_add_u32 s61, s61, s22
    buffer_load_dwordx4 v16, s[40:43], s61 offen lds
    s_add_u32 s64, s64, 4096
    s_cmp_eq_u32 s64, 36864
    s_cselect_b32 s64, 0, s64
    s_add_u32 m0, s64, s65
    s_mul_i32 s61, s64, 10
    s_add_u32 s61, s61, s22
    buffer_load_dwordx4 v16, s[40:43], s61 offen lds
    s_add_u32 s64, s64, 4096
    s_add_u32 m0, s64, s65
    s_mul_i32 s61, s64, 10
    s_add_u32 s61, s61, s22
    buffer_load_dwordx4 v16, s[40:43], s61 offen lds
    s_add_u32 s64, s64, 4096
    s_cmp_eq_u32 s64, 36864
    s_cselect_b32 s64, 0, s64
    s_add_u32 m0, s64, s65
    s_mul_i32 s61, s64, 10
    s_add_u32 s61, s61, s22
    buffer_load_dwordx4 v16, s[40:43], s61 offen lds
    s_add_u32 s64, s64, 4096
    s_add_u32 m0, s64, s65
    s_mul_i32 s61, s64, 10
    s_add_u32 s61, s61, s22
    buffer_load_dwordx4 v16, s[40:43], s61 offen lds
    s_add_u32 s64, s64, 4096
    s_cmp_eq_u32 s64, 36864
    s_cselect_b32 s64, 0, s64
    s_add_u32 m0, s64, s65
    s_mul_i32 s61, s64, 10
    s_add_u32 s61, s61, s22
    buffer_load_dwordx4 v16, s[40:43], s61 offen lds
    s_add_u32 s64, s64, 4096
    s_add_u32 m0, s64, s65
    s_mul_i32 s61, s64, 10
    s_add_u32 s61, s61, s22
    buffer_load_dwordx4 v16, s[40:43], s61 offen lds
    s_add_u32 s64, s64, 4096
    s_cmp_eq_u32 s64, 36864
    s_cselect_b32 s64, 0, s64
    s_add_u32 m0, s64, s65
    s_mul_i32 s61, s64, 10
    s_add_u32 s61, s61, s22
    buffer_load_dwordx4 v16, s[40:43], s61 offen lds
    s_add_u32 s64, s64, 4096
    s_add_u32 m0, s64, s65
    s_mul_i32 s61, s64, 10
    s_add_u32 s61, s61, s22
    buffer_load_dwordx4 v16, s[40:43], s61 offen lds
    s_waitcnt lgkmcnt(0)
L_RC_CHK:
    v_xor_b32 v2, s52, v85
    v_bitop3_b32 v2, v87, s52, v2 bitop3:0xbe
    v_cmp_ne_u32 vcc, 0, v2
    s_cbranch_vccnz L_RC_RETRY
L_RC_OK:
    s_waitcnt vmcnt(9)
    s_barrier
    s_cmp_lg_u32 s3, 1
    s_cbranch_scc1 L_NORS
    v_mov_b32 v124, s52
    v_mov_b32 v125, s52
    v_mov_b32 v126, s52
    v_mov_b32 v127, s52
    s_add_u32 s60, s98, s58
    s_mov_b64 exec, 0xff
    buffer_store_dwordx4 v[124:127], v6, s[28:31], s60 offen sc1
    s_mov_b64 exec, -1
L_NORS:
    s_lshl_b32 s60, s59, 10
    s_add_u32 m0, s60, 36864
    s_add_u32 s60, s22, 368640
    buffer_load_dwordx4 v16, s[40:43], s60 offen lds
    s_mov_b64 exec, 1
    buffer_load_dwordx4 v[112:115], v6, s[28:31], 0 offen offset:256
    s_mov_b64 exec, -1
    s_mul_i32 s64, s71, 10
    s_add_u32 s61, s64, s23
    buffer_load_dwordx4 v[216:219], v16, s[40:43], s61 offen
    s_add_u32 s64, s64, 40960
    s_add_u32 s61, s64, s23
    buffer_load_dwordx4 v[220:223], v16, s[40:43], s61 offen
    s_add_u32 s64, s64, 40960
    s_cmp_eq_u32 s64, 409600
    s_cselect_b32 s64, 0, s64
    s_add_u32 s61, s64, s23
    buffer_load_dwordx4 v[224:227], v16, s[40:43], s61 offen
    s_add_u32 s64, s64, 40960
    s_add_u32 s61, s64, s23
    buffer_load_dwordx4 v[228:231], v16, s[40:43], s61 offen
    s_add_u32 s64, s64, 40960
    s_cmp_eq_u32 s64, 409600
    s_cselect_b32 s64, 0, s64
    s_add_u32 s61, s64, s23
    buffer_load_dwordx4 v[232:235], v16, s[40:43], s61 offen
    s_add_u32 s64, s64, 40960
    s_add_u32 s61, s64, s23
    buffer_load_dwordx4 v[236:239], v16, s[40:43], s61 offen
    s_add_u32 s64, s64, 40960
    s_cmp_eq_u32 s64, 409600
    s_cselect_b32 s64, 0, s64
    s_add_u32 s61, s64, s23
    buffer_load_dwordx4 v[240:243], v16, s[40:43], s61 offen
    s_add_u32 s64, s64, 40960
    s_add_u32 s61, s64, s23
    buffer_load_dwordx4 v[244:247], v16, s[40:43], s61 offen
    s_add_u32 s64, s64, 40960
    s_cmp_eq_u32 s64, 409600
    s_cselect_b32 s64, 0, s64
    s_add_u32 s61, s64, s23
    buffer_load_dwordx4 v[248:251], v16, s[40:43], s61 offen
    s_add_u32 s64, s64, 40960
    s_add_u32 s61, s64, s23
    buffer_load_dwordx4 v[252:255], v16, s[40:43], s61 offen
    s_mov_b64 exec, 0
    s_bitcmp1_b32 s3, 0
    s_cbranch_scc1 TC4
    s_branch TC0
TC_END:
    s_mov_b64 exec, -1
    s_barrier
    s_setprio 1
    s_cmp_eq_u32 s13, 1
    s_cbranch_scc1 AL_S
    ds_read_b64 v[64:65], v20 offset:4480
    ds_read_b64 v[66:67], v21 offset:4480
    ds_read_b64 v[84:85], v20 offset:4352
    ds_read_b64 v[86:87], v21 offset:4352
    ds_read_b64 v[68:69], v20 offset:8832
    ds_read_b64 v[70:71], v21 offset:8832
    ds_read_b64 v[88:89], v20 offset:8704
    ds_read_b64 v[90:91], v21 offset:8704
    ds_read_b64 v[72:73], v20 offset:13184
    ds_read_b64 v[74:75], v21 offset:13184
    ds_read_b64 v[92:93], v20 offset:13056
    ds_read_b64 v[94:95], v21 offset:13056
    ds_read_b64 v[76:77], v20 offset:17536
    ds_read_b64 v[78:79], v21 offset:17536
    ds_read_b64 v[96:97], v20 offset:17408
    ds_read_b64 v[98:99], v21 offset:17408
    s_cmp_lg_u32 s3, 2
    s_cbranch_scc1 AL_NOR0
    s_mov_b32 exec_lo, s99
    s_mov_b32 exec_hi, 0
    buffer_load_dword v109, v108, s[28:31], s98 offen sc1
    s_mov_b64 exec, -1
AL_NOR0:
    v_lshl_add_u32 v3, v5, 8, v26
    v_mov_b32 v0, v27
    s_waitcnt lgkmcnt(12)
    v_mfma_f32_16x16x32_bf16 v[168:171], v[84:87], v[64:67], v[42:45]
    s_waitcnt lgkmcnt(8)
    v_mfma_f32_16x16x32_bf16 v[172:175], v[88:91], v[68:71], v[32:35]
    v_mfma_f32_16x16x32_bf16 v[52:55], v[84:87], v[68:71], v[36:39]
    s_waitcnt lgkmcnt(4)
    v_mfma_f32_16x16x32_bf16 v[176:179], v[92:95], v[72:75], v[32:35]
    v_mfma_f32_16x16x32_bf16 v[56:59], v[88:91], v[72:75], v[36:39]
    s_waitcnt lgkmcnt(0)
    v_mfma_f32_16x16x32_bf16 v[180:183], v[96:99], v[76:79], v[32:35]
    v_mfma_f32_16x16x32_bf16 v[60:63], v[92:95], v[76:79], v[36:39]
    s_branch AL_J
AL_S:
    ds_read_b64 v[64:65], v20 offset:4480
    ds_read_b64 v[84:85], v20 offset:4352
    ds_read_b64 v[68:69], v20 offset:8832
    ds_read_b64 v[88:89], v20 offset:8704
    ds_read_b64 v[72:73], v20 offset:13184
    ds_read_b64 v[92:93], v20 offset:13056
    ds_read_b64 v[76:77], v20 offset:17536
    ds_read_b64 v[96:97], v20 offset:17408
    v_lshl_add_u32 v3, v5, 8, v26
    v_mov_b32 v0, v27
    s_waitcnt lgkmcnt(6)
    v_mfma_f32_16x16x16_bf16 v[168:171], v[84:85], v[64:65], v[42:45]
    s_waitcnt lgkmcnt(4)
    v_mfma_f32_16x16x16_bf16 v[172:175], v[88:89], v[68:69], v[32:35]
    v_mfma_f32_16x16x16_bf16 v[52:55], v[84:85], v[68:69], v[36:39]
    s_waitcnt lgkmcnt(2)
    v_mfma_f32_16x16x16_bf16 v[176:179], v[92:93], v[72:73], v[32:35]
    v_mfma_f32_16x16x16_bf16 v[56:59], v[88:89], v[72:73], v[36:39]
    s_waitcnt lgkmcnt(0)
    v_mfma_f32_16x16x16_bf16 v[180:183], v[96:97], v[76:77], v[32:35]
    v_mfma_f32_16x16x16_bf16 v[60:63], v[92:93], v[76:77], v[36:39]
AL_J:
    ds_read_b32 v27, v3
    ds_read2st64_b32 v[36:37], v26 offset1:1
    ds_read2st64_b32 v[38:39], v26 offset0:2 offset1:3
    v_max_f32 v172, v172, v52
    v_max_f32 v173, v173, v53
    v_max_f32 v174, v174, v54
    v_max_f32 v175, v175, v55
    v_max_f32 v176, v176, v56
    v_max_f32 v177, v177, v57
    v_max_f32 v178, v178, v58
    v_max_f32 v179, v179, v59
    v_max_f32 v180, v180, v60
    v_max_f32 v181, v181, v61
    v_max_f32 v182, v182, v62
    v_max_f32 v183, v183, v63
    s_cmp_lg_u32 s13, 1
    s_cbranch_scc1 AL_SM
    v_cvt_pk_bf16_f32 v64, v168, v169
    v_mov_b32 v65, s52
    v_cvt_pk_bf16_f32 v66, v170, v171
    v_mov_b32 v67, s52
    buffer_store_dwordx4 v[64:67], v6, s[28:31], s11 offen offset:0 sc1
    v_cvt_pk_bf16_f32 v68, v172, v173
    v_mov_b32 v69, s52
    v_cvt_pk_bf16_f32 v70, v174, v175
    v_mov_b32 v71, s52
    buffer_store_dwordx4 v[68:71], v6, s[28:31], s11 offen offset:1024 sc1
    v_cvt_pk_bf16_f32 v72, v176, v177
    v_mov_b32 v73, s52
    v_cvt_pk_bf16_f32 v74, v178, v179
    v_mov_b32 v75, s52
    buffer_store_dwordx4 v[72:75], v6, s[28:31], s11 offen offset:2048 sc1
    v_cvt_pk_bf16_f32 v76, v180, v181
    v_mov_b32 v77, s52
    v_cvt_pk_bf16_f32 v78, v182, v183
    v_mov_b32 v79, s52
    buffer_store_dwordx4 v[76:79], v6, s[28:31], s11 offen offset:3072 sc1
    s_branch AL_X
AL_SM:
    v_max3_f32 v136, v168, v169, v170
    v_max3_f32 v138, v172, v173, v174
    v_max3_f32 v140, v176, v177, v178
    v_max3_f32 v142, v180, v181, v182
    v_max_f32 v136, v136, v171
    v_max_f32 v138, v138, v175
    v_max_f32 v140, v140, v179
    v_max_f32 v142, v142, v183
    s_nop 0
    v_permlane32_swap_b32 v136, v140
    v_permlane32_swap_b32 v138, v142
    v_max_f32 v136, v136, v140
    v_max_f32 v138, v138, v142
    s_waitcnt lgkmcnt(0)
    v_mul_f32 v27, 0x3ea52b5c, v27
    v_permlane16_swap_b32 v136, v138
    v_max_f32 v136, v136, v138
    v_mul_f32 v138, v136, v27
    v_mul_f32 v136, v136, v27
    v_mul_f32 v32, 0x3ea52b5c, v36
    v_mul_f32 v34, 0x3ea52b5c, v37
    v_permlane16_swap_b32 v136, v138
    v_mov_b32 v140, v136
    v_mov_b32 v142, v138
    v_mul_f32 v36, 0x3ea52b5c, v38
    v_mul_f32 v38, 0x3ea52b5c, v39
    v_permlane32_swap_b32 v136, v140
    v_permlane32_swap_b32 v138, v142
    v_pk_fma_f32 v[168:169], v[168:169], v[32:33], v[136:137] op_sel_hi:[1,0,0] neg_lo:[0,0,1] neg_hi:[0,0,1]
    v_pk_fma_f32 v[170:171], v[170:171], v[32:33], v[136:137] op_sel_hi:[1,0,0] neg_lo:[0,0,1] neg_hi:[0,0,1]
    v_pk_fma_f32 v[172:173], v[172:173], v[34:35], v[138:139] op_sel_hi:[1,0,0] neg_lo:[0,0,1] neg_hi:[0,0,1]
    v_pk_fma_f32 v[174:175], v[174:175], v[34:35], v[138:139] op_sel_hi:[1,0,0] neg_lo:[0,0,1] neg_hi:[0,0,1]
    v_pk_fma_f32 v[176:177], v[176:177], v[36:37], v[140:141] op_sel_hi:[1,0,0] neg_lo:[0,0,1] neg_hi:[0,0,1]
    v_pk_fma_f32 v[178:179], v[178:179], v[36:37], v[140:141] op_sel_hi:[1,0,0] neg_lo:[0,0,1] neg_hi:[0,0,1]
    v_pk_fma_f32 v[180:181], v[180:181], v[38:39], v[142:143] op_sel_hi:[1,0,0] neg_lo:[0,0,1] neg_hi:[0,0,1]
    v_pk_fma_f32 v[182:183], v[182:183], v[38:39], v[142:143] op_sel_hi:[1,0,0] neg_lo:[0,0,1] neg_hi:[0,0,1]
    s_cmp_eq_u32 s13, 1
    s_cbranch_scc1 AL_NOY
    s_cmp_lg_u32 s3, 2
    s_cbranch_scc1 AL_NOR1
    s_mov_b32 exec_lo, s99
    s_mov_b32 exec_hi, 0
    s_waitcnt vmcnt(0)
AL_RD_CHK:
    v_xor_b32 v2, s52, v109
    v_cmp_ne_u32 vcc, 0, v2
    s_cbranch_vccz AL_RD_OK
AL_RD_RETRY:
    s_add_u32 s100, s100, 1
    s_cmp_gt_u32 s100, 20000
    s_cbranch_scc1 AL_RD_OK
    s_sleep 1
    buffer_load_dword v109, v108, s[28:31], s98 offen sc1
    s_waitcnt vmcnt(0)
    s_branch AL_RD_CHK
AL_RD_OK:
    s_mov_b64 exec, -1
AL_NOR1:
    s_waitcnt vmcnt(0)
    s_barrier
    ds_read_b64_tr_b16 v[184:185], v22 offset:2176
    ds_read_b64_tr_b16 v[194:195], v23 offset:2176
    ds_read_b64_tr_b16 v[186:187], v22 offset:2176
    ds_read_b64_tr_b16 v[196:197], v23 offset:2176
    ds_read_b64_tr_b16 v[188:189], v22 offset:4352
    ds_read_b64_tr_b16 v[198:199], v23 offset:4352
    ds_read_b64_tr_b16 v[190:191], v22 offset:6528
    ds_read_b64_tr_b16 v[200:201], v23 offset:6528
    ds_read_b64_tr_b16 v[192:193], v22 offset:8704
    ds_read_b64_tr_b16 v[202:203], v23 offset:8704
AL_NOY:
    v_exp_f32 v168, v168
    v_exp_f32 v169, v169
    v_exp_f32 v170, v170
    v_exp_f32 v171, v171
    v_cvt_pk_bf16_f32 v2, v168, v169
    v_cvt_pk_bf16_f32 v3, v170, v171
    v_bfi_b32 v168, v40, 0, v2
    v_bfi_b32 v169, v41, 0, v3
    v_and_b32 v170, v40, v2
    v_and_b32 v171, v41, v3
    s_waitcnt lgkmcnt(0)
    v_exp_f32 v172, v172
    v_mfma_f32_16x16x32_bf16 v[116:119], v[28:31], v[168:171], 0
    v_exp_f32 v173, v173
    v_mfma_f32_16x16x32_bf16 v[136:139], v[184:187], v[168:171], 0
    v_exp_f32 v174, v174
    v_mfma_f32_16x16x32_bf16 v[152:155], v[194:197], v[168:171], 0
    v_exp_f32 v175, v175
    v_cvt_pk_bf16_f32 v2, v172, v173
    v_cvt_pk_bf16_f32 v3, v174, v175
    v_bfi_b32 v172, v40, 0, v2
    v_bfi_b32 v173, v41, 0, v3
    v_and_b32 v174, v40, v2
    v_and_b32 v175, v41, v3
    v_rcp_f32 v32, v116
    v_exp_f32 v176, v176
    v_mfma_f32_16x16x32_bf16 v[120:123], v[28:31], v[172:175], 0
    v_exp_f32 v177, v177
    v_mfma_f32_16x16x32_bf16 v[140:143], v[186:189], v[172:175], 0
    v_exp_f32 v178, v178
    v_mfma_f32_16x16x32_bf16 v[156:159], v[196:199], v[172:175], 0
    v_exp_f32 v179, v179
    v_cvt_pk_bf16_f32 v2, v176, v177
    v_cvt_pk_bf16_f32 v3, v178, v179
    v_bfi_b32 v176, v40, 0, v2
    v_bfi_b32 v177, v41, 0, v3
    v_and_b32 v178, v40, v2
    v_and_b32 v179, v41, v3
    v_rcp_f32 v34, v120
    v_exp_f32 v180, v180
    v_mfma_f32_16x16x32_bf16 v[116:119], v[28:31], v[176:179], 0
    v_exp_f32 v181, v181
    v_mfma_f32_16x16x32_bf16 v[144:147], v[188:191], v[176:179], 0
    v_exp_f32 v182, v182
    v_mfma_f32_16x16x32_bf16 v[160:163], v[198:201], v[176:179], 0
    v_exp_f32 v183, v183
    v_cvt_pk_bf16_f32 v2, v180, v181
    v_cvt_pk_bf16_f32 v3, v182, v183
    v_bfi_b32 v180, v40, 0, v2
    v_bfi_b32 v181, v41, 0, v3
    v_and_b32 v182, v40, v2
    v_and_b32 v183, v41, v3
    v_rcp_f32 v36, v116
    v_mul_f32 v136, v136, v32
    v_mfma_f32_16x16x32_bf16 v[120:123], v[28:31], v[180:183], 0
    v_mul_f32 v137, v137, v32
    v_mfma_f32_16x16x32_bf16 v[148:151], v[190:193], v[180:183], 0
    v_mul_f32 v138, v138, v32
    v_mfma_f32_16x16x32_bf16 v[164:167], v[200:203], v[180:183], 0
    v_mul_f32 v139, v139, v32
    v_cvt_pk_bf16_f32 v136, v136, v137
    v_cvt_pk_bf16_f32 v137, v138, v139
    v_mul_f32 v140, v140, v34
    v_mul_f32 v141, v141, v34
    v_mul_f32 v142, v142, v34
    v_mul_f32 v143, v143, v34
    v_cvt_pk_bf16_f32 v138, v140, v141
    v_cvt_pk_bf16_f32 v139, v142, v143
    v_rcp_f32 v38, v120
    v_pk_mul_f32 v[144:145], v[144:145], v[36:37] op_sel_hi:[1,0]
    v_pk_mul_f32 v[146:147], v[146:147], v[36:37] op_sel_hi:[1,0]
    v_permlane32_swap_b32 v136, v138
    v_permlane32_swap_b32 v137, v139
    v_pk_mul_f32 v[148:149], v[148:149], v[38:39] op_sel_hi:[1,0]
    v_pk_mul_f32 v[150:151], v[150:151], v[38:39] op_sel_hi:[1,0]
    v_cvt_pk_bf16_f32 v144, v144, v145
    v_cvt_pk_bf16_f32 v145, v146, v147
    v_cvt_pk_bf16_f32 v146, v148, v149
    v_cvt_pk_bf16_f32 v147, v150, v151
    s_mov_b64 exec, s[14:15]
    buffer_store_dwordx4 v[136:139], v24, s[28:31], s9 offen sc1
    s_mov_b64 exec, -1
    v_permlane32_swap_b32 v144, v146
    v_permlane32_swap_b32 v145, v147
    v_pk_mul_f32 v[152:153], v[152:153], v[32:33] op_sel_hi:[1,0]
    v_pk_mul_f32 v[154:155], v[154:155], v[32:33] op_sel_hi:[1,0]
    s_mov_b64 exec, s[16:17]
    buffer_store_dwordx4 v[144:147], v24, s[28:31], s5 offen sc1
    s_lshl_b64 exec, -1, 16
    v_pk_mul_f32 v[152:153], v[156:157], v[34:35] op_sel_hi:[1,0]
    v_pk_mul_f32 v[154:155], v[158:159], v[34:35] op_sel_hi:[1,0]
    s_lshl_b64 exec, -1, 32
    v_pk_mul_f32 v[152:153], v[160:161], v[36:37] op_sel_hi:[1,0]
    v_pk_mul_f32 v[154:155], v[162:163], v[36:37] op_sel_hi:[1,0]
    s_lshl_b64 exec, -1, 48
    v_pk_mul_f32 v[152:153], v[164:165], v[38:39] op_sel_hi:[1,0]
    v_pk_mul_f32 v[154:155], v[166:167], v[38:39] op_sel_hi:[1,0]
    s_mov_b64 exec, s[18:19]
    v_cvt_pk_bf16_f32 v152, v152, v153
    v_cvt_pk_bf16_f32 v153, v154, v155
    buffer_store_dwordx2 v[152:153], v25, s[28:31], s10 offen sc1
    s_mov_b64 exec, -1
    s_cmp_eq_u32 s13, 1
    s_cbranch_scc1 P_TAIL
    s_mov_b32 s64, s71
    s_add_u32 s65, s69, 40960
    s_add_u32 s61, s64, s65
    v_add_u32 v3, s61, v6
    ds_write_b128 v3, v[216:219] offset:0
    ds_write_b128 v3, v[220:223] offset:4096
    s_add_u32 s64, s64, 8192
    s_cmp_eq_u32 s64, 40960
    s_cselect_b32 s64, 0, s64
    s_add_u32 s61, s64, s65
    v_add_u32 v3, s61, v6
    ds_write_b128 v3, v[224:227] offset:0
    ds_write_b128 v3, v[228:231] offset:4096
    s_add_u32 s64, s64, 8192
    s_cmp_eq_u32 s64, 40960
    s_cselect_b32 s64, 0, s64
    s_add_u32 s61, s64, s65
    v_add_u32 v3, s61, v6
    ds_write_b128 v3, v[232:235] offset:0
    ds_write_b128 v3, v[236:239] offset:4096
    s_add_u32 s64, s64, 8192
    s_cmp_eq_u32 s64, 40960
    s_cselect_b32 s64, 0, s64
    s_add_u32 s61, s64, s65
    v_add_u32 v3, s61, v6
    ds_write_b128 v3, v[240:243] offset:0
    ds_write_b128 v3, v[244:247] offset:4096
    s_add_u32 s64, s64, 8192
    s_cmp_eq_u32 s64, 40960
    s_cselect_b32 s64, 0, s64
    s_add_u32 s61, s64, s65
    v_add_u32 v3, s61, v6
    ds_write_b128 v3, v[248:251] offset:0
    ds_write_b128 v3, v[252:255] offset:4096
    v_mov_b32 v2, 1
    ds_write_b8 v18, v2 offset:16
    s_branch A_DONE
AC_X:
TC0:
    s_cbranch_execz TC1
    s_setprio 0
    s_call_b64 s[20:21], K_P1
    s_call_b64 s[20:21], K_P2
    s_sleep 0
    s_setprio 2
    buffer_load_dwordx4 v[136:139], v6, s[28:31], s12 offen offset:0 sc1
    buffer_load_dwordx4 v[140:143], v6, s[28:31], s12 offen offset:1024 sc1
    buffer_load_dwordx4 v[144:147], v6, s[28:31], s12 offen offset:2048 sc1
    s_setprio 2
    s_call_b64 s[20:21], K_P3
    s_setprio 2
    s_waitcnt vmcnt(0)
AC_MB_CHK:
    v_xor_b32 v2, s52, v137
    v_bitop3_b32 v2, v139, s52, v2 bitop3:0xbe
    v_bitop3_b32 v2, v141, s52, v2 bitop3:0xbe
    v_bitop3_b32 v2, v143, s52, v2 bitop3:0xbe
    v_bitop3_b32 v2, v145, s52, v2 bitop3:0xbe
    v_bitop3_b32 v2, v147, s52, v2 bitop3:0xbe
    v_cmp_ne_u32 vcc, 0, v2
    s_cbranch_vccnz AC_MB_RETRY
AC_MB_OK:
    v_lshlrev_b32 v137, 16, v136
    v_and_b32 v136, s55, v136
    v_lshlrev_b32 v139, 16, v138
    v_and_b32 v138, s55, v138
    v_add_f32 v168, v168, v137
    v_add_f32 v169, v169, v136
    v_add_f32 v170, v170, v139
    v_add_f32 v171, v171, v138
    v_lshlrev_b32 v141, 16, v140
    v_and_b32 v140, s55, v140
    v_lshlrev_b32 v143, 16, v142
    v_and_b32 v142, s55, v142
    v_add_f32 v172, v172, v141
    v_add_f32 v173, v173, v140
    v_add_f32 v174, v174, v143
    v_add_f32 v175, v175, v142
    v_lshlrev_b32 v145, 16, v144
    v_and_b32 v144, s55, v144
    v_lshlrev_b32 v147, 16, v146
    v_and_b32 v146, s55, v146
    v_add_f32 v176, v176, v145
    v_add_f32 v177, v177, v144
    v_add_f32 v178, v178, v147
    v_add_f32 v179, v179, v146
    s_branch AC_SM
AL_X:
TC7:
    s_cbranch_execz TC_END
    s_setprio 0
    s_mov_b64 exec, 1
    s_waitcnt vmcnt(4)
L_FL_CHK:
    v_xor_b32 v2, s52, v113
    v_bitop3_b32 v2, v115, s52, v2 bitop3:0xbe
    v_cmp_ne_u32 vcc, 0, v2
    s_cbranch_vccnz L_FL_RETRY
L_FL_OK:
    ds_write2_b32 v19, v112, v114 offset0:10 offset1:11
    s_mov_b64 exec, -1
    s_waitcnt lgkmcnt(0)
    s_barrier
    ds_read_b64_tr_b16 v[184:185], v22 offset:2176
    ds_read_b64_tr_b16 v[194:195], v23 offset:2176
    ds_read_b64_tr_b16 v[186:187], v22 offset:2176
    ds_read_b64_tr_b16 v[196:197], v23 offset:2176
    ds_read_b64_tr_b16 v[188:189], v22 offset:4352
    ds_read_b64_tr_b16 v[198:199], v23 offset:4352
    ds_read_b64_tr_b16 v[190:191], v22 offset:6528
    ds_read_b64_tr_b16 v[200:201], v23 offset:6528
    ds_read_b64_tr_b16 v[192:193], v22 offset:8704
    ds_read_b64_tr_b16 v[202:203], v23 offset:8704
    s_mov_b32 s64, s71
    s_add_u32 s65, s69, 40960
    s_add_u32 s61, s64, s65
    v_add_u32 v3, s61, v6
    ds_write_b128 v3, v[216:219] offset:0
    ds_write_b128 v3, v[220:223] offset:4096
    s_add_u32 s64, s64, 8192
    s_cmp_eq_u32 s64, 40960
    s_cselect_b32 s64, 0, s64
    s_add_u32 s61, s64, s65
    v_add_u32 v3, s61, v6
    ds_write_b128 v3, v[224:227] offset:0
    ds_write_b128 v3, v[228:231] offset:4096
    s_add_u32 s64, s64, 8192
    s_cmp_eq_u32 s64, 40960
    s_cselect_b32 s64, 0, s64
    s_add_u32 s61, s64, s65
    v_add_u32 v3, s61, v6
    ds_write_b128 v3, v[232:235] offset:0
    ds_write_b128 v3, v[236:239] offset:4096
    s_add_u32 s64, s64, 8192
    s_cmp_eq_u32 s64, 40960
    s_cselect_b32 s64, 0, s64
    s_add_u32 s61, s64, s65
    v_add_u32 v3, s61, v6
    ds_write_b128 v3, v[240:243] offset:0
    ds_write_b128 v3, v[244:247] offset:4096
    s_add_u32 s64, s64, 8192
    s_cmp_eq_u32 s64, 40960
    s_cselect_b32 s64, 0, s64
    s_add_u32 s61, s64, s65
    v_add_u32 v3, s61, v6
    ds_write_b128 v3, v[248:251] offset:0
    ds_write_b128 v3, v[252:255] offset:4096
    v_mov_b32 v2, 1
    ds_write_b8 v18, v2 offset:16
    s_call_b64 s[20:21], K_P1
    s_sleep 2
    s_setprio 2
    buffer_load_dwordx4 v[136:139], v6, s[28:31], s12 offen offset:0 sc1
    buffer_load_dwordx4 v[140:143], v6, s[28:31], s12 offen offset:1024 sc1
    buffer_load_dwordx4 v[144:147], v6, s[28:31], s12 offen offset:2048 sc1
    buffer_load_dwordx4 v[148:151], v6, s[28:31], s12 offen offset:3072 sc1
    s_setprio 2
    s_call_b64 s[20:21], K_P2
    s_call_b64 s[20:21], K_P3
    s_setprio 2
    s_waitcnt vmcnt(0)
AL_MB_CHK:
    v_xor_b32 v2, s52, v137
    v_bitop3_b32 v2, v139, s52, v2 bitop3:0xbe
    v_bitop3_b32 v2, v141, s52, v2 bitop3:0xbe
    v_bitop3_b32 v2, v143, s52, v2 bitop3:0xbe
    v_bitop3_b32 v2, v145, s52, v2 bitop3:0xbe
    v_bitop3_b32 v2, v147, s52, v2 bitop3:0xbe
    v_bitop3_b32 v2, v149, s52, v2 bitop3:0xbe
    v_bitop3_b32 v2, v151, s52, v2 bitop3:0xbe
    v_cmp_ne_u32 vcc, 0, v2
    s_cbranch_vccnz AL_MB_RETRY
AL_MB_OK:
    v_lshlrev_b32 v137, 16, v136
    v_and_b32 v136, s55, v136
    v_lshlrev_b32 v139, 16, v138
    v_and_b32 v138, s55, v138
    v_add_f32 v168, v168, v137
    v_add_f32 v169, v169, v136
    v_add_f32 v170, v170, v139
    v_add_f32 v171, v171, v138
    v_lshlrev_b32 v141, 16, v140
    v_and_b32 v140, s55, v140
    v_lshlrev_b32 v143, 16, v142
    v_and_b32 v142, s55, v142
    v_add_f32 v172, v172, v141
    v_add_f32 v173, v173, v140
    v_add_f32 v174, v174, v143
    v_add_f32 v175, v175, v142
    v_lshlrev_b32 v145, 16, v144
    v_and_b32 v144, s55, v144
    v_lshlrev_b32 v147, 16, v146
    v_and_b32 v146, s55, v146
    v_add_f32 v176, v176, v145
    v_add_f32 v177, v177, v144
    v_add_f32 v178, v178, v147
    v_add_f32 v179, v179, v146
    v_lshlrev_b32 v149, 16, v148
    v_and_b32 v148, s55, v148
    v_lshlrev_b32 v151, 16, v150
    v_and_b32 v150, s55, v150
    v_add_f32 v180, v180, v149
    v_add_f32 v181, v181, v148
    v_add_f32 v182, v182, v151
    v_add_f32 v183, v183, v150
    s_branch AL_SM
AC_MB_RETRY:
    s_add_u32 s100, s100, 1
    s_cmp_gt_u32 s100, 20000
    s_cbranch_scc1 AC_MB_OK
    s_sleep 6
    buffer_load_dwordx4 v[136:139], v6, s[28:31], s12 offen offset:0 sc1
    buffer_load_dwordx4 v[140:143], v6, s[28:31], s12 offen offset:1024 sc1
    buffer_load_dwordx4 v[144:147], v6, s[28:31], s12 offen offset:2048 sc1
    s_waitcnt vmcnt(0)
    s_branch AC_MB_CHK
G2_R0:
TC2:
    s_cbranch_execz TC3
    s_sleep 3
    buffer_load_dwordx4 v[96:99], v0, s[28:31], s96 offen offset:0 sc1
    buffer_load_dwordx4 v[100:103], v31, s[28:31], s96 offen offset:0 sc1
    buffer_load_dwordx4 v[104:107], v0, s[28:31], s96 offen offset:1024 sc1
    buffer_load_dwordx4 v[108:111], v31, s[28:31], s96 offen offset:1024 sc1
    buffer_load_dwordx4 v[112:115], v0, s[28:31], s96 offen offset:2048 sc1
    buffer_load_dwordx4 v[116:119], v31, s[28:31], s96 offen offset:2048 sc1
    buffer_load_dwordx4 v[120:123], v0, s[28:31], s96 offen offset:3072 sc1
    buffer_load_dwordx4 v[124:127], v31, s[28:31], s96 offen offset:3072 sc1
    buffer_load_dwordx4 v[128:131], v0, s[28:31], s92 offen offset:0 sc1
    buffer_load_dwordx4 v[132:135], v31, s[28:31], s92 offen offset:0 sc1
    s_add_u32 s100, s100, 1
    s_cmp_gt_u32 s100, 20000
    s_waitcnt vmcnt(0)
    s_cbranch_scc1 G2_OK0
    v_max3_u32 v2, v96, v98, v100
    v_max_u32 v2, v2, v102
    v_cmp_eq_u32 vcc, -1, v2
    s_cbranch_vccnz G2_R0
    s_branch G2_OK0
G2_R1:
    s_sleep 3
    buffer_load_dwordx4 v[104:107], v0, s[28:31], s96 offen offset:1024 sc1
    buffer_load_dwordx4 v[108:111], v31, s[28:31], s96 offen offset:1024 sc1
    buffer_load_dwordx4 v[112:115], v0, s[28:31], s96 offen offset:2048 sc1
    buffer_load_dwordx4 v[116:119], v31, s[28:31], s96 offen offset:2048 sc1
    buffer_load_dwordx4 v[120:123], v0, s[28:31], s96 offen offset:3072 sc1
    buffer_load_dwordx4 v[124:127], v31, s[28:31], s96 offen offset:3072 sc1
    buffer_load_dwordx4 v[128:131], v0, s[28:31], s92 offen offset:0 sc1
    buffer_load_dwordx4 v[132:135], v31, s[28:31], s92 offen offset:0 sc1
    buffer_load_dwordx4 v[136:139], v0, s[28:31], s92 offen offset:1024 sc1
    buffer_load_dwordx4 v[140:143], v31, s[28:31], s92 offen offset:1024 sc1
    s_add_u32 s100, s100, 1
    s_cmp_gt_u32 s100, 20000
    s_waitcnt vmcnt(0)
    s_cbranch_scc1 G2_OK1
    v_max3_u32 v2, v104, v106, v108
    v_max_u32 v2, v2, v110
    v_cmp_eq_u32 vcc, -1, v2
    s_cbranch_vccnz G2_R1
    s_branch G2_OK1
G2_R2:
    s_sleep 3
    buffer_load_dwordx4 v[112:115], v0, s[28:31], s96 offen offset:2048 sc1
    buffer_load_dwordx4 v[116:119], v31, s[28:31], s96 offen offset:2048 sc1
    buffer_load_dwordx4 v[120:123], v0, s[28:31], s96 offen offset:3072 sc1
    buffer_load_dwordx4 v[124:127], v31, s[28:31], s96 offen offset:3072 sc1
    buffer_load_dwordx4 v[128:131], v0, s[28:31], s92 offen offset:0 sc1
    buffer_load_dwordx4 v[132:135], v31, s[28:31], s92 offen offset:0 sc1
    buffer_load_dwordx4 v[136:139], v0, s[28:31], s92 offen offset:1024 sc1
    buffer_load_dwordx4 v[140:143], v31, s[28:31], s92 offen offset:1024 sc1
    buffer_load_dwordx4 v[144:147], v0, s[28:31], s92 offen offset:2048 sc1
    buffer_load_dwordx4 v[148:151], v31, s[28:31], s92 offen offset:2048 sc1
    s_add_u32 s100, s100, 1
    s_cmp_gt_u32 s100, 20000
    s_waitcnt vmcnt(0)
    s_cbranch_scc1 G2_OK2
    v_max3_u32 v2, v112, v114, v116
    v_max_u32 v2, v2, v118
    v_cmp_eq_u32 vcc, -1, v2
    s_cbranch_vccnz G2_R2
    s_branch G2_OK2
G2_ZA:
    s_waitcnt lgkmcnt(0)
    v_and_b32 v2, v2, v3
    v_cmp_ne_u32 vcc, 0x01010101, v2
    s_cbranch_vccz G2_ZAOK
G2_ZAR:
    s_add_u32 s100, s100, 1
    s_cmp_gt_u32 s100, 200000
    s_cbranch_scc1 G2_ZAOK
    s_sleep 1
    ds_read_b64 v[2:3], v19 offset:16
    s_branch G2_ZA
G2_R3:
    s_sleep 3
    buffer_load_dwordx4 v[120:123], v0, s[28:31], s96 offen offset:3072 sc1
    buffer_load_dwordx4 v[124:127], v31, s[28:31], s96 offen offset:3072 sc1
    buffer_load_dwordx4 v[128:131], v0, s[28:31], s92 offen offset:0 sc1
    buffer_load_dwordx4 v[132:135], v31, s[28:31], s92 offen offset:0 sc1
    buffer_load_dwordx4 v[136:139], v0, s[28:31], s92 offen offset:1024 sc1
    buffer_load_dwordx4 v[140:143], v31, s[28:31], s92 offen offset:1024 sc1
    buffer_load_dwordx4 v[144:147], v0, s[28:31], s92 offen offset:2048 sc1
    buffer_load_dwordx4 v[148:151], v31, s[28:31], s92 offen offset:2048 sc1
    buffer_load_dwordx4 v[152:155], v0, s[28:31], s4 offen offset:0 sc1
    buffer_load_dwordx4 v[156:159], v31, s[28:31], s4 offen offset:0 sc1
    s_add_u32 s100, s100, 1
    s_cmp_gt_u32 s100, 20000
    s_waitcnt vmcnt(0)
    s_cbranch_scc1 G2_OK3
    v_max3_u32 v2, v120, v122, v124
    v_max_u32 v2, v2, v126
    v_cmp_eq_u32 vcc, -1, v2
    s_cbranch_vccnz G2_R3
    s_branch G2_OK3
G2_R4:
    s_sleep 3
    buffer_load_dwordx4 v[128:131], v0, s[28:31], s92 offen offset:0 sc1
    buffer_load_dwordx4 v[132:135], v31, s[28:31], s92 offen offset:0 sc1
    buffer_load_dwordx4 v[136:139], v0, s[28:31], s92 offen offset:1024 sc1
    buffer_load_dwordx4 v[140:143], v31, s[28:31], s92 offen offset:1024 sc1
    buffer_load_dwordx4 v[144:147], v0, s[28:31], s92 offen offset:2048 sc1
    buffer_load_dwordx4 v[148:151], v31, s[28:31], s92 offen offset:2048 sc1
    buffer_load_dwordx4 v[152:155], v0, s[28:31], s4 offen offset:0 sc1
    buffer_load_dwordx4 v[156:159], v31, s[28:31], s4 offen offset:0 sc1
    buffer_load_dwordx4 v[96:99], v0, s[28:31], s4 offen offset:1024 sc1
    buffer_load_dwordx4 v[100:103], v31, s[28:31], s4 offen offset:1024 sc1
    s_add_u32 s100, s100, 1
    s_cmp_gt_u32 s100, 20000
    s_waitcnt vmcnt(0)
    s_cbranch_scc1 G2_OK4
    v_max3_u32 v2, v128, v130, v132
    v_max_u32 v2, v2, v134
    v_cmp_eq_u32 vcc, -1, v2
    s_cbranch_vccnz G2_R4
    s_branch G2_OK4
G2_R5:
    s_sleep 3
    buffer_load_dwordx4 v[136:139], v0, s[28:31], s92 offen offset:1024 sc1
    buffer_load_dwordx4 v[140:143], v31, s[28:31], s92 offen offset:1024 sc1
    buffer_load_dwordx4 v[144:147], v0, s[28:31], s92 offen offset:2048 sc1
    buffer_load_dwordx4 v[148:151], v31, s[28:31], s92 offen offset:2048 sc1
    buffer_load_dwordx4 v[152:155], v0, s[28:31], s4 offen offset:0 sc1
    buffer_load_dwordx4 v[156:159], v31, s[28:31], s4 offen offset:0 sc1
    buffer_load_dwordx4 v[96:99], v0, s[28:31], s4 offen offset:1024 sc1
    buffer_load_dwordx4 v[100:103], v31, s[28:31], s4 offen offset:1024 sc1
    buffer_load_dwordx4 v[104:107], v0, s[28:31], s4 offen offset:2048 sc1
    buffer_load_dwordx4 v[108:111], v31, s[28:31], s4 offen offset:2048 sc1
    s_add_u32 s100, s100, 1
    s_cmp_gt_u32 s100, 20000
    s_waitcnt vmcnt(0)
    s_cbranch_scc1 G2_OK5
    v_max3_u32 v2, v136, v138, v140
    v_max_u32 v2, v2, v142
    v_cmp_eq_u32 vcc, -1, v2
    s_cbranch_vccnz G2_R5
    s_branch G2_OK5
G2_R6:
    s_sleep 3
    buffer_load_dwordx4 v[144:147], v0, s[28:31], s92 offen offset:2048 sc1
    buffer_load_dwordx4 v[148:151], v31, s[28:31], s92 offen offset:2048 sc1
    buffer_load_dwordx4 v[152:155], v0, s[28:31], s4 offen offset:0 sc1
    buffer_load_dwordx4 v[156:159], v31, s[28:31], s4 offen offset:0 sc1
    buffer_load_dwordx4 v[96:99], v0, s[28:31], s4 offen offset:1024 sc1
    buffer_load_dwordx4 v[100:103], v31, s[28:31], s4 offen offset:1024 sc1
    buffer_load_dwordx4 v[104:107], v0, s[28:31], s4 offen offset:2048 sc1
    buffer_load_dwordx4 v[108:111], v31, s[28:31], s4 offen offset:2048 sc1
    buffer_load_dwordx4 v[112:115], v0, s[28:31], s4 offen offset:3072 sc1
    buffer_load_dwordx4 v[116:119], v31, s[28:31], s4 offen offset:3072 sc1
    s_add_u32 s100, s100, 1
    s_cmp_gt_u32 s100, 20000
    s_waitcnt vmcnt(0)
    s_cbranch_scc1 G2_OK6
    v_max3_u32 v2, v144, v146, v148
    v_max_u32 v2, v2, v150
    v_cmp_eq_u32 vcc, -1, v2
    s_cbranch_vccnz G2_R6
    s_branch G2_OK6
G2_R7:
TC3:
    s_cbranch_execz TC_END
    s_sleep 3
    buffer_load_dwordx4 v[152:155], v0, s[28:31], s4 offen offset:0 sc1
    buffer_load_dwordx4 v[156:159], v31, s[28:31], s4 offen offset:0 sc1
    buffer_load_dwordx4 v[96:99], v0, s[28:31], s4 offen offset:1024 sc1
    buffer_load_dwordx4 v[100:103], v31, s[28:31], s4 offen offset:1024 sc1
    buffer_load_dwordx4 v[104:107], v0, s[28:31], s4 offen offset:2048 sc1
    buffer_load_dwordx4 v[108:111], v31, s[28:31], s4 offen offset:2048 sc1
    buffer_load_dwordx4 v[112:115], v0, s[28:31], s4 offen offset:3072 sc1
    buffer_load_dwordx4 v[116:119], v31, s[28:31], s4 offen offset:3072 sc1
    buffer_load_dwordx4 v[120:123], v0, s[28:31], s6 offen offset:0 sc1
    buffer_load_dwordx4 v[124:127], v31, s[28:31], s6 offen offset:0 sc1
    s_add_u32 s100, s100, 1
    s_cmp_gt_u32 s100, 20000
    s_waitcnt vmcnt(0)
    s_cbranch_scc1 G2_OK7
    v_max3_u32 v2, v152, v154, v156
    v_max_u32 v2, v2, v158
    v_cmp_eq_u32 vcc, -1, v2
    s_cbranch_vccnz G2_R7
    s_branch G2_OK7
G2_R8:
    s_sleep 3
    buffer_load_dwordx4 v[96:99], v0, s[28:31], s4 offen offset:1024 sc1
    buffer_load_dwordx4 v[100:103], v31, s[28:31], s4 offen offset:1024 sc1
    buffer_load_dwordx4 v[104:107], v0, s[28:31], s4 offen offset:2048 sc1
    buffer_load_dwordx4 v[108:111], v31, s[28:31], s4 offen offset:2048 sc1
    buffer_load_dwordx4 v[112:115], v0, s[28:31], s4 offen offset:3072 sc1
    buffer_load_dwordx4 v[116:119], v31, s[28:31], s4 offen offset:3072 sc1
    buffer_load_dwordx4 v[120:123], v0, s[28:31], s6 offen offset:0 sc1
    buffer_load_dwordx4 v[124:127], v31, s[28:31], s6 offen offset:0 sc1
    buffer_load_dwordx4 v[128:131], v0, s[28:31], s6 offen offset:1024 sc1
    buffer_load_dwordx4 v[132:135], v31, s[28:31], s6 offen offset:1024 sc1
    s_add_u32 s100, s100, 1
    s_cmp_gt_u32 s100, 20000
    s_waitcnt vmcnt(0)
    s_cbranch_scc1 G2_OK8
    v_max3_u32 v2, v96, v98, v100
    v_max_u32 v2, v2, v102
    v_cmp_eq_u32 vcc, -1, v2
    s_cbranch_vccnz G2_R8
    s_branch G2_OK8
G2_R9:
    s_sleep 3
    buffer_load_dwordx4 v[104:107], v0, s[28:31], s4 offen offset:2048 sc1
    buffer_load_dwordx4 v[108:111], v31, s[28:31], s4 offen offset:2048 sc1
    buffer_load_dwordx4 v[112:115], v0, s[28:31], s4 offen offset:3072 sc1
    buffer_load_dwordx4 v[116:119], v31, s[28:31], s4 offen offset:3072 sc1
    buffer_load_dwordx4 v[120:123], v0, s[28:31], s6 offen offset:0 sc1
    buffer_load_dwordx4 v[124:127], v31, s[28:31], s6 offen offset:0 sc1
    buffer_load_dwordx4 v[128:131], v0, s[28:31], s6 offen offset:1024 sc1
    buffer_load_dwordx4 v[132:135], v31, s[28:31], s6 offen offset:1024 sc1
    buffer_load_dwordx4 v[136:139], v0, s[28:31], s6 offen offset:2048 sc1
    buffer_load_dwordx4 v[140:143], v31, s[28:31], s6 offen offset:2048 sc1
    s_add_u32 s100, s100, 1
    s_cmp_gt_u32 s100, 20000
    s_waitcnt vmcnt(0)
    s_cbranch_scc1 G2_OK9
    v_max3_u32 v2, v104, v106, v108
    v_max_u32 v2, v2, v110
    v_cmp_eq_u32 vcc, -1, v2
    s_cbranch_vccnz G2_R9
    s_branch G2_OK9
G2_ZL:
    s_waitcnt lgkmcnt(0)
    v_and_b32 v2, v2, v3
    v_cmp_ne_u32 vcc, 0x01010101, v2
    s_cbranch_vccz G2_ZLOK
G2_ZLR:
    s_add_u32 s100, s100, 1
    s_cmp_gt_u32 s100, 200000
    s_cbranch_scc1 G2_ZLOK
    s_sleep 1
    ds_read_b64 v[2:3], v19 offset:0
    s_branch G2_ZL
G2_R10:
    s_sleep 3
    buffer_load_dwordx4 v[112:115], v0, s[28:31], s4 offen offset:3072 sc1
    buffer_load_dwordx4 v[116:119], v31, s[28:31], s4 offen offset:3072 sc1
    buffer_load_dwordx4 v[120:123], v0, s[28:31], s6 offen offset:0 sc1
    buffer_load_dwordx4 v[124:127], v31, s[28:31], s6 offen offset:0 sc1
    buffer_load_dwordx4 v[128:131], v0, s[28:31], s6 offen offset:1024 sc1
    buffer_load_dwordx4 v[132:135], v31, s[28:31], s6 offen offset:1024 sc1
    buffer_load_dwordx4 v[136:139], v0, s[28:31], s6 offen offset:2048 sc1
    buffer_load_dwordx4 v[140:143], v31, s[28:31], s6 offen offset:2048 sc1
    s_add_u32 s100, s100, 1
    s_cmp_gt_u32 s100, 20000
    s_waitcnt vmcnt(0)
    s_cbranch_scc1 G2_OK10
    v_max3_u32 v2, v112, v114, v116
    v_max_u32 v2, v2, v118
    v_cmp_eq_u32 vcc, -1, v2
    s_cbranch_vccnz G2_R10
    s_branch G2_OK10
G2_R11:
    s_sleep 3
    buffer_load_dwordx4 v[120:123], v0, s[28:31], s6 offen offset:0 sc1
    buffer_load_dwordx4 v[124:127], v31, s[28:31], s6 offen offset:0 sc1
    buffer_load_dwordx4 v[128:131], v0, s[28:31], s6 offen offset:1024 sc1
    buffer_load_dwordx4 v[132:135], v31, s[28:31], s6 offen offset:1024 sc1
    buffer_load_dwordx4 v[136:139], v0, s[28:31], s6 offen offset:2048 sc1
    buffer_load_dwordx4 v[140:143], v31, s[28:31], s6 offen offset:2048 sc1
    s_add_u32 s100, s100, 1
    s_cmp_gt_u32 s100, 20000
    s_waitcnt vmcnt(0)
    s_cbranch_scc1 G2_OK11
    v_max3_u32 v2, v120, v122, v124
    v_max_u32 v2, v2, v126
    v_cmp_eq_u32 vcc, -1, v2
    s_cbranch_vccnz G2_R11
    s_branch G2_OK11
G2_R12:
    s_sleep 3
    buffer_load_dwordx4 v[128:131], v0, s[28:31], s6 offen offset:1024 sc1
    buffer_load_dwordx4 v[132:135], v31, s[28:31], s6 offen offset:1024 sc1
    buffer_load_dwordx4 v[136:139], v0, s[28:31], s6 offen offset:2048 sc1
    buffer_load_dwordx4 v[140:143], v31, s[28:31], s6 offen offset:2048 sc1
    buffer_load_dwordx4 v[144:147], v0, s[28:31], s93 offen offset:0 sc1
    buffer_load_dwordx4 v[148:151], v31, s[28:31], s93 offen offset:0 sc1
    buffer_load_dwordx4 v[152:155], v0, s[28:31], s7 offen offset:0 sc1
    buffer_load_dwordx4 v[156:159], v31, s[28:31], s7 offen offset:0 sc1
    s_add_u32 s100, s100, 1
    s_cmp_gt_u32 s100, 20000
    s_waitcnt vmcnt(0)
    s_cbranch_scc1 G2_OK12
    v_max3_u32 v2, v128, v130, v132
    v_max_u32 v2, v2, v134
    v_cmp_eq_u32 vcc, -1, v2
    s_cbranch_vccnz G2_R12
    s_branch G2_OK12
G2_R13:
    s_sleep 3
    buffer_load_dwordx4 v[136:139], v0, s[28:31], s6 offen offset:2048 sc1
    buffer_load_dwordx4 v[140:143], v31, s[28:31], s6 offen offset:2048 sc1
    buffer_load_dwordx4 v[144:147], v0, s[28:31], s93 offen offset:0 sc1
    buffer_load_dwordx4 v[148:151], v31, s[28:31], s93 offen offset:0 sc1
    buffer_load_dwordx4 v[152:155], v0, s[28:31], s7 offen offset:0 sc1
    buffer_load_dwordx4 v[156:159], v31, s[28:31], s7 offen offset:0 sc1
    buffer_load_dwordx4 v[96:99], v0, s[28:31], s93 offen offset:1024 sc1
    buffer_load_dwordx4 v[100:103], v31, s[28:31], s93 offen offset:1024 sc1
    buffer_load_dwordx4 v[104:107], v0, s[28:31], s7 offen offset:1024 sc1
    buffer_load_dwordx4 v[108:111], v31, s[28:31], s7 offen offset:1024 sc1
    s_add_u32 s100, s100, 1
    s_cmp_gt_u32 s100, 20000
    s_waitcnt vmcnt(0)
    s_cbranch_scc1 G2_OK13
    v_max3_u32 v2, v136, v138, v140
    v_max_u32 v2, v2, v142
    v_cmp_eq_u32 vcc, -1, v2
    s_cbranch_vccnz G2_R13
    s_branch G2_OK13
G2_R14:
TC4:
    s_cbranch_execz TC5
    s_sleep 3
    buffer_load_dwordx4 v[144:147], v0, s[28:31], s93 offen offset:0 sc1
    buffer_load_dwordx4 v[148:151], v31, s[28:31], s93 offen offset:0 sc1
    buffer_load_dwordx4 v[152:155], v0, s[28:31], s7 offen offset:0 sc1
    buffer_load_dwordx4 v[156:159], v31, s[28:31], s7 offen offset:0 sc1
    buffer_load_dwordx4 v[96:99], v0, s[28:31], s93 offen offset:1024 sc1
    buffer_load_dwordx4 v[100:103], v31, s[28:31], s93 offen offset:1024 sc1
    buffer_load_dwordx4 v[104:107], v0, s[28:31], s7 offen offset:1024 sc1
    buffer_load_dwordx4 v[108:111], v31, s[28:31], s7 offen offset:1024 sc1
    buffer_load_dwordx4 v[112:115], v0, s[28:31], s92 offen offset:3072 sc1
    buffer_load_dwordx4 v[116:119], v31, s[28:31], s92 offen offset:3072 sc1
    s_add_u32 s100, s100, 1
    s_cmp_gt_u32 s100, 20000
    s_waitcnt vmcnt(0)
    s_cbranch_scc1 G2_OK14
    v_max3_u32 v2, v144, v146, v148
    v_max_u32 v2, v2, v150
    v_cmp_eq_u32 vcc, -1, v2
    s_cbranch_vccnz G2_R14
    s_branch G2_OK14
G2_R15:
    s_sleep 3
    buffer_load_dwordx4 v[152:155], v0, s[28:31], s7 offen offset:0 sc1
    buffer_load_dwordx4 v[156:159], v31, s[28:31], s7 offen offset:0 sc1
    buffer_load_dwordx4 v[96:99], v0, s[28:31], s93 offen offset:1024 sc1
    buffer_load_dwordx4 v[100:103], v31, s[28:31], s93 offen offset:1024 sc1
    buffer_load_dwordx4 v[104:107], v0, s[28:31], s7 offen offset:1024 sc1
    buffer_load_dwordx4 v[108:111], v31, s[28:31], s7 offen offset:1024 sc1
    buffer_load_dwordx4 v[112:115], v0, s[28:31], s92 offen offset:3072 sc1
    buffer_load_dwordx4 v[116:119], v31, s[28:31], s92 offen offset:3072 sc1
    buffer_load_dwordx4 v[120:123], v0, s[28:31], s6 offen offset:3072 sc1
    buffer_load_dwordx4 v[124:127], v31, s[28:31], s6 offen offset:3072 sc1
    s_add_u32 s100, s100, 1
    s_cmp_gt_u32 s100, 20000
    s_waitcnt vmcnt(0)
    s_cbranch_scc1 G2_OK15
    v_max3_u32 v2, v152, v154, v156
    v_max_u32 v2, v2, v158
    v_cmp_eq_u32 vcc, -1, v2
    s_cbranch_vccnz G2_R15
    s_branch G2_OK15
G2_R16:
    s_sleep 3
    buffer_load_dwordx4 v[96:99], v0, s[28:31], s93 offen offset:1024 sc1
    buffer_load_dwordx4 v[100:103], v31, s[28:31], s93 offen offset:1024 sc1
    buffer_load_dwordx4 v[104:107], v0, s[28:31], s7 offen offset:1024 sc1
    buffer_load_dwordx4 v[108:111], v31, s[28:31], s7 offen offset:1024 sc1
    buffer_load_dwordx4 v[112:115], v0, s[28:31], s92 offen offset:3072 sc1
    buffer_load_dwordx4 v[116:119], v31, s[28:31], s92 offen offset:3072 sc1
    buffer_load_dwordx4 v[120:123], v0, s[28:31], s6 offen offset:3072 sc1
    buffer_load_dwordx4 v[124:127], v31, s[28:31], s6 offen offset:3072 sc1
    s_add_u32 s100, s100, 1
    s_cmp_gt_u32 s100, 20000
    s_waitcnt vmcnt(0)
    s_cbranch_scc1 G2_OK16
    v_max3_u32 v2, v96, v98, v100
    v_max_u32 v2, v2, v102
    v_cmp_eq_u32 vcc, -1, v2
    s_cbranch_vccnz G2_R16
    s_branch G2_OK16
G2_R17:
    s_sleep 3
    buffer_load_dwordx4 v[104:107], v0, s[28:31], s7 offen offset:1024 sc1
    buffer_load_dwordx4 v[108:111], v31, s[28:31], s7 offen offset:1024 sc1
    buffer_load_dwordx4 v[112:115], v0, s[28:31], s92 offen offset:3072 sc1
    buffer_load_dwordx4 v[116:119], v31, s[28:31], s92 offen offset:3072 sc1
    buffer_load_dwordx4 v[120:123], v0, s[28:31], s6 offen offset:3072 sc1
    buffer_load_dwordx4 v[124:127], v31, s[28:31], s6 offen offset:3072 sc1
    s_add_u32 s100, s100, 1
    s_cmp_gt_u32 s100, 20000
    s_waitcnt vmcnt(0)
    s_cbranch_scc1 G2_OK17
    v_max3_u32 v2, v104, v106, v108
    v_max_u32 v2, v2, v110
    v_cmp_eq_u32 vcc, -1, v2
    s_cbranch_vccnz G2_R17
    s_branch G2_OK17
G2_R18:
    s_sleep 3
    buffer_load_dwordx4 v[112:115], v0, s[28:31], s92 offen offset:3072 sc1
    buffer_load_dwordx4 v[116:119], v31, s[28:31], s92 offen offset:3072 sc1
    buffer_load_dwordx4 v[120:123], v0, s[28:31], s6 offen offset:3072 sc1
    buffer_load_dwordx4 v[124:127], v31, s[28:31], s6 offen offset:3072 sc1
    s_add_u32 s100, s100, 1
    s_cmp_gt_u32 s100, 20000
    s_waitcnt vmcnt(0)
    s_cbranch_scc1 G2_OK18
    v_max3_u32 v2, v112, v114, v116
    v_max_u32 v2, v2, v118
    v_cmp_eq_u32 vcc, -1, v2
    s_cbranch_vccnz G2_R18
    s_branch G2_OK18
G2_ZG:
    s_waitcnt lgkmcnt(0)
    v_and_b32 v2, v2, v3
    v_cmp_ne_u32 vcc, 0x01010101, v2
    s_cbranch_vccz G2_ZGOK
G2_ZGR:
    s_add_u32 s100, s100, 1
    s_cmp_gt_u32 s100, 200000
    s_cbranch_scc1 G2_ZGOK
    s_sleep 1
    ds_read_b64 v[2:3], v19 offset:8
    s_branch G2_ZG
G2_R19:
    s_sleep 3
    buffer_load_dwordx4 v[120:123], v0, s[28:31], s6 offen offset:3072 sc1
    buffer_load_dwordx4 v[124:127], v31, s[28:31], s6 offen offset:3072 sc1
    s_add_u32 s100, s100, 1
    s_cmp_gt_u32 s100, 20000
    s_waitcnt vmcnt(0)
    s_cbranch_scc1 G2_OK19
    v_max3_u32 v2, v120, v122, v124
    v_max_u32 v2, v2, v126
    v_cmp_eq_u32 vcc, -1, v2
    s_cbranch_vccnz G2_R19
    s_branch G2_OK19
P_ZR:
    s_add_u32 s100, s100, 1
    s_cmp_gt_u32 s100, 200000
    s_cbranch_scc1 P_ZOK
    s_sleep 1
    ds_read_b64 v[2:3], v19 offset:0
    s_branch P_Z
L_RC_RETRY:
    s_add_u32 s100, s100, 1
    s_cmp_gt_u32 s100, 20000
    s_cbranch_scc1 L_RC_OK
    s_sleep 4
    s_mul_i32 s60, s59, 448
    s_add_u32 m0, s60, 161536
    s_mov_b64 exec, 0xfffffff
    buffer_load_dwordx4 v81, s[28:31], 0 offen sc1 lds
    s_mov_b64 exec, -1
    s_waitcnt vmcnt(0)
    ds_read_b128 v[84:87], v82
    s_waitcnt lgkmcnt(0)
    s_waitcnt vmcnt(0)
    s_branch L_RC_CHK
L_FL_RETRY:
    s_add_u32 s100, s100, 1
    s_cmp_gt_u32 s100, 20000
    s_cbranch_scc1 L_FL_OK
    s_sleep 8
    s_mov_b64 exec, 1
    buffer_load_dwordx4 v[112:115], v6, s[28:31], 0 offen offset:256 sc1
    s_waitcnt vmcnt(0)
    s_branch L_FL_CHK
AL_MB_RETRY:
    s_add_u32 s100, s100, 1
    s_cmp_gt_u32 s100, 20000
    s_cbranch_scc1 AL_MB_OK
    s_sleep 6
    buffer_load_dwordx4 v[136:139], v6, s[28:31], s12 offen offset:0 sc1
    buffer_load_dwordx4 v[140:143], v6, s[28:31], s12 offen offset:1024 sc1
    buffer_load_dwordx4 v[144:147], v6, s[28:31], s12 offen offset:2048 sc1
    buffer_load_dwordx4 v[148:151], v6, s[28:31], s12 offen offset:3072 sc1
    s_waitcnt vmcnt(0)
    s_branch AL_MB_CHK
K_AUX0:
    s_sub_u32 s56, s2, 200
K_AUX:
    s_lshr_b32 s3, s3, 6
    s_and_b32 s59, s3, 3
    s_mov_b32 s55, 0xffff0000
    s_mov_b32 s100, 0
    v_and_b32 v1, 63, v0
    v_and_b32 v4, 15, v1
    v_lshrrev_b32 v5, 4, v1
    v_mov_b32 v19, 163584
    v_add_u32 v18, s3, v19
    s_mov_b32 s30, 7077888
    s_mov_b32 s31, 0x20000
    s_cmp_ge_u32 s3, 4
    s_cbranch_scc1 K_FC
    s_cmp_lg_u32 s101, 5
    s_cbranch_scc1 FL_SPARE
    s_waitcnt vmcnt(16)
    s_barrier
    s_mov_b32 s70, 4
FL_GU1b:
    s_mov_b32 m0, s69
    s_sub_u32 s70, s70, 1
    buffer_load_dwordx4 v30, s[48:51], s68 offen nt lds
    s_add_u32 m0, s69, 16384
    s_add_u32 s69, s69, 4096
    buffer_load_dwordx4 v30, s[36:39], s68 offen nt lds
    s_add_u32 s68, s68, 110592
    s_and_b32 s60, s70, 3
    s_cselect_b32 s60, 0, 16384
    s_add_u32 s69, s69, s60
    s_cmp_lg_u32 s70, 0
    s_cbranch_scc1 FL_GU1b
    s_barrier
    s_lshl_b32 s69, s59, 10
    s_add_u32 m0, s69, 0
    s_nop 0
    buffer_load_dwordx4 v30, s[48:51], s68 offen nt lds
    s_add_u32 m0, s69, 16384
    s_nop 0
    buffer_load_dwordx4 v30, s[36:39], s68 offen nt lds
    s_add_u32 s68, s68, 110592
    s_add_u32 m0, s69, 4096
    s_nop 0
    buffer_load_dwordx4 v30, s[48:51], s68 offen nt lds
    s_add_u32 m0, s69, 20480
    s_nop 0
    buffer_load_dwordx4 v30, s[36:39], s68 offen nt lds
    s_add_u32 s68, s68, 110592
    s_add_u32 m0, s69, 8192
    s_nop 0
    buffer_load_dwordx4 v30, s[48:51], s68 offen nt lds
    s_add_u32 m0, s69, 24576
    s_nop 0
    buffer_load_dwordx4 v30, s[36:39], s68 offen nt lds
    s_add_u32 s68, s68, 110592
    s_waitcnt vmcnt(14)
    s_barrier
    s_add_u32 m0, s69, 12288
    s_nop 0
    buffer_load_dwordx4 v30, s[48:51], s68 offen nt lds
    s_add_u32 m0, s69, 28672
    s_nop 0
    buffer_load_dwordx4 v30, s[36:39], s68 offen nt lds
    s_add_u32 s68, s68, 110592
    s_waitcnt vmcnt(0)
    s_barrier
    s_branch K_END
FL_SPARE:
    s_waitcnt lgkmcnt(0)
    s_load_dwordx2 s[48:49], s[0:1], 56
    s_load_dwordx2 s[40:41], s[0:1], 16
    s_mov_b32 s42, 819200
    s_mov_b32 s43, 0x20000
    s_and_b32 s60, s59, 2
    s_lshl_b32 s60, s60, 2
    v_lshl_or_b32 v2, v5, 1, s60
    v_xor_b32 v2, v2, v1
    v_and_b32 v2, 15, v2
    v_lshrrev_b32 v31, 4, v0
    v_mul_u32_u24 v31, 1280, v31
    v_lshl_add_u32 v31, v2, 4, v31
    s_sub_u32 s61, s56, 27
    s_mul_i32 s61, s61, 81920
    v_add_u32 v31, s61, v31
    s_lshl_b32 s63, s59, 10
    s_mov_b32 s50, 2211840
    s_mov_b32 s51, 0x20000
    s_waitcnt lgkmcnt(0)
    s_sleep 30
    s_lshl3_add_u32 s60, s56, s3
    s_lshl_b32 s60, s60, 10
    s_add_u32 s60, s60, 827392
    v_mov_b32 v108, -1
    v_mov_b32 v109, -1
    v_mov_b32 v110, -1
    v_mov_b32 v111, -1
    v_lshlrev_b32 v15, 4, v1
FL_CLR:
    buffer_store_dwordx4 v[108:111], v15, s[28:31], s60 offen sc1
    s_add_u32 s60, s60, 237568
    s_cmp_lt_u32 s60, 3977216
    s_cbranch_scc1 FL_CLR
    s_waitcnt vmcnt(0)
    s_barrier
    s_add_u32 m0, s63, 0
    s_mov_b32 s60, 0
    buffer_load_dwordx4 v31, s[48:51], s60 offen nt lds
    s_add_u32 m0, s63, 4096
    s_mov_b32 s60, 20480
    buffer_load_dwordx4 v31, s[48:51], s60 offen nt lds
    s_add_u32 m0, s63, 8192
    s_mov_b32 s60, 40960
    buffer_load_dwordx4 v31, s[48:51], s60 offen nt lds
    s_add_u32 m0, s63, 12288
    s_mov_b32 s60, 61440
    buffer_load_dwordx4 v31, s[48:51], s60 offen nt lds
    s_add_u32 m0, s63, 16384
    s_mov_b32 s60, 256
    buffer_load_dwordx4 v31, s[48:51], s60 offen nt lds
    s_add_u32 m0, s63, 20480
    s_mov_b32 s60, 20736
    buffer_load_dwordx4 v31, s[48:51], s60 offen nt lds
    s_add_u32 m0, s63, 24576
    s_mov_b32 s60, 41216
    buffer_load_dwordx4 v31, s[48:51], s60 offen nt lds
    s_add_u32 m0, s63, 28672
    s_mov_b32 s60, 61696
    buffer_load_dwordx4 v31, s[48:51], s60 offen nt lds
    s_add_u32 m0, s63, 32768
    s_mov_b32 s60, 512
    buffer_load_dwordx4 v31, s[48:51], s60 offen nt lds
    s_add_u32 m0, s63, 36864
    s_mov_b32 s60, 20992
    buffer_load_dwordx4 v31, s[48:51], s60 offen nt lds
    s_add_u32 m0, s63, 40960
    s_mov_b32 s60, 41472
    buffer_load_dwordx4 v31, s[48:51], s60 offen nt lds
    s_add_u32 m0, s63, 45056
    s_mov_b32 s60, 61952
    buffer_load_dwordx4 v31, s[48:51], s60 offen nt lds
    s_add_u32 m0, s63, 49152
    s_mov_b32 s60, 768
    buffer_load_dwordx4 v31, s[48:51], s60 offen nt lds
    s_add_u32 m0, s63, 53248
    s_mov_b32 s60, 21248
    buffer_load_dwordx4 v31, s[48:51], s60 offen nt lds
    s_add_u32 m0, s63, 57344
    s_mov_b32 s60, 41728
    buffer_load_dwordx4 v31, s[48:51], s60 offen nt lds
    s_add_u32 m0, s63, 61440
    s_mov_b32 s60, 62208
    buffer_load_dwordx4 v31, s[48:51], s60 offen nt lds
    s_add_u32 m0, s63, 65536
    s_mov_b32 s60, 1024
    buffer_load_dwordx4 v31, s[48:51], s60 offen nt lds
    s_add_u32 m0, s63, 69632
    s_mov_b32 s60, 21504
    buffer_load_dwordx4 v31, s[48:51], s60 offen nt lds
    s_add_u32 m0, s63, 73728
    s_mov_b32 s60, 41984
    buffer_load_dwordx4 v31, s[48:51], s60 offen nt lds
    s_add_u32 m0, s63, 77824
    s_mov_b32 s60, 62464
    buffer_load_dwordx4 v31, s[48:51], s60 offen nt lds
    s_sub_u32 s60, s56, 27
    s_mul_i32 s60, s60, 28672
    v_lshlrev_b32 v30, 4, v0
    s_add_u32 m0, s63, 81920
    s_nop 0
    buffer_load_dwordx4 v30, s[40:43], s60 offen lds
    s_add_u32 s60, s60, 4096
    buffer_load_dwordx4 v30, s[40:43], s60 offen lds
    s_add_u32 s60, s60, 4096
    buffer_load_dwordx4 v30, s[40:43], s60 offen lds
    s_add_u32 s60, s60, 4096
    buffer_load_dwordx4 v30, s[40:43], s60 offen lds
    s_add_u32 s60, s60, 4096
    buffer_load_dwordx4 v30, s[40:43], s60 offen lds
    s_add_u32 s60, s60, 4096
    buffer_load_dwordx4 v30, s[40:43], s60 offen lds
    s_add_u32 s60, s60, 4096
    buffer_load_dwordx4 v30, s[40:43], s60 offen lds
    s_add_u32 s60, s60, 4096
    s_waitcnt vmcnt(7)
    s_barrier
    s_branch K_END
K_FC:
    s_waitcnt lgkmcnt(0)
    v_mov_b32 v241, 0x3f803f80
    s_mul_i32 s52, s52, 0x9E3779B1
    s_add_u32 s52, s52, 0x7F4A7C15
    s_or_b32 s52, s52, 1
    v_mov_b32 v245, s52
    v_mov_b32 v247, s52
    s_bfe_u32 s60, s2, 0x10002
    s_lshl4_add_u32 s60, s68, s60
    s_sub_u32 s60, 0xffff, s60
    v_lshlrev_b32 v239, 1, v232
    v_sub_u32 v239, s60, v239
    v_lshlrev_b32 v243, 3, v232
    v_lshlrev_b32 v232, 4, v232
    v_mov_b32 v249, s52
    s_setprio 3
    s_waitcnt vmcnt(3)
    v_dot2_f32_bf16 v233, v212, v241, 0
    v_dot2_f32_bf16 v234, v212, v212, 0
    v_dot2_f32_bf16 v233, v213, v241, v233
    v_dot2_f32_bf16 v234, v213, v213, v234
    v_dot2_f32_bf16 v233, v214, v241, v233
    v_dot2_f32_bf16 v234, v214, v214, v234
    v_dot2_f32_bf16 v233, v215, v241, v233
    v_dot2_f32_bf16 v234, v215, v215, v234
    v_dot2_f32_bf16 v233, v216, v241, v233
    v_dot2_f32_bf16 v234, v216, v216, v234
    v_dot2_f32_bf16 v233, v217, v241, v233
    v_dot2_f32_bf16 v234, v217, v217, v234
    v_dot2_f32_bf16 v233, v218, v241, v233
    v_dot2_f32_bf16 v234, v218, v218, v234
    v_dot2_f32_bf16 v233, v219, v241, v233
    v_dot2_f32_bf16 v234, v219, v219, v234
    v_dot2_f32_bf16 v233, v220, v241, v233
    v_dot2_f32_bf16 v234, v220, v220, v234
    v_dot2_f32_bf16 v233, v221, v241, v233
    v_dot2_f32_bf16 v234, v221, v221, v234
    s_waitcnt vmcnt(0)
    v_dot2_f32_bf16 v235, v212, v222, 0
    v_dot2_f32_bf16 v236, v222, v241, 0
    v_dot2_f32_bf16 v235, v213, v223, v235
    v_dot2_f32_bf16 v236, v223, v241, v236
    v_dot2_f32_bf16 v235, v214, v224, v235
    v_dot2_f32_bf16 v236, v224, v241, v236
    v_dot2_f32_bf16 v235, v215, v225, v235
    v_dot2_f32_bf16 v236, v225, v241, v236
    v_dot2_f32_bf16 v235, v216, v226, v235
    v_dot2_f32_bf16 v236, v226, v241, v236
    v_dot2_f32_bf16 v235, v217, v227, v235
    v_dot2_f32_bf16 v236, v227, v241, v236
    v_dot2_f32_bf16 v235, v218, v228, v235
    v_dot2_f32_bf16 v236, v228, v241, v236
    v_dot2_f32_bf16 v235, v219, v229, v235
    v_dot2_f32_bf16 v236, v229, v241, v236
    v_dot2_f32_bf16 v235, v220, v230, v235
    v_dot2_f32_bf16 v236, v230, v241, v236
    v_dot2_f32_bf16 v235, v221, v231, v235
    v_dot2_f32_bf16 v236, v231, v241, v236
    v_permlane16_swap_b32 v233, v234
    v_add_f32 v233, v233, v234
    s_nop 0
    v_permlane16_swap_b32 v235, v236
    v_add_f32 v235, v235, v236
    v_add_f32_dpp v233, v233, v233 row_ror:8 row_mask:0xf bank_mask:0xf
    s_nop 0
    v_add_f32_dpp v235, v235, v235 row_ror:8 row_mask:0xf bank_mask:0xf
    v_add_f32_dpp v233, v233, v233 row_ror:4 row_mask:0xf bank_mask:0xf
    s_nop 0
    v_add_f32_dpp v235, v235, v235 row_ror:4 row_mask:0xf bank_mask:0xf
    v_add_f32_dpp v233, v233, v233 row_ror:2 row_mask:0xf bank_mask:0xf
    s_nop 0
    v_add_f32_dpp v235, v235, v235 row_ror:2 row_mask:0xf bank_mask:0xf
    v_add_f32_dpp v233, v233, v233 row_ror:1 row_mask:0xf bank_mask:0xf
    s_nop 0
    v_add_f32_dpp v235, v235, v235 row_ror:1 row_mask:0xf bank_mask:0xf
    v_mul_f32 v233, 0x3acccccd, v233
    v_mov_b32 v236, v235
    v_mov_b32 v234, v233
    s_nop 0
    v_permlane16_swap_b32 v235, v236
    v_permlane16_swap_b32 v233, v234
    v_fma_f32 v234, -v233, v233, v234
    v_max_f32 v234, 0, v234
    v_cvt_pk_bf16_f32 v237, v233, v234
    v_lshlrev_b32 v233, 16, v237
    v_and_b32 v234, 0xffff0000, v237
    v_add_f32 v234, 0x3727c5ac, v234
    v_cvt_pk_bf16_f32 v234, v234, v234
    v_lshlrev_b32 v234, 16, v234
    v_sqrt_f32 v234, v234
    v_fma_f32 v235, -v233, v236, v235
    v_cvt_pk_bf16_f32 v234, v234, v234
    v_lshlrev_b32 v234, 16, v234
    v_rcp_f32 v246, v234
    s_mov_b32 exec_lo, 1
    s_mov_b32 exec_hi, 1
    v_mul_f32 v235, v235, v246
    v_xor_b32 v244, 0x80000000, v233
    v_cvt_pk_bf16_f32 v235, v235, v235
    buffer_store_dwordx4 v[244:247], v232, s[28:31], s70 offen sc1
    v_ashrrev_i32 v237, 31, v235
    v_or_b32 v237, 0x80000000, v237
    v_xor_b32 v235, v235, v237
    v_bfi_b32 v248, s55, v235, v239
    buffer_store_dwordx2 v[248:249], v243, s[28:31], s71 offen sc1
    s_mov_b64 exec, -1
    s_cmp_ge_u32 s56, 27
    s_cbranch_scc1 FC_SPARE
    v_bfe_u32 v7, v1, 2, 2
    v_and_b32 v8, 3, v1
    v_lshl_add_u32 v6, v5, 3, v7
    v_bfe_u32 v2, v1, 3, 2
    v_xor_b32 v2, s59, v2
    v_lshlrev_b32 v9, 5, v2
    v_lshl_add_u32 v9, v8, 3, v9
    v_lshl_add_u32 v9, v6, 7, v9
    v_add_u32 v8, 65536, v9
    v_mov_b32 v176, 0x3f803f80
    v_mov_b32 v177, 0x3f803f80
    v_mov_b32 v178, 0x3f803f80
    v_mov_b32 v179, 0x3f803f80
    v_mov_b32 v180, 0x3f803f80
    v_mov_b32 v181, 0x3f803f80
    v_mov_b32 v182, 0x3f803f80
    v_mov_b32 v183, 0x3f803f80
    v_mov_b32 v184, 0x3f803f80
    v_mov_b32 v185, 0x3f803f80
    v_mov_b32 v186, 0x3f803f80
    v_mov_b32 v187, 0x3f803f80
    v_mov_b32 v188, 0x3f803f80
    v_mov_b32 v189, 0x3f803f80
    v_mov_b32 v190, 0x3f803f80
    v_mov_b32 v191, 0x3f803f80
    v_mov_b32 v192, 0x3f803f80
    v_mov_b32 v193, 0x3f803f80
    v_mov_b32 v194, 0x3f803f80
    v_mov_b32 v195, 0x3f803f80
    v_mov_b32 v196, 0x3f803f80
    v_mov_b32 v197, 0x3f803f80
    v_mov_b32 v198, 0x3f803f80
    v_mov_b32 v199, 0x3f803f80
    v_mov_b32 v200, 0x3f803f80
    v_mov_b32 v201, 0x3f803f80
    v_mov_b32 v202, 0x3f803f80
    v_mov_b32 v203, 0x3f803f80
    v_mov_b32 v204, 0x3f803f80
    v_mov_b32 v205, 0x3f803f80
    v_mov_b32 v206, 0x3f803f80
    v_mov_b32 v207, 0x3f803f80
    v_mov_b32 v208, 0x3f803f80
    v_mov_b32 v209, 0x3f803f80
    v_mov_b32 v210, 0x3f803f80
    v_mov_b32 v211, 0x3f803f80
    v_mov_b32 v212, 0x3f803f80
    v_mov_b32 v213, 0x3f803f80
    v_mov_b32 v214, 0x3f803f80
    v_mov_b32 v215, 0x3f803f80
    v_mov_b32 v216, 0x3f803f80
    v_mov_b32 v217, 0x3f803f80
    v_mov_b32 v218, 0x3f803f80
    v_mov_b32 v219, 0x3f803f80
    v_mov_b32 v220, 0x3f803f80
    v_mov_b32 v221, 0x3f803f80
    v_mov_b32 v222, 0x3f803f80
    v_mov_b32 v223, 0x3f803f80
    v_mov_b32 v224, 0x3f803f80
    v_mov_b32 v225, 0x3f803f80
    v_mov_b32 v226, 0x3f803f80
    v_mov_b32 v227, 0x3f803f80
    v_mov_b32 v228, 0x3f803f80
    v_mov_b32 v229, 0x3f803f80
    v_mov_b32 v230, 0x3f803f80
    v_mov_b32 v231, 0x3f803f80
    v_mov_b32 v232, 0x3f803f80
    v_mov_b32 v233, 0x3f803f80
    v_mov_b32 v234, 0x3f803f80
    v_mov_b32 v235, 0x3f803f80
    v_mov_b32 v236, 0x3f803f80
    v_mov_b32 v237, 0x3f803f80
    v_mov_b32 v238, 0x3f803f80
    v_mov_b32 v239, 0x3f803f80
    v_mov_b32 v240, 0x3f803f80
    v_mov_b32 v241, 0x3f803f80
    v_mov_b32 v242, 0x3f803f80
    v_mov_b32 v243, 0x3f803f80
    v_mov_b32 v244, 0x3f803f80
    v_mov_b32 v245, 0x3f803f80
    v_mov_b32 v246, 0x3f803f80
    v_mov_b32 v247, 0x3f803f80
    v_mov_b32 v248, 0x3f803f80
    v_mov_b32 v249, 0x3f803f80
    v_mov_b32 v250, 0x3f803f80
    v_mov_b32 v251, 0x3f803f80
    v_mov_b32 v252, 0x3f803f80
    v_mov_b32 v253, 0x3f803f80
    v_mov_b32 v254, 0x3f803f80
    v_mov_b32 v255, 0x3f803f80
    s_lshl2_add_u32 s65, s56, s59
    v_bfe_i32 v17, v1, 0, 1
    v_bfe_u32 v6, v0, 4, 4
    v_lshlrev_b32 v6, 3, v6
    v_add_u32 v6, 157952, v6
    v_lshlrev_b32 v7, 3, v4
    v_add_u32 v7, 157952, v7
    s_barrier
    v_lshlrev_b32 v12, 4, v1
    s_lshl_b32 s62, s59, 12
    s_add_u32 s60, s62, 49152
    buffer_load_dwordx4 v[120:123], v12, s[28:31], s60 offen offset:0 sc1
    buffer_load_dwordx4 v[124:127], v12, s[28:31], s60 offen offset:1024 sc1
    buffer_load_dwordx4 v[128:131], v12, s[28:31], s60 offen offset:2048 sc1
    buffer_load_dwordx4 v[132:135], v12, s[28:31], s60 offen offset:3072 sc1
    ds_read_b64_tr_b16 v[24:25], v9 offset:0
    ds_read_b64_tr_b16 v[26:27], v9 offset:512
    ds_read_b64_tr_b16 v[72:73], v9 offset:16384
    ds_read_b64_tr_b16 v[74:75], v9 offset:16896
    ds_read_b64_tr_b16 v[28:29], v9 offset:4096
    ds_read_b64_tr_b16 v[30:31], v9 offset:4608
    ds_read_b64_tr_b16 v[76:77], v9 offset:20480
    ds_read_b64_tr_b16 v[78:79], v9 offset:20992
    ds_read_b64_tr_b16 v[32:33], v9 offset:8192
    ds_read_b64_tr_b16 v[34:35], v9 offset:8704
    ds_read_b64_tr_b16 v[80:81], v9 offset:24576
    ds_read_b64_tr_b16 v[82:83], v9 offset:25088
    ds_read_b64_tr_b16 v[36:37], v9 offset:12288
    ds_read_b64_tr_b16 v[38:39], v9 offset:12800
    ds_read_b64_tr_b16 v[84:85], v9 offset:28672
    ds_read_b64_tr_b16 v[86:87], v9 offset:29184
    s_waitcnt lgkmcnt(0)
    s_barrier
    s_waitcnt vmcnt(0)
FC_KY_CHK:
    v_xor_b32 v2, s52, v121
    v_bitop3_b32 v2, v123, s52, v2 bitop3:0xbe
    v_bitop3_b32 v2, v125, s52, v2 bitop3:0xbe
    v_bitop3_b32 v2, v127, s52, v2 bitop3:0xbe
    v_bitop3_b32 v2, v129, s52, v2 bitop3:0xbe
    v_bitop3_b32 v2, v131, s52, v2 bitop3:0xbe
    v_bitop3_b32 v2, v133, s52, v2 bitop3:0xbe
    v_bitop3_b32 v2, v135, s52, v2 bitop3:0xbe
    v_cmp_ne_u32 vcc, 0, v2
    s_cbranch_vccz FC_KY_OK
FC_KY_RETRY:
    s_add_u32 s100, s100, 1
    s_cmp_gt_u32 s100, 20000
    s_cbranch_scc1 FC_KY_OK
    s_sleep 16
    s_add_u32 s60, s62, 49152
    buffer_load_dwordx4 v[120:123], v12, s[28:31], s60 offen offset:0 sc1
    buffer_load_dwordx4 v[124:127], v12, s[28:31], s60 offen offset:1024 sc1
    buffer_load_dwordx4 v[128:131], v12, s[28:31], s60 offen offset:2048 sc1
    buffer_load_dwordx4 v[132:135], v12, s[28:31], s60 offen offset:3072 sc1
    s_waitcnt vmcnt(0)
    s_branch FC_KY_CHK
FC_KY_OK:
    v_max_u32 v20, v120, v122
    v_min_u32 v21, v120, v122
    v_med3_u32 v21, v20, v21, v124
    v_max_u32 v20, v20, v124
    v_med3_u32 v21, v20, v21, v126
    v_max_u32 v20, v20, v126
    v_med3_u32 v21, v20, v21, v128
    v_max_u32 v20, v20, v128
    v_med3_u32 v21, v20, v21, v130
    v_max_u32 v20, v20, v130
    v_med3_u32 v21, v20, v21, v132
    v_max_u32 v20, v20, v132
    v_med3_u32 v21, v20, v21, v134
    v_max_u32 v20, v20, v134
    s_nop 1
    v_mov_b32_dpp v22, v20 row_ror:8 row_mask:0xf bank_mask:0xf
    v_mov_b32_dpp v23, v21 row_ror:8 row_mask:0xf bank_mask:0xf
    v_min_u32 v2, v20, v22
    v_max_u32 v20, v20, v22
    v_max3_u32 v21, v21, v23, v2
    s_nop 0
    v_mov_b32_dpp v22, v20 row_ror:4 row_mask:0xf bank_mask:0xf
    v_mov_b32_dpp v23, v21 row_ror:4 row_mask:0xf bank_mask:0xf
    v_min_u32 v2, v20, v22
    v_max_u32 v20, v20, v22
    v_max3_u32 v21, v21, v23, v2
    s_nop 0
    v_mov_b32_dpp v22, v20 row_ror:2 row_mask:0xf bank_mask:0xf
    v_mov_b32_dpp v23, v21 row_ror:2 row_mask:0xf bank_mask:0xf
    v_min_u32 v2, v20, v22
    v_max_u32 v20, v20, v22
    v_max3_u32 v21, v21, v23, v2
    s_nop 0
    v_mov_b32_dpp v22, v20 row_ror:1 row_mask:0xf bank_mask:0xf
    v_mov_b32_dpp v23, v21 row_ror:1 row_mask:0xf bank_mask:0xf
    v_min_u32 v2, v20, v22
    v_max_u32 v20, v20, v22
    v_max3_u32 v21, v21, v23, v2
    ds_write_b64 v6, v[20:21]
    s_waitcnt lgkmcnt(0)
    s_barrier
    ds_read_b64 v[20:21], v7
    s_waitcnt lgkmcnt(0)
    v_mov_b32_dpp v22, v20 row_ror:8 row_mask:0xf bank_mask:0xf
    v_mov_b32_dpp v23, v21 row_ror:8 row_mask:0xf bank_mask:0xf
    v_min_u32 v2, v20, v22
    v_max_u32 v20, v20, v22
    v_max3_u32 v21, v21, v23, v2
    s_nop 0
    v_mov_b32_dpp v22, v20 row_ror:4 row_mask:0xf bank_mask:0xf
    v_mov_b32_dpp v23, v21 row_ror:4 row_mask:0xf bank_mask:0xf
    v_min_u32 v2, v20, v22
    v_max_u32 v20, v20, v22
    v_max3_u32 v21, v21, v23, v2
    s_nop 0
    v_mov_b32_dpp v22, v20 row_ror:2 row_mask:0xf bank_mask:0xf
    v_mov_b32_dpp v23, v21 row_ror:2 row_mask:0xf bank_mask:0xf
    v_min_u32 v2, v20, v22
    v_max_u32 v20, v20, v22
    v_max3_u32 v21, v21, v23, v2
    s_nop 0
    v_mov_b32_dpp v22, v20 row_ror:1 row_mask:0xf bank_mask:0xf
    v_mov_b32_dpp v23, v21 row_ror:1 row_mask:0xf bank_mask:0xf
    v_min_u32 v2, v20, v22
    v_max_u32 v20, v20, v22
    v_max3_u32 v21, v21, v23, v2
    v_bfi_b32 v10, v17, v21, v20
    v_not_b32 v2, v10
    v_and_b32 v2, 2047, v2
    v_mul_u32_u24 v17, 1280, v2
    v_lshrrev_b32 v16, 1, v2
    v_and_b32 v3, 1, v2
    v_lshl_add_u32 v16, v3, 10, v16
    v_readlane_b32 s60, v17, 0
    v_readlane_b32 s61, v17, 1
    v_lshlrev_b32 v16, 4, v16
    v_add_u32 v16, 16384, v16
    s_mul_i32 s62, s59, 2624
    s_add_u32 s62, s62, 147456
    s_add_u32 m0, s62, 0
    s_nop 0
    buffer_load_dwordx4 v12, s[24:27], s60 offen lds
    s_add_u32 m0, s62, 1344
    s_nop 0
    buffer_load_dwordx4 v12, s[24:27], s61 offen lds
    s_mov_b64 exec, 0xffff
    s_add_u32 m0, s62, 0
    s_nop 0
    buffer_load_dwordx4 v12, s[24:27], s60 offen offset:1024 lds
    s_add_u32 m0, s62, 1344
    s_nop 0
    buffer_load_dwordx4 v12, s[24:27], s61 offen offset:1024 lds
    s_mov_b32 exec_lo, 0x00030003
    s_mov_b32 exec_hi, 0x00030003
    buffer_load_dwordx4 v[20:23], v16, s[28:31], 0 offen
    s_mov_b64 exec, -1
    v_and_b32 v17, 1, v1
    v_mul_u32_u24 v17, 1344, v17
    v_lshl_add_u32 v17, v5, 4, v17
    v_add_u32 v17, s62, v17
    ds_read_b64_tr_b16 v[40:41], v9 offset:32768
    ds_read_b64_tr_b16 v[42:43], v9 offset:33280
    ds_read_b64_tr_b16 v[88:89], v9 offset:49152
    ds_read_b64_tr_b16 v[90:91], v9 offset:49664
    ds_read_b64_tr_b16 v[44:45], v9 offset:36864
    ds_read_b64_tr_b16 v[46:47], v9 offset:37376
    ds_read_b64_tr_b16 v[92:93], v9 offset:53248
    ds_read_b64_tr_b16 v[94:95], v9 offset:53760
    ds_read_b64_tr_b16 v[48:49], v9 offset:40960
    ds_read_b64_tr_b16 v[50:51], v9 offset:41472
    ds_read_b64_tr_b16 v[96:97], v9 offset:57344
    ds_read_b64_tr_b16 v[98:99], v9 offset:57856
    ds_read_b64_tr_b16 v[52:53], v9 offset:45056
    ds_read_b64_tr_b16 v[54:55], v9 offset:45568
    ds_read_b64_tr_b16 v[100:101], v9 offset:61440
    ds_read_b64_tr_b16 v[102:103], v9 offset:61952
    ds_read_b64_tr_b16 v[56:57], v8 offset:0
    ds_read_b64_tr_b16 v[58:59], v8 offset:512
    ds_read_b64_tr_b16 v[104:105], v8 offset:16384
    ds_read_b64_tr_b16 v[106:107], v8 offset:16896
    ds_read_b64_tr_b16 v[60:61], v8 offset:4096
    ds_read_b64_tr_b16 v[62:63], v8 offset:4608
    ds_read_b64_tr_b16 v[108:109], v8 offset:20480
    ds_read_b64_tr_b16 v[110:111], v8 offset:20992
    ds_read_b64_tr_b16 v[64:65], v8 offset:8192
    ds_read_b64_tr_b16 v[66:67], v8 offset:8704
    ds_read_b64_tr_b16 v[112:113], v8 offset:24576
    ds_read_b64_tr_b16 v[114:115], v8 offset:25088
    ds_read_b64_tr_b16 v[68:69], v8 offset:12288
    ds_read_b64_tr_b16 v[70:71], v8 offset:12800
    ds_read_b64_tr_b16 v[116:117], v8 offset:28672
    ds_read_b64_tr_b16 v[118:119], v8 offset:29184
    s_waitcnt vmcnt(0)
    s_mov_b32 exec_lo, 0x00030003
    s_mov_b32 exec_hi, 0x00030003
    ds_read_b128 v[176:179], v17 offset:0
    ds_read_b128 v[180:183], v17 offset:64
    ds_read_b128 v[184:187], v17 offset:128
    ds_read_b128 v[188:191], v17 offset:192
    ds_read_b128 v[192:195], v17 offset:256
    ds_read_b128 v[196:199], v17 offset:320
    ds_read_b128 v[200:203], v17 offset:384
    ds_read_b128 v[204:207], v17 offset:448
    ds_read_b128 v[208:211], v17 offset:512
    ds_read_b128 v[212:215], v17 offset:576
    ds_read_b128 v[216:219], v17 offset:640
    ds_read_b128 v[220:223], v17 offset:704
    ds_read_b128 v[224:227], v17 offset:768
    ds_read_b128 v[228:231], v17 offset:832
    ds_read_b128 v[232:235], v17 offset:896
    ds_read_b128 v[236:239], v17 offset:960
    ds_read_b128 v[240:243], v17 offset:1024
    ds_read_b128 v[244:247], v17 offset:1088
    ds_read_b128 v[248:251], v17 offset:1152
    ds_read_b128 v[252:255], v17 offset:1216
    s_mov_b64 exec, -1
    s_waitcnt lgkmcnt(15)
    v_mfma_f32_16x16x32_bf16 v[152:155], v[24:27], v[176:179], 0
    v_mfma_f32_16x16x32_bf16 v[156:159], v[72:75], v[176:179], 0
    v_mfma_f32_16x16x32_bf16 v[152:155], v[28:31], v[180:183], v[152:155]
    v_mfma_f32_16x16x32_bf16 v[156:159], v[76:79], v[180:183], v[156:159]
    v_mfma_f32_16x16x32_bf16 v[152:155], v[32:35], v[184:187], v[152:155]
    v_mfma_f32_16x16x32_bf16 v[156:159], v[80:83], v[184:187], v[156:159]
    v_mfma_f32_16x16x32_bf16 v[152:155], v[36:39], v[188:191], v[152:155]
    v_mfma_f32_16x16x32_bf16 v[156:159], v[84:87], v[188:191], v[156:159]
    s_waitcnt lgkmcnt(12)
    v_mfma_f32_16x16x32_bf16 v[152:155], v[40:43], v[192:195], v[152:155]
    v_mfma_f32_16x16x32_bf16 v[156:159], v[88:91], v[192:195], v[156:159]
    v_mfma_f32_16x16x32_bf16 v[152:155], v[44:47], v[196:199], v[152:155]
    v_mfma_f32_16x16x32_bf16 v[156:159], v[92:95], v[196:199], v[156:159]
    v_mfma_f32_16x16x32_bf16 v[152:155], v[48:51], v[200:203], v[152:155]
    v_mfma_f32_16x16x32_bf16 v[156:159], v[96:99], v[200:203], v[156:159]
    v_mfma_f32_16x16x32_bf16 v[152:155], v[52:55], v[204:207], v[152:155]
    v_mfma_f32_16x16x32_bf16 v[156:159], v[100:103], v[204:207], v[156:159]
    s_waitcnt lgkmcnt(8)
    v_mfma_f32_16x16x32_bf16 v[152:155], v[56:59], v[208:211], v[152:155]
    v_mfma_f32_16x16x32_bf16 v[156:159], v[104:107], v[208:211], v[156:159]
    v_mfma_f32_16x16x32_bf16 v[152:155], v[60:63], v[212:215], v[152:155]
    v_mfma_f32_16x16x32_bf16 v[156:159], v[108:111], v[212:215], v[156:159]
    v_mfma_f32_16x16x32_bf16 v[152:155], v[64:67], v[216:219], v[152:155]
    v_mfma_f32_16x16x32_bf16 v[156:159], v[112:115], v[216:219], v[156:159]
    v_mfma_f32_16x16x32_bf16 v[152:155], v[68:71], v[220:223], v[152:155]
    v_mfma_f32_16x16x32_bf16 v[156:159], v[116:119], v[220:223], v[156:159]
    s_barrier
    ds_read_b64_tr_b16 v[120:121], v8 offset:32768
    ds_read_b64_tr_b16 v[122:123], v8 offset:33280
    ds_read_b64_tr_b16 v[136:137], v8 offset:49152
    ds_read_b64_tr_b16 v[138:139], v8 offset:49664
    ds_read_b64_tr_b16 v[124:125], v8 offset:36864
    ds_read_b64_tr_b16 v[126:127], v8 offset:37376
    ds_read_b64_tr_b16 v[140:141], v8 offset:53248
    ds_read_b64_tr_b16 v[142:143], v8 offset:53760
    ds_read_b64_tr_b16 v[128:129], v8 offset:40960
    ds_read_b64_tr_b16 v[130:131], v8 offset:41472
    ds_read_b64_tr_b16 v[144:145], v8 offset:57344
    ds_read_b64_tr_b16 v[146:147], v8 offset:57856
    ds_read_b64_tr_b16 v[132:133], v8 offset:45056
    ds_read_b64_tr_b16 v[134:135], v8 offset:45568
    ds_read_b64_tr_b16 v[148:149], v8 offset:61440
    ds_read_b64_tr_b16 v[150:151], v8 offset:61952
    ds_read_b64_tr_b16 v[24:25], v9 offset:0
    ds_read_b64_tr_b16 v[26:27], v9 offset:512
    ds_read_b64_tr_b16 v[72:73], v9 offset:16384
    ds_read_b64_tr_b16 v[74:75], v9 offset:16896
    ds_read_b64_tr_b16 v[28:29], v9 offset:4096
    ds_read_b64_tr_b16 v[30:31], v9 offset:4608
    ds_read_b64_tr_b16 v[76:77], v9 offset:20480
    ds_read_b64_tr_b16 v[78:79], v9 offset:20992
    ds_read_b64_tr_b16 v[32:33], v9 offset:8192
    ds_read_b64_tr_b16 v[34:35], v9 offset:8704
    ds_read_b64_tr_b16 v[80:81], v9 offset:24576
    ds_read_b64_tr_b16 v[82:83], v9 offset:25088
    ds_read_b64_tr_b16 v[36:37], v9 offset:12288
    ds_read_b64_tr_b16 v[38:39], v9 offset:12800
    ds_read_b64_tr_b16 v[84:85], v9 offset:28672
    ds_read_b64_tr_b16 v[86:87], v9 offset:29184
    s_waitcnt lgkmcnt(15)
    v_mfma_f32_16x16x32_bf16 v[152:155], v[120:123], v[224:227], v[152:155]
    v_mfma_f32_16x16x32_bf16 v[156:159], v[136:139], v[224:227], v[156:159]
    v_mfma_f32_16x16x32_bf16 v[152:155], v[124:127], v[228:231], v[152:155]
    v_mfma_f32_16x16x32_bf16 v[156:159], v[140:143], v[228:231], v[156:159]
    v_mfma_f32_16x16x32_bf16 v[152:155], v[128:131], v[232:235], v[152:155]
    v_mfma_f32_16x16x32_bf16 v[156:159], v[144:147], v[232:235], v[156:159]
    v_mfma_f32_16x16x32_bf16 v[152:155], v[132:135], v[236:239], v[152:155]
    v_mfma_f32_16x16x32_bf16 v[156:159], v[148:151], v[236:239], v[156:159]
    s_waitcnt lgkmcnt(0)
    v_mfma_f32_16x16x32_bf16 v[152:155], v[24:27], v[240:243], v[152:155]
    v_mfma_f32_16x16x32_bf16 v[156:159], v[72:75], v[240:243], v[156:159]
    v_mfma_f32_16x16x32_bf16 v[152:155], v[28:31], v[244:247], v[152:155]
    v_mfma_f32_16x16x32_bf16 v[156:159], v[76:79], v[244:247], v[156:159]
    v_mfma_f32_16x16x32_bf16 v[152:155], v[32:35], v[248:251], v[152:155]
    v_mfma_f32_16x16x32_bf16 v[156:159], v[80:83], v[248:251], v[156:159]
    v_mfma_f32_16x16x32_bf16 v[152:155], v[36:39], v[252:255], v[152:155]
    v_mfma_f32_16x16x32_bf16 v[156:159], v[84:87], v[252:255], v[156:159]
    s_mov_b32 exec_lo, 0x00030003
    s_mov_b32 exec_hi, 0x00030003
    s_waitcnt vmcnt(0)
FC_RC_CHK:
    v_xor_b32 v2, s52, v21
    v_bitop3_b32 v2, v23, s52, v2 bitop3:0xbe
    v_cmp_ne_u32 vcc, 0, v2
    s_cbranch_vccz FC_RC_OK
FC_RC_RETRY:
    s_add_u32 s100, s100, 1
    s_cmp_gt_u32 s100, 20000
    s_cbranch_scc1 FC_RC_OK
    s_sleep 2
    buffer_load_dwordx4 v[20:23], v16, s[28:31], 0 offen sc1
    s_waitcnt vmcnt(0)
    s_branch FC_RC_CHK
FC_RC_OK:
    s_mov_b64 exec, -1
    v_mov_b32_dpp v160, v152 row_newbcast:2 row_mask:0xf bank_mask:0xf
    v_mov_b32_dpp v164, v156 row_newbcast:2 row_mask:0xf bank_mask:0xf
    v_mov_b32_dpp v161, v153 row_newbcast:2 row_mask:0xf bank_mask:0xf
    v_mov_b32_dpp v165, v157 row_newbcast:2 row_mask:0xf bank_mask:0xf
    v_mov_b32_dpp v162, v154 row_newbcast:2 row_mask:0xf bank_mask:0xf
    v_mov_b32_dpp v166, v158 row_newbcast:2 row_mask:0xf bank_mask:0xf
    v_mov_b32_dpp v163, v155 row_newbcast:2 row_mask:0xf bank_mask:0xf
    v_mov_b32_dpp v167, v159 row_newbcast:2 row_mask:0xf bank_mask:0xf
    v_fma_f32 v152, v20, v160, v152
    v_fma_f32 v156, v20, v164, v156
    v_fma_f32 v153, v20, v161, v153
    v_fma_f32 v157, v20, v165, v157
    v_fma_f32 v154, v20, v162, v154
    v_fma_f32 v158, v20, v166, v158
    v_fma_f32 v155, v20, v163, v155
    v_fma_f32 v159, v20, v167, v159
    v_mul_f32 v152, v152, v22
    v_mul_f32 v156, v156, v22
    v_mul_f32 v153, v153, v22
    v_mul_f32 v157, v157, v22
    v_mul_f32 v154, v154, v22
    v_mul_f32 v158, v158, v22
    v_mul_f32 v155, v155, v22
    v_mul_f32 v159, v159, v22
    v_cvt_pk_bf16_f32 v152, v152, v156
    v_cvt_pk_bf16_f32 v153, v153, v157
    v_cvt_pk_bf16_f32 v154, v154, v158
    v_cvt_pk_bf16_f32 v155, v155, v159
    v_and_b32 v156, s55, v152
    v_lshlrev_b32 v152, 16, v152
    v_and_b32 v157, s55, v153
    v_lshlrev_b32 v153, 16, v153
    v_and_b32 v158, s55, v154
    v_lshlrev_b32 v154, 16, v154
    v_and_b32 v159, s55, v155
    v_lshlrev_b32 v155, 16, v155
    v_mul_f32 v160, 0xbfb8aa3b, v152
    v_mul_f32 v161, 0xbfb8aa3b, v153
    v_mul_f32 v162, 0xbfb8aa3b, v154
    v_mul_f32 v163, 0xbfb8aa3b, v155
    v_exp_f32 v160, v160
    v_exp_f32 v161, v161
    v_exp_f32 v162, v162
    v_exp_f32 v163, v163
    v_add_f32 v160, 1.0, v160
    v_add_f32 v161, 1.0, v161
    v_add_f32 v162, 1.0, v162
    v_add_f32 v163, 1.0, v163
    v_rcp_f32 v160, v160
    v_rcp_f32 v161, v161
    v_rcp_f32 v162, v162
    v_rcp_f32 v163, v163
    v_mul_f32 v152, v152, v160
    v_mul_f32 v153, v153, v161
    v_mul_f32 v154, v154, v162
    v_mul_f32 v155, v155, v163
    v_cvt_pk_bf16_f32 v152, v152, v152
    v_cvt_pk_bf16_f32 v153, v153, v153
    v_cvt_pk_bf16_f32 v154, v154, v154
    v_cvt_pk_bf16_f32 v155, v155, v155
    v_lshlrev_b32 v152, 16, v152
    v_lshlrev_b32 v153, 16, v153
    v_lshlrev_b32 v154, 16, v154
    v_lshlrev_b32 v155, 16, v155
    v_mul_f32 v152, v152, v156
    v_mul_f32 v153, v153, v157
    v_mul_f32 v154, v154, v158
    v_mul_f32 v155, v155, v159
    v_cvt_pk_bf16_f32 v152, v152, v153
    v_cvt_pk_bf16_f32 v154, v154, v155
    v_mov_b32 v153, s52
    v_mov_b32 v155, s52
    v_lshlrev_b32 v3, 6, v4
    v_lshl_add_u32 v3, v5, 4, v3
    s_lshl_b32 s60, s65, 7
    s_add_u32 s60, s60, 425984
    s_mov_b32 exec_lo, 0x00030003
    s_mov_b32 exec_hi, 0x00030003
    buffer_store_dwordx4 v[152:155], v3, s[28:31], s60 offen sc1
    s_mov_b64 exec, -1
    s_branch K_END
FC_SPARE:
    v_bfe_u32 v7, v1, 2, 2
    v_and_b32 v8, 3, v1
    v_and_b32 v3, 1, v5
    v_lshl_or_b32 v12, v3, 2, v7
    v_lshl_add_u32 v6, v5, 3, v7
    v_lshlrev_b32 v13, 8, v6
    v_lshl_add_u32 v13, v8, 3, v13
    s_lshl3_add_u32 s60, s56, s3
    s_lshl_b32 s60, s60, 10
    s_add_u32 s60, s60, 827392
    v_mov_b32 v108, -1
    v_mov_b32 v109, -1
    v_mov_b32 v110, -1
    v_mov_b32 v111, -1
    v_lshlrev_b32 v15, 4, v1
FC_CLR:
    buffer_store_dwordx4 v[108:111], v15, s[28:31], s60 offen sc1
    s_add_u32 s60, s60, 237568
    s_cmp_lt_u32 s60, 3977216
    s_cbranch_scc1 FC_CLR
    s_lshl_b32 s64, s56, 7
    s_add_u32 s64, s64, 4736
    v_mov_b32 v104, s52
    v_mov_b32 v105, s52
    v_mov_b32 v106, s52
    v_mov_b32 v107, s52
    s_waitcnt vmcnt(0)
    s_barrier
    s_cmp_lg_u32 s59, 0
    s_cbranch_scc1 FC_NOFL
    s_mov_b64 exec, 0xff
    buffer_store_dwordx4 v[104:107], v15, s[28:31], s64 offen sc1
    s_mov_b64 exec, -1
FC_NOFL:
    s_lshl2_add_u32 s60, s56, s59
    s_cmp_eq_u32 s60, 221
    s_cbranch_scc1 FC_TOP
    s_cmp_lg_u32 s54, 30
    s_cbranch_scc1 FC_NOWR
    s_and_b32 s60, s2, 4
    s_add_u32 s60, s60, s59
    s_lshl_b32 s60, s60, 12
    s_add_u32 s60, s60, 16384
    buffer_load_dwordx4 v[168:171], v15, s[28:31], s60 offen offset:0
    buffer_load_dwordx4 v[168:171], v15, s[28:31], s60 offen offset:1024
    buffer_load_dwordx4 v[168:171], v15, s[28:31], s60 offen offset:2048
    buffer_load_dwordx4 v[168:171], v15, s[28:31], s60 offen offset:3072
FC_NOWR:
    s_barrier
    s_mul_i32 s60, s59, 10
    s_add_u32 s60, s60, 0
    s_and_b32 s61, s60, 7
    s_lshr_b32 s60, s60, 3
    s_lshl_b32 s60, s60, 14
    v_xor_b32 v2, s61, v12
    v_lshl_add_u32 v2, v2, 5, v13
    v_add_u32 v2, s60, v2
    ds_read_b64_tr_b16 v[24:25], v2 offset:0
    ds_read_b64_tr_b16 v[26:27], v2 offset:1024
    ds_read_b64_tr_b16 v[28:29], v2 offset:8192
    ds_read_b64_tr_b16 v[30:31], v2 offset:9216
    s_mul_i32 s60, s59, 10
    s_add_u32 s60, s60, 1
    s_and_b32 s61, s60, 7
    s_lshr_b32 s60, s60, 3
    s_lshl_b32 s60, s60, 14
    v_xor_b32 v2, s61, v12
    v_lshl_add_u32 v2, v2, 5, v13
    v_add_u32 v2, s60, v2
    ds_read_b64_tr_b16 v[32:33], v2 offset:0
    ds_read_b64_tr_b16 v[34:35], v2 offset:1024
    ds_read_b64_tr_b16 v[36:37], v2 offset:8192
    ds_read_b64_tr_b16 v[38:39], v2 offset:9216
    s_mul_i32 s60, s59, 10
    s_add_u32 s60, s60, 2
    s_and_b32 s61, s60, 7
    s_lshr_b32 s60, s60, 3
    s_lshl_b32 s60, s60, 14
    v_xor_b32 v2, s61, v12
    v_lshl_add_u32 v2, v2, 5, v13
    v_add_u32 v2, s60, v2
    ds_read_b64_tr_b16 v[40:41], v2 offset:0
    ds_read_b64_tr_b16 v[42:43], v2 offset:1024
    ds_read_b64_tr_b16 v[44:45], v2 offset:8192
    ds_read_b64_tr_b16 v[46:47], v2 offset:9216
    s_mul_i32 s60, s59, 10
    s_add_u32 s60, s60, 3
    s_and_b32 s61, s60, 7
    s_lshr_b32 s60, s60, 3
    s_lshl_b32 s60, s60, 14
    v_xor_b32 v2, s61, v12
    v_lshl_add_u32 v2, v2, 5, v13
    v_add_u32 v2, s60, v2
    ds_read_b64_tr_b16 v[48:49], v2 offset:0
    ds_read_b64_tr_b16 v[50:51], v2 offset:1024
    ds_read_b64_tr_b16 v[52:53], v2 offset:8192
    ds_read_b64_tr_b16 v[54:55], v2 offset:9216
    s_mul_i32 s60, s59, 10
    s_add_u32 s60, s60, 4
    s_and_b32 s61, s60, 7
    s_lshr_b32 s60, s60, 3
    s_lshl_b32 s60, s60, 14
    v_xor_b32 v2, s61, v12
    v_lshl_add_u32 v2, v2, 5, v13
    v_add_u32 v2, s60, v2
    ds_read_b64_tr_b16 v[56:57], v2 offset:0
    ds_read_b64_tr_b16 v[58:59], v2 offset:1024
    ds_read_b64_tr_b16 v[60:61], v2 offset:8192
    ds_read_b64_tr_b16 v[62:63], v2 offset:9216
    s_mul_i32 s60, s59, 10
    s_add_u32 s60, s60, 5
    s_and_b32 s61, s60, 7
    s_lshr_b32 s60, s60, 3
    s_lshl_b32 s60, s60, 14
    v_xor_b32 v2, s61, v12
    v_lshl_add_u32 v2, v2, 5, v13
    v_add_u32 v2, s60, v2
    ds_read_b64_tr_b16 v[64:65], v2 offset:0
    ds_read_b64_tr_b16 v[66:67], v2 offset:1024
    ds_read_b64_tr_b16 v[68:69], v2 offset:8192
    ds_read_b64_tr_b16 v[70:71], v2 offset:9216
    s_mul_i32 s60, s59, 10
    s_add_u32 s60, s60, 6
    s_and_b32 s61, s60, 7
    s_lshr_b32 s60, s60, 3
    s_lshl_b32 s60, s60, 14
    v_xor_b32 v2, s61, v12
    v_lshl_add_u32 v2, v2, 5, v13
    v_add_u32 v2, s60, v2
    ds_read_b64_tr_b16 v[72:73], v2 offset:0
    ds_read_b64_tr_b16 v[74:75], v2 offset:1024
    ds_read_b64_tr_b16 v[76:77], v2 offset:8192
    ds_read_b64_tr_b16 v[78:79], v2 offset:9216
    s_mul_i32 s60, s59, 10
    s_add_u32 s60, s60, 7
    s_and_b32 s61, s60, 7
    s_lshr_b32 s60, s60, 3
    s_lshl_b32 s60, s60, 14
    v_xor_b32 v2, s61, v12
    v_lshl_add_u32 v2, v2, 5, v13
    v_add_u32 v2, s60, v2
    ds_read_b64_tr_b16 v[80:81], v2 offset:0
    ds_read_b64_tr_b16 v[82:83], v2 offset:1024
    ds_read_b64_tr_b16 v[84:85], v2 offset:8192
    ds_read_b64_tr_b16 v[86:87], v2 offset:9216
    s_mul_i32 s60, s59, 10
    s_add_u32 s60, s60, 8
    s_and_b32 s61, s60, 7
    s_lshr_b32 s60, s60, 3
    s_lshl_b32 s60, s60, 14
    v_xor_b32 v2, s61, v12
    v_lshl_add_u32 v2, v2, 5, v13
    v_add_u32 v2, s60, v2
    ds_read_b64_tr_b16 v[88:89], v2 offset:0
    ds_read_b64_tr_b16 v[90:91], v2 offset:1024
    ds_read_b64_tr_b16 v[92:93], v2 offset:8192
    ds_read_b64_tr_b16 v[94:95], v2 offset:9216
    s_mul_i32 s60, s59, 10
    s_add_u32 s60, s60, 9
    s_and_b32 s61, s60, 7
    s_lshr_b32 s60, s60, 3
    s_lshl_b32 s60, s60, 14
    v_xor_b32 v2, s61, v12
    v_lshl_add_u32 v2, v2, 5, v13
    v_add_u32 v2, s60, v2
    ds_read_b64_tr_b16 v[96:97], v2 offset:0
    ds_read_b64_tr_b16 v[98:99], v2 offset:1024
    ds_read_b64_tr_b16 v[100:101], v2 offset:8192
    ds_read_b64_tr_b16 v[102:103], v2 offset:9216
    v_lshrrev_b32 v14, 1, v5
    v_lshlrev_b32 v14, 7, v14
    v_and_b32 v2, 1, v1
    v_lshl_add_u32 v14, v2, 6, v14
    v_lshl_add_u32 v14, v3, 5, v14
    s_sub_u32 s63, s56, 27
    s_waitcnt lgkmcnt(0)
    s_cmp_ge_u32 s63, 27
    s_cbranch_scc1 K_END
    s_lshl_b32 s65, s63, 9
    s_add_u32 s65, s65, 425984
    s_mov_b32 exec_lo, 0x33333333
    s_mov_b32 exec_hi, 0x33333333
    buffer_load_dwordx4 v[112:115], v14, s[28:31], s65 offen offset:0 sc1
    buffer_load_dwordx4 v[116:119], v14, s[28:31], s65 offen offset:16 sc1
    buffer_load_dwordx4 v[120:123], v14, s[28:31], s65 offen offset:256 sc1
    buffer_load_dwordx4 v[124:127], v14, s[28:31], s65 offen offset:272 sc1
    s_waitcnt vmcnt(0)
D_H_CHK:
    v_xor_b32 v2, s52, v113
    v_bitop3_b32 v2, v115, s52, v2 bitop3:0xbe
    v_bitop3_b32 v2, v117, s52, v2 bitop3:0xbe
    v_bitop3_b32 v2, v119, s52, v2 bitop3:0xbe
    v_bitop3_b32 v2, v121, s52, v2 bitop3:0xbe
    v_bitop3_b32 v2, v123, s52, v2 bitop3:0xbe
    v_bitop3_b32 v2, v125, s52, v2 bitop3:0xbe
    v_bitop3_b32 v2, v127, s52, v2 bitop3:0xbe
    v_cmp_ne_u32 vcc, 0, v2
    s_cbranch_vccz D_H_OK
D_H_RETRY:
    s_add_u32 s100, s100, 1
    s_cmp_gt_u32 s100, 20000
    s_cbranch_scc1 D_H_OK
    s_sleep 6
    buffer_load_dwordx4 v[112:115], v14, s[28:31], s65 offen offset:0 sc1
    buffer_load_dwordx4 v[116:119], v14, s[28:31], s65 offen offset:16 sc1
    buffer_load_dwordx4 v[120:123], v14, s[28:31], s65 offen offset:256 sc1
    buffer_load_dwordx4 v[124:127], v14, s[28:31], s65 offen offset:272 sc1
    s_waitcnt vmcnt(0)
    s_branch D_H_CHK
D_H_OK:
    s_mov_b64 exec, -1
    v_mov_b32 v132, v112
    v_mov_b32 v133, v114
    v_mov_b32 v134, v116
    v_mov_b32 v135, v118
    v_mov_b32 v136, v120
    v_mov_b32 v137, v122
    v_mov_b32 v138, v124
    v_mov_b32 v139, v126
    v_mfma_f32_16x16x32_bf16 v[176:179], v[132:135], v[24:27], 0
    v_mfma_f32_16x16x32_bf16 v[180:183], v[132:135], v[32:35], 0
    v_mfma_f32_16x16x32_bf16 v[184:187], v[132:135], v[40:43], 0
    v_mfma_f32_16x16x32_bf16 v[188:191], v[132:135], v[48:51], 0
    v_mfma_f32_16x16x32_bf16 v[192:195], v[132:135], v[56:59], 0
    v_mfma_f32_16x16x32_bf16 v[196:199], v[132:135], v[64:67], 0
    v_mfma_f32_16x16x32_bf16 v[200:203], v[132:135], v[72:75], 0
    v_mfma_f32_16x16x32_bf16 v[204:207], v[132:135], v[80:83], 0
    v_mfma_f32_16x16x32_bf16 v[208:211], v[132:135], v[88:91], 0
    v_mfma_f32_16x16x32_bf16 v[212:215], v[132:135], v[96:99], 0
    v_mfma_f32_16x16x32_bf16 v[176:179], v[136:139], v[28:31], v[176:179]
    v_mfma_f32_16x16x32_bf16 v[180:183], v[136:139], v[36:39], v[180:183]
    v_mfma_f32_16x16x32_bf16 v[184:187], v[136:139], v[44:47], v[184:187]
    v_mfma_f32_16x16x32_bf16 v[188:191], v[136:139], v[52:55], v[188:191]
    v_mfma_f32_16x16x32_bf16 v[192:195], v[136:139], v[60:63], v[192:195]
    v_mfma_f32_16x16x32_bf16 v[196:199], v[136:139], v[68:71], v[196:199]
    v_mfma_f32_16x16x32_bf16 v[200:203], v[136:139], v[76:79], v[200:203]
    v_mfma_f32_16x16x32_bf16 v[204:207], v[136:139], v[84:87], v[204:207]
    v_mfma_f32_16x16x32_bf16 v[208:211], v[136:139], v[92:95], v[208:211]
    v_mfma_f32_16x16x32_bf16 v[212:215], v[136:139], v[100:103], v[212:215]
    v_lshlrev_b32 v2, 3, v1
    s_mul_i32 s60, s59, 1280
    s_mul_i32 s61, s63, 5120
    s_add_u32 s60, s60, s61
    s_add_u32 s60, s60, 131072
    s_add_u32 s61, s60, 138240
    v_mov_b32 v141, s52
    v_mov_b32 v143, s52
    v_mov_b32 v145, s52
    v_mov_b32 v147, s52
    v_mov_b32 v149, s52
    v_mov_b32 v151, s52
    s_mov_b32 exec_lo, 0xffff
    s_mov_b32 exec_hi, 0
    v_mov_b32 v140, v176
    v_mov_b32 v142, v177
    v_mov_b32 v144, v192
    v_mov_b32 v146, v193
    v_mov_b32 v148, v208
    v_mov_b32 v150, v209
    s_mov_b32 exec_lo, 0xffff0000
    s_mov_b32 exec_hi, 0
    v_mov_b32 v140, v180
    v_mov_b32 v142, v181
    v_mov_b32 v144, v196
    v_mov_b32 v146, v197
    v_mov_b32 v148, v212
    v_mov_b32 v150, v213
    s_mov_b32 exec_lo, 0
    s_mov_b32 exec_hi, 0xffff
    v_mov_b32 v140, v184
    v_mov_b32 v142, v185
    v_mov_b32 v144, v200
    v_mov_b32 v146, v201
    s_mov_b32 exec_lo, 0
    s_mov_b32 exec_hi, 0xffff0000
    v_mov_b32 v140, v188
    v_mov_b32 v142, v189
    v_mov_b32 v144, v204
    v_mov_b32 v146, v205
    s_mov_b64 exec, -1
    buffer_store_dwordx2 v[140:141], v2, s[28:31], s60 offen offset:0 sc1
    buffer_store_dwordx2 v[142:143], v2, s[28:31], s61 offen offset:0 sc1
    buffer_store_dwordx2 v[144:145], v2, s[28:31], s60 offen offset:512 sc1
    buffer_store_dwordx2 v[146:147], v2, s[28:31], s61 offen offset:512 sc1
    s_mov_b32 exec_hi, 0
    buffer_store_dwordx2 v[148:149], v2, s[28:31], s60 offen offset:1024 sc1
    buffer_store_dwordx2 v[150:151], v2, s[28:31], s61 offen offset:1024 sc1
    s_mov_b64 exec, -1
    s_branch K_END
FC_TOP:
    v_lshlrev_b32 v12, 4, v1
    s_mov_b32 s62, 0
    s_add_u32 s60, s62, 49152
    buffer_load_dwordx4 v[88:91], v12, s[28:31], s60 offen offset:0 sc1
    buffer_load_dwordx4 v[92:95], v12, s[28:31], s60 offen offset:1024 sc1
    buffer_load_dwordx4 v[96:99], v12, s[28:31], s60 offen offset:2048 sc1
    buffer_load_dwordx4 v[100:103], v12, s[28:31], s60 offen offset:3072 sc1
    s_add_u32 s60, s62, 53248
    buffer_load_dwordx4 v[104:107], v12, s[28:31], s60 offen offset:0 sc1
    buffer_load_dwordx4 v[108:111], v12, s[28:31], s60 offen offset:1024 sc1
    buffer_load_dwordx4 v[112:115], v12, s[28:31], s60 offen offset:2048 sc1
    buffer_load_dwordx4 v[116:119], v12, s[28:31], s60 offen offset:3072 sc1
    s_add_u32 s60, s62, 57344
    buffer_load_dwordx4 v[120:123], v12, s[28:31], s60 offen offset:0 sc1
    buffer_load_dwordx4 v[124:127], v12, s[28:31], s60 offen offset:1024 sc1
    buffer_load_dwordx4 v[128:131], v12, s[28:31], s60 offen offset:2048 sc1
    buffer_load_dwordx4 v[132:135], v12, s[28:31], s60 offen offset:3072 sc1
    s_add_u32 s60, s62, 61440
    buffer_load_dwordx4 v[136:139], v12, s[28:31], s60 offen offset:0 sc1
    buffer_load_dwordx4 v[140:143], v12, s[28:31], s60 offen offset:1024 sc1
    buffer_load_dwordx4 v[144:147], v12, s[28:31], s60 offen offset:2048 sc1
    buffer_load_dwordx4 v[148:151], v12, s[28:31], s60 offen offset:3072 sc1
    s_waitcnt vmcnt(0)
T_KY_CHK:
    v_xor_b32 v2, s52, v89
    v_bitop3_b32 v2, v91, s52, v2 bitop3:0xbe
    v_bitop3_b32 v2, v93, s52, v2 bitop3:0xbe
    v_bitop3_b32 v2, v95, s52, v2 bitop3:0xbe
    v_bitop3_b32 v2, v97, s52, v2 bitop3:0xbe
    v_bitop3_b32 v2, v99, s52, v2 bitop3:0xbe
    v_bitop3_b32 v2, v101, s52, v2 bitop3:0xbe
    v_bitop3_b32 v2, v103, s52, v2 bitop3:0xbe
    v_bitop3_b32 v2, v105, s52, v2 bitop3:0xbe
    v_bitop3_b32 v2, v107, s52, v2 bitop3:0xbe
    v_bitop3_b32 v2, v109, s52, v2 bitop3:0xbe
    v_bitop3_b32 v2, v111, s52, v2 bitop3:0xbe
    v_bitop3_b32 v2, v113, s52, v2 bitop3:0xbe
    v_bitop3_b32 v2, v115, s52, v2 bitop3:0xbe
    v_bitop3_b32 v2, v117, s52, v2 bitop3:0xbe
    v_bitop3_b32 v2, v119, s52, v2 bitop3:0xbe
    v_bitop3_b32 v2, v121, s52, v2 bitop3:0xbe
    v_bitop3_b32 v2, v123, s52, v2 bitop3:0xbe
    v_bitop3_b32 v2, v125, s52, v2 bitop3:0xbe
    v_bitop3_b32 v2, v127, s52, v2 bitop3:0xbe
    v_bitop3_b32 v2, v129, s52, v2 bitop3:0xbe
    v_bitop3_b32 v2, v131, s52, v2 bitop3:0xbe
    v_bitop3_b32 v2, v133, s52, v2 bitop3:0xbe
    v_bitop3_b32 v2, v135, s52, v2 bitop3:0xbe
    v_bitop3_b32 v2, v137, s52, v2 bitop3:0xbe
    v_bitop3_b32 v2, v139, s52, v2 bitop3:0xbe
    v_bitop3_b32 v2, v141, s52, v2 bitop3:0xbe
    v_bitop3_b32 v2, v143, s52, v2 bitop3:0xbe
    v_bitop3_b32 v2, v145, s52, v2 bitop3:0xbe
    v_bitop3_b32 v2, v147, s52, v2 bitop3:0xbe
    v_bitop3_b32 v2, v149, s52, v2 bitop3:0xbe
    v_bitop3_b32 v2, v151, s52, v2 bitop3:0xbe
    v_cmp_ne_u32 vcc, 0, v2
    s_cbranch_vccz T_KY_OK
T_KY_RETRY:
    s_add_u32 s100, s100, 1
    s_cmp_gt_u32 s100, 20000
    s_cbranch_scc1 T_KY_OK
    s_sleep 16
    s_add_u32 s60, s62, 49152
    buffer_load_dwordx4 v[88:91], v12, s[28:31], s60 offen offset:0 sc1
    buffer_load_dwordx4 v[92:95], v12, s[28:31], s60 offen offset:1024 sc1
    buffer_load_dwordx4 v[96:99], v12, s[28:31], s60 offen offset:2048 sc1
    buffer_load_dwordx4 v[100:103], v12, s[28:31], s60 offen offset:3072 sc1
    s_add_u32 s60, s62, 53248
    buffer_load_dwordx4 v[104:107], v12, s[28:31], s60 offen offset:0 sc1
    buffer_load_dwordx4 v[108:111], v12, s[28:31], s60 offen offset:1024 sc1
    buffer_load_dwordx4 v[112:115], v12, s[28:31], s60 offen offset:2048 sc1
    buffer_load_dwordx4 v[116:119], v12, s[28:31], s60 offen offset:3072 sc1
    s_add_u32 s60, s62, 57344
    buffer_load_dwordx4 v[120:123], v12, s[28:31], s60 offen offset:0 sc1
    buffer_load_dwordx4 v[124:127], v12, s[28:31], s60 offen offset:1024 sc1
    buffer_load_dwordx4 v[128:131], v12, s[28:31], s60 offen offset:2048 sc1
    buffer_load_dwordx4 v[132:135], v12, s[28:31], s60 offen offset:3072 sc1
    s_add_u32 s60, s62, 61440
    buffer_load_dwordx4 v[136:139], v12, s[28:31], s60 offen offset:0 sc1
    buffer_load_dwordx4 v[140:143], v12, s[28:31], s60 offen offset:1024 sc1
    buffer_load_dwordx4 v[144:147], v12, s[28:31], s60 offen offset:2048 sc1
    buffer_load_dwordx4 v[148:151], v12, s[28:31], s60 offen offset:3072 sc1
    s_waitcnt vmcnt(0)
    s_branch T_KY_CHK
T_KY_OK:
    v_max_u32 v20, v88, v90
    v_min_u32 v21, v88, v90
    v_med3_u32 v21, v20, v21, v92
    v_max_u32 v20, v20, v92
    v_med3_u32 v21, v20, v21, v94
    v_max_u32 v20, v20, v94
    v_med3_u32 v21, v20, v21, v96
    v_max_u32 v20, v20, v96
    v_med3_u32 v21, v20, v21, v98
    v_max_u32 v20, v20, v98
    v_med3_u32 v21, v20, v21, v100
    v_max_u32 v20, v20, v100
    v_med3_u32 v21, v20, v21, v102
    v_max_u32 v20, v20, v102
    v_med3_u32 v21, v20, v21, v104
    v_max_u32 v20, v20, v104
    v_med3_u32 v21, v20, v21, v106
    v_max_u32 v20, v20, v106
    v_med3_u32 v21, v20, v21, v108
    v_max_u32 v20, v20, v108
    v_med3_u32 v21, v20, v21, v110
    v_max_u32 v20, v20, v110
    v_med3_u32 v21, v20, v21, v112
    v_max_u32 v20, v20, v112
    v_med3_u32 v21, v20, v21, v114
    v_max_u32 v20, v20, v114
    v_med3_u32 v21, v20, v21, v116
    v_max_u32 v20, v20, v116
    v_med3_u32 v21, v20, v21, v118
    v_max_u32 v20, v20, v118
    v_med3_u32 v21, v20, v21, v120
    v_max_u32 v20, v20, v120
    v_med3_u32 v21, v20, v21, v122
    v_max_u32 v20, v20, v122
    v_med3_u32 v21, v20, v21, v124
    v_max_u32 v20, v20, v124
    v_med3_u32 v21, v20, v21, v126
    v_max_u32 v20, v20, v126
    v_med3_u32 v21, v20, v21, v128
    v_max_u32 v20, v20, v128
    v_med3_u32 v21, v20, v21, v130
    v_max_u32 v20, v20, v130
    v_med3_u32 v21, v20, v21, v132
    v_max_u32 v20, v20, v132
    v_med3_u32 v21, v20, v21, v134
    v_max_u32 v20, v20, v134
    v_med3_u32 v21, v20, v21, v136
    v_max_u32 v20, v20, v136
    v_med3_u32 v21, v20, v21, v138
    v_max_u32 v20, v20, v138
    v_med3_u32 v21, v20, v21, v140
    v_max_u32 v20, v20, v140
    v_med3_u32 v21, v20, v21, v142
    v_max_u32 v20, v20, v142
    v_med3_u32 v21, v20, v21, v144
    v_max_u32 v20, v20, v144
    v_med3_u32 v21, v20, v21, v146
    v_max_u32 v20, v20, v146
    v_med3_u32 v21, v20, v21, v148
    v_max_u32 v20, v20, v148
    v_med3_u32 v21, v20, v21, v150
    v_max_u32 v20, v20, v150
    s_nop 1
    v_mov_b32_dpp v22, v20 row_ror:8 row_mask:0xf bank_mask:0xf
    v_mov_b32_dpp v23, v21 row_ror:8 row_mask:0xf bank_mask:0xf
    v_min_u32 v2, v20, v22
    v_max_u32 v20, v20, v22
    v_max3_u32 v21, v21, v23, v2
    s_nop 0
    v_mov_b32_dpp v22, v20 row_ror:4 row_mask:0xf bank_mask:0xf
    v_mov_b32_dpp v23, v21 row_ror:4 row_mask:0xf bank_mask:0xf
    v_min_u32 v2, v20, v22
    v_max_u32 v20, v20, v22
    v_max3_u32 v21, v21, v23, v2
    s_nop 0
    v_mov_b32_dpp v22, v20 row_ror:2 row_mask:0xf bank_mask:0xf
    v_mov_b32_dpp v23, v21 row_ror:2 row_mask:0xf bank_mask:0xf
    v_min_u32 v2, v20, v22
    v_max_u32 v20, v20, v22
    v_max3_u32 v21, v21, v23, v2
    s_nop 0
    v_mov_b32_dpp v22, v20 row_ror:1 row_mask:0xf bank_mask:0xf
    v_mov_b32_dpp v23, v21 row_ror:1 row_mask:0xf bank_mask:0xf
    v_min_u32 v2, v20, v22
    v_max_u32 v20, v20, v22
    v_max3_u32 v21, v21, v23, v2
    v_mov_b32 v22, v20
    v_mov_b32 v23, v21
    s_nop 0
    v_permlane16_swap_b32 v20, v22
    v_permlane16_swap_b32 v21, v23
    v_min_u32 v2, v20, v22
    v_max_u32 v20, v20, v22
    v_max3_u32 v21, v21, v23, v2
    v_mov_b32 v22, v20
    v_mov_b32 v23, v21
    s_nop 0
    v_permlane32_swap_b32 v20, v22
    v_permlane32_swap_b32 v21, v23
    v_min_u32 v2, v20, v22
    v_max_u32 v20, v20, v22
    v_max3_u32 v21, v21, v23, v2
    s_mov_b64 exec, 0x1fffffff
    v_lshlrev_b32 v11, 7, v1
    s_movk_i32 s63, 8192
    buffer_load_dword v16, v11, s[28:31], s63 offen sc1
    v_mov_b32 v104, v20
    v_mov_b32 v106, v21
    s_waitcnt vmcnt(0)
T_FL_CHK:
    v_xor_b32 v2, s52, v16
    v_cmp_ne_u32 vcc, 0, v2
    s_cbranch_vccz T_FL_OK
T_FL_RETRY:
    s_add_u32 s100, s100, 1
    s_cmp_gt_u32 s100, 20000
    s_cbranch_scc1 T_FL_OK
    s_sleep 8
    s_movk_i32 s63, 8192
    buffer_load_dword v16, v11, s[28:31], s63 offen sc1
    s_waitcnt vmcnt(0)
    s_branch T_FL_CHK
T_FL_OK:
    s_mov_b64 exec, 0xff
    buffer_store_dwordx4 v[104:107], v15, s[28:31], 0 offen offset:256 sc1
    s_mov_b64 exec, 1
    buffer_store_dword v105, v15, s[28:31], 0 offen offset:0 sc1
    s_mov_b64 exec, -1
    s_branch K_END
K_END:
K_EXIT:
    s_endpgm
    .p2align 6
    .type K_TAB,@object
K_TAB:
    .long 0x18100800, 0x80808020, 0x18100800, 0x20, 0x0, 0x1400, 0x1e00, 0x0
    .long 0x0, 0x2, 0xff00ff00, 0xffffffff, 0xffffffff, 0xffffffff, 0xffffff00, 0xffffffff
    .long 0x18100800, 0x80808080, 0x18100800, 0x18, 0x6, 0x2000, 0x7ff00000, 0x1c00
    .long 0x0, 0x1, 0xff00ff00, 0xffffffff, 0xffffffff, 0xffffffff, 0xffffff00, 0xffffffff
    .long 0x80100800, 0x80808080, 0x8080000, 0x10, 0x6, 0x2500, 0x1d08, 0x5400
    .long 0x3800, 0x1, 0xff00, 0xffff, 0xffff, 0xffff, 0xffffff00, 0xffffffff
    .long 0x80800800, 0x80808080, 0x8080000, 0x8, 0x6, 0x2700, 0x7ff00000, 0x8c00
    .long 0x7000, 0x1, 0xff00, 0xffff, 0xffff, 0xffff, 0xffffff00, 0xffffffff
    .long 0x80808000, 0x80808080, 0x8080000, 0x0, 0x6, 0x7ff00000, 0x1f08, 0xc400
    .long 0xa800, 0x1, 0xff00, 0xffff, 0xffff, 0xffff, 0xffffff00, 0xffffffff
    .long 0x40383028, 0x80808048, 0x40383028, 0x48, 0x2, 0x0, 0x1800, 0x0
    .long 0x0, 0x0, 0xff00ff00, 0xffffffff, 0xffffffff, 0xffffffff, 0xffffff00, 0xffffffff
    .long 0x38302820, 0x80808040, 0x38302820, 0x40, 0x0, 0x400, 0x1a00, 0x0
    .long 0x0, 0x0, 0xff00ff00, 0xffffffff, 0xffffffff, 0xffffffff, 0xffffff00, 0xffffffff
    .long 0x30282018, 0x80808038, 0x30282018, 0x38, 0x0, 0x800, 0x1808, 0x0
    .long 0x0, 0x0, 0xff00ff00, 0xffffffff, 0xffffffff, 0xffffffff, 0xffffff00, 0xffffffff
    .long 0x28201810, 0x80808030, 0x28201810, 0x30, 0x0, 0xc00, 0x1a08, 0x0
    .long 0x0, 0x0, 0xff00ff00, 0xffffffff, 0xffffffff, 0xffffffff, 0xffffff00, 0xffffffff
    .long 0x20181008, 0x80808028, 0x20181008, 0x28, 0x0, 0x1000, 0x1c00, 0x0
    .long 0x0, 0x0, 0xff00ff00, 0xffffffff, 0xffffffff, 0xffffffff, 0xffffff00, 0xffffffff
    .long 0x68605850, 0x80808070, 0x68605850, 0x70, 0x4, 0x200, 0x1900, 0x0
    .long 0x0, 0x0, 0xff00ff00, 0xffffffff, 0xffffffff, 0xffffffff, 0xffffff00, 0xffffffff
    .long 0x60585048, 0x80808068, 0x60585048, 0x68, 0x2, 0x600, 0x1b00, 0x0
    .long 0x0, 0x0, 0xff00ff00, 0xffffffff, 0xffffffff, 0xffffffff, 0xffffff00, 0xffffffff
    .long 0x58504840, 0x80808060, 0x58504840, 0x60, 0x2, 0xa00, 0x1908, 0x0
    .long 0x0, 0x0, 0xff00ff00, 0xffffffff, 0xffffffff, 0xffffffff, 0xffffff00, 0xffffffff
    .long 0x50484038, 0x80808058, 0x50484038, 0x58, 0x2, 0xe00, 0x1b08, 0x0
    .long 0x0, 0x0, 0xff00ff00, 0xffffffff, 0xffffffff, 0xffffffff, 0xffffff00, 0xffffffff
    .long 0x48403830, 0x80808050, 0x48403830, 0x50, 0x2, 0x1200, 0x1d00, 0x0
    .long 0x0, 0x0, 0xff00ff00, 0xffffffff, 0xffffffff, 0xffffffff, 0xffffff00, 0xffffffff
    .long 0x80808078, 0x80808080, 0x80807878, 0x78, 0x6, 0x7ff00000, 0x1c08, 0x0
    .long 0x1c00, 0x1, 0xff00, 0xffff, 0xffff, 0xffff, 0xffffff00, 0xffffffff
    .long 0x80807870, 0x80808080, 0x78787070, 0x78, 0x4, 0x2400, 0x7ff00000, 0x3800
    .long 0x5400, 0x1, 0xff00, 0xffff, 0xffff, 0xffff, 0xffffff00, 0xffffffff
    .long 0x80787068, 0x80808080, 0x70706868, 0x78, 0x4, 0x2600, 0x1e08, 0x7000
    .long 0x8c00, 0x1, 0xff00, 0xffff, 0xffff, 0xffff, 0xffffff00, 0xffffffff
    .long 0x78706860, 0x80808080, 0x78706860, 0x78, 0x4, 0x2200, 0x7ff00000, 0xa800
    .long 0xc400, 0x1, 0xff00ff00, 0xffffffff, 0xffffffff, 0xffffffff, 0xffffff00, 0xffffffff
    .long 0x70686058, 0x80808078, 0x70686058, 0x78, 0x4, 0x1600, 0x1f00, 0x0
    .long 0x0, 0x2, 0xff00ff00, 0xffffffff, 0xffffffff, 0xffffffff, 0xffffff00, 0xffffffff
    .long 0x40383028, 0x80808048, 0x40383028, 0x48, 0x0, 0x14000, 0x15800, 0x0
    .long 0x0, 0x0, 0xffffffff, 0xffffffff, 0xffffffff, 0x0, 0xffffffff, 0xffff
    .long 0x38302820, 0x80808040, 0x38302820, 0x40, 0x6, 0x14400, 0x15a00, 0x0
    .long 0x0, 0x0, 0xffffffff, 0xffffffff, 0xffffffff, 0x0, 0xffffffff, 0xffff
    .long 0x30282018, 0x80808038, 0x30282018, 0x38, 0x6, 0x14800, 0x15808, 0x0
    .long 0x0, 0x0, 0xffffffff, 0xffffffff, 0xffffffff, 0x0, 0xffffffff, 0xffff
    .long 0x28201810, 0x80808030, 0x28201810, 0x30, 0x6, 0x14c00, 0x15a08, 0x0
    .long 0x0, 0x0, 0xffffffff, 0xffffffff, 0xffffffff, 0x0, 0xffffffff, 0xffff
    .long 0x20181008, 0x80808028, 0x20181008, 0x28, 0x6, 0x15000, 0x15c00, 0x0
    .long 0x0, 0x0, 0xffffffff, 0xffffffff, 0xffffffff, 0x0, 0xffffffff, 0xffff
    .long 0x18100800, 0x80808020, 0x18100800, 0x20, 0x2, 0x15400, 0x15e00, 0x0
    .long 0x0, 0x2, 0xffffffff, 0xffffffff, 0xffffffff, 0x0, 0xffffffff, 0xffff
    .long 0x18100800, 0x80808080, 0x18100800, 0x18, 0x0, 0x16000, 0x7ff00000, 0x2c00
    .long 0x1000, 0x1, 0xffffffff, 0xffffffff, 0xffffffff, 0x0, 0xffffffff, 0xffff
    .long 0x80100800, 0x80808080, 0x8080000, 0x10, 0x0, 0x16500, 0x15d08, 0x6400
    .long 0x4800, 0x1, 0xffff, 0xffff, 0xffff, 0x0, 0xffffffff, 0xffff
    .long 0x80800800, 0x80808080, 0x8080000, 0x8, 0x0, 0x16700, 0x7ff00000, 0x9c00
    .long 0x8000, 0x1, 0xffff, 0xffff, 0xffff, 0x0, 0xffffffff, 0xffff
    .long 0x80808000, 0x80808080, 0x8080000, 0x0, 0x0, 0x7ff00000, 0x15f08, 0xd400
    .long 0xb800, 0x1, 0xffff, 0xffff, 0xffff, 0x0, 0xffffffff, 0xffff
    .long 0x80808078, 0x80808080, 0x80807878, 0x78, 0x4, 0x7ff00000, 0x15c08, 0x1000
    .long 0x2c00, 0x1, 0xffff, 0xffff, 0xffff, 0x0, 0xffffffff, 0xffff
    .long 0x80807870, 0x80808080, 0x78787070, 0x78, 0x2, 0x16400, 0x7ff00000, 0x4800
    .long 0x6400, 0x1, 0xffff, 0xffff, 0xffff, 0x0, 0xffffffff, 0xffff
    .long 0x80787068, 0x80808080, 0x70706868, 0x78, 0x2, 0x16600, 0x15e08, 0x8000
    .long 0x9c00, 0x1, 0xffff, 0xffff, 0xffff, 0x0, 0xffffffff, 0xffff
    .long 0x78706860, 0x80808080, 0x78706860, 0x78, 0x2, 0x16200, 0x7ff00000, 0xb800
    .long 0xd400, 0x1, 0xffffffff, 0xffffffff, 0xffffffff, 0x0, 0xffffffff, 0xffff
    .long 0x70686058, 0x80808078, 0x70686058, 0x78, 0x2, 0x15600, 0x15f00, 0x0
    .long 0x0, 0x2, 0xffffffff, 0xffffffff, 0xffffffff, 0x0, 0xffffffff, 0xffff
    .long 0x68605850, 0x80808070, 0x68605850, 0x70, 0x6, 0x14200, 0x15900, 0x0
    .long 0x0, 0x0, 0xffffffff, 0xffffffff, 0xffffffff, 0x0, 0xffffffff, 0xffff
    .long 0x60585048, 0x80808068, 0x60585048, 0x68, 0x4, 0x14600, 0x15b00, 0x0
    .long 0x0, 0x0, 0xffffffff, 0xffffffff, 0xffffffff, 0x0, 0xffffffff, 0xffff
    .long 0x58504840, 0x80808060, 0x58504840, 0x60, 0x4, 0x14a00, 0x15908, 0x0
    .long 0x0, 0x0, 0xffffffff, 0xffffffff, 0xffffffff, 0x0, 0xffffffff, 0xffff
    .long 0x50484038, 0x80808058, 0x50484038, 0x58, 0x4, 0x14e00, 0x15b08, 0x0
    .long 0x0, 0x0, 0xffffffff, 0xffffffff, 0xffffffff, 0x0, 0xffffffff, 0xffff
    .long 0x48403830, 0x80808050, 0x48403830, 0x50, 0x4, 0x15200, 0x15d00, 0x0
    .long 0x0, 0x0, 0xffffffff, 0xffffffff, 0xffffffff, 0x0, 0xffffffff, 0xffff
    .fill (40960 - (. - recurrent_scan__sliding_local_dilated__moe_arch_mod__prompt_kernel)) / 4, 4, 0xbf810000
.section .rodata,"a"
.p2align 6
.amdhsa_kernel recurrent_scan__sliding_local_dilated__moe_arch_mod__prompt_kernel
  .amdhsa_next_free_vgpr 256
  .amdhsa_next_free_sgpr 102
  .amdhsa_accum_offset 256
  .amdhsa_group_segment_fixed_size 0
  .amdhsa_kernarg_size 88
  .amdhsa_user_sgpr_count 2
  .amdhsa_user_sgpr_kernarg_segment_ptr 1
  .amdhsa_system_sgpr_workgroup_id_x 1
.end_amdhsa_kernel
```

```asm
; @launch grid=(256,1,1) block=(512,1,1) lds=163840
.amdgcn_target "amdgcn-amd-amdhsa--gfx950"
.text
.globl recurrent_scan__sliding_local_dilated__moe_arch_mod__prompt_kernel
.p2align 8
.type recurrent_scan__sliding_local_dilated__moe_arch_mod__prompt_kernel,@function
recurrent_scan__sliding_local_dilated__moe_arch_mod__prompt_kernel:
    s_load_dwordx2 s[24:25], s[0:1], 0
    s_load_dwordx2 s[32:33], s[0:1], 8
    s_load_dwordx2 s[28:29], s[0:1], 80
    s_cmpk_ge_u32 s2, 256
    s_cbranch_scc1 K_EXIT
    v_readfirstlane_b32 s3, v0
    s_getpc_b64 s[20:21]
K_PC:
    s_lshr_b32 s54, s2, 3
    s_lshl_b32 s60, s54, 10
    v_lshl_add_u32 v2, v0, 1, s60
    global_load_ushort v255, v2, s[20:21]
    s_mul_i32 s60, s54, 52
    s_lshr_b32 s60, s60, 8
    s_mul_i32 s53, s60, 5
    s_sub_u32 s53, s54, s53
    s_add_u32 s67, s60, s53
    s_bitcmp1_b32 s2, 1
    s_cselect_b32 s61, 5, 0
    s_add_u32 s56, s60, s61
    s_mulk_i32 s56, 104
    s_sub_u32 s56, s56, 8
    s_and_b32 s57, s2, 4
    s_mulk_i32 s57, 320
    s_bitcmp1_b32 s2, 0
    s_cselect_b32 s61, 5, 0
    s_add_u32 s58, s53, s61
    s_lshl_b32 s58, s58, 7
    s_mov_b32 s26, 2621440
    s_mov_b32 s27, 0x20000
    s_lshr_b32 s60, s3, 3
    s_max_u32 s60, s60, s54
    s_cmp_ge_u32 s60, 25
    s_cbranch_scc1 K_NL
    v_lshrrev_b32 v2, 3, v0
    v_add_u32 v3, s56, v2
    v_mul_i32_i24 v3, 2560, v3
    v_bitop3_b32 v1, v0, v2, 7 bitop3:0x28
    v_lshl_add_u32 v196, v1, 4, v3
    v_and_b32 v3, 2, v2
    v_lshrrev_b32 v1, 1, v2
    v_and_or_b32 v3, v1, 4, v3
    v_bitop3_b32 v3, v0, v3, 7 bitop3:0x28
    v_mul_u32_u24 v200, 3840, v2
    v_lshl_add_u32 v200, v3, 4, v200
    s_cmp_ge_u32 s67, 5
    s_cselect_b32 s61, 5, 0
    s_sub_u32 s67, s67, s61
    s_lshl_b32 s67, s67, 2
    s_and_b32 s68, s2, 6
    s_mul_i32 s68, s68, 5
    s_lshr_b32 s68, s68, 2
    s_lshl_b32 s69, s3, 4
    s_mov_b32 s34, 2457600
    s_mov_b32 s35, s27
    s_cmp_eq_u32 s3, 0
    s_cselect_b32 s70, 0xffffff00, -1
    s_cmpk_lt_u32 s69, 2048
    s_cselect_b64 vcc, -1, 0
    s_lshr_b32 s64, 66064, s67
    s_and_b32 s64, s64, 15
    s_add_u32 s64, s64, s68
    s_cmp_ge_u32 s64, 10
    s_cselect_b32 s65, 10, 0
    s_sub_u32 s64, s64, s65
    s_mul_i32 s65, s64, 245760
    s_lshl_b32 s64, s64, 7
    s_add_u32 s64, s64, s57
    s_add_u32 m0, s69, 77824
    s_mov_b32 exec_lo, s70
    s_waitcnt lgkmcnt(0)
    buffer_load_dwordx4 v196, s[24:27], s64 offen lds
    s_add_u32 m0, s69, 81920
    s_mov_b32 exec_lo, -1
    v_add_u32 v197, 81920, v196
    buffer_load_dwordx4 v197, s[24:27], s64 offen lds
    s_add_u32 m0, s69, 86016
    s_add_u32 s65, s65, s58
    v_add_u32 v198, 163840, v196
    buffer_load_dwordx4 v198, s[24:27], s64 offen lds
    v_add_u32 v199, 245760, v196
    s_cbranch_vccz L_SK0
    s_add_u32 m0, s69, 90112
    s_nop 0
    buffer_load_dwordx4 v199, s[24:27], s64 offen lds
L_SK0:
    s_add_u32 m0, s69, 92160
    s_add_u32 s66, s65, 122880
    buffer_load_dwordx4 v200, s[32:35], s65 offen offset:0 lds
    s_add_u32 m0, s69, 99072
    s_nop 0
    buffer_load_dwordx4 v200, s[32:35], s65 offen offset:1280 lds
    s_add_u32 m0, s69, 105984
    s_nop 0
    buffer_load_dwordx4 v200, s[32:35], s65 offen offset:2560 lds
    s_add_u32 m0, s69, 96256
    s_nop 0
    buffer_load_dwordx4 v200, s[32:35], s66 offen offset:0 lds
    s_add_u32 m0, s69, 103168
    s_nop 0
    buffer_load_dwordx4 v200, s[32:35], s66 offen offset:1280 lds
    s_add_u32 m0, s69, 110080
    s_nop 0
    buffer_load_dwordx4 v200, s[32:35], s66 offen offset:2560 lds
    s_branch L_CONT
K_NL:
    s_cmpk_ge_u32 s3, 256
    s_cbranch_scc1 K_ER
    s_sub_u32 s56, s2, 200
    s_mov_b32 s101, 1
    s_cmp_ge_u32 s56, 27
    s_cbranch_scc1 K_AUX
    s_load_dwordx2 s[48:49], s[0:1], 40
    s_load_dwordx2 s[36:37], s[0:1], 48
    v_lshrrev_b32 v2, 3, v0
    v_and_b32 v3, 2, v2
    v_lshrrev_b32 v1, 1, v2
    v_and_or_b32 v3, v1, 4, v3
    v_bitop3_b32 v3, v0, v3, 7 bitop3:0x28
    v_mul_u32_u24 v30, 3456, v2
    v_lshl_add_u32 v30, v3, 4, v30
    s_lshl_b32 s68, s56, 7
    s_lshl_b32 s69, s3, 4
    s_mov_b32 s70, 12
    s_mov_b32 s50, 2211840
    s_mov_b32 s51, 0x20000
    s_mov_b32 s38, 2211840
    s_mov_b32 s39, 0x20000
    s_waitcnt lgkmcnt(0)
FL_GU1:
    s_mov_b32 m0, s69
    s_sub_u32 s70, s70, 1
    buffer_load_dwordx4 v30, s[48:51], s68 offen nt lds
    s_add_u32 m0, s69, 16384
    s_add_u32 s69, s69, 4096
    buffer_load_dwordx4 v30, s[36:39], s68 offen nt lds
    s_add_u32 s68, s68, 110592
    s_and_b32 s60, s70, 3
    s_cselect_b32 s60, 0, 16384
    s_add_u32 s69, s69, s60
    s_cmp_lg_u32 s70, 0
    s_cbranch_scc1 FL_GU1
    s_mov_b32 s101, 5
    s_branch K_AUX
K_ER:
    s_setprio 3
    s_load_dwordx2 s[22:23], s[0:1], 32
    v_bfe_u32 v232, v0, 5, 3
    v_and_b32 v4, 31, v0
    v_mul_u32_u24 v7, 2560, v232
    v_lshlrev_b32 v5, 4, v4
    v_lshlrev_b32 v6, 3, v4
    v_add_u32 v8, v7, v6
    v_add_u32 v7, v7, v5
    s_and_b32 s68, s2, 3
    s_lshl_b32 s68, s68, 5
    s_add_u32 s68, s68, s54
    s_mul_i32 s69, s68, 20480
    s_add_u32 s69, s69, s57
    s_waitcnt lgkmcnt(0)
    buffer_load_dwordx4 v[212:215], v7, s[24:27], s69 offen
    buffer_load_dwordx4 v[216:219], v7, s[24:27], s69 offen offset:512
    buffer_load_dwordx2 v[220:221], v8, s[24:27], s69 offen offset:1024
    global_load_dwordx4 v[222:225], v5, s[22:23]
    global_load_dwordx4 v[226:229], v5, s[22:23] offset:512
    global_load_dwordx2 v[230:231], v6, s[22:23] offset:1024
    s_load_dword s52, s[28:29], 0
    s_mov_b32 s30, 7077888
    s_mov_b32 s31, 0x20000
    s_and_b32 s70, s2, 4
    s_lshl_b32 s70, s70, 5
    s_add_u32 s70, s70, s68
    s_lshl_b32 s71, s70, 6
    s_lshl_b32 s70, s70, 7
    s_add_u32 s70, s70, 16384
    s_add_u32 s71, s71, 49152
    s_setprio 0
    s_mov_b32 s101, 1
    s_cmp_ge_u32 s54, 25
    s_cbranch_scc1 K_AUX0
    s_mul_i32 s60, s3, 5
    s_lshl_b32 s61, s53, 6
    s_add_u32 s60, s60, s61
    s_add_u32 s60, s60, K_TAB-K_PC
    s_load_dwordx16 s[4:19], s[20:21], s60
    s_load_dwordx2 s[44:45], s[0:1], 64
    s_load_dwordx2 s[40:41], s[0:1], 16
    s_mov_b32 s46, 2621440
    s_mov_b32 s47, 0x20000
    s_mov_b32 s30, 7077888
    s_mov_b32 s31, 0x20000
    s_mov_b32 s42, 819200
    s_mov_b32 s43, 0x20000
    s_lshr_b32 s3, s3, 6
    s_and_b32 s59, s3, 3
    s_mov_b32 s55, 0xffff0000
    s_mov_b32 s100, 0
    v_and_b32 v1, 63, v0
    v_and_b32 v4, 15, v1
    v_lshrrev_b32 v5, 4, v1
    v_mov_b32 v19, 163584
    v_add_u32 v18, s3, v19
    v_mov_b32 v2, 0
    v_mov_b32 v3, 0
    v_mov_b32 v46, 0x00010100
    v_mov_b32 v47, 0x01000001
    ds_write2_b64 v19, v[2:3], v[46:47] offset1:1
    v_mov_b32 v45, 0x01010101
    ds_write2_b32 v19, v2, v45 offset0:4 offset1:5
    v_bfe_u32 v46, v0, 1, 7
    v_min_u32 v46, 111, v46
    v_mul_u32_u24 v46, 272, v46
    v_add_u32 v46, 116992, v46
    ds_write_b64 v46, v[2:3]
    s_min_u32 s60, s59, 2
    s_mul_i32 s60, s60, 38912
    v_and_b32 v46, 31, v0
    v_lshl_add_u32 v46, v46, 2, s60
    v_mov_b32 v47, 0x3f803f80
    ds_write_b32 v46, v47
    v_lshlrev_b32 v6, 4, v1
    v_mov_b32 v28, 0x3f803f80
    v_mov_b32 v29, 0x3f803f80
    v_mov_b32 v30, 0x3f803f80
    v_mov_b32 v31, 0x3f803f80
    v_lshlrev_b32 v2, 2, v5
    v_sub_u32 v3, v4, v2
    v_add_u32 v3, 12, v3
    s_mov_b32 s60, 267390975
    v_bfe_i32 v32, s60, v3, 1
    v_and_b32 v32, 0xff800000, v32
    s_mov_b32 s60, 268435440
    v_bfe_i32 v36, s60, v3, 1
    v_and_b32 v36, 0xff800000, v36
    s_mov_b32 s60, 266346495
    v_bfe_i32 v33, s60, v3, 1
    v_and_b32 v33, 0xff800000, v33
    s_mov_b32 s60, 268435424
    v_bfe_i32 v37, s60, v3, 1
    v_and_b32 v37, 0xff800000, v37
    s_mov_b32 s60, 264257535
    v_bfe_i32 v34, s60, v3, 1
    v_and_b32 v34, 0xff800000, v34
    s_mov_b32 s60, 268435392
    v_bfe_i32 v38, s60, v3, 1
    v_and_b32 v38, 0xff800000, v38
    s_mov_b32 s60, 260079615
    v_bfe_i32 v35, s60, v3, 1
    v_and_b32 v35, 0xff800000, v35
    s_mov_b32 s60, 268435328
    v_bfe_i32 v39, s60, v3, 1
    v_and_b32 v39, 0xff800000, v39
    v_sub_u32 v2, 13, v3
    v_med3_i32 v2, v2, 0, 2
    v_lshlrev_b32 v2, 3, v2
    v_mov_b32 v40, -1
    v_lshrrev_b32 v40, v2, v40
    v_lshrrev_b32 v40, v2, v40
    v_sub_u32 v2, 15, v3
    v_med3_i32 v2, v2, 0, 2
    v_lshlrev_b32 v2, 3, v2
    v_mov_b32 v41, -1
    v_lshrrev_b32 v41, v2, v41
    v_lshrrev_b32 v41, v2, v41
    v_mul_u32_u24 v25, 20224, v5
    v_add_u32 v25, v25, v6
    v_lshrrev_b32 v24, 5, v1
    v_mul_u32_u24 v24, 19968, v24
    v_add_u32 v24, v24, v6
    v_lshlrev_b32 v26, 4, v4
    v_add_u32 v26, 162568, v26
    v_bfe_u32 v2, v1, 2, 2
    v_lshlrev_b32 v2, 7, v2
    v_and_b32 v3, 8, v1
    v_lshl_add_u32 v2, v3, 2, v2
    v_and_b32 v3, 3, v1
    v_lshl_add_u32 v2, v3, 3, v2
    v_and_b32 v3, 48, v1
    s_mov_b32 s62, 0xffff
    s_mov_b32 s60, 201329216
    s_mov_b32 s61, 373298176
    v_lshrrev_b64 v[46:47], v3, s[60:61]
    v_and_or_b32 v9, v46, s62, v2
    s_mov_b32 s60, 37748736
    s_mov_b32 s61, 2550175296
    v_lshrrev_b64 v[46:47], v3, s[60:61]
    v_and_or_b32 v10, v46, s62, v2
    s_mov_b32 s60, 469766720
    s_mov_b32 s61, 977285120
    v_lshrrev_b64 v[46:47], v3, s[60:61]
    v_and_or_b32 v11, v46, s62, v2
    s_mov_b32 s60, 2483063360
    s_mov_b32 s61, 2654996480
    v_lshrrev_b64 v[46:47], v3, s[60:61]
    v_and_or_b32 v12, v46, s62, v2
    s_mov_b32 s60, 574627840
    s_mov_b32 s61, 2051045376
    v_lshrrev_b64 v[46:47], v3, s[60:61]
    v_and_or_b32 v13, v46, s62, v2
    s_mov_b32 s60, 1073757184
    s_mov_b32 s61, 1610635840
    v_lshrrev_b64 v[46:47], v3, s[60:61]
    v_and_or_b32 v14, v46, s62, v2
    s_mov_b32 s60, 1140858432
    s_mov_b32 s61, 2147507776
    v_lshrrev_b64 v[46:47], v3, s[60:61]
    v_and_or_b32 v15, v46, s62, v2
    v_lshrrev_b32 v2, 3, v1
    v_bitop3_b32 v3, v1, v2, 7 bitop3:0x28
    v_mul_u32_u24 v7, 2560, v2
    v_lshl_add_u32 v7, v3, 4, v7
    v_lshrrev_b32 v2, 5, v1
    v_bitop3_b32 v2, v2, v4, 7 bitop3:0x28
    v_lshlrev_b32 v8, 7, v4
    v_lshl_add_u32 v8, v2, 4, v8
    v_and_b32 v2, 1, v5
    v_lshl_add_u32 v8, v2, 3, v8
    v_bfe_u32 v2, v0, 3, 5
    v_and_b32 v3, 6, v2
    v_bitop3_b32 v3, v0, v3, 7 bitop3:0x28
    v_mul_u32_u24 v16, 1280, v2
    v_lshl_add_u32 v16, v3, 4, v16
    s_lshl_b32 s98, s56, 4
    s_mul_i32 s60, s57, 13
    s_add_u32 s98, s98, s60
    s_add_u32 s98, s98, 458880
    s_add_u32 s98, s98, s58
    s_cmp_eq_u32 s59, 0
    s_cselect_b32 s98, s98, 2146435072
    s_add_u32 s96, s56, 8
    s_mulk_i32 s96, 1408
    s_mul_i32 s60, s57, 1144
    s_add_u32 s96, s96, s60
    s_add_u32 s96, s96, 1048576
    s_and_b32 s62, s2, 1
    s_mulk_i32 s62, 10240
    s_add_u32 s62, s62, s96
    s_sub_u32 s63, s54, s53
    s_and_b32 s60, s2, 7
    s_mul_i32 s60, s60, 25
    s_add_u32 s63, s63, s60
    s_mulk_i32 s63, 11520
    s_add_u32 s63, s63, 4194304
    v_mul_u32_u24 v2, 272, v4
    v_add_u32 v2, 129792, v2
    v_lshlrev_b32 v3, 3, v5
    s_waitcnt lgkmcnt(0)
    s_mul_i32 s52, s52, 0x9E3779B1
    s_add_u32 s52, s52, 0x7F4A7C15
    s_or_b32 s52, s52, 1
    v_mov_b32 v46, s52
    ds_write_b32 v19, v46 offset:32
    v_bfe_u32 v20, s4, v3, 8
    v_bfe_u32 v21, s5, v3, 8
    v_add_u32 v20, v20, v2
    v_add_u32 v21, v21, v2
    v_lshrrev_b32 v2, 2, v1
    v_mul_u32_u24 v2, 136, v2
    v_add_u32 v2, 88448, v2
    v_add_u32 v23, s7, v2
    v_lshlrev_b32 v3, 3, v1
    v_bfe_u32 v22, s6, v3, 8
    v_add_u32 v22, v22, v2
    s_add_u32 s9, s9, s62
    s_add_u32 s10, s10, s62
    s_add_u32 s11, s11, s63
    s_add_u32 s12, s12, s63
    s_add_u32 s5, s9, 40960
    s_mul_i32 s60, s8, 20480
    s_add_u32 s96, s96, s60
    s_lshl4_add_u32 s95, s8, s56
    s_cmp_eq_u32 s8, 6
    s_cselect_b32 s101, 1, 2
    s_cmpk_ge_i32 s95, 1024
    s_cselect_b32 s101, 0, s101
    s_mul_i32 s97, s95, 2560
    s_add_u32 s97, s97, s57
    s_add_u32 s97, s97, s58
    s_add_u32 s94, s97, 20480
    s_cmp_eq_u32 s8, 0
    s_cselect_b32 s97, 2146435072, s97
    s_cselect_b32 s61, 2146435072, 0
    s_and_b32 s60, s2, 1
    s_lshl_b32 s60, s60, 1
    s_mul_i32 s22, s60, 204800
    s_sub_u32 s23, 409600, s22
    s_add_u32 s22, s22, s58
    s_add_u32 s23, s23, s58
    s_mulk_i32 s60, 5120
    s_sub_u32 s4, s96, s60
    s_add_u32 s4, s4, 10240
    s_add_u32 s96, s96, s60
    s_add_u32 s92, s96, 4096
    s_add_u32 s93, s92, 4096
    s_add_u32 s6, s4, 4096
    s_add_u32 s7, s6, 4096
    v_bfe_i32 v2, v1, 3, 1
    v_bfi_b32 v2, v2, 0, s61
    v_or_b32 v27, v2, v6
    s_and_b32 s60, s2, 4
    s_lshl_b32 s60, s60, 8
    s_add_u32 s95, s95, s60
    s_lshl_b32 s60, s8, 11
    s_add_u32 s60, s60, 147200
    v_add_u32 v8, s60, v8
    s_lshl_b32 s60, s8, 8
    s_add_u32 s60, s60, 161536
    v_lshl_add_u32 v17, v4, 4, s60
    v_bitop3_b32 v2, v5, v4, 7 bitop3:0x28
    v_lshlrev_b32 v2, 4, v2
    v_lshl_add_u32 v42, v4, 7, v2
    v_add_u32 v42, 77824, v42
    v_xor_b32 v43, 64, v42
    v_bfe_u32 v2, v1, 3, 2
    v_xor_b32 v2, s59, v2
    v_lshlrev_b32 v2, 5, v2
    v_lshl_add_u32 v2, v5, 10, v2
    v_bfe_u32 v3, v1, 2, 2
    v_lshl_add_u32 v2, v3, 7, v2
    v_and_b32 v3, 3, v1
    v_lshl_add_u32 v2, v3, 3, v2
    v_add_u32 v44, 92160, v2
    s_lshl_b32 s60, s59, 5
    s_add_u32 s60, s60, 116736
    v_mul_u32_u24 v46, 272, v4
    v_lshl_add_u32 v2, v5, 3, s60
    v_add_u32 v46, v46, v2
    v_mul_u32_u24 v47, 136, v4
    v_add_u32 v47, v47, v2
    v_subrev_u32 v47, 34816, v47
    v_lshlrev_b32 v45, 4, v4
    v_add_u32 v45, 161536, v45
    s_mov_b64 exec, 0
    s_branch TL0
TL0_END:
    s_mov_b64 exec, -1
    v_mov_b32 v241, 0x3f803f80
    v_mov_b32 v245, s52
    v_mov_b32 v247, s52
    s_bfe_u32 s60, s2, 0x10002
    s_lshl4_add_u32 s60, s68, s60
    s_sub_u32 s60, 0xffff, s60
    v_lshlrev_b32 v239, 1, v232
    v_sub_u32 v239, s60, v239
    v_lshlrev_b32 v243, 3, v232
    v_lshlrev_b32 v232, 4, v232
    v_mov_b32 v249, s52
    s_setprio 3
    s_waitcnt vmcnt(3)
    v_dot2_f32_bf16 v233, v212, v241, 0
    v_dot2_f32_bf16 v234, v212, v212, 0
    v_dot2_f32_bf16 v233, v213, v241, v233
    v_dot2_f32_bf16 v234, v213, v213, v234
    v_dot2_f32_bf16 v233, v214, v241, v233
    v_dot2_f32_bf16 v234, v214, v214, v234
    v_dot2_f32_bf16 v233, v215, v241, v233
    v_dot2_f32_bf16 v234, v215, v215, v234
    v_dot2_f32_bf16 v233, v216, v241, v233
    v_dot2_f32_bf16 v234, v216, v216, v234
    v_dot2_f32_bf16 v233, v217, v241, v233
    v_dot2_f32_bf16 v234, v217, v217, v234
    v_dot2_f32_bf16 v233, v218, v241, v233
    v_dot2_f32_bf16 v234, v218, v218, v234
    v_dot2_f32_bf16 v233, v219, v241, v233
    v_dot2_f32_bf16 v234, v219, v219, v234
    v_dot2_f32_bf16 v233, v220, v241, v233
    v_dot2_f32_bf16 v234, v220, v220, v234
    v_dot2_f32_bf16 v233, v221, v241, v233
    v_dot2_f32_bf16 v234, v221, v221, v234
    s_waitcnt vmcnt(0)
    v_dot2_f32_bf16 v235, v212, v222, 0
    v_dot2_f32_bf16 v236, v222, v241, 0
    v_dot2_f32_bf16 v235, v213, v223, v235
    v_dot2_f32_bf16 v236, v223, v241, v236
    v_dot2_f32_bf16 v235, v214, v224, v235
    v_dot2_f32_bf16 v236, v224, v241, v236
    v_dot2_f32_bf16 v235, v215, v225, v235
    v_dot2_f32_bf16 v236, v225, v241, v236
    v_dot2_f32_bf16 v235, v216, v226, v235
    v_dot2_f32_bf16 v236, v226, v241, v236
    v_dot2_f32_bf16 v235, v217, v227, v235
    v_dot2_f32_bf16 v236, v227, v241, v236
    v_dot2_f32_bf16 v235, v218, v228, v235
    v_dot2_f32_bf16 v236, v228, v241, v236
    v_dot2_f32_bf16 v235, v219, v229, v235
    v_dot2_f32_bf16 v236, v229, v241, v236
    v_dot2_f32_bf16 v235, v220, v230, v235
    v_dot2_f32_bf16 v236, v230, v241, v236
    v_dot2_f32_bf16 v235, v221, v231, v235
    v_dot2_f32_bf16 v236, v231, v241, v236
    v_permlane16_swap_b32 v233, v234
    v_add_f32 v233, v233, v234
    s_nop 0
    v_permlane16_swap_b32 v235, v236
    v_add_f32 v235, v235, v236
    v_add_f32_dpp v233, v233, v233 row_ror:8 row_mask:0xf bank_mask:0xf
    s_nop 0
    v_add_f32_dpp v235, v235, v235 row_ror:8 row_mask:0xf bank_mask:0xf
    v_add_f32_dpp v233, v233, v233 row_ror:4 row_mask:0xf bank_mask:0xf
    s_nop 0
    v_add_f32_dpp v235, v235, v235 row_ror:4 row_mask:0xf bank_mask:0xf
    v_add_f32_dpp v233, v233, v233 row_ror:2 row_mask:0xf bank_mask:0xf
    s_nop 0
    v_add_f32_dpp v235, v235, v235 row_ror:2 row_mask:0xf bank_mask:0xf
    v_add_f32_dpp v233, v233, v233 row_ror:1 row_mask:0xf bank_mask:0xf
    s_nop 0
    v_add_f32_dpp v235, v235, v235 row_ror:1 row_mask:0xf bank_mask:0xf
    v_mul_f32 v233, 0x3acccccd, v233
    v_mov_b32 v236, v235
    v_mov_b32 v234, v233
    s_nop 0
    v_permlane16_swap_b32 v235, v236
    v_permlane16_swap_b32 v233, v234
    v_fma_f32 v234, -v233, v233, v234
    v_max_f32 v234, 0, v234
    v_cvt_pk_bf16_f32 v237, v233, v234
    v_lshlrev_b32 v233, 16, v237
    v_and_b32 v234, 0xffff0000, v237
    v_add_f32 v234, 0x3727c5ac, v234
    v_cvt_pk_bf16_f32 v234, v234, v234
    v_lshlrev_b32 v234, 16, v234
    v_sqrt_f32 v234, v234
    v_fma_f32 v235, -v233, v236, v235
    v_cvt_pk_bf16_f32 v234, v234, v234
    v_lshlrev_b32 v234, 16, v234
    v_rcp_f32 v246, v234
    s_mov_b32 exec_lo, 1
    s_mov_b32 exec_hi, 1
    v_mul_f32 v235, v235, v246
    v_xor_b32 v244, 0x80000000, v233
    v_cvt_pk_bf16_f32 v235, v235, v235
    buffer_store_dwordx4 v[244:247], v232, s[28:31], s70 offen sc1
    v_ashrrev_i32 v237, 31, v235
    v_or_b32 v237, 0x80000000, v237
    v_xor_b32 v235, v235, v237
    v_bfi_b32 v248, s55, v235, v239
    buffer_store_dwordx2 v[248:249], v243, s[28:31], s71 offen sc1
    s_mov_b64 exec, -1
    s_setprio 0
    s_mov_b32 s63, 0
    s_mov_b32 s64, 77824
    s_mov_b32 s67, 38912
    s_waitcnt lgkmcnt(0)
    s_barrier
    ds_read_b64_tr_b16 v[132:133], v44 offset:0
    ds_read_b64_tr_b16 v[134:135], v44 offset:512
    ds_read_b128 v[156:159], v42 offset:0
    ds_read_b64_tr_b16 v[136:137], v44 offset:8192
    ds_read_b64_tr_b16 v[138:139], v44 offset:8704
    ds_read_b128 v[160:163], v42 offset:2048
    ds_read_b64_tr_b16 v[140:141], v44 offset:16384
    ds_read_b64_tr_b16 v[142:143], v44 offset:16896
    ds_read_b128 v[164:167], v42 offset:4096
    ds_read_b128 v[168:171], v42 offset:6144
    ds_read_b128 v[172:175], v42 offset:8192
    ds_read_b128 v[176:179], v42 offset:10240
    ds_read_b128 v[180:183], v42 offset:12288
    s_waitcnt lgkmcnt(10)
    v_mfma_f32_16x16x32_bf16 v[48:51], v[132:135], v[156:159], 0
    ds_read_b64_tr_b16 v[144:145], v44 offset:4096
    s_waitcnt lgkmcnt(9)
    v_mfma_f32_16x16x32_bf16 v[76:79], v[136:139], v[156:159], 0
    ds_read_b64_tr_b16 v[146:147], v44 offset:4608
    s_waitcnt lgkmcnt(9)
    v_mfma_f32_16x16x32_bf16 v[52:55], v[132:135], v[160:163], 0
    ds_read_b128 v[184:187], v43 offset:0
    v_mfma_f32_16x16x32_bf16 v[80:83], v[136:139], v[160:163], 0
    ds_read_b64_tr_b16 v[148:149], v44 offset:12288
    s_waitcnt lgkmcnt(9)
    v_mfma_f32_16x16x32_bf16 v[104:107], v[140:143], v[156:159], 0
    ds_read_b64_tr_b16 v[150:151], v44 offset:12800
    v_mfma_f32_16x16x32_bf16 v[108:111], v[140:143], v[160:163], 0
    ds_read_b128 v[188:191], v43 offset:2048
    s_waitcnt lgkmcnt(10)
    v_mfma_f32_16x16x32_bf16 v[56:59], v[132:135], v[164:167], 0
    ds_read_b64_tr_b16 v[152:153], v44 offset:20480
    v_mfma_f32_16x16x32_bf16 v[84:87], v[136:139], v[164:167], 0
    ds_read_b64_tr_b16 v[154:155], v44 offset:20992
    v_mfma_f32_16x16x32_bf16 v[112:115], v[140:143], v[164:167], 0
    ds_read_b128 v[192:195], v43 offset:4096
    s_waitcnt lgkmcnt(12)
    v_mfma_f32_16x16x32_bf16 v[60:63], v[132:135], v[168:171], 0
    ds_read_b128 v[196:199], v43 offset:6144
    v_mfma_f32_16x16x32_bf16 v[88:91], v[136:139], v[168:171], 0
    ds_read_b128 v[200:203], v43 offset:8192
    v_mfma_f32_16x16x32_bf16 v[116:119], v[140:143], v[168:171], 0
    ds_read_b128 v[204:207], v43 offset:10240
    s_waitcnt lgkmcnt(14)
    v_mfma_f32_16x16x32_bf16 v[64:67], v[132:135], v[172:175], 0
    ds_read_b128 v[208:211], v43 offset:12288
    v_mfma_f32_16x16x32_bf16 v[92:95], v[136:139], v[172:175], 0
    v_mfma_f32_16x16x32_bf16 v[120:123], v[140:143], v[172:175], 0
    s_cmp_eq_u32 s64, 77824
    s_cselect_b32 s66, 4294889472, s67
    s_waitcnt lgkmcnt(14)
    v_mfma_f32_16x16x32_bf16 v[68:71], v[132:135], v[176:179], 0
    s_add_u32 s64, s64, s66
    s_add_u32 s63, s63, 1
    v_mfma_f32_16x16x32_bf16 v[96:99], v[136:139], v[176:179], 0
    v_add_u32 v44, s66, v44
    v_mfma_f32_16x16x32_bf16 v[124:127], v[140:143], v[176:179], 0
    v_add_u32 v42, s66, v42
    s_waitcnt lgkmcnt(13)
    v_mfma_f32_16x16x32_bf16 v[72:75], v[132:135], v[180:183], 0
    v_add_u32 v43, s66, v43
    v_mfma_f32_16x16x32_bf16 v[100:103], v[136:139], v[180:183], 0
    s_cmp_lt_u32 s63, 9
    v_mfma_f32_16x16x32_bf16 v[128:131], v[140:143], v[180:183], 0
    s_branch C_MID
C_LOOP:
    s_waitcnt lgkmcnt(10)
    v_mfma_f32_16x16x32_bf16 v[48:51], v[132:135], v[156:159], v[48:51]
    ds_read_b64_tr_b16 v[144:145], v44 offset:4096
    s_waitcnt lgkmcnt(9)
    v_mfma_f32_16x16x32_bf16 v[76:79], v[136:139], v[156:159], v[76:79]
    ds_read_b64_tr_b16 v[146:147], v44 offset:4608
    s_waitcnt lgkmcnt(9)
    v_mfma_f32_16x16x32_bf16 v[52:55], v[132:135], v[160:163], v[52:55]
    ds_read_b128 v[184:187], v43 offset:0
    v_mfma_f32_16x16x32_bf16 v[80:83], v[136:139], v[160:163], v[80:83]
    ds_read_b64_tr_b16 v[148:149], v44 offset:12288
    s_waitcnt lgkmcnt(9)
    v_mfma_f32_16x16x32_bf16 v[104:107], v[140:143], v[156:159], v[104:107]
    ds_read_b64_tr_b16 v[150:151], v44 offset:12800
    v_mfma_f32_16x16x32_bf16 v[108:111], v[140:143], v[160:163], v[108:111]
    ds_read_b128 v[188:191], v43 offset:2048
    s_waitcnt lgkmcnt(10)
    v_mfma_f32_16x16x32_bf16 v[56:59], v[132:135], v[164:167], v[56:59]
    ds_read_b64_tr_b16 v[152:153], v44 offset:20480
    v_mfma_f32_16x16x32_bf16 v[84:87], v[136:139], v[164:167], v[84:87]
    ds_read_b64_tr_b16 v[154:155], v44 offset:20992
    v_mfma_f32_16x16x32_bf16 v[112:115], v[140:143], v[164:167], v[112:115]
    ds_read_b128 v[192:195], v43 offset:4096
    s_waitcnt lgkmcnt(12)
    v_mfma_f32_16x16x32_bf16 v[60:63], v[132:135], v[168:171], v[60:63]
    ds_read_b128 v[196:199], v43 offset:6144
    v_mfma_f32_16x16x32_bf16 v[88:91], v[136:139], v[168:171], v[88:91]
    ds_read_b128 v[200:203], v43 offset:8192
    v_mfma_f32_16x16x32_bf16 v[116:119], v[140:143], v[168:171], v[116:119]
    ds_read_b128 v[204:207], v43 offset:10240
    s_waitcnt lgkmcnt(14)
    v_mfma_f32_16x16x32_bf16 v[64:67], v[132:135], v[172:175], v[64:67]
    ds_read_b128 v[208:211], v43 offset:12288
    v_mfma_f32_16x16x32_bf16 v[92:95], v[136:139], v[172:175], v[92:95]
    v_mfma_f32_16x16x32_bf16 v[120:123], v[140:143], v[172:175], v[120:123]
    s_cmp_eq_u32 s64, 77824
    s_cselect_b32 s66, 4294889472, s67
    s_waitcnt lgkmcnt(14)
    v_mfma_f32_16x16x32_bf16 v[68:71], v[132:135], v[176:179], v[68:71]
    s_add_u32 s64, s64, s66
    s_add_u32 s63, s63, 1
    v_mfma_f32_16x16x32_bf16 v[96:99], v[136:139], v[176:179], v[96:99]
    v_add_u32 v44, s66, v44
    v_mfma_f32_16x16x32_bf16 v[124:127], v[140:143], v[176:179], v[124:127]
    v_add_u32 v42, s66, v42
    s_waitcnt lgkmcnt(13)
    v_mfma_f32_16x16x32_bf16 v[72:75], v[132:135], v[180:183], v[72:75]
    v_add_u32 v43, s66, v43
    v_mfma_f32_16x16x32_bf16 v[100:103], v[136:139], v[180:183], v[100:103]
    s_cmp_lt_u32 s63, 9
    v_mfma_f32_16x16x32_bf16 v[128:131], v[140:143], v[180:183], v[128:131]
C_MID:
    s_waitcnt lgkmcnt(0)
    v_mfma_f32_16x16x32_bf16 v[48:51], v[144:147], v[184:187], v[48:51]
    v_mfma_f32_16x16x32_bf16 v[76:79], v[148:151], v[184:187], v[76:79]
    v_mfma_f32_16x16x32_bf16 v[104:107], v[152:155], v[184:187], v[104:107]
    v_mfma_f32_16x16x32_bf16 v[108:111], v[152:155], v[188:191], v[108:111]
    v_mfma_f32_16x16x32_bf16 v[80:83], v[148:151], v[188:191], v[80:83]
    v_mfma_f32_16x16x32_bf16 v[52:55], v[144:147], v[188:191], v[52:55]
    s_barrier
    ds_read_b64_tr_b16 v[132:133], v44 offset:0
    v_mfma_f32_16x16x32_bf16 v[56:59], v[144:147], v[192:195], v[56:59]
    ds_read_b64_tr_b16 v[134:135], v44 offset:512
    v_mfma_f32_16x16x32_bf16 v[84:87], v[148:151], v[192:195], v[84:87]
    ds_read_b128 v[156:159], v42 offset:0
    v_mfma_f32_16x16x32_bf16 v[112:115], v[152:155], v[192:195], v[112:115]
    ds_read_b64_tr_b16 v[136:137], v44 offset:8192
    v_mfma_f32_16x16x32_bf16 v[116:119], v[152:155], v[196:199], v[116:119]
    ds_read_b64_tr_b16 v[138:139], v44 offset:8704
    v_mfma_f32_16x16x32_bf16 v[88:91], v[148:151], v[196:199], v[88:91]
    ds_read_b128 v[160:163], v42 offset:2048
    v_mfma_f32_16x16x32_bf16 v[60:63], v[144:147], v[196:199], v[60:63]
    ds_read_b64_tr_b16 v[140:141], v44 offset:16384
    v_mfma_f32_16x16x32_bf16 v[64:67], v[144:147], v[200:203], v[64:67]
    ds_read_b64_tr_b16 v[142:143], v44 offset:16896
    v_mfma_f32_16x16x32_bf16 v[92:95], v[148:151], v[200:203], v[92:95]
    ds_read_b128 v[164:167], v42 offset:4096
    v_mfma_f32_16x16x32_bf16 v[120:123], v[152:155], v[200:203], v[120:123]
    ds_read_b128 v[168:171], v42 offset:6144
    v_mfma_f32_16x16x32_bf16 v[124:127], v[152:155], v[204:207], v[124:127]
    ds_read_b128 v[172:175], v42 offset:8192
    v_mfma_f32_16x16x32_bf16 v[96:99], v[148:151], v[204:207], v[96:99]
    ds_read_b128 v[176:179], v42 offset:10240
    v_mfma_f32_16x16x32_bf16 v[68:71], v[144:147], v[204:207], v[68:71]
    ds_read_b128 v[180:183], v42 offset:12288
    v_mfma_f32_16x16x32_bf16 v[72:75], v[144:147], v[208:211], v[72:75]
    v_mfma_f32_16x16x32_bf16 v[100:103], v[148:151], v[208:211], v[100:103]
    v_mfma_f32_16x16x32_bf16 v[128:131], v[152:155], v[208:211], v[128:131]
    s_cbranch_scc1 C_LOOP
TL0:
    s_cbranch_execz TL0_END
    s_setprio 2
    s_waitcnt lgkmcnt(10)
    v_mfma_f32_16x16x32_bf16 v[48:51], v[132:135], v[156:159], v[48:51]
    ds_read_b64_tr_b16 v[144:145], v44 offset:4096
    s_waitcnt lgkmcnt(9)
    v_mfma_f32_16x16x32_bf16 v[76:79], v[136:139], v[156:159], v[76:79]
    ds_read_b64_tr_b16 v[146:147], v44 offset:4608
    s_waitcnt lgkmcnt(9)
    v_mfma_f32_16x16x32_bf16 v[52:55], v[132:135], v[160:163], v[52:55]
    ds_read_b64_tr_b16 v[148:149], v44 offset:12288
    v_mfma_f32_16x16x32_bf16 v[80:83], v[136:139], v[160:163], v[80:83]
    ds_read_b64_tr_b16 v[150:151], v44 offset:12800
    s_waitcnt lgkmcnt(8)
    v_mfma_f32_16x16x32_bf16 v[56:59], v[132:135], v[164:167], v[56:59]
    ds_read_b128 v[184:187], v43 offset:0
    v_mfma_f32_16x16x32_bf16 v[84:87], v[136:139], v[164:167], v[84:87]
    ds_read_b128 v[188:191], v43 offset:2048
    s_waitcnt lgkmcnt(9)
    v_mfma_f32_16x16x32_bf16 v[60:63], v[132:135], v[168:171], v[60:63]
    ds_read_b128 v[192:195], v43 offset:4096
    v_mfma_f32_16x16x32_bf16 v[88:91], v[136:139], v[168:171], v[88:91]
    ds_read_b128 v[196:199], v43 offset:6144
    s_waitcnt lgkmcnt(10)
    v_mfma_f32_16x16x32_bf16 v[64:67], v[132:135], v[172:175], v[64:67]
    ds_read_b128 v[200:203], v43 offset:8192
    v_mfma_f32_16x16x32_bf16 v[92:95], v[136:139], v[172:175], v[92:95]
    ds_read_b128 v[204:207], v43 offset:10240
    s_waitcnt lgkmcnt(11)
    v_mfma_f32_16x16x32_bf16 v[68:71], v[132:135], v[176:179], v[68:71]
    ds_read_b128 v[208:211], v43 offset:12288
    v_mfma_f32_16x16x32_bf16 v[96:99], v[136:139], v[176:179], v[96:99]
    ds_read_b128 v[212:215], v45 offset:0
    s_waitcnt lgkmcnt(12)
    v_mfma_f32_16x16x32_bf16 v[72:75], v[132:135], v[180:183], v[72:75]
    ds_read_b128 v[216:219], v45 offset:256
    v_mfma_f32_16x16x32_bf16 v[100:103], v[136:139], v[180:183], v[100:103]
    ds_read_b128 v[220:223], v45 offset:512
    s_waitcnt lgkmcnt(7)
    v_mfma_f32_16x16x32_bf16 v[48:51], v[144:147], v[184:187], v[48:51]
    ds_read_b64_tr_b16 v[152:153], v44 offset:20480
    v_mfma_f32_16x16x32_bf16 v[76:79], v[148:151], v[184:187], v[76:79]
    ds_read_b64_tr_b16 v[154:155], v44 offset:20992
    v_mfma_f32_16x16x32_bf16 v[52:55], v[144:147], v[188:191], v[52:55]
    ds_read_b128 v[224:227], v45 offset:768
    s_waitcnt lgkmcnt(3)
    v_mfma_f32_16x16x32_bf16 v[80:83], v[148:151], v[188:191], v[80:83]
    ds_read_b128 v[228:231], v45 offset:1024
    v_mov_b32_dpp v240, v48 row_newbcast:0 row_mask:0xf bank_mask:0xf
    v_mov_b32_dpp v241, v49 row_newbcast:0 row_mask:0xf bank_mask:0xf
    v_mfma_f32_16x16x32_bf16 v[56:59], v[144:147], v[192:195], v[56:59]
    ds_read_b128 v[232:235], v45 offset:1280
    v_mov_b32_dpp v242, v50 row_newbcast:0 row_mask:0xf bank_mask:0xf
    v_mov_b32_dpp v243, v51 row_newbcast:0 row_mask:0xf bank_mask:0xf
    v_mfma_f32_16x16x32_bf16 v[84:87], v[148:151], v[192:195], v[84:87]
    ds_read_b128 v[236:239], v45 offset:1536
    v_mov_b32_dpp v244, v76 row_newbcast:0 row_mask:0xf bank_mask:0xf
    v_mov_b32_dpp v245, v77 row_newbcast:0 row_mask:0xf bank_mask:0xf
    v_mfma_f32_16x16x32_bf16 v[60:63], v[144:147], v[196:199], v[60:63]
    v_mov_b32_dpp v246, v78 row_newbcast:0 row_mask:0xf bank_mask:0xf
    v_mov_b32_dpp v247, v79 row_newbcast:0 row_mask:0xf bank_mask:0xf
    v_mfma_f32_16x16x32_bf16 v[88:91], v[148:151], v[196:199], v[88:91]
    v_fmac_f32 v48, v212, v240
    v_fmac_f32 v49, v212, v241
    v_mfma_f32_16x16x32_bf16 v[64:67], v[144:147], v[200:203], v[64:67]
    v_fmac_f32 v50, v212, v242
    v_fmac_f32 v51, v212, v243
    s_waitcnt lgkmcnt(0)
    v_mfma_f32_16x16x32_bf16 v[92:95], v[148:151], v[200:203], v[92:95]
    v_cvt_pk_bf16_f32 v48, v48, v49
    v_cvt_pk_bf16_f32 v49, v50, v51
    v_mfma_f32_16x16x32_bf16 v[68:71], v[144:147], v[204:207], v[68:71]
    ds_write_b64 v46, v[48:49] offset:128
    v_fmac_f32 v76, v212, v244
    v_mfma_f32_16x16x32_bf16 v[96:99], v[148:151], v[204:207], v[96:99]
    v_fmac_f32 v77, v212, v245
    v_fmac_f32 v78, v212, v246
    v_mfma_f32_16x16x32_bf16 v[72:75], v[144:147], v[208:211], v[72:75]
    v_fmac_f32 v79, v212, v247
    v_mul_f32 v76, v76, v214
    v_mfma_f32_16x16x32_bf16 v[100:103], v[148:151], v[208:211], v[100:103]
    v_mul_f32 v77, v77, v214
    v_mul_f32 v78, v78, v214
    v_mfma_f32_16x16x32_bf16 v[104:107], v[140:143], v[156:159], v[104:107]
    v_mul_f32 v79, v79, v214
    v_cvt_pk_bf16_f32 v76, v76, v77
    v_mfma_f32_16x16x32_bf16 v[108:111], v[140:143], v[160:163], v[108:111]
    v_cvt_pk_bf16_f32 v77, v78, v79
    ds_write_b64 v46, v[76:77] offset:0
    v_mfma_f32_16x16x32_bf16 v[104:107], v[152:155], v[184:187], v[104:107]
    v_fmac_f32 v52, v216, v240
    v_fmac_f32 v53, v216, v241
    v_mfma_f32_16x16x32_bf16 v[108:111], v[152:155], v[188:191], v[108:111]
    v_fmac_f32 v54, v216, v242
    v_fmac_f32 v55, v216, v243
    v_mfma_f32_16x16x32_bf16 v[112:115], v[140:143], v[164:167], v[112:115]
    v_cvt_pk_bf16_f32 v52, v52, v53
    v_cvt_pk_bf16_f32 v53, v54, v55
    v_mfma_f32_16x16x32_bf16 v[116:119], v[140:143], v[168:171], v[116:119]
    ds_write_b64 v46, v[52:53] offset:4480
    v_fmac_f32 v80, v216, v244
    v_mfma_f32_16x16x32_bf16 v[112:115], v[152:155], v[192:195], v[112:115]
    v_fmac_f32 v81, v216, v245
    v_fmac_f32 v82, v216, v246
    v_mfma_f32_16x16x32_bf16 v[116:119], v[152:155], v[196:199], v[116:119]
    v_fmac_f32 v83, v216, v247
    v_mul_f32 v80, v80, v218
    v_mfma_f32_16x16x32_bf16 v[120:123], v[140:143], v[172:175], v[120:123]
    v_mul_f32 v81, v81, v218
    v_mul_f32 v82, v82, v218
    v_mfma_f32_16x16x32_bf16 v[124:127], v[140:143], v[176:179], v[124:127]
    v_mul_f32 v83, v83, v218
    v_cvt_pk_bf16_f32 v80, v80, v81
    v_mfma_f32_16x16x32_bf16 v[120:123], v[152:155], v[200:203], v[120:123]
    v_cvt_pk_bf16_f32 v81, v82, v83
    ds_write_b64 v46, v[80:81] offset:4352
    v_mfma_f32_16x16x32_bf16 v[124:127], v[152:155], v[204:207], v[124:127]
    v_fmac_f32 v56, v220, v240
    v_fmac_f32 v57, v220, v241
    v_mfma_f32_16x16x32_bf16 v[128:131], v[140:143], v[180:183], v[128:131]
    v_fmac_f32 v58, v220, v242
    v_fmac_f32 v59, v220, v243
    v_mfma_f32_16x16x32_bf16 v[128:131], v[152:155], v[208:211], v[128:131]
    v_cvt_pk_bf16_f32 v56, v56, v57
    v_cvt_pk_bf16_f32 v57, v58, v59
    ds_write_b64 v46, v[56:57] offset:8832
    v_fmac_f32 v84, v220, v244
    v_fmac_f32 v85, v220, v245
    v_fmac_f32 v86, v220, v246
    v_fmac_f32 v87, v220, v247
    v_mul_f32 v84, v84, v222
    v_mul_f32 v85, v85, v222
    v_mul_f32 v86, v86, v222
    v_mul_f32 v87, v87, v222
    v_cvt_pk_bf16_f32 v84, v84, v85
    v_cvt_pk_bf16_f32 v85, v86, v87
    ds_write_b64 v46, v[84:85] offset:8704
    v_pk_fma_f32 v[88:89], v[224:225], v[244:245], v[88:89] op_sel_hi:[0,1,1]
    v_pk_fma_f32 v[90:91], v[224:225], v[246:247], v[90:91] op_sel_hi:[0,1,1]
    v_pk_fma_f32 v[60:61], v[224:225], v[240:241], v[60:61] op_sel_hi:[0,1,1]
    v_pk_fma_f32 v[62:63], v[224:225], v[242:243], v[62:63] op_sel_hi:[0,1,1]
    v_pk_mul_f32 v[88:89], v[88:89], v[226:227] op_sel_hi:[1,0]
    v_pk_mul_f32 v[90:91], v[90:91], v[226:227] op_sel_hi:[1,0]
    v_cvt_pk_bf16_f32 v60, v60, v61
    v_cvt_pk_bf16_f32 v61, v62, v63
    ds_write_b64 v46, v[60:61] offset:13184
    v_cvt_pk_bf16_f32 v88, v88, v89
    v_cvt_pk_bf16_f32 v89, v90, v91
    ds_write_b64 v46, v[88:89] offset:13056
    v_pk_fma_f32 v[92:93], v[228:229], v[244:245], v[92:93] op_sel_hi:[0,1,1]
    v_pk_fma_f32 v[94:95], v[228:229], v[246:247], v[94:95] op_sel_hi:[0,1,1]
    v_pk_fma_f32 v[64:65], v[228:229], v[240:241], v[64:65] op_sel_hi:[0,1,1]
    v_pk_fma_f32 v[66:67], v[228:229], v[242:243], v[66:67] op_sel_hi:[0,1,1]
    v_pk_mul_f32 v[92:93], v[92:93], v[230:231] op_sel_hi:[1,0]
    v_pk_mul_f32 v[94:95], v[94:95], v[230:231] op_sel_hi:[1,0]
    v_cvt_pk_bf16_f32 v64, v64, v65
    v_cvt_pk_bf16_f32 v65, v66, v67
    ds_write_b64 v46, v[64:65] offset:17536
    v_cvt_pk_bf16_f32 v92, v92, v93
    v_cvt_pk_bf16_f32 v93, v94, v95
    ds_write_b64 v46, v[92:93] offset:17408
    v_pk_fma_f32 v[96:97], v[232:233], v[244:245], v[96:97] op_sel_hi:[0,1,1]
    v_pk_fma_f32 v[98:99], v[232:233], v[246:247], v[98:99] op_sel_hi:[0,1,1]
    v_pk_fma_f32 v[68:69], v[232:233], v[240:241], v[68:69] op_sel_hi:[0,1,1]
    v_pk_fma_f32 v[70:71], v[232:233], v[242:243], v[70:71] op_sel_hi:[0,1,1]
    v_pk_mul_f32 v[96:97], v[96:97], v[234:235] op_sel_hi:[1,0]
    v_pk_mul_f32 v[98:99], v[98:99], v[234:235] op_sel_hi:[1,0]
    v_cvt_pk_bf16_f32 v68, v68, v69
    v_cvt_pk_bf16_f32 v69, v70, v71
    ds_write_b64 v46, v[68:69] offset:21888
    v_cvt_pk_bf16_f32 v96, v96, v97
    v_cvt_pk_bf16_f32 v97, v98, v99
    ds_write_b64 v46, v[96:97] offset:21760
    v_pk_fma_f32 v[100:101], v[236:237], v[244:245], v[100:101] op_sel_hi:[0,1,1]
    v_pk_fma_f32 v[102:103], v[236:237], v[246:247], v[102:103] op_sel_hi:[0,1,1]
    v_pk_fma_f32 v[72:73], v[236:237], v[240:241], v[72:73] op_sel_hi:[0,1,1]
    v_pk_fma_f32 v[74:75], v[236:237], v[242:243], v[74:75] op_sel_hi:[0,1,1]
    v_pk_mul_f32 v[100:101], v[100:101], v[238:239] op_sel_hi:[1,0]
    v_pk_mul_f32 v[102:103], v[102:103], v[238:239] op_sel_hi:[1,0]
    v_cvt_pk_bf16_f32 v72, v72, v73
    v_cvt_pk_bf16_f32 v73, v74, v75
    ds_write_b64 v46, v[72:73] offset:26240
    v_cvt_pk_bf16_f32 v100, v100, v101
    v_cvt_pk_bf16_f32 v101, v102, v103
    ds_write_b64 v46, v[100:101] offset:26112
    s_waitcnt lgkmcnt(0)
    s_barrier
    s_cmp_eq_u32 s13, 1
    s_cbranch_scc1 AC_S
    ds_read_b64 v[80:81], v20 offset:0
    ds_read_b64 v[82:83], v21 offset:0
    ds_read_b64 v[64:65], v20 offset:4480
    ds_read_b64 v[66:67], v21 offset:4480
    ds_read_b64 v[84:85], v20 offset:4352
    ds_read_b64 v[86:87], v21 offset:4352
    ds_read_b64 v[68:69], v20 offset:8832
    ds_read_b64 v[70:71], v21 offset:8832
    ds_read_b64 v[88:89], v20 offset:8704
    ds_read_b64 v[90:91], v21 offset:8704
    ds_read_b64 v[72:73], v20 offset:13184
    ds_read_b64 v[74:75], v21 offset:13184
    ds_read_b64 v[92:93], v20 offset:13056
    ds_read_b64 v[94:95], v21 offset:13056
    v_lshl_add_u32 v3, v5, 8, v26
    v_mov_b32 v0, v27
    v_mov_b32_dpp v248, v104 row_newbcast:0 row_mask:0xf bank_mask:0xf
    v_mov_b32_dpp v249, v105 row_newbcast:0 row_mask:0xf bank_mask:0xf
    v_mov_b32_dpp v250, v106 row_newbcast:0 row_mask:0xf bank_mask:0xf
    v_mov_b32_dpp v251, v107 row_newbcast:0 row_mask:0xf bank_mask:0xf
    v_pk_fma_f32 v[104:105], v[212:213], v[248:249], v[104:105] op_sel_hi:[0,1,1]
    v_pk_fma_f32 v[106:107], v[212:213], v[250:251], v[106:107] op_sel_hi:[0,1,1]
    v_pk_fma_f32 v[108:109], v[216:217], v[248:249], v[108:109] op_sel_hi:[0,1,1]
    v_pk_fma_f32 v[110:111], v[216:217], v[250:251], v[110:111] op_sel_hi:[0,1,1]
    v_pk_mul_f32 v[104:105], v[104:105], v[214:215] op_sel_hi:[1,0]
    v_pk_mul_f32 v[106:107], v[106:107], v[214:215] op_sel_hi:[1,0]
    v_pk_mul_f32 v[108:109], v[108:109], v[218:219] op_sel_hi:[1,0]
    v_pk_mul_f32 v[110:111], v[110:111], v[218:219] op_sel_hi:[1,0]
    v_cvt_pk_bf16_f32 v104, v104, v105
    v_cvt_pk_bf16_f32 v105, v106, v107
    ds_write_b64 v47, v[104:105] offset:0
    v_cvt_pk_bf16_f32 v108, v108, v109
    v_cvt_pk_bf16_f32 v109, v110, v111
    ds_write_b64 v47, v[108:109] offset:2176
    s_waitcnt lgkmcnt(10)
    v_mfma_f32_16x16x32_bf16 v[168:171], v[84:87], v[64:67], v[32:35]
    v_mfma_f32_16x16x32_bf16 v[48:51], v[80:83], v[64:67], v[36:39]
    s_waitcnt lgkmcnt(6)
    v_mfma_f32_16x16x32_bf16 v[172:175], v[88:91], v[68:71], v[32:35]
    v_mfma_f32_16x16x32_bf16 v[52:55], v[84:87], v[68:71], v[36:39]
    s_waitcnt lgkmcnt(2)
    v_mfma_f32_16x16x32_bf16 v[176:179], v[92:95], v[72:75], v[32:35]
    v_mfma_f32_16x16x32_bf16 v[56:59], v[88:91], v[72:75], v[36:39]
    s_branch AC_J
AC_S:
    ds_read_b64 v[80:81], v20 offset:0
    ds_read_b64 v[64:65], v20 offset:4480
    ds_read_b64 v[84:85], v20 offset:4352
    ds_read_b64 v[68:69], v20 offset:8832
    ds_read_b64 v[88:89], v20 offset:8704
    ds_read_b64 v[72:73], v20 offset:13184
    ds_read_b64 v[92:93], v20 offset:13056
    v_lshl_add_u32 v3, v5, 8, v26
    v_mov_b32 v0, v27
    v_mov_b32_dpp v248, v104 row_newbcast:0 row_mask:0xf bank_mask:0xf
    v_mov_b32_dpp v249, v105 row_newbcast:0 row_mask:0xf bank_mask:0xf
    v_mov_b32_dpp v250, v106 row_newbcast:0 row_mask:0xf bank_mask:0xf
    v_mov_b32_dpp v251, v107 row_newbcast:0 row_mask:0xf bank_mask:0xf
    v_pk_fma_f32 v[104:105], v[212:213], v[248:249], v[104:105] op_sel_hi:[0,1,1]
    v_pk_fma_f32 v[106:107], v[212:213], v[250:251], v[106:107] op_sel_hi:[0,1,1]
    v_pk_fma_f32 v[108:109], v[216:217], v[248:249], v[108:109] op_sel_hi:[0,1,1]
    v_pk_fma_f32 v[110:111], v[216:217], v[250:251], v[110:111] op_sel_hi:[0,1,1]
    v_pk_mul_f32 v[104:105], v[104:105], v[214:215] op_sel_hi:[1,0]
    v_pk_mul_f32 v[106:107], v[106:107], v[214:215] op_sel_hi:[1,0]
    v_pk_mul_f32 v[108:109], v[108:109], v[218:219] op_sel_hi:[1,0]
    v_pk_mul_f32 v[110:111], v[110:111], v[218:219] op_sel_hi:[1,0]
    v_cvt_pk_bf16_f32 v104, v104, v105
    v_cvt_pk_bf16_f32 v105, v106, v107
    ds_write_b64 v47, v[104:105] offset:0
    v_cvt_pk_bf16_f32 v108, v108, v109
    v_cvt_pk_bf16_f32 v109, v110, v111
    ds_write_b64 v47, v[108:109] offset:2176
    s_waitcnt lgkmcnt(6)
    v_mfma_f32_16x16x16_bf16 v[168:171], v[84:85], v[64:65], v[32:35]
    v_mfma_f32_16x16x16_bf16 v[48:51], v[80:81], v[64:65], v[36:39]
    s_waitcnt lgkmcnt(4)
    v_mfma_f32_16x16x16_bf16 v[172:175], v[88:89], v[68:69], v[32:35]
    v_mfma_f32_16x16x16_bf16 v[52:55], v[84:85], v[68:69], v[36:39]
    s_waitcnt lgkmcnt(2)
    v_mfma_f32_16x16x16_bf16 v[176:179], v[92:93], v[72:73], v[32:35]
    v_mfma_f32_16x16x16_bf16 v[56:59], v[88:89], v[72:73], v[36:39]
AC_J:
    ds_read_b32 v27, v3
    ds_read2st64_b32 v[36:37], v26 offset1:1
    ds_read2st64_b32 v[38:39], v26 offset0:2 offset1:3
    v_max_f32 v168, v168, v48
    v_max_f32 v169, v169, v49
    v_max_f32 v170, v170, v50
    v_max_f32 v171, v171, v51
    v_max_f32 v172, v172, v52
    v_max_f32 v173, v173, v53
    v_max_f32 v174, v174, v54
    v_max_f32 v175, v175, v55
    v_max_f32 v176, v176, v56
    v_max_f32 v177, v177, v57
    v_max_f32 v178, v178, v58
    v_max_f32 v179, v179, v59
    s_cmp_lg_u32 s13, 1
    s_cbranch_scc1 AC_NS
    v_cvt_pk_bf16_f32 v64, v168, v169
    v_mov_b32 v65, s52
    v_cvt_pk_bf16_f32 v66, v170, v171
    v_mov_b32 v67, s52
    buffer_store_dwordx4 v[64:67], v6, s[28:31], s11 offen offset:0 sc1
    v_cvt_pk_bf16_f32 v68, v172, v173
    v_mov_b32 v69, s52
    v_cvt_pk_bf16_f32 v70, v174, v175
    v_mov_b32 v71, s52
    buffer_store_dwordx4 v[68:71], v6, s[28:31], s11 offen offset:1024 sc1
    v_cvt_pk_bf16_f32 v72, v176, v177
    v_mov_b32 v73, s52
    v_cvt_pk_bf16_f32 v74, v178, v179
    v_mov_b32 v75, s52
    buffer_store_dwordx4 v[72:75], v6, s[28:31], s11 offen offset:2048 sc1
AC_NS:
    v_pk_fma_f32 v[112:113], v[220:221], v[248:249], v[112:113] op_sel_hi:[0,1,1]
    v_pk_fma_f32 v[114:115], v[220:221], v[250:251], v[114:115] op_sel_hi:[0,1,1]
    v_pk_fma_f32 v[116:117], v[224:225], v[248:249], v[116:117] op_sel_hi:[0,1,1]
    v_pk_fma_f32 v[118:119], v[224:225], v[250:251], v[118:119] op_sel_hi:[0,1,1]
    v_pk_mul_f32 v[112:113], v[112:113], v[222:223] op_sel_hi:[1,0]
    v_pk_mul_f32 v[114:115], v[114:115], v[222:223] op_sel_hi:[1,0]
    v_pk_mul_f32 v[116:117], v[116:117], v[226:227] op_sel_hi:[1,0]
    v_pk_mul_f32 v[118:119], v[118:119], v[226:227] op_sel_hi:[1,0]
    v_cvt_pk_bf16_f32 v112, v112, v113
    v_cvt_pk_bf16_f32 v113, v114, v115
    ds_write_b64 v47, v[112:113] offset:4352
    v_cvt_pk_bf16_f32 v116, v116, v117
    v_cvt_pk_bf16_f32 v117, v118, v119
    ds_write_b64 v47, v[116:117] offset:6528
    v_pk_fma_f32 v[120:121], v[228:229], v[248:249], v[120:121] op_sel_hi:[0,1,1]
    v_pk_fma_f32 v[122:123], v[228:229], v[250:251], v[122:123] op_sel_hi:[0,1,1]
    v_pk_fma_f32 v[124:125], v[232:233], v[248:249], v[124:125] op_sel_hi:[0,1,1]
    v_pk_fma_f32 v[126:127], v[232:233], v[250:251], v[126:127] op_sel_hi:[0,1,1]
    v_pk_mul_f32 v[120:121], v[120:121], v[230:231] op_sel_hi:[1,0]
    v_pk_mul_f32 v[122:123], v[122:123], v[230:231] op_sel_hi:[1,0]
    v_pk_mul_f32 v[124:125], v[124:125], v[234:235] op_sel_hi:[1,0]
    v_pk_mul_f32 v[126:127], v[126:127], v[234:235] op_sel_hi:[1,0]
    v_cvt_pk_bf16_f32 v120, v120, v121
    v_cvt_pk_bf16_f32 v121, v122, v123
    ds_write_b64 v47, v[120:121] offset:8704
    v_cvt_pk_bf16_f32 v124, v124, v125
    v_cvt_pk_bf16_f32 v125, v126, v127
    ds_write_b64 v47, v[124:125] offset:10880
    v_pk_fma_f32 v[128:129], v[236:237], v[248:249], v[128:129] op_sel_hi:[0,1,1]
    v_pk_fma_f32 v[130:131], v[236:237], v[250:251], v[130:131] op_sel_hi:[0,1,1]
    v_pk_mul_f32 v[128:129], v[128:129], v[238:239] op_sel_hi:[1,0]
    v_pk_mul_f32 v[130:131], v[130:131], v[238:239] op_sel_hi:[1,0]
    v_cvt_pk_bf16_f32 v128, v128, v129
    v_cvt_pk_bf16_f32 v129, v130, v131
    ds_write_b64 v47, v[128:129] offset:13056
    s_waitcnt lgkmcnt(0)
    s_barrier
    ds_read_b64_tr_b16 v[184:185], v22 offset:0
    ds_read_b64_tr_b16 v[194:195], v23 offset:0
    ds_read_b64_tr_b16 v[186:187], v22 offset:2176
    ds_read_b64_tr_b16 v[196:197], v23 offset:2176
    ds_read_b64_tr_b16 v[188:189], v22 offset:4352
    ds_read_b64_tr_b16 v[198:199], v23 offset:4352
    ds_read_b64_tr_b16 v[190:191], v22 offset:6528
    ds_read_b64_tr_b16 v[200:201], v23 offset:6528
    s_cbranch_scc0 AC_X
AC_SM:
    v_max3_f32 v136, v168, v169, v170
    v_max3_f32 v138, v172, v173, v174
    v_max3_f32 v140, v176, v177, v178
    v_max_f32 v136, v136, v171
    v_max_f32 v138, v138, v175
    v_max_f32 v140, v140, v179
    s_nop 1
    v_permlane32_swap_b32 v136, v140
    v_permlane32_swap_b32 v138, v142
    v_max_f32 v136, v136, v140
    v_max_f32 v138, v138, v142
    v_mul_f32 v27, 0x3ea52b5c, v27
    s_nop 0
    v_permlane16_swap_b32 v136, v138
    v_max_f32 v136, v136, v138
    v_mul_f32 v138, v136, v27
    v_mul_f32 v136, v136, v27
    v_mul_f32 v32, 0x3ea52b5c, v36
    v_mul_f32 v34, 0x3ea52b5c, v37
    v_permlane16_swap_b32 v136, v138
    v_mov_b32 v140, v136
    v_mov_b32 v142, v138
    v_mul_f32 v36, 0x3ea52b5c, v38
    v_permlane32_swap_b32 v136, v140
    v_permlane32_swap_b32 v138, v142
    v_pk_fma_f32 v[168:169], v[168:169], v[32:33], v[136:137] op_sel_hi:[1,0,0] neg_lo:[0,0,1] neg_hi:[0,0,1]
    v_pk_fma_f32 v[170:171], v[170:171], v[32:33], v[136:137] op_sel_hi:[1,0,0] neg_lo:[0,0,1] neg_hi:[0,0,1]
    v_pk_fma_f32 v[172:173], v[172:173], v[34:35], v[138:139] op_sel_hi:[1,0,0] neg_lo:[0,0,1] neg_hi:[0,0,1]
    v_pk_fma_f32 v[174:175], v[174:175], v[34:35], v[138:139] op_sel_hi:[1,0,0] neg_lo:[0,0,1] neg_hi:[0,0,1]
    v_pk_fma_f32 v[176:177], v[176:177], v[36:37], v[140:141] op_sel_hi:[1,0,0] neg_lo:[0,0,1] neg_hi:[0,0,1]
    v_pk_fma_f32 v[178:179], v[178:179], v[36:37], v[140:141] op_sel_hi:[1,0,0] neg_lo:[0,0,1] neg_hi:[0,0,1]
    v_exp_f32 v168, v168
    v_exp_f32 v169, v169
    v_exp_f32 v170, v170
    v_exp_f32 v171, v171
    v_cvt_pk_bf16_f32 v2, v168, v169
    v_cvt_pk_bf16_f32 v3, v170, v171
    v_bfi_b32 v168, v40, 0, v2
    v_bfi_b32 v169, v41, 0, v3
    v_and_b32 v170, v40, v2
    v_and_b32 v171, v41, v3
    s_waitcnt lgkmcnt(0)
    v_exp_f32 v172, v172
    v_mfma_f32_16x16x32_bf16 v[116:119], v[28:31], v[168:171], 0
    v_exp_f32 v173, v173
    v_mfma_f32_16x16x32_bf16 v[136:139], v[184:187], v[168:171], 0
    v_exp_f32 v174, v174
    v_mfma_f32_16x16x32_bf16 v[152:155], v[194:197], v[168:171], 0
    v_exp_f32 v175, v175
    v_cvt_pk_bf16_f32 v2, v172, v173
    v_cvt_pk_bf16_f32 v3, v174, v175
    v_bfi_b32 v172, v40, 0, v2
    v_bfi_b32 v173, v41, 0, v3
    v_and_b32 v174, v40, v2
    v_and_b32 v175, v41, v3
    v_rcp_f32 v32, v116
    v_exp_f32 v176, v176
    v_mfma_f32_16x16x32_bf16 v[120:123], v[28:31], v[172:175], 0
    v_exp_f32 v177, v177
    v_mfma_f32_16x16x32_bf16 v[140:143], v[186:189], v[172:175], 0
    v_exp_f32 v178, v178
    v_mfma_f32_16x16x32_bf16 v[156:159], v[196:199], v[172:175], 0
    v_exp_f32 v179, v179
    v_cvt_pk_bf16_f32 v2, v176, v177
    v_cvt_pk_bf16_f32 v3, v178, v179
    v_bfi_b32 v176, v40, 0, v2
    v_bfi_b32 v177, v41, 0, v3
    v_and_b32 v178, v40, v2
    v_and_b32 v179, v41, v3
    v_rcp_f32 v34, v120
    v_mul_f32 v136, v136, v32
    v_mfma_f32_16x16x32_bf16 v[116:119], v[28:31], v[176:179], 0
    v_mul_f32 v137, v137, v32
    v_mfma_f32_16x16x32_bf16 v[144:147], v[188:191], v[176:179], 0
    v_mul_f32 v138, v138, v32
    v_mfma_f32_16x16x32_bf16 v[160:163], v[198:201], v[176:179], 0
    v_mul_f32 v139, v139, v32
    v_cvt_pk_bf16_f32 v136, v136, v137
    v_cvt_pk_bf16_f32 v137, v138, v139
    v_mul_f32 v140, v140, v34
    v_mul_f32 v141, v141, v34
    v_mul_f32 v142, v142, v34
    v_mul_f32 v143, v143, v34
    v_cvt_pk_bf16_f32 v138, v140, v141
    v_cvt_pk_bf16_f32 v139, v142, v143
    v_rcp_f32 v36, v116
    v_permlane32_swap_b32 v136, v138
    v_permlane32_swap_b32 v137, v139
    v_pk_mul_f32 v[144:145], v[144:145], v[36:37] op_sel_hi:[1,0]
    v_pk_mul_f32 v[146:147], v[146:147], v[36:37] op_sel_hi:[1,0]
    v_cvt_pk_bf16_f32 v144, v144, v145
    v_cvt_pk_bf16_f32 v145, v146, v147
    s_mov_b64 exec, s[14:15]
    buffer_store_dwordx4 v[136:139], v24, s[28:31], s9 offen sc1
    s_mov_b64 exec, -1
    v_permlane32_swap_b32 v144, v146
    v_permlane32_swap_b32 v145, v147
    v_pk_mul_f32 v[152:153], v[152:153], v[32:33] op_sel_hi:[1,0]
    v_pk_mul_f32 v[154:155], v[154:155], v[32:33] op_sel_hi:[1,0]
    s_mov_b64 exec, s[16:17]
    buffer_store_dwordx4 v[144:147], v24, s[28:31], s5 offen sc1
    s_lshl_b64 exec, -1, 16
    v_pk_mul_f32 v[152:153], v[156:157], v[34:35] op_sel_hi:[1,0]
    v_pk_mul_f32 v[154:155], v[158:159], v[34:35] op_sel_hi:[1,0]
    s_lshl_b64 exec, -1, 32
    v_pk_mul_f32 v[152:153], v[160:161], v[36:37] op_sel_hi:[1,0]
    v_pk_mul_f32 v[154:155], v[162:163], v[36:37] op_sel_hi:[1,0]
    s_mov_b64 exec, s[18:19]
    v_cvt_pk_bf16_f32 v152, v152, v153
    v_cvt_pk_bf16_f32 v153, v154, v155
    buffer_store_dwordx2 v[152:153], v25, s[28:31], s10 offen sc1
    s_mov_b64 exec, -1
A_DONE:
TC1:
    s_cbranch_execz TC2
    s_cmp_lg_u32 s13, 0
    s_cbranch_scc1 P_TAIL
    s_setprio 1
    v_mov_b32 v2, 1
    ds_write_b8 v18, v2 offset:0
    s_cmp_eq_u32 s101, 0
    s_cbranch_scc1 K_END
    ds_read_b64 v[2:3], v19 offset:16
G2_ZA:
    s_waitcnt lgkmcnt(0)
    v_and_b32 v2, v2, v3
    v_cmp_ne_u32 vcc, 0x01010101, v2
    s_cbranch_vccnz G2_ZAR
G2_ZAOK:
    v_xor_b32 v28, 32, v8
    v_xor_b32 v29, 64, v8
    v_xor_b32 v30, 96, v8
    ds_read_b64 v[48:49], v8 offset:0
    ds_read_b64 v[50:51], v28 offset:0
    ds_read_b64 v[52:53], v29 offset:0
    ds_read_b64 v[54:55], v30 offset:0
    ds_read_b64 v[56:57], v8 offset:2048
    ds_read_b64 v[58:59], v28 offset:2048
    ds_read_b64 v[60:61], v29 offset:2048
    ds_read_b64 v[62:63], v30 offset:2048
    s_cmp_eq_u32 s101, 2
    s_cselect_b32 s60, 0, 2146435072
    s_add_u32 s60, s60, 20480
    v_add_u32 v31, s60, v6
    s_mov_b32 s100, 0
    v_xor_b32 v28, 32, v9
    v_xor_b32 v29, 64, v9
    v_xor_b32 v30, 96, v9
    ds_read_b64_tr_b16 v[160:161], v9 offset:0
    ds_read_b64_tr_b16 v[164:165], v28 offset:0
    ds_read_b64_tr_b16 v[168:169], v29 offset:0
    ds_read_b64_tr_b16 v[172:173], v30 offset:0
    ds_read_b64_tr_b16 v[162:163], v9 offset:1024
    ds_read_b64_tr_b16 v[166:167], v28 offset:1024
    ds_read_b64_tr_b16 v[170:171], v29 offset:1024
    ds_read_b64_tr_b16 v[174:175], v30 offset:1024
    s_waitcnt lgkmcnt(8)
    v_lshlrev_b32 v64, 16, v48
    ds_read_b64_tr_b16 v[176:177], v29 offset:7680
    v_and_b32 v65, 0xffff0000, v48
    ds_read_b64_tr_b16 v[180:181], v30 offset:7680
    v_lshlrev_b32 v66, 16, v49
    ds_read_b64_tr_b16 v[184:185], v9 offset:7680
    v_and_b32 v67, 0xffff0000, v49
    ds_read_b64_tr_b16 v[188:189], v28 offset:7680
    v_lshlrev_b32 v68, 16, v50
    ds_read_b64_tr_b16 v[178:179], v29 offset:8704
    v_and_b32 v69, 0xffff0000, v50
    ds_read_b64_tr_b16 v[182:183], v30 offset:8704
    v_lshlrev_b32 v70, 16, v51
    ds_read_b64_tr_b16 v[186:187], v9 offset:8704
    v_and_b32 v71, 0xffff0000, v51
    ds_read_b64_tr_b16 v[190:191], v28 offset:8704
    v_lshlrev_b32 v72, 16, v52
    ds_read_b64_tr_b16 v[192:193], v9 offset:15360
    v_and_b32 v73, 0xffff0000, v52
    ds_read_b64_tr_b16 v[196:197], v28 offset:15360
    v_lshlrev_b32 v74, 16, v53
    ds_read_b64_tr_b16 v[200:201], v29 offset:15360
    v_and_b32 v75, 0xffff0000, v53
    ds_read_b64_tr_b16 v[204:205], v30 offset:15360
    v_lshlrev_b32 v76, 16, v54
    ds_read_b64_tr_b16 v[194:195], v9 offset:16384
    v_and_b32 v77, 0xffff0000, v54
    ds_read_b64_tr_b16 v[198:199], v28 offset:16384
    v_lshlrev_b32 v78, 16, v55
    ds_read_b64_tr_b16 v[202:203], v29 offset:16384
    v_and_b32 v79, 0xffff0000, v55
    ds_read_b64_tr_b16 v[206:207], v30 offset:16384
    v_lshlrev_b32 v80, 16, v56
    ds_read_b64_tr_b16 v[208:209], v29 offset:23040
    v_and_b32 v81, 0xffff0000, v56
    ds_read_b64_tr_b16 v[212:213], v30 offset:23040
    v_lshlrev_b32 v82, 16, v57
    ds_read_b64_tr_b16 v[216:217], v9 offset:23040
    v_and_b32 v83, 0xffff0000, v57
    ds_read_b64_tr_b16 v[220:221], v28 offset:23040
    v_lshlrev_b32 v84, 16, v58
    ds_read_b64_tr_b16 v[210:211], v29 offset:24064
    v_and_b32 v85, 0xffff0000, v58
    ds_read_b64_tr_b16 v[214:215], v30 offset:24064
    v_lshlrev_b32 v86, 16, v59
    ds_read_b64_tr_b16 v[218:219], v9 offset:24064
    v_and_b32 v87, 0xffff0000, v59
    ds_read_b64_tr_b16 v[222:223], v28 offset:24064
    v_lshlrev_b32 v88, 16, v60
    ds_read_b64_tr_b16 v[224:225], v9 offset:30720
    buffer_load_dwordx4 v[96:99], v0, s[28:31], s96 offen offset:0 sc1
    buffer_load_dwordx4 v[100:103], v31, s[28:31], s96 offen offset:0 sc1
    buffer_load_dwordx4 v[104:107], v0, s[28:31], s96 offen offset:1024 sc1
    buffer_load_dwordx4 v[108:111], v31, s[28:31], s96 offen offset:1024 sc1
    buffer_load_dwordx4 v[112:115], v0, s[28:31], s96 offen offset:2048 sc1
    buffer_load_dwordx4 v[116:119], v31, s[28:31], s96 offen offset:2048 sc1
    buffer_load_dwordx4 v[120:123], v0, s[28:31], s96 offen offset:3072 sc1
    buffer_load_dwordx4 v[124:127], v31, s[28:31], s96 offen offset:3072 sc1
    buffer_load_dwordx4 v[128:131], v0, s[28:31], s92 offen offset:0 sc1
    buffer_load_dwordx4 v[132:135], v31, s[28:31], s92 offen offset:0 sc1
    v_and_b32 v89, 0xffff0000, v60
    ds_read_b64_tr_b16 v[228:229], v28 offset:30720
    v_lshlrev_b32 v90, 16, v61
    ds_read_b64_tr_b16 v[232:233], v29 offset:30720
    v_and_b32 v91, 0xffff0000, v61
    ds_read_b64_tr_b16 v[236:237], v30 offset:30720
    v_lshlrev_b32 v92, 16, v62
    ds_read_b64_tr_b16 v[226:227], v9 offset:31744
    v_and_b32 v93, 0xffff0000, v62
    ds_read_b64_tr_b16 v[230:231], v28 offset:31744
    v_lshlrev_b32 v94, 16, v63
    ds_read_b64_tr_b16 v[234:235], v29 offset:31744
    v_and_b32 v95, 0xffff0000, v63
    ds_read_b64_tr_b16 v[238:239], v30 offset:31744
    v_xor_b32 v28, 32, v10
    v_xor_b32 v29, 64, v10
    v_xor_b32 v30, 96, v10
    ds_read_b64_tr_b16 v[240:241], v10 offset:0
    ds_read_b64_tr_b16 v[244:245], v28 offset:0
    ds_read_b64_tr_b16 v[248:249], v29 offset:0
    ds_read_b64_tr_b16 v[252:253], v30 offset:0
    ds_read_b64_tr_b16 v[242:243], v10 offset:1024
    ds_read_b64_tr_b16 v[246:247], v28 offset:1024
    ds_read_b64_tr_b16 v[250:251], v29 offset:1024
    ds_read_b64_tr_b16 v[254:255], v30 offset:1024
    s_waitcnt vmcnt(8)
    v_max3_u32 v2, v96, v98, v100
    v_max_u32 v2, v2, v102
    v_cmp_eq_u32 vcc, -1, v2
    s_waitcnt lgkmcnt(15)
    s_cbranch_vccnz G2_R0
G2_OK0:
    v_mfma_f32_16x16x32_bf16 v[32:35], v[160:163], v[96:99], 0
    buffer_load_dwordx4 v[136:139], v0, s[28:31], s92 offen offset:1024 sc1
    v_mfma_f32_16x16x32_bf16 v[48:51], v[160:163], v[100:103], 0
    s_waitcnt vmcnt(7)
    v_mfma_f32_16x16x32_bf16 v[36:39], v[164:167], v[96:99], 0
    v_max3_u32 v2, v104, v106, v108
    v_mfma_f32_16x16x32_bf16 v[52:55], v[164:167], v[100:103], 0
    v_max_u32 v2, v2, v110
    v_mfma_f32_16x16x32_bf16 v[40:43], v[168:171], v[96:99], 0
    buffer_load_dwordx4 v[140:143], v31, s[28:31], s92 offen offset:1024 sc1
    v_mfma_f32_16x16x32_bf16 v[56:59], v[168:171], v[100:103], 0
    v_cmp_eq_u32 vcc, -1, v2
    v_mfma_f32_16x16x32_bf16 v[44:47], v[172:175], v[96:99], 0
    s_waitcnt lgkmcnt(15)
    v_mfma_f32_16x16x32_bf16 v[60:63], v[172:175], v[100:103], 0
    s_cbranch_vccnz G2_R1
G2_OK1:
    v_mfma_f32_16x16x32_bf16 v[32:35], v[176:179], v[104:107], v[32:35]
    v_xor_b32 v28, 32, v11
    v_xor_b32 v29, 64, v11
    buffer_load_dwordx4 v[144:147], v0, s[28:31], s92 offen offset:2048 sc1
    v_mfma_f32_16x16x32_bf16 v[48:51], v[176:179], v[108:111], v[48:51]
    v_xor_b32 v30, 96, v11
    s_waitcnt vmcnt(7)
    v_mfma_f32_16x16x32_bf16 v[36:39], v[180:183], v[104:107], v[36:39]
    ds_read_b64_tr_b16 v[160:161], v11 offset:0
    ds_read_b64_tr_b16 v[164:165], v28 offset:0
    v_max3_u32 v2, v112, v114, v116
    v_mfma_f32_16x16x32_bf16 v[52:55], v[180:183], v[108:111], v[52:55]
    ds_read_b64_tr_b16 v[168:169], v29 offset:0
    v_max_u32 v2, v2, v118
    v_mfma_f32_16x16x32_bf16 v[40:43], v[184:187], v[104:107], v[40:43]
    ds_read_b64_tr_b16 v[172:173], v30 offset:0
    buffer_load_dwordx4 v[148:151], v31, s[28:31], s92 offen offset:2048 sc1
    v_mfma_f32_16x16x32_bf16 v[56:59], v[184:187], v[108:111], v[56:59]
    ds_read_b64_tr_b16 v[162:163], v11 offset:15360
    ds_read_b64_tr_b16 v[166:167], v28 offset:15360
    v_cmp_eq_u32 vcc, -1, v2
    v_mfma_f32_16x16x32_bf16 v[44:47], v[188:191], v[104:107], v[44:47]
    ds_read_b64_tr_b16 v[170:171], v29 offset:15360
    s_waitcnt lgkmcnt(15)
    v_mfma_f32_16x16x32_bf16 v[60:63], v[188:191], v[108:111], v[60:63]
    ds_read_b64_tr_b16 v[174:175], v30 offset:15360
    s_cbranch_vccnz G2_R2
G2_OK2:
    v_mfma_f32_16x16x32_bf16 v[32:35], v[192:195], v[112:115], v[32:35]
    v_add_u32 v9, 40960, v9
    v_xor_b32 v28, 32, v9
    buffer_load_dwordx4 v[152:155], v0, s[28:31], s4 offen offset:0 sc1
    v_mfma_f32_16x16x32_bf16 v[48:51], v[192:195], v[116:119], v[48:51]
    v_xor_b32 v29, 64, v9
    s_waitcnt vmcnt(7)
    v_mfma_f32_16x16x32_bf16 v[36:39], v[196:199], v[112:115], v[36:39]
    v_xor_b32 v30, 96, v9
    ds_read_b64_tr_b16 v[176:177], v9 offset:0
    v_max3_u32 v2, v120, v122, v124
    v_mfma_f32_16x16x32_bf16 v[52:55], v[196:199], v[116:119], v[52:55]
    ds_read_b64_tr_b16 v[180:181], v28 offset:0
    v_max_u32 v2, v2, v126
    v_mfma_f32_16x16x32_bf16 v[40:43], v[200:203], v[112:115], v[40:43]
    ds_read_b64_tr_b16 v[184:185], v29 offset:0
    ds_read_b64_tr_b16 v[188:189], v30 offset:0
    buffer_load_dwordx4 v[156:159], v31, s[28:31], s4 offen offset:0 sc1
    v_mfma_f32_16x16x32_bf16 v[56:59], v[200:203], v[116:119], v[56:59]
    ds_read_b64_tr_b16 v[178:179], v9 offset:1024
    v_cmp_eq_u32 vcc, -1, v2
    v_mfma_f32_16x16x32_bf16 v[44:47], v[204:207], v[112:115], v[44:47]
    ds_read_b64_tr_b16 v[182:183], v28 offset:1024
    ds_read_b64_tr_b16 v[186:187], v29 offset:1024
    s_waitcnt lgkmcnt(15)
    v_mfma_f32_16x16x32_bf16 v[60:63], v[204:207], v[116:119], v[60:63]
    ds_read_b64_tr_b16 v[190:191], v30 offset:1024
    s_cbranch_vccnz G2_R3
G2_OK3:
    v_mfma_f32_16x16x32_bf16 v[32:35], v[208:211], v[120:123], v[32:35]
    ds_read_b64_tr_b16 v[192:193], v29 offset:7680
    buffer_load_dwordx4 v[96:99], v0, s[28:31], s4 offen offset:1024 sc1
    v_mfma_f32_16x16x32_bf16 v[48:51], v[208:211], v[124:127], v[48:51]
    ds_read_b64_tr_b16 v[196:197], v30 offset:7680
    s_waitcnt vmcnt(7)
    v_mfma_f32_16x16x32_bf16 v[36:39], v[212:215], v[120:123], v[36:39]
    ds_read_b64_tr_b16 v[200:201], v9 offset:7680
    v_max3_u32 v2, v128, v130, v132
    v_mfma_f32_16x16x32_bf16 v[52:55], v[212:215], v[124:127], v[52:55]
    ds_read_b64_tr_b16 v[204:205], v28 offset:7680
    v_max_u32 v2, v2, v134
    v_mfma_f32_16x16x32_bf16 v[40:43], v[216:219], v[120:123], v[40:43]
    ds_read_b64_tr_b16 v[194:195], v29 offset:8704
    buffer_load_dwordx4 v[100:103], v31, s[28:31], s4 offen offset:1024 sc1
    v_mfma_f32_16x16x32_bf16 v[56:59], v[216:219], v[124:127], v[56:59]
    ds_read_b64_tr_b16 v[198:199], v30 offset:8704
    v_cmp_eq_u32 vcc, -1, v2
    v_mfma_f32_16x16x32_bf16 v[44:47], v[220:223], v[120:123], v[44:47]
    ds_read_b64_tr_b16 v[202:203], v9 offset:8704
    s_waitcnt lgkmcnt(15)
    v_mfma_f32_16x16x32_bf16 v[60:63], v[220:223], v[124:127], v[60:63]
    ds_read_b64_tr_b16 v[206:207], v28 offset:8704
    s_cbranch_vccnz G2_R4
G2_OK4:
    v_mfma_f32_16x16x32_bf16 v[32:35], v[224:227], v[128:131], v[32:35]
    ds_read_b64_tr_b16 v[208:209], v9 offset:15360
    buffer_load_dwordx4 v[104:107], v0, s[28:31], s4 offen offset:2048 sc1
    v_mfma_f32_16x16x32_bf16 v[48:51], v[224:227], v[132:135], v[48:51]
    ds_read_b64_tr_b16 v[212:213], v28 offset:15360
    s_waitcnt vmcnt(7)
    v_mfma_f32_16x16x32_bf16 v[36:39], v[228:231], v[128:131], v[36:39]
    ds_read_b64_tr_b16 v[216:217], v29 offset:15360
    v_max3_u32 v2, v136, v138, v140
    v_mfma_f32_16x16x32_bf16 v[52:55], v[228:231], v[132:135], v[52:55]
    ds_read_b64_tr_b16 v[220:221], v30 offset:15360
    v_max_u32 v2, v2, v142
    v_mfma_f32_16x16x32_bf16 v[40:43], v[232:235], v[128:131], v[40:43]
    ds_read_b64_tr_b16 v[210:211], v9 offset:16384
    buffer_load_dwordx4 v[108:111], v31, s[28:31], s4 offen offset:2048 sc1
    v_mfma_f32_16x16x32_bf16 v[56:59], v[232:235], v[132:135], v[56:59]
    ds_read_b64_tr_b16 v[214:215], v28 offset:16384
    v_cmp_eq_u32 vcc, -1, v2
    v_mfma_f32_16x16x32_bf16 v[44:47], v[236:239], v[128:131], v[44:47]
    ds_read_b64_tr_b16 v[218:219], v29 offset:16384
    s_waitcnt lgkmcnt(15)
    v_mfma_f32_16x16x32_bf16 v[60:63], v[236:239], v[132:135], v[60:63]
    ds_read_b64_tr_b16 v[222:223], v30 offset:16384
    s_cbranch_vccnz G2_R5
G2_OK5:
    v_mfma_f32_16x16x32_bf16 v[32:35], v[240:243], v[136:139], v[32:35]
    ds_read_b64_tr_b16 v[224:225], v29 offset:23040
    buffer_load_dwordx4 v[112:115], v0, s[28:31], s4 offen offset:3072 sc1
    v_mfma_f32_16x16x32_bf16 v[48:51], v[240:243], v[140:143], v[48:51]
    ds_read_b64_tr_b16 v[228:229], v30 offset:23040
    s_waitcnt vmcnt(7)
    v_mfma_f32_16x16x32_bf16 v[36:39], v[244:247], v[136:139], v[36:39]
    ds_read_b64_tr_b16 v[232:233], v9 offset:23040
    v_max3_u32 v2, v144, v146, v148
    v_mfma_f32_16x16x32_bf16 v[52:55], v[244:247], v[140:143], v[52:55]
    ds_read_b64_tr_b16 v[236:237], v28 offset:23040
    v_max_u32 v2, v2, v150
    v_mfma_f32_16x16x32_bf16 v[40:43], v[248:251], v[136:139], v[40:43]
    ds_read_b64_tr_b16 v[226:227], v29 offset:24064
    buffer_load_dwordx4 v[116:119], v31, s[28:31], s4 offen offset:3072 sc1
    v_mfma_f32_16x16x32_bf16 v[56:59], v[248:251], v[140:143], v[56:59]
    ds_read_b64_tr_b16 v[230:231], v30 offset:24064
    v_cmp_eq_u32 vcc, -1, v2
    v_mfma_f32_16x16x32_bf16 v[44:47], v[252:255], v[136:139], v[44:47]
    ds_read_b64_tr_b16 v[234:235], v9 offset:24064
    s_waitcnt lgkmcnt(15)
    v_mfma_f32_16x16x32_bf16 v[60:63], v[252:255], v[140:143], v[60:63]
    ds_read_b64_tr_b16 v[238:239], v28 offset:24064
    s_cbranch_vccnz G2_R6
G2_OK6:
    v_mfma_f32_16x16x32_bf16 v[32:35], v[160:163], v[144:147], v[32:35]
    ds_read_b64_tr_b16 v[240:241], v9 offset:30720
    buffer_load_dwordx4 v[120:123], v0, s[28:31], s6 offen offset:0 sc1
    v_mfma_f32_16x16x32_bf16 v[48:51], v[160:163], v[148:151], v[48:51]
    ds_read_b64_tr_b16 v[244:245], v28 offset:30720
    s_waitcnt vmcnt(7)
    v_mfma_f32_16x16x32_bf16 v[36:39], v[164:167], v[144:147], v[36:39]
    ds_read_b64_tr_b16 v[248:249], v29 offset:30720
    v_max3_u32 v2, v152, v154, v156
    v_mfma_f32_16x16x32_bf16 v[52:55], v[164:167], v[148:151], v[52:55]
    ds_read_b64_tr_b16 v[252:253], v30 offset:30720
    v_max_u32 v2, v2, v158
    v_mfma_f32_16x16x32_bf16 v[40:43], v[168:171], v[144:147], v[40:43]
    ds_read_b64_tr_b16 v[242:243], v9 offset:31744
    buffer_load_dwordx4 v[124:127], v31, s[28:31], s6 offen offset:0 sc1
    v_mfma_f32_16x16x32_bf16 v[56:59], v[168:171], v[148:151], v[56:59]
    ds_read_b64_tr_b16 v[246:247], v28 offset:31744
    v_cmp_eq_u32 vcc, -1, v2
    v_mfma_f32_16x16x32_bf16 v[44:47], v[172:175], v[144:147], v[44:47]
    ds_read_b64_tr_b16 v[250:251], v29 offset:31744
    s_waitcnt lgkmcnt(15)
    v_mfma_f32_16x16x32_bf16 v[60:63], v[172:175], v[148:151], v[60:63]
    ds_read_b64_tr_b16 v[254:255], v30 offset:31744
    s_cbranch_vccnz G2_R7
G2_OK7:
    v_mfma_f32_16x16x32_bf16 v[32:35], v[176:179], v[152:155], v[32:35]
    ds_read_b64 v[24:25], v19 offset:0
    v_xor_b32 v28, 32, v10
    buffer_load_dwordx4 v[128:131], v0, s[28:31], s6 offen offset:1024 sc1
    v_mfma_f32_16x16x32_bf16 v[48:51], v[176:179], v[156:159], v[48:51]
    v_xor_b32 v29, 64, v10
    s_waitcnt vmcnt(7)
    v_mfma_f32_16x16x32_bf16 v[36:39], v[180:183], v[152:155], v[36:39]
    v_xor_b32 v30, 96, v10
    ds_read_b64_tr_b16 v[160:161], v10 offset:40960
    v_max3_u32 v2, v96, v98, v100
    v_mfma_f32_16x16x32_bf16 v[52:55], v[180:183], v[156:159], v[52:55]
    ds_read_b64_tr_b16 v[164:165], v28 offset:40960
    v_max_u32 v2, v2, v102
    v_mfma_f32_16x16x32_bf16 v[40:43], v[184:187], v[152:155], v[40:43]
    ds_read_b64_tr_b16 v[168:169], v29 offset:40960
    ds_read_b64_tr_b16 v[172:173], v30 offset:40960
    buffer_load_dwordx4 v[132:135], v31, s[28:31], s6 offen offset:1024 sc1
    v_mfma_f32_16x16x32_bf16 v[56:59], v[184:187], v[156:159], v[56:59]
    ds_read_b64_tr_b16 v[162:163], v10 offset:41984
    v_cmp_eq_u32 vcc, -1, v2
    v_mfma_f32_16x16x32_bf16 v[44:47], v[188:191], v[152:155], v[44:47]
    ds_read_b64_tr_b16 v[166:167], v28 offset:41984
    ds_read_b64_tr_b16 v[170:171], v29 offset:41984
    s_waitcnt lgkmcnt(7)
    v_mfma_f32_16x16x32_bf16 v[60:63], v[188:191], v[156:159], v[60:63]
    ds_read_b64_tr_b16 v[174:175], v30 offset:41984
    s_cbranch_vccnz G2_R8
G2_OK8:
    v_mfma_f32_16x16x32_bf16 v[32:35], v[192:195], v[96:99], v[32:35]
    v_xor_b32 v28, 32, v11
    v_xor_b32 v29, 64, v11
    v_and_b32 v3, v24, v25
    v_cmp_ne_u32 vcc, 0x01010101, v3
    v_mfma_f32_16x16x32_bf16 v[48:51], v[192:195], v[100:103], v[48:51]
    v_xor_b32 v30, 96, v11
    buffer_load_dwordx4 v[136:139], v0, s[28:31], s6 offen offset:2048 sc1
    s_waitcnt vmcnt(7)
    v_mfma_f32_16x16x32_bf16 v[36:39], v[196:199], v[96:99], v[36:39]
    ds_read_b64_tr_b16 v[176:177], v11 offset:40960
    ds_read_b64_tr_b16 v[180:181], v28 offset:40960
    s_cbranch_vccnz G2_ZLR
G2_ZLOK:
    v_mfma_f32_16x16x32_bf16 v[52:55], v[196:199], v[100:103], v[52:55]
    ds_read_b64_tr_b16 v[184:185], v29 offset:40960
    v_max3_u32 v2, v104, v106, v108
    v_max_u32 v2, v2, v110
    v_mfma_f32_16x16x32_bf16 v[40:43], v[200:203], v[96:99], v[40:43]
    ds_read_b64_tr_b16 v[188:189], v30 offset:40960
    buffer_load_dwordx4 v[140:143], v31, s[28:31], s6 offen offset:2048 sc1
    v_mfma_f32_16x16x32_bf16 v[56:59], v[200:203], v[100:103], v[56:59]
    ds_read_b64_tr_b16 v[178:179], v11 offset:56320
    ds_read_b64_tr_b16 v[182:183], v28 offset:56320
    v_cmp_eq_u32 vcc, -1, v2
    v_mfma_f32_16x16x32_bf16 v[44:47], v[204:207], v[96:99], v[44:47]
    ds_read_b64_tr_b16 v[186:187], v29 offset:56320
    v_mfma_f32_16x16x32_bf16 v[60:63], v[204:207], v[100:103], v[60:63]
    ds_read_b64_tr_b16 v[190:191], v30 offset:56320
    s_cbranch_vccnz G2_R9
G2_OK9:
    v_mfma_f32_16x16x32_bf16 v[32:35], v[208:211], v[104:107], v[32:35]
    v_xor_b32 v28, 32, v13
    v_xor_b32 v29, 64, v13
    v_mfma_f32_16x16x32_bf16 v[48:51], v[208:211], v[108:111], v[48:51]
    v_xor_b32 v30, 96, v13
    s_waitcnt vmcnt(6)
    v_mfma_f32_16x16x32_bf16 v[36:39], v[212:215], v[104:107], v[36:39]
    ds_read_b64_tr_b16 v[192:193], v13 offset:0
    ds_read_b64_tr_b16 v[196:197], v28 offset:0
    v_max3_u32 v2, v112, v114, v116
    v_mfma_f32_16x16x32_bf16 v[52:55], v[212:215], v[108:111], v[52:55]
    ds_read_b64_tr_b16 v[200:201], v29 offset:0
    v_max_u32 v2, v2, v118
    v_mfma_f32_16x16x32_bf16 v[40:43], v[216:219], v[104:107], v[40:43]
    ds_read_b64_tr_b16 v[204:205], v30 offset:0
    v_mfma_f32_16x16x32_bf16 v[56:59], v[216:219], v[108:111], v[56:59]
    ds_read_b64_tr_b16 v[194:195], v13 offset:1024
    ds_read_b64_tr_b16 v[198:199], v28 offset:1024
    v_cmp_eq_u32 vcc, -1, v2
    v_mfma_f32_16x16x32_bf16 v[44:47], v[220:223], v[104:107], v[44:47]
    ds_read_b64_tr_b16 v[202:203], v29 offset:1024
    v_mfma_f32_16x16x32_bf16 v[60:63], v[220:223], v[108:111], v[60:63]
    ds_read_b64_tr_b16 v[206:207], v30 offset:1024
    s_cbranch_vccnz G2_R10
G2_OK10:
    v_mfma_f32_16x16x32_bf16 v[32:35], v[224:227], v[112:115], v[32:35]
    ds_read_b64_tr_b16 v[208:209], v13 offset:40960
    v_mfma_f32_16x16x32_bf16 v[48:51], v[224:227], v[116:119], v[48:51]
    ds_read_b64_tr_b16 v[212:213], v28 offset:40960
    s_waitcnt vmcnt(4)
    v_mfma_f32_16x16x32_bf16 v[36:39], v[228:231], v[112:115], v[36:39]
    ds_read_b64_tr_b16 v[216:217], v29 offset:40960
    v_max3_u32 v2, v120, v122, v124
    v_mfma_f32_16x16x32_bf16 v[52:55], v[228:231], v[116:119], v[52:55]
    ds_read_b64_tr_b16 v[220:221], v30 offset:40960
    v_max_u32 v2, v2, v126
    v_mfma_f32_16x16x32_bf16 v[40:43], v[232:235], v[112:115], v[40:43]
    ds_read_b64_tr_b16 v[210:211], v13 offset:41984
    v_mfma_f32_16x16x32_bf16 v[56:59], v[232:235], v[116:119], v[56:59]
    ds_read_b64_tr_b16 v[214:215], v28 offset:41984
    v_cmp_eq_u32 vcc, -1, v2
    v_mfma_f32_16x16x32_bf16 v[44:47], v[236:239], v[112:115], v[44:47]
    ds_read_b64_tr_b16 v[218:219], v29 offset:41984
    v_mfma_f32_16x16x32_bf16 v[60:63], v[236:239], v[116:119], v[60:63]
    ds_read_b64_tr_b16 v[222:223], v30 offset:41984
    s_cbranch_vccnz G2_R11
G2_OK11:
    v_mfma_f32_16x16x32_bf16 v[32:35], v[240:243], v[120:123], v[32:35]
    v_xor_b32 v28, 32, v14
    v_xor_b32 v29, 64, v14
    buffer_load_dwordx4 v[144:147], v0, s[28:31], s93 offen offset:0 sc1
    buffer_load_dwordx4 v[148:151], v31, s[28:31], s93 offen offset:0 sc1
    v_mfma_f32_16x16x32_bf16 v[48:51], v[240:243], v[124:127], v[48:51]
    v_xor_b32 v30, 96, v14
    s_waitcnt vmcnt(4)
    v_mfma_f32_16x16x32_bf16 v[36:39], v[244:247], v[120:123], v[36:39]
    ds_read_b64_tr_b16 v[224:225], v14 offset:0
    ds_read_b64_tr_b16 v[228:229], v28 offset:0
    v_max3_u32 v2, v128, v130, v132
    v_mfma_f32_16x16x32_bf16 v[52:55], v[244:247], v[124:127], v[52:55]
    ds_read_b64_tr_b16 v[232:233], v29 offset:0
    v_max_u32 v2, v2, v134
    v_mfma_f32_16x16x32_bf16 v[40:43], v[248:251], v[120:123], v[40:43]
    ds_read_b64_tr_b16 v[236:237], v30 offset:0
    buffer_load_dwordx4 v[152:155], v0, s[28:31], s7 offen offset:0 sc1
    buffer_load_dwordx4 v[156:159], v31, s[28:31], s7 offen offset:0 sc1
    v_mfma_f32_16x16x32_bf16 v[56:59], v[248:251], v[124:127], v[56:59]
    ds_read_b64_tr_b16 v[226:227], v29 offset:512
    ds_read_b64_tr_b16 v[230:231], v30 offset:512
    v_cmp_eq_u32 vcc, -1, v2
    v_mfma_f32_16x16x32_bf16 v[44:47], v[252:255], v[120:123], v[44:47]
    ds_read_b64_tr_b16 v[234:235], v14 offset:512
    s_waitcnt lgkmcnt(15)
    v_mfma_f32_16x16x32_bf16 v[60:63], v[252:255], v[124:127], v[60:63]
    ds_read_b64_tr_b16 v[238:239], v28 offset:512
    s_cbranch_vccnz G2_R12
G2_OK12:
    v_mfma_f32_16x16x32_bf16 v[32:35], v[160:163], v[128:131], v[32:35]
    ds_read_b64_tr_b16 v[240:241], v14 offset:40960
    buffer_load_dwordx4 v[96:99], v0, s[28:31], s93 offen offset:1024 sc1
    buffer_load_dwordx4 v[100:103], v31, s[28:31], s93 offen offset:1024 sc1
    v_mfma_f32_16x16x32_bf16 v[48:51], v[160:163], v[132:135], v[48:51]
    ds_read_b64_tr_b16 v[244:245], v28 offset:40960
    s_waitcnt vmcnt(6)
    v_mfma_f32_16x16x32_bf16 v[36:39], v[164:167], v[128:131], v[36:39]
    ds_read_b64_tr_b16 v[248:249], v29 offset:40960
    v_max3_u32 v2, v136, v138, v140
    v_mfma_f32_16x16x32_bf16 v[52:55], v[164:167], v[132:135], v[52:55]
    ds_read_b64_tr_b16 v[252:253], v30 offset:40960
    v_max_u32 v2, v2, v142
    v_mfma_f32_16x16x32_bf16 v[40:43], v[168:171], v[128:131], v[40:43]
    ds_read_b64_tr_b16 v[242:243], v29 offset:41472
    buffer_load_dwordx4 v[104:107], v0, s[28:31], s7 offen offset:1024 sc1
    buffer_load_dwordx4 v[108:111], v31, s[28:31], s7 offen offset:1024 sc1
    v_mfma_f32_16x16x32_bf16 v[56:59], v[168:171], v[132:135], v[56:59]
    ds_read_b64_tr_b16 v[246:247], v30 offset:41472
    v_cmp_eq_u32 vcc, -1, v2
    v_mfma_f32_16x16x32_bf16 v[44:47], v[172:175], v[128:131], v[44:47]
    ds_read_b64_tr_b16 v[250:251], v14 offset:41472
    s_waitcnt lgkmcnt(15)
    v_mfma_f32_16x16x32_bf16 v[60:63], v[172:175], v[132:135], v[60:63]
    ds_read_b64_tr_b16 v[254:255], v28 offset:41472
    s_cbranch_vccnz G2_R13
G2_OK13:
    v_mfma_f32_16x16x32_bf16 v[32:35], v[176:179], v[136:139], v[32:35]
    v_xor_b32 v28, 32, v12
    v_xor_b32 v29, 64, v12
    buffer_load_dwordx4 v[112:115], v0, s[28:31], s92 offen offset:3072 sc1
    v_mfma_f32_16x16x32_bf16 v[48:51], v[176:179], v[140:143], v[48:51]
    v_xor_b32 v30, 96, v12
    ds_read_b64_tr_b16 v[160:161], v12 offset:0
    s_waitcnt vmcnt(7)
    v_mfma_f32_16x16x32_bf16 v[36:39], v[180:183], v[136:139], v[36:39]
    ds_read_b64_tr_b16 v[164:165], v28 offset:0
    ds_read_b64_tr_b16 v[168:169], v29 offset:0
    v_max3_u32 v2, v144, v146, v148
    v_mfma_f32_16x16x32_bf16 v[52:55], v[180:183], v[140:143], v[52:55]
    ds_read_b64_tr_b16 v[172:173], v30 offset:0
    v_max_u32 v2, v2, v150
    v_mfma_f32_16x16x32_bf16 v[40:43], v[184:187], v[136:139], v[40:43]
    v_xor_b32 v28, 32, v15
    v_xor_b32 v29, 64, v15
    buffer_load_dwordx4 v[116:119], v31, s[28:31], s92 offen offset:3072 sc1
    v_mfma_f32_16x16x32_bf16 v[56:59], v[184:187], v[140:143], v[56:59]
    v_xor_b32 v30, 96, v15
    ds_read_b64_tr_b16 v[162:163], v15 offset:0
    v_cmp_eq_u32 vcc, -1, v2
    v_mfma_f32_16x16x32_bf16 v[44:47], v[188:191], v[136:139], v[44:47]
    ds_read_b64_tr_b16 v[166:167], v28 offset:0
    ds_read_b64_tr_b16 v[170:171], v29 offset:0
    s_waitcnt lgkmcnt(15)
    v_mfma_f32_16x16x32_bf16 v[60:63], v[188:191], v[140:143], v[60:63]
    ds_read_b64_tr_b16 v[174:175], v30 offset:0
    s_cbranch_vccnz G2_R14
G2_OK14:
    v_mfma_f32_16x16x32_bf16 v[32:35], v[192:195], v[144:147], v[32:35]
    v_xor_b32 v28, 32, v12
    v_xor_b32 v29, 64, v12
    buffer_load_dwordx4 v[120:123], v0, s[28:31], s6 offen offset:3072 sc1
    v_mfma_f32_16x16x32_bf16 v[48:51], v[192:195], v[148:151], v[48:51]
    v_xor_b32 v30, 96, v12
    ds_read_b64_tr_b16 v[176:177], v12 offset:40960
    s_waitcnt vmcnt(7)
    v_mfma_f32_16x16x32_bf16 v[36:39], v[196:199], v[144:147], v[36:39]
    ds_read_b64_tr_b16 v[180:181], v28 offset:40960
    ds_read_b64_tr_b16 v[184:185], v29 offset:40960
    v_max3_u32 v2, v152, v154, v156
    v_mfma_f32_16x16x32_bf16 v[52:55], v[196:199], v[148:151], v[52:55]
    ds_read_b64_tr_b16 v[188:189], v30 offset:40960
    v_max_u32 v2, v2, v158
    v_mfma_f32_16x16x32_bf16 v[40:43], v[200:203], v[144:147], v[40:43]
    v_xor_b32 v28, 32, v15
    v_xor_b32 v29, 64, v15
    buffer_load_dwordx4 v[124:127], v31, s[28:31], s6 offen offset:3072 sc1
    v_mfma_f32_16x16x32_bf16 v[56:59], v[200:203], v[148:151], v[56:59]
    v_xor_b32 v30, 96, v15
    ds_read_b64_tr_b16 v[178:179], v15 offset:40960
    v_cmp_eq_u32 vcc, -1, v2
    v_mfma_f32_16x16x32_bf16 v[44:47], v[204:207], v[144:147], v[44:47]
    ds_read_b64_tr_b16 v[182:183], v28 offset:40960
    ds_read_b64_tr_b16 v[186:187], v29 offset:40960
    s_waitcnt lgkmcnt(15)
    v_mfma_f32_16x16x32_bf16 v[60:63], v[204:207], v[148:151], v[60:63]
    ds_read_b64_tr_b16 v[190:191], v30 offset:40960
    s_cbranch_vccnz G2_R15
G2_OK15:
    v_mfma_f32_16x16x32_bf16 v[32:35], v[208:211], v[152:155], v[32:35]
    v_mfma_f32_16x16x32_bf16 v[48:51], v[208:211], v[156:159], v[48:51]
    s_waitcnt vmcnt(6)
    v_mfma_f32_16x16x32_bf16 v[36:39], v[212:215], v[152:155], v[36:39]
    v_max3_u32 v2, v96, v98, v100
    v_mfma_f32_16x16x32_bf16 v[52:55], v[212:215], v[156:159], v[52:55]
    v_max_u32 v2, v2, v102
    v_mfma_f32_16x16x32_bf16 v[40:43], v[216:219], v[152:155], v[40:43]
    v_mfma_f32_16x16x32_bf16 v[56:59], v[216:219], v[156:159], v[56:59]
    v_cmp_eq_u32 vcc, -1, v2
    v_mfma_f32_16x16x32_bf16 v[44:47], v[220:223], v[152:155], v[44:47]
    s_waitcnt lgkmcnt(15)
    v_mfma_f32_16x16x32_bf16 v[60:63], v[220:223], v[156:159], v[60:63]
    s_cbranch_vccnz G2_R16
G2_OK16:
    v_mfma_f32_16x16x32_bf16 v[32:35], v[224:227], v[96:99], v[32:35]
    ds_read_b64 v[24:25], v19 offset:8
    v_xor_b32 v28, 32, v8
    v_mfma_f32_16x16x32_bf16 v[48:51], v[224:227], v[100:103], v[48:51]
    v_xor_b32 v29, 64, v8
    s_waitcnt vmcnt(4)
    v_mfma_f32_16x16x32_bf16 v[36:39], v[228:231], v[96:99], v[36:39]
    v_xor_b32 v30, 96, v8
    v_max3_u32 v2, v104, v106, v108
    v_mfma_f32_16x16x32_bf16 v[52:55], v[228:231], v[100:103], v[52:55]
    s_lshl_b32 s60, s8, 11
    v_max_u32 v2, v2, v110
    v_mfma_f32_16x16x32_bf16 v[40:43], v[232:235], v[96:99], v[40:43]
    s_add_u32 s61, s60, 147200
    v_mfma_f32_16x16x32_bf16 v[56:59], v[232:235], v[100:103], v[56:59]
    v_add_u32 v17, s61, v6
    v_cmp_eq_u32 vcc, -1, v2
    v_mfma_f32_16x16x32_bf16 v[44:47], v[236:239], v[96:99], v[44:47]
    s_lshl1_add_u32 s60, s60, 81920
    s_waitcnt lgkmcnt(0)
    v_mfma_f32_16x16x32_bf16 v[60:63], v[236:239], v[100:103], v[60:63]
    v_add_u32 v20, s60, v6
    s_cbranch_vccnz G2_R17
G2_OK17:
    v_mfma_f32_16x16x32_bf16 v[32:35], v[240:243], v[104:107], v[32:35]
    v_and_b32 v3, v24, v25
    v_cmp_ne_u32 vcc, 0x01010101, v3
    v_mfma_f32_16x16x32_bf16 v[48:51], v[240:243], v[108:111], v[48:51]
    s_waitcnt vmcnt(2)
    v_mfma_f32_16x16x32_bf16 v[36:39], v[244:247], v[104:107], v[36:39]
    s_cbranch_vccnz G2_ZGR
G2_ZGOK:
    v_mfma_f32_16x16x32_bf16 v[52:55], v[244:247], v[108:111], v[52:55]
    ds_read_b128 v[192:195], v20 offset:0
    ds_read_b128 v[196:199], v20 offset:1024
    v_max3_u32 v2, v112, v114, v116
    v_max_u32 v2, v2, v118
    v_mfma_f32_16x16x32_bf16 v[40:43], v[248:251], v[104:107], v[40:43]
    ds_read_b128 v[200:203], v20 offset:2048
    ds_read_b128 v[204:207], v20 offset:3072
    v_mfma_f32_16x16x32_bf16 v[56:59], v[248:251], v[108:111], v[56:59]
    ds_read_b128 v[208:211], v20 offset:4096
    v_cmp_eq_u32 vcc, -1, v2
    v_mfma_f32_16x16x32_bf16 v[44:47], v[252:255], v[104:107], v[44:47]
    ds_read_b128 v[212:215], v20 offset:5120
    ds_read_b128 v[216:219], v20 offset:6144
    v_mfma_f32_16x16x32_bf16 v[60:63], v[252:255], v[108:111], v[60:63]
    ds_read_b128 v[220:223], v20 offset:7168
    s_cbranch_vccnz G2_R18
G2_OK18:
    v_mfma_f32_16x16x32_bf16 v[32:35], v[160:163], v[112:115], v[32:35]
    s_waitcnt vmcnt(0)
    v_max3_u32 v2, v120, v122, v124
    v_mfma_f32_16x16x32_bf16 v[36:39], v[164:167], v[112:115], v[36:39]
    v_max_u32 v2, v2, v126
    v_cmp_eq_u32 vcc, -1, v2
    v_mfma_f32_16x16x32_bf16 v[40:43], v[168:171], v[112:115], v[40:43]
    v_mfma_f32_16x16x32_bf16 v[44:47], v[172:175], v[112:115], v[44:47]
    s_cbranch_vccnz G2_R19
G2_OK19:
    v_mfma_f32_16x16x32_bf16 v[32:35], v[176:179], v[120:123], v[32:35]
    v_mfma_f32_16x16x32_bf16 v[36:39], v[180:183], v[120:123], v[36:39]
    v_mfma_f32_16x16x32_bf16 v[40:43], v[184:187], v[120:123], v[40:43]
    v_mfma_f32_16x16x32_bf16 v[44:47], v[188:191], v[120:123], v[44:47]
    s_waitcnt lgkmcnt(0)
    s_cmp_eq_u32 s101, 1
    s_cbranch_scc1 G2_ONE
    v_mfma_f32_16x16x32_bf16 v[48:51], v[160:163], v[116:119], v[48:51]
    v_mfma_f32_16x16x32_bf16 v[52:55], v[164:167], v[116:119], v[52:55]
    v_fmac_f32 v64, v32, v192
    v_fmac_f32 v65, v33, v193
    v_fmac_f32 v66, v34, v194
    v_mfma_f32_16x16x32_bf16 v[56:59], v[168:171], v[116:119], v[56:59]
    v_fmac_f32 v67, v35, v195
    v_cvt_pk_bf16_f32 v96, v64, v65
    v_cvt_pk_bf16_f32 v97, v66, v67
    v_mfma_f32_16x16x32_bf16 v[60:63], v[172:175], v[116:119], v[60:63]
    ds_write_b64 v8, v[96:97] offset:0
    v_fmac_f32 v68, v36, v196
    v_fmac_f32 v69, v37, v197
    v_mfma_f32_16x16x32_bf16 v[48:51], v[176:179], v[124:127], v[48:51]
    v_fmac_f32 v70, v38, v198
    v_fmac_f32 v71, v39, v199
    v_cvt_pk_bf16_f32 v98, v68, v69
    v_mfma_f32_16x16x32_bf16 v[52:55], v[180:183], v[124:127], v[52:55]
    v_cvt_pk_bf16_f32 v99, v70, v71
    ds_write_b64 v28, v[98:99] offset:0
    v_fmac_f32 v72, v40, v200
    v_mfma_f32_16x16x32_bf16 v[56:59], v[184:187], v[124:127], v[56:59]
    v_fmac_f32 v73, v41, v201
    v_fmac_f32 v74, v42, v202
    v_fmac_f32 v75, v43, v203
    v_mfma_f32_16x16x32_bf16 v[60:63], v[188:191], v[124:127], v[60:63]
    v_cvt_pk_bf16_f32 v100, v72, v73
    v_cvt_pk_bf16_f32 v101, v74, v75
    ds_write_b64 v29, v[100:101] offset:0
    v_fmac_f32 v76, v44, v204
    v_fmac_f32 v77, v45, v205
    v_fmac_f32 v78, v46, v206
    v_fmac_f32 v79, v47, v207
    v_cvt_pk_bf16_f32 v102, v76, v77
    v_cvt_pk_bf16_f32 v103, v78, v79
    ds_write_b64 v30, v[102:103] offset:0
    ds_read_b128 v[224:227], v17 offset:0
    ds_read_b128 v[228:231], v17 offset:1024
    v_pk_fma_f32 v[80:81], v[48:49], v[208:209], v[80:81]
    v_pk_fma_f32 v[82:83], v[50:51], v[210:211], v[82:83]
    v_pk_fma_f32 v[84:85], v[52:53], v[212:213], v[84:85]
    v_pk_fma_f32 v[86:87], v[54:55], v[214:215], v[86:87]
    v_pk_fma_f32 v[88:89], v[56:57], v[216:217], v[88:89]
    v_pk_fma_f32 v[90:91], v[58:59], v[218:219], v[90:91]
    v_pk_fma_f32 v[92:93], v[60:61], v[220:221], v[92:93]
    v_pk_fma_f32 v[94:95], v[62:63], v[222:223], v[94:95]
    v_cvt_pk_bf16_f32 v104, v80, v81
    v_cvt_pk_bf16_f32 v105, v82, v83
    s_waitcnt lgkmcnt(1)
    buffer_store_dwordx4 v[224:227], v7, s[44:47], s97 offen sc1
    s_waitcnt lgkmcnt(0)
    buffer_store_dwordx4 v[228:231], v7, s[44:47], s94 offen sc1
    ds_write_b64 v8, v[104:105] offset:2048
    v_cvt_pk_bf16_f32 v106, v84, v85
    v_cvt_pk_bf16_f32 v107, v86, v87
    ds_write_b64 v28, v[106:107] offset:2048
    v_cvt_pk_bf16_f32 v108, v88, v89
    v_cvt_pk_bf16_f32 v109, v90, v91
    ds_write_b64 v29, v[108:109] offset:2048
    v_cvt_pk_bf16_f32 v110, v92, v93
    v_cvt_pk_bf16_f32 v111, v94, v95
    ds_write_b64 v30, v[110:111] offset:2048
    ds_read_b128 v[232:235], v17 offset:2048
    ds_read_b128 v[236:239], v17 offset:3072
    s_add_u32 s94, s94, 20480
    s_waitcnt lgkmcnt(1)
    buffer_store_dwordx4 v[232:235], v7, s[44:47], s94 offen sc1
    s_add_u32 s94, s94, 20480
    s_waitcnt lgkmcnt(0)
    buffer_store_dwordx4 v[236:239], v7, s[44:47], s94 offen sc1
    s_endpgm
G2_ONE:
    s_nop 7
    v_pk_fma_f32 v[64:65], v[32:33], v[192:193], v[64:65]
    v_pk_fma_f32 v[66:67], v[34:35], v[194:195], v[66:67]
    v_pk_fma_f32 v[68:69], v[36:37], v[196:197], v[68:69]
    v_pk_fma_f32 v[70:71], v[38:39], v[198:199], v[70:71]
    v_pk_fma_f32 v[72:73], v[40:41], v[200:201], v[72:73]
    v_pk_fma_f32 v[74:75], v[42:43], v[202:203], v[74:75]
    v_pk_fma_f32 v[76:77], v[44:45], v[204:205], v[76:77]
    v_pk_fma_f32 v[78:79], v[46:47], v[206:207], v[78:79]
    v_cvt_pk_bf16_f32 v96, v64, v65
    v_cvt_pk_bf16_f32 v97, v66, v67
    ds_write_b64 v8, v[96:97] offset:0
    v_cvt_pk_bf16_f32 v98, v68, v69
    v_cvt_pk_bf16_f32 v99, v70, v71
    ds_write_b64 v28, v[98:99] offset:0
    v_cvt_pk_bf16_f32 v100, v72, v73
    v_cvt_pk_bf16_f32 v101, v74, v75
    ds_write_b64 v29, v[100:101] offset:0
    v_cvt_pk_bf16_f32 v102, v76, v77
    v_cvt_pk_bf16_f32 v103, v78, v79
    ds_write_b64 v30, v[102:103] offset:0
    ds_read_b128 v[224:227], v17 offset:0
    ds_read_b128 v[228:231], v17 offset:1024
    s_waitcnt lgkmcnt(1)
    buffer_store_dwordx4 v[224:227], v7, s[44:47], s97 offen sc1
    s_waitcnt lgkmcnt(0)
    buffer_store_dwordx4 v[228:231], v7, s[44:47], s94 offen sc1
    s_endpgm
K_P1:
TC5:
    s_cbranch_execz TC6
    ds_read_b128 v[240:243], v17 offset:0
    ds_read_b128 v[248:251], v17 offset:256
    ds_read_b64 v[48:49], v8 offset:0
    ds_read_b64 v[56:57], v8 offset:2048
    v_xor_b32 v100, 32, v8
    ds_read_b64 v[50:51], v100 offset:0
    ds_read_b64 v[58:59], v100 offset:2048
    v_xor_b32 v100, 64, v8
    ds_read_b64 v[52:53], v100 offset:0
    ds_read_b64 v[60:61], v100 offset:2048
    v_xor_b32 v100, 96, v8
    ds_read_b64 v[54:55], v100 offset:0
    ds_read_b64 v[62:63], v100 offset:2048
    s_waitcnt lgkmcnt(0)
    v_mul_f32 v240, v240, v242
    v_mul_f32 v244, 0xbfb8aa3b, v242
    v_mul_f32 v246, 0xbfb8aa3b, v240
    v_lshlrev_b32 v208, 16, v48
    v_and_b32 v209, 0xffff0000, v48
    v_lshlrev_b32 v210, 16, v49
    v_and_b32 v211, 0xffff0000, v49
    v_lshlrev_b32 v212, 16, v50
    v_and_b32 v213, 0xffff0000, v50
    v_lshlrev_b32 v214, 16, v51
    v_and_b32 v215, 0xffff0000, v51
    v_pk_fma_f32 v[100:101], v[208:209], v[244:245], v[246:247] op_sel_hi:[1,0,0]
    v_pk_fma_f32 v[102:103], v[210:211], v[244:245], v[246:247] op_sel_hi:[1,0,0]
    v_pk_fma_f32 v[104:105], v[212:213], v[244:245], v[246:247] op_sel_hi:[1,0,0]
    v_pk_fma_f32 v[106:107], v[214:215], v[244:245], v[246:247] op_sel_hi:[1,0,0]
    v_pk_fma_f32 v[208:209], v[208:209], v[242:243], v[240:241] op_sel_hi:[1,0,0]
    v_pk_fma_f32 v[210:211], v[210:211], v[242:243], v[240:241] op_sel_hi:[1,0,0]
    v_pk_fma_f32 v[212:213], v[212:213], v[242:243], v[240:241] op_sel_hi:[1,0,0]
    v_pk_fma_f32 v[214:215], v[214:215], v[242:243], v[240:241] op_sel_hi:[1,0,0]
    v_exp_f32 v100, v100
    v_exp_f32 v101, v101
    v_exp_f32 v102, v102
    v_exp_f32 v103, v103
    v_exp_f32 v104, v104
    v_exp_f32 v105, v105
    v_exp_f32 v106, v106
    v_exp_f32 v107, v107
    v_pk_add_f32 v[100:101], v[100:101], 1.0 op_sel_hi:[1,0]
    v_pk_add_f32 v[102:103], v[102:103], 1.0 op_sel_hi:[1,0]
    v_pk_add_f32 v[104:105], v[104:105], 1.0 op_sel_hi:[1,0]
    v_pk_add_f32 v[106:107], v[106:107], 1.0 op_sel_hi:[1,0]
    v_rcp_f32 v100, v100
    v_rcp_f32 v101, v101
    v_rcp_f32 v102, v102
    v_rcp_f32 v103, v103
    v_rcp_f32 v104, v104
    v_rcp_f32 v105, v105
    v_rcp_f32 v106, v106
    v_rcp_f32 v107, v107
    v_pk_mul_f32 v[208:209], v[208:209], v[100:101]
    v_pk_mul_f32 v[210:211], v[210:211], v[102:103]
    v_pk_mul_f32 v[212:213], v[212:213], v[104:105]
    v_pk_mul_f32 v[214:215], v[214:215], v[106:107]
    s_setpc_b64 s[20:21]
K_P2:
    v_lshlrev_b32 v216, 16, v52
    v_and_b32 v217, 0xffff0000, v52
    v_lshlrev_b32 v218, 16, v53
    v_and_b32 v219, 0xffff0000, v53
    v_lshlrev_b32 v220, 16, v54
    v_and_b32 v221, 0xffff0000, v54
    v_lshlrev_b32 v222, 16, v55
    v_and_b32 v223, 0xffff0000, v55
    v_pk_fma_f32 v[100:101], v[216:217], v[244:245], v[246:247] op_sel_hi:[1,0,0]
    v_pk_fma_f32 v[102:103], v[218:219], v[244:245], v[246:247] op_sel_hi:[1,0,0]
    v_pk_fma_f32 v[104:105], v[220:221], v[244:245], v[246:247] op_sel_hi:[1,0,0]
    v_pk_fma_f32 v[106:107], v[222:223], v[244:245], v[246:247] op_sel_hi:[1,0,0]
    v_pk_fma_f32 v[216:217], v[216:217], v[242:243], v[240:241] op_sel_hi:[1,0,0]
    v_pk_fma_f32 v[218:219], v[218:219], v[242:243], v[240:241] op_sel_hi:[1,0,0]
    v_pk_fma_f32 v[220:221], v[220:221], v[242:243], v[240:241] op_sel_hi:[1,0,0]
    v_pk_fma_f32 v[222:223], v[222:223], v[242:243], v[240:241] op_sel_hi:[1,0,0]
    v_exp_f32 v100, v100
    v_exp_f32 v101, v101
    v_exp_f32 v102, v102
    v_exp_f32 v103, v103
    v_exp_f32 v104, v104
    v_exp_f32 v105, v105
    v_exp_f32 v106, v106
    v_exp_f32 v107, v107
    v_pk_add_f32 v[100:101], v[100:101], 1.0 op_sel_hi:[1,0]
    v_pk_add_f32 v[102:103], v[102:103], 1.0 op_sel_hi:[1,0]
    v_pk_add_f32 v[104:105], v[104:105], 1.0 op_sel_hi:[1,0]
    v_pk_add_f32 v[106:107], v[106:107], 1.0 op_sel_hi:[1,0]
    v_rcp_f32 v100, v100
    v_rcp_f32 v101, v101
    v_rcp_f32 v102, v102
    v_rcp_f32 v103, v103
    v_rcp_f32 v104, v104
    v_rcp_f32 v105, v105
    v_rcp_f32 v106, v106
    v_rcp_f32 v107, v107
    v_pk_mul_f32 v[216:217], v[216:217], v[100:101]
    v_pk_mul_f32 v[218:219], v[218:219], v[102:103]
    v_pk_mul_f32 v[220:221], v[220:221], v[104:105]
    v_pk_mul_f32 v[222:223], v[222:223], v[106:107]
    s_setpc_b64 s[20:21]
K_P3:
    s_cmp_lt_u32 s101, 2
    s_cbranch_scc1 K_P3R
    v_mul_f32 v248, v248, v250
    v_mul_f32 v252, 0xbfb8aa3b, v250
    v_mul_f32 v254, 0xbfb8aa3b, v248
    v_lshlrev_b32 v224, 16, v56
    v_and_b32 v225, 0xffff0000, v56
    v_lshlrev_b32 v226, 16, v57
    v_and_b32 v227, 0xffff0000, v57
    v_lshlrev_b32 v228, 16, v58
    v_and_b32 v229, 0xffff0000, v58
    v_lshlrev_b32 v230, 16, v59
    v_and_b32 v231, 0xffff0000, v59
    v_pk_fma_f32 v[100:101], v[224:225], v[252:253], v[254:255] op_sel_hi:[1,0,0]
    v_pk_fma_f32 v[102:103], v[226:227], v[252:253], v[254:255] op_sel_hi:[1,0,0]
    v_pk_fma_f32 v[104:105], v[228:229], v[252:253], v[254:255] op_sel_hi:[1,0,0]
    v_pk_fma_f32 v[106:107], v[230:231], v[252:253], v[254:255] op_sel_hi:[1,0,0]
    v_pk_fma_f32 v[224:225], v[224:225], v[250:251], v[248:249] op_sel_hi:[1,0,0]
    v_pk_fma_f32 v[226:227], v[226:227], v[250:251], v[248:249] op_sel_hi:[1,0,0]
    v_pk_fma_f32 v[228:229], v[228:229], v[250:251], v[248:249] op_sel_hi:[1,0,0]
    v_pk_fma_f32 v[230:231], v[230:231], v[250:251], v[248:249] op_sel_hi:[1,0,0]
    v_exp_f32 v100, v100
    v_exp_f32 v101, v101
    v_exp_f32 v102, v102
    v_exp_f32 v103, v103
    v_exp_f32 v104, v104
    v_exp_f32 v105, v105
    v_exp_f32 v106, v106
    v_exp_f32 v107, v107
    v_pk_add_f32 v[100:101], v[100:101], 1.0 op_sel_hi:[1,0]
    v_pk_add_f32 v[102:103], v[102:103], 1.0 op_sel_hi:[1,0]
    v_pk_add_f32 v[104:105], v[104:105], 1.0 op_sel_hi:[1,0]
    v_pk_add_f32 v[106:107], v[106:107], 1.0 op_sel_hi:[1,0]
    v_rcp_f32 v100, v100
    v_rcp_f32 v101, v101
    v_rcp_f32 v102, v102
    v_rcp_f32 v103, v103
    v_rcp_f32 v104, v104
    v_rcp_f32 v105, v105
    v_rcp_f32 v106, v106
    v_rcp_f32 v107, v107
    v_pk_mul_f32 v[224:225], v[224:225], v[100:101]
    v_pk_mul_f32 v[226:227], v[226:227], v[102:103]
    v_pk_mul_f32 v[228:229], v[228:229], v[104:105]
    v_pk_mul_f32 v[230:231], v[230:231], v[106:107]
K_P3R:
    s_setpc_b64 s[20:21]
K_P4:
    s_cmp_lt_u32 s101, 2
    s_cbranch_scc1 K_P3R
    v_lshlrev_b32 v232, 16, v60
    v_and_b32 v233, 0xffff0000, v60
    v_lshlrev_b32 v234, 16, v61
    v_and_b32 v235, 0xffff0000, v61
    v_lshlrev_b32 v236, 16, v62
    v_and_b32 v237, 0xffff0000, v62
    v_lshlrev_b32 v238, 16, v63
    v_and_b32 v239, 0xffff0000, v63
    v_fma_f32 v100, v232, v252, v254
    v_fma_f32 v101, v233, v252, v254
    v_fma_f32 v102, v234, v252, v254
    v_fma_f32 v103, v235, v252, v254
    v_fma_f32 v104, v236, v252, v254
    v_fma_f32 v105, v237, v252, v254
    v_fma_f32 v106, v238, v252, v254
    v_fma_f32 v107, v239, v252, v254
    v_exp_f32 v100, v100
    v_fma_f32 v232, v232, v250, v248
    v_exp_f32 v101, v101
    v_fma_f32 v233, v233, v250, v248
    v_exp_f32 v102, v102
    v_fma_f32 v234, v234, v250, v248
    v_exp_f32 v103, v103
    v_fma_f32 v235, v235, v250, v248
    v_exp_f32 v104, v104
    v_fma_f32 v236, v236, v250, v248
    v_exp_f32 v105, v105
    v_fma_f32 v237, v237, v250, v248
    v_exp_f32 v106, v106
    v_fma_f32 v238, v238, v250, v248
    v_exp_f32 v107, v107
    v_fma_f32 v239, v239, v250, v248
    v_add_f32 v100, 1.0, v100
    v_add_f32 v101, 1.0, v101
    v_add_f32 v102, 1.0, v102
    v_add_f32 v103, 1.0, v103
    v_add_f32 v104, 1.0, v104
    v_add_f32 v105, 1.0, v105
    v_add_f32 v106, 1.0, v106
    v_add_f32 v107, 1.0, v107
    v_rcp_f32 v100, v100
    v_rcp_f32 v101, v101
    v_rcp_f32 v102, v102
    v_rcp_f32 v103, v103
    v_rcp_f32 v104, v104
    v_rcp_f32 v105, v105
    v_rcp_f32 v106, v106
    v_rcp_f32 v107, v107
    v_mul_f32 v232, v232, v100
    v_mul_f32 v233, v233, v101
    v_mul_f32 v234, v234, v102
    v_mul_f32 v235, v235, v103
    v_mul_f32 v236, v236, v104
    v_mul_f32 v237, v237, v105
    v_mul_f32 v238, v238, v106
    v_mul_f32 v239, v239, v107
    s_setpc_b64 s[20:21]
P_TAIL:
TC6:
    s_cbranch_execz TC7
    s_setprio 0
    v_mov_b32 v2, 1
    ds_write_b8 v18, v2 offset:0
    s_cmp_eq_u32 s13, 1
    s_cbranch_scc1 P_ST
    s_call_b64 s[20:21], K_P1
    s_call_b64 s[20:21], K_P2
    s_call_b64 s[20:21], K_P3
P_ST:
    s_setprio 0
    s_call_b64 s[20:21], K_P4
    ds_read_b64 v[22:23], v19 offset:40
    s_lshl_b32 s60, s8, 12
    s_add_u32 s60, s60, 81920
    v_add_u32 v20, s60, v6
    s_lshl_b32 s62, s101, 4
    s_mov_b32 s100, 0
    s_waitcnt lgkmcnt(0)
    v_readfirstlane_b32 s90, v22
    v_readfirstlane_b32 s91, v23
    s_lshl_b32 s67, s58, 2
    s_add_u32 s67, s67, 131072
    s_mov_b32 s68, 2
FIX_L:
    v_mov_b32 v45, v49
    v_mov_b32 v46, v50
    v_mov_b32 v47, v51
    v_mov_b32 v49, 114688
    s_not_b32 s60, s90
    s_bfe_u32 s61, s60, 655361
    s_and_b32 s60, s60, 1
    s_lshl_b32 s60, s60, 10
    s_add_u32 s60, s60, s61
    s_sub_u32 s63, s60, s95
    s_cmp_lt_u32 s63, s62
    s_cbranch_scc1 FIX_RUN
FIX_N:
    s_mov_b32 s90, s91
    s_add_u32 s67, s67, 138240
    s_sub_u32 s68, s68, 1
    s_cmp_lg_u32 s68, 0
    s_cbranch_scc1 FIX_L
    s_setprio 0
    s_mov_b32 s100, 0
    ds_read_b64 v[2:3], v19 offset:0
P_Z:
    s_waitcnt lgkmcnt(0)
    v_and_b32 v2, v2, v3
    v_cmp_ne_u32 vcc, 0x01010101, v2
    s_cbranch_vccnz P_ZR
P_ZOK:
    ds_write_b128 v20, v[208:211] offset:0
    ds_write_b128 v20, v[212:215] offset:1024
    ds_write_b128 v20, v[216:219] offset:2048
    ds_write_b128 v20, v[220:223] offset:3072
    ds_write_b128 v20, v[224:227] offset:4096
    ds_write_b128 v20, v[228:231] offset:5120
    ds_write_b128 v20, v[232:235] offset:6144
    ds_write_b128 v20, v[236:239] offset:7168
    s_mov_b32 exec_hi, 0
    ds_write_b64 v49, v[50:51]
    ds_write_b64 v45, v[46:47]
    v_mov_b32 v2, 1
    ds_write_b8 v18, v2 offset:8
    s_endpgm
FIX_RUN:
    s_setprio 3
    v_lshrrev_b32 v48, 5, v1
    v_mul_u32_u24 v48, 4608, v48
    v_add_u32 v48, v48, v6
    v_mov_b32 v116, 0
    v_mov_b32 v117, s52
    v_mov_b32 v118, 0
    v_mov_b32 v119, s52
    s_add_u32 s60, s67, 0
    buffer_load_dwordx4 v[64:67], v48, s[28:31], s60 offen sc1
    s_add_u32 s60, s67, 10240
    buffer_load_dwordx4 v[68:71], v48, s[28:31], s60 offen sc1
    s_add_u32 s60, s67, 20480
    buffer_load_dwordx4 v[72:75], v48, s[28:31], s60 offen sc1
    s_add_u32 s60, s67, 30720
    buffer_load_dwordx4 v[76:79], v48, s[28:31], s60 offen sc1
    s_add_u32 s60, s67, 40960
    buffer_load_dwordx4 v[80:83], v48, s[28:31], s60 offen sc1
    s_add_u32 s60, s67, 51200
    buffer_load_dwordx4 v[84:87], v48, s[28:31], s60 offen sc1
    s_add_u32 s60, s67, 61440
    buffer_load_dwordx4 v[88:91], v48, s[28:31], s60 offen sc1
    s_add_u32 s60, s67, 71680
    buffer_load_dwordx4 v[92:95], v48, s[28:31], s60 offen sc1
    s_add_u32 s60, s67, 81920
    buffer_load_dwordx4 v[96:99], v48, s[28:31], s60 offen sc1
    s_add_u32 s60, s67, 92160
    buffer_load_dwordx4 v[100:103], v48, s[28:31], s60 offen sc1
    s_add_u32 s60, s67, 102400
    buffer_load_dwordx4 v[104:107], v48, s[28:31], s60 offen sc1
    s_add_u32 s60, s67, 112640
    buffer_load_dwordx4 v[108:111], v48, s[28:31], s60 offen sc1
    s_add_u32 s60, s67, 122880
    buffer_load_dwordx4 v[112:115], v48, s[28:31], s60 offen sc1
    s_add_u32 s60, s67, 133120
    s_mov_b32 exec_hi, 0
    buffer_load_dwordx4 v[116:119], v48, s[28:31], s60 offen sc1
    s_mov_b32 exec_hi, -1
    s_lshl4_add_u32 s64, s8, s63
    s_lshl_b32 s60, s64, 4
    s_add_u32 s60, s60, 161536
    v_mov_b32 v2, s60
    ds_read_b96 v[52:54], v2
    v_bfe_u32 v2, v1, 2, 3
    s_and_b32 s60, s64, 7
    v_xor_b32 v2, s60, v2
    v_and_b32 v3, 3, v1
    v_lshl_add_u32 v2, v2, 2, v3
    s_lshl_b32 s60, s64, 7
    s_add_u32 s60, s60, 147200
    v_lshl_add_u32 v2, v2, 2, s60
    ds_read_b32 v50, v2
    s_ashr_i32 s60, s90, 31
    s_orn2_b32 s60, 0x80000000, s60
    s_xor_b32 s60, s60, s90
    s_and_b32 s60, s60, s55
    v_mov_b32 v55, 0xbfb8aa3b
    v_mul_f32 v55, s60, v55
    v_exp_f32 v55, v55
    s_nop 0
    v_add_f32 v55, 1.0, v55
    v_rcp_f32 v55, v55
    s_nop 0
    v_cvt_pk_bf16_f32 v55, v55, v55
    v_lshlrev_b32 v55, 16, v55
    s_lshr_b32 s60, s64, 4
    s_lshl_b32 s60, s60, 12
    s_and_b32 s61, s64, 15
    s_lshl4_add_u32 s60, s61, s60
    s_add_u32 s60, s60, 81920
    v_lshrrev_b32 v49, 1, v1
    v_lshl_add_u32 v49, v49, 8, s60
    v_and_b32 v3, 1, v1
    v_lshl_add_u32 v49, v3, 3, v49
    s_waitcnt lgkmcnt(0)
    v_and_b32 v51, 0xffff0000, v50
    v_lshlrev_b32 v50, 16, v50
    v_add_f32 v50, v50, v52
    v_add_f32 v51, v51, v52
    v_cvt_pk_bf16_f32 v3, v50, v51
    v_lshlrev_b32 v50, 16, v3
    v_and_b32 v51, s55, v3
    v_mul_f32 v50, v50, v54
    v_mul_f32 v51, v51, v54
    v_cvt_pk_bf16_f32 v3, v50, v51
    v_lshlrev_b32 v50, 16, v3
    v_and_b32 v51, s55, v3
    s_waitcnt vmcnt(0)
FIX_Y_CHK:
    v_xor_b32 v2, s52, v65
    v_bitop3_b32 v2, v67, s52, v2 bitop3:0xbe
    v_bitop3_b32 v2, v69, s52, v2 bitop3:0xbe
    v_bitop3_b32 v2, v71, s52, v2 bitop3:0xbe
    v_bitop3_b32 v2, v73, s52, v2 bitop3:0xbe
    v_bitop3_b32 v2, v75, s52, v2 bitop3:0xbe
    v_bitop3_b32 v2, v77, s52, v2 bitop3:0xbe
    v_bitop3_b32 v2, v79, s52, v2 bitop3:0xbe
    v_bitop3_b32 v2, v81, s52, v2 bitop3:0xbe
    v_bitop3_b32 v2, v83, s52, v2 bitop3:0xbe
    v_bitop3_b32 v2, v85, s52, v2 bitop3:0xbe
    v_bitop3_b32 v2, v87, s52, v2 bitop3:0xbe
    v_bitop3_b32 v2, v89, s52, v2 bitop3:0xbe
    v_bitop3_b32 v2, v91, s52, v2 bitop3:0xbe
    v_bitop3_b32 v2, v93, s52, v2 bitop3:0xbe
    v_bitop3_b32 v2, v95, s52, v2 bitop3:0xbe
    v_bitop3_b32 v2, v97, s52, v2 bitop3:0xbe
    v_bitop3_b32 v2, v99, s52, v2 bitop3:0xbe
    v_bitop3_b32 v2, v101, s52, v2 bitop3:0xbe
    v_bitop3_b32 v2, v103, s52, v2 bitop3:0xbe
    v_bitop3_b32 v2, v105, s52, v2 bitop3:0xbe
    v_bitop3_b32 v2, v107, s52, v2 bitop3:0xbe
    v_bitop3_b32 v2, v109, s52, v2 bitop3:0xbe
    v_bitop3_b32 v2, v111, s52, v2 bitop3:0xbe
    v_bitop3_b32 v2, v113, s52, v2 bitop3:0xbe
    v_bitop3_b32 v2, v115, s52, v2 bitop3:0xbe
    v_bitop3_b32 v2, v117, s52, v2 bitop3:0xbe
    v_bitop3_b32 v2, v119, s52, v2 bitop3:0xbe
    v_cmp_ne_u32 vcc, 0, v2
    s_cbranch_vccz FIX_Y_OK
FIX_Y_RETRY:
    s_add_u32 s100, s100, 1
    s_cmp_gt_u32 s100, 20000
    s_cbranch_scc1 FIX_Y_OK
    s_sleep 8
    s_add_u32 s60, s67, 0
    buffer_load_dwordx4 v[64:67], v48, s[28:31], s60 offen sc1
    s_add_u32 s60, s67, 10240
    buffer_load_dwordx4 v[68:71], v48, s[28:31], s60 offen sc1
    s_add_u32 s60, s67, 20480
    buffer_load_dwordx4 v[72:75], v48, s[28:31], s60 offen sc1
    s_add_u32 s60, s67, 30720
    buffer_load_dwordx4 v[76:79], v48, s[28:31], s60 offen sc1
    s_add_u32 s60, s67, 40960
    buffer_load_dwordx4 v[80:83], v48, s[28:31], s60 offen sc1
    s_add_u32 s60, s67, 51200
    buffer_load_dwordx4 v[84:87], v48, s[28:31], s60 offen sc1
    s_add_u32 s60, s67, 61440
    buffer_load_dwordx4 v[88:91], v48, s[28:31], s60 offen sc1
    s_add_u32 s60, s67, 71680
    buffer_load_dwordx4 v[92:95], v48, s[28:31], s60 offen sc1
    s_add_u32 s60, s67, 81920
    buffer_load_dwordx4 v[96:99], v48, s[28:31], s60 offen sc1
    s_add_u32 s60, s67, 92160
    buffer_load_dwordx4 v[100:103], v48, s[28:31], s60 offen sc1
    s_add_u32 s60, s67, 102400
    buffer_load_dwordx4 v[104:107], v48, s[28:31], s60 offen sc1
    s_add_u32 s60, s67, 112640
    buffer_load_dwordx4 v[108:111], v48, s[28:31], s60 offen sc1
    s_add_u32 s60, s67, 122880
    buffer_load_dwordx4 v[112:115], v48, s[28:31], s60 offen sc1
    s_add_u32 s60, s67, 133120
    s_mov_b32 exec_hi, 0
    buffer_load_dwordx4 v[116:119], v48, s[28:31], s60 offen sc1
    s_mov_b32 exec_hi, -1
    s_waitcnt vmcnt(0)
    s_branch FIX_Y_CHK
FIX_Y_OK:
    v_add_f32 v64, v64, v68
    v_add_f32 v66, v66, v70
    v_add_f32 v64, v64, v72
    v_add_f32 v66, v66, v74
    v_add_f32 v64, v64, v76
    v_add_f32 v66, v66, v78
    v_add_f32 v64, v64, v80
    v_add_f32 v66, v66, v82
    v_add_f32 v64, v64, v84
    v_add_f32 v66, v66, v86
    v_add_f32 v64, v64, v88
    v_add_f32 v66, v66, v90
    v_add_f32 v64, v64, v92
    v_add_f32 v66, v66, v94
    v_add_f32 v64, v64, v96
    v_add_f32 v66, v66, v98
    v_add_f32 v64, v64, v100
    v_add_f32 v66, v66, v102
    v_add_f32 v64, v64, v104
    v_add_f32 v66, v66, v106
    v_add_f32 v64, v64, v108
    v_add_f32 v66, v66, v110
    v_add_f32 v64, v64, v112
    v_add_f32 v66, v66, v114
    v_add_f32 v64, v64, v116
    v_add_f32 v66, v66, v118
    v_mov_b32 v65, v66
    v_mov_b32 v66, v64
    v_mov_b32 v67, v65
    s_nop 0
    v_permlane32_swap_b32 v64, v66
    v_permlane32_swap_b32 v65, v67
    v_add_f32 v64, v64, v66
    v_add_f32 v65, v65, v67
    v_cvt_pk_bf16_f32 v3, v64, v65
    v_lshlrev_b32 v64, 16, v3
    v_and_b32 v65, s55, v3
    v_mul_f32 v64, v64, v55
    v_mul_f32 v65, v65, v55
    v_cvt_pk_bf16_f32 v3, v64, v65
    v_lshlrev_b32 v64, 16, v3
    v_and_b32 v65, s55, v3
    v_add_f32 v50, v50, v64
    v_add_f32 v51, v51, v65
    v_cvt_pk_bf16_f32 v3, v50, v51
    v_lshlrev_b32 v50, 16, v3
    v_and_b32 v51, s55, v3
    v_mul_f32 v64, 0xbfb8aa3b, v50
    v_mul_f32 v65, 0xbfb8aa3b, v51
    v_exp_f32 v64, v64
    v_exp_f32 v65, v65
    v_add_f32 v64, 1.0, v64
    v_add_f32 v65, 1.0, v65
    v_rcp_f32 v64, v64
    v_rcp_f32 v65, v65
    v_mul_f32 v50, v50, v64
    v_mul_f32 v51, v51, v65
    s_branch FIX_N
L_CONT:
    s_mul_i32 s60, s3, 5
    s_lshl_b32 s61, s53, 6
    s_add_u32 s60, s60, s61
    s_add_u32 s60, s60, K_TAB-K_PC
    s_load_dwordx16 s[4:19], s[20:21], s60
    s_load_dwordx2 s[44:45], s[0:1], 64
    s_load_dwordx2 s[40:41], s[0:1], 16
    s_mov_b32 s46, 2621440
    s_mov_b32 s47, 0x20000
    s_mov_b32 s30, 7077888
    s_mov_b32 s31, 0x20000
    s_mov_b32 s42, 819200
    s_mov_b32 s43, 0x20000
    s_lshr_b32 s3, s3, 6
    s_and_b32 s59, s3, 3
    s_mov_b32 s55, 0xffff0000
    s_mov_b32 s100, 0
    v_and_b32 v1, 63, v0
    v_and_b32 v4, 15, v1
    v_lshrrev_b32 v5, 4, v1
    v_mov_b32 v19, 163584
    v_add_u32 v18, s3, v19
    v_lshlrev_b32 v6, 4, v1
    v_mov_b32 v28, 0x3f803f80
    v_mov_b32 v29, 0x3f803f80
    v_mov_b32 v30, 0x3f803f80
    v_mov_b32 v31, 0x3f803f80
    v_lshlrev_b32 v2, 2, v5
    v_sub_u32 v3, v4, v2
    v_add_u32 v3, 12, v3
    s_mov_b32 s60, 267390975
    v_bfe_i32 v32, s60, v3, 1
    v_and_b32 v32, 0xff800000, v32
    s_mov_b32 s60, 268435440
    v_bfe_i32 v36, s60, v3, 1
    v_and_b32 v36, 0xff800000, v36
    s_mov_b32 s60, 266346495
    v_bfe_i32 v33, s60, v3, 1
    v_and_b32 v33, 0xff800000, v33
    s_mov_b32 s60, 268435424
    v_bfe_i32 v37, s60, v3, 1
    v_and_b32 v37, 0xff800000, v37
    s_mov_b32 s60, 264257535
    v_bfe_i32 v34, s60, v3, 1
    v_and_b32 v34, 0xff800000, v34
    s_mov_b32 s60, 268435392
    v_bfe_i32 v38, s60, v3, 1
    v_and_b32 v38, 0xff800000, v38
    s_mov_b32 s60, 260079615
    v_bfe_i32 v35, s60, v3, 1
    v_and_b32 v35, 0xff800000, v35
    s_mov_b32 s60, 268435328
    v_bfe_i32 v39, s60, v3, 1
    v_and_b32 v39, 0xff800000, v39
    v_sub_u32 v2, 13, v3
    v_med3_i32 v2, v2, 0, 2
    v_lshlrev_b32 v2, 3, v2
    v_mov_b32 v40, -1
    v_lshrrev_b32 v40, v2, v40
    v_lshrrev_b32 v40, v2, v40
    v_sub_u32 v2, 15, v3
    v_med3_i32 v2, v2, 0, 2
    v_lshlrev_b32 v2, 3, v2
    v_mov_b32 v41, -1
    v_lshrrev_b32 v41, v2, v41
    v_lshrrev_b32 v41, v2, v41
    s_ashr_i32 s60, s56, 31
    s_and_b32 s60, s60, 0xff800000
    v_lshrrev_b32 v2, 3, v1
    v_bfe_i32 v2, 10, v2, 1
    v_and_b32 v2, s60, v2
    v_or_b32 v42, v32, v2
    v_or_b32 v43, v33, v2
    v_or_b32 v44, v34, v2
    v_or_b32 v45, v35, v2
    v_mul_u32_u24 v25, 20224, v5
    v_add_u32 v25, v25, v6
    v_lshrrev_b32 v24, 5, v1
    v_mul_u32_u24 v24, 19968, v24
    v_add_u32 v24, v24, v6
    v_lshlrev_b32 v26, 4, v4
    v_add_u32 v26, 161544, v26
    v_bfe_u32 v2, v1, 2, 2
    v_lshlrev_b32 v2, 7, v2
    v_and_b32 v3, 8, v1
    v_lshl_add_u32 v2, v3, 2, v2
    v_and_b32 v3, 3, v1
    v_lshl_add_u32 v2, v3, 3, v2
    v_and_b32 v3, 48, v1
    s_mov_b32 s62, 0xffff
    s_mov_b32 s60, 201329216
    s_mov_b32 s61, 373298176
    v_lshrrev_b64 v[46:47], v3, s[60:61]
    v_and_or_b32 v9, v46, s62, v2
    s_mov_b32 s60, 37748736
    s_mov_b32 s61, 2550175296
    v_lshrrev_b64 v[46:47], v3, s[60:61]
    v_and_or_b32 v10, v46, s62, v2
    s_mov_b32 s60, 469766720
    s_mov_b32 s61, 977285120
    v_lshrrev_b64 v[46:47], v3, s[60:61]
    v_and_or_b32 v11, v46, s62, v2
    s_mov_b32 s60, 2483063360
    s_mov_b32 s61, 2654996480
    v_lshrrev_b64 v[46:47], v3, s[60:61]
    v_and_or_b32 v12, v46, s62, v2
    s_mov_b32 s60, 574627840
    s_mov_b32 s61, 2051045376
    v_lshrrev_b64 v[46:47], v3, s[60:61]
    v_and_or_b32 v13, v46, s62, v2
    s_mov_b32 s60, 1073757184
    s_mov_b32 s61, 1610635840
    v_lshrrev_b64 v[46:47], v3, s[60:61]
    v_and_or_b32 v14, v46, s62, v2
    s_mov_b32 s60, 1140858432
    s_mov_b32 s61, 2147507776
    v_lshrrev_b64 v[46:47], v3, s[60:61]
    v_and_or_b32 v15, v46, s62, v2
    v_lshrrev_b32 v2, 3, v1
    v_bitop3_b32 v3, v1, v2, 7 bitop3:0x28
    v_mul_u32_u24 v7, 2560, v2
    v_lshl_add_u32 v7, v3, 4, v7
    v_lshrrev_b32 v2, 5, v1
    v_bitop3_b32 v2, v2, v4, 7 bitop3:0x28
    v_lshlrev_b32 v8, 7, v4
    v_lshl_add_u32 v8, v2, 4, v8
    v_and_b32 v2, 1, v5
    v_lshl_add_u32 v8, v2, 3, v8
    v_bfe_u32 v2, v0, 3, 5
    v_and_b32 v3, 6, v2
    v_bitop3_b32 v3, v0, v3, 7 bitop3:0x28
    v_mul_u32_u24 v16, 1280, v2
    v_lshl_add_u32 v16, v3, 4, v16
    s_lshl_b32 s98, s56, 4
    s_mul_i32 s60, s57, 13
    s_add_u32 s98, s98, s60
    s_add_u32 s98, s98, 458880
    s_add_u32 s96, s56, 8
    s_mulk_i32 s96, 1408
    s_mul_i32 s60, s57, 1144
    s_add_u32 s96, s96, s60
    s_add_u32 s96, s96, 1048576
    s_and_b32 s62, s2, 1
    s_mulk_i32 s62, 10240
    s_add_u32 s62, s62, s96
    s_sub_u32 s63, s54, s53
    s_and_b32 s60, s2, 7
    s_mul_i32 s60, s60, 25
    s_add_u32 s63, s63, s60
    s_mulk_i32 s63, 11520
    s_add_u32 s63, s63, 4194304
    v_mul_u32_u24 v2, 272, v4
    v_add_u32 v2, 112384, v2
    v_lshlrev_b32 v3, 3, v5
    s_waitcnt lgkmcnt(0)
    v_bfe_u32 v20, s4, v3, 8
    v_bfe_u32 v21, s5, v3, 8
    v_add_u32 v20, v20, v2
    v_add_u32 v21, v21, v2
    v_lshrrev_b32 v2, 2, v1
    v_mul_u32_u24 v2, 136, v2
    v_add_u32 v2, 79744, v2
    v_add_u32 v23, s7, v2
    v_lshlrev_b32 v3, 3, v1
    v_bfe_u32 v22, s6, v3, 8
    v_add_u32 v22, v22, v2
    s_add_u32 s9, s9, s62
    s_add_u32 s10, s10, s62
    s_add_u32 s11, s11, s63
    s_add_u32 s12, s12, s63
    s_add_u32 s5, s9, 40960
    s_mul_i32 s60, s8, 20480
    s_add_u32 s96, s96, s60
    s_lshl4_add_u32 s95, s8, s56
    s_cmp_eq_u32 s8, 6
    s_cselect_b32 s101, 1, 2
    s_cmpk_ge_i32 s95, 1024
    s_cselect_b32 s101, 0, s101
    s_mul_i32 s97, s95, 2560
    s_add_u32 s97, s97, s57
    s_add_u32 s97, s97, s58
    s_add_u32 s94, s97, 20480
    s_cmp_eq_u32 s8, 0
    s_cselect_b32 s97, 2146435072, s97
    s_cselect_b32 s61, 2146435072, 0
    s_and_b32 s60, s2, 1
    s_lshl_b32 s60, s60, 1
    s_mul_i32 s22, s60, 204800
    s_sub_u32 s23, 409600, s22
    s_add_u32 s22, s22, s58
    s_add_u32 s23, s23, s58
    s_mulk_i32 s60, 5120
    s_sub_u32 s4, s96, s60
    s_add_u32 s4, s4, 10240
    s_add_u32 s96, s96, s60
    s_add_u32 s92, s96, 4096
    s_add_u32 s93, s92, 4096
    s_add_u32 s6, s4, 4096
    s_add_u32 s7, s6, 4096
    v_bfe_i32 v2, v1, 3, 1
    v_bfi_b32 v2, v2, 0, s61
    v_or_b32 v27, v2, v6
    s_and_b32 s60, s2, 4
    s_lshl_b32 s60, s60, 8
    s_add_u32 s95, s95, s60
    s_lshl_b32 s60, s8, 11
    s_add_u32 s60, s60, 147200
    v_add_u32 v8, s60, v8
    s_lshl_b32 s60, s8, 8
    s_add_u32 s60, s60, 161536
    v_lshl_add_u32 v17, v4, 4, s60
    s_mul_i32 s60, s59, 28
    v_min_u32 v2, 27, v1
    v_add_u32 v2, s60, v2
    v_lshlrev_b32 v82, 4, v2
    v_add_u32 v82, 161536, v82
    v_add_u32 v2, s56, v2
    v_max_i32 v2, 0, v2
    v_min_u32 v2, 1023, v2
    s_and_b32 s60, s2, 4
    s_lshl_b32 s60, s60, 12
    s_add_u32 s60, s60, 16384
    v_lshl_add_u32 v81, v2, 4, s60
    s_lshr_b32 s60, s58, 7
    s_movk_i32 s99, 0x3ff
    s_bitset0_b32 s99, s60
    v_lshlrev_b32 v108, 7, v1
    s_mul_i32 s71, s54, 52
    s_lshr_b32 s71, s71, 8
    s_lshl_b32 s71, s71, 13
L_GAP:
    s_lshr_b32 s64, 4099, s67
    s_and_b32 s64, s64, 15
    s_add_u32 s64, s64, s68
    s_cmp_ge_u32 s64, 10
    s_cselect_b32 s65, 10, 0
    s_sub_u32 s64, s64, s65
    s_mul_i32 s65, s64, 245760
    s_lshl_b32 s64, s64, 7
    s_add_u32 s64, s64, s57
    s_add_u32 m0, s69, 0
    s_mov_b32 exec_lo, s70
    buffer_load_dwordx4 v196, s[24:27], s64 offen lds
    s_add_u32 m0, s69, 4096
    s_mov_b32 exec_lo, -1
    buffer_load_dwordx4 v197, s[24:27], s64 offen lds
    s_add_u32 m0, s69, 8192
    s_add_u32 s65, s65, s58
    buffer_load_dwordx4 v198, s[24:27], s64 offen lds
    s_cbranch_vccz L_SK1
    s_add_u32 m0, s69, 12288
    s_nop 0
    buffer_load_dwordx4 v199, s[24:27], s64 offen lds
L_SK1:
    s_add_u32 m0, s69, 14336
    s_add_u32 s66, s65, 122880
    buffer_load_dwordx4 v200, s[32:35], s65 offen offset:0 lds
    s_add_u32 m0, s69, 21248
    s_nop 0
    buffer_load_dwordx4 v200, s[32:35], s65 offen offset:1280 lds
    s_add_u32 m0, s69, 28160
    s_nop 0
    buffer_load_dwordx4 v200, s[32:35], s65 offen offset:2560 lds
    s_add_u32 m0, s69, 18432
    s_nop 0
    buffer_load_dwordx4 v200, s[32:35], s66 offen offset:0 lds
    s_add_u32 m0, s69, 25344
    s_nop 0
    buffer_load_dwordx4 v200, s[32:35], s66 offen offset:1280 lds
    s_add_u32 m0, s69, 32256
    s_nop 0
    buffer_load_dwordx4 v200, s[32:35], s66 offen offset:2560 lds
    s_waitcnt vmcnt(10)
    s_cbranch_vccnz L_W0b
    s_waitcnt vmcnt(9)
L_W0b:
    s_barrier
    s_lshr_b32 s64, 139585, s67
    s_and_b32 s64, s64, 15
    s_add_u32 s64, s64, s68
    s_cmp_ge_u32 s64, 10
    s_cselect_b32 s65, 10, 0
    s_sub_u32 s64, s64, s65
    s_mul_i32 s65, s64, 245760
    s_lshl_b32 s64, s64, 7
    s_add_u32 s64, s64, s57
    s_add_u32 m0, s69, 38912
    s_mov_b32 exec_lo, s70
    buffer_load_dwordx4 v196, s[24:27], s64 offen lds
    s_add_u32 m0, s69, 43008
    s_mov_b32 exec_lo, -1
    buffer_load_dwordx4 v197, s[24:27], s64 offen lds
    s_add_u32 m0, s69, 47104
    s_add_u32 s65, s65, s58
    buffer_load_dwordx4 v198, s[24:27], s64 offen lds
    s_cbranch_vccz L_SK2
    s_add_u32 m0, s69, 51200
    s_nop 0
    buffer_load_dwordx4 v199, s[24:27], s64 offen lds
L_SK2:
    s_add_u32 m0, s69, 53248
    s_add_u32 s66, s65, 122880
    buffer_load_dwordx4 v200, s[32:35], s65 offen offset:0 lds
    s_add_u32 m0, s69, 60160
    s_nop 0
    buffer_load_dwordx4 v200, s[32:35], s65 offen offset:1280 lds
    s_add_u32 m0, s69, 67072
    s_nop 0
    buffer_load_dwordx4 v200, s[32:35], s65 offen offset:2560 lds
    s_add_u32 m0, s69, 57344
    s_nop 0
    buffer_load_dwordx4 v200, s[32:35], s66 offen offset:0 lds
    s_add_u32 m0, s69, 64256
    s_nop 0
    buffer_load_dwordx4 v200, s[32:35], s66 offen offset:1280 lds
    s_add_u32 m0, s69, 71168
    s_nop 0
    buffer_load_dwordx4 v200, s[32:35], s66 offen offset:2560 lds
    s_waitcnt vmcnt(9)
    s_barrier
    s_lshr_b32 s64, 217890, s67
    s_and_b32 s64, s64, 15
    s_add_u32 s64, s64, s68
    s_cmp_ge_u32 s64, 10
    s_cselect_b32 s65, 10, 0
    s_sub_u32 s64, s64, s65
    s_mul_i32 s65, s64, 245760
    s_lshl_b32 s64, s64, 7
    s_add_u32 s64, s64, s57
    s_add_u32 m0, s69, 77824
    s_mov_b32 exec_lo, s70
    buffer_load_dwordx4 v196, s[24:27], s64 offen lds
    s_add_u32 m0, s69, 81920
    s_mov_b32 exec_lo, -1
    buffer_load_dwordx4 v197, s[24:27], s64 offen lds
    s_add_u32 m0, s69, 86016
    s_add_u32 s65, s65, s58
    buffer_load_dwordx4 v198, s[24:27], s64 offen lds
    s_cbranch_vccz L_SK3
    s_add_u32 m0, s69, 90112
    s_nop 0
    buffer_load_dwordx4 v199, s[24:27], s64 offen lds
L_SK3:
    s_add_u32 m0, s69, 92160
    s_add_u32 s66, s65, 122880
    buffer_load_dwordx4 v200, s[32:35], s65 offen offset:0 lds
    s_add_u32 m0, s69, 99072
    s_nop 0
    buffer_load_dwordx4 v200, s[32:35], s65 offen offset:1280 lds
    s_add_u32 m0, s69, 105984
    s_nop 0
    buffer_load_dwordx4 v200, s[32:35], s65 offen offset:2560 lds
    s_add_u32 m0, s69, 96256
    s_nop 0
    buffer_load_dwordx4 v200, s[32:35], s66 offen offset:0 lds
    s_add_u32 m0, s69, 103168
    s_nop 0
    buffer_load_dwordx4 v200, s[32:35], s66 offen offset:1280 lds
    s_add_u32 m0, s69, 110080
    s_nop 0
    buffer_load_dwordx4 v200, s[32:35], s66 offen offset:2560 lds
    s_waitcnt vmcnt(9)
    s_barrier
    s_lshr_b32 s64, 406580, s67
    s_and_b32 s64, s64, 15
    s_add_u32 s64, s64, s68
    s_cmp_ge_u32 s64, 10
    s_cselect_b32 s65, 10, 0
    s_sub_u32 s64, s64, s65
    s_mul_i32 s65, s64, 245760
    s_lshl_b32 s64, s64, 7
    s_add_u32 s64, s64, s57
    s_add_u32 m0, s69, 0
    s_mov_b32 exec_lo, s70
    buffer_load_dwordx4 v196, s[24:27], s64 offen lds
    s_add_u32 m0, s69, 4096
    s_mov_b32 exec_lo, -1
    buffer_load_dwordx4 v197, s[24:27], s64 offen lds
    s_add_u32 m0, s69, 8192
    s_add_u32 s65, s65, s58
    buffer_load_dwordx4 v198, s[24:27], s64 offen lds
    s_cbranch_vccz L_SK4
    s_add_u32 m0, s69, 12288
    s_nop 0
    buffer_load_dwordx4 v199, s[24:27], s64 offen lds
L_SK4:
    s_add_u32 m0, s69, 14336
    s_add_u32 s66, s65, 122880
    buffer_load_dwordx4 v200, s[32:35], s65 offen offset:0 lds
    ds_read_b32 v109, v19 offset:32
    s_add_u32 m0, s69, 21248
    s_nop 0
    buffer_load_dwordx4 v200, s[32:35], s65 offen offset:1280 lds
    s_add_u32 m0, s69, 28160
    s_nop 0
    buffer_load_dwordx4 v200, s[32:35], s65 offen offset:2560 lds
    s_add_u32 m0, s69, 18432
    s_nop 0
    buffer_load_dwordx4 v200, s[32:35], s66 offen offset:0 lds
    s_add_u32 m0, s69, 25344
    s_nop 0
    buffer_load_dwordx4 v200, s[32:35], s66 offen offset:1280 lds
    s_add_u32 m0, s69, 32256
    s_nop 0
    buffer_load_dwordx4 v200, s[32:35], s66 offen offset:2560 lds
    s_add_u32 m0, s69, 147200
    s_add_u32 s64, s58, s57
    buffer_load_dwordx4 v196, s[24:27], s64 offen lds
    s_waitcnt vmcnt(10)
    s_barrier
    s_lshr_b32 s64, 280405, s67
    s_and_b32 s64, s64, 15
    s_add_u32 s64, s64, s68
    s_cmp_ge_u32 s64, 10
    s_cselect_b32 s65, 10, 0
    s_sub_u32 s64, s64, s65
    s_mul_i32 s65, s64, 245760
    s_lshl_b32 s64, s64, 7
    s_add_u32 s64, s64, s57
    s_add_u32 m0, s69, 38912
    s_mov_b32 exec_lo, s70
    buffer_load_dwordx4 v196, s[24:27], s64 offen lds
    s_add_u32 m0, s69, 43008
    s_mov_b32 exec_lo, -1
    buffer_load_dwordx4 v197, s[24:27], s64 offen lds
    s_add_u32 m0, s69, 47104
    s_add_u32 s65, s65, s58
    buffer_load_dwordx4 v198, s[24:27], s64 offen lds
    s_cbranch_vccz L_SK5
    s_add_u32 m0, s69, 51200
    s_nop 0
    buffer_load_dwordx4 v199, s[24:27], s64 offen lds
L_SK5:
    s_add_u32 m0, s69, 53248
    s_add_u32 s66, s65, 122880
    buffer_load_dwordx4 v200, s[32:35], s65 offen offset:0 lds
    s_add_u32 m0, s69, 60160
    s_nop 0
    buffer_load_dwordx4 v200, s[32:35], s65 offen offset:1280 lds
    s_add_u32 m0, s69, 67072
    s_nop 0
    buffer_load_dwordx4 v200, s[32:35], s65 offen offset:2560 lds
    s_add_u32 m0, s69, 57344
    s_nop 0
    buffer_load_dwordx4 v200, s[32:35], s66 offen offset:0 lds
    s_add_u32 m0, s69, 64256
    s_nop 0
    buffer_load_dwordx4 v200, s[32:35], s66 offen offset:1280 lds
    s_add_u32 m0, s69, 71168
    s_nop 0
    buffer_load_dwordx4 v200, s[32:35], s66 offen offset:2560 lds
    s_add_u32 m0, s69, 151296
    s_add_u32 s64, s58, s57
    buffer_load_dwordx4 v197, s[24:27], s64 offen lds
    s_waitcnt vmcnt(10)
    s_barrier
    s_lshr_b32 s64, 353640, s67
    s_and_b32 s64, s64, 15
    s_add_u32 s64, s64, s68
    s_cmp_ge_u32 s64, 10
    s_cselect_b32 s65, 10, 0
    s_sub_u32 s64, s64, s65
    s_mul_i32 s65, s64, 245760
    s_lshl_b32 s64, s64, 7
    s_add_u32 s64, s64, s57
    s_add_u32 m0, s69, 77824
    s_mov_b32 exec_lo, s70
    buffer_load_dwordx4 v196, s[24:27], s64 offen lds
    s_add_u32 m0, s69, 81920
    s_mov_b32 exec_lo, -1
    buffer_load_dwordx4 v197, s[24:27], s64 offen lds
    s_add_u32 m0, s69, 86016
    s_add_u32 s65, s65, s58
    buffer_load_dwordx4 v198, s[24:27], s64 offen lds
    s_cbranch_vccz L_SK6
    s_add_u32 m0, s69, 90112
    s_nop 0
    buffer_load_dwordx4 v199, s[24:27], s64 offen lds
L_SK6:
    s_add_u32 m0, s69, 92160
    s_add_u32 s66, s65, 122880
    buffer_load_dwordx4 v200, s[32:35], s65 offen offset:0 lds
    s_waitcnt lgkmcnt(0)
    s_add_u32 m0, s69, 99072
    s_nop 0
    buffer_load_dwordx4 v200, s[32:35], s65 offen offset:1280 lds
    s_add_u32 m0, s69, 105984
    s_nop 0
    buffer_load_dwordx4 v200, s[32:35], s65 offen offset:2560 lds
    s_add_u32 m0, s69, 96256
    s_nop 0
    buffer_load_dwordx4 v200, s[32:35], s66 offen offset:0 lds
    s_add_u32 m0, s69, 103168
    s_nop 0
    buffer_load_dwordx4 v200, s[32:35], s66 offen offset:1280 lds
    s_add_u32 m0, s69, 110080
    s_nop 0
    buffer_load_dwordx4 v200, s[32:35], s66 offen offset:2560 lds
    s_add_u32 m0, s69, 155392
    s_add_u32 s64, s58, s57
    buffer_load_dwordx4 v198, s[24:27], s64 offen lds
    s_waitcnt vmcnt(10)
    s_barrier
    s_lshr_b32 s64, 489110, s67
    s_and_b32 s64, s64, 15
    s_add_u32 s64, s64, s68
    s_cmp_ge_u32 s64, 10
    s_cselect_b32 s65, 10, 0
    s_sub_u32 s64, s64, s65
    s_mul_i32 s65, s64, 245760
    s_lshl_b32 s64, s64, 7
    s_add_u32 s64, s64, s57
    s_add_u32 m0, s69, 0
    s_mov_b32 exec_lo, s70
    buffer_load_dwordx4 v196, s[24:27], s64 offen lds
    s_add_u32 m0, s69, 4096
    s_mov_b32 exec_lo, -1
    buffer_load_dwordx4 v197, s[24:27], s64 offen lds
    s_add_u32 m0, s69, 8192
    s_add_u32 s65, s65, s58
    buffer_load_dwordx4 v198, s[24:27], s64 offen lds
    s_cbranch_vccz L_SK7
    s_add_u32 m0, s69, 12288
    s_nop 0
    buffer_load_dwordx4 v199, s[24:27], s64 offen lds
L_SK7:
    s_add_u32 m0, s69, 14336
    s_add_u32 s66, s65, 122880
    buffer_load_dwordx4 v200, s[32:35], s65 offen offset:0 lds
    s_add_u32 m0, s69, 21248
    s_nop 0
    buffer_load_dwordx4 v200, s[32:35], s65 offen offset:1280 lds
    s_add_u32 m0, s69, 28160
    s_nop 0
    buffer_load_dwordx4 v200, s[32:35], s65 offen offset:2560 lds
    s_add_u32 m0, s69, 18432
    s_nop 0
    buffer_load_dwordx4 v200, s[32:35], s66 offen offset:0 lds
    s_add_u32 m0, s69, 25344
    s_nop 0
    buffer_load_dwordx4 v200, s[32:35], s66 offen offset:1280 lds
    s_add_u32 m0, s69, 32256
    s_nop 0
    buffer_load_dwordx4 v200, s[32:35], s66 offen offset:2560 lds
    s_cbranch_vccz L_SKX
    s_add_u32 m0, s69, 159488
    s_add_u32 s64, s58, s57
    buffer_load_dwordx4 v199, s[24:27], s64 offen lds
L_SKX:
    s_waitcnt vmcnt(9)
    s_barrier
    s_lshr_b32 s64, 559223, s67
    s_and_b32 s64, s64, 15
    s_add_u32 s64, s64, s68
    s_cmp_ge_u32 s64, 10
    s_cselect_b32 s65, 10, 0
    s_sub_u32 s64, s64, s65
    s_mul_i32 s65, s64, 245760
    s_lshl_b32 s64, s64, 7
    s_add_u32 s64, s64, s57
    s_add_u32 m0, s69, 38912
    s_mov_b32 exec_lo, s70
    buffer_load_dwordx4 v196, s[24:27], s64 offen lds
    s_add_u32 m0, s69, 43008
    s_mov_b32 exec_lo, -1
    buffer_load_dwordx4 v197, s[24:27], s64 offen lds
    s_add_u32 m0, s69, 47104
    s_add_u32 s65, s65, s58
    buffer_load_dwordx4 v198, s[24:27], s64 offen lds
    s_cbranch_vccz L_SK8
    s_add_u32 m0, s69, 51200
    s_nop 0
    buffer_load_dwordx4 v199, s[24:27], s64 offen lds
L_SK8:
    s_add_u32 m0, s69, 53248
    s_add_u32 s66, s65, 122880
    buffer_load_dwordx4 v200, s[32:35], s65 offen offset:0 lds
    v_readfirstlane_b32 s52, v109
    s_add_u32 m0, s69, 60160
    s_nop 0
    buffer_load_dwordx4 v200, s[32:35], s65 offen offset:1280 lds
    s_add_u32 m0, s69, 67072
    s_nop 0
    buffer_load_dwordx4 v200, s[32:35], s65 offen offset:2560 lds
    s_add_u32 m0, s69, 57344
    s_nop 0
    buffer_load_dwordx4 v200, s[32:35], s66 offen offset:0 lds
    s_add_u32 m0, s69, 64256
    s_nop 0
    buffer_load_dwordx4 v200, s[32:35], s66 offen offset:1280 lds
    s_add_u32 m0, s69, 71168
    s_nop 0
    buffer_load_dwordx4 v200, s[32:35], s66 offen offset:2560 lds
    s_mul_i32 s60, s59, 448
    s_add_u32 m0, s60, 161536
    s_mov_b64 exec, 0xfffffff
    buffer_load_dwordx4 v81, s[28:31], 0 offen  lds
    s_mov_b64 exec, -1
    s_waitcnt vmcnt(10)
    s_barrier
    s_lshr_b32 s64, 629129, s67
    s_and_b32 s64, s64, 15
    s_add_u32 s64, s64, s68
    s_cmp_ge_u32 s64, 10
    s_cselect_b32 s65, 10, 0
    s_sub_u32 s64, s64, s65
    s_mul_i32 s65, s64, 245760
    s_lshl_b32 s64, s64, 7
    s_add_u32 s64, s64, s57
    s_add_u32 m0, s69, 77824
    s_mov_b32 exec_lo, s70
    buffer_load_dwordx4 v196, s[24:27], s64 offen lds
    s_add_u32 m0, s69, 81920
    s_mov_b32 exec_lo, -1
    buffer_load_dwordx4 v197, s[24:27], s64 offen lds
    s_add_u32 m0, s69, 86016
    s_add_u32 s65, s65, s58
    buffer_load_dwordx4 v198, s[24:27], s64 offen lds
    s_cbranch_vccz L_SK9
    s_add_u32 m0, s69, 90112
    s_nop 0
    buffer_load_dwordx4 v199, s[24:27], s64 offen lds
L_SK9:
    s_add_u32 m0, s69, 92160
    s_add_u32 s66, s65, 122880
    buffer_load_dwordx4 v200, s[32:35], s65 offen offset:0 lds
    s_add_u32 m0, s69, 99072
    s_nop 0
    buffer_load_dwordx4 v200, s[32:35], s65 offen offset:1280 lds
    s_add_u32 m0, s69, 105984
    s_nop 0
    buffer_load_dwordx4 v200, s[32:35], s65 offen offset:2560 lds
    s_add_u32 m0, s69, 96256
    s_nop 0
    buffer_load_dwordx4 v200, s[32:35], s66 offen offset:0 lds
    s_add_u32 m0, s69, 103168
    s_nop 0
    buffer_load_dwordx4 v200, s[32:35], s66 offen offset:1280 lds
    s_add_u32 m0, s69, 110080
    s_nop 0
    buffer_load_dwordx4 v200, s[32:35], s66 offen offset:2560 lds
    s_waitcnt vmcnt(9)
    s_barrier
    ds_read_b128 v[84:87], v82
    s_mov_b32 s64, s71
    s_add_u32 s65, s69, 0
    s_add_u32 m0, s64, s65
    s_mul_i32 s61, s64, 10
    s_add_u32 s61, s61, s22
    buffer_load_dwordx4 v16, s[40:43], s61 offen lds
    s_add_u32 s64, s64, 4096
    s_cmp_eq_u32 s64, 36864
    s_cselect_b32 s64, 0, s64
    s_add_u32 m0, s64, s65
    s_mul_i32 s61, s64, 10
    s_add_u32 s61, s61, s22
    buffer_load_dwordx4 v16, s[40:43], s61 offen lds
    s_add_u32 s64, s64, 4096
    s_add_u32 m0, s64, s65
    s_mul_i32 s61, s64, 10
    s_add_u32 s61, s61, s22
    buffer_load_dwordx4 v16, s[40:43], s61 offen lds
    s_add_u32 s64, s64, 4096
    s_cmp_eq_u32 s64, 36864
    s_cselect_b32 s64, 0, s64
    s_add_u32 m0, s64, s65
    s_mul_i32 s61, s64, 10
    s_add_u32 s61, s61, s22
    buffer_load_dwordx4 v16, s[40:43], s61 offen lds
    s_add_u32 s64, s64, 4096
    s_add_u32 m0, s64, s65
    s_mul_i32 s61, s64, 10
    s_add_u32 s61, s61, s22
    buffer_load_dwordx4 v16, s[40:43], s61 offen lds
    s_add_u32 s64, s64, 4096
    s_cmp_eq_u32 s64, 36864
    s_cselect_b32 s64, 0, s64
    s_add_u32 m0, s64, s65
    s_mul_i32 s61, s64, 10
    s_add_u32 s61, s61, s22
    buffer_load_dwordx4 v16, s[40:43], s61 offen lds
    s_add_u32 s64, s64, 4096
    s_add_u32 m0, s64, s65
    s_mul_i32 s61, s64, 10
    s_add_u32 s61, s61, s22
    buffer_load_dwordx4 v16, s[40:43], s61 offen lds
    s_add_u32 s64, s64, 4096
    s_cmp_eq_u32 s64, 36864
    s_cselect_b32 s64, 0, s64
    s_add_u32 m0, s64, s65
    s_mul_i32 s61, s64, 10
    s_add_u32 s61, s61, s22
    buffer_load_dwordx4 v16, s[40:43], s61 offen lds
    s_add_u32 s64, s64, 4096
    s_add_u32 m0, s64, s65
    s_mul_i32 s61, s64, 10
    s_add_u32 s61, s61, s22
    buffer_load_dwordx4 v16, s[40:43], s61 offen lds
    s_waitcnt lgkmcnt(0)
L_RC_CHK:
    v_xor_b32 v2, s52, v85
    v_bitop3_b32 v2, v87, s52, v2 bitop3:0xbe
    v_cmp_ne_u32 vcc, 0, v2
    s_cbranch_vccnz L_RC_RETRY
L_RC_OK:
    s_waitcnt vmcnt(9)
    s_barrier
    s_cmp_lg_u32 s3, 1
    s_cbranch_scc1 L_NORS
    v_mov_b32 v124, s52
    v_mov_b32 v125, s52
    v_mov_b32 v126, s52
    v_mov_b32 v127, s52
    s_add_u32 s60, s98, s58
    s_mov_b64 exec, 0xff
    buffer_store_dwordx4 v[124:127], v6, s[28:31], s60 offen sc1
    s_mov_b64 exec, -1
L_NORS:
    s_lshl_b32 s60, s59, 10
    s_add_u32 m0, s60, 36864
    s_add_u32 s60, s22, 368640
    buffer_load_dwordx4 v16, s[40:43], s60 offen lds
    s_mul_i32 s64, s71, 10
    s_add_u32 s61, s64, s23
    buffer_load_dwordx4 v[216:219], v16, s[40:43], s61 offen
    s_add_u32 s64, s64, 40960
    s_add_u32 s61, s64, s23
    buffer_load_dwordx4 v[220:223], v16, s[40:43], s61 offen
    s_add_u32 s64, s64, 40960
    s_cmp_eq_u32 s64, 409600
    s_cselect_b32 s64, 0, s64
    s_add_u32 s61, s64, s23
    buffer_load_dwordx4 v[224:227], v16, s[40:43], s61 offen
    s_add_u32 s64, s64, 40960
    s_add_u32 s61, s64, s23
    buffer_load_dwordx4 v[228:231], v16, s[40:43], s61 offen
    s_add_u32 s64, s64, 40960
    s_cmp_eq_u32 s64, 409600
    s_cselect_b32 s64, 0, s64
    s_add_u32 s61, s64, s23
    buffer_load_dwordx4 v[232:235], v16, s[40:43], s61 offen
    s_add_u32 s64, s64, 40960
    s_add_u32 s61, s64, s23
    buffer_load_dwordx4 v[236:239], v16, s[40:43], s61 offen
    s_add_u32 s64, s64, 40960
    s_cmp_eq_u32 s64, 409600
    s_cselect_b32 s64, 0, s64
    s_add_u32 s61, s64, s23
    buffer_load_dwordx4 v[240:243], v16, s[40:43], s61 offen
    s_add_u32 s64, s64, 40960
    s_add_u32 s61, s64, s23
    buffer_load_dwordx4 v[244:247], v16, s[40:43], s61 offen
    s_add_u32 s64, s64, 40960
    s_cmp_eq_u32 s64, 409600
    s_cselect_b32 s64, 0, s64
    s_add_u32 s61, s64, s23
    buffer_load_dwordx4 v[248:251], v16, s[40:43], s61 offen
    s_add_u32 s64, s64, 40960
    s_add_u32 s61, s64, s23
    buffer_load_dwordx4 v[252:255], v16, s[40:43], s61 offen
    s_mov_b64 exec, 1
    buffer_load_dwordx4 v[112:115], v6, s[28:31], 0 offen offset:256
    s_mov_b64 exec, -1
    s_mov_b64 exec, 0
    s_bitcmp1_b32 s3, 0
    s_cbranch_scc1 TC4
    s_branch TC0
TC_END:
    s_mov_b64 exec, -1
    s_barrier
    s_setprio 1
    s_cmp_eq_u32 s13, 1
    s_cbranch_scc1 AL_S
    ds_read_b64 v[64:65], v20 offset:4480
    ds_read_b64 v[66:67], v21 offset:4480
    ds_read_b64 v[84:85], v20 offset:4352
    ds_read_b64 v[86:87], v21 offset:4352
    ds_read_b64 v[68:69], v20 offset:8832
    ds_read_b64 v[70:71], v21 offset:8832
    ds_read_b64 v[88:89], v20 offset:8704
    ds_read_b64 v[90:91], v21 offset:8704
    ds_read_b64 v[72:73], v20 offset:13184
    ds_read_b64 v[74:75], v21 offset:13184
    ds_read_b64 v[92:93], v20 offset:13056
    ds_read_b64 v[94:95], v21 offset:13056
    ds_read_b64 v[76:77], v20 offset:17536
    ds_read_b64 v[78:79], v21 offset:17536
    ds_read_b64 v[96:97], v20 offset:17408
    ds_read_b64 v[98:99], v21 offset:17408
    s_cmp_lg_u32 s3, 2
    s_cbranch_scc1 AL_NOR0
    s_mov_b32 exec_lo, s99
    s_mov_b32 exec_hi, 0
    buffer_load_dword v109, v108, s[28:31], s98 offen sc1
    s_mov_b64 exec, -1
AL_NOR0:
    v_lshl_add_u32 v3, v5, 8, v26
    v_mov_b32 v0, v27
    s_waitcnt lgkmcnt(12)
    v_mfma_f32_16x16x32_bf16 v[168:171], v[84:87], v[64:67], v[42:45]
    s_waitcnt lgkmcnt(8)
    v_mfma_f32_16x16x32_bf16 v[172:175], v[88:91], v[68:71], v[32:35]
    v_mfma_f32_16x16x32_bf16 v[52:55], v[84:87], v[68:71], v[36:39]
    s_waitcnt lgkmcnt(4)
    v_mfma_f32_16x16x32_bf16 v[176:179], v[92:95], v[72:75], v[32:35]
    v_mfma_f32_16x16x32_bf16 v[56:59], v[88:91], v[72:75], v[36:39]
    s_waitcnt lgkmcnt(0)
    v_mfma_f32_16x16x32_bf16 v[180:183], v[96:99], v[76:79], v[32:35]
    v_mfma_f32_16x16x32_bf16 v[60:63], v[92:95], v[76:79], v[36:39]
    s_branch AL_J
AL_S:
    ds_read_b64 v[64:65], v20 offset:4480
    ds_read_b64 v[84:85], v20 offset:4352
    ds_read_b64 v[68:69], v20 offset:8832
    ds_read_b64 v[88:89], v20 offset:8704
    ds_read_b64 v[72:73], v20 offset:13184
    ds_read_b64 v[92:93], v20 offset:13056
    ds_read_b64 v[76:77], v20 offset:17536
    ds_read_b64 v[96:97], v20 offset:17408
    v_lshl_add_u32 v3, v5, 8, v26
    v_mov_b32 v0, v27
    s_waitcnt lgkmcnt(6)
    v_mfma_f32_16x16x16_bf16 v[168:171], v[84:85], v[64:65], v[42:45]
    s_waitcnt lgkmcnt(4)
    v_mfma_f32_16x16x16_bf16 v[172:175], v[88:89], v[68:69], v[32:35]
    v_mfma_f32_16x16x16_bf16 v[52:55], v[84:85], v[68:69], v[36:39]
    s_waitcnt lgkmcnt(2)
    v_mfma_f32_16x16x16_bf16 v[176:179], v[92:93], v[72:73], v[32:35]
    v_mfma_f32_16x16x16_bf16 v[56:59], v[88:89], v[72:73], v[36:39]
    s_waitcnt lgkmcnt(0)
    v_mfma_f32_16x16x16_bf16 v[180:183], v[96:97], v[76:77], v[32:35]
    v_mfma_f32_16x16x16_bf16 v[60:63], v[92:93], v[76:77], v[36:39]
AL_J:
    ds_read_b32 v27, v3
    ds_read2st64_b32 v[36:37], v26 offset1:1
    ds_read2st64_b32 v[38:39], v26 offset0:2 offset1:3
    v_max_f32 v172, v172, v52
    v_max_f32 v173, v173, v53
    v_max_f32 v174, v174, v54
    v_max_f32 v175, v175, v55
    v_max_f32 v176, v176, v56
    v_max_f32 v177, v177, v57
    v_max_f32 v178, v178, v58
    v_max_f32 v179, v179, v59
    v_max_f32 v180, v180, v60
    v_max_f32 v181, v181, v61
    v_max_f32 v182, v182, v62
    v_max_f32 v183, v183, v63
    s_cmp_lg_u32 s13, 1
    s_cbranch_scc1 AL_SM
    v_cvt_pk_bf16_f32 v64, v168, v169
    v_mov_b32 v65, s52
    v_cvt_pk_bf16_f32 v66, v170, v171
    v_mov_b32 v67, s52
    buffer_store_dwordx4 v[64:67], v6, s[28:31], s11 offen offset:0 sc1
    v_cvt_pk_bf16_f32 v68, v172, v173
    v_mov_b32 v69, s52
    v_cvt_pk_bf16_f32 v70, v174, v175
    v_mov_b32 v71, s52
    buffer_store_dwordx4 v[68:71], v6, s[28:31], s11 offen offset:1024 sc1
    v_cvt_pk_bf16_f32 v72, v176, v177
    v_mov_b32 v73, s52
    v_cvt_pk_bf16_f32 v74, v178, v179
    v_mov_b32 v75, s52
    buffer_store_dwordx4 v[72:75], v6, s[28:31], s11 offen offset:2048 sc1
    v_cvt_pk_bf16_f32 v76, v180, v181
    v_mov_b32 v77, s52
    v_cvt_pk_bf16_f32 v78, v182, v183
    v_mov_b32 v79, s52
    buffer_store_dwordx4 v[76:79], v6, s[28:31], s11 offen offset:3072 sc1
    s_branch AL_X
AL_SM:
    v_max3_f32 v136, v168, v169, v170
    v_max3_f32 v138, v172, v173, v174
    v_max3_f32 v140, v176, v177, v178
    v_max3_f32 v142, v180, v181, v182
    v_max_f32 v136, v136, v171
    v_max_f32 v138, v138, v175
    v_max_f32 v140, v140, v179
    v_max_f32 v142, v142, v183
    s_nop 0
    v_permlane32_swap_b32 v136, v140
    v_permlane32_swap_b32 v138, v142
    v_max_f32 v136, v136, v140
    v_max_f32 v138, v138, v142
    s_waitcnt lgkmcnt(0)
    v_mul_f32 v27, 0x3ea52b5c, v27
    v_permlane16_swap_b32 v136, v138
    v_max_f32 v136, v136, v138
    v_mul_f32 v138, v136, v27
    v_mul_f32 v136, v136, v27
    v_mul_f32 v32, 0x3ea52b5c, v36
    v_mul_f32 v34, 0x3ea52b5c, v37
    v_permlane16_swap_b32 v136, v138
    v_mov_b32 v140, v136
    v_mov_b32 v142, v138
    v_mul_f32 v36, 0x3ea52b5c, v38
    v_mul_f32 v38, 0x3ea52b5c, v39
    v_permlane32_swap_b32 v136, v140
    v_permlane32_swap_b32 v138, v142
    v_pk_fma_f32 v[168:169], v[168:169], v[32:33], v[136:137] op_sel_hi:[1,0,0] neg_lo:[0,0,1] neg_hi:[0,0,1]
    v_pk_fma_f32 v[170:171], v[170:171], v[32:33], v[136:137] op_sel_hi:[1,0,0] neg_lo:[0,0,1] neg_hi:[0,0,1]
    v_pk_fma_f32 v[172:173], v[172:173], v[34:35], v[138:139] op_sel_hi:[1,0,0] neg_lo:[0,0,1] neg_hi:[0,0,1]
    v_pk_fma_f32 v[174:175], v[174:175], v[34:35], v[138:139] op_sel_hi:[1,0,0] neg_lo:[0,0,1] neg_hi:[0,0,1]
    v_pk_fma_f32 v[176:177], v[176:177], v[36:37], v[140:141] op_sel_hi:[1,0,0] neg_lo:[0,0,1] neg_hi:[0,0,1]
    v_pk_fma_f32 v[178:179], v[178:179], v[36:37], v[140:141] op_sel_hi:[1,0,0] neg_lo:[0,0,1] neg_hi:[0,0,1]
    v_pk_fma_f32 v[180:181], v[180:181], v[38:39], v[142:143] op_sel_hi:[1,0,0] neg_lo:[0,0,1] neg_hi:[0,0,1]
    v_pk_fma_f32 v[182:183], v[182:183], v[38:39], v[142:143] op_sel_hi:[1,0,0] neg_lo:[0,0,1] neg_hi:[0,0,1]
    s_cmp_eq_u32 s13, 1
    s_cbranch_scc1 AL_NOY
    s_cmp_lg_u32 s3, 2
    s_cbranch_scc1 AL_NOR1
    s_mov_b32 exec_lo, s99
    s_mov_b32 exec_hi, 0
    s_waitcnt vmcnt(0)
AL_RD_CHK:
    v_xor_b32 v2, s52, v109
    v_cmp_ne_u32 vcc, 0, v2
    s_cbranch_vccz AL_RD_OK
AL_RD_RETRY:
    s_add_u32 s100, s100, 1
    s_cmp_gt_u32 s100, 20000
    s_cbranch_scc1 AL_RD_OK
    s_sleep 1
    buffer_load_dword v109, v108, s[28:31], s98 offen sc1
    s_waitcnt vmcnt(0)
    s_branch AL_RD_CHK
AL_RD_OK:
    s_mov_b64 exec, -1
AL_NOR1:
    s_waitcnt vmcnt(0)
    s_barrier
    ds_read_b64_tr_b16 v[184:185], v22 offset:2176
    ds_read_b64_tr_b16 v[194:195], v23 offset:2176
    ds_read_b64_tr_b16 v[186:187], v22 offset:2176
    ds_read_b64_tr_b16 v[196:197], v23 offset:2176
    ds_read_b64_tr_b16 v[188:189], v22 offset:4352
    ds_read_b64_tr_b16 v[198:199], v23 offset:4352
    ds_read_b64_tr_b16 v[190:191], v22 offset:6528
    ds_read_b64_tr_b16 v[200:201], v23 offset:6528
    ds_read_b64_tr_b16 v[192:193], v22 offset:8704
    ds_read_b64_tr_b16 v[202:203], v23 offset:8704
AL_NOY:
    v_exp_f32 v168, v168
    v_exp_f32 v169, v169
    v_exp_f32 v170, v170
    v_exp_f32 v171, v171
    v_cvt_pk_bf16_f32 v2, v168, v169
    v_cvt_pk_bf16_f32 v3, v170, v171
    v_bfi_b32 v168, v40, 0, v2
    v_bfi_b32 v169, v41, 0, v3
    v_and_b32 v170, v40, v2
    v_and_b32 v171, v41, v3
    s_waitcnt lgkmcnt(0)
    v_exp_f32 v172, v172
    v_mfma_f32_16x16x32_bf16 v[116:119], v[28:31], v[168:171], 0
    v_exp_f32 v173, v173
    v_mfma_f32_16x16x32_bf16 v[136:139], v[184:187], v[168:171], 0
    v_exp_f32 v174, v174
    v_mfma_f32_16x16x32_bf16 v[152:155], v[194:197], v[168:171], 0
    v_exp_f32 v175, v175
    v_cvt_pk_bf16_f32 v2, v172, v173
    v_cvt_pk_bf16_f32 v3, v174, v175
    v_bfi_b32 v172, v40, 0, v2
    v_bfi_b32 v173, v41, 0, v3
    v_and_b32 v174, v40, v2
    v_and_b32 v175, v41, v3
    v_rcp_f32 v32, v116
    v_exp_f32 v176, v176
    v_mfma_f32_16x16x32_bf16 v[120:123], v[28:31], v[172:175], 0
    v_exp_f32 v177, v177
    v_mfma_f32_16x16x32_bf16 v[140:143], v[186:189], v[172:175], 0
    v_exp_f32 v178, v178
    v_mfma_f32_16x16x32_bf16 v[156:159], v[196:199], v[172:175], 0
    v_exp_f32 v179, v179
    v_cvt_pk_bf16_f32 v2, v176, v177
    v_cvt_pk_bf16_f32 v3, v178, v179
    v_bfi_b32 v176, v40, 0, v2
    v_bfi_b32 v177, v41, 0, v3
    v_and_b32 v178, v40, v2
    v_and_b32 v179, v41, v3
    v_rcp_f32 v34, v120
    v_exp_f32 v180, v180
    v_mfma_f32_16x16x32_bf16 v[116:119], v[28:31], v[176:179], 0
    v_exp_f32 v181, v181
    v_mfma_f32_16x16x32_bf16 v[144:147], v[188:191], v[176:179], 0
    v_exp_f32 v182, v182
    v_mfma_f32_16x16x32_bf16 v[160:163], v[198:201], v[176:179], 0
    v_exp_f32 v183, v183
    v_cvt_pk_bf16_f32 v2, v180, v181
    v_cvt_pk_bf16_f32 v3, v182, v183
    v_bfi_b32 v180, v40, 0, v2
    v_bfi_b32 v181, v41, 0, v3
    v_and_b32 v182, v40, v2
    v_and_b32 v183, v41, v3
    v_rcp_f32 v36, v116
    v_mul_f32 v136, v136, v32
    v_mfma_f32_16x16x32_bf16 v[120:123], v[28:31], v[180:183], 0
    v_mul_f32 v137, v137, v32
    v_mfma_f32_16x16x32_bf16 v[148:151], v[190:193], v[180:183], 0
    v_mul_f32 v138, v138, v32
    v_mfma_f32_16x16x32_bf16 v[164:167], v[200:203], v[180:183], 0
    v_mul_f32 v139, v139, v32
    v_cvt_pk_bf16_f32 v136, v136, v137
    v_cvt_pk_bf16_f32 v137, v138, v139
    v_mul_f32 v140, v140, v34
    v_mul_f32 v141, v141, v34
    v_mul_f32 v142, v142, v34
    v_mul_f32 v143, v143, v34
    v_cvt_pk_bf16_f32 v138, v140, v141
    v_cvt_pk_bf16_f32 v139, v142, v143
    v_rcp_f32 v38, v120
    v_pk_mul_f32 v[144:145], v[144:145], v[36:37] op_sel_hi:[1,0]
    v_pk_mul_f32 v[146:147], v[146:147], v[36:37] op_sel_hi:[1,0]
    v_permlane32_swap_b32 v136, v138
    v_permlane32_swap_b32 v137, v139
    v_pk_mul_f32 v[148:149], v[148:149], v[38:39] op_sel_hi:[1,0]
    v_pk_mul_f32 v[150:151], v[150:151], v[38:39] op_sel_hi:[1,0]
    v_cvt_pk_bf16_f32 v144, v144, v145
    v_cvt_pk_bf16_f32 v145, v146, v147
    v_cvt_pk_bf16_f32 v146, v148, v149
    v_cvt_pk_bf16_f32 v147, v150, v151
    s_mov_b64 exec, s[14:15]
    buffer_store_dwordx4 v[136:139], v24, s[28:31], s9 offen sc1
    s_mov_b64 exec, -1
    v_permlane32_swap_b32 v144, v146
    v_permlane32_swap_b32 v145, v147
    v_pk_mul_f32 v[152:153], v[152:153], v[32:33] op_sel_hi:[1,0]
    v_pk_mul_f32 v[154:155], v[154:155], v[32:33] op_sel_hi:[1,0]
    s_mov_b64 exec, s[16:17]
    buffer_store_dwordx4 v[144:147], v24, s[28:31], s5 offen sc1
    s_lshl_b64 exec, -1, 16
    v_pk_mul_f32 v[152:153], v[156:157], v[34:35] op_sel_hi:[1,0]
    v_pk_mul_f32 v[154:155], v[158:159], v[34:35] op_sel_hi:[1,0]
    s_lshl_b64 exec, -1, 32
    v_pk_mul_f32 v[152:153], v[160:161], v[36:37] op_sel_hi:[1,0]
    v_pk_mul_f32 v[154:155], v[162:163], v[36:37] op_sel_hi:[1,0]
    s_lshl_b64 exec, -1, 48
    v_pk_mul_f32 v[152:153], v[164:165], v[38:39] op_sel_hi:[1,0]
    v_pk_mul_f32 v[154:155], v[166:167], v[38:39] op_sel_hi:[1,0]
    s_mov_b64 exec, s[18:19]
    v_cvt_pk_bf16_f32 v152, v152, v153
    v_cvt_pk_bf16_f32 v153, v154, v155
    buffer_store_dwordx2 v[152:153], v25, s[28:31], s10 offen sc1
    s_mov_b64 exec, -1
    s_cmp_eq_u32 s13, 1
    s_cbranch_scc1 P_TAIL
    s_mov_b32 s64, s71
    s_add_u32 s65, s69, 40960
    s_add_u32 s61, s64, s65
    v_add_u32 v3, s61, v6
    ds_write_b128 v3, v[216:219] offset:0
    ds_write_b128 v3, v[220:223] offset:4096
    s_add_u32 s64, s64, 8192
    s_cmp_eq_u32 s64, 40960
    s_cselect_b32 s64, 0, s64
    s_add_u32 s61, s64, s65
    v_add_u32 v3, s61, v6
    ds_write_b128 v3, v[224:227] offset:0
    ds_write_b128 v3, v[228:231] offset:4096
    s_add_u32 s64, s64, 8192
    s_cmp_eq_u32 s64, 40960
    s_cselect_b32 s64, 0, s64
    s_add_u32 s61, s64, s65
    v_add_u32 v3, s61, v6
    ds_write_b128 v3, v[232:235] offset:0
    ds_write_b128 v3, v[236:239] offset:4096
    s_add_u32 s64, s64, 8192
    s_cmp_eq_u32 s64, 40960
    s_cselect_b32 s64, 0, s64
    s_add_u32 s61, s64, s65
    v_add_u32 v3, s61, v6
    ds_write_b128 v3, v[240:243] offset:0
    ds_write_b128 v3, v[244:247] offset:4096
    s_add_u32 s64, s64, 8192
    s_cmp_eq_u32 s64, 40960
    s_cselect_b32 s64, 0, s64
    s_add_u32 s61, s64, s65
    v_add_u32 v3, s61, v6
    ds_write_b128 v3, v[248:251] offset:0
    ds_write_b128 v3, v[252:255] offset:4096
    v_mov_b32 v2, 1
    ds_write_b8 v18, v2 offset:16
    s_branch A_DONE
AC_X:
TC0:
    s_cbranch_execz TC1
    s_setprio 0
    s_call_b64 s[20:21], K_P1
    s_call_b64 s[20:21], K_P2
    s_setprio 2
    buffer_load_dwordx4 v[136:139], v6, s[28:31], s12 offen offset:0 sc1
    buffer_load_dwordx4 v[140:143], v6, s[28:31], s12 offen offset:1024 sc1
    buffer_load_dwordx4 v[144:147], v6, s[28:31], s12 offen offset:2048 sc1
    s_setprio 2
    s_call_b64 s[20:21], K_P3
    s_setprio 2
    s_waitcnt vmcnt(0)
AC_MB_CHK:
    v_xor_b32 v2, s52, v137
    v_bitop3_b32 v2, v139, s52, v2 bitop3:0xbe
    v_bitop3_b32 v2, v141, s52, v2 bitop3:0xbe
    v_bitop3_b32 v2, v143, s52, v2 bitop3:0xbe
    v_bitop3_b32 v2, v145, s52, v2 bitop3:0xbe
    v_bitop3_b32 v2, v147, s52, v2 bitop3:0xbe
    v_cmp_ne_u32 vcc, 0, v2
    s_cbranch_vccnz AC_MB_RETRY
AC_MB_OK:
    v_lshlrev_b32 v137, 16, v136
    v_and_b32 v136, s55, v136
    v_lshlrev_b32 v139, 16, v138
    v_and_b32 v138, s55, v138
    v_add_f32 v168, v168, v137
    v_add_f32 v169, v169, v136
    v_add_f32 v170, v170, v139
    v_add_f32 v171, v171, v138
    v_lshlrev_b32 v141, 16, v140
    v_and_b32 v140, s55, v140
    v_lshlrev_b32 v143, 16, v142
    v_and_b32 v142, s55, v142
    v_add_f32 v172, v172, v141
    v_add_f32 v173, v173, v140
    v_add_f32 v174, v174, v143
    v_add_f32 v175, v175, v142
    v_lshlrev_b32 v145, 16, v144
    v_and_b32 v144, s55, v144
    v_lshlrev_b32 v147, 16, v146
    v_and_b32 v146, s55, v146
    v_add_f32 v176, v176, v145
    v_add_f32 v177, v177, v144
    v_add_f32 v178, v178, v147
    v_add_f32 v179, v179, v146
    s_branch AC_SM
AL_X:
TC7:
    s_cbranch_execz TC_END
    s_setprio 0
    s_mov_b64 exec, 1
    s_waitcnt vmcnt(4)
L_FL_CHK:
    v_xor_b32 v2, s52, v113
    v_bitop3_b32 v2, v115, s52, v2 bitop3:0xbe
    v_cmp_ne_u32 vcc, 0, v2
    s_cbranch_vccnz L_FL_RETRY
L_FL_OK:
    ds_write2_b32 v19, v112, v114 offset0:10 offset1:11
    s_mov_b64 exec, -1
    s_waitcnt lgkmcnt(0)
    s_barrier
    ds_read_b64_tr_b16 v[184:185], v22 offset:2176
    ds_read_b64_tr_b16 v[194:195], v23 offset:2176
    ds_read_b64_tr_b16 v[186:187], v22 offset:2176
    ds_read_b64_tr_b16 v[196:197], v23 offset:2176
    ds_read_b64_tr_b16 v[188:189], v22 offset:4352
    ds_read_b64_tr_b16 v[198:199], v23 offset:4352
    ds_read_b64_tr_b16 v[190:191], v22 offset:6528
    ds_read_b64_tr_b16 v[200:201], v23 offset:6528
    ds_read_b64_tr_b16 v[192:193], v22 offset:8704
    ds_read_b64_tr_b16 v[202:203], v23 offset:8704
    s_mov_b32 s64, s71
    s_add_u32 s65, s69, 40960
    s_add_u32 s61, s64, s65
    v_add_u32 v3, s61, v6
    ds_write_b128 v3, v[216:219] offset:0
    ds_write_b128 v3, v[220:223] offset:4096
    s_add_u32 s64, s64, 8192
    s_cmp_eq_u32 s64, 40960
    s_cselect_b32 s64, 0, s64
    s_add_u32 s61, s64, s65
    v_add_u32 v3, s61, v6
    ds_write_b128 v3, v[224:227] offset:0
    ds_write_b128 v3, v[228:231] offset:4096
    s_add_u32 s64, s64, 8192
    s_cmp_eq_u32 s64, 40960
    s_cselect_b32 s64, 0, s64
    s_add_u32 s61, s64, s65
    v_add_u32 v3, s61, v6
    ds_write_b128 v3, v[232:235] offset:0
    ds_write_b128 v3, v[236:239] offset:4096
    s_add_u32 s64, s64, 8192
    s_cmp_eq_u32 s64, 40960
    s_cselect_b32 s64, 0, s64
    s_add_u32 s61, s64, s65
    v_add_u32 v3, s61, v6
    ds_write_b128 v3, v[240:243] offset:0
    ds_write_b128 v3, v[244:247] offset:4096
    s_add_u32 s64, s64, 8192
    s_cmp_eq_u32 s64, 40960
    s_cselect_b32 s64, 0, s64
    s_add_u32 s61, s64, s65
    v_add_u32 v3, s61, v6
    ds_write_b128 v3, v[248:251] offset:0
    ds_write_b128 v3, v[252:255] offset:4096
    v_mov_b32 v2, 1
    ds_write_b8 v18, v2 offset:16
    s_call_b64 s[20:21], K_P1
    s_setprio 2
    buffer_load_dwordx4 v[136:139], v6, s[28:31], s12 offen offset:0 sc1
    buffer_load_dwordx4 v[140:143], v6, s[28:31], s12 offen offset:1024 sc1
    buffer_load_dwordx4 v[144:147], v6, s[28:31], s12 offen offset:2048 sc1
    buffer_load_dwordx4 v[148:151], v6, s[28:31], s12 offen offset:3072 sc1
    s_setprio 2
    s_call_b64 s[20:21], K_P2
    s_call_b64 s[20:21], K_P3
    s_setprio 2
    s_waitcnt vmcnt(0)
AL_MB_CHK:
    v_xor_b32 v2, s52, v137
    v_bitop3_b32 v2, v139, s52, v2 bitop3:0xbe
    v_bitop3_b32 v2, v141, s52, v2 bitop3:0xbe
    v_bitop3_b32 v2, v143, s52, v2 bitop3:0xbe
    v_bitop3_b32 v2, v145, s52, v2 bitop3:0xbe
    v_bitop3_b32 v2, v147, s52, v2 bitop3:0xbe
    v_bitop3_b32 v2, v149, s52, v2 bitop3:0xbe
    v_bitop3_b32 v2, v151, s52, v2 bitop3:0xbe
    v_cmp_ne_u32 vcc, 0, v2
    s_cbranch_vccnz AL_MB_RETRY
AL_MB_OK:
    v_lshlrev_b32 v137, 16, v136
    v_and_b32 v136, s55, v136
    v_lshlrev_b32 v139, 16, v138
    v_and_b32 v138, s55, v138
    v_add_f32 v168, v168, v137
    v_add_f32 v169, v169, v136
    v_add_f32 v170, v170, v139
    v_add_f32 v171, v171, v138
    v_lshlrev_b32 v141, 16, v140
    v_and_b32 v140, s55, v140
    v_lshlrev_b32 v143, 16, v142
    v_and_b32 v142, s55, v142
    v_add_f32 v172, v172, v141
    v_add_f32 v173, v173, v140
    v_add_f32 v174, v174, v143
    v_add_f32 v175, v175, v142
    v_lshlrev_b32 v145, 16, v144
    v_and_b32 v144, s55, v144
    v_lshlrev_b32 v147, 16, v146
    v_and_b32 v146, s55, v146
    v_add_f32 v176, v176, v145
    v_add_f32 v177, v177, v144
    v_add_f32 v178, v178, v147
    v_add_f32 v179, v179, v146
    v_lshlrev_b32 v149, 16, v148
    v_and_b32 v148, s55, v148
    v_lshlrev_b32 v151, 16, v150
    v_and_b32 v150, s55, v150
    v_add_f32 v180, v180, v149
    v_add_f32 v181, v181, v148
    v_add_f32 v182, v182, v151
    v_add_f32 v183, v183, v150
    s_branch AL_SM
AC_MB_RETRY:
    s_add_u32 s100, s100, 1
    s_cmp_gt_u32 s100, 20000
    s_cbranch_scc1 AC_MB_OK
    s_sleep 6
    buffer_load_dwordx4 v[136:139], v6, s[28:31], s12 offen offset:0 sc1
    buffer_load_dwordx4 v[140:143], v6, s[28:31], s12 offen offset:1024 sc1
    buffer_load_dwordx4 v[144:147], v6, s[28:31], s12 offen offset:2048 sc1
    s_waitcnt vmcnt(0)
    s_branch AC_MB_CHK
G2_ZAR:
    s_add_u32 s100, s100, 1
    s_cmp_gt_u32 s100, 200000
    s_cbranch_scc1 G2_ZAOK
    s_sleep 1
    ds_read_b64 v[2:3], v19 offset:16
    s_branch G2_ZA
G2_R0:
TC2:
    s_cbranch_execz TC3
    s_sleep 3
    buffer_load_dwordx4 v[96:99], v0, s[28:31], s96 offen offset:0 sc1
    buffer_load_dwordx4 v[100:103], v31, s[28:31], s96 offen offset:0 sc1
    buffer_load_dwordx4 v[104:107], v0, s[28:31], s96 offen offset:1024 sc1
    buffer_load_dwordx4 v[108:111], v31, s[28:31], s96 offen offset:1024 sc1
    buffer_load_dwordx4 v[112:115], v0, s[28:31], s96 offen offset:2048 sc1
    buffer_load_dwordx4 v[116:119], v31, s[28:31], s96 offen offset:2048 sc1
    buffer_load_dwordx4 v[120:123], v0, s[28:31], s96 offen offset:3072 sc1
    buffer_load_dwordx4 v[124:127], v31, s[28:31], s96 offen offset:3072 sc1
    buffer_load_dwordx4 v[128:131], v0, s[28:31], s92 offen offset:0 sc1
    buffer_load_dwordx4 v[132:135], v31, s[28:31], s92 offen offset:0 sc1
    s_add_u32 s100, s100, 1
    s_cmp_gt_u32 s100, 20000
    s_waitcnt vmcnt(0)
    s_cbranch_scc1 G2_OK0
    v_max3_u32 v2, v96, v98, v100
    v_max_u32 v2, v2, v102
    v_cmp_eq_u32 vcc, -1, v2
    s_cbranch_vccnz G2_R0
    s_branch G2_OK0
G2_R1:
    s_sleep 3
    buffer_load_dwordx4 v[104:107], v0, s[28:31], s96 offen offset:1024 sc1
    buffer_load_dwordx4 v[108:111], v31, s[28:31], s96 offen offset:1024 sc1
    buffer_load_dwordx4 v[112:115], v0, s[28:31], s96 offen offset:2048 sc1
    buffer_load_dwordx4 v[116:119], v31, s[28:31], s96 offen offset:2048 sc1
    buffer_load_dwordx4 v[120:123], v0, s[28:31], s96 offen offset:3072 sc1
    buffer_load_dwordx4 v[124:127], v31, s[28:31], s96 offen offset:3072 sc1
    buffer_load_dwordx4 v[128:131], v0, s[28:31], s92 offen offset:0 sc1
    buffer_load_dwordx4 v[132:135], v31, s[28:31], s92 offen offset:0 sc1
    buffer_load_dwordx4 v[136:139], v0, s[28:31], s92 offen offset:1024 sc1
    buffer_load_dwordx4 v[140:143], v31, s[28:31], s92 offen offset:1024 sc1
    s_add_u32 s100, s100, 1
    s_cmp_gt_u32 s100, 20000
    s_waitcnt vmcnt(0)
    s_cbranch_scc1 G2_OK1
    v_max3_u32 v2, v104, v106, v108
    v_max_u32 v2, v2, v110
    v_cmp_eq_u32 vcc, -1, v2
    s_cbranch_vccnz G2_R1
    s_branch G2_OK1
G2_R2:
    s_sleep 3
    buffer_load_dwordx4 v[112:115], v0, s[28:31], s96 offen offset:2048 sc1
    buffer_load_dwordx4 v[116:119], v31, s[28:31], s96 offen offset:2048 sc1
    buffer_load_dwordx4 v[120:123], v0, s[28:31], s96 offen offset:3072 sc1
    buffer_load_dwordx4 v[124:127], v31, s[28:31], s96 offen offset:3072 sc1
    buffer_load_dwordx4 v[128:131], v0, s[28:31], s92 offen offset:0 sc1
    buffer_load_dwordx4 v[132:135], v31, s[28:31], s92 offen offset:0 sc1
    buffer_load_dwordx4 v[136:139], v0, s[28:31], s92 offen offset:1024 sc1
    buffer_load_dwordx4 v[140:143], v31, s[28:31], s92 offen offset:1024 sc1
    buffer_load_dwordx4 v[144:147], v0, s[28:31], s92 offen offset:2048 sc1
    buffer_load_dwordx4 v[148:151], v31, s[28:31], s92 offen offset:2048 sc1
    s_add_u32 s100, s100, 1
    s_cmp_gt_u32 s100, 20000
    s_waitcnt vmcnt(0)
    s_cbranch_scc1 G2_OK2
    v_max3_u32 v2, v112, v114, v116
    v_max_u32 v2, v2, v118
    v_cmp_eq_u32 vcc, -1, v2
    s_cbranch_vccnz G2_R2
    s_branch G2_OK2
G2_R3:
    s_sleep 3
    buffer_load_dwordx4 v[120:123], v0, s[28:31], s96 offen offset:3072 sc1
    buffer_load_dwordx4 v[124:127], v31, s[28:31], s96 offen offset:3072 sc1
    buffer_load_dwordx4 v[128:131], v0, s[28:31], s92 offen offset:0 sc1
    buffer_load_dwordx4 v[132:135], v31, s[28:31], s92 offen offset:0 sc1
    buffer_load_dwordx4 v[136:139], v0, s[28:31], s92 offen offset:1024 sc1
    buffer_load_dwordx4 v[140:143], v31, s[28:31], s92 offen offset:1024 sc1
    buffer_load_dwordx4 v[144:147], v0, s[28:31], s92 offen offset:2048 sc1
    buffer_load_dwordx4 v[148:151], v31, s[28:31], s92 offen offset:2048 sc1
    buffer_load_dwordx4 v[152:155], v0, s[28:31], s4 offen offset:0 sc1
    buffer_load_dwordx4 v[156:159], v31, s[28:31], s4 offen offset:0 sc1
    s_add_u32 s100, s100, 1
    s_cmp_gt_u32 s100, 20000
    s_waitcnt vmcnt(0)
    s_cbranch_scc1 G2_OK3
    v_max3_u32 v2, v120, v122, v124
    v_max_u32 v2, v2, v126
    v_cmp_eq_u32 vcc, -1, v2
    s_cbranch_vccnz G2_R3
    s_branch G2_OK3
G2_R4:
    s_sleep 3
    buffer_load_dwordx4 v[128:131], v0, s[28:31], s92 offen offset:0 sc1
    buffer_load_dwordx4 v[132:135], v31, s[28:31], s92 offen offset:0 sc1
    buffer_load_dwordx4 v[136:139], v0, s[28:31], s92 offen offset:1024 sc1
    buffer_load_dwordx4 v[140:143], v31, s[28:31], s92 offen offset:1024 sc1
    buffer_load_dwordx4 v[144:147], v0, s[28:31], s92 offen offset:2048 sc1
    buffer_load_dwordx4 v[148:151], v31, s[28:31], s92 offen offset:2048 sc1
    buffer_load_dwordx4 v[152:155], v0, s[28:31], s4 offen offset:0 sc1
    buffer_load_dwordx4 v[156:159], v31, s[28:31], s4 offen offset:0 sc1
    buffer_load_dwordx4 v[96:99], v0, s[28:31], s4 offen offset:1024 sc1
    buffer_load_dwordx4 v[100:103], v31, s[28:31], s4 offen offset:1024 sc1
    s_add_u32 s100, s100, 1
    s_cmp_gt_u32 s100, 20000
    s_waitcnt vmcnt(0)
    s_cbranch_scc1 G2_OK4
    v_max3_u32 v2, v128, v130, v132
    v_max_u32 v2, v2, v134
    v_cmp_eq_u32 vcc, -1, v2
    s_cbranch_vccnz G2_R4
    s_branch G2_OK4
G2_R5:
    s_sleep 3
    buffer_load_dwordx4 v[136:139], v0, s[28:31], s92 offen offset:1024 sc1
    buffer_load_dwordx4 v[140:143], v31, s[28:31], s92 offen offset:1024 sc1
    buffer_load_dwordx4 v[144:147], v0, s[28:31], s92 offen offset:2048 sc1
    buffer_load_dwordx4 v[148:151], v31, s[28:31], s92 offen offset:2048 sc1
    buffer_load_dwordx4 v[152:155], v0, s[28:31], s4 offen offset:0 sc1
    buffer_load_dwordx4 v[156:159], v31, s[28:31], s4 offen offset:0 sc1
    buffer_load_dwordx4 v[96:99], v0, s[28:31], s4 offen offset:1024 sc1
    buffer_load_dwordx4 v[100:103], v31, s[28:31], s4 offen offset:1024 sc1
    buffer_load_dwordx4 v[104:107], v0, s[28:31], s4 offen offset:2048 sc1
    buffer_load_dwordx4 v[108:111], v31, s[28:31], s4 offen offset:2048 sc1
    s_add_u32 s100, s100, 1
    s_cmp_gt_u32 s100, 20000
    s_waitcnt vmcnt(0)
    s_cbranch_scc1 G2_OK5
    v_max3_u32 v2, v136, v138, v140
    v_max_u32 v2, v2, v142
    v_cmp_eq_u32 vcc, -1, v2
    s_cbranch_vccnz G2_R5
    s_branch G2_OK5
G2_R6:
    s_sleep 3
    buffer_load_dwordx4 v[144:147], v0, s[28:31], s92 offen offset:2048 sc1
    buffer_load_dwordx4 v[148:151], v31, s[28:31], s92 offen offset:2048 sc1
    buffer_load_dwordx4 v[152:155], v0, s[28:31], s4 offen offset:0 sc1
    buffer_load_dwordx4 v[156:159], v31, s[28:31], s4 offen offset:0 sc1
    buffer_load_dwordx4 v[96:99], v0, s[28:31], s4 offen offset:1024 sc1
    buffer_load_dwordx4 v[100:103], v31, s[28:31], s4 offen offset:1024 sc1
    buffer_load_dwordx4 v[104:107], v0, s[28:31], s4 offen offset:2048 sc1
    buffer_load_dwordx4 v[108:111], v31, s[28:31], s4 offen offset:2048 sc1
    buffer_load_dwordx4 v[112:115], v0, s[28:31], s4 offen offset:3072 sc1
    buffer_load_dwordx4 v[116:119], v31, s[28:31], s4 offen offset:3072 sc1
    s_add_u32 s100, s100, 1
    s_cmp_gt_u32 s100, 20000
    s_waitcnt vmcnt(0)
    s_cbranch_scc1 G2_OK6
    v_max3_u32 v2, v144, v146, v148
    v_max_u32 v2, v2, v150
    v_cmp_eq_u32 vcc, -1, v2
    s_cbranch_vccnz G2_R6
    s_branch G2_OK6
G2_R7:
TC3:
    s_cbranch_execz TC_END
    s_sleep 3
    buffer_load_dwordx4 v[152:155], v0, s[28:31], s4 offen offset:0 sc1
    buffer_load_dwordx4 v[156:159], v31, s[28:31], s4 offen offset:0 sc1
    buffer_load_dwordx4 v[96:99], v0, s[28:31], s4 offen offset:1024 sc1
    buffer_load_dwordx4 v[100:103], v31, s[28:31], s4 offen offset:1024 sc1
    buffer_load_dwordx4 v[104:107], v0, s[28:31], s4 offen offset:2048 sc1
    buffer_load_dwordx4 v[108:111], v31, s[28:31], s4 offen offset:2048 sc1
    buffer_load_dwordx4 v[112:115], v0, s[28:31], s4 offen offset:3072 sc1
    buffer_load_dwordx4 v[116:119], v31, s[28:31], s4 offen offset:3072 sc1
    buffer_load_dwordx4 v[120:123], v0, s[28:31], s6 offen offset:0 sc1
    buffer_load_dwordx4 v[124:127], v31, s[28:31], s6 offen offset:0 sc1
    s_add_u32 s100, s100, 1
    s_cmp_gt_u32 s100, 20000
    s_waitcnt vmcnt(0)
    s_cbranch_scc1 G2_OK7
    v_max3_u32 v2, v152, v154, v156
    v_max_u32 v2, v2, v158
    v_cmp_eq_u32 vcc, -1, v2
    s_cbranch_vccnz G2_R7
    s_branch G2_OK7
G2_R8:
    s_sleep 3
    buffer_load_dwordx4 v[96:99], v0, s[28:31], s4 offen offset:1024 sc1
    buffer_load_dwordx4 v[100:103], v31, s[28:31], s4 offen offset:1024 sc1
    buffer_load_dwordx4 v[104:107], v0, s[28:31], s4 offen offset:2048 sc1
    buffer_load_dwordx4 v[108:111], v31, s[28:31], s4 offen offset:2048 sc1
    buffer_load_dwordx4 v[112:115], v0, s[28:31], s4 offen offset:3072 sc1
    buffer_load_dwordx4 v[116:119], v31, s[28:31], s4 offen offset:3072 sc1
    buffer_load_dwordx4 v[120:123], v0, s[28:31], s6 offen offset:0 sc1
    buffer_load_dwordx4 v[124:127], v31, s[28:31], s6 offen offset:0 sc1
    buffer_load_dwordx4 v[128:131], v0, s[28:31], s6 offen offset:1024 sc1
    buffer_load_dwordx4 v[132:135], v31, s[28:31], s6 offen offset:1024 sc1
    s_add_u32 s100, s100, 1
    s_cmp_gt_u32 s100, 20000
    s_waitcnt vmcnt(0)
    s_cbranch_scc1 G2_OK8
    v_max3_u32 v2, v96, v98, v100
    v_max_u32 v2, v2, v102
    v_cmp_eq_u32 vcc, -1, v2
    s_cbranch_vccnz G2_R8
    s_branch G2_OK8
G2_R9:
    s_sleep 3
    buffer_load_dwordx4 v[104:107], v0, s[28:31], s4 offen offset:2048 sc1
    buffer_load_dwordx4 v[108:111], v31, s[28:31], s4 offen offset:2048 sc1
    buffer_load_dwordx4 v[112:115], v0, s[28:31], s4 offen offset:3072 sc1
    buffer_load_dwordx4 v[116:119], v31, s[28:31], s4 offen offset:3072 sc1
    buffer_load_dwordx4 v[120:123], v0, s[28:31], s6 offen offset:0 sc1
    buffer_load_dwordx4 v[124:127], v31, s[28:31], s6 offen offset:0 sc1
    buffer_load_dwordx4 v[128:131], v0, s[28:31], s6 offen offset:1024 sc1
    buffer_load_dwordx4 v[132:135], v31, s[28:31], s6 offen offset:1024 sc1
    buffer_load_dwordx4 v[136:139], v0, s[28:31], s6 offen offset:2048 sc1
    buffer_load_dwordx4 v[140:143], v31, s[28:31], s6 offen offset:2048 sc1
    s_add_u32 s100, s100, 1
    s_cmp_gt_u32 s100, 20000
    s_waitcnt vmcnt(0)
    s_cbranch_scc1 G2_OK9
    v_max3_u32 v2, v104, v106, v108
    v_max_u32 v2, v2, v110
    v_cmp_eq_u32 vcc, -1, v2
    s_cbranch_vccnz G2_R9
    s_branch G2_OK9
G2_ZL:
    s_waitcnt lgkmcnt(0)
    v_and_b32 v2, v2, v3
    v_cmp_ne_u32 vcc, 0x01010101, v2
    s_cbranch_vccz G2_ZLOK
G2_ZLR:
    s_add_u32 s100, s100, 1
    s_cmp_gt_u32 s100, 200000
    s_cbranch_scc1 G2_ZLOK
    s_sleep 1
    ds_read_b64 v[2:3], v19 offset:0
    s_branch G2_ZL
G2_R10:
    s_sleep 3
    buffer_load_dwordx4 v[112:115], v0, s[28:31], s4 offen offset:3072 sc1
    buffer_load_dwordx4 v[116:119], v31, s[28:31], s4 offen offset:3072 sc1
    buffer_load_dwordx4 v[120:123], v0, s[28:31], s6 offen offset:0 sc1
    buffer_load_dwordx4 v[124:127], v31, s[28:31], s6 offen offset:0 sc1
    buffer_load_dwordx4 v[128:131], v0, s[28:31], s6 offen offset:1024 sc1
    buffer_load_dwordx4 v[132:135], v31, s[28:31], s6 offen offset:1024 sc1
    buffer_load_dwordx4 v[136:139], v0, s[28:31], s6 offen offset:2048 sc1
    buffer_load_dwordx4 v[140:143], v31, s[28:31], s6 offen offset:2048 sc1
    s_add_u32 s100, s100, 1
    s_cmp_gt_u32 s100, 20000
    s_waitcnt vmcnt(0)
    s_cbranch_scc1 G2_OK10
    v_max3_u32 v2, v112, v114, v116
    v_max_u32 v2, v2, v118
    v_cmp_eq_u32 vcc, -1, v2
    s_cbranch_vccnz G2_R10
    s_branch G2_OK10
G2_R11:
    s_sleep 3
    buffer_load_dwordx4 v[120:123], v0, s[28:31], s6 offen offset:0 sc1
    buffer_load_dwordx4 v[124:127], v31, s[28:31], s6 offen offset:0 sc1
    buffer_load_dwordx4 v[128:131], v0, s[28:31], s6 offen offset:1024 sc1
    buffer_load_dwordx4 v[132:135], v31, s[28:31], s6 offen offset:1024 sc1
    buffer_load_dwordx4 v[136:139], v0, s[28:31], s6 offen offset:2048 sc1
    buffer_load_dwordx4 v[140:143], v31, s[28:31], s6 offen offset:2048 sc1
    s_add_u32 s100, s100, 1
    s_cmp_gt_u32 s100, 20000
    s_waitcnt vmcnt(0)
    s_cbranch_scc1 G2_OK11
    v_max3_u32 v2, v120, v122, v124
    v_max_u32 v2, v2, v126
    v_cmp_eq_u32 vcc, -1, v2
    s_cbranch_vccnz G2_R11
    s_branch G2_OK11
G2_R12:
    s_sleep 3
    buffer_load_dwordx4 v[128:131], v0, s[28:31], s6 offen offset:1024 sc1
    buffer_load_dwordx4 v[132:135], v31, s[28:31], s6 offen offset:1024 sc1
    buffer_load_dwordx4 v[136:139], v0, s[28:31], s6 offen offset:2048 sc1
    buffer_load_dwordx4 v[140:143], v31, s[28:31], s6 offen offset:2048 sc1
    buffer_load_dwordx4 v[144:147], v0, s[28:31], s93 offen offset:0 sc1
    buffer_load_dwordx4 v[148:151], v31, s[28:31], s93 offen offset:0 sc1
    buffer_load_dwordx4 v[152:155], v0, s[28:31], s7 offen offset:0 sc1
    buffer_load_dwordx4 v[156:159], v31, s[28:31], s7 offen offset:0 sc1
    s_add_u32 s100, s100, 1
    s_cmp_gt_u32 s100, 20000
    s_waitcnt vmcnt(0)
    s_cbranch_scc1 G2_OK12
    v_max3_u32 v2, v128, v130, v132
    v_max_u32 v2, v2, v134
    v_cmp_eq_u32 vcc, -1, v2
    s_cbranch_vccnz G2_R12
    s_branch G2_OK12
G2_R13:
    s_sleep 3
    buffer_load_dwordx4 v[136:139], v0, s[28:31], s6 offen offset:2048 sc1
    buffer_load_dwordx4 v[140:143], v31, s[28:31], s6 offen offset:2048 sc1
    buffer_load_dwordx4 v[144:147], v0, s[28:31], s93 offen offset:0 sc1
    buffer_load_dwordx4 v[148:151], v31, s[28:31], s93 offen offset:0 sc1
    buffer_load_dwordx4 v[152:155], v0, s[28:31], s7 offen offset:0 sc1
    buffer_load_dwordx4 v[156:159], v31, s[28:31], s7 offen offset:0 sc1
    buffer_load_dwordx4 v[96:99], v0, s[28:31], s93 offen offset:1024 sc1
    buffer_load_dwordx4 v[100:103], v31, s[28:31], s93 offen offset:1024 sc1
    buffer_load_dwordx4 v[104:107], v0, s[28:31], s7 offen offset:1024 sc1
    buffer_load_dwordx4 v[108:111], v31, s[28:31], s7 offen offset:1024 sc1
    s_add_u32 s100, s100, 1
    s_cmp_gt_u32 s100, 20000
    s_waitcnt vmcnt(0)
    s_cbranch_scc1 G2_OK13
    v_max3_u32 v2, v136, v138, v140
    v_max_u32 v2, v2, v142
    v_cmp_eq_u32 vcc, -1, v2
    s_cbranch_vccnz G2_R13
    s_branch G2_OK13
G2_R14:
TC4:
    s_cbranch_execz TC5
    s_sleep 3
    buffer_load_dwordx4 v[144:147], v0, s[28:31], s93 offen offset:0 sc1
    buffer_load_dwordx4 v[148:151], v31, s[28:31], s93 offen offset:0 sc1
    buffer_load_dwordx4 v[152:155], v0, s[28:31], s7 offen offset:0 sc1
    buffer_load_dwordx4 v[156:159], v31, s[28:31], s7 offen offset:0 sc1
    buffer_load_dwordx4 v[96:99], v0, s[28:31], s93 offen offset:1024 sc1
    buffer_load_dwordx4 v[100:103], v31, s[28:31], s93 offen offset:1024 sc1
    buffer_load_dwordx4 v[104:107], v0, s[28:31], s7 offen offset:1024 sc1
    buffer_load_dwordx4 v[108:111], v31, s[28:31], s7 offen offset:1024 sc1
    buffer_load_dwordx4 v[112:115], v0, s[28:31], s92 offen offset:3072 sc1
    buffer_load_dwordx4 v[116:119], v31, s[28:31], s92 offen offset:3072 sc1
    s_add_u32 s100, s100, 1
    s_cmp_gt_u32 s100, 20000
    s_waitcnt vmcnt(0)
    s_cbranch_scc1 G2_OK14
    v_max3_u32 v2, v144, v146, v148
    v_max_u32 v2, v2, v150
    v_cmp_eq_u32 vcc, -1, v2
    s_cbranch_vccnz G2_R14
    s_branch G2_OK14
G2_R15:
    s_sleep 3
    buffer_load_dwordx4 v[152:155], v0, s[28:31], s7 offen offset:0 sc1
    buffer_load_dwordx4 v[156:159], v31, s[28:31], s7 offen offset:0 sc1
    buffer_load_dwordx4 v[96:99], v0, s[28:31], s93 offen offset:1024 sc1
    buffer_load_dwordx4 v[100:103], v31, s[28:31], s93 offen offset:1024 sc1
    buffer_load_dwordx4 v[104:107], v0, s[28:31], s7 offen offset:1024 sc1
    buffer_load_dwordx4 v[108:111], v31, s[28:31], s7 offen offset:1024 sc1
    buffer_load_dwordx4 v[112:115], v0, s[28:31], s92 offen offset:3072 sc1
    buffer_load_dwordx4 v[116:119], v31, s[28:31], s92 offen offset:3072 sc1
    buffer_load_dwordx4 v[120:123], v0, s[28:31], s6 offen offset:3072 sc1
    buffer_load_dwordx4 v[124:127], v31, s[28:31], s6 offen offset:3072 sc1
    s_add_u32 s100, s100, 1
    s_cmp_gt_u32 s100, 20000
    s_waitcnt vmcnt(0)
    s_cbranch_scc1 G2_OK15
    v_max3_u32 v2, v152, v154, v156
    v_max_u32 v2, v2, v158
    v_cmp_eq_u32 vcc, -1, v2
    s_cbranch_vccnz G2_R15
    s_branch G2_OK15
G2_R16:
    s_sleep 3
    buffer_load_dwordx4 v[96:99], v0, s[28:31], s93 offen offset:1024 sc1
    buffer_load_dwordx4 v[100:103], v31, s[28:31], s93 offen offset:1024 sc1
    buffer_load_dwordx4 v[104:107], v0, s[28:31], s7 offen offset:1024 sc1
    buffer_load_dwordx4 v[108:111], v31, s[28:31], s7 offen offset:1024 sc1
    buffer_load_dwordx4 v[112:115], v0, s[28:31], s92 offen offset:3072 sc1
    buffer_load_dwordx4 v[116:119], v31, s[28:31], s92 offen offset:3072 sc1
    buffer_load_dwordx4 v[120:123], v0, s[28:31], s6 offen offset:3072 sc1
    buffer_load_dwordx4 v[124:127], v31, s[28:31], s6 offen offset:3072 sc1
    s_add_u32 s100, s100, 1
    s_cmp_gt_u32 s100, 20000
    s_waitcnt vmcnt(0)
    s_cbranch_scc1 G2_OK16
    v_max3_u32 v2, v96, v98, v100
    v_max_u32 v2, v2, v102
    v_cmp_eq_u32 vcc, -1, v2
    s_cbranch_vccnz G2_R16
    s_branch G2_OK16
G2_R17:
    s_sleep 3
    buffer_load_dwordx4 v[104:107], v0, s[28:31], s7 offen offset:1024 sc1
    buffer_load_dwordx4 v[108:111], v31, s[28:31], s7 offen offset:1024 sc1
    buffer_load_dwordx4 v[112:115], v0, s[28:31], s92 offen offset:3072 sc1
    buffer_load_dwordx4 v[116:119], v31, s[28:31], s92 offen offset:3072 sc1
    buffer_load_dwordx4 v[120:123], v0, s[28:31], s6 offen offset:3072 sc1
    buffer_load_dwordx4 v[124:127], v31, s[28:31], s6 offen offset:3072 sc1
    s_add_u32 s100, s100, 1
    s_cmp_gt_u32 s100, 20000
    s_waitcnt vmcnt(0)
    s_cbranch_scc1 G2_OK17
    v_max3_u32 v2, v104, v106, v108
    v_max_u32 v2, v2, v110
    v_cmp_eq_u32 vcc, -1, v2
    s_cbranch_vccnz G2_R17
    s_branch G2_OK17
G2_R18:
    s_sleep 3
    buffer_load_dwordx4 v[112:115], v0, s[28:31], s92 offen offset:3072 sc1
    buffer_load_dwordx4 v[116:119], v31, s[28:31], s92 offen offset:3072 sc1
    buffer_load_dwordx4 v[120:123], v0, s[28:31], s6 offen offset:3072 sc1
    buffer_load_dwordx4 v[124:127], v31, s[28:31], s6 offen offset:3072 sc1
    s_add_u32 s100, s100, 1
    s_cmp_gt_u32 s100, 20000
    s_waitcnt vmcnt(0)
    s_cbranch_scc1 G2_OK18
    v_max3_u32 v2, v112, v114, v116
    v_max_u32 v2, v2, v118
    v_cmp_eq_u32 vcc, -1, v2
    s_cbranch_vccnz G2_R18
    s_branch G2_OK18
G2_ZG:
    s_waitcnt lgkmcnt(0)
    v_and_b32 v2, v2, v3
    v_cmp_ne_u32 vcc, 0x01010101, v2
    s_cbranch_vccz G2_ZGOK
G2_ZGR:
    s_add_u32 s100, s100, 1
    s_cmp_gt_u32 s100, 200000
    s_cbranch_scc1 G2_ZGOK
    s_sleep 1
    ds_read_b64 v[2:3], v19 offset:8
    s_branch G2_ZG
G2_R19:
    s_sleep 3
    buffer_load_dwordx4 v[120:123], v0, s[28:31], s6 offen offset:3072 sc1
    buffer_load_dwordx4 v[124:127], v31, s[28:31], s6 offen offset:3072 sc1
    s_add_u32 s100, s100, 1
    s_cmp_gt_u32 s100, 20000
    s_waitcnt vmcnt(0)
    s_cbranch_scc1 G2_OK19
    v_max3_u32 v2, v120, v122, v124
    v_max_u32 v2, v2, v126
    v_cmp_eq_u32 vcc, -1, v2
    s_cbranch_vccnz G2_R19
    s_branch G2_OK19
P_ZR:
    s_add_u32 s100, s100, 1
    s_cmp_gt_u32 s100, 200000
    s_cbranch_scc1 P_ZOK
    s_sleep 1
    ds_read_b64 v[2:3], v19 offset:0
    s_branch P_Z
L_RC_RETRY:
    s_add_u32 s100, s100, 1
    s_cmp_gt_u32 s100, 20000
    s_cbranch_scc1 L_RC_OK
    s_sleep 4
    s_mul_i32 s60, s59, 448
    s_add_u32 m0, s60, 161536
    s_mov_b64 exec, 0xfffffff
    buffer_load_dwordx4 v81, s[28:31], 0 offen sc1 lds
    s_mov_b64 exec, -1
    s_waitcnt vmcnt(0)
    ds_read_b128 v[84:87], v82
    s_waitcnt lgkmcnt(0)
    s_waitcnt vmcnt(0)
    s_branch L_RC_CHK
L_FL_RETRY:
    s_add_u32 s100, s100, 1
    s_cmp_gt_u32 s100, 20000
    s_cbranch_scc1 L_FL_OK
    s_sleep 8
    s_mov_b64 exec, 1
    buffer_load_dwordx4 v[112:115], v6, s[28:31], 0 offen offset:256 sc1
    s_waitcnt vmcnt(0)
    s_branch L_FL_CHK
AL_MB_RETRY:
    s_add_u32 s100, s100, 1
    s_cmp_gt_u32 s100, 20000
    s_cbranch_scc1 AL_MB_OK
    s_sleep 6
    buffer_load_dwordx4 v[136:139], v6, s[28:31], s12 offen offset:0 sc1
    buffer_load_dwordx4 v[140:143], v6, s[28:31], s12 offen offset:1024 sc1
    buffer_load_dwordx4 v[144:147], v6, s[28:31], s12 offen offset:2048 sc1
    buffer_load_dwordx4 v[148:151], v6, s[28:31], s12 offen offset:3072 sc1
    s_waitcnt vmcnt(0)
    s_branch AL_MB_CHK
K_AUX0:
    s_sub_u32 s56, s2, 200
K_AUX:
    s_lshr_b32 s3, s3, 6
    s_and_b32 s59, s3, 3
    s_mov_b32 s55, 0xffff0000
    s_mov_b32 s100, 0
    v_and_b32 v1, 63, v0
    v_and_b32 v4, 15, v1
    v_lshrrev_b32 v5, 4, v1
    v_mov_b32 v19, 163584
    v_add_u32 v18, s3, v19
    s_mov_b32 s30, 7077888
    s_mov_b32 s31, 0x20000
    s_cmp_ge_u32 s3, 4
    s_cbranch_scc1 K_FC
    s_cmp_lg_u32 s101, 5
    s_cbranch_scc1 FL_SPARE
    s_waitcnt vmcnt(16)
    s_barrier
    s_mov_b32 s70, 4
FL_GU1b:
    s_mov_b32 m0, s69
    s_sub_u32 s70, s70, 1
    buffer_load_dwordx4 v30, s[48:51], s68 offen nt lds
    s_add_u32 m0, s69, 16384
    s_add_u32 s69, s69, 4096
    buffer_load_dwordx4 v30, s[36:39], s68 offen nt lds
    s_add_u32 s68, s68, 110592
    s_and_b32 s60, s70, 3
    s_cselect_b32 s60, 0, 16384
    s_add_u32 s69, s69, s60
    s_cmp_lg_u32 s70, 0
    s_cbranch_scc1 FL_GU1b
    s_barrier
    s_lshl_b32 s69, s59, 10
    s_add_u32 m0, s69, 0
    s_nop 0
    buffer_load_dwordx4 v30, s[48:51], s68 offen nt lds
    s_add_u32 m0, s69, 16384
    s_nop 0
    buffer_load_dwordx4 v30, s[36:39], s68 offen nt lds
    s_add_u32 s68, s68, 110592
    s_add_u32 m0, s69, 4096
    s_nop 0
    buffer_load_dwordx4 v30, s[48:51], s68 offen nt lds
    s_add_u32 m0, s69, 20480
    s_nop 0
    buffer_load_dwordx4 v30, s[36:39], s68 offen nt lds
    s_add_u32 s68, s68, 110592
    s_add_u32 m0, s69, 8192
    s_nop 0
    buffer_load_dwordx4 v30, s[48:51], s68 offen nt lds
    s_add_u32 m0, s69, 24576
    s_nop 0
    buffer_load_dwordx4 v30, s[36:39], s68 offen nt lds
    s_add_u32 s68, s68, 110592
    s_waitcnt vmcnt(14)
    s_barrier
    s_add_u32 m0, s69, 12288
    s_nop 0
    buffer_load_dwordx4 v30, s[48:51], s68 offen nt lds
    s_add_u32 m0, s69, 28672
    s_nop 0
    buffer_load_dwordx4 v30, s[36:39], s68 offen nt lds
    s_add_u32 s68, s68, 110592
    s_waitcnt vmcnt(0)
    s_barrier
    s_branch K_END
FL_SPARE:
    s_waitcnt lgkmcnt(0)
    s_load_dwordx2 s[48:49], s[0:1], 56
    s_load_dwordx2 s[40:41], s[0:1], 16
    s_mov_b32 s42, 819200
    s_mov_b32 s43, 0x20000
    s_and_b32 s60, s59, 2
    s_lshl_b32 s60, s60, 2
    v_lshl_or_b32 v2, v5, 1, s60
    v_xor_b32 v2, v2, v1
    v_and_b32 v2, 15, v2
    v_lshrrev_b32 v31, 4, v0
    v_mul_u32_u24 v31, 1280, v31
    v_lshl_add_u32 v31, v2, 4, v31
    s_sub_u32 s61, s56, 27
    s_mul_i32 s61, s61, 81920
    v_add_u32 v31, s61, v31
    s_lshl_b32 s63, s59, 10
    s_mov_b32 s50, 2211840
    s_mov_b32 s51, 0x20000
    s_waitcnt lgkmcnt(0)
    s_sub_u32 s60, s56, 27
    s_mul_i32 s60, s60, 28672
    v_lshlrev_b32 v30, 4, v0
    s_add_u32 m0, s63, 81920
    s_nop 0
    buffer_load_dwordx4 v30, s[40:43], s60 offen lds
    s_add_u32 s60, s60, 4096
    buffer_load_dwordx4 v30, s[40:43], s60 offen lds
    s_add_u32 s60, s60, 4096
    buffer_load_dwordx4 v30, s[40:43], s60 offen lds
    s_add_u32 s60, s60, 4096
    buffer_load_dwordx4 v30, s[40:43], s60 offen lds
    s_add_u32 s60, s60, 4096
    buffer_load_dwordx4 v30, s[40:43], s60 offen lds
    s_add_u32 s60, s60, 4096
    buffer_load_dwordx4 v30, s[40:43], s60 offen lds
    s_add_u32 s60, s60, 4096
    buffer_load_dwordx4 v30, s[40:43], s60 offen lds
    s_add_u32 s60, s60, 4096
    s_waitcnt vmcnt(0)
    s_lshl3_add_u32 s60, s56, s3
    s_lshl_b32 s60, s60, 10
    s_add_u32 s60, s60, 827392
    v_mov_b32 v108, -1
    v_mov_b32 v109, -1
    v_mov_b32 v110, -1
    v_mov_b32 v111, -1
    v_lshlrev_b32 v15, 4, v1
FL_CLR:
    buffer_store_dwordx4 v[108:111], v15, s[28:31], s60 offen sc1
    s_add_u32 s60, s60, 237568
    s_cmp_lt_u32 s60, 3977216
    s_cbranch_scc1 FL_CLR
    s_waitcnt vmcnt(0)
    s_barrier
    s_add_u32 m0, s63, 0
    s_mov_b32 s60, 0
    buffer_load_dwordx4 v31, s[48:51], s60 offen nt lds
    s_add_u32 m0, s63, 4096
    s_mov_b32 s60, 20480
    buffer_load_dwordx4 v31, s[48:51], s60 offen nt lds
    s_add_u32 m0, s63, 8192
    s_mov_b32 s60, 40960
    buffer_load_dwordx4 v31, s[48:51], s60 offen nt lds
    s_add_u32 m0, s63, 12288
    s_mov_b32 s60, 61440
    buffer_load_dwordx4 v31, s[48:51], s60 offen nt lds
    s_add_u32 m0, s63, 16384
    s_mov_b32 s60, 256
    buffer_load_dwordx4 v31, s[48:51], s60 offen nt lds
    s_add_u32 m0, s63, 20480
    s_mov_b32 s60, 20736
    buffer_load_dwordx4 v31, s[48:51], s60 offen nt lds
    s_add_u32 m0, s63, 24576
    s_mov_b32 s60, 41216
    buffer_load_dwordx4 v31, s[48:51], s60 offen nt lds
    s_add_u32 m0, s63, 28672
    s_mov_b32 s60, 61696
    buffer_load_dwordx4 v31, s[48:51], s60 offen nt lds
    s_add_u32 m0, s63, 32768
    s_mov_b32 s60, 512
    buffer_load_dwordx4 v31, s[48:51], s60 offen nt lds
    s_add_u32 m0, s63, 36864
    s_mov_b32 s60, 20992
    buffer_load_dwordx4 v31, s[48:51], s60 offen nt lds
    s_add_u32 m0, s63, 40960
    s_mov_b32 s60, 41472
    buffer_load_dwordx4 v31, s[48:51], s60 offen nt lds
    s_add_u32 m0, s63, 45056
    s_mov_b32 s60, 61952
    buffer_load_dwordx4 v31, s[48:51], s60 offen nt lds
    s_add_u32 m0, s63, 49152
    s_mov_b32 s60, 768
    buffer_load_dwordx4 v31, s[48:51], s60 offen nt lds
    s_add_u32 m0, s63, 53248
    s_mov_b32 s60, 21248
    buffer_load_dwordx4 v31, s[48:51], s60 offen nt lds
    s_add_u32 m0, s63, 57344
    s_mov_b32 s60, 41728
    buffer_load_dwordx4 v31, s[48:51], s60 offen nt lds
    s_add_u32 m0, s63, 61440
    s_mov_b32 s60, 62208
    buffer_load_dwordx4 v31, s[48:51], s60 offen nt lds
    s_add_u32 m0, s63, 65536
    s_mov_b32 s60, 1024
    buffer_load_dwordx4 v31, s[48:51], s60 offen nt lds
    s_add_u32 m0, s63, 69632
    s_mov_b32 s60, 21504
    buffer_load_dwordx4 v31, s[48:51], s60 offen nt lds
    s_add_u32 m0, s63, 73728
    s_mov_b32 s60, 41984
    buffer_load_dwordx4 v31, s[48:51], s60 offen nt lds
    s_add_u32 m0, s63, 77824
    s_mov_b32 s60, 62464
    buffer_load_dwordx4 v31, s[48:51], s60 offen nt lds
    s_waitcnt vmcnt(0)
    s_barrier
    s_branch K_END
K_FC:
    s_waitcnt lgkmcnt(0)
    v_mov_b32 v241, 0x3f803f80
    s_mul_i32 s52, s52, 0x9E3779B1
    s_add_u32 s52, s52, 0x7F4A7C15
    s_or_b32 s52, s52, 1
    v_mov_b32 v245, s52
    v_mov_b32 v247, s52
    s_bfe_u32 s60, s2, 0x10002
    s_lshl4_add_u32 s60, s68, s60
    s_sub_u32 s60, 0xffff, s60
    v_lshlrev_b32 v239, 1, v232
    v_sub_u32 v239, s60, v239
    v_lshlrev_b32 v243, 3, v232
    v_lshlrev_b32 v232, 4, v232
    v_mov_b32 v249, s52
    s_setprio 3
    s_waitcnt vmcnt(3)
    v_dot2_f32_bf16 v233, v212, v241, 0
    v_dot2_f32_bf16 v234, v212, v212, 0
    v_dot2_f32_bf16 v233, v213, v241, v233
    v_dot2_f32_bf16 v234, v213, v213, v234
    v_dot2_f32_bf16 v233, v214, v241, v233
    v_dot2_f32_bf16 v234, v214, v214, v234
    v_dot2_f32_bf16 v233, v215, v241, v233
    v_dot2_f32_bf16 v234, v215, v215, v234
    v_dot2_f32_bf16 v233, v216, v241, v233
    v_dot2_f32_bf16 v234, v216, v216, v234
    v_dot2_f32_bf16 v233, v217, v241, v233
    v_dot2_f32_bf16 v234, v217, v217, v234
    v_dot2_f32_bf16 v233, v218, v241, v233
    v_dot2_f32_bf16 v234, v218, v218, v234
    v_dot2_f32_bf16 v233, v219, v241, v233
    v_dot2_f32_bf16 v234, v219, v219, v234
    v_dot2_f32_bf16 v233, v220, v241, v233
    v_dot2_f32_bf16 v234, v220, v220, v234
    v_dot2_f32_bf16 v233, v221, v241, v233
    v_dot2_f32_bf16 v234, v221, v221, v234
    s_waitcnt vmcnt(0)
    v_dot2_f32_bf16 v235, v212, v222, 0
    v_dot2_f32_bf16 v236, v222, v241, 0
    v_dot2_f32_bf16 v235, v213, v223, v235
    v_dot2_f32_bf16 v236, v223, v241, v236
    v_dot2_f32_bf16 v235, v214, v224, v235
    v_dot2_f32_bf16 v236, v224, v241, v236
    v_dot2_f32_bf16 v235, v215, v225, v235
    v_dot2_f32_bf16 v236, v225, v241, v236
    v_dot2_f32_bf16 v235, v216, v226, v235
    v_dot2_f32_bf16 v236, v226, v241, v236
    v_dot2_f32_bf16 v235, v217, v227, v235
    v_dot2_f32_bf16 v236, v227, v241, v236
    v_dot2_f32_bf16 v235, v218, v228, v235
    v_dot2_f32_bf16 v236, v228, v241, v236
    v_dot2_f32_bf16 v235, v219, v229, v235
    v_dot2_f32_bf16 v236, v229, v241, v236
    v_dot2_f32_bf16 v235, v220, v230, v235
    v_dot2_f32_bf16 v236, v230, v241, v236
    v_dot2_f32_bf16 v235, v221, v231, v235
    v_dot2_f32_bf16 v236, v231, v241, v236
    v_permlane16_swap_b32 v233, v234
    v_add_f32 v233, v233, v234
    s_nop 0
    v_permlane16_swap_b32 v235, v236
    v_add_f32 v235, v235, v236
    v_add_f32_dpp v233, v233, v233 row_ror:8 row_mask:0xf bank_mask:0xf
    s_nop 0
    v_add_f32_dpp v235, v235, v235 row_ror:8 row_mask:0xf bank_mask:0xf
    v_add_f32_dpp v233, v233, v233 row_ror:4 row_mask:0xf bank_mask:0xf
    s_nop 0
    v_add_f32_dpp v235, v235, v235 row_ror:4 row_mask:0xf bank_mask:0xf
    v_add_f32_dpp v233, v233, v233 row_ror:2 row_mask:0xf bank_mask:0xf
    s_nop 0
    v_add_f32_dpp v235, v235, v235 row_ror:2 row_mask:0xf bank_mask:0xf
    v_add_f32_dpp v233, v233, v233 row_ror:1 row_mask:0xf bank_mask:0xf
    s_nop 0
    v_add_f32_dpp v235, v235, v235 row_ror:1 row_mask:0xf bank_mask:0xf
    v_mul_f32 v233, 0x3acccccd, v233
    v_mov_b32 v236, v235
    v_mov_b32 v234, v233
    s_nop 0
    v_permlane16_swap_b32 v235, v236
    v_permlane16_swap_b32 v233, v234
    v_fma_f32 v234, -v233, v233, v234
    v_max_f32 v234, 0, v234
    v_cvt_pk_bf16_f32 v237, v233, v234
    v_lshlrev_b32 v233, 16, v237
    v_and_b32 v234, 0xffff0000, v237
    v_add_f32 v234, 0x3727c5ac, v234
    v_cvt_pk_bf16_f32 v234, v234, v234
    v_lshlrev_b32 v234, 16, v234
    v_sqrt_f32 v234, v234
    v_fma_f32 v235, -v233, v236, v235
    v_cvt_pk_bf16_f32 v234, v234, v234
    v_lshlrev_b32 v234, 16, v234
    v_rcp_f32 v246, v234
    s_mov_b32 exec_lo, 1
    s_mov_b32 exec_hi, 1
    v_mul_f32 v235, v235, v246
    v_xor_b32 v244, 0x80000000, v233
    v_cvt_pk_bf16_f32 v235, v235, v235
    buffer_store_dwordx4 v[244:247], v232, s[28:31], s70 offen sc1
    v_ashrrev_i32 v237, 31, v235
    v_or_b32 v237, 0x80000000, v237
    v_xor_b32 v235, v235, v237
    v_bfi_b32 v248, s55, v235, v239
    buffer_store_dwordx2 v[248:249], v243, s[28:31], s71 offen sc1
    s_mov_b64 exec, -1
    s_cmp_ge_u32 s56, 27
    s_cbranch_scc1 FC_SPARE
    v_bfe_u32 v7, v1, 2, 2
    v_and_b32 v8, 3, v1
    v_lshl_add_u32 v6, v5, 3, v7
    v_bfe_u32 v2, v1, 3, 2
    v_xor_b32 v2, s59, v2
    v_lshlrev_b32 v9, 5, v2
    v_lshl_add_u32 v9, v8, 3, v9
    v_lshl_add_u32 v9, v6, 7, v9
    v_add_u32 v8, 65536, v9
    v_mov_b32 v176, 0x3f803f80
    v_mov_b32 v177, 0x3f803f80
    v_mov_b32 v178, 0x3f803f80
    v_mov_b32 v179, 0x3f803f80
    v_mov_b32 v180, 0x3f803f80
    v_mov_b32 v181, 0x3f803f80
    v_mov_b32 v182, 0x3f803f80
    v_mov_b32 v183, 0x3f803f80
    v_mov_b32 v184, 0x3f803f80
    v_mov_b32 v185, 0x3f803f80
    v_mov_b32 v186, 0x3f803f80
    v_mov_b32 v187, 0x3f803f80
    v_mov_b32 v188, 0x3f803f80
    v_mov_b32 v189, 0x3f803f80
    v_mov_b32 v190, 0x3f803f80
    v_mov_b32 v191, 0x3f803f80
    v_mov_b32 v192, 0x3f803f80
    v_mov_b32 v193, 0x3f803f80
    v_mov_b32 v194, 0x3f803f80
    v_mov_b32 v195, 0x3f803f80
    v_mov_b32 v196, 0x3f803f80
    v_mov_b32 v197, 0x3f803f80
    v_mov_b32 v198, 0x3f803f80
    v_mov_b32 v199, 0x3f803f80
    v_mov_b32 v200, 0x3f803f80
    v_mov_b32 v201, 0x3f803f80
    v_mov_b32 v202, 0x3f803f80
    v_mov_b32 v203, 0x3f803f80
    v_mov_b32 v204, 0x3f803f80
    v_mov_b32 v205, 0x3f803f80
    v_mov_b32 v206, 0x3f803f80
    v_mov_b32 v207, 0x3f803f80
    v_mov_b32 v208, 0x3f803f80
    v_mov_b32 v209, 0x3f803f80
    v_mov_b32 v210, 0x3f803f80
    v_mov_b32 v211, 0x3f803f80
    v_mov_b32 v212, 0x3f803f80
    v_mov_b32 v213, 0x3f803f80
    v_mov_b32 v214, 0x3f803f80
    v_mov_b32 v215, 0x3f803f80
    v_mov_b32 v216, 0x3f803f80
    v_mov_b32 v217, 0x3f803f80
    v_mov_b32 v218, 0x3f803f80
    v_mov_b32 v219, 0x3f803f80
    v_mov_b32 v220, 0x3f803f80
    v_mov_b32 v221, 0x3f803f80
    v_mov_b32 v222, 0x3f803f80
    v_mov_b32 v223, 0x3f803f80
    v_mov_b32 v224, 0x3f803f80
    v_mov_b32 v225, 0x3f803f80
    v_mov_b32 v226, 0x3f803f80
    v_mov_b32 v227, 0x3f803f80
    v_mov_b32 v228, 0x3f803f80
    v_mov_b32 v229, 0x3f803f80
    v_mov_b32 v230, 0x3f803f80
    v_mov_b32 v231, 0x3f803f80
    v_mov_b32 v232, 0x3f803f80
    v_mov_b32 v233, 0x3f803f80
    v_mov_b32 v234, 0x3f803f80
    v_mov_b32 v235, 0x3f803f80
    v_mov_b32 v236, 0x3f803f80
    v_mov_b32 v237, 0x3f803f80
    v_mov_b32 v238, 0x3f803f80
    v_mov_b32 v239, 0x3f803f80
    v_mov_b32 v240, 0x3f803f80
    v_mov_b32 v241, 0x3f803f80
    v_mov_b32 v242, 0x3f803f80
    v_mov_b32 v243, 0x3f803f80
    v_mov_b32 v244, 0x3f803f80
    v_mov_b32 v245, 0x3f803f80
    v_mov_b32 v246, 0x3f803f80
    v_mov_b32 v247, 0x3f803f80
    v_mov_b32 v248, 0x3f803f80
    v_mov_b32 v249, 0x3f803f80
    v_mov_b32 v250, 0x3f803f80
    v_mov_b32 v251, 0x3f803f80
    v_mov_b32 v252, 0x3f803f80
    v_mov_b32 v253, 0x3f803f80
    v_mov_b32 v254, 0x3f803f80
    v_mov_b32 v255, 0x3f803f80
    s_lshl2_add_u32 s65, s56, s59
    v_bfe_i32 v17, v1, 0, 1
    v_bfe_u32 v6, v0, 4, 4
    v_lshlrev_b32 v6, 3, v6
    v_add_u32 v6, 157952, v6
    v_lshlrev_b32 v7, 3, v4
    v_add_u32 v7, 157952, v7
    s_barrier
    v_lshlrev_b32 v12, 4, v1
    s_lshl_b32 s62, s59, 12
    s_add_u32 s60, s62, 49152
    buffer_load_dwordx4 v[120:123], v12, s[28:31], s60 offen offset:0 sc1
    buffer_load_dwordx4 v[124:127], v12, s[28:31], s60 offen offset:1024 sc1
    buffer_load_dwordx4 v[128:131], v12, s[28:31], s60 offen offset:2048 sc1
    buffer_load_dwordx4 v[132:135], v12, s[28:31], s60 offen offset:3072 sc1
    ds_read_b64_tr_b16 v[24:25], v9 offset:0
    ds_read_b64_tr_b16 v[26:27], v9 offset:512
    ds_read_b64_tr_b16 v[72:73], v9 offset:16384
    ds_read_b64_tr_b16 v[74:75], v9 offset:16896
    ds_read_b64_tr_b16 v[28:29], v9 offset:4096
    ds_read_b64_tr_b16 v[30:31], v9 offset:4608
    ds_read_b64_tr_b16 v[76:77], v9 offset:20480
    ds_read_b64_tr_b16 v[78:79], v9 offset:20992
    ds_read_b64_tr_b16 v[32:33], v9 offset:8192
    ds_read_b64_tr_b16 v[34:35], v9 offset:8704
    ds_read_b64_tr_b16 v[80:81], v9 offset:24576
    ds_read_b64_tr_b16 v[82:83], v9 offset:25088
    ds_read_b64_tr_b16 v[36:37], v9 offset:12288
    ds_read_b64_tr_b16 v[38:39], v9 offset:12800
    ds_read_b64_tr_b16 v[84:85], v9 offset:28672
    ds_read_b64_tr_b16 v[86:87], v9 offset:29184
    s_waitcnt lgkmcnt(0)
    s_barrier
    s_waitcnt vmcnt(0)
FC_KY_CHK:
    v_xor_b32 v2, s52, v121
    v_bitop3_b32 v2, v123, s52, v2 bitop3:0xbe
    v_bitop3_b32 v2, v125, s52, v2 bitop3:0xbe
    v_bitop3_b32 v2, v127, s52, v2 bitop3:0xbe
    v_bitop3_b32 v2, v129, s52, v2 bitop3:0xbe
    v_bitop3_b32 v2, v131, s52, v2 bitop3:0xbe
    v_bitop3_b32 v2, v133, s52, v2 bitop3:0xbe
    v_bitop3_b32 v2, v135, s52, v2 bitop3:0xbe
    v_cmp_ne_u32 vcc, 0, v2
    s_cbranch_vccz FC_KY_OK
FC_KY_RETRY:
    s_add_u32 s100, s100, 1
    s_cmp_gt_u32 s100, 20000
    s_cbranch_scc1 FC_KY_OK
    s_sleep 16
    s_add_u32 s60, s62, 49152
    buffer_load_dwordx4 v[120:123], v12, s[28:31], s60 offen offset:0 sc1
    buffer_load_dwordx4 v[124:127], v12, s[28:31], s60 offen offset:1024 sc1
    buffer_load_dwordx4 v[128:131], v12, s[28:31], s60 offen offset:2048 sc1
    buffer_load_dwordx4 v[132:135], v12, s[28:31], s60 offen offset:3072 sc1
    s_waitcnt vmcnt(0)
    s_branch FC_KY_CHK
FC_KY_OK:
    v_max_u32 v20, v120, v122
    v_min_u32 v21, v120, v122
    v_med3_u32 v21, v20, v21, v124
    v_max_u32 v20, v20, v124
    v_med3_u32 v21, v20, v21, v126
    v_max_u32 v20, v20, v126
    v_med3_u32 v21, v20, v21, v128
    v_max_u32 v20, v20, v128
    v_med3_u32 v21, v20, v21, v130
    v_max_u32 v20, v20, v130
    v_med3_u32 v21, v20, v21, v132
    v_max_u32 v20, v20, v132
    v_med3_u32 v21, v20, v21, v134
    v_max_u32 v20, v20, v134
    s_nop 1
    v_mov_b32_dpp v22, v20 row_ror:8 row_mask:0xf bank_mask:0xf
    v_mov_b32_dpp v23, v21 row_ror:8 row_mask:0xf bank_mask:0xf
    v_min_u32 v2, v20, v22
    v_max_u32 v20, v20, v22
    v_max3_u32 v21, v21, v23, v2
    s_nop 0
    v_mov_b32_dpp v22, v20 row_ror:4 row_mask:0xf bank_mask:0xf
    v_mov_b32_dpp v23, v21 row_ror:4 row_mask:0xf bank_mask:0xf
    v_min_u32 v2, v20, v22
    v_max_u32 v20, v20, v22
    v_max3_u32 v21, v21, v23, v2
    s_nop 0
    v_mov_b32_dpp v22, v20 row_ror:2 row_mask:0xf bank_mask:0xf
    v_mov_b32_dpp v23, v21 row_ror:2 row_mask:0xf bank_mask:0xf
    v_min_u32 v2, v20, v22
    v_max_u32 v20, v20, v22
    v_max3_u32 v21, v21, v23, v2
    s_nop 0
    v_mov_b32_dpp v22, v20 row_ror:1 row_mask:0xf bank_mask:0xf
    v_mov_b32_dpp v23, v21 row_ror:1 row_mask:0xf bank_mask:0xf
    v_min_u32 v2, v20, v22
    v_max_u32 v20, v20, v22
    v_max3_u32 v21, v21, v23, v2
    ds_write_b64 v6, v[20:21]
    s_waitcnt lgkmcnt(0)
    s_barrier
    ds_read_b64 v[20:21], v7
    s_waitcnt lgkmcnt(0)
    v_mov_b32_dpp v22, v20 row_ror:8 row_mask:0xf bank_mask:0xf
    v_mov_b32_dpp v23, v21 row_ror:8 row_mask:0xf bank_mask:0xf
    v_min_u32 v2, v20, v22
    v_max_u32 v20, v20, v22
    v_max3_u32 v21, v21, v23, v2
    s_nop 0
    v_mov_b32_dpp v22, v20 row_ror:4 row_mask:0xf bank_mask:0xf
    v_mov_b32_dpp v23, v21 row_ror:4 row_mask:0xf bank_mask:0xf
    v_min_u32 v2, v20, v22
    v_max_u32 v20, v20, v22
    v_max3_u32 v21, v21, v23, v2
    s_nop 0
    v_mov_b32_dpp v22, v20 row_ror:2 row_mask:0xf bank_mask:0xf
    v_mov_b32_dpp v23, v21 row_ror:2 row_mask:0xf bank_mask:0xf
    v_min_u32 v2, v20, v22
    v_max_u32 v20, v20, v22
    v_max3_u32 v21, v21, v23, v2
    s_nop 0
    v_mov_b32_dpp v22, v20 row_ror:1 row_mask:0xf bank_mask:0xf
    v_mov_b32_dpp v23, v21 row_ror:1 row_mask:0xf bank_mask:0xf
    v_min_u32 v2, v20, v22
    v_max_u32 v20, v20, v22
    v_max3_u32 v21, v21, v23, v2
    v_bfi_b32 v10, v17, v21, v20
    v_not_b32 v2, v10
    v_and_b32 v2, 2047, v2
    v_mul_u32_u24 v17, 1280, v2
    v_lshrrev_b32 v16, 1, v2
    v_and_b32 v3, 1, v2
    v_lshl_add_u32 v16, v3, 10, v16
    v_readlane_b32 s60, v17, 0
    v_readlane_b32 s61, v17, 1
    v_lshlrev_b32 v16, 4, v16
    v_add_u32 v16, 16384, v16
    s_mul_i32 s62, s59, 2624
    s_add_u32 s62, s62, 147456
    s_add_u32 m0, s62, 0
    s_nop 0
    buffer_load_dwordx4 v12, s[24:27], s60 offen lds
    s_add_u32 m0, s62, 1344
    s_nop 0
    buffer_load_dwordx4 v12, s[24:27], s61 offen lds
    s_mov_b64 exec, 0xffff
    s_add_u32 m0, s62, 0
    s_nop 0
    buffer_load_dwordx4 v12, s[24:27], s60 offen offset:1024 lds
    s_add_u32 m0, s62, 1344
    s_nop 0
    buffer_load_dwordx4 v12, s[24:27], s61 offen offset:1024 lds
    s_mov_b32 exec_lo, 0x00030003
    s_mov_b32 exec_hi, 0x00030003
    buffer_load_dwordx4 v[20:23], v16, s[28:31], 0 offen
    s_mov_b64 exec, -1
    v_and_b32 v17, 1, v1
    v_mul_u32_u24 v17, 1344, v17
    v_lshl_add_u32 v17, v5, 4, v17
    v_add_u32 v17, s62, v17
    ds_read_b64_tr_b16 v[40:41], v9 offset:32768
    ds_read_b64_tr_b16 v[42:43], v9 offset:33280
    ds_read_b64_tr_b16 v[88:89], v9 offset:49152
    ds_read_b64_tr_b16 v[90:91], v9 offset:49664
    ds_read_b64_tr_b16 v[44:45], v9 offset:36864
    ds_read_b64_tr_b16 v[46:47], v9 offset:37376
    ds_read_b64_tr_b16 v[92:93], v9 offset:53248
    ds_read_b64_tr_b16 v[94:95], v9 offset:53760
    ds_read_b64_tr_b16 v[48:49], v9 offset:40960
    ds_read_b64_tr_b16 v[50:51], v9 offset:41472
    ds_read_b64_tr_b16 v[96:97], v9 offset:57344
    ds_read_b64_tr_b16 v[98:99], v9 offset:57856
    ds_read_b64_tr_b16 v[52:53], v9 offset:45056
    ds_read_b64_tr_b16 v[54:55], v9 offset:45568
    ds_read_b64_tr_b16 v[100:101], v9 offset:61440
    ds_read_b64_tr_b16 v[102:103], v9 offset:61952
    ds_read_b64_tr_b16 v[56:57], v8 offset:0
    ds_read_b64_tr_b16 v[58:59], v8 offset:512
    ds_read_b64_tr_b16 v[104:105], v8 offset:16384
    ds_read_b64_tr_b16 v[106:107], v8 offset:16896
    ds_read_b64_tr_b16 v[60:61], v8 offset:4096
    ds_read_b64_tr_b16 v[62:63], v8 offset:4608
    ds_read_b64_tr_b16 v[108:109], v8 offset:20480
    ds_read_b64_tr_b16 v[110:111], v8 offset:20992
    ds_read_b64_tr_b16 v[64:65], v8 offset:8192
    ds_read_b64_tr_b16 v[66:67], v8 offset:8704
    ds_read_b64_tr_b16 v[112:113], v8 offset:24576
    ds_read_b64_tr_b16 v[114:115], v8 offset:25088
    ds_read_b64_tr_b16 v[68:69], v8 offset:12288
    ds_read_b64_tr_b16 v[70:71], v8 offset:12800
    ds_read_b64_tr_b16 v[116:117], v8 offset:28672
    ds_read_b64_tr_b16 v[118:119], v8 offset:29184
    s_waitcnt vmcnt(0)
    s_mov_b32 exec_lo, 0x00030003
    s_mov_b32 exec_hi, 0x00030003
    ds_read_b128 v[176:179], v17 offset:0
    ds_read_b128 v[180:183], v17 offset:64
    ds_read_b128 v[184:187], v17 offset:128
    ds_read_b128 v[188:191], v17 offset:192
    ds_read_b128 v[192:195], v17 offset:256
    ds_read_b128 v[196:199], v17 offset:320
    ds_read_b128 v[200:203], v17 offset:384
    ds_read_b128 v[204:207], v17 offset:448
    ds_read_b128 v[208:211], v17 offset:512
    ds_read_b128 v[212:215], v17 offset:576
    ds_read_b128 v[216:219], v17 offset:640
    ds_read_b128 v[220:223], v17 offset:704
    ds_read_b128 v[224:227], v17 offset:768
    ds_read_b128 v[228:231], v17 offset:832
    ds_read_b128 v[232:235], v17 offset:896
    ds_read_b128 v[236:239], v17 offset:960
    ds_read_b128 v[240:243], v17 offset:1024
    ds_read_b128 v[244:247], v17 offset:1088
    ds_read_b128 v[248:251], v17 offset:1152
    ds_read_b128 v[252:255], v17 offset:1216
    s_mov_b64 exec, -1
    s_waitcnt lgkmcnt(15)
    v_mfma_f32_16x16x32_bf16 v[152:155], v[24:27], v[176:179], 0
    v_mfma_f32_16x16x32_bf16 v[156:159], v[72:75], v[176:179], 0
    v_mfma_f32_16x16x32_bf16 v[152:155], v[28:31], v[180:183], v[152:155]
    v_mfma_f32_16x16x32_bf16 v[156:159], v[76:79], v[180:183], v[156:159]
    v_mfma_f32_16x16x32_bf16 v[152:155], v[32:35], v[184:187], v[152:155]
    v_mfma_f32_16x16x32_bf16 v[156:159], v[80:83], v[184:187], v[156:159]
    v_mfma_f32_16x16x32_bf16 v[152:155], v[36:39], v[188:191], v[152:155]
    v_mfma_f32_16x16x32_bf16 v[156:159], v[84:87], v[188:191], v[156:159]
    s_waitcnt lgkmcnt(12)
    v_mfma_f32_16x16x32_bf16 v[152:155], v[40:43], v[192:195], v[152:155]
    v_mfma_f32_16x16x32_bf16 v[156:159], v[88:91], v[192:195], v[156:159]
    v_mfma_f32_16x16x32_bf16 v[152:155], v[44:47], v[196:199], v[152:155]
    v_mfma_f32_16x16x32_bf16 v[156:159], v[92:95], v[196:199], v[156:159]
    v_mfma_f32_16x16x32_bf16 v[152:155], v[48:51], v[200:203], v[152:155]
    v_mfma_f32_16x16x32_bf16 v[156:159], v[96:99], v[200:203], v[156:159]
    v_mfma_f32_16x16x32_bf16 v[152:155], v[52:55], v[204:207], v[152:155]
    v_mfma_f32_16x16x32_bf16 v[156:159], v[100:103], v[204:207], v[156:159]
    s_waitcnt lgkmcnt(8)
    v_mfma_f32_16x16x32_bf16 v[152:155], v[56:59], v[208:211], v[152:155]
    v_mfma_f32_16x16x32_bf16 v[156:159], v[104:107], v[208:211], v[156:159]
    v_mfma_f32_16x16x32_bf16 v[152:155], v[60:63], v[212:215], v[152:155]
    v_mfma_f32_16x16x32_bf16 v[156:159], v[108:111], v[212:215], v[156:159]
    v_mfma_f32_16x16x32_bf16 v[152:155], v[64:67], v[216:219], v[152:155]
    v_mfma_f32_16x16x32_bf16 v[156:159], v[112:115], v[216:219], v[156:159]
    v_mfma_f32_16x16x32_bf16 v[152:155], v[68:71], v[220:223], v[152:155]
    v_mfma_f32_16x16x32_bf16 v[156:159], v[116:119], v[220:223], v[156:159]
    s_barrier
    ds_read_b64_tr_b16 v[120:121], v8 offset:32768
    ds_read_b64_tr_b16 v[122:123], v8 offset:33280
    ds_read_b64_tr_b16 v[136:137], v8 offset:49152
    ds_read_b64_tr_b16 v[138:139], v8 offset:49664
    ds_read_b64_tr_b16 v[124:125], v8 offset:36864
    ds_read_b64_tr_b16 v[126:127], v8 offset:37376
    ds_read_b64_tr_b16 v[140:141], v8 offset:53248
    ds_read_b64_tr_b16 v[142:143], v8 offset:53760
    ds_read_b64_tr_b16 v[128:129], v8 offset:40960
    ds_read_b64_tr_b16 v[130:131], v8 offset:41472
    ds_read_b64_tr_b16 v[144:145], v8 offset:57344
    ds_read_b64_tr_b16 v[146:147], v8 offset:57856
    ds_read_b64_tr_b16 v[132:133], v8 offset:45056
    ds_read_b64_tr_b16 v[134:135], v8 offset:45568
    ds_read_b64_tr_b16 v[148:149], v8 offset:61440
    ds_read_b64_tr_b16 v[150:151], v8 offset:61952
    ds_read_b64_tr_b16 v[24:25], v9 offset:0
    ds_read_b64_tr_b16 v[26:27], v9 offset:512
    ds_read_b64_tr_b16 v[72:73], v9 offset:16384
    ds_read_b64_tr_b16 v[74:75], v9 offset:16896
    ds_read_b64_tr_b16 v[28:29], v9 offset:4096
    ds_read_b64_tr_b16 v[30:31], v9 offset:4608
    ds_read_b64_tr_b16 v[76:77], v9 offset:20480
    ds_read_b64_tr_b16 v[78:79], v9 offset:20992
    ds_read_b64_tr_b16 v[32:33], v9 offset:8192
    ds_read_b64_tr_b16 v[34:35], v9 offset:8704
    ds_read_b64_tr_b16 v[80:81], v9 offset:24576
    ds_read_b64_tr_b16 v[82:83], v9 offset:25088
    ds_read_b64_tr_b16 v[36:37], v9 offset:12288
    ds_read_b64_tr_b16 v[38:39], v9 offset:12800
    ds_read_b64_tr_b16 v[84:85], v9 offset:28672
    ds_read_b64_tr_b16 v[86:87], v9 offset:29184
    s_waitcnt lgkmcnt(15)
    v_mfma_f32_16x16x32_bf16 v[152:155], v[120:123], v[224:227], v[152:155]
    v_mfma_f32_16x16x32_bf16 v[156:159], v[136:139], v[224:227], v[156:159]
    v_mfma_f32_16x16x32_bf16 v[152:155], v[124:127], v[228:231], v[152:155]
    v_mfma_f32_16x16x32_bf16 v[156:159], v[140:143], v[228:231], v[156:159]
    v_mfma_f32_16x16x32_bf16 v[152:155], v[128:131], v[232:235], v[152:155]
    v_mfma_f32_16x16x32_bf16 v[156:159], v[144:147], v[232:235], v[156:159]
    v_mfma_f32_16x16x32_bf16 v[152:155], v[132:135], v[236:239], v[152:155]
    v_mfma_f32_16x16x32_bf16 v[156:159], v[148:151], v[236:239], v[156:159]
    s_waitcnt lgkmcnt(0)
    v_mfma_f32_16x16x32_bf16 v[152:155], v[24:27], v[240:243], v[152:155]
    v_mfma_f32_16x16x32_bf16 v[156:159], v[72:75], v[240:243], v[156:159]
    v_mfma_f32_16x16x32_bf16 v[152:155], v[28:31], v[244:247], v[152:155]
    v_mfma_f32_16x16x32_bf16 v[156:159], v[76:79], v[244:247], v[156:159]
    v_mfma_f32_16x16x32_bf16 v[152:155], v[32:35], v[248:251], v[152:155]
    v_mfma_f32_16x16x32_bf16 v[156:159], v[80:83], v[248:251], v[156:159]
    v_mfma_f32_16x16x32_bf16 v[152:155], v[36:39], v[252:255], v[152:155]
    v_mfma_f32_16x16x32_bf16 v[156:159], v[84:87], v[252:255], v[156:159]
    s_mov_b32 exec_lo, 0x00030003
    s_mov_b32 exec_hi, 0x00030003
    s_waitcnt vmcnt(0)
FC_RC_CHK:
    v_xor_b32 v2, s52, v21
    v_bitop3_b32 v2, v23, s52, v2 bitop3:0xbe
    v_cmp_ne_u32 vcc, 0, v2
    s_cbranch_vccz FC_RC_OK
FC_RC_RETRY:
    s_add_u32 s100, s100, 1
    s_cmp_gt_u32 s100, 20000
    s_cbranch_scc1 FC_RC_OK
    s_sleep 2
    buffer_load_dwordx4 v[20:23], v16, s[28:31], 0 offen sc1
    s_waitcnt vmcnt(0)
    s_branch FC_RC_CHK
FC_RC_OK:
    s_mov_b64 exec, -1
    v_mov_b32_dpp v160, v152 row_newbcast:2 row_mask:0xf bank_mask:0xf
    v_mov_b32_dpp v164, v156 row_newbcast:2 row_mask:0xf bank_mask:0xf
    v_mov_b32_dpp v161, v153 row_newbcast:2 row_mask:0xf bank_mask:0xf
    v_mov_b32_dpp v165, v157 row_newbcast:2 row_mask:0xf bank_mask:0xf
    v_mov_b32_dpp v162, v154 row_newbcast:2 row_mask:0xf bank_mask:0xf
    v_mov_b32_dpp v166, v158 row_newbcast:2 row_mask:0xf bank_mask:0xf
    v_mov_b32_dpp v163, v155 row_newbcast:2 row_mask:0xf bank_mask:0xf
    v_mov_b32_dpp v167, v159 row_newbcast:2 row_mask:0xf bank_mask:0xf
    v_fma_f32 v152, v20, v160, v152
    v_fma_f32 v156, v20, v164, v156
    v_fma_f32 v153, v20, v161, v153
    v_fma_f32 v157, v20, v165, v157
    v_fma_f32 v154, v20, v162, v154
    v_fma_f32 v158, v20, v166, v158
    v_fma_f32 v155, v20, v163, v155
    v_fma_f32 v159, v20, v167, v159
    v_mul_f32 v152, v152, v22
    v_mul_f32 v156, v156, v22
    v_mul_f32 v153, v153, v22
    v_mul_f32 v157, v157, v22
    v_mul_f32 v154, v154, v22
    v_mul_f32 v158, v158, v22
    v_mul_f32 v155, v155, v22
    v_mul_f32 v159, v159, v22
    v_cvt_pk_bf16_f32 v152, v152, v156
    v_cvt_pk_bf16_f32 v153, v153, v157
    v_cvt_pk_bf16_f32 v154, v154, v158
    v_cvt_pk_bf16_f32 v155, v155, v159
    v_and_b32 v156, s55, v152
    v_lshlrev_b32 v152, 16, v152
    v_and_b32 v157, s55, v153
    v_lshlrev_b32 v153, 16, v153
    v_and_b32 v158, s55, v154
    v_lshlrev_b32 v154, 16, v154
    v_and_b32 v159, s55, v155
    v_lshlrev_b32 v155, 16, v155
    v_mul_f32 v160, 0xbfb8aa3b, v152
    v_mul_f32 v161, 0xbfb8aa3b, v153
    v_mul_f32 v162, 0xbfb8aa3b, v154
    v_mul_f32 v163, 0xbfb8aa3b, v155
    v_exp_f32 v160, v160
    v_exp_f32 v161, v161
    v_exp_f32 v162, v162
    v_exp_f32 v163, v163
    v_add_f32 v160, 1.0, v160
    v_add_f32 v161, 1.0, v161
    v_add_f32 v162, 1.0, v162
    v_add_f32 v163, 1.0, v163
    v_rcp_f32 v160, v160
    v_rcp_f32 v161, v161
    v_rcp_f32 v162, v162
    v_rcp_f32 v163, v163
    v_mul_f32 v152, v152, v160
    v_mul_f32 v153, v153, v161
    v_mul_f32 v154, v154, v162
    v_mul_f32 v155, v155, v163
    v_cvt_pk_bf16_f32 v152, v152, v152
    v_cvt_pk_bf16_f32 v153, v153, v153
    v_cvt_pk_bf16_f32 v154, v154, v154
    v_cvt_pk_bf16_f32 v155, v155, v155
    v_lshlrev_b32 v152, 16, v152
    v_lshlrev_b32 v153, 16, v153
    v_lshlrev_b32 v154, 16, v154
    v_lshlrev_b32 v155, 16, v155
    v_mul_f32 v152, v152, v156
    v_mul_f32 v153, v153, v157
    v_mul_f32 v154, v154, v158
    v_mul_f32 v155, v155, v159
    v_cvt_pk_bf16_f32 v152, v152, v153
    v_cvt_pk_bf16_f32 v154, v154, v155
    v_mov_b32 v153, s52
    v_mov_b32 v155, s52
    v_lshlrev_b32 v3, 6, v4
    v_lshl_add_u32 v3, v5, 4, v3
    s_lshl_b32 s60, s65, 7
    s_add_u32 s60, s60, 425984
    s_mov_b32 exec_lo, 0x00030003
    s_mov_b32 exec_hi, 0x00030003
    buffer_store_dwordx4 v[152:155], v3, s[28:31], s60 offen sc1
    s_mov_b64 exec, -1
    s_branch K_END
FC_SPARE:
    v_bfe_u32 v7, v1, 2, 2
    v_and_b32 v8, 3, v1
    v_and_b32 v3, 1, v5
    v_lshl_or_b32 v12, v3, 2, v7
    v_lshl_add_u32 v6, v5, 3, v7
    v_lshlrev_b32 v13, 8, v6
    v_lshl_add_u32 v13, v8, 3, v13
    s_lshl3_add_u32 s60, s56, s3
    s_lshl_b32 s60, s60, 10
    s_add_u32 s60, s60, 827392
    v_mov_b32 v108, -1
    v_mov_b32 v109, -1
    v_mov_b32 v110, -1
    v_mov_b32 v111, -1
    v_lshlrev_b32 v15, 4, v1
FC_CLR:
    buffer_store_dwordx4 v[108:111], v15, s[28:31], s60 offen sc1
    s_add_u32 s60, s60, 237568
    s_cmp_lt_u32 s60, 3977216
    s_cbranch_scc1 FC_CLR
    s_lshl_b32 s64, s56, 7
    s_add_u32 s64, s64, 4736
    v_mov_b32 v104, s52
    v_mov_b32 v105, s52
    v_mov_b32 v106, s52
    v_mov_b32 v107, s52
    s_waitcnt vmcnt(0)
    s_barrier
    s_cmp_lg_u32 s59, 0
    s_cbranch_scc1 FC_NOFL
    s_mov_b64 exec, 0xff
    buffer_store_dwordx4 v[104:107], v15, s[28:31], s64 offen sc1
    s_mov_b64 exec, -1
FC_NOFL:
    s_lshl2_add_u32 s60, s56, s59
    s_cmp_eq_u32 s60, 221
    s_cbranch_scc1 FC_TOP
    s_cmp_lg_u32 s54, 30
    s_cbranch_scc1 FC_NOWR
    s_and_b32 s60, s2, 4
    s_add_u32 s60, s60, s59
    s_lshl_b32 s60, s60, 12
    s_add_u32 s60, s60, 16384
    buffer_load_dwordx4 v[168:171], v15, s[28:31], s60 offen offset:0
    buffer_load_dwordx4 v[168:171], v15, s[28:31], s60 offen offset:1024
    buffer_load_dwordx4 v[168:171], v15, s[28:31], s60 offen offset:2048
    buffer_load_dwordx4 v[168:171], v15, s[28:31], s60 offen offset:3072
FC_NOWR:
    s_barrier
    s_mul_i32 s60, s59, 10
    s_add_u32 s60, s60, 0
    s_and_b32 s61, s60, 7
    s_lshr_b32 s60, s60, 3
    s_lshl_b32 s60, s60, 14
    v_xor_b32 v2, s61, v12
    v_lshl_add_u32 v2, v2, 5, v13
    v_add_u32 v2, s60, v2
    ds_read_b64_tr_b16 v[24:25], v2 offset:0
    ds_read_b64_tr_b16 v[26:27], v2 offset:1024
    ds_read_b64_tr_b16 v[28:29], v2 offset:8192
    ds_read_b64_tr_b16 v[30:31], v2 offset:9216
    s_mul_i32 s60, s59, 10
    s_add_u32 s60, s60, 1
    s_and_b32 s61, s60, 7
    s_lshr_b32 s60, s60, 3
    s_lshl_b32 s60, s60, 14
    v_xor_b32 v2, s61, v12
    v_lshl_add_u32 v2, v2, 5, v13
    v_add_u32 v2, s60, v2
    ds_read_b64_tr_b16 v[32:33], v2 offset:0
    ds_read_b64_tr_b16 v[34:35], v2 offset:1024
    ds_read_b64_tr_b16 v[36:37], v2 offset:8192
    ds_read_b64_tr_b16 v[38:39], v2 offset:9216
    s_mul_i32 s60, s59, 10
    s_add_u32 s60, s60, 2
    s_and_b32 s61, s60, 7
    s_lshr_b32 s60, s60, 3
    s_lshl_b32 s60, s60, 14
    v_xor_b32 v2, s61, v12
    v_lshl_add_u32 v2, v2, 5, v13
    v_add_u32 v2, s60, v2
    ds_read_b64_tr_b16 v[40:41], v2 offset:0
    ds_read_b64_tr_b16 v[42:43], v2 offset:1024
    ds_read_b64_tr_b16 v[44:45], v2 offset:8192
    ds_read_b64_tr_b16 v[46:47], v2 offset:9216
    s_mul_i32 s60, s59, 10
    s_add_u32 s60, s60, 3
    s_and_b32 s61, s60, 7
    s_lshr_b32 s60, s60, 3
    s_lshl_b32 s60, s60, 14
    v_xor_b32 v2, s61, v12
    v_lshl_add_u32 v2, v2, 5, v13
    v_add_u32 v2, s60, v2
    ds_read_b64_tr_b16 v[48:49], v2 offset:0
    ds_read_b64_tr_b16 v[50:51], v2 offset:1024
    ds_read_b64_tr_b16 v[52:53], v2 offset:8192
    ds_read_b64_tr_b16 v[54:55], v2 offset:9216
    s_mul_i32 s60, s59, 10
    s_add_u32 s60, s60, 4
    s_and_b32 s61, s60, 7
    s_lshr_b32 s60, s60, 3
    s_lshl_b32 s60, s60, 14
    v_xor_b32 v2, s61, v12
    v_lshl_add_u32 v2, v2, 5, v13
    v_add_u32 v2, s60, v2
    ds_read_b64_tr_b16 v[56:57], v2 offset:0
    ds_read_b64_tr_b16 v[58:59], v2 offset:1024
    ds_read_b64_tr_b16 v[60:61], v2 offset:8192
    ds_read_b64_tr_b16 v[62:63], v2 offset:9216
    s_mul_i32 s60, s59, 10
    s_add_u32 s60, s60, 5
    s_and_b32 s61, s60, 7
    s_lshr_b32 s60, s60, 3
    s_lshl_b32 s60, s60, 14
    v_xor_b32 v2, s61, v12
    v_lshl_add_u32 v2, v2, 5, v13
    v_add_u32 v2, s60, v2
    ds_read_b64_tr_b16 v[64:65], v2 offset:0
    ds_read_b64_tr_b16 v[66:67], v2 offset:1024
    ds_read_b64_tr_b16 v[68:69], v2 offset:8192
    ds_read_b64_tr_b16 v[70:71], v2 offset:9216
    s_mul_i32 s60, s59, 10
    s_add_u32 s60, s60, 6
    s_and_b32 s61, s60, 7
    s_lshr_b32 s60, s60, 3
    s_lshl_b32 s60, s60, 14
    v_xor_b32 v2, s61, v12
    v_lshl_add_u32 v2, v2, 5, v13
    v_add_u32 v2, s60, v2
    ds_read_b64_tr_b16 v[72:73], v2 offset:0
    ds_read_b64_tr_b16 v[74:75], v2 offset:1024
    ds_read_b64_tr_b16 v[76:77], v2 offset:8192
    ds_read_b64_tr_b16 v[78:79], v2 offset:9216
    s_mul_i32 s60, s59, 10
    s_add_u32 s60, s60, 7
    s_and_b32 s61, s60, 7
    s_lshr_b32 s60, s60, 3
    s_lshl_b32 s60, s60, 14
    v_xor_b32 v2, s61, v12
    v_lshl_add_u32 v2, v2, 5, v13
    v_add_u32 v2, s60, v2
    ds_read_b64_tr_b16 v[80:81], v2 offset:0
    ds_read_b64_tr_b16 v[82:83], v2 offset:1024
    ds_read_b64_tr_b16 v[84:85], v2 offset:8192
    ds_read_b64_tr_b16 v[86:87], v2 offset:9216
    s_mul_i32 s60, s59, 10
    s_add_u32 s60, s60, 8
    s_and_b32 s61, s60, 7
    s_lshr_b32 s60, s60, 3
    s_lshl_b32 s60, s60, 14
    v_xor_b32 v2, s61, v12
    v_lshl_add_u32 v2, v2, 5, v13
    v_add_u32 v2, s60, v2
    ds_read_b64_tr_b16 v[88:89], v2 offset:0
    ds_read_b64_tr_b16 v[90:91], v2 offset:1024
    ds_read_b64_tr_b16 v[92:93], v2 offset:8192
    ds_read_b64_tr_b16 v[94:95], v2 offset:9216
    s_mul_i32 s60, s59, 10
    s_add_u32 s60, s60, 9
    s_and_b32 s61, s60, 7
    s_lshr_b32 s60, s60, 3
    s_lshl_b32 s60, s60, 14
    v_xor_b32 v2, s61, v12
    v_lshl_add_u32 v2, v2, 5, v13
    v_add_u32 v2, s60, v2
    ds_read_b64_tr_b16 v[96:97], v2 offset:0
    ds_read_b64_tr_b16 v[98:99], v2 offset:1024
    ds_read_b64_tr_b16 v[100:101], v2 offset:8192
    ds_read_b64_tr_b16 v[102:103], v2 offset:9216
    v_lshrrev_b32 v14, 1, v5
    v_lshlrev_b32 v14, 7, v14
    v_and_b32 v2, 1, v1
    v_lshl_add_u32 v14, v2, 6, v14
    v_lshl_add_u32 v14, v3, 5, v14
    s_sub_u32 s63, s56, 27
    s_waitcnt lgkmcnt(0)
    s_cmp_ge_u32 s63, 27
    s_cbranch_scc1 K_END
    s_lshl_b32 s65, s63, 9
    s_add_u32 s65, s65, 425984
    s_mov_b32 exec_lo, 0x33333333
    s_mov_b32 exec_hi, 0x33333333
    buffer_load_dwordx4 v[112:115], v14, s[28:31], s65 offen offset:0 sc1
    buffer_load_dwordx4 v[116:119], v14, s[28:31], s65 offen offset:16 sc1
    buffer_load_dwordx4 v[120:123], v14, s[28:31], s65 offen offset:256 sc1
    buffer_load_dwordx4 v[124:127], v14, s[28:31], s65 offen offset:272 sc1
    s_waitcnt vmcnt(0)
D_H_CHK:
    v_xor_b32 v2, s52, v113
    v_bitop3_b32 v2, v115, s52, v2 bitop3:0xbe
    v_bitop3_b32 v2, v117, s52, v2 bitop3:0xbe
    v_bitop3_b32 v2, v119, s52, v2 bitop3:0xbe
    v_bitop3_b32 v2, v121, s52, v2 bitop3:0xbe
    v_bitop3_b32 v2, v123, s52, v2 bitop3:0xbe
    v_bitop3_b32 v2, v125, s52, v2 bitop3:0xbe
    v_bitop3_b32 v2, v127, s52, v2 bitop3:0xbe
    v_cmp_ne_u32 vcc, 0, v2
    s_cbranch_vccz D_H_OK
D_H_RETRY:
    s_add_u32 s100, s100, 1
    s_cmp_gt_u32 s100, 20000
    s_cbranch_scc1 D_H_OK
    s_sleep 6
    buffer_load_dwordx4 v[112:115], v14, s[28:31], s65 offen offset:0 sc1
    buffer_load_dwordx4 v[116:119], v14, s[28:31], s65 offen offset:16 sc1
    buffer_load_dwordx4 v[120:123], v14, s[28:31], s65 offen offset:256 sc1
    buffer_load_dwordx4 v[124:127], v14, s[28:31], s65 offen offset:272 sc1
    s_waitcnt vmcnt(0)
    s_branch D_H_CHK
D_H_OK:
    s_mov_b64 exec, -1
    v_mov_b32 v132, v112
    v_mov_b32 v133, v114
    v_mov_b32 v134, v116
    v_mov_b32 v135, v118
    v_mov_b32 v136, v120
    v_mov_b32 v137, v122
    v_mov_b32 v138, v124
    v_mov_b32 v139, v126
    v_mfma_f32_16x16x32_bf16 v[176:179], v[132:135], v[24:27], 0
    v_mfma_f32_16x16x32_bf16 v[180:183], v[132:135], v[32:35], 0
    v_mfma_f32_16x16x32_bf16 v[184:187], v[132:135], v[40:43], 0
    v_mfma_f32_16x16x32_bf16 v[188:191], v[132:135], v[48:51], 0
    v_mfma_f32_16x16x32_bf16 v[192:195], v[132:135], v[56:59], 0
    v_mfma_f32_16x16x32_bf16 v[196:199], v[132:135], v[64:67], 0
    v_mfma_f32_16x16x32_bf16 v[200:203], v[132:135], v[72:75], 0
    v_mfma_f32_16x16x32_bf16 v[204:207], v[132:135], v[80:83], 0
    v_mfma_f32_16x16x32_bf16 v[208:211], v[132:135], v[88:91], 0
    v_mfma_f32_16x16x32_bf16 v[212:215], v[132:135], v[96:99], 0
    v_mfma_f32_16x16x32_bf16 v[176:179], v[136:139], v[28:31], v[176:179]
    v_mfma_f32_16x16x32_bf16 v[180:183], v[136:139], v[36:39], v[180:183]
    v_mfma_f32_16x16x32_bf16 v[184:187], v[136:139], v[44:47], v[184:187]
    v_mfma_f32_16x16x32_bf16 v[188:191], v[136:139], v[52:55], v[188:191]
    v_mfma_f32_16x16x32_bf16 v[192:195], v[136:139], v[60:63], v[192:195]
    v_mfma_f32_16x16x32_bf16 v[196:199], v[136:139], v[68:71], v[196:199]
    v_mfma_f32_16x16x32_bf16 v[200:203], v[136:139], v[76:79], v[200:203]
    v_mfma_f32_16x16x32_bf16 v[204:207], v[136:139], v[84:87], v[204:207]
    v_mfma_f32_16x16x32_bf16 v[208:211], v[136:139], v[92:95], v[208:211]
    v_mfma_f32_16x16x32_bf16 v[212:215], v[136:139], v[100:103], v[212:215]
    v_lshlrev_b32 v2, 3, v1
    s_mul_i32 s60, s59, 1280
    s_mul_i32 s61, s63, 5120
    s_add_u32 s60, s60, s61
    s_add_u32 s60, s60, 131072
    s_add_u32 s61, s60, 138240
    v_mov_b32 v141, s52
    v_mov_b32 v143, s52
    v_mov_b32 v145, s52
    v_mov_b32 v147, s52
    v_mov_b32 v149, s52
    v_mov_b32 v151, s52
    s_mov_b32 exec_lo, 0xffff
    s_mov_b32 exec_hi, 0
    v_mov_b32 v140, v176
    v_mov_b32 v142, v177
    v_mov_b32 v144, v192
    v_mov_b32 v146, v193
    v_mov_b32 v148, v208
    v_mov_b32 v150, v209
    s_mov_b32 exec_lo, 0xffff0000
    s_mov_b32 exec_hi, 0
    v_mov_b32 v140, v180
    v_mov_b32 v142, v181
    v_mov_b32 v144, v196
    v_mov_b32 v146, v197
    v_mov_b32 v148, v212
    v_mov_b32 v150, v213
    s_mov_b32 exec_lo, 0
    s_mov_b32 exec_hi, 0xffff
    v_mov_b32 v140, v184
    v_mov_b32 v142, v185
    v_mov_b32 v144, v200
    v_mov_b32 v146, v201
    s_mov_b32 exec_lo, 0
    s_mov_b32 exec_hi, 0xffff0000
    v_mov_b32 v140, v188
    v_mov_b32 v142, v189
    v_mov_b32 v144, v204
    v_mov_b32 v146, v205
    s_mov_b64 exec, -1
    buffer_store_dwordx2 v[140:141], v2, s[28:31], s60 offen offset:0 sc1
    buffer_store_dwordx2 v[142:143], v2, s[28:31], s61 offen offset:0 sc1
    buffer_store_dwordx2 v[144:145], v2, s[28:31], s60 offen offset:512 sc1
    buffer_store_dwordx2 v[146:147], v2, s[28:31], s61 offen offset:512 sc1
    s_mov_b32 exec_hi, 0
    buffer_store_dwordx2 v[148:149], v2, s[28:31], s60 offen offset:1024 sc1
    buffer_store_dwordx2 v[150:151], v2, s[28:31], s61 offen offset:1024 sc1
    s_mov_b64 exec, -1
    s_branch K_END
FC_TOP:
    v_lshlrev_b32 v12, 4, v1
    s_mov_b32 s62, 0
    s_add_u32 s60, s62, 49152
    buffer_load_dwordx4 v[88:91], v12, s[28:31], s60 offen offset:0 sc1
    buffer_load_dwordx4 v[92:95], v12, s[28:31], s60 offen offset:1024 sc1
    buffer_load_dwordx4 v[96:99], v12, s[28:31], s60 offen offset:2048 sc1
    buffer_load_dwordx4 v[100:103], v12, s[28:31], s60 offen offset:3072 sc1
    s_add_u32 s60, s62, 53248
    buffer_load_dwordx4 v[104:107], v12, s[28:31], s60 offen offset:0 sc1
    buffer_load_dwordx4 v[108:111], v12, s[28:31], s60 offen offset:1024 sc1
    buffer_load_dwordx4 v[112:115], v12, s[28:31], s60 offen offset:2048 sc1
    buffer_load_dwordx4 v[116:119], v12, s[28:31], s60 offen offset:3072 sc1
    s_add_u32 s60, s62, 57344
    buffer_load_dwordx4 v[120:123], v12, s[28:31], s60 offen offset:0 sc1
    buffer_load_dwordx4 v[124:127], v12, s[28:31], s60 offen offset:1024 sc1
    buffer_load_dwordx4 v[128:131], v12, s[28:31], s60 offen offset:2048 sc1
    buffer_load_dwordx4 v[132:135], v12, s[28:31], s60 offen offset:3072 sc1
    s_add_u32 s60, s62, 61440
    buffer_load_dwordx4 v[136:139], v12, s[28:31], s60 offen offset:0 sc1
    buffer_load_dwordx4 v[140:143], v12, s[28:31], s60 offen offset:1024 sc1
    buffer_load_dwordx4 v[144:147], v12, s[28:31], s60 offen offset:2048 sc1
    buffer_load_dwordx4 v[148:151], v12, s[28:31], s60 offen offset:3072 sc1
    s_waitcnt vmcnt(0)
T_KY_CHK:
    v_xor_b32 v2, s52, v89
    v_bitop3_b32 v2, v91, s52, v2 bitop3:0xbe
    v_bitop3_b32 v2, v93, s52, v2 bitop3:0xbe
    v_bitop3_b32 v2, v95, s52, v2 bitop3:0xbe
    v_bitop3_b32 v2, v97, s52, v2 bitop3:0xbe
    v_bitop3_b32 v2, v99, s52, v2 bitop3:0xbe
    v_bitop3_b32 v2, v101, s52, v2 bitop3:0xbe
    v_bitop3_b32 v2, v103, s52, v2 bitop3:0xbe
    v_bitop3_b32 v2, v105, s52, v2 bitop3:0xbe
    v_bitop3_b32 v2, v107, s52, v2 bitop3:0xbe
    v_bitop3_b32 v2, v109, s52, v2 bitop3:0xbe
    v_bitop3_b32 v2, v111, s52, v2 bitop3:0xbe
    v_bitop3_b32 v2, v113, s52, v2 bitop3:0xbe
    v_bitop3_b32 v2, v115, s52, v2 bitop3:0xbe
    v_bitop3_b32 v2, v117, s52, v2 bitop3:0xbe
    v_bitop3_b32 v2, v119, s52, v2 bitop3:0xbe
    v_bitop3_b32 v2, v121, s52, v2 bitop3:0xbe
    v_bitop3_b32 v2, v123, s52, v2 bitop3:0xbe
    v_bitop3_b32 v2, v125, s52, v2 bitop3:0xbe
    v_bitop3_b32 v2, v127, s52, v2 bitop3:0xbe
    v_bitop3_b32 v2, v129, s52, v2 bitop3:0xbe
    v_bitop3_b32 v2, v131, s52, v2 bitop3:0xbe
    v_bitop3_b32 v2, v133, s52, v2 bitop3:0xbe
    v_bitop3_b32 v2, v135, s52, v2 bitop3:0xbe
    v_bitop3_b32 v2, v137, s52, v2 bitop3:0xbe
    v_bitop3_b32 v2, v139, s52, v2 bitop3:0xbe
    v_bitop3_b32 v2, v141, s52, v2 bitop3:0xbe
    v_bitop3_b32 v2, v143, s52, v2 bitop3:0xbe
    v_bitop3_b32 v2, v145, s52, v2 bitop3:0xbe
    v_bitop3_b32 v2, v147, s52, v2 bitop3:0xbe
    v_bitop3_b32 v2, v149, s52, v2 bitop3:0xbe
    v_bitop3_b32 v2, v151, s52, v2 bitop3:0xbe
    v_cmp_ne_u32 vcc, 0, v2
    s_cbranch_vccz T_KY_OK
T_KY_RETRY:
    s_add_u32 s100, s100, 1
    s_cmp_gt_u32 s100, 20000
    s_cbranch_scc1 T_KY_OK
    s_sleep 16
    s_add_u32 s60, s62, 49152
    buffer_load_dwordx4 v[88:91], v12, s[28:31], s60 offen offset:0 sc1
    buffer_load_dwordx4 v[92:95], v12, s[28:31], s60 offen offset:1024 sc1
    buffer_load_dwordx4 v[96:99], v12, s[28:31], s60 offen offset:2048 sc1
    buffer_load_dwordx4 v[100:103], v12, s[28:31], s60 offen offset:3072 sc1
    s_add_u32 s60, s62, 53248
    buffer_load_dwordx4 v[104:107], v12, s[28:31], s60 offen offset:0 sc1
    buffer_load_dwordx4 v[108:111], v12, s[28:31], s60 offen offset:1024 sc1
    buffer_load_dwordx4 v[112:115], v12, s[28:31], s60 offen offset:2048 sc1
    buffer_load_dwordx4 v[116:119], v12, s[28:31], s60 offen offset:3072 sc1
    s_add_u32 s60, s62, 57344
    buffer_load_dwordx4 v[120:123], v12, s[28:31], s60 offen offset:0 sc1
    buffer_load_dwordx4 v[124:127], v12, s[28:31], s60 offen offset:1024 sc1
    buffer_load_dwordx4 v[128:131], v12, s[28:31], s60 offen offset:2048 sc1
    buffer_load_dwordx4 v[132:135], v12, s[28:31], s60 offen offset:3072 sc1
    s_add_u32 s60, s62, 61440
    buffer_load_dwordx4 v[136:139], v12, s[28:31], s60 offen offset:0 sc1
    buffer_load_dwordx4 v[140:143], v12, s[28:31], s60 offen offset:1024 sc1
    buffer_load_dwordx4 v[144:147], v12, s[28:31], s60 offen offset:2048 sc1
    buffer_load_dwordx4 v[148:151], v12, s[28:31], s60 offen offset:3072 sc1
    s_waitcnt vmcnt(0)
    s_branch T_KY_CHK
T_KY_OK:
    v_max_u32 v20, v88, v90
    v_min_u32 v21, v88, v90
    v_med3_u32 v21, v20, v21, v92
    v_max_u32 v20, v20, v92
    v_med3_u32 v21, v20, v21, v94
    v_max_u32 v20, v20, v94
    v_med3_u32 v21, v20, v21, v96
    v_max_u32 v20, v20, v96
    v_med3_u32 v21, v20, v21, v98
    v_max_u32 v20, v20, v98
    v_med3_u32 v21, v20, v21, v100
    v_max_u32 v20, v20, v100
    v_med3_u32 v21, v20, v21, v102
    v_max_u32 v20, v20, v102
    v_med3_u32 v21, v20, v21, v104
    v_max_u32 v20, v20, v104
    v_med3_u32 v21, v20, v21, v106
    v_max_u32 v20, v20, v106
    v_med3_u32 v21, v20, v21, v108
    v_max_u32 v20, v20, v108
    v_med3_u32 v21, v20, v21, v110
    v_max_u32 v20, v20, v110
    v_med3_u32 v21, v20, v21, v112
    v_max_u32 v20, v20, v112
    v_med3_u32 v21, v20, v21, v114
    v_max_u32 v20, v20, v114
    v_med3_u32 v21, v20, v21, v116
    v_max_u32 v20, v20, v116
    v_med3_u32 v21, v20, v21, v118
    v_max_u32 v20, v20, v118
    v_med3_u32 v21, v20, v21, v120
    v_max_u32 v20, v20, v120
    v_med3_u32 v21, v20, v21, v122
    v_max_u32 v20, v20, v122
    v_med3_u32 v21, v20, v21, v124
    v_max_u32 v20, v20, v124
    v_med3_u32 v21, v20, v21, v126
    v_max_u32 v20, v20, v126
    v_med3_u32 v21, v20, v21, v128
    v_max_u32 v20, v20, v128
    v_med3_u32 v21, v20, v21, v130
    v_max_u32 v20, v20, v130
    v_med3_u32 v21, v20, v21, v132
    v_max_u32 v20, v20, v132
    v_med3_u32 v21, v20, v21, v134
    v_max_u32 v20, v20, v134
    v_med3_u32 v21, v20, v21, v136
    v_max_u32 v20, v20, v136
    v_med3_u32 v21, v20, v21, v138
    v_max_u32 v20, v20, v138
    v_med3_u32 v21, v20, v21, v140
    v_max_u32 v20, v20, v140
    v_med3_u32 v21, v20, v21, v142
    v_max_u32 v20, v20, v142
    v_med3_u32 v21, v20, v21, v144
    v_max_u32 v20, v20, v144
    v_med3_u32 v21, v20, v21, v146
    v_max_u32 v20, v20, v146
    v_med3_u32 v21, v20, v21, v148
    v_max_u32 v20, v20, v148
    v_med3_u32 v21, v20, v21, v150
    v_max_u32 v20, v20, v150
    s_nop 1
    v_mov_b32_dpp v22, v20 row_ror:8 row_mask:0xf bank_mask:0xf
    v_mov_b32_dpp v23, v21 row_ror:8 row_mask:0xf bank_mask:0xf
    v_min_u32 v2, v20, v22
    v_max_u32 v20, v20, v22
    v_max3_u32 v21, v21, v23, v2
    s_nop 0
    v_mov_b32_dpp v22, v20 row_ror:4 row_mask:0xf bank_mask:0xf
    v_mov_b32_dpp v23, v21 row_ror:4 row_mask:0xf bank_mask:0xf
    v_min_u32 v2, v20, v22
    v_max_u32 v20, v20, v22
    v_max3_u32 v21, v21, v23, v2
    s_nop 0
    v_mov_b32_dpp v22, v20 row_ror:2 row_mask:0xf bank_mask:0xf
    v_mov_b32_dpp v23, v21 row_ror:2 row_mask:0xf bank_mask:0xf
    v_min_u32 v2, v20, v22
    v_max_u32 v20, v20, v22
    v_max3_u32 v21, v21, v23, v2
    s_nop 0
    v_mov_b32_dpp v22, v20 row_ror:1 row_mask:0xf bank_mask:0xf
    v_mov_b32_dpp v23, v21 row_ror:1 row_mask:0xf bank_mask:0xf
    v_min_u32 v2, v20, v22
    v_max_u32 v20, v20, v22
    v_max3_u32 v21, v21, v23, v2
    v_mov_b32 v22, v20
    v_mov_b32 v23, v21
    s_nop 0
    v_permlane16_swap_b32 v20, v22
    v_permlane16_swap_b32 v21, v23
    v_min_u32 v2, v20, v22
    v_max_u32 v20, v20, v22
    v_max3_u32 v21, v21, v23, v2
    v_mov_b32 v22, v20
    v_mov_b32 v23, v21
    s_nop 0
    v_permlane32_swap_b32 v20, v22
    v_permlane32_swap_b32 v21, v23
    v_min_u32 v2, v20, v22
    v_max_u32 v20, v20, v22
    v_max3_u32 v21, v21, v23, v2
    s_mov_b64 exec, 0x1fffffff
    v_lshlrev_b32 v11, 7, v1
    s_movk_i32 s63, 8192
    buffer_load_dword v16, v11, s[28:31], s63 offen sc1
    v_mov_b32 v104, v20
    v_mov_b32 v106, v21
    s_waitcnt vmcnt(0)
T_FL_CHK:
    v_xor_b32 v2, s52, v16
    v_cmp_ne_u32 vcc, 0, v2
    s_cbranch_vccz T_FL_OK
T_FL_RETRY:
    s_add_u32 s100, s100, 1
    s_cmp_gt_u32 s100, 20000
    s_cbranch_scc1 T_FL_OK
    s_sleep 8
    s_movk_i32 s63, 8192
    buffer_load_dword v16, v11, s[28:31], s63 offen sc1
    s_waitcnt vmcnt(0)
    s_branch T_FL_CHK
T_FL_OK:
    s_mov_b64 exec, 0xff
    buffer_store_dwordx4 v[104:107], v15, s[28:31], 0 offen offset:256 sc1
    s_mov_b64 exec, 1
    buffer_store_dword v105, v15, s[28:31], 0 offen offset:0 sc1
    s_mov_b64 exec, -1
    s_branch K_END
K_END:
K_EXIT:
    s_endpgm
    .p2align 6
    .type K_TAB,@object
K_TAB:
    .long 0x18100800, 0x80808020, 0x18100800, 0x20, 0x0, 0x1400, 0x1e00, 0x0
    .long 0x0, 0x2, 0xff00ff00, 0xffffffff, 0xffffffff, 0xffffffff, 0xffffff00, 0xffffffff
    .long 0x18100800, 0x80808080, 0x18100800, 0x18, 0x6, 0x2000, 0x7ff00000, 0x1c00
    .long 0x0, 0x1, 0xff00ff00, 0xffffffff, 0xffffffff, 0xffffffff, 0xffffff00, 0xffffffff
    .long 0x80100800, 0x80808080, 0x8080000, 0x10, 0x6, 0x2500, 0x1d08, 0x5400
    .long 0x3800, 0x1, 0xff00, 0xffff, 0xffff, 0xffff, 0xffffff00, 0xffffffff
    .long 0x80800800, 0x80808080, 0x8080000, 0x8, 0x6, 0x2700, 0x7ff00000, 0x8c00
    .long 0x7000, 0x1, 0xff00, 0xffff, 0xffff, 0xffff, 0xffffff00, 0xffffffff
    .long 0x80808000, 0x80808080, 0x8080000, 0x0, 0x6, 0x7ff00000, 0x1f08, 0xc400
    .long 0xa800, 0x1, 0xff00, 0xffff, 0xffff, 0xffff, 0xffffff00, 0xffffffff
    .long 0x40383028, 0x80808048, 0x40383028, 0x48, 0x2, 0x0, 0x1800, 0x0
    .long 0x0, 0x0, 0xff00ff00, 0xffffffff, 0xffffffff, 0xffffffff, 0xffffff00, 0xffffffff
    .long 0x38302820, 0x80808040, 0x38302820, 0x40, 0x0, 0x400, 0x1a00, 0x0
    .long 0x0, 0x0, 0xff00ff00, 0xffffffff, 0xffffffff, 0xffffffff, 0xffffff00, 0xffffffff
    .long 0x30282018, 0x80808038, 0x30282018, 0x38, 0x0, 0x800, 0x1808, 0x0
    .long 0x0, 0x0, 0xff00ff00, 0xffffffff, 0xffffffff, 0xffffffff, 0xffffff00, 0xffffffff
    .long 0x28201810, 0x80808030, 0x28201810, 0x30, 0x0, 0xc00, 0x1a08, 0x0
    .long 0x0, 0x0, 0xff00ff00, 0xffffffff, 0xffffffff, 0xffffffff, 0xffffff00, 0xffffffff
    .long 0x20181008, 0x80808028, 0x20181008, 0x28, 0x0, 0x1000, 0x1c00, 0x0
    .long 0x0, 0x0, 0xff00ff00, 0xffffffff, 0xffffffff, 0xffffffff, 0xffffff00, 0xffffffff
    .long 0x68605850, 0x80808070, 0x68605850, 0x70, 0x4, 0x200, 0x1900, 0x0
    .long 0x0, 0x0, 0xff00ff00, 0xffffffff, 0xffffffff, 0xffffffff, 0xffffff00, 0xffffffff
    .long 0x60585048, 0x80808068, 0x60585048, 0x68, 0x2, 0x600, 0x1b00, 0x0
    .long 0x0, 0x0, 0xff00ff00, 0xffffffff, 0xffffffff, 0xffffffff, 0xffffff00, 0xffffffff
    .long 0x58504840, 0x80808060, 0x58504840, 0x60, 0x2, 0xa00, 0x1908, 0x0
    .long 0x0, 0x0, 0xff00ff00, 0xffffffff, 0xffffffff, 0xffffffff, 0xffffff00, 0xffffffff
    .long 0x50484038, 0x80808058, 0x50484038, 0x58, 0x2, 0xe00, 0x1b08, 0x0
    .long 0x0, 0x0, 0xff00ff00, 0xffffffff, 0xffffffff, 0xffffffff, 0xffffff00, 0xffffffff
    .long 0x48403830, 0x80808050, 0x48403830, 0x50, 0x2, 0x1200, 0x1d00, 0x0
    .long 0x0, 0x0, 0xff00ff00, 0xffffffff, 0xffffffff, 0xffffffff, 0xffffff00, 0xffffffff
    .long 0x80808078, 0x80808080, 0x80807878, 0x78, 0x6, 0x7ff00000, 0x1c08, 0x0
    .long 0x1c00, 0x1, 0xff00, 0xffff, 0xffff, 0xffff, 0xffffff00, 0xffffffff
    .long 0x80807870, 0x80808080, 0x78787070, 0x78, 0x4, 0x2400, 0x7ff00000, 0x3800
    .long 0x5400, 0x1, 0xff00, 0xffff, 0xffff, 0xffff, 0xffffff00, 0xffffffff
    .long 0x80787068, 0x80808080, 0x70706868, 0x78, 0x4, 0x2600, 0x1e08, 0x7000
    .long 0x8c00, 0x1, 0xff00, 0xffff, 0xffff, 0xffff, 0xffffff00, 0xffffffff
    .long 0x78706860, 0x80808080, 0x78706860, 0x78, 0x4, 0x2200, 0x7ff00000, 0xa800
    .long 0xc400, 0x1, 0xff00ff00, 0xffffffff, 0xffffffff, 0xffffffff, 0xffffff00, 0xffffffff
    .long 0x70686058, 0x80808078, 0x70686058, 0x78, 0x4, 0x1600, 0x1f00, 0x0
    .long 0x0, 0x2, 0xff00ff00, 0xffffffff, 0xffffffff, 0xffffffff, 0xffffff00, 0xffffffff
    .long 0x40383028, 0x80808048, 0x40383028, 0x48, 0x0, 0x14000, 0x15800, 0x0
    .long 0x0, 0x0, 0xffffffff, 0xffffffff, 0xffffffff, 0x0, 0xffffffff, 0xffff
    .long 0x38302820, 0x80808040, 0x38302820, 0x40, 0x6, 0x14400, 0x15a00, 0x0
    .long 0x0, 0x0, 0xffffffff, 0xffffffff, 0xffffffff, 0x0, 0xffffffff, 0xffff
    .long 0x30282018, 0x80808038, 0x30282018, 0x38, 0x6, 0x14800, 0x15808, 0x0
    .long 0x0, 0x0, 0xffffffff, 0xffffffff, 0xffffffff, 0x0, 0xffffffff, 0xffff
    .long 0x28201810, 0x80808030, 0x28201810, 0x30, 0x6, 0x14c00, 0x15a08, 0x0
    .long 0x0, 0x0, 0xffffffff, 0xffffffff, 0xffffffff, 0x0, 0xffffffff, 0xffff
    .long 0x20181008, 0x80808028, 0x20181008, 0x28, 0x6, 0x15000, 0x15c00, 0x0
    .long 0x0, 0x0, 0xffffffff, 0xffffffff, 0xffffffff, 0x0, 0xffffffff, 0xffff
    .long 0x18100800, 0x80808020, 0x18100800, 0x20, 0x2, 0x15400, 0x15e00, 0x0
    .long 0x0, 0x2, 0xffffffff, 0xffffffff, 0xffffffff, 0x0, 0xffffffff, 0xffff
    .long 0x18100800, 0x80808080, 0x18100800, 0x18, 0x0, 0x16000, 0x7ff00000, 0x2c00
    .long 0x1000, 0x1, 0xffffffff, 0xffffffff, 0xffffffff, 0x0, 0xffffffff, 0xffff
    .long 0x80100800, 0x80808080, 0x8080000, 0x10, 0x0, 0x16500, 0x15d08, 0x6400
    .long 0x4800, 0x1, 0xffff, 0xffff, 0xffff, 0x0, 0xffffffff, 0xffff
    .long 0x80800800, 0x80808080, 0x8080000, 0x8, 0x0, 0x16700, 0x7ff00000, 0x9c00
    .long 0x8000, 0x1, 0xffff, 0xffff, 0xffff, 0x0, 0xffffffff, 0xffff
    .long 0x80808000, 0x80808080, 0x8080000, 0x0, 0x0, 0x7ff00000, 0x15f08, 0xd400
    .long 0xb800, 0x1, 0xffff, 0xffff, 0xffff, 0x0, 0xffffffff, 0xffff
    .long 0x80808078, 0x80808080, 0x80807878, 0x78, 0x4, 0x7ff00000, 0x15c08, 0x1000
    .long 0x2c00, 0x1, 0xffff, 0xffff, 0xffff, 0x0, 0xffffffff, 0xffff
    .long 0x80807870, 0x80808080, 0x78787070, 0x78, 0x2, 0x16400, 0x7ff00000, 0x4800
    .long 0x6400, 0x1, 0xffff, 0xffff, 0xffff, 0x0, 0xffffffff, 0xffff
    .long 0x80787068, 0x80808080, 0x70706868, 0x78, 0x2, 0x16600, 0x15e08, 0x8000
    .long 0x9c00, 0x1, 0xffff, 0xffff, 0xffff, 0x0, 0xffffffff, 0xffff
    .long 0x78706860, 0x80808080, 0x78706860, 0x78, 0x2, 0x16200, 0x7ff00000, 0xb800
    .long 0xd400, 0x1, 0xffffffff, 0xffffffff, 0xffffffff, 0x0, 0xffffffff, 0xffff
    .long 0x70686058, 0x80808078, 0x70686058, 0x78, 0x2, 0x15600, 0x15f00, 0x0
    .long 0x0, 0x2, 0xffffffff, 0xffffffff, 0xffffffff, 0x0, 0xffffffff, 0xffff
    .long 0x68605850, 0x80808070, 0x68605850, 0x70, 0x6, 0x14200, 0x15900, 0x0
    .long 0x0, 0x0, 0xffffffff, 0xffffffff, 0xffffffff, 0x0, 0xffffffff, 0xffff
    .long 0x60585048, 0x80808068, 0x60585048, 0x68, 0x4, 0x14600, 0x15b00, 0x0
    .long 0x0, 0x0, 0xffffffff, 0xffffffff, 0xffffffff, 0x0, 0xffffffff, 0xffff
    .long 0x58504840, 0x80808060, 0x58504840, 0x60, 0x4, 0x14a00, 0x15908, 0x0
    .long 0x0, 0x0, 0xffffffff, 0xffffffff, 0xffffffff, 0x0, 0xffffffff, 0xffff
    .long 0x50484038, 0x80808058, 0x50484038, 0x58, 0x4, 0x14e00, 0x15b08, 0x0
    .long 0x0, 0x0, 0xffffffff, 0xffffffff, 0xffffffff, 0x0, 0xffffffff, 0xffff
    .long 0x48403830, 0x80808050, 0x48403830, 0x50, 0x4, 0x15200, 0x15d00, 0x0
    .long 0x0, 0x0, 0xffffffff, 0xffffffff, 0xffffffff, 0x0, 0xffffffff, 0xffff
    .fill (40960 - (. - recurrent_scan__sliding_local_dilated__moe_arch_mod__prompt_kernel)) / 4, 4, 0xbf810000
.section .rodata,"a"
.p2align 6
.amdhsa_kernel recurrent_scan__sliding_local_dilated__moe_arch_mod__prompt_kernel
  .amdhsa_next_free_vgpr 256
  .amdhsa_next_free_sgpr 102
  .amdhsa_accum_offset 256
  .amdhsa_group_segment_fixed_size 0
  .amdhsa_kernarg_size 88
  .amdhsa_user_sgpr_count 2
  .amdhsa_user_sgpr_kernarg_segment_ptr 1
  .amdhsa_system_sgpr_workgroup_id_x 1
.end_amdhsa_kernel
```
